```python
import torch

def _softmax(x, axis=-1):
    return torch.softmax(x, dim=axis)

def _gelu(x):
    return torch.nn.functional.gelu(x, approximate='tanh')

def _silu(x):
    return torch.nn.functional.silu(x)

def _sigmoid(x):
    return torch.sigmoid(x)

def _layernorm(x, axis=-1, eps=1e-05):
    m = x.mean(dim=axis, keepdim=True)
    v = x.var(dim=axis, keepdim=True, unbiased=False)
    return (x - m) / torch.sqrt(v + eps)

def _scatter_add(tgt, idx, src, axis=0):
    return tgt.clone().index_add_(axis, idx, src)

def _segment_sum(src, seg, n):
    out = torch.zeros((n,) + src.shape[1:], dtype=src.dtype)
    return out.index_add_(0, seg, src)

def _pad(x, pw):
    flat = tuple((v for pair in reversed(pw) for v in pair))
    return torch.nn.functional.pad(x, flat)
kernel_name = 'standalone__neighborhood_dinat__vision'

def setup_inputs():

    _w = lambda a: (lambda t: t.to(torch.bfloat16) if t.is_floating_point() else t)(torch.as_tensor(a))
    ks, dil, nh = (7, 2, 4)
    H = W = max(ks * dil, 224 // dil * dil)
    C = max(nh, 192 // nh * nh)
    return {'x': _w((lambda *s: torch.randn(*s, dtype=torch.bfloat16) * 0.2)(1, H, W, C)), 'wqkv': _w((lambda *s: torch.randn(*s, dtype=torch.bfloat16) * 0.2)(C, 3 * C)), 'wo': _w((lambda *s: torch.randn(*s, dtype=torch.bfloat16) * 0.4)(C, C)), 'rpb': _w((lambda *s: torch.randn(*s, dtype=torch.bfloat16) * 0.4)(nh, 2 * ks - 1, 2 * ks - 1))}

def reference(x, wqkv, wo, rpb):
    B, H, W, C = x.shape
    ks, dil, nh = (7, 2, 4)
    hd = C // nh
    scale = hd ** (-0.5)
    qkv = (x @ wqkv).reshape(B, H, W, 3, nh, hd)
    q = qkv[:, :, :, 0].clone()
    k = qkv[:, :, :, 1].clone()
    v = qkv[:, :, :, 2].clone()
    ih = torch.arange(H)
    iw = torch.arange(W)
    m = torch.arange(ks)
    sh = torch.clip(ih // dil - ks // 2, 0, H // dil - ks)
    sw = torch.clip(iw // dil - ks // 2, 0, W // dil - ks)
    kh = (sh[:, None] + m[None, :]) * dil + (ih % dil)[:, None]
    kw = (sw[:, None] + m[None, :]) * dil + (iw % dil)[:, None]
    rh = sh[:, None] + m[None, :] - (ih // dil)[:, None] + (ks - 1)
    rw = sw[:, None] + m[None, :] - (iw // dil)[:, None] + (ks - 1)
    ih4 = kh[:, :, None, None].clone()
    iw4 = kw[None, None, :, :].clone()
    kg = (lambda x, *d: x.permute(*d))(k[:, ih4, iw4, :, :], 0, 1, 3, 5, 2, 4, 6).reshape(B, H, W, nh, ks * ks, hd)
    vg = (lambda x, *d: x.permute(*d))(v[:, ih4, iw4, :, :], 0, 1, 3, 5, 2, 4, 6).reshape(B, H, W, nh, ks * ks, hd)
    bg = (lambda x, *d: x.permute(*d))(rpb[:, rh[:, :, None, None], rw[None, None, :, :]], 1, 3, 0, 2, 4).reshape(1, H, W, nh, ks * ks)
    logits = torch.einsum('bhwnd,bhwnkd->bhwnk', q, kg) * scale + bg
    attn = _softmax(logits, axis=-1)
    out = torch.einsum('bhwnk,bhwnkd->bhwnd', attn, vg).reshape(B, H, W, C)
    return out @ wo
```

```asm
; @launch grid=(256,1,1) block=(256,1,1) lds=163840
.amdgcn_target "amdgcn-amd-amdhsa--gfx950"
.text
.globl standalone__neighborhood_dinat__vision_kernel
.p2align 8
.type standalone__neighborhood_dinat__vision_kernel,@function
standalone__neighborhood_dinat__vision_kernel:
    s_cmp_ge_u32 s2, 0x100
    s_cbranch_scc1 L_exit
    s_load_dwordx8 s[52:59], s[0:1], 0
    s_load_dwordx2 s[60:61], s[0:1], 32
    s_load_dwordx2 s[62:63], s[0:1], 48
    s_getpc_b64 s[68:69]
    v_lshrrev_b32 v4, 6, v0
    s_nop 0
    v_readfirstlane_b32 s28, v4
    s_lshr_b32 s67, s2, 6
    s_and_b32 s3, s2, 1
    s_lshl_b32 s3, s3, 2
    s_or_b32 s64, s67, s3
    s_bfe_u32 s65, s2, 0x30003
    s_bfe_u32 s67, s2, 0x10002
    s_mul_i32 s66, s67, 0x15000
    s_bfe_u32 s67, s2, 0x10001
    s_mul_i32 s67, s67, 0x180
    s_add_u32 s66, s66, s67
    s_mul_i32 s67, s64, 14
    s_sub_u32 s67, s67, 3
    s_cmp_eq_u32 s64, 7
    s_cselect_b32 s35, 1, 0
    s_cselect_b32 s67, 0x72, s67
    s_mov_b32 s3, 0x2a000
    s_cselect_b32 s30, 0xfffd6000, s3
    s_cselect_b32 s33, 3, 0
    s_cselect_b32 s49, 0xffffffe6, 26
    s_cselect_b32 s48, 9, 3
    s_mul_i32 s48, s48, 26
    s_cmp_eq_u32 s64, 0
    s_cselect_b32 s33, 3, s33
    s_mul_i32 s32, s67, 0x2a000
    s_mul_i32 s67, s65, 14
    s_sub_u32 s67, s67, 3
    s_cmp_eq_u32 s65, 7
    s_cselect_b32 s36, 1, 0
    s_cselect_b32 s34, 1, 0
    s_cselect_b32 s64, 0x6b, s67
    s_cselect_b32 s67, 0x72, s67
    s_mov_b32 s3, 0x300
    s_cselect_b32 s31, 0xfffffd00, s3
    s_cmp_eq_u32 s65, 0
    s_cselect_b32 s34, 1, s34
    s_lshl_b32 s45, s31, 3
    s_mul_i32 s64, s64, 0x300
    s_add_u32 s64, s64, s66
    s_mul_i32 s3, s30, s28
    s_add_u32 s3, s3, s32
    s_max_i32 s40, s3, 0
    s_min_i32 s40, s40, 0x1236000
    s_add_u32 s40, s40, s64
    s_add_u32 s3, s3, s64
    s_lshl2_add_u32 s3, s30, s3
    s_mov_b32 s41, s3
    s_lshl2_add_u32 s3, s30, s3
    s_mov_b32 s42, s3
    s_lshl2_add_u32 s3, s30, s3
    s_mov_b32 s43, s3
    s_lshl2_add_u32 s3, s30, s3
    s_mov_b32 s44, s3
    s_mul_i32 s67, s67, 0x300
    s_add_u32 s32, s32, s67
    s_add_u32 s32, s32, s66
    s_mul_i32 s46, s28, 0x1e00
    s_mul_i32 s29, s28, 0x3000
    s_add_u32 s29, s29, 0x16800
    s_mul_i32 s39, s28, 0x60
    s_mul_i32 s37, s28, 0x1180
    s_add_u32 s37, s37, 0x239c0
    s_mul_i32 s67, s28, 0x152
    s_add_u32 s48, s48, s67
    s_mov_b32 s38, 0x3e553b95
    v_mbcnt_lo_u32_b32 v1, -1, 0
    v_mbcnt_hi_u32_b32 v1, -1, v1
    s_lshl_b32 s50, s28, 1
    s_mul_i32 s51, s36, 7
    v_add_u32 v2, 0, v1
    v_mul_u32_u24 v3, 0xaab, v2
    v_lshrrev_b32 v3, 16, v3
    v_mul_u32_u24 v4, 24, v3
    v_sub_u32 v2, v2, v4
    v_bfe_u32 v4, v3, 1, 1
    v_or_b32 v4, s50, v4
    v_xor_b32 v2, v2, v4
    v_xor_b32 v3, s51, v3
    v_mul_u32_u24 v3, 0x300, v3
    v_lshl_add_u32 v168, v2, 4, v3
    v_add_u32 v2, 64, v1
    v_mul_u32_u24 v3, 0xaab, v2
    v_lshrrev_b32 v3, 16, v3
    v_mul_u32_u24 v4, 24, v3
    v_sub_u32 v2, v2, v4
    v_bfe_u32 v4, v3, 1, 1
    v_or_b32 v4, s50, v4
    v_xor_b32 v2, v2, v4
    v_xor_b32 v3, s51, v3
    v_mul_u32_u24 v3, 0x300, v3
    v_lshl_add_u32 v169, v2, 4, v3
    v_add_u32 v2, 0x80, v1
    v_mul_u32_u24 v3, 0xaab, v2
    v_lshrrev_b32 v3, 16, v3
    v_mul_u32_u24 v4, 24, v3
    v_sub_u32 v2, v2, v4
    v_bfe_u32 v4, v3, 1, 1
    v_or_b32 v4, s50, v4
    v_xor_b32 v2, v2, v4
    v_xor_b32 v3, s51, v3
    v_mul_u32_u24 v3, 0x300, v3
    v_lshl_add_u32 v170, v2, 4, v3
    v_add_u32 v2, 32, v1
    v_mul_u32_u24 v3, 0xaab, v2
    v_lshrrev_b32 v3, 16, v3
    v_mul_u32_u24 v4, 24, v3
    v_sub_u32 v2, v2, v4
    v_bfe_u32 v4, v3, 1, 1
    v_or_b32 v4, s50, v4
    v_xor_b32 v2, v2, v4
    v_xor_b32 v3, s51, v3
    v_mul_u32_u24 v3, 0x300, v3
    v_lshl_add_u32 v171, v2, 4, v3
    v_add_u32 v2, 0, v1
    v_mul_u32_u24 v3, 0x2aab, v2
    v_lshrrev_b32 v3, 16, v3
    v_mul_u32_u24 v4, 6, v3
    v_sub_u32 v2, v2, v4
    v_lshrrev_b32 v4, 1, v3
    v_and_b32 v4, 4, v4
    v_xor_b32 v3, v3, v4
    v_mul_u32_u24 v3, 0x480, v3
    v_lshl_add_u32 v172, v2, 4, v3
    v_add_u32 v2, 64, v1
    v_mul_u32_u24 v3, 0x2aab, v2
    v_lshrrev_b32 v3, 16, v3
    v_mul_u32_u24 v4, 6, v3
    v_sub_u32 v2, v2, v4
    v_lshrrev_b32 v4, 1, v3
    v_and_b32 v4, 4, v4
    v_xor_b32 v3, v3, v4
    v_mul_u32_u24 v3, 0x480, v3
    v_lshl_add_u32 v173, v2, 4, v3
    v_add_u32 v2, 0x80, v1
    v_mul_u32_u24 v3, 0x2aab, v2
    v_lshrrev_b32 v3, 16, v3
    v_mul_u32_u24 v4, 6, v3
    v_sub_u32 v2, v2, v4
    v_lshrrev_b32 v4, 1, v3
    v_and_b32 v4, 4, v4
    v_xor_b32 v3, v3, v4
    v_mul_u32_u24 v3, 0x480, v3
    v_lshl_add_u32 v174, v2, 4, v3
    s_waitcnt lgkmcnt(0)
    s_mov_b32 s4, s52
    s_and_b32 s5, s53, 0xffff
    s_mov_b32 s6, 0x1260000
    s_mov_b32 s7, 0x20000
    s_mov_b32 s8, s54
    s_and_b32 s9, s55, 0xffff
    s_mov_b32 s10, 0x36000
    s_mov_b32 s11, 0x20000
    s_mov_b32 s12, s56
    s_and_b32 s13, s57, 0xffff
    s_mov_b32 s14, 0x12000
    s_mov_b32 s15, 0x20000
    s_mov_b32 s16, s58
    s_and_b32 s17, s59, 0xffff
    s_mov_b32 s18, 0x548
    s_mov_b32 s19, 0x20000
    s_mov_b32 s20, s60
    s_and_b32 s21, s61, 0xffff
    s_mov_b32 s22, 0x1260000
    s_mov_b32 s23, 0x20000
    s_mov_b32 s24, s62
    s_and_b32 s25, s63, 0xffff
    s_mov_b32 s26, 0x12000
    s_mov_b32 s27, 0x20000
    v_lshl_add_u32 v8, s28, 6, v1
    v_lshlrev_b32 v9, 5, v8
    s_lshr_b32 s66, s2, 3
    s_mul_i32 s67, s66, 0x1b00
    buffer_load_dword v10, v9, s[8:11], s67 offen
    s_mul_i32 s67, s66, 0x900
    v_lshlrev_b32 v11, 4, v8
    buffer_load_dword v10, v11, s[12:15], s67 offen
    s_lshl_b32 s67, s66, 11
    v_lshlrev_b32 v12, 3, v8
    v_add_u32 v12, s67, v12
    global_load_dword v10, v12, s[68:69]
    s_add_u32 s51, s39, 0x180
    s_add_u32 m0, s29, 0
    v_add_u32 v5, s40, v168
    buffer_load_dwordx4 v172, s[8:11], s51 offen lds
    s_add_u32 m0, s29, 0x400
    v_max_i32 v5, 0, v5
    buffer_load_dwordx4 v173, s[8:11], s51 offen lds
    s_add_u32 m0, s29, 0x800
    v_add_u32 v6, s40, v169
    buffer_load_dwordx4 v174, s[8:11], s51 offen lds
    s_add_u32 m0, s46, 0
    v_max_i32 v6, 0, v6
    buffer_load_dwordx4 v5, s[4:7], 0 offen lds
    s_add_u32 m0, s46, 0x400
    v_add_u32 v7, s40, v170
    buffer_load_dwordx4 v6, s[4:7], 0 offen lds
    s_add_u32 m0, s46, 0x800
    v_max_i32 v7, 0, v7
    buffer_load_dwordx4 v7, s[4:7], 0 offen lds
    s_add_u32 s52, s40, s45
    s_add_u32 m0, s46, 0xc00
    s_add_u32 s53, s40, s45
    buffer_load_dwordx4 v168, s[4:7], s52 offen lds
    s_add_u32 m0, s46, 0x1000
    s_add_u32 s54, s40, s45
    buffer_load_dwordx4 v169, s[4:7], s53 offen lds
    s_add_u32 m0, s46, 0x1400
    s_lshl1_add_u32 s55, s45, s40
    buffer_load_dwordx4 v170, s[4:7], s54 offen lds
    s_add_u32 m0, s46, 0x1800
    s_lshl1_add_u32 s56, s45, s40
    s_add_u32 s57, s39, 0x9180
    s_add_u32 s58, s39, 0x12180
    s_add_u32 s59, s39, 0x1b180
    v_and_b32 v13, 15, v1
    v_lshrrev_b32 v14, 4, v1
    v_lshrrev_b32 v15, 2, v13
    v_and_b32 v16, 3, v13
    v_and_b32 v17, 1, v14
    v_lshl_add_u32 v18, v14, 3, v15
    v_xor_b32 v19, 0, v17
    v_lshl_add_u32 v19, v19, 2, v18
    v_mul_u32_u24 v19, 0x60, v19
    v_lshl_add_u32 v19, v16, 3, v19
    v_add_u32 v249, s29, v19
    v_xor_b32 v19, 1, v17
    v_lshl_add_u32 v19, v19, 2, v18
    v_mul_u32_u24 v19, 0x60, v19
    v_lshl_add_u32 v19, v16, 3, v19
    v_add_u32 v250, s29, v19
    v_mov_b32 v17, v15
    v_and_b32 v18, 3, v17
    v_mul_u32_u24 v17, 0x1e00, v17
    v_lshlrev_b32 v18, 1, v18
    v_bfe_u32 v241, v16, 1, 1
    v_or_b32 v18, v18, v241
    v_xor_b32 v18, v18, v14
    v_lshl_add_u32 v17, v18, 4, v17
    v_mul_u32_u24 v18, 0x180, v16
    v_add_u32 v240, v17, v18
    v_xor_b32 v241, 64, v240
    s_add_u32 s54, s39, 0x24180
    v_mbcnt_lo_u32_b32 v24, -1, 0
    v_mbcnt_hi_u32_b32 v24, -1, v24
    v_add_u32 v25, 0, v24
    v_mul_u32_u24 v26, 0x2aab, v25
    v_lshrrev_b32 v26, 16, v26
    v_mul_u32_u24 v27, 6, v26
    v_sub_u32 v25, v25, v27
    v_lshrrev_b32 v27, 1, v26
    v_and_b32 v27, 4, v27
    v_xor_b32 v26, v26, v27
    v_mul_u32_u24 v26, 0x180, v26
    v_lshl_add_u32 v28, v25, 4, v26
    v_add_u32 v25, 64, v24
    v_mul_u32_u24 v26, 0x2aab, v25
    v_lshrrev_b32 v26, 16, v26
    v_mul_u32_u24 v27, 6, v26
    v_sub_u32 v25, v25, v27
    v_lshrrev_b32 v27, 1, v26
    v_and_b32 v27, 4, v27
    v_xor_b32 v26, v26, v27
    v_mul_u32_u24 v26, 0x180, v26
    v_lshl_add_u32 v29, v25, 4, v26
    v_add_u32 v25, 0x80, v24
    v_mul_u32_u24 v26, 0x2aab, v25
    v_lshrrev_b32 v26, 16, v26
    v_mul_u32_u24 v27, 6, v26
    v_sub_u32 v25, v25, v27
    v_lshrrev_b32 v27, 1, v26
    v_and_b32 v27, 4, v27
    v_xor_b32 v26, v26, v27
    v_mul_u32_u24 v26, 0x180, v26
    v_lshl_add_u32 v58, v25, 4, v26
    v_mbcnt_lo_u32_b32 v253, -1, 0
    v_mbcnt_hi_u32_b32 v253, -1, v253
    v_and_b32 v253, 2, v253
    s_lshl2_add_u32 s67, s28, 0x23000
    v_add_u32 v17, 3, v15
    v_add_u32 v19, 3, v16
    v_and_b32 v18, 3, v17
    v_mul_u32_u24 v17, 0x1e00, v17
    v_lshlrev_b32 v18, 1, v18
    v_bfe_u32 v243, v19, 1, 1
    v_or_b32 v18, v18, v243
    v_xor_b32 v18, v18, v14
    v_lshl_add_u32 v17, v18, 4, v17
    v_mul_u32_u24 v18, 0x180, v19
    v_add_u32 v242, v17, v18
    v_xor_b32 v243, 64, v242
    v_accvgpr_write_b32 a252, v168
    v_accvgpr_read_b32 v254, a252
    v_accvgpr_write_b32 a253, v169
    v_accvgpr_read_b32 v255, a253
    v_accvgpr_write_b32 a254, v170
    v_accvgpr_write_b32 a255, v171
    v_mov_b32 v17, 0x3f803f80
    v_accvgpr_write_b32 a248, v17
    v_accvgpr_write_b32 a249, v17
    v_accvgpr_write_b32 a250, v17
    v_accvgpr_write_b32 a251, v17
    v_mov_b32 v248, 0
    v_mul_u32_u24 v17, 0x1a0, v13
    v_lshl_add_u32 v17, v14, 3, v17
    v_add_u32 v17, s39, v17
    v_add_u32 v247, 0x7800, v17
    v_add_u32 v251, 0x1e000, v17
    v_sub_u32 v17, v14, v15
    v_mul_i32_i24 v17, 0x1c0, v17
    v_lshlrev_b32 v18, 4, v16
    v_sub_u32 v17, v17, v18
    v_add_u32 v17, s37, v17
    v_max_u32 v18, s33, v15
    v_sub_u32 v18, v14, v18
    v_add_u32 v244, 0, v18
    v_cmp_gt_u32 vcc, 7, v244
    v_add_u32 v244, 0xfffdc870, v17
    v_add_u32 v245, 4, v18
    v_cndmask_b32 v244, 0, v244, vcc
    v_add_u32 v244, 0x237c0, v244
    v_cmp_gt_u32 vcc, 7, v245
    v_add_u32 v245, 0xfffdcf70, v17
    v_add_u32 v246, 8, v18
    v_cndmask_b32 v245, 0, v245, vcc
    v_add_u32 v245, 0x237c0, v245
    v_cmp_gt_u32 vcc, 7, v246
    v_add_u32 v246, 0xfffdd670, v17
    v_min_u32 v20, 55, v1
    v_cndmask_b32 v246, 0, v246, vcc
    v_add_u32 v246, 0x237c0, v246
    v_lshlrev_b32 v62, 3, v20
    v_add_u32 v62, s37, v62
    v_lshrrev_b32 v21, 1, v20
    v_and_b32 v20, 1, v20
    v_lshlrev_b32 v20, 1, v20
    v_add_u32 v22, -12, v21
    v_cmp_lt_u32 vcc, 11, v21
    v_mov_b32 v23, s34
    s_lshl_b32 s66, s36, 1
    v_cndmask_b32 v22, v21, v22, vcc
    v_cndmask_b32 v23, 0, v23, vcc
    s_sub_u32 s66, 1, s66
    v_add_u32 v63, 0, v20
    v_add3_u32 v64, v22, v63, -6
    v_add_u32 v65, 3, v64
    v_and_b32 v66, 12, v22
    v_add3_u32 v66, v66, v63, -3
    v_cmp_ne_u32 vcc, 0, v23
    v_mul_i32_i24 v64, s66, v64
    v_add_lshl_u32 v64, v64, 6, 1
    v_cndmask_b32 v65, v65, v66, vcc
    v_cmp_gt_u32 vcc, 7, v65
    v_mov_b32 v65, 0xf149f2ca
    v_add_u32 v63, 1, v20
    v_cndmask_b32 v50, 0, v64, vcc
    v_mov_b32 v64, 0x3fb8aa3b
    v_cndmask_b32 v52, 0, v64, vcc
    v_mov_b32 v64, 0
    v_cndmask_b32 v60, v65, v64, vcc
    v_add3_u32 v64, v22, v63, -6
    v_add_u32 v65, 3, v64
    v_and_b32 v66, 12, v22
    v_add3_u32 v66, v66, v63, -3
    v_cmp_ne_u32 vcc, 0, v23
    v_mul_i32_i24 v64, s66, v64
    s_mul_i32 s66, s28, 0x4800
    v_lshl_add_u32 v89, v24, 4, s66
    v_and_b32 v24, 3, v24
    v_lshl_add_u32 v59, v24, 3, v249
    v_lshl_add_u32 v88, v24, 3, v250
    s_mul_i32 s66, s28, 0x4800
    v_cndmask_b32 v65, v65, v66, vcc
    v_cmp_gt_u32 vcc, 7, v65
    v_add_lshl_u32 v64, v64, 6, 1
    v_mov_b32 v65, 0xf149f2ca
    v_cndmask_b32 v51, 0, v64, vcc
    v_mov_b32 v64, 0x3fb8aa3b
    v_cndmask_b32 v53, 0, v64, vcc
    v_mov_b32 v64, 0
    v_cndmask_b32 v61, v65, v64, vcc
    v_cmp_eq_u32 vcc, 0, v253
    v_add_u32 v253, 0xfffdd200, v247
    s_mul_i32 s60, s49, 0
    v_cndmask_b32 v253, 0, v253, vcc
    v_add_u32 v253, 0x22e00, v253
    s_add_u32 s60, s60, s48
    buffer_load_ushort v30, v50, s[16:19], s60 offen
    buffer_load_ushort v31, v51, s[16:19], s60 offen
    s_lshl1_add_u32 s60, s45, s41
    s_mul_i32 s61, s49, 1
    s_add_u32 s61, s61, s48
    buffer_load_ushort v32, v50, s[16:19], s61 offen
    buffer_load_ushort v33, v51, s[16:19], s61 offen
    s_add_u32 s61, s39, 0x300
    s_mul_i32 s62, s49, 2
    s_add_u32 s62, s62, s48
    buffer_load_ushort v34, v50, s[16:19], s62 offen
    buffer_load_ushort v35, v51, s[16:19], s62 offen
    s_add_u32 s62, s39, 0x9300
    s_mul_i32 s63, s49, 3
    s_add_u32 s63, s63, s48
    buffer_load_ushort v36, v50, s[16:19], s63 offen
    buffer_load_ushort v37, v51, s[16:19], s63 offen
    s_add_u32 s63, s39, 0x12300
    s_mul_i32 s64, s49, 4
    s_add_u32 s64, s64, s48
    buffer_load_ushort v38, v50, s[16:19], s64 offen
    buffer_load_ushort v39, v51, s[16:19], s64 offen
    s_add_u32 s64, s39, 0x1b300
    s_mul_i32 s65, s49, 5
    s_add_u32 s65, s65, s48
    buffer_load_ushort v40, v50, s[16:19], s65 offen
    buffer_load_ushort v41, v51, s[16:19], s65 offen
    s_add_u32 s65, s42, s45
    s_mul_i32 s50, s49, 6
    s_add_u32 s50, s50, s48
    buffer_load_ushort v42, v50, s[16:19], s50 offen
    buffer_load_ushort v43, v51, s[16:19], s50 offen
    s_add_u32 s50, s42, s45
    s_mul_i32 s51, s49, 7
    s_add_u32 s51, s51, s48
    buffer_load_ushort v44, v50, s[16:19], s51 offen
    buffer_load_ushort v45, v51, s[16:19], s51 offen
    s_add_u32 s51, s42, s45
    buffer_load_dwordx4 v168, s[4:7], s55 offen lds
    s_add_u32 m0, s46, 0x1a00
    s_add_u32 s55, s39, 0x2d180
    s_mul_i32 s52, s49, 8
    s_add_u32 s52, s52, s48
    buffer_load_ushort v46, v50, s[16:19], s52 offen
    buffer_load_ushort v47, v51, s[16:19], s52 offen
    s_lshl1_add_u32 s52, s45, s42
    s_mul_i32 s53, s49, 9
    s_add_u32 s53, s53, s48
    buffer_load_ushort v48, v50, s[16:19], s53 offen
    buffer_load_ushort v49, v51, s[16:19], s53 offen
    s_lshl1_add_u32 s53, s45, s42
    v_mov_b32 v64, 0xf149f2ca
    v_mov_b32 v65, 0xf149f2ca
    v_lshlrev_b32 v63, 3, v1
    v_add_u32 v63, 0x237c0, v63
    ds_write_b64 v63, v[64:65] offset:0
    buffer_load_dwordx4 v171, s[4:7], s56 offen lds
    s_add_u32 m0, s29, 0xc00
    s_add_u32 s56, s41, s45
    buffer_load_dwordx4 v172, s[8:11], s57 offen lds
    s_waitcnt vmcnt(29)
    s_add_u32 m0, s29, 0x1000
    ds_read_b64_tr_b16 a[0:1], v249 offset:0
    ds_read_b64_tr_b16 a[2:3], v250 offset:0
    ds_read_b64_tr_b16 a[24:25], v249 offset:32
    ds_read_b64_tr_b16 a[26:27], v250 offset:32
    ds_read_b64_tr_b16 a[48:49], v249 offset:64
    ds_read_b64_tr_b16 a[50:51], v250 offset:64
    buffer_load_dwordx4 v173, s[8:11], s57 offen lds
    s_add_u32 m0, s29, 0x1400
    s_nop 0
    buffer_load_dwordx4 v174, s[8:11], s57 offen lds
    s_add_u32 m0, s29, 0x1800
    s_add_u32 s57, s41, s45
    buffer_load_dwordx4 v172, s[8:11], s58 offen lds
    s_add_u32 m0, s29, 0x1c00
    s_nop 0
    buffer_load_dwordx4 v173, s[8:11], s58 offen lds
    s_add_u32 m0, s29, 0x2000
    s_nop 0
    buffer_load_dwordx4 v174, s[8:11], s58 offen lds
    s_add_u32 m0, s29, 0x2400
    s_add_u32 s58, s41, s45
    buffer_load_dwordx4 v172, s[8:11], s59 offen lds
    s_add_u32 m0, s29, 0x2800
    s_nop 0
    s_waitcnt vmcnt(28)
    v_lshlrev_b32 v30, 16, v30
    v_fma_f32 v30, v30, v52, v60
    s_waitcnt vmcnt(27)
    v_lshlrev_b32 v31, 16, v31
    v_fma_f32 v31, v31, v53, v61
    ds_write_b64 v62, v[30:31] offset:0
    s_waitcnt vmcnt(26)
    v_lshlrev_b32 v32, 16, v32
    v_fma_f32 v32, v32, v52, v60
    s_waitcnt vmcnt(25)
    v_lshlrev_b32 v33, 16, v33
    v_fma_f32 v33, v33, v53, v61
    ds_write_b64 v62, v[32:33] offset:448
    s_waitcnt vmcnt(23)
    v_lshlrev_b32 v34, 16, v34
    v_fma_f32 v34, v34, v52, v60
    v_lshlrev_b32 v35, 16, v35
    v_fma_f32 v35, v35, v53, v61
    ds_write_b64 v62, v[34:35] offset:896
    s_waitcnt vmcnt(21)
    v_lshlrev_b32 v36, 16, v36
    v_fma_f32 v36, v36, v52, v60
    v_lshlrev_b32 v37, 16, v37
    v_fma_f32 v37, v37, v53, v61
    ds_write_b64 v62, v[36:37] offset:1344
    s_waitcnt vmcnt(19)
    v_lshlrev_b32 v38, 16, v38
    v_fma_f32 v38, v38, v52, v60
    v_lshlrev_b32 v39, 16, v39
    v_fma_f32 v39, v39, v53, v61
    ds_write_b64 v62, v[38:39] offset:1792
    s_waitcnt vmcnt(16)
    v_lshlrev_b32 v40, 16, v40
    v_fma_f32 v40, v40, v52, v60
    v_lshlrev_b32 v41, 16, v41
    v_fma_f32 v41, v41, v53, v61
    ds_write_b64 v62, v[40:41] offset:2240
    s_waitcnt vmcnt(14)
    v_lshlrev_b32 v42, 16, v42
    v_fma_f32 v42, v42, v52, v60
    v_lshlrev_b32 v43, 16, v43
    v_fma_f32 v43, v43, v53, v61
    ds_write_b64 v62, v[42:43] offset:2688
    s_waitcnt vmcnt(13)
    v_lshlrev_b32 v44, 16, v44
    v_fma_f32 v44, v44, v52, v60
    v_lshlrev_b32 v45, 16, v45
    v_fma_f32 v45, v45, v53, v61
    ds_write_b64 v62, v[44:45] offset:3136
    buffer_load_dwordx4 v173, s[8:11], s59 offen lds
    s_add_u32 m0, s29, 0x2c00
    s_nop 0
    s_waitcnt vmcnt(12)
    v_lshlrev_b32 v46, 16, v46
    v_fma_f32 v46, v46, v52, v60
    s_waitcnt vmcnt(11)
    v_lshlrev_b32 v47, 16, v47
    v_fma_f32 v47, v47, v53, v61
    ds_write_b64 v62, v[46:47] offset:3584
    s_waitcnt vmcnt(10)
    v_lshlrev_b32 v48, 16, v48
    v_fma_f32 v48, v48, v52, v60
    s_waitcnt vmcnt(9)
    v_lshlrev_b32 v49, 16, v49
    v_fma_f32 v49, v49, v53, v61
    ds_write_b64 v62, v[48:49] offset:4032
    buffer_load_dwordx4 v174, s[8:11], s59 offen lds
    s_waitcnt vmcnt(9)
    s_add_u32 m0, s29, 0
    s_lshl1_add_u32 s59, s45, s41
    s_barrier
    ds_read_b128 a[216:219], v240 offset:0
    s_waitcnt lgkmcnt(2)
    ds_read_b128 a[220:223], v240 offset:1536
    ds_read_b128 a[224:227], v240 offset:3072
    ds_read_b128 a[228:231], v240 offset:4608
    ds_read_b128 a[232:235], v241 offset:0
    ds_read_b128 a[236:239], v241 offset:1536
    ds_read_b128 a[240:243], v241 offset:3072
    ds_read_b128 a[244:247], v241 offset:4608
    buffer_load_dwordx4 v172, s[8:11], s54 offen lds
    s_add_u32 m0, s29, 0x400
    s_nop 0
    s_waitcnt lgkmcnt(7)
    v_mfma_f32_16x16x32_bf16 v[180:183], a[0:3], a[216:219], 0
    s_waitcnt lgkmcnt(6)
    v_mfma_f32_16x16x32_bf16 v[184:187], a[24:27], a[216:219], 0
    s_waitcnt lgkmcnt(4)
    v_mfma_f32_16x16x32_bf16 v[188:191], a[48:51], a[216:219], 0
    ds_read_b128 a[216:219], v240 offset:128
    v_mfma_f32_16x16x32_bf16 v[192:195], a[0:3], a[220:223], 0
    v_mfma_f32_16x16x32_bf16 v[196:199], a[24:27], a[220:223], 0
    buffer_load_dwordx4 v173, s[8:11], s54 offen lds
    s_add_u32 m0, s29, 0x800
    v_mfma_f32_16x16x32_bf16 v[200:203], a[48:51], a[220:223], 0
    ds_read_b128 a[220:223], v240 offset:1664
    v_mfma_f32_16x16x32_bf16 v[204:207], a[0:3], a[224:227], 0
    v_mfma_f32_16x16x32_bf16 v[208:211], a[24:27], a[224:227], 0
    v_mfma_f32_16x16x32_bf16 v[212:215], a[48:51], a[224:227], 0
    ds_read_b128 a[224:227], v240 offset:3200
    v_mfma_f32_16x16x32_bf16 v[216:219], a[0:3], a[228:231], 0
    v_mfma_f32_16x16x32_bf16 v[220:223], a[24:27], a[228:231], 0
    v_mfma_f32_16x16x32_bf16 v[224:227], a[48:51], a[228:231], 0
    s_waitcnt vmcnt(8)
    buffer_load_dwordx4 v174, s[8:11], s54 offen lds
    ds_read_b64_tr_b16 a[4:5], v249 offset:3072
    ds_read_b64_tr_b16 a[6:7], v250 offset:3072
    ds_read_b64_tr_b16 a[28:29], v249 offset:3104
    ds_read_b64_tr_b16 a[30:31], v250 offset:3104
    ds_read_b64_tr_b16 a[52:53], v249 offset:3136
    ds_read_b64_tr_b16 a[54:55], v250 offset:3136
    s_add_u32 m0, s29, 0xc00
    ds_read_b128 a[228:231], v240 offset:4736
    s_add_u32 s54, s39, 0x24300
    s_waitcnt lgkmcnt(5)
    v_mfma_f32_16x16x32_bf16 v[180:183], a[4:7], a[232:235], v[180:183]
    v_mfma_f32_16x16x32_bf16 v[192:195], a[4:7], a[236:239], v[192:195]
    s_waitcnt lgkmcnt(2)
    v_mfma_f32_16x16x32_bf16 v[184:187], a[28:31], a[232:235], v[184:187]
    s_waitcnt lgkmcnt(0)
    buffer_load_dwordx4 v172, s[8:11], s55 offen lds
    v_mfma_f32_16x16x32_bf16 v[188:191], a[52:55], a[232:235], v[188:191]
    ds_read_b128 a[232:235], v241 offset:128
    s_add_u32 m0, s29, 0x1000
    v_mfma_f32_16x16x32_bf16 v[196:199], a[28:31], a[236:239], v[196:199]
    buffer_load_dwordx4 v173, s[8:11], s55 offen lds
    s_add_u32 m0, s29, 0x1400
    v_mfma_f32_16x16x32_bf16 v[200:203], a[52:55], a[236:239], v[200:203]
    ds_read_b128 a[236:239], v241 offset:1664
    v_mfma_f32_16x16x32_bf16 v[204:207], a[4:7], a[240:243], v[204:207]
    v_mfma_f32_16x16x32_bf16 v[208:211], a[28:31], a[240:243], v[208:211]
    v_mfma_f32_16x16x32_bf16 v[212:215], a[52:55], a[240:243], v[212:215]
    ds_read_b128 a[240:243], v241 offset:3200
    v_mfma_f32_16x16x32_bf16 v[216:219], a[4:7], a[244:247], v[216:219]
    v_mfma_f32_16x16x32_bf16 v[220:223], a[28:31], a[244:247], v[220:223]
    v_mfma_f32_16x16x32_bf16 v[224:227], a[52:55], a[244:247], v[224:227]
    s_waitcnt vmcnt(8)
    buffer_load_dwordx4 v174, s[8:11], s55 offen lds
    s_add_u32 m0, s46, 0x7800
    ds_read_b64_tr_b16 a[8:9], v249 offset:6144
    ds_read_b64_tr_b16 a[10:11], v250 offset:6144
    ds_read_b64_tr_b16 a[32:33], v249 offset:6176
    ds_read_b64_tr_b16 a[34:35], v250 offset:6176
    ds_read_b64_tr_b16 a[56:57], v249 offset:6208
    ds_read_b64_tr_b16 a[58:59], v250 offset:6208
    ds_read_b128 a[244:247], v241 offset:4736
    s_add_u32 s55, s39, 0x2d300
    buffer_load_dwordx4 v168, s[4:7], s41 offen lds
    s_add_u32 m0, s46, 0x7c00
    s_nop 0
    s_waitcnt lgkmcnt(5)
    v_mfma_f32_16x16x32_bf16 v[180:183], a[8:11], a[216:219], v[180:183]
    v_mfma_f32_16x16x32_bf16 v[192:195], a[8:11], a[220:223], v[192:195]
    s_waitcnt lgkmcnt(2)
    v_mfma_f32_16x16x32_bf16 v[184:187], a[32:35], a[216:219], v[184:187]
    s_waitcnt lgkmcnt(0)
    v_mfma_f32_16x16x32_bf16 v[188:191], a[56:59], a[216:219], v[188:191]
    ds_read_b128 a[216:219], v240 offset:256
    v_mfma_f32_16x16x32_bf16 v[196:199], a[32:35], a[220:223], v[196:199]
    buffer_load_dwordx4 v169, s[4:7], s41 offen lds
    s_add_u32 m0, s46, 0x8000
    v_mfma_f32_16x16x32_bf16 v[200:203], a[56:59], a[220:223], v[200:203]
    ds_read_b128 a[220:223], v240 offset:1792
    v_mfma_f32_16x16x32_bf16 v[204:207], a[8:11], a[224:227], v[204:207]
    v_mfma_f32_16x16x32_bf16 v[208:211], a[32:35], a[224:227], v[208:211]
    v_mfma_f32_16x16x32_bf16 v[212:215], a[56:59], a[224:227], v[212:215]
    ds_read_b128 a[224:227], v240 offset:3328
    v_mfma_f32_16x16x32_bf16 v[216:219], a[8:11], a[228:231], v[216:219]
    v_mfma_f32_16x16x32_bf16 v[220:223], a[32:35], a[228:231], v[220:223]
    v_mfma_f32_16x16x32_bf16 v[224:227], a[56:59], a[228:231], v[224:227]
    s_waitcnt vmcnt(8)
    buffer_load_dwordx4 v170, s[4:7], s41 offen lds
    s_add_u32 m0, s46, 0x8400
    ds_read_b64_tr_b16 a[12:13], v249 offset:9216
    ds_read_b64_tr_b16 a[14:15], v250 offset:9216
    ds_read_b64_tr_b16 a[36:37], v249 offset:9248
    ds_read_b64_tr_b16 a[38:39], v250 offset:9248
    ds_read_b64_tr_b16 a[60:61], v249 offset:9280
    ds_read_b64_tr_b16 a[62:63], v250 offset:9280
    ds_read_b128 a[228:231], v240 offset:4864
    buffer_load_dwordx4 v168, s[4:7], s56 offen lds
    s_add_u32 m0, s46, 0x8800
    s_add_u32 s56, s39, 0
    s_waitcnt lgkmcnt(5)
    v_mfma_f32_16x16x32_bf16 v[180:183], a[12:15], a[232:235], v[180:183]
    v_mfma_f32_16x16x32_bf16 v[192:195], a[12:15], a[236:239], v[192:195]
    s_waitcnt lgkmcnt(2)
    v_mfma_f32_16x16x32_bf16 v[184:187], a[36:39], a[232:235], v[184:187]
    s_waitcnt lgkmcnt(0)
    v_mfma_f32_16x16x32_bf16 v[188:191], a[60:63], a[232:235], v[188:191]
    ds_read_b128 a[232:235], v241 offset:256
    v_mfma_f32_16x16x32_bf16 v[196:199], a[36:39], a[236:239], v[196:199]
    buffer_load_dwordx4 v169, s[4:7], s57 offen lds
    s_add_u32 m0, s46, 0x8c00
    s_add_u32 s57, s39, 0x9000
    v_mfma_f32_16x16x32_bf16 v[200:203], a[60:63], a[236:239], v[200:203]
    ds_read_b128 a[236:239], v241 offset:1792
    v_mfma_f32_16x16x32_bf16 v[204:207], a[12:15], a[240:243], v[204:207]
    v_mfma_f32_16x16x32_bf16 v[208:211], a[36:39], a[240:243], v[208:211]
    v_mfma_f32_16x16x32_bf16 v[212:215], a[60:63], a[240:243], v[212:215]
    ds_read_b128 a[240:243], v241 offset:3328
    v_mfma_f32_16x16x32_bf16 v[216:219], a[12:15], a[244:247], v[216:219]
    v_mfma_f32_16x16x32_bf16 v[220:223], a[36:39], a[244:247], v[220:223]
    v_mfma_f32_16x16x32_bf16 v[224:227], a[60:63], a[244:247], v[224:227]
    s_waitcnt vmcnt(8)
    buffer_load_dwordx4 v170, s[4:7], s58 offen lds
    s_add_u32 m0, s46, 0x9000
    ds_read_b64_tr_b16 a[16:17], v249 offset:0
    ds_read_b64_tr_b16 a[18:19], v250 offset:0
    ds_read_b64_tr_b16 a[40:41], v249 offset:32
    ds_read_b64_tr_b16 a[42:43], v250 offset:32
    ds_read_b64_tr_b16 a[64:65], v249 offset:64
    ds_read_b64_tr_b16 a[66:67], v250 offset:64
    ds_read_b128 a[244:247], v241 offset:4864
    s_add_u32 s58, s39, 0x12000
    buffer_load_dwordx4 v168, s[4:7], s59 offen lds
    s_add_u32 m0, s46, 0x9200
    s_add_u32 s59, s39, 0x1b000
    s_waitcnt lgkmcnt(5)
    v_mfma_f32_16x16x32_bf16 v[180:183], a[16:19], a[216:219], v[180:183]
    v_mfma_f32_16x16x32_bf16 v[192:195], a[16:19], a[220:223], v[192:195]
    s_waitcnt lgkmcnt(2)
    v_mfma_f32_16x16x32_bf16 v[184:187], a[40:43], a[216:219], v[184:187]
    s_waitcnt lgkmcnt(0)
    v_mfma_f32_16x16x32_bf16 v[188:191], a[64:67], a[216:219], v[188:191]
    v_mfma_f32_16x16x32_bf16 v[196:199], a[40:43], a[220:223], v[196:199]
    buffer_load_dwordx4 v171, s[4:7], s60 offen lds
    s_add_u32 m0, s29, 0x1800
    s_add_u32 s60, s39, 0x24000
    v_mfma_f32_16x16x32_bf16 v[200:203], a[64:67], a[220:223], v[200:203]
    v_mfma_f32_16x16x32_bf16 v[204:207], a[16:19], a[224:227], v[204:207]
    v_mfma_f32_16x16x32_bf16 v[208:211], a[40:43], a[224:227], v[208:211]
    v_mfma_f32_16x16x32_bf16 v[212:215], a[64:67], a[224:227], v[212:215]
    v_mfma_f32_16x16x32_bf16 v[216:219], a[16:19], a[228:231], v[216:219]
    v_mfma_f32_16x16x32_bf16 v[220:223], a[40:43], a[228:231], v[220:223]
    buffer_load_dwordx4 v172, s[8:11], s61 offen lds
    s_add_u32 m0, s29, 0x1c00
    s_waitcnt vmcnt(9)
    v_mfma_f32_16x16x32_bf16 v[224:227], a[64:67], a[228:231], v[224:227]
    ds_read_b64_tr_b16 a[20:21], v249 offset:3072
    ds_read_b64_tr_b16 a[22:23], v250 offset:3072
    ds_read_b64_tr_b16 a[44:45], v249 offset:3104
    ds_read_b64_tr_b16 a[46:47], v250 offset:3104
    ds_read_b64_tr_b16 a[68:69], v249 offset:3136
    ds_read_b64_tr_b16 a[70:71], v250 offset:3136
    buffer_load_dwordx4 v173, s[8:11], s61 offen lds
    s_add_u32 m0, s29, 0x2000
    s_nop 0
    s_waitcnt lgkmcnt(4)
    v_mfma_f32_16x16x32_bf16 v[180:183], a[20:23], a[232:235], v[180:183]
    v_mfma_f32_16x16x32_bf16 v[192:195], a[20:23], a[236:239], v[192:195]
    s_waitcnt lgkmcnt(1)
    v_mfma_f32_16x16x32_bf16 v[184:187], a[44:47], a[232:235], v[184:187]
    s_waitcnt lgkmcnt(0)
    v_mfma_f32_16x16x32_bf16 v[188:191], a[68:71], a[232:235], v[188:191]
    v_mfma_f32_16x16x32_bf16 v[196:199], a[44:47], a[236:239], v[196:199]
    buffer_load_dwordx4 v174, s[8:11], s61 offen lds
    s_add_u32 m0, s29, 0x2400
    v_cvt_pk_bf16_f32 v90, v180, v181
    v_mfma_f32_16x16x32_bf16 v[200:203], a[68:71], a[236:239], v[200:203]
    s_add_u32 s61, s39, 0x2d000
    v_cvt_pk_bf16_f32 v91, v182, v183
    v_cvt_pk_bf16_f32 v92, v184, v185
    v_mfma_f32_16x16x32_bf16 v[204:207], a[20:23], a[240:243], v[204:207]
    v_cvt_pk_bf16_f32 v93, v186, v187
    v_cvt_pk_bf16_f32 v94, v188, v189
    v_mfma_f32_16x16x32_bf16 v[208:211], a[44:47], a[240:243], v[208:211]
    v_cvt_pk_bf16_f32 v95, v190, v191
    v_cvt_pk_bf16_f32 v96, v192, v193
    v_mfma_f32_16x16x32_bf16 v[212:215], a[68:71], a[240:243], v[212:215]
    v_cvt_pk_bf16_f32 v97, v194, v195
    v_cvt_pk_bf16_f32 v98, v196, v197
    v_mfma_f32_16x16x32_bf16 v[216:219], a[20:23], a[244:247], v[216:219]
    v_cvt_pk_bf16_f32 v99, v198, v199
    v_cvt_pk_bf16_f32 v100, v200, v201
    v_mfma_f32_16x16x32_bf16 v[220:223], a[44:47], a[244:247], v[220:223]
    v_cvt_pk_bf16_f32 v101, v202, v203
    v_cvt_pk_bf16_f32 v102, v204, v205
    v_mfma_f32_16x16x32_bf16 v[224:227], a[68:71], a[244:247], v[224:227]
    buffer_load_dwordx4 v172, s[8:11], s62 offen lds
    s_add_u32 m0, s29, 0x2800
    v_cvt_pk_bf16_f32 v103, v206, v207
    v_cvt_pk_bf16_f32 v104, v208, v209
    v_cvt_pk_bf16_f32 v105, v210, v211
    v_cvt_pk_bf16_f32 v106, v212, v213
    v_cvt_pk_bf16_f32 v107, v214, v215
    v_cvt_pk_bf16_f32 v108, v216, v217
    v_cvt_pk_bf16_f32 v109, v218, v219
    v_cvt_pk_bf16_f32 v110, v220, v221
    v_cvt_pk_bf16_f32 v111, v222, v223
    v_cvt_pk_bf16_f32 v112, v224, v225
    v_cvt_pk_bf16_f32 v113, v226, v227
    buffer_load_dwordx4 v173, s[8:11], s62 offen lds
    s_add_u32 m0, s29, 0x2c00
    s_nop 0
    buffer_load_dwordx4 v174, s[8:11], s62 offen lds
    s_add_u32 m0, s29, 0
    s_add_u32 s62, s39, 0
    buffer_load_dwordx4 v172, s[8:11], s63 offen lds
    s_add_u32 m0, s29, 0x400
    s_nop 0
    buffer_load_dwordx4 v173, s[8:11], s63 offen lds
    s_add_u32 m0, s29, 0x800
    s_nop 0
    buffer_load_dwordx4 v174, s[8:11], s63 offen lds
    s_waitcnt vmcnt(9)
    s_add_u32 m0, s29, 0xc00
    s_barrier
    ds_read_b128 a[216:219], v240 offset:30720
    ds_read_b128 a[220:223], v241 offset:30720
    ds_read_b128 a[224:227], v240 offset:30848
    ds_read_b128 a[228:231], v241 offset:30848
    ds_read_b128 a[232:235], v240 offset:30976
    ds_read_b128 a[236:239], v241 offset:30976
    ds_read_b128 a[240:243], v240 offset:32256
    ds_read_b128 a[244:247], v241 offset:32256
    s_add_u32 s63, s39, 0x3000
    buffer_load_dwordx4 v172, s[8:11], s64 offen lds
    s_add_u32 m0, s29, 0x1000
    s_nop 0
    s_waitcnt lgkmcnt(7)
    v_mfma_f32_16x16x32_bf16 v[180:183], a[0:3], a[216:219], 0
    s_waitcnt lgkmcnt(6)
    v_mfma_f32_16x16x32_bf16 v[184:187], a[24:27], a[216:219], 0
    v_mfma_f32_16x16x32_bf16 v[188:191], a[48:51], a[216:219], 0
    ds_read_b128 a[216:219], v240 offset:32384
    v_mfma_f32_16x16x32_bf16 v[180:183], a[4:7], a[220:223], v[180:183]
    s_waitcnt lgkmcnt(1)
    v_mfma_f32_16x16x32_bf16 v[184:187], a[28:31], a[220:223], v[184:187]
    v_mfma_f32_16x16x32_bf16 v[188:191], a[52:55], a[220:223], v[188:191]
    buffer_load_dwordx4 v173, s[8:11], s64 offen lds
    s_add_u32 m0, s29, 0x1400
    v_mfma_f32_16x16x32_bf16 v[180:183], a[8:11], a[224:227], v[180:183]
    ds_read_b128 a[220:223], v241 offset:32384
    v_mfma_f32_16x16x32_bf16 v[184:187], a[32:35], a[224:227], v[184:187]
    v_mfma_f32_16x16x32_bf16 v[188:191], a[56:59], a[224:227], v[188:191]
    ds_read_b128 a[224:227], v240 offset:32512
    v_mfma_f32_16x16x32_bf16 v[180:183], a[12:15], a[228:231], v[180:183]
    v_mfma_f32_16x16x32_bf16 v[184:187], a[36:39], a[228:231], v[184:187]
    v_mfma_f32_16x16x32_bf16 v[188:191], a[60:63], a[228:231], v[188:191]
    buffer_load_dwordx4 v174, s[8:11], s64 offen lds
    s_add_u32 m0, s46, 0xf000
    s_add_u32 s64, s39, 0x6000
    v_mfma_f32_16x16x32_bf16 v[180:183], a[16:19], a[232:235], v[180:183]
    ds_read_b128 a[228:231], v241 offset:32512
    s_waitcnt vmcnt(9)
    v_mfma_f32_16x16x32_bf16 v[184:187], a[40:43], a[232:235], v[184:187]
    ds_read_b64_tr_b16 a[72:73], v249 offset:6144
    v_mfma_f32_16x16x32_bf16 v[188:191], a[64:67], a[232:235], v[188:191]
    ds_read_b128 a[232:235], v240 offset:33792
    v_mfma_f32_16x16x32_bf16 v[180:183], a[20:23], a[236:239], v[180:183]
    ds_read_b64_tr_b16 a[74:75], v250 offset:6144
    v_mfma_f32_16x16x32_bf16 v[184:187], a[44:47], a[236:239], v[184:187]
    ds_read_b64_tr_b16 a[96:97], v249 offset:6176
    v_mfma_f32_16x16x32_bf16 v[188:191], a[68:71], a[236:239], v[188:191]
    ds_read_b128 a[236:239], v241 offset:33792
    v_mfma_f32_16x16x32_bf16 v[192:195], a[0:3], a[240:243], 0
    buffer_load_dwordx4 v168, s[4:7], s42 offen lds
    s_add_u32 m0, s46, 0xf400
    v_cvt_pk_bf16_f32 v114, v180, v181
    v_mfma_f32_16x16x32_bf16 v[196:199], a[24:27], a[240:243], 0
    ds_read_b64_tr_b16 a[98:99], v250 offset:6176
    v_cvt_pk_bf16_f32 v115, v182, v183
    v_mfma_f32_16x16x32_bf16 v[200:203], a[48:51], a[240:243], 0
    ds_read_b128 a[240:243], v240 offset:33920
    v_cvt_pk_bf16_f32 v116, v184, v185
    v_mfma_f32_16x16x32_bf16 v[192:195], a[4:7], a[244:247], v[192:195]
    ds_read_b64_tr_b16 a[120:121], v249 offset:6208
    s_waitcnt lgkmcnt(7)
    v_cvt_pk_bf16_f32 v117, v186, v187
    v_mfma_f32_16x16x32_bf16 v[196:199], a[28:31], a[244:247], v[196:199]
    ds_read_b64_tr_b16 a[122:123], v250 offset:6208
    s_waitcnt lgkmcnt(7)
    v_cvt_pk_bf16_f32 v118, v188, v189
    v_mfma_f32_16x16x32_bf16 v[200:203], a[52:55], a[244:247], v[200:203]
    ds_read_b128 a[244:247], v241 offset:33920
    v_cvt_pk_bf16_f32 v119, v190, v191
    v_mfma_f32_16x16x32_bf16 v[192:195], a[8:11], a[216:219], v[192:195]
    v_mfma_f32_16x16x32_bf16 v[196:199], a[32:35], a[216:219], v[196:199]
    buffer_load_dwordx4 v169, s[4:7], s42 offen lds
    s_add_u32 m0, s46, 0xf800
    v_mfma_f32_16x16x32_bf16 v[200:203], a[56:59], a[216:219], v[200:203]
    ds_read_b128 a[216:219], v240 offset:34048
    v_mfma_f32_16x16x32_bf16 v[192:195], a[12:15], a[220:223], v[192:195]
    v_mfma_f32_16x16x32_bf16 v[196:199], a[36:39], a[220:223], v[196:199]
    v_mfma_f32_16x16x32_bf16 v[200:203], a[60:63], a[220:223], v[200:203]
    ds_read_b128 a[220:223], v241 offset:34048
    v_mfma_f32_16x16x32_bf16 v[192:195], a[16:19], a[224:227], v[192:195]
    v_mfma_f32_16x16x32_bf16 v[196:199], a[40:43], a[224:227], v[196:199]
    v_mfma_f32_16x16x32_bf16 v[200:203], a[64:67], a[224:227], v[200:203]
    buffer_load_dwordx4 v170, s[4:7], s42 offen lds
    s_add_u32 m0, s46, 0xfc00
    s_waitcnt vmcnt(9)
    v_mfma_f32_16x16x32_bf16 v[192:195], a[20:23], a[228:231], v[192:195]
    ds_read_b128 a[224:227], v240 offset:35328
    v_mfma_f32_16x16x32_bf16 v[196:199], a[44:47], a[228:231], v[196:199]
    ds_read_b64_tr_b16 a[76:77], v249 offset:9216
    v_mfma_f32_16x16x32_bf16 v[200:203], a[68:71], a[228:231], v[200:203]
    ds_read_b128 a[228:231], v241 offset:35328
    v_mfma_f32_16x16x32_bf16 v[204:207], a[0:3], a[232:235], 0
    ds_read_b64_tr_b16 a[78:79], v250 offset:9216
    s_waitcnt lgkmcnt(5)
    v_cvt_pk_bf16_f32 v120, v192, v193
    v_mfma_f32_16x16x32_bf16 v[208:211], a[24:27], a[232:235], 0
    ds_read_b64_tr_b16 a[100:101], v249 offset:9248
    v_cvt_pk_bf16_f32 v121, v194, v195
    v_mfma_f32_16x16x32_bf16 v[212:215], a[48:51], a[232:235], 0
    ds_read_b128 a[232:235], v240 offset:35456
    v_cvt_pk_bf16_f32 v122, v196, v197
    v_mfma_f32_16x16x32_bf16 v[204:207], a[4:7], a[236:239], v[204:207]
    buffer_load_dwordx4 v168, s[4:7], s65 offen lds
    s_add_u32 m0, s46, 0x10000
    v_cvt_pk_bf16_f32 v123, v198, v199
    v_mfma_f32_16x16x32_bf16 v[208:211], a[28:31], a[236:239], v[208:211]
    ds_read_b64_tr_b16 a[102:103], v250 offset:9248
    s_add_u32 s65, s39, 0x9000
    v_cvt_pk_bf16_f32 v124, v200, v201
    v_mfma_f32_16x16x32_bf16 v[212:215], a[52:55], a[236:239], v[212:215]
    ds_read_b128 a[236:239], v241 offset:35456
    s_waitcnt lgkmcnt(7)
    v_cvt_pk_bf16_f32 v125, v202, v203
    v_mfma_f32_16x16x32_bf16 v[204:207], a[8:11], a[240:243], v[204:207]
    ds_read_b64_tr_b16 a[124:125], v249 offset:9280
    v_mfma_f32_16x16x32_bf16 v[208:211], a[32:35], a[240:243], v[208:211]
    ds_read_b64_tr_b16 a[126:127], v250 offset:9280
    v_mfma_f32_16x16x32_bf16 v[212:215], a[56:59], a[240:243], v[212:215]
    ds_read_b128 a[240:243], v240 offset:35584
    v_mfma_f32_16x16x32_bf16 v[204:207], a[12:15], a[244:247], v[204:207]
    v_mfma_f32_16x16x32_bf16 v[208:211], a[36:39], a[244:247], v[208:211]
    buffer_load_dwordx4 v169, s[4:7], s50 offen lds
    s_add_u32 m0, s46, 0x10400
    s_mov_b32 s50, 0
    v_mfma_f32_16x16x32_bf16 v[212:215], a[60:63], a[244:247], v[212:215]
    ds_read_b128 a[244:247], v241 offset:35584
    v_mfma_f32_16x16x32_bf16 v[204:207], a[16:19], a[216:219], v[204:207]
    v_mfma_f32_16x16x32_bf16 v[208:211], a[40:43], a[216:219], v[208:211]
    v_mfma_f32_16x16x32_bf16 v[212:215], a[64:67], a[216:219], v[212:215]
    v_mfma_f32_16x16x32_bf16 v[204:207], a[20:23], a[220:223], v[204:207]
    v_mfma_f32_16x16x32_bf16 v[208:211], a[44:47], a[220:223], v[208:211]
    v_mfma_f32_16x16x32_bf16 v[212:215], a[68:71], a[220:223], v[212:215]
    buffer_load_dwordx4 v170, s[4:7], s51 offen lds
    s_add_u32 m0, s46, 0x10800
    s_mov_b32 s51, 0x1800
    v_mfma_f32_16x16x32_bf16 v[216:219], a[0:3], a[224:227], 0
    s_waitcnt vmcnt(9) lgkmcnt(1)
    ds_read_b64_tr_b16 a[80:81], v249 offset:0
    v_mfma_f32_16x16x32_bf16 v[220:223], a[24:27], a[224:227], 0
    ds_read_b64_tr_b16 a[82:83], v250 offset:0
    v_cvt_pk_bf16_f32 v126, v204, v205
    v_mfma_f32_16x16x32_bf16 v[224:227], a[48:51], a[224:227], 0
    ds_read_b64_tr_b16 a[104:105], v249 offset:32
    v_cvt_pk_bf16_f32 v127, v206, v207
    v_mfma_f32_16x16x32_bf16 v[216:219], a[4:7], a[228:231], v[216:219]
    ds_read_b64_tr_b16 a[106:107], v250 offset:32
    v_cvt_pk_bf16_f32 v128, v208, v209
    v_mfma_f32_16x16x32_bf16 v[220:223], a[28:31], a[228:231], v[220:223]
    ds_read_b64_tr_b16 a[128:129], v249 offset:64
    v_cvt_pk_bf16_f32 v129, v210, v211
    v_mfma_f32_16x16x32_bf16 v[224:227], a[52:55], a[228:231], v[224:227]
    ds_read_b64_tr_b16 a[130:131], v250 offset:64
    v_cvt_pk_bf16_f32 v130, v212, v213
    v_mfma_f32_16x16x32_bf16 v[216:219], a[8:11], a[232:235], v[216:219]
    buffer_load_dwordx4 v168, s[4:7], s52 offen lds
    s_add_u32 m0, s46, 0x10a00
    v_cvt_pk_bf16_f32 v131, v214, v215
    v_mfma_f32_16x16x32_bf16 v[220:223], a[32:35], a[232:235], v[220:223]
    s_mov_b32 s52, 0x3000
    v_mfma_f32_16x16x32_bf16 v[224:227], a[56:59], a[232:235], v[224:227]
    v_mfma_f32_16x16x32_bf16 v[216:219], a[12:15], a[236:239], v[216:219]
    v_mfma_f32_16x16x32_bf16 v[220:223], a[36:39], a[236:239], v[220:223]
    v_mfma_f32_16x16x32_bf16 v[224:227], a[60:63], a[236:239], v[224:227]
    v_mfma_f32_16x16x32_bf16 v[216:219], a[16:19], a[240:243], v[216:219]
    buffer_load_dwordx4 v171, s[4:7], s53 offen lds
    s_add_u32 m0, s29, 0x1800
    s_add_u32 s53, s39, 0xc000
    v_mfma_f32_16x16x32_bf16 v[220:223], a[40:43], a[240:243], v[220:223]
    s_waitcnt lgkmcnt(1)
    v_mfma_f32_16x16x32_bf16 v[224:227], a[64:67], a[240:243], v[224:227]
    v_mfma_f32_16x16x32_bf16 v[216:219], a[20:23], a[244:247], v[216:219]
    v_mfma_f32_16x16x32_bf16 v[220:223], a[44:47], a[244:247], v[220:223]
    v_mfma_f32_16x16x32_bf16 v[224:227], a[68:71], a[244:247], v[224:227]
    s_nop 5
    v_cvt_pk_bf16_f32 v132, v216, v217
    v_cvt_pk_bf16_f32 v133, v218, v219
    v_cvt_pk_bf16_f32 v134, v220, v221
    v_cvt_pk_bf16_f32 v135, v222, v223
    v_cvt_pk_bf16_f32 v136, v224, v225
    v_cvt_pk_bf16_f32 v137, v226, v227
    buffer_load_dwordx4 v172, s[8:11], s54 offen lds
    s_waitcnt vmcnt(9)
    s_add_u32 m0, s29, 0x1c00
    ds_read_b64_tr_b16 a[84:85], v249 offset:3072
    ds_read_b64_tr_b16 a[86:87], v250 offset:3072
    ds_read_b64_tr_b16 a[108:109], v249 offset:3104
    ds_read_b64_tr_b16 a[110:111], v250 offset:3104
    ds_read_b64_tr_b16 a[132:133], v249 offset:3136
    ds_read_b64_tr_b16 a[134:135], v250 offset:3136
    buffer_load_dwordx4 v173, s[8:11], s54 offen lds
    s_add_u32 m0, s29, 0x2000
    s_nop 0
    buffer_load_dwordx4 v174, s[8:11], s54 offen lds
    s_add_u32 m0, s29, 0x2400
    s_mov_b32 s54, 0x400
    buffer_load_dwordx4 v172, s[8:11], s55 offen lds
    s_add_u32 m0, s29, 0x2800
    s_nop 0
    buffer_load_dwordx4 v173, s[8:11], s55 offen lds
    s_add_u32 m0, s29, 0x2c00
    s_nop 0
    buffer_load_dwordx4 v174, s[8:11], s55 offen lds
    s_add_u32 m0, s29, 0
    s_mov_b32 s55, 0x1c00
    s_waitcnt lgkmcnt(0)
    buffer_load_dwordx4 v172, s[8:11], s56 offen lds
    s_add_u32 m0, s29, 0x400
    s_nop 0
    buffer_load_dwordx4 v173, s[8:11], s56 offen lds
    s_add_u32 m0, s29, 0x800
    s_nop 0
    buffer_load_dwordx4 v174, s[8:11], s56 offen lds
    s_waitcnt vmcnt(9)
    s_add_u32 m0, s29, 0xc00
    s_barrier
    ds_read_b128 a[216:219], v240 offset:61440
    ds_read_b128 a[220:223], v241 offset:61440
    ds_read_b128 a[224:227], v240 offset:61568
    ds_read_b128 a[228:231], v241 offset:61568
    ds_read_b128 a[232:235], v240 offset:61696
    ds_read_b128 a[236:239], v241 offset:61696
    ds_read_b128 a[240:243], v240 offset:62976
    ds_read_b128 a[244:247], v241 offset:62976
    s_mov_b32 s56, 0x3400
    buffer_load_dwordx4 v172, s[8:11], s57 offen lds
    s_add_u32 m0, s29, 0x1000
    s_nop 0
    s_waitcnt lgkmcnt(7)
    v_mfma_f32_16x16x32_bf16 v[180:183], a[0:3], a[216:219], 0
    s_waitcnt lgkmcnt(6)
    v_mfma_f32_16x16x32_bf16 v[184:187], a[24:27], a[216:219], 0
    v_mfma_f32_16x16x32_bf16 v[188:191], a[48:51], a[216:219], 0
    ds_read_b128 a[216:219], v240 offset:63104
    v_mfma_f32_16x16x32_bf16 v[180:183], a[4:7], a[220:223], v[180:183]
    s_waitcnt lgkmcnt(1)
    v_mfma_f32_16x16x32_bf16 v[184:187], a[28:31], a[220:223], v[184:187]
    v_mfma_f32_16x16x32_bf16 v[188:191], a[52:55], a[220:223], v[188:191]
    buffer_load_dwordx4 v173, s[8:11], s57 offen lds
    s_add_u32 m0, s29, 0x1400
    v_mfma_f32_16x16x32_bf16 v[180:183], a[8:11], a[224:227], v[180:183]
    ds_read_b128 a[220:223], v241 offset:63104
    v_mfma_f32_16x16x32_bf16 v[184:187], a[32:35], a[224:227], v[184:187]
    v_mfma_f32_16x16x32_bf16 v[188:191], a[56:59], a[224:227], v[188:191]
    ds_read_b128 a[224:227], v240 offset:63232
    v_mfma_f32_16x16x32_bf16 v[180:183], a[12:15], a[228:231], v[180:183]
    v_mfma_f32_16x16x32_bf16 v[184:187], a[36:39], a[228:231], v[184:187]
    v_mfma_f32_16x16x32_bf16 v[188:191], a[60:63], a[228:231], v[188:191]
    buffer_load_dwordx4 v174, s[8:11], s57 offen lds
    s_add_u32 m0, s29, 0x1800
    s_add_u32 s57, s39, 0xf000
    v_mfma_f32_16x16x32_bf16 v[180:183], a[16:19], a[232:235], v[180:183]
    ds_read_b128 a[228:231], v241 offset:63232
    s_waitcnt vmcnt(9)
    v_mfma_f32_16x16x32_bf16 v[184:187], a[40:43], a[232:235], v[184:187]
    ds_read_b64_tr_b16 a[88:89], v249 offset:6144
    v_mfma_f32_16x16x32_bf16 v[188:191], a[64:67], a[232:235], v[188:191]
    ds_read_b64_tr_b16 a[90:91], v250 offset:6144
    v_mfma_f32_16x16x32_bf16 v[180:183], a[20:23], a[236:239], v[180:183]
    ds_read_b64_tr_b16 a[112:113], v249 offset:6176
    v_mfma_f32_16x16x32_bf16 v[184:187], a[44:47], a[236:239], v[184:187]
    ds_read_b64_tr_b16 a[114:115], v250 offset:6176
    v_mfma_f32_16x16x32_bf16 v[188:191], a[68:71], a[236:239], v[188:191]
    ds_read_b64_tr_b16 a[136:137], v249 offset:6208
    v_mfma_f32_16x16x32_bf16 v[192:195], a[0:3], a[240:243], 0
    ds_read_b64_tr_b16 a[138:139], v250 offset:6208
    v_mfma_f32_16x16x32_bf16 v[196:199], a[24:27], a[240:243], 0
    ds_read_b128 a[232:235], v240 offset:64512
    v_cvt_pk_bf16_f32 v138, v180, v181
    v_mfma_f32_16x16x32_bf16 v[200:203], a[48:51], a[240:243], 0
    ds_read_b128 a[236:239], v241 offset:64512
    v_cvt_pk_bf16_f32 v139, v182, v183
    v_mfma_f32_16x16x32_bf16 v[192:195], a[4:7], a[244:247], v[192:195]
    ds_read_b128 a[240:243], v240 offset:64640
    s_waitcnt lgkmcnt(8)
    v_cvt_pk_bf16_f32 v140, v184, v185
    v_mfma_f32_16x16x32_bf16 v[196:199], a[28:31], a[244:247], v[196:199]
    v_cvt_pk_bf16_f32 v141, v186, v187
    v_cvt_pk_bf16_f32 v142, v188, v189
    v_mfma_f32_16x16x32_bf16 v[200:203], a[52:55], a[244:247], v[200:203]
    ds_read_b128 a[244:247], v241 offset:64640
    v_cvt_pk_bf16_f32 v143, v190, v191
    v_mfma_f32_16x16x32_bf16 v[192:195], a[8:11], a[216:219], v[192:195]
    v_mfma_f32_16x16x32_bf16 v[196:199], a[32:35], a[216:219], v[196:199]
    v_mfma_f32_16x16x32_bf16 v[200:203], a[56:59], a[216:219], v[200:203]
    ds_read_b128 a[216:219], v240 offset:64768
    s_waitcnt lgkmcnt(5)
    v_add_u32 v240, 0xf000, v240
    v_mfma_f32_16x16x32_bf16 v[192:195], a[12:15], a[220:223], v[192:195]
    buffer_load_dwordx4 v172, s[8:11], s58 offen lds
    s_add_u32 m0, s29, 0x1c00
    s_waitcnt lgkmcnt(4)
    v_mfma_f32_16x16x32_bf16 v[196:199], a[36:39], a[220:223], v[196:199]
    buffer_load_dwordx4 v173, s[8:11], s58 offen lds
    s_add_u32 m0, s29, 0x2000
    v_mfma_f32_16x16x32_bf16 v[200:203], a[60:63], a[220:223], v[200:203]
    ds_read_b128 a[220:223], v241 offset:64768
    v_add_u32 v241, 0xf000, v241
    v_mfma_f32_16x16x32_bf16 v[192:195], a[16:19], a[224:227], v[192:195]
    v_mfma_f32_16x16x32_bf16 v[196:199], a[40:43], a[224:227], v[196:199]
    v_mfma_f32_16x16x32_bf16 v[200:203], a[64:67], a[224:227], v[200:203]
    buffer_load_dwordx4 v174, s[8:11], s58 offen lds
    s_add_u32 m0, s29, 0x2400
    s_mov_b32 s58, 0x800
    v_mfma_f32_16x16x32_bf16 v[192:195], a[20:23], a[228:231], v[192:195]
    ds_read_b128 a[224:227], v240 offset:4608
    s_waitcnt vmcnt(9)
    v_mfma_f32_16x16x32_bf16 v[196:199], a[44:47], a[228:231], v[196:199]
    ds_read_b64_tr_b16 a[92:93], v249 offset:9216
    v_mfma_f32_16x16x32_bf16 v[200:203], a[68:71], a[228:231], v[200:203]
    ds_read_b64_tr_b16 a[94:95], v250 offset:9216
    v_mfma_f32_16x16x32_bf16 v[204:207], a[0:3], a[232:235], 0
    ds_read_b64_tr_b16 a[116:117], v249 offset:9248
    s_waitcnt lgkmcnt(5)
    v_cvt_pk_bf16_f32 v144, v192, v193
    v_mfma_f32_16x16x32_bf16 v[208:211], a[24:27], a[232:235], 0
    ds_read_b64_tr_b16 a[118:119], v250 offset:9248
    v_cvt_pk_bf16_f32 v145, v194, v195
    v_mfma_f32_16x16x32_bf16 v[212:215], a[48:51], a[232:235], 0
    ds_read_b64_tr_b16 a[140:141], v249 offset:9280
    v_cvt_pk_bf16_f32 v146, v196, v197
    v_mfma_f32_16x16x32_bf16 v[204:207], a[4:7], a[236:239], v[204:207]
    ds_read_b64_tr_b16 a[142:143], v250 offset:9280
    v_cvt_pk_bf16_f32 v147, v198, v199
    v_mfma_f32_16x16x32_bf16 v[208:211], a[28:31], a[236:239], v[208:211]
    ds_read_b128 a[228:231], v241 offset:4608
    v_cvt_pk_bf16_f32 v148, v200, v201
    v_mfma_f32_16x16x32_bf16 v[212:215], a[52:55], a[236:239], v[212:215]
    ds_read_b128 a[232:235], v240 offset:4736
    s_waitcnt lgkmcnt(8)
    v_cvt_pk_bf16_f32 v149, v202, v203
    v_mfma_f32_16x16x32_bf16 v[204:207], a[8:11], a[240:243], v[204:207]
    ds_read_b128 a[236:239], v241 offset:4736
    v_mfma_f32_16x16x32_bf16 v[208:211], a[32:35], a[240:243], v[208:211]
    v_mfma_f32_16x16x32_bf16 v[212:215], a[56:59], a[240:243], v[212:215]
    ds_read_b128 a[240:243], v240 offset:4864
    v_add_u32 v240, 0xffff1000, v240
    v_mfma_f32_16x16x32_bf16 v[204:207], a[12:15], a[244:247], v[204:207]
    v_mfma_f32_16x16x32_bf16 v[208:211], a[36:39], a[244:247], v[208:211]
    v_mfma_f32_16x16x32_bf16 v[212:215], a[60:63], a[244:247], v[212:215]
    ds_read_b128 a[244:247], v241 offset:4864
    s_waitcnt lgkmcnt(5)
    v_add_u32 v241, 0xffff1000, v241
    v_mfma_f32_16x16x32_bf16 v[204:207], a[16:19], a[216:219], v[204:207]
    buffer_load_dwordx4 v172, s[8:11], s59 offen lds
    s_add_u32 m0, s29, 0x2800
    v_mfma_f32_16x16x32_bf16 v[208:211], a[40:43], a[216:219], v[208:211]
    buffer_load_dwordx4 v173, s[8:11], s59 offen lds
    s_add_u32 m0, s29, 0x2c00
    v_mfma_f32_16x16x32_bf16 v[212:215], a[64:67], a[216:219], v[212:215]
    ds_read_b128 a[216:219], v240 offset:0
    v_mfma_f32_16x16x32_bf16 v[204:207], a[20:23], a[220:223], v[204:207]
    v_mfma_f32_16x16x32_bf16 v[208:211], a[44:47], a[220:223], v[208:211]
    v_mfma_f32_16x16x32_bf16 v[212:215], a[68:71], a[220:223], v[212:215]
    buffer_load_dwordx4 v174, s[8:11], s59 offen lds
    s_add_u32 m0, s29, 0
    s_mov_b32 s59, 0x2000
    v_mfma_f32_16x16x32_bf16 v[216:219], a[0:3], a[224:227], 0
    ds_read_b128 a[220:223], v241 offset:0
    s_waitcnt vmcnt(9) lgkmcnt(3)
    v_cvt_pk_bf16_f32 v150, v204, v205
    v_mfma_f32_16x16x32_bf16 v[220:223], a[24:27], a[224:227], 0
    ds_read_b64_tr_b16 a[144:145], v249 offset:0
    v_cvt_pk_bf16_f32 v151, v206, v207
    v_mfma_f32_16x16x32_bf16 v[224:227], a[48:51], a[224:227], 0
    ds_read_b64_tr_b16 a[146:147], v250 offset:0
    v_cvt_pk_bf16_f32 v152, v208, v209
    v_mfma_f32_16x16x32_bf16 v[216:219], a[4:7], a[228:231], v[216:219]
    ds_read_b64_tr_b16 a[168:169], v249 offset:32
    v_cvt_pk_bf16_f32 v153, v210, v211
    v_mfma_f32_16x16x32_bf16 v[220:223], a[28:31], a[228:231], v[220:223]
    ds_read_b64_tr_b16 a[170:171], v250 offset:32
    s_waitcnt lgkmcnt(5)
    v_cvt_pk_bf16_f32 v154, v212, v213
    v_mfma_f32_16x16x32_bf16 v[224:227], a[52:55], a[228:231], v[224:227]
    ds_read_b64_tr_b16 a[192:193], v249 offset:64
    v_cvt_pk_bf16_f32 v155, v214, v215
    v_mfma_f32_16x16x32_bf16 v[216:219], a[8:11], a[232:235], v[216:219]
    ds_read_b64_tr_b16 a[194:195], v250 offset:64
    v_mfma_f32_16x16x32_bf16 v[220:223], a[32:35], a[232:235], v[220:223]
    ds_read_b128 a[224:227], v240 offset:128
    v_mfma_f32_16x16x32_bf16 v[224:227], a[56:59], a[232:235], v[224:227]
    ds_read_b128 a[228:231], v241 offset:128
    v_mfma_f32_16x16x32_bf16 v[216:219], a[12:15], a[236:239], v[216:219]
    ds_read_b128 a[232:235], v240 offset:256
    v_mfma_f32_16x16x32_bf16 v[220:223], a[36:39], a[236:239], v[220:223]
    v_mfma_f32_16x16x32_bf16 v[224:227], a[60:63], a[236:239], v[224:227]
    ds_read_b128 a[236:239], v241 offset:256
    v_mfma_f32_16x16x32_bf16 v[216:219], a[16:19], a[240:243], v[216:219]
    v_mfma_f32_16x16x32_bf16 v[220:223], a[40:43], a[240:243], v[220:223]
    v_mfma_f32_16x16x32_bf16 v[224:227], a[64:67], a[240:243], v[224:227]
    ds_read_b128 a[240:243], v240 offset:1536
    s_waitcnt lgkmcnt(5)
    v_mfma_f32_16x16x32_bf16 v[216:219], a[20:23], a[244:247], v[216:219]
    buffer_load_dwordx4 v172, s[8:11], s60 offen lds
    s_add_u32 m0, s29, 0x400
    v_mfma_f32_16x16x32_bf16 v[220:223], a[44:47], a[244:247], v[220:223]
    buffer_load_dwordx4 v173, s[8:11], s60 offen lds
    s_add_u32 m0, s29, 0x800
    v_mfma_f32_16x16x32_bf16 v[224:227], a[68:71], a[244:247], v[224:227]
    ds_read_b128 a[244:247], v241 offset:1536
    v_mfma_f32_16x16x32_bf16 v[180:183], a[216:219], a[72:75], 0
    v_cvt_pk_bf16_f32 v156, v216, v217
    v_cvt_pk_bf16_f32 v157, v218, v219
    v_mfma_f32_16x16x32_bf16 v[184:187], a[216:219], a[96:99], 0
    buffer_load_dwordx4 v174, s[8:11], s60 offen lds
    s_add_u32 m0, s29, 0xc00
    v_cvt_pk_bf16_f32 v158, v220, v221
    v_mfma_f32_16x16x32_bf16 v[188:191], a[216:219], a[120:123], 0
    ds_read_b128 a[216:219], v240 offset:1664
    s_mov_b32 s60, 0x3800
    v_cvt_pk_bf16_f32 v159, v222, v223
    v_mfma_f32_16x16x32_bf16 v[180:183], a[220:223], a[76:79], v[180:183]
    s_waitcnt vmcnt(9) lgkmcnt(3)
    v_cvt_pk_bf16_f32 v160, v224, v225
    v_cvt_pk_bf16_f32 v161, v226, v227
    v_mfma_f32_16x16x32_bf16 v[184:187], a[220:223], a[100:103], v[184:187]
    ds_read_b64_tr_b16 a[148:149], v249 offset:3072
    s_waitcnt lgkmcnt(3)
    v_mfma_f32_16x16x32_bf16 v[188:191], a[220:223], a[124:127], v[188:191]
    ds_read_b64_tr_b16 a[150:151], v250 offset:3072
    v_mfma_f32_16x16x32_bf16 v[180:183], a[224:227], a[80:83], v[180:183]
    ds_read_b64_tr_b16 a[172:173], v249 offset:3104
    v_mfma_f32_16x16x32_bf16 v[184:187], a[224:227], a[104:107], v[184:187]
    ds_read_b64_tr_b16 a[174:175], v250 offset:3104
    v_mfma_f32_16x16x32_bf16 v[188:191], a[224:227], a[128:131], v[188:191]
    ds_read_b64_tr_b16 a[196:197], v249 offset:3136
    v_mfma_f32_16x16x32_bf16 v[180:183], a[228:231], a[84:87], v[180:183]
    ds_read_b64_tr_b16 a[198:199], v250 offset:3136
    v_mfma_f32_16x16x32_bf16 v[184:187], a[228:231], a[108:111], v[184:187]
    ds_read_b128 a[220:223], v241 offset:1664
    v_mfma_f32_16x16x32_bf16 v[188:191], a[228:231], a[132:135], v[188:191]
    ds_read_b128 a[224:227], v240 offset:1792
    v_mfma_f32_16x16x32_bf16 v[180:183], a[232:235], a[88:91], v[180:183]
    ds_read_b128 a[228:231], v241 offset:1792
    v_mfma_f32_16x16x32_bf16 v[184:187], a[232:235], a[112:115], v[184:187]
    v_mfma_f32_16x16x32_bf16 v[188:191], a[232:235], a[136:139], v[188:191]
    ds_read_b128 a[232:235], v240 offset:3072
    v_mfma_f32_16x16x32_bf16 v[180:183], a[236:239], a[92:95], v[180:183]
    v_mfma_f32_16x16x32_bf16 v[184:187], a[236:239], a[116:119], v[184:187]
    v_mfma_f32_16x16x32_bf16 v[188:191], a[236:239], a[140:143], v[188:191]
    ds_read_b128 a[236:239], v241 offset:3072
    s_waitcnt lgkmcnt(5)
    v_mfma_f32_16x16x32_bf16 v[192:195], a[240:243], a[72:75], 0
    buffer_load_dwordx4 v172, s[8:11], s61 offen lds
    s_add_u32 m0, s29, 0x1000
    v_mfma_f32_16x16x32_bf16 v[196:199], a[240:243], a[96:99], 0
    buffer_load_dwordx4 v173, s[8:11], s61 offen lds
    s_add_u32 m0, s29, 0x1400
    v_cvt_pk_bf16_f32 v0, v180, v181
    v_mfma_f32_16x16x32_bf16 v[200:203], a[240:243], a[120:123], 0
    ds_read_b128 a[240:243], v240 offset:3200
    v_cvt_pk_bf16_f32 v3, v182, v183
    v_mfma_f32_16x16x32_bf16 v[192:195], a[244:247], a[76:79], v[192:195]
    v_cvt_pk_bf16_f32 v30, v184, v185
    v_cvt_pk_bf16_f32 v33, v186, v187
    v_mfma_f32_16x16x32_bf16 v[196:199], a[244:247], a[100:103], v[196:199]
    v_cvt_pk_bf16_f32 v60, v188, v189
    v_cvt_pk_bf16_f32 v63, v190, v191
    v_mfma_f32_16x16x32_bf16 v[200:203], a[244:247], a[124:127], v[200:203]
    ds_read_b128 a[244:247], v241 offset:3200
    s_waitcnt lgkmcnt(3)
    v_mfma_f32_16x16x32_bf16 v[192:195], a[216:219], a[80:83], v[192:195]
    v_mfma_f32_16x16x32_bf16 v[196:199], a[216:219], a[104:107], v[196:199]
    buffer_load_dwordx4 v174, s[8:11], s61 offen lds
    s_add_u32 m0, s29, 0x1800
    s_mov_b32 s61, 0xc00
    v_mfma_f32_16x16x32_bf16 v[200:203], a[216:219], a[128:131], v[200:203]
    ds_read_b128 a[216:219], v240 offset:3328
    s_waitcnt vmcnt(9)
    v_mfma_f32_16x16x32_bf16 v[192:195], a[220:223], a[84:87], v[192:195]
    ds_read_b64_tr_b16 a[152:153], v249 offset:6144
    v_mfma_f32_16x16x32_bf16 v[196:199], a[220:223], a[108:111], v[196:199]
    ds_read_b64_tr_b16 a[154:155], v250 offset:6144
    v_mfma_f32_16x16x32_bf16 v[200:203], a[220:223], a[132:135], v[200:203]
    ds_read_b64_tr_b16 a[176:177], v249 offset:6176
    v_mfma_f32_16x16x32_bf16 v[192:195], a[224:227], a[88:91], v[192:195]
    ds_read_b64_tr_b16 a[178:179], v250 offset:6176
    v_mfma_f32_16x16x32_bf16 v[196:199], a[224:227], a[112:115], v[196:199]
    ds_read_b64_tr_b16 a[200:201], v249 offset:6208
    v_mfma_f32_16x16x32_bf16 v[200:203], a[224:227], a[136:139], v[200:203]
    ds_read_b64_tr_b16 a[202:203], v250 offset:6208
    v_mfma_f32_16x16x32_bf16 v[192:195], a[228:231], a[92:95], v[192:195]
    ds_read_b128 a[220:223], v241 offset:3328
    v_mfma_f32_16x16x32_bf16 v[196:199], a[228:231], a[116:119], v[196:199]
    ds_read_b128 a[224:227], v240 offset:30720
    v_mfma_f32_16x16x32_bf16 v[200:203], a[228:231], a[140:143], v[200:203]
    ds_read_b128 a[228:231], v241 offset:30720
    v_mfma_f32_16x16x32_bf16 v[204:207], a[232:235], a[72:75], 0
    s_waitcnt lgkmcnt(8)
    v_mfma_f32_16x16x32_bf16 v[208:211], a[232:235], a[96:99], 0
    v_cvt_pk_bf16_f32 v6, v192, v193
    v_cvt_pk_bf16_f32 v9, v194, v195
    v_mfma_f32_16x16x32_bf16 v[212:215], a[232:235], a[120:123], 0
    ds_read_b128 a[232:235], v240 offset:30848
    v_cvt_pk_bf16_f32 v36, v196, v197
    v_mfma_f32_16x16x32_bf16 v[204:207], a[236:239], a[76:79], v[204:207]
    v_cvt_pk_bf16_f32 v39, v198, v199
    v_cvt_pk_bf16_f32 v66, v200, v201
    v_mfma_f32_16x16x32_bf16 v[208:211], a[236:239], a[100:103], v[208:211]
    v_cvt_pk_bf16_f32 v69, v202, v203
    s_waitcnt lgkmcnt(4)
    v_mfma_f32_16x16x32_bf16 v[212:215], a[236:239], a[124:127], v[212:215]
    buffer_load_dwordx4 v28, s[12:15], s62 offen lds
    s_add_u32 m0, s29, 0x1c00
    v_mfma_f32_16x16x32_bf16 v[204:207], a[240:243], a[80:83], v[204:207]
    buffer_load_dwordx4 v29, s[12:15], s62 offen lds
    s_add_u32 m0, s29, 0x2000
    s_waitcnt lgkmcnt(2)
    v_mfma_f32_16x16x32_bf16 v[208:211], a[240:243], a[104:107], v[208:211]
    ds_read_b128 a[236:239], v241 offset:30848
    v_mfma_f32_16x16x32_bf16 v[212:215], a[240:243], a[128:131], v[212:215]
    ds_read_b128 a[240:243], v240 offset:30976
    v_mfma_f32_16x16x32_bf16 v[204:207], a[244:247], a[84:87], v[204:207]
    v_mfma_f32_16x16x32_bf16 v[208:211], a[244:247], a[108:111], v[208:211]
    buffer_load_dwordx4 v58, s[12:15], s62 offen lds
    s_add_u32 m0, s29, 0x2400
    s_mov_b32 s62, 0x2400
    v_mfma_f32_16x16x32_bf16 v[212:215], a[244:247], a[132:135], v[212:215]
    ds_read_b128 a[244:247], v241 offset:30976
    s_waitcnt vmcnt(9)
    v_mfma_f32_16x16x32_bf16 v[204:207], a[216:219], a[88:91], v[204:207]
    ds_read_b64_tr_b16 a[156:157], v249 offset:9216
    v_mfma_f32_16x16x32_bf16 v[208:211], a[216:219], a[112:115], v[208:211]
    ds_read_b64_tr_b16 a[158:159], v250 offset:9216
    v_mfma_f32_16x16x32_bf16 v[212:215], a[216:219], a[136:139], v[212:215]
    ds_read_b64_tr_b16 a[180:181], v249 offset:9248
    v_mfma_f32_16x16x32_bf16 v[204:207], a[220:223], a[92:95], v[204:207]
    ds_read_b64_tr_b16 a[182:183], v250 offset:9248
    v_mfma_f32_16x16x32_bf16 v[208:211], a[220:223], a[116:119], v[208:211]
    ds_read_b64_tr_b16 a[204:205], v249 offset:9280
    v_mfma_f32_16x16x32_bf16 v[212:215], a[220:223], a[140:143], v[212:215]
    ds_read_b64_tr_b16 a[206:207], v250 offset:9280
    v_mfma_f32_16x16x32_bf16 v[216:219], a[224:227], a[72:75], 0
    ds_read_b128 a[216:219], v240 offset:32256
    s_waitcnt lgkmcnt(8)
    v_cvt_pk_bf16_f32 v12, v204, v205
    v_mfma_f32_16x16x32_bf16 v[220:223], a[224:227], a[96:99], 0
    ds_read_b128 a[220:223], v241 offset:32256
    v_cvt_pk_bf16_f32 v15, v206, v207
    v_mfma_f32_16x16x32_bf16 v[224:227], a[224:227], a[120:123], 0
    ds_read_b128 a[224:227], v240 offset:32384
    v_cvt_pk_bf16_f32 v42, v208, v209
    v_mfma_f32_16x16x32_bf16 v[216:219], a[228:231], a[76:79], v[216:219]
    v_cvt_pk_bf16_f32 v45, v210, v211
    v_cvt_pk_bf16_f32 v72, v212, v213
    v_mfma_f32_16x16x32_bf16 v[220:223], a[228:231], a[100:103], v[220:223]
    v_cvt_pk_bf16_f32 v75, v214, v215
    v_mfma_f32_16x16x32_bf16 v[224:227], a[228:231], a[124:127], v[224:227]
    ds_read_b128 a[228:231], v241 offset:32384
    v_mfma_f32_16x16x32_bf16 v[216:219], a[232:235], a[80:83], v[216:219]
    v_mfma_f32_16x16x32_bf16 v[220:223], a[232:235], a[104:107], v[220:223]
    v_mfma_f32_16x16x32_bf16 v[224:227], a[232:235], a[128:131], v[224:227]
    ds_read_b128 a[232:235], v240 offset:32512
    s_waitcnt lgkmcnt(4)
    v_mfma_f32_16x16x32_bf16 v[216:219], a[236:239], a[84:87], v[216:219]
    buffer_load_dwordx4 v28, s[12:15], s63 offen lds
    s_add_u32 m0, s29, 0x2800
    v_mfma_f32_16x16x32_bf16 v[220:223], a[236:239], a[108:111], v[220:223]
    buffer_load_dwordx4 v29, s[12:15], s63 offen lds
    s_add_u32 m0, s29, 0x2c00
    v_mfma_f32_16x16x32_bf16 v[224:227], a[236:239], a[132:135], v[224:227]
    ds_read_b128 a[236:239], v241 offset:32512
    v_mfma_f32_16x16x32_bf16 v[216:219], a[240:243], a[88:91], v[216:219]
    v_mfma_f32_16x16x32_bf16 v[220:223], a[240:243], a[112:115], v[220:223]
    buffer_load_dwordx4 v58, s[12:15], s63 offen lds
    s_add_u32 m0, s29, 0
    s_mov_b32 s63, 0x3c00
    v_mfma_f32_16x16x32_bf16 v[224:227], a[240:243], a[136:139], v[224:227]
    ds_read_b128 a[240:243], v240 offset:33792
    s_waitcnt vmcnt(9)
    v_mfma_f32_16x16x32_bf16 v[216:219], a[244:247], a[92:95], v[216:219]
    ds_read_b64_tr_b16 a[160:161], v249 offset:0
    v_mfma_f32_16x16x32_bf16 v[220:223], a[244:247], a[116:119], v[220:223]
    ds_read_b64_tr_b16 a[162:163], v250 offset:0
    v_mfma_f32_16x16x32_bf16 v[224:227], a[244:247], a[140:143], v[224:227]
    ds_read_b64_tr_b16 a[184:185], v249 offset:32
    v_mfma_f32_16x16x32_bf16 v[180:183], a[216:219], a[72:75], 0
    ds_read_b64_tr_b16 a[186:187], v250 offset:32
    s_waitcnt lgkmcnt(6)
    v_cvt_pk_bf16_f32 v1, v216, v217
    v_mfma_f32_16x16x32_bf16 v[184:187], a[216:219], a[96:99], 0
    ds_read_b64_tr_b16 a[208:209], v249 offset:64
    v_cvt_pk_bf16_f32 v4, v218, v219
    v_mfma_f32_16x16x32_bf16 v[188:191], a[216:219], a[120:123], 0
    ds_read_b64_tr_b16 a[210:211], v250 offset:64
    v_cvt_pk_bf16_f32 v31, v220, v221
    v_mfma_f32_16x16x32_bf16 v[180:183], a[220:223], a[76:79], v[180:183]
    ds_read_b128 a[244:247], v241 offset:33792
    v_cvt_pk_bf16_f32 v34, v222, v223
    v_mfma_f32_16x16x32_bf16 v[184:187], a[220:223], a[100:103], v[184:187]
    ds_read_b128 a[216:219], v240 offset:33920
    s_waitcnt lgkmcnt(8)
    v_cvt_pk_bf16_f32 v61, v224, v225
    v_mfma_f32_16x16x32_bf16 v[188:191], a[220:223], a[124:127], v[188:191]
    ds_read_b128 a[220:223], v241 offset:33920
    v_cvt_pk_bf16_f32 v64, v226, v227
    v_mfma_f32_16x16x32_bf16 v[180:183], a[224:227], a[80:83], v[180:183]
    v_mfma_f32_16x16x32_bf16 v[184:187], a[224:227], a[104:107], v[184:187]
    v_mfma_f32_16x16x32_bf16 v[188:191], a[224:227], a[128:131], v[188:191]
    ds_read_b128 a[224:227], v240 offset:34048
    v_mfma_f32_16x16x32_bf16 v[180:183], a[228:231], a[84:87], v[180:183]
    v_mfma_f32_16x16x32_bf16 v[184:187], a[228:231], a[108:111], v[184:187]
    v_mfma_f32_16x16x32_bf16 v[188:191], a[228:231], a[132:135], v[188:191]
    ds_read_b128 a[228:231], v241 offset:34048
    s_waitcnt lgkmcnt(4)
    v_mfma_f32_16x16x32_bf16 v[180:183], a[232:235], a[88:91], v[180:183]
    buffer_load_dwordx4 v28, s[12:15], s64 offen lds
    s_add_u32 m0, s29, 0x400
    v_mfma_f32_16x16x32_bf16 v[184:187], a[232:235], a[112:115], v[184:187]
    buffer_load_dwordx4 v29, s[12:15], s64 offen lds
    s_add_u32 m0, s29, 0x800
    v_mfma_f32_16x16x32_bf16 v[188:191], a[232:235], a[136:139], v[188:191]
    ds_read_b128 a[232:235], v240 offset:61440
    v_mfma_f32_16x16x32_bf16 v[180:183], a[236:239], a[92:95], v[180:183]
    v_mfma_f32_16x16x32_bf16 v[184:187], a[236:239], a[116:119], v[184:187]
    buffer_load_dwordx4 v58, s[12:15], s64 offen lds
    s_add_u32 m0, s29, 0xc00
    s_mov_b32 s64, 0x1000
    v_mfma_f32_16x16x32_bf16 v[188:191], a[236:239], a[140:143], v[188:191]
    ds_read_b128 a[236:239], v241 offset:61440
    s_waitcnt vmcnt(9)
    v_mfma_f32_16x16x32_bf16 v[192:195], a[240:243], a[72:75], 0
    ds_read_b64_tr_b16 a[164:165], v249 offset:3072
    v_cvt_pk_bf16_f32 v7, v180, v181
    v_mfma_f32_16x16x32_bf16 v[196:199], a[240:243], a[96:99], 0
    ds_read_b64_tr_b16 a[166:167], v250 offset:3072
    v_cvt_pk_bf16_f32 v10, v182, v183
    v_mfma_f32_16x16x32_bf16 v[200:203], a[240:243], a[120:123], 0
    ds_read_b64_tr_b16 a[188:189], v249 offset:3104
    v_cvt_pk_bf16_f32 v37, v184, v185
    v_mfma_f32_16x16x32_bf16 v[192:195], a[244:247], a[76:79], v[192:195]
    ds_read_b64_tr_b16 a[190:191], v250 offset:3104
    s_waitcnt lgkmcnt(6)
    v_cvt_pk_bf16_f32 v40, v186, v187
    v_mfma_f32_16x16x32_bf16 v[196:199], a[244:247], a[100:103], v[196:199]
    ds_read_b64_tr_b16 a[212:213], v249 offset:3136
    s_waitcnt lgkmcnt(6)
    v_cvt_pk_bf16_f32 v67, v188, v189
    v_mfma_f32_16x16x32_bf16 v[200:203], a[244:247], a[124:127], v[200:203]
    ds_read_b64_tr_b16 a[214:215], v250 offset:3136
    v_cvt_pk_bf16_f32 v70, v190, v191
    v_mfma_f32_16x16x32_bf16 v[192:195], a[216:219], a[80:83], v[192:195]
    ds_read_b128 a[240:243], v240 offset:61568
    v_mfma_f32_16x16x32_bf16 v[196:199], a[216:219], a[104:107], v[196:199]
    ds_read_b128 a[244:247], v241 offset:61568
    v_mfma_f32_16x16x32_bf16 v[200:203], a[216:219], a[128:131], v[200:203]
    ds_read_b128 a[216:219], v240 offset:61696
    v_mfma_f32_16x16x32_bf16 v[192:195], a[220:223], a[84:87], v[192:195]
    v_mfma_f32_16x16x32_bf16 v[196:199], a[220:223], a[108:111], v[196:199]
    v_mfma_f32_16x16x32_bf16 v[200:203], a[220:223], a[132:135], v[200:203]
    ds_read_b128 a[220:223], v241 offset:61696
    v_mfma_f32_16x16x32_bf16 v[192:195], a[224:227], a[88:91], v[192:195]
    v_mfma_f32_16x16x32_bf16 v[196:199], a[224:227], a[112:115], v[196:199]
    v_mfma_f32_16x16x32_bf16 v[200:203], a[224:227], a[136:139], v[200:203]
    ds_read_b128 a[224:227], v240 offset:62976
    s_waitcnt lgkmcnt(4)
    v_mfma_f32_16x16x32_bf16 v[192:195], a[228:231], a[92:95], v[192:195]
    buffer_load_dwordx4 v28, s[12:15], s65 offen lds
    s_add_u32 m0, s29, 0x1000
    v_mfma_f32_16x16x32_bf16 v[196:199], a[228:231], a[116:119], v[196:199]
    buffer_load_dwordx4 v29, s[12:15], s65 offen lds
    s_add_u32 m0, s29, 0x1400
    v_mfma_f32_16x16x32_bf16 v[200:203], a[228:231], a[140:143], v[200:203]
    ds_read_b128 a[228:231], v241 offset:62976
    v_mfma_f32_16x16x32_bf16 v[204:207], a[232:235], a[72:75], 0
    v_cvt_pk_bf16_f32 v13, v192, v193
    v_cvt_pk_bf16_f32 v16, v194, v195
    v_mfma_f32_16x16x32_bf16 v[208:211], a[232:235], a[96:99], 0
    v_cvt_pk_bf16_f32 v43, v196, v197
    v_cvt_pk_bf16_f32 v46, v198, v199
    v_mfma_f32_16x16x32_bf16 v[212:215], a[232:235], a[120:123], 0
    ds_read_b128 a[232:235], v240 offset:63104
    v_cvt_pk_bf16_f32 v73, v200, v201
    v_mfma_f32_16x16x32_bf16 v[204:207], a[236:239], a[76:79], v[204:207]
    buffer_load_dwordx4 v58, s[12:15], s65 offen lds
    s_add_u32 m0, s29, 0x1800
    v_cvt_pk_bf16_f32 v76, v202, v203
    v_mfma_f32_16x16x32_bf16 v[208:211], a[236:239], a[100:103], v[208:211]
    s_mov_b32 s65, 0x2800
    v_mov_b32 v195, 0
    s_waitcnt vmcnt(9) lgkmcnt(2)
    v_mfma_f32_16x16x32_bf16 v[212:215], a[236:239], a[124:127], v[212:215]
    ds_read_b128 a[236:239], v241 offset:63104
    v_mfma_f32_16x16x32_bf16 v[204:207], a[240:243], a[80:83], v[204:207]
    ds_read_b64_tr_b16 v[24:25], v59 offset:6144
    v_mfma_f32_16x16x32_bf16 v[208:211], a[240:243], a[104:107], v[208:211]
    ds_read_b64_tr_b16 v[26:27], v88 offset:6144
    v_mfma_f32_16x16x32_bf16 v[212:215], a[240:243], a[128:131], v[212:215]
    ds_read_b128 a[240:243], v240 offset:63232
    v_mfma_f32_16x16x32_bf16 v[204:207], a[244:247], a[84:87], v[204:207]
    ds_read_b64_tr_b16 v[54:55], v59 offset:6152
    v_mfma_f32_16x16x32_bf16 v[208:211], a[244:247], a[108:111], v[208:211]
    ds_read_b64_tr_b16 v[56:57], v88 offset:6152
    v_mfma_f32_16x16x32_bf16 v[212:215], a[244:247], a[132:135], v[212:215]
    ds_read_b128 a[244:247], v241 offset:63232
    v_mfma_f32_16x16x32_bf16 v[204:207], a[216:219], a[88:91], v[204:207]
    ds_read_b64_tr_b16 v[84:85], v249 offset:6208
    v_mfma_f32_16x16x32_bf16 v[208:211], a[216:219], a[112:115], v[208:211]
    ds_read_b64_tr_b16 v[86:87], v250 offset:6208
    v_mfma_f32_16x16x32_bf16 v[212:215], a[216:219], a[136:139], v[212:215]
    ds_read_b128 a[216:219], v240 offset:64512
    v_mfma_f32_16x16x32_bf16 v[204:207], a[220:223], a[92:95], v[204:207]
    v_mfma_f32_16x16x32_bf16 v[208:211], a[220:223], a[116:119], v[208:211]
    s_waitcnt lgkmcnt(7)
    v_mfma_f32_16x16x32_bf16 v[212:215], a[220:223], a[140:143], v[212:215]
    ds_read_b128 a[220:223], v241 offset:64512
    v_mfma_f32_16x16x32_bf16 v[216:219], a[224:227], a[72:75], 0
    buffer_store_dwordx4 v[24:27], v89, s[24:27], s50 offen
    v_mfma_f32_16x16x32_bf16 v[220:223], a[224:227], a[96:99], 0
    s_mov_b32 s50, 0x4000
    v_cvt_pk_bf16_f32 v2, v204, v205
    v_cvt_pk_bf16_f32 v5, v206, v207
    v_mfma_f32_16x16x32_bf16 v[224:227], a[224:227], a[120:123], 0
    ds_read_b128 a[224:227], v240 offset:64640
    s_waitcnt lgkmcnt(4)
    v_cvt_pk_bf16_f32 v32, v208, v209
    v_mfma_f32_16x16x32_bf16 v[216:219], a[228:231], a[76:79], v[216:219]
    buffer_store_dwordx4 v[54:57], v89, s[24:27], s51 offen
    v_mfma_f32_16x16x32_bf16 v[220:223], a[228:231], a[100:103], v[220:223]
    s_mov_b32 s51, 0x1400
    v_cvt_pk_bf16_f32 v35, v210, v211
    v_cvt_pk_bf16_f32 v62, v212, v213
    v_mfma_f32_16x16x32_bf16 v[224:227], a[228:231], a[124:127], v[224:227]
    ds_read_b128 a[228:231], v241 offset:64640
    s_waitcnt lgkmcnt(3)
    v_cvt_pk_bf16_f32 v65, v214, v215
    v_mfma_f32_16x16x32_bf16 v[216:219], a[232:235], a[80:83], v[216:219]
    v_mfma_f32_16x16x32_bf16 v[220:223], a[232:235], a[104:107], v[220:223]
    buffer_load_dwordx4 v28, s[12:15], s53 offen lds
    s_add_u32 m0, s29, 0x1c00
    s_waitcnt vmcnt(9)
    v_mfma_f32_16x16x32_bf16 v[224:227], a[232:235], a[128:131], v[224:227]
    ds_read_b128 a[232:235], v240 offset:64768
    v_mfma_f32_16x16x32_bf16 v[216:219], a[236:239], a[84:87], v[216:219]
    ds_read_b64_tr_b16 v[24:25], v59 offset:9216
    v_mfma_f32_16x16x32_bf16 v[220:223], a[236:239], a[108:111], v[220:223]
    ds_read_b64_tr_b16 v[26:27], v88 offset:9216
    v_mfma_f32_16x16x32_bf16 v[224:227], a[236:239], a[132:135], v[224:227]
    ds_read_b128 a[236:239], v241 offset:64768
    v_mfma_f32_16x16x32_bf16 v[216:219], a[240:243], a[88:91], v[216:219]
    ds_read_b64_tr_b16 v[54:55], v59 offset:9224
    v_mfma_f32_16x16x32_bf16 v[220:223], a[240:243], a[112:115], v[220:223]
    ds_read_b64_tr_b16 v[56:57], v88 offset:9224
    v_mfma_f32_16x16x32_bf16 v[224:227], a[240:243], a[136:139], v[224:227]
    buffer_load_dwordx4 v29, s[12:15], s53 offen lds
    s_add_u32 m0, s29, 0x2000
    v_mfma_f32_16x16x32_bf16 v[216:219], a[244:247], a[92:95], v[216:219]
    ds_read_b128 a[240:243], v242 offset:0
    v_mfma_f32_16x16x32_bf16 v[220:223], a[244:247], a[116:119], v[220:223]
    v_mfma_f32_16x16x32_bf16 v[224:227], a[244:247], a[140:143], v[224:227]
    ds_read_b128 a[244:247], v243 offset:0
    v_mfma_f32_16x16x32_bf16 v[180:183], a[216:219], a[72:75], 0
    s_waitcnt lgkmcnt(6)
    s_waitcnt lgkmcnt(5)
    v_mfma_f32_16x16x32_bf16 v[184:187], a[216:219], a[96:99], 0
    v_cvt_pk_bf16_f32 v8, v216, v217
    v_cvt_pk_bf16_f32 v11, v218, v219
    v_mfma_f32_16x16x32_bf16 v[188:191], a[216:219], a[120:123], 0
    ds_read_b128 a[216:219], v242 offset:128
    v_cvt_pk_bf16_f32 v38, v220, v221
    v_mfma_f32_16x16x32_bf16 v[180:183], a[220:223], a[76:79], v[180:183]
    buffer_load_dwordx4 v58, s[12:15], s53 offen lds
    s_add_u32 m0, s29, 0x2400
    v_cvt_pk_bf16_f32 v41, v222, v223
    v_mfma_f32_16x16x32_bf16 v[184:187], a[220:223], a[100:103], v[184:187]
    s_mov_b32 s53, 0x4400
    v_cvt_pk_bf16_f32 v68, v224, v225
    v_cvt_pk_bf16_f32 v71, v226, v227
    v_mfma_f32_16x16x32_bf16 v[188:191], a[220:223], a[124:127], v[188:191]
    ds_read_b128 a[220:223], v243 offset:128
    s_waitcnt lgkmcnt(3)
    v_mfma_f32_16x16x32_bf16 v[180:183], a[224:227], a[80:83], v[180:183]
    v_mfma_f32_16x16x32_bf16 v[184:187], a[224:227], a[104:107], v[184:187]
    v_mfma_f32_16x16x32_bf16 v[188:191], a[224:227], a[128:131], v[188:191]
    ds_read_b128 a[224:227], v242 offset:256
    v_mfma_f32_16x16x32_bf16 v[180:183], a[228:231], a[84:87], v[180:183]
    v_mfma_f32_16x16x32_bf16 v[184:187], a[228:231], a[108:111], v[184:187]
    buffer_store_dwordx4 v[84:87], v89, s[24:27], s52 offen
    v_mfma_f32_16x16x32_bf16 v[188:191], a[228:231], a[132:135], v[188:191]
    ds_read_b128 a[228:231], v243 offset:256
    s_mov_b32 s52, 0x2c00
    v_mfma_f32_16x16x32_bf16 v[180:183], a[232:235], a[88:91], v[180:183]
    ds_read_b64_tr_b16 v[84:85], v249 offset:9280
    v_mfma_f32_16x16x32_bf16 v[184:187], a[232:235], a[112:115], v[184:187]
    ds_read_b64_tr_b16 v[86:87], v250 offset:9280
    v_mfma_f32_16x16x32_bf16 v[188:191], a[232:235], a[136:139], v[188:191]
    ds_read_b128 a[232:235], v240 offset:4608
    v_mfma_f32_16x16x32_bf16 v[180:183], a[236:239], a[92:95], v[180:183]
    v_mfma_f32_16x16x32_bf16 v[184:187], a[236:239], a[116:119], v[184:187]
    v_mfma_f32_16x16x32_bf16 v[188:191], a[236:239], a[140:143], v[188:191]
    ds_read_b128 a[236:239], v241 offset:4608
    v_mfma_f32_16x16x32_bf16 v[228:231], a[144:147], a[240:243], 0
    buffer_store_dwordx4 v[24:27], v89, s[24:27], s54 offen
    v_mfma_f32_16x16x32_bf16 v[232:235], a[168:171], a[240:243], 0
    s_add_u32 s54, s43, s45
    s_waitcnt vmcnt(9) lgkmcnt(4)
    v_cvt_pk_bf16_f32 v14, v180, v181
    v_mfma_f32_16x16x32_bf16 v[228:231], a[148:151], a[244:247], v[228:231]
    ds_read_b64_tr_b16 v[24:25], v59 offset:0
    v_cvt_pk_bf16_f32 v17, v182, v183
    v_mfma_f32_16x16x32_bf16 v[228:231], a[152:155], a[216:219], v[228:231]
    ds_read_b64_tr_b16 v[26:27], v88 offset:0
    s_waitcnt lgkmcnt(4)
    v_cvt_pk_bf16_f32 v44, v184, v185
    v_mfma_f32_16x16x32_bf16 v[228:231], a[156:159], a[220:223], v[228:231]
    v_cvt_pk_bf16_f32 v47, v186, v187
    v_cvt_pk_bf16_f32 v74, v188, v189
    v_mfma_f32_16x16x32_bf16 v[228:231], a[160:163], a[224:227], v[228:231]
    v_cvt_pk_bf16_f32 v77, v190, v191
    v_mfma_f32_16x16x32_bf16 v[228:231], a[164:167], a[228:231], v[228:231]
    buffer_load_dwordx4 v28, s[12:15], s57 offen lds
    s_add_u32 m0, s29, 0x2800
    v_mfma_f32_16x16x32_bf16 v[232:235], a[172:175], a[244:247], v[232:235]
    v_mfma_f32_16x16x32_bf16 v[232:235], a[176:179], a[216:219], v[232:235]
    v_mfma_f32_16x16x32_bf16 v[232:235], a[180:183], a[220:223], v[232:235]
    v_mfma_f32_16x16x32_bf16 v[232:235], a[184:187], a[224:227], v[232:235]
    v_mfma_f32_16x16x32_bf16 v[232:235], a[188:191], a[228:231], v[232:235]
    v_mfma_f32_16x16x32_bf16 v[236:239], a[192:195], a[240:243], 0
    buffer_load_dwordx4 v29, s[12:15], s57 offen lds
    s_add_u32 m0, s29, 0x2c00
    v_mul_f32 v228, s38, v228
    v_mfma_f32_16x16x32_bf16 v[236:239], a[196:199], a[244:247], v[236:239]
    ds_read_b128 a[240:243], v240 offset:4736
    s_waitcnt lgkmcnt(1)
    v_mul_f32 v229, s38, v229
    v_mfma_f32_16x16x32_bf16 v[236:239], a[200:203], a[216:219], v[236:239]
    ds_read_b128 a[244:247], v241 offset:4736
    v_mul_f32 v230, s38, v230
    v_mfma_f32_16x16x32_bf16 v[236:239], a[204:207], a[220:223], v[236:239]
    ds_read_b128 a[216:219], v240 offset:4864
    v_mul_f32 v231, s38, v231
    v_mfma_f32_16x16x32_bf16 v[236:239], a[208:211], a[224:227], v[236:239]
    ds_read_b128 a[220:223], v241 offset:4864
    v_cvt_pk_bf16_f32 v168, v228, v229
    v_mfma_f32_16x16x32_bf16 v[236:239], a[212:215], a[228:231], v[236:239]
    ds_read_b128 a[224:227], v240 offset:35328
    ds_read_b128 a[228:231], v241 offset:35328
    v_cvt_pk_bf16_f32 v169, v230, v231
    v_mfma_f32_16x16x32_bf16 v[228:231], a[232:235], a[72:75], 0
    v_mul_f32 v232, s38, v232
    v_mul_f32 v233, s38, v233
    v_mfma_f32_16x16x32_bf16 v[228:231], a[236:239], a[76:79], v[228:231]
    buffer_load_dwordx4 v58, s[12:15], s57 offen lds
    s_add_u32 m0, s46, 0x16800
    v_mul_f32 v234, s38, v234
    v_mul_f32 v235, s38, v235
    v_cvt_pk_bf16_f32 v170, v232, v233
    v_cvt_pk_bf16_f32 v171, v234, v235
    v_mfma_f32_16x16x32_bf16 v[232:235], a[232:235], a[96:99], 0
    s_lshl1_add_u32 s57, s45, s43
    v_mul_f32 v236, s38, v236
    v_mul_f32 v237, s38, v237
    v_mfma_f32_16x16x32_bf16 v[232:235], a[236:239], a[100:103], v[232:235]
    s_waitcnt lgkmcnt(5)
    v_mul_f32 v238, s38, v238
    v_mul_f32 v239, s38, v239
    v_mfma_f32_16x16x32_bf16 v[228:231], a[240:243], a[80:83], v[228:231]
    s_waitcnt lgkmcnt(4)
    v_cvt_pk_bf16_f32 v172, v236, v237
    v_cvt_pk_bf16_f32 v173, v238, v239
    v_mfma_f32_16x16x32_bf16 v[228:231], a[244:247], a[84:87], v[228:231]
    s_waitcnt lgkmcnt(3)
    v_mfma_f32_16x16x32_bf16 v[228:231], a[216:219], a[88:91], v[228:231]
    s_waitcnt lgkmcnt(2)
    v_mfma_f32_16x16x32_bf16 v[228:231], a[220:223], a[92:95], v[228:231]
    v_mfma_f32_16x16x32_bf16 v[232:235], a[240:243], a[104:107], v[232:235]
    buffer_store_dwordx4 v[54:57], v89, s[24:27], s55 offen
    v_mfma_f32_16x16x32_bf16 v[232:235], a[244:247], a[108:111], v[232:235]
    s_add_u32 s55, s43, s45
    ds_read_b64_tr_b16 v[54:55], v59 offset:8
    v_mfma_f32_16x16x32_bf16 v[232:235], a[216:219], a[112:115], v[232:235]
    ds_read_b64_tr_b16 v[56:57], v88 offset:8
    v_mfma_f32_16x16x32_bf16 v[232:235], a[220:223], a[116:119], v[232:235]
    v_cvt_pk_bf16_f32 v18, v228, v229
    v_cvt_pk_bf16_f32 v21, v230, v231
    v_mfma_f32_16x16x32_bf16 v[236:239], a[232:235], a[120:123], 0
    ds_read_b128 a[232:235], v240 offset:35456
    s_waitcnt lgkmcnt(3)
    v_mfma_f32_16x16x32_bf16 v[236:239], a[236:239], a[124:127], v[236:239]
    ds_read_b128 a[236:239], v241 offset:35456
    v_mfma_f32_16x16x32_bf16 v[236:239], a[240:243], a[128:131], v[236:239]
    ds_read_b128 a[240:243], v240 offset:35584
    v_cvt_pk_bf16_f32 v48, v232, v233
    v_mfma_f32_16x16x32_bf16 v[236:239], a[244:247], a[132:135], v[236:239]
    ds_read_b128 a[244:247], v241 offset:35584
    v_cvt_pk_bf16_f32 v51, v234, v235
    v_mfma_f32_16x16x32_bf16 v[236:239], a[216:219], a[136:139], v[236:239]
    buffer_store_dwordx4 v[84:87], v89, s[24:27], s56 offen
    v_mfma_f32_16x16x32_bf16 v[236:239], a[220:223], a[140:143], v[236:239]
    s_add_u32 s56, s43, s45
    v_add_u32 v240, 0xf000, v240
    v_add_u32 v241, 0xf000, v241
    v_mfma_f32_16x16x32_bf16 v[228:231], a[224:227], a[72:75], 0
    ds_read_b128 a[216:219], v240 offset:4608
    s_waitcnt lgkmcnt(5)
    v_mfma_f32_16x16x32_bf16 v[228:231], a[228:231], a[76:79], v[228:231]
    ds_read_b128 a[220:223], v241 offset:4608
    v_cvt_pk_bf16_f32 v78, v236, v237
    v_mfma_f32_16x16x32_bf16 v[232:235], a[224:227], a[96:99], 0
    ds_read_b64_tr_b16 v[84:85], v249 offset:64
    s_waitcnt lgkmcnt(6)
    v_cvt_pk_bf16_f32 v81, v238, v239
    v_mfma_f32_16x16x32_bf16 v[228:231], a[232:235], a[80:83], v[228:231]
    buffer_store_dwordx4 v[24:27], v89, s[24:27], s58 offen
    v_mfma_f32_16x16x32_bf16 v[232:235], a[228:231], a[100:103], v[232:235]
    ds_read_b64_tr_b16 v[86:87], v250 offset:64
    s_lshl1_add_u32 s58, s45, s43
    s_waitcnt vmcnt(9) lgkmcnt(5)
    v_mfma_f32_16x16x32_bf16 v[228:231], a[236:239], a[84:87], v[228:231]
    ds_read_b64_tr_b16 v[24:25], v59 offset:3072
    v_mfma_f32_16x16x32_bf16 v[228:231], a[240:243], a[88:91], v[228:231]
    ds_read_b64_tr_b16 v[26:27], v88 offset:3072
    s_waitcnt lgkmcnt(6)
    v_mfma_f32_16x16x32_bf16 v[228:231], a[244:247], a[92:95], v[228:231]
    v_mfma_f32_16x16x32_bf16 v[232:235], a[232:235], a[104:107], v[232:235]
    v_mfma_f32_16x16x32_bf16 v[232:235], a[236:239], a[108:111], v[232:235]
    buffer_store_dwordx4 v[54:57], v89, s[24:27], s59 offen
    v_mfma_f32_16x16x32_bf16 v[232:235], a[240:243], a[112:115], v[232:235]
    s_add_u32 s59, s44, s45
    ds_read_b64_tr_b16 v[54:55], v59 offset:3080
    v_mfma_f32_16x16x32_bf16 v[232:235], a[244:247], a[116:119], v[232:235]
    ds_read_b64_tr_b16 v[56:57], v88 offset:3080
    v_cvt_pk_bf16_f32 v19, v228, v229
    v_mfma_f32_16x16x32_bf16 v[236:239], a[224:227], a[120:123], 0
    ds_read_b128 a[224:227], v240 offset:4736
    s_waitcnt lgkmcnt(5)
    v_cvt_pk_bf16_f32 v22, v230, v231
    v_mfma_f32_16x16x32_bf16 v[236:239], a[228:231], a[124:127], v[236:239]
    ds_read_b128 a[228:231], v241 offset:4736
    v_cvt_pk_bf16_f32 v49, v232, v233
    v_mfma_f32_16x16x32_bf16 v[236:239], a[232:235], a[128:131], v[236:239]
    ds_read_b128 a[232:235], v240 offset:4864
    s_waitcnt lgkmcnt(5)
    v_cvt_pk_bf16_f32 v52, v234, v235
    v_mfma_f32_16x16x32_bf16 v[236:239], a[236:239], a[132:135], v[236:239]
    ds_read_b128 a[236:239], v241 offset:4864
    v_add_u32 v240, 0xffff1000, v240
    v_mfma_f32_16x16x32_bf16 v[236:239], a[240:243], a[136:139], v[236:239]
    ds_read_b128 a[240:243], v240 offset:6144
    v_add_u32 v241, 0xffff1000, v241
    v_mfma_f32_16x16x32_bf16 v[236:239], a[244:247], a[140:143], v[236:239]
    ds_read_b128 a[244:247], v241 offset:6144
    v_mfma_f32_16x16x32_bf16 v[228:231], a[216:219], a[72:75], 0
    buffer_store_dwordx4 v[84:87], v89, s[24:27], s60 offen
    v_mfma_f32_16x16x32_bf16 v[228:231], a[220:223], a[76:79], v[228:231]
    s_add_u32 s60, s44, s45
    ds_read_b64_tr_b16 v[84:85], v249 offset:3136
    v_mfma_f32_16x16x32_bf16 v[232:235], a[216:219], a[96:99], 0
    ds_read_b64_tr_b16 v[86:87], v250 offset:3136
    s_waitcnt lgkmcnt(7)
    v_cvt_pk_bf16_f32 v79, v236, v237
    v_mfma_f32_16x16x32_bf16 v[228:231], a[224:227], a[80:83], v[228:231]
    s_waitcnt lgkmcnt(6)
    v_cvt_pk_bf16_f32 v82, v238, v239
    v_mfma_f32_16x16x32_bf16 v[228:231], a[228:231], a[84:87], v[228:231]
    s_waitcnt lgkmcnt(5)
    v_mfma_f32_16x16x32_bf16 v[228:231], a[232:235], a[88:91], v[228:231]
    buffer_store_dwordx4 v[24:27], v89, s[24:27], s61 offen
    v_mfma_f32_16x16x32_bf16 v[232:235], a[220:223], a[100:103], v[232:235]
    s_add_u32 s61, s44, s45
    s_waitcnt vmcnt(9) lgkmcnt(3)
    v_mfma_f32_16x16x32_bf16 v[228:231], a[236:239], a[92:95], v[228:231]
    ds_read_b64_tr_b16 v[24:25], v59 offset:6144
    v_mfma_f32_16x16x32_bf16 v[232:235], a[224:227], a[104:107], v[232:235]
    ds_read_b64_tr_b16 v[26:27], v88 offset:6144
    v_mfma_f32_16x16x32_bf16 v[232:235], a[228:231], a[108:111], v[232:235]
    v_mfma_f32_16x16x32_bf16 v[232:235], a[232:235], a[112:115], v[232:235]
    s_waitcnt lgkmcnt(2)
    v_mfma_f32_16x16x32_bf16 v[232:235], a[236:239], a[116:119], v[232:235]
    buffer_store_dwordx4 v[54:57], v89, s[24:27], s62 offen
    v_mfma_f32_16x16x32_bf16 v[236:239], a[216:219], a[120:123], 0
    ds_read_b128 a[216:219], v240 offset:6272
    s_lshl1_add_u32 s62, s45, s44
    v_cvt_pk_bf16_f32 v20, v228, v229
    v_mfma_f32_16x16x32_bf16 v[236:239], a[220:223], a[124:127], v[236:239]
    ds_read_b128 a[220:223], v241 offset:6272
    v_cvt_pk_bf16_f32 v23, v230, v231
    v_mfma_f32_16x16x32_bf16 v[236:239], a[224:227], a[128:131], v[236:239]
    ds_read_b128 a[224:227], v240 offset:6400
    v_cvt_pk_bf16_f32 v50, v232, v233
    v_mfma_f32_16x16x32_bf16 v[236:239], a[228:231], a[132:135], v[236:239]
    ds_read_b128 a[228:231], v241 offset:6400
    v_cvt_pk_bf16_f32 v53, v234, v235
    v_mfma_f32_16x16x32_bf16 v[236:239], a[232:235], a[136:139], v[236:239]
    ds_read_b128 a[232:235], v242 offset:1536
    s_waitcnt lgkmcnt(5)
    v_mfma_f32_16x16x32_bf16 v[236:239], a[236:239], a[140:143], v[236:239]
    ds_read_b128 a[236:239], v243 offset:1536
    v_mfma_f32_16x16x32_bf16 v[228:231], a[0:3], a[240:243], 0
    buffer_store_dwordx4 v[84:87], v89, s[24:27], s63 offen
    v_mfma_f32_16x16x32_bf16 v[228:231], a[4:7], a[244:247], v[228:231]
    ds_read_b64_tr_b16 v[54:55], v59 offset:6152
    s_lshl1_add_u32 s63, s45, s44
    v_mfma_f32_16x16x32_bf16 v[232:235], a[24:27], a[240:243], 0
    ds_read_b64_tr_b16 v[56:57], v88 offset:6152
    s_waitcnt lgkmcnt(7)
    v_cvt_pk_bf16_f32 v80, v236, v237
    v_mfma_f32_16x16x32_bf16 v[228:231], a[8:11], a[216:219], v[228:231]
    ds_read_b64_tr_b16 v[84:85], v249 offset:6208
    s_waitcnt lgkmcnt(7)
    v_cvt_pk_bf16_f32 v83, v238, v239
    v_mfma_f32_16x16x32_bf16 v[228:231], a[12:15], a[220:223], v[228:231]
    ds_read_b64_tr_b16 v[86:87], v250 offset:6208
    s_waitcnt lgkmcnt(7)
    v_mfma_f32_16x16x32_bf16 v[228:231], a[16:19], a[224:227], v[228:231]
    s_waitcnt lgkmcnt(6)
    v_mfma_f32_16x16x32_bf16 v[228:231], a[20:23], a[228:231], v[228:231]
    v_mfma_f32_16x16x32_bf16 v[232:235], a[28:31], a[244:247], v[232:235]
    buffer_store_dwordx4 v[24:27], v89, s[24:27], s64 offen
    v_mfma_f32_16x16x32_bf16 v[232:235], a[32:35], a[216:219], v[232:235]
    s_mov_b32 s64, 0
    s_waitcnt vmcnt(9)
    v_mfma_f32_16x16x32_bf16 v[232:235], a[36:39], a[220:223], v[232:235]
    ds_read_b64_tr_b16 v[24:25], v59 offset:9216
    v_mfma_f32_16x16x32_bf16 v[232:235], a[40:43], a[224:227], v[232:235]
    ds_read_b64_tr_b16 v[26:27], v88 offset:9216
    s_waitcnt lgkmcnt(4)
    v_cvt_pk_bf16_f32 v162, v228, v229
    v_mfma_f32_16x16x32_bf16 v[232:235], a[44:47], a[228:231], v[232:235]
    v_cvt_pk_bf16_f32 v163, v230, v231
    v_mfma_f32_16x16x32_bf16 v[236:239], a[48:51], a[240:243], 0
    ds_read_b128 a[240:243], v242 offset:1664
    s_waitcnt lgkmcnt(3)
    v_mfma_f32_16x16x32_bf16 v[236:239], a[52:55], a[244:247], v[236:239]
    ds_read_b128 a[244:247], v243 offset:1664
    v_mfma_f32_16x16x32_bf16 v[236:239], a[56:59], a[216:219], v[236:239]
    ds_read_b128 a[216:219], v242 offset:1792
    v_cvt_pk_bf16_f32 v164, v232, v233
    v_mfma_f32_16x16x32_bf16 v[236:239], a[60:63], a[220:223], v[236:239]
    ds_read_b128 a[220:223], v243 offset:1792
    v_cvt_pk_bf16_f32 v165, v234, v235
    v_mfma_f32_16x16x32_bf16 v[236:239], a[64:67], a[224:227], v[236:239]
    buffer_store_dwordx4 v[54:57], v89, s[24:27], s65 offen
    v_mfma_f32_16x16x32_bf16 v[236:239], a[68:71], a[228:231], v[236:239]
    s_mov_b32 s65, 0
    ds_read_b64_tr_b16 v[54:55], v59 offset:9224
    v_mfma_f32_16x16x32_bf16 v[228:231], a[144:147], a[232:235], 0
    ds_read_b64_tr_b16 v[56:57], v88 offset:9224
    s_waitcnt lgkmcnt(6)
    v_mfma_f32_16x16x32_bf16 v[228:231], a[148:151], a[236:239], v[228:231]
    v_mfma_f32_16x16x32_bf16 v[232:235], a[168:171], a[232:235], 0
    buffer_store_dwordx4 v[84:87], v89, s[24:27], s50 offen
    v_mfma_f32_16x16x32_bf16 v[232:235], a[172:175], a[236:239], v[232:235]
    s_waitcnt lgkmcnt(4)
    v_cvt_pk_bf16_f32 v166, v236, v237
    v_cvt_pk_bf16_f32 v167, v238, v239
    v_mfma_f32_16x16x32_bf16 v[228:231], a[152:155], a[240:243], v[228:231]
    ds_read_b64_tr_b16 v[84:85], v249 offset:9280
    s_mov_b32 s50, 0
    v_mfma_f32_16x16x32_bf16 v[228:231], a[156:159], a[244:247], v[228:231]
    ds_read_b64_tr_b16 v[86:87], v250 offset:9280
    s_waitcnt lgkmcnt(4)
    v_mfma_f32_16x16x32_bf16 v[228:231], a[160:163], a[216:219], v[228:231]
    v_mfma_f32_16x16x32_bf16 v[228:231], a[164:167], a[220:223], v[228:231]
    v_mfma_f32_16x16x32_bf16 v[232:235], a[176:179], a[240:243], v[232:235]
    buffer_store_dwordx4 v[24:27], v89, s[24:27], s51 offen
    v_mfma_f32_16x16x32_bf16 v[232:235], a[180:183], a[244:247], v[232:235]
    s_mov_b32 s51, 0
    s_waitcnt lgkmcnt(2)
    v_mfma_f32_16x16x32_bf16 v[232:235], a[184:187], a[216:219], v[232:235]
    v_mfma_f32_16x16x32_bf16 v[232:235], a[188:191], a[220:223], v[232:235]
    v_mfma_f32_16x16x32_bf16 v[236:239], a[192:195], a[232:235], 0
    v_mul_f32 v228, s38, v228
    v_mul_f32 v229, s38, v229
    v_mfma_f32_16x16x32_bf16 v[236:239], a[196:199], a[236:239], v[236:239]
    s_waitcnt lgkmcnt(0)
    v_mul_f32 v230, s38, v230
    v_mul_f32 v231, s38, v231
    v_mfma_f32_16x16x32_bf16 v[236:239], a[200:203], a[240:243], v[236:239]
    s_barrier
    v_cvt_pk_bf16_f32 v174, v228, v229
    v_cvt_pk_bf16_f32 v175, v230, v231
    v_mfma_f32_16x16x32_bf16 v[236:239], a[204:207], a[244:247], v[236:239]
    ds_read_b128 v[196:199], v244 offset:192
    v_mul_f32 v232, s38, v232
    v_mfma_f32_16x16x32_bf16 v[236:239], a[208:211], a[216:219], v[236:239]
    ds_read_b128 v[200:203], v245 offset:192
    v_mul_f32 v233, s38, v233
    v_mfma_f32_16x16x32_bf16 v[236:239], a[212:215], a[220:223], v[236:239]
    ds_read_b128 v[204:207], v246 offset:192
    ds_read_b128 v[208:211], v244 offset:256
    buffer_load_dwordx4 v254, s[4:7], s43 offen lds
    s_add_u32 m0, s46, 0x16c00
    v_mul_f32 v234, s38, v234
    v_mul_f32 v235, s38, v235
    v_cvt_pk_bf16_f32 v176, v232, v233
    v_cvt_pk_bf16_f32 v177, v234, v235
    v_mul_f32 v236, s38, v236
    v_mul_f32 v237, s38, v237
    v_mul_f32 v238, s38, v238
    v_mul_f32 v239, s38, v239
    v_cvt_pk_bf16_f32 v178, v236, v237
    v_cvt_pk_bf16_f32 v179, v238, v239
    v_accvgpr_read_b32 v254, a254
    ds_read_b128 a[224:227], v240 offset:6144
    ds_read_b128 a[228:231], v241 offset:6144
    buffer_load_dwordx4 v255, s[4:7], s43 offen lds
    s_add_u32 m0, s46, 0x17000
    v_accvgpr_read_b32 v255, a252
    ds_read_b128 a[232:235], v240 offset:6272
    ds_read_b128 a[236:239], v241 offset:6272
    s_waitcnt lgkmcnt(7)
    v_mfma_f32_16x16x32_bf16 v[196:199], v[90:93], v[168:171], v[196:199]
    ds_read_b128 a[240:243], v240 offset:6400
    ds_read_b128 a[244:247], v241 offset:6400
    s_waitcnt lgkmcnt(8)
    v_mfma_f32_16x16x32_bf16 v[200:203], v[114:117], v[168:171], v[200:203]
    ds_read_b128 a[216:219], v240 offset:36864
    s_waitcnt lgkmcnt(8)
    v_mfma_f32_16x16x16_bf16 v[196:199], v[94:95], v[172:173], v[196:199]
    ds_read_b128 a[220:223], v241 offset:36864
    s_waitcnt lgkmcnt(8)
    v_mfma_f32_16x16x32_bf16 v[204:207], v[138:141], v[168:171], v[204:207]
    v_mfma_f32_16x16x16_bf16 v[200:203], v[118:119], v[172:173], v[200:203]
    v_mfma_f32_16x16x32_bf16 v[208:211], v[96:99], v[168:171], v[208:211]
    buffer_load_dwordx4 v254, s[4:7], s43 offen lds
    s_add_u32 m0, s46, 0x17400
    s_waitcnt lgkmcnt(7)
    v_mfma_f32_16x16x32_bf16 v[228:231], a[224:227], a[72:75], 0
    s_waitcnt lgkmcnt(6)
    v_accvgpr_read_b32 v254, a253
    v_mfma_f32_16x16x16_bf16 v[204:207], v[142:143], v[172:173], v[204:207]
    v_exp_f32 v196, v196
    v_mfma_f32_16x16x16_bf16 v[208:211], v[100:101], v[172:173], v[208:211]
    v_exp_f32 v197, v197
    v_mfma_f32_16x16x32_bf16 v[228:231], a[228:231], a[76:79], v[228:231]
    s_waitcnt lgkmcnt(2)
    v_exp_f32 v198, v198
    v_mfma_f32_16x16x32_bf16 v[228:231], a[232:235], a[80:83], v[228:231]
    v_exp_f32 v199, v199
    v_mfma_f32_16x16x32_bf16 v[228:231], a[236:239], a[84:87], v[228:231]
    v_cvt_pk_bf16_f32 v180, v196, v197
    v_cvt_pk_bf16_f32 v183, v198, v199
    v_mfma_f32_16x16x32_bf16 v[228:231], a[240:243], a[88:91], v[228:231]
    ds_read_b128 v[196:199], v245 offset:256
    v_mfma_f32_16x16x32_bf16 v[228:231], a[244:247], a[92:95], v[228:231]
    buffer_load_dwordx4 v255, s[4:7], s54 offen lds
    s_add_u32 m0, s46, 0x17800
    v_accvgpr_read_b32 v255, a254
    v_mfma_f32_16x16x32_bf16 v[232:235], a[224:227], a[96:99], 0
    s_mov_b32 s54, 0x1000
    v_exp_f32 v200, v200
    v_mfma_f32_16x16x32_bf16 v[232:235], a[228:231], a[100:103], v[232:235]
    v_exp_f32 v201, v201
    v_mfma_f32_16x16x32_bf16 v[232:235], a[232:235], a[104:107], v[232:235]
    v_cvt_pk_bf16_f32 v24, v228, v229
    v_cvt_pk_bf16_f32 v27, v230, v231
    v_mfma_f32_16x16x32_bf16 v[232:235], a[236:239], a[108:111], v[232:235]
    s_waitcnt lgkmcnt(1)
    v_exp_f32 v202, v202
    v_mfma_f32_16x16x32_bf16 v[232:235], a[240:243], a[112:115], v[232:235]
    v_exp_f32 v203, v203
    v_mfma_f32_16x16x32_bf16 v[232:235], a[244:247], a[116:119], v[232:235]
    buffer_load_dwordx4 v254, s[4:7], s55 offen lds
    s_add_u32 m0, s46, 0x17c00
    v_accvgpr_read_b32 v254, a252
    v_mfma_f32_16x16x32_bf16 v[236:239], a[224:227], a[120:123], 0
    ds_read_b128 a[224:227], v240 offset:36992
    s_mov_b32 s55, 0x1000
    v_cvt_pk_bf16_f32 v181, v200, v201
    v_mfma_f32_16x16x32_bf16 v[236:239], a[228:231], a[124:127], v[236:239]
    ds_read_b128 a[228:231], v241 offset:36992
    s_waitcnt lgkmcnt(2)
    v_cvt_pk_bf16_f32 v184, v202, v203
    v_mfma_f32_16x16x32_bf16 v[196:199], v[120:123], v[168:171], v[196:199]
    ds_read_b128 v[200:203], v246 offset:256
    v_mfma_f32_16x16x32_bf16 v[236:239], a[232:235], a[128:131], v[236:239]
    ds_read_b128 a[232:235], v240 offset:37120
    v_add_u32 v240, 0xf000, v240
    v_mfma_f32_16x16x32_bf16 v[236:239], a[236:239], a[132:135], v[236:239]
    ds_read_b128 a[236:239], v241 offset:37120
    v_add_u32 v241, 0xf000, v241
    v_mfma_f32_16x16x16_bf16 v[196:199], v[124:125], v[172:173], v[196:199]
    v_exp_f32 v204, v204
    v_mfma_f32_16x16x32_bf16 v[236:239], a[240:243], a[136:139], v[236:239]
    buffer_load_dwordx4 v255, s[4:7], s56 offen lds
    s_add_u32 m0, s46, 0x18000
    v_accvgpr_read_b32 v255, a255
    v_mfma_f32_16x16x32_bf16 v[236:239], a[244:247], a[140:143], v[236:239]
    ds_read_b128 a[240:243], v242 offset:3072
    s_mov_b32 s56, 0x2000
    v_mfma_f32_16x16x32_bf16 v[228:231], a[0:3], a[216:219], 0
    ds_read_b128 a[244:247], v243 offset:3072
    v_mfma_f32_16x16x32_bf16 v[228:231], a[4:7], a[220:223], v[228:231]
    s_waitcnt lgkmcnt(6)
    v_exp_f32 v205, v205
    v_mfma_f32_16x16x32_bf16 v[228:231], a[8:11], a[224:227], v[228:231]
    s_waitcnt lgkmcnt(5)
    v_exp_f32 v206, v206
    v_mfma_f32_16x16x32_bf16 v[228:231], a[12:15], a[228:231], v[228:231]
    s_waitcnt lgkmcnt(4)
    v_exp_f32 v207, v207
    v_mfma_f32_16x16x32_bf16 v[200:203], v[144:147], v[168:171], v[200:203]
    s_waitcnt lgkmcnt(3)
    v_cvt_pk_bf16_f32 v182, v204, v205
    v_cvt_pk_bf16_f32 v185, v206, v207
    v_mfma_f32_16x16x32_bf16 v[228:231], a[16:19], a[232:235], v[228:231]
    ds_read_b128 v[204:207], v244 offset:320
    s_waitcnt lgkmcnt(3)
    v_mfma_f32_16x16x32_bf16 v[212:215], v[0:3], v[180:183], 0
    buffer_load_dwordx4 v254, s[4:7], s57 offen lds
    s_add_u32 m0, s46, 0x18200
    v_mbcnt_lo_u32_b32 v254, -1, 0
    v_mfma_f32_16x16x32_bf16 v[216:219], v[30:33], v[180:183], 0
    s_mov_b32 s57, 0x2000
    v_mbcnt_hi_u32_b32 v254, -1, v254
    v_bfe_u32 v254, v254, 1, 1
    v_mfma_f32_16x16x32_bf16 v[220:223], v[60:63], v[180:183], 0
    v_exp_f32 v208, v208
    v_mfma_f32_16x16x32_bf16 v[224:227], a[248:251], v[180:183], 0
    v_exp_f32 v209, v209
    v_mfma_f32_16x16x16_bf16 v[200:203], v[148:149], v[172:173], v[200:203]
    v_exp_f32 v210, v210
    v_mfma_f32_16x16x32_bf16 v[228:231], a[20:23], a[236:239], v[228:231]
    buffer_load_dwordx4 v255, s[4:7], s58 offen lds
    s_add_u32 m0, s46, 0
    v_lshlrev_b32 v255, 4, v254
    v_xor_b32 v255, v255, v242
    v_mul_u32_u24 v254, 0x7500, v254
    v_add_u32 v254, v254, v255
    v_xor_b32 v255, 64, v254
    s_mov_b32 s58, 0x2000
    v_cvt_pk_bf16_f32 v90, v228, v229
    v_cvt_pk_bf16_f32 v91, v230, v231
    v_mfma_f32_16x16x32_bf16 v[228:231], a[216:219], a[72:75], 0
    s_waitcnt lgkmcnt(0)
    v_exp_f32 v211, v211
    v_mfma_f32_16x16x32_bf16 v[204:207], v[102:105], v[168:171], v[204:207]
    v_cvt_pk_bf16_f32 v186, v208, v209
    v_cvt_pk_bf16_f32 v189, v210, v211
    v_mfma_f32_16x16x32_bf16 v[228:231], a[220:223], a[76:79], v[228:231]
    ds_read_b128 v[208:211], v245 offset:320
    v_mfma_f32_16x16x32_bf16 v[228:231], a[224:227], a[80:83], v[228:231]
    v_exp_f32 v196, v196
    v_mfma_f32_16x16x16_bf16 v[204:207], v[106:107], v[172:173], v[204:207]
    buffer_store_dwordx4 v[54:57], v89, s[24:27], s52 offen
    v_mfma_f32_16x16x32_bf16 v[228:231], a[228:231], a[84:87], v[228:231]
    s_mov_b32 s52, 0x1000
    v_cvt_pk_bf16_f32 v54, v232, v233
    v_cvt_pk_bf16_f32 v57, v234, v235
    v_mfma_f32_16x16x32_bf16 v[232:235], a[24:27], a[216:219], 0
    v_exp_f32 v197, v197
    v_mfma_f32_16x16x32_bf16 v[232:235], a[28:31], a[220:223], v[232:235]
    v_exp_f32 v198, v198
    v_mfma_f32_16x16x32_bf16 v[232:235], a[32:35], a[224:227], v[232:235]
    v_exp_f32 v199, v199
    v_mfma_f32_16x16x32_bf16 v[232:235], a[36:39], a[228:231], v[232:235]
    v_cvt_pk_bf16_f32 v187, v196, v197
    v_cvt_pk_bf16_f32 v190, v198, v199
    v_mfma_f32_16x16x32_bf16 v[232:235], a[40:43], a[232:235], v[232:235]
    ds_read_b128 v[196:199], v246 offset:320
    s_waitcnt lgkmcnt(1)
    v_mfma_f32_16x16x32_bf16 v[212:215], v[4:7], v[184:187], v[212:215]
    buffer_store_dwordx4 v[84:87], v89, s[24:27], s53 offen
    v_mfma_f32_16x16x32_bf16 v[216:219], v[34:37], v[184:187], v[216:219]
    s_mov_b32 s53, 0x1000
    v_cvt_pk_bf16_f32 v84, v236, v237
    v_cvt_pk_bf16_f32 v87, v238, v239
    v_mfma_f32_16x16x32_bf16 v[220:223], v[64:67], v[184:187], v[220:223]
    v_exp_f32 v200, v200
    v_mfma_f32_16x16x32_bf16 v[224:227], a[248:251], v[184:187], v[224:227]
    v_exp_f32 v201, v201
    v_mfma_f32_16x16x32_bf16 v[208:211], v[126:129], v[168:171], v[208:211]
    v_exp_f32 v202, v202
    v_mfma_f32_16x16x32_bf16 v[232:235], a[44:47], a[236:239], v[232:235]
    v_exp_f32 v203, v203
    v_mfma_f32_16x16x32_bf16 v[236:239], a[48:51], a[216:219], 0
    v_cvt_pk_bf16_f32 v188, v200, v201
    v_cvt_pk_bf16_f32 v191, v202, v203
    v_mfma_f32_16x16x16_bf16 v[208:211], v[130:131], v[172:173], v[208:211]
    ds_read_b128 v[200:203], v244 offset:0
    s_waitcnt lgkmcnt(1)
    v_mfma_f32_16x16x32_bf16 v[212:215], v[8:11], v[188:191], v[212:215]
    v_cvt_pk_bf16_f32 v92, v232, v233
    v_cvt_pk_bf16_f32 v93, v234, v235
    v_mfma_f32_16x16x32_bf16 v[216:219], v[38:41], v[188:191], v[216:219]
    v_exp_f32 v204, v204
    v_mfma_f32_16x16x32_bf16 v[220:223], v[68:71], v[188:191], v[220:223]
    v_exp_f32 v205, v205
    v_mfma_f32_16x16x32_bf16 v[224:227], a[248:251], v[188:191], v[224:227]
    v_cvt_pk_bf16_f32 v192, v204, v205
    v_mfma_f32_16x16x32_bf16 v[196:199], v[150:153], v[168:171], v[196:199]
    ds_read_b128 v[204:207], v245 offset:0
    v_mfma_f32_16x16x32_bf16 v[236:239], a[52:55], a[220:223], v[236:239]
    v_exp_f32 v208, v208
    v_mfma_f32_16x16x32_bf16 v[236:239], a[56:59], a[224:227], v[236:239]
    v_exp_f32 v209, v209
    v_mfma_f32_16x16x32_bf16 v[236:239], a[60:63], a[228:231], v[236:239]
    v_cvt_pk_bf16_f32 v193, v208, v209
    s_waitcnt lgkmcnt(1)
    v_mfma_f32_16x16x16_bf16 v[196:199], v[154:155], v[172:173], v[196:199]
    ds_read_b128 v[208:211], v246 offset:0
    v_mfma_f32_16x16x32_bf16 v[200:203], v[96:99], v[174:177], v[200:203]
    v_mfma_f32_16x16x32_bf16 v[236:239], a[64:67], a[232:235], v[236:239]
    v_mfma_f32_16x16x32_bf16 v[236:239], a[68:71], a[236:239], v[236:239]
    v_mfma_f32_16x16x32_bf16 v[228:231], a[232:235], a[88:91], v[228:231]
    v_mfma_f32_16x16x32_bf16 v[228:231], a[236:239], a[92:95], v[228:231]
    s_waitcnt lgkmcnt(1)
    v_mfma_f32_16x16x32_bf16 v[204:207], v[120:123], v[174:177], v[204:207]
    v_exp_f32 v196, v196
    v_mfma_f32_16x16x16_bf16 v[200:203], v[100:101], v[178:179], v[200:203]
    v_exp_f32 v197, v197
    v_mfma_f32_16x16x32_bf16 v[232:235], a[216:219], a[96:99], 0
    v_cvt_pk_bf16_f32 v94, v236, v237
    v_cvt_pk_bf16_f32 v95, v238, v239
    v_mfma_f32_16x16x16_bf16 v[204:207], v[124:125], v[178:179], v[204:207]
    s_waitcnt lgkmcnt(0)
    v_cvt_pk_bf16_f32 v25, v228, v229
    v_cvt_pk_bf16_f32 v28, v230, v231
    v_mfma_f32_16x16x32_bf16 v[208:211], v[144:147], v[174:177], v[208:211]
    v_cvt_pk_bf16_f32 v194, v196, v197
    v_mfma_f32_16x16x32_bf16 v[232:235], a[220:223], a[100:103], v[232:235]
    ds_read_b128 v[196:199], v244 offset:64
    v_mfma_f32_16x16x32_bf16 v[212:215], v[12:15], v[192:195], v[212:215]
    v_exp_f32 v200, v200
    v_mfma_f32_16x16x32_bf16 v[216:219], v[42:45], v[192:195], v[216:219]
    v_exp_f32 v201, v201
    v_mfma_f32_16x16x32_bf16 v[220:223], v[72:75], v[192:195], v[220:223]
    v_exp_f32 v202, v202
    v_mfma_f32_16x16x32_bf16 v[224:227], a[248:251], v[192:195], v[224:227]
    v_exp_f32 v203, v203
    v_mfma_f32_16x16x16_bf16 v[208:211], v[148:149], v[178:179], v[208:211]
    v_cvt_pk_bf16_f32 v180, v200, v201
    v_cvt_pk_bf16_f32 v183, v202, v203
    v_mfma_f32_16x16x32_bf16 v[232:235], a[224:227], a[104:107], v[232:235]
    ds_read_b128 v[200:203], v245 offset:64
    v_mfma_f32_16x16x32_bf16 v[232:235], a[228:231], a[108:111], v[232:235]
    v_exp_f32 v204, v204
    v_mfma_f32_16x16x32_bf16 v[232:235], a[232:235], a[112:115], v[232:235]
    v_rcp_f32 v252, v224
    v_mfma_f32_16x16x32_bf16 v[232:235], a[236:239], a[116:119], v[232:235]
    s_waitcnt lgkmcnt(1)
    v_max3_f32 v248, v248, v224, v252
    v_mul_f32 v212, v212, v252
    v_mfma_f32_16x16x32_bf16 v[196:199], v[102:105], v[174:177], v[196:199]
    v_mul_f32 v213, v213, v252
    v_mul_f32 v214, v214, v252
    v_mfma_f32_16x16x32_bf16 v[236:239], a[216:219], a[120:123], 0
    ds_read_b128 a[216:219], v242 offset:3200
    v_mul_f32 v215, v215, v252
    v_mfma_f32_16x16x32_bf16 v[236:239], a[220:223], a[124:127], v[236:239]
    ds_read_b128 a[220:223], v243 offset:3200
    v_cvt_pk_bf16_f32 v212, v212, v213
    v_mfma_f32_16x16x16_bf16 v[196:199], v[106:107], v[178:179], v[196:199]
    v_cvt_pk_bf16_f32 v213, v214, v215
    v_mul_f32 v216, v216, v252
    v_mfma_f32_16x16x32_bf16 v[236:239], a[224:227], a[128:131], v[236:239]
    ds_write_b64 v251, v[212:213] offset:0
    v_mfma_f32_16x16x32_bf16 v[236:239], a[228:231], a[132:135], v[236:239]
    ds_read_b128 a[224:227], v242 offset:3328
    s_waitcnt lgkmcnt(4)
    v_mul_f32 v217, v217, v252
    v_mfma_f32_16x16x32_bf16 v[200:203], v[126:129], v[174:177], v[200:203]
    ds_read_b128 a[228:231], v243 offset:3328
    v_mul_f32 v218, v218, v252
    v_mfma_f32_16x16x32_bf16 v[236:239], a[232:235], a[136:139], v[236:239]
    ds_read_b128 a[232:235], v240 offset:6144
    v_mul_f32 v219, v219, v252
    v_mfma_f32_16x16x32_bf16 v[236:239], a[236:239], a[140:143], v[236:239]
    ds_read_b128 a[236:239], v241 offset:6144
    v_cvt_pk_bf16_f32 v216, v216, v217
    v_mfma_f32_16x16x16_bf16 v[200:203], v[130:131], v[178:179], v[200:203]
    v_cvt_pk_bf16_f32 v217, v218, v219
    v_mul_f32 v220, v220, v252
    v_mfma_f32_16x16x32_bf16 v[228:231], a[144:147], a[240:243], 0
    ds_write_b64 v251, v[216:217] offset:32
    v_mfma_f32_16x16x32_bf16 v[228:231], a[148:151], a[244:247], v[228:231]
    s_waitcnt lgkmcnt(6)
    v_mul_f32 v221, v221, v252
    v_mul_f32 v222, v222, v252
    v_mfma_f32_16x16x32_bf16 v[228:231], a[152:155], a[216:219], v[228:231]
    v_mul_f32 v223, v223, v252
    v_cvt_pk_bf16_f32 v220, v220, v221
    v_mfma_f32_16x16x32_bf16 v[228:231], a[156:159], a[220:223], v[228:231]
    s_waitcnt lgkmcnt(4)
    v_cvt_pk_bf16_f32 v221, v222, v223
    v_cvt_pk_bf16_f32 v55, v232, v233
    v_mfma_f32_16x16x32_bf16 v[228:231], a[160:163], a[224:227], v[228:231]
    s_waitcnt lgkmcnt(3)
    v_cvt_pk_bf16_f32 v58, v234, v235
    v_cvt_pk_bf16_f32 v85, v236, v237
    v_mfma_f32_16x16x32_bf16 v[228:231], a[164:167], a[228:231], v[228:231]
    ds_write_b64 v251, v[220:221] offset:64
    v_mfma_f32_16x16x32_bf16 v[232:235], a[168:171], a[240:243], 0
    v_cvt_pk_bf16_f32 v88, v238, v239
    v_mfma_f32_16x16x32_bf16 v[232:235], a[172:175], a[244:247], v[232:235]
    v_exp_f32 v205, v205
    v_mfma_f32_16x16x32_bf16 v[232:235], a[176:179], a[216:219], v[232:235]
    v_exp_f32 v206, v206
    v_mfma_f32_16x16x32_bf16 v[232:235], a[180:183], a[220:223], v[232:235]
    v_mul_f32 v228, s38, v228
    v_mul_f32 v229, s38, v229
    v_mfma_f32_16x16x32_bf16 v[232:235], a[184:187], a[224:227], v[232:235]
    v_mul_f32 v230, s38, v230
    v_mul_f32 v231, s38, v231
    v_mfma_f32_16x16x32_bf16 v[232:235], a[188:191], a[228:231], v[232:235]
    v_cvt_pk_bf16_f32 v168, v228, v229
    v_cvt_pk_bf16_f32 v169, v230, v231
    v_mfma_f32_16x16x32_bf16 v[236:239], a[192:195], a[240:243], 0
    ds_read_b128 a[240:243], v240 offset:6272
    s_waitcnt lgkmcnt(2)
    v_cvt_pk_bf16_f32 v181, v204, v205
    v_mfma_f32_16x16x32_bf16 v[236:239], a[196:199], a[244:247], v[236:239]
    ds_read_b128 a[244:247], v241 offset:6272
    v_mul_f32 v232, s38, v232
    v_mfma_f32_16x16x32_bf16 v[236:239], a[200:203], a[216:219], v[236:239]
    ds_read_b128 a[216:219], v240 offset:6400
    v_mul_f32 v233, s38, v233
    v_mfma_f32_16x16x32_bf16 v[236:239], a[204:207], a[220:223], v[236:239]
    ds_read_b128 a[220:223], v241 offset:6400
    v_mul_f32 v234, s38, v234
    v_mfma_f32_16x16x32_bf16 v[236:239], a[208:211], a[224:227], v[236:239]
    ds_read_b128 a[224:227], v254 offset:4608
    v_mul_f32 v235, s38, v235
    v_mfma_f32_16x16x32_bf16 v[236:239], a[212:215], a[228:231], v[236:239]
    ds_read_b128 a[228:231], v255 offset:4608
    v_cvt_pk_bf16_f32 v170, v232, v233
    v_mfma_f32_16x16x32_bf16 v[228:231], a[0:3], a[232:235], 0
    v_cvt_pk_bf16_f32 v171, v234, v235
    v_mfma_f32_16x16x32_bf16 v[228:231], a[4:7], a[236:239], v[228:231]
    v_exp_f32 v207, v207
    v_mfma_f32_16x16x32_bf16 v[232:235], a[24:27], a[232:235], 0
    v_cvt_pk_bf16_f32 v184, v206, v207
    v_mul_f32 v236, s38, v236
    v_mfma_f32_16x16x32_bf16 v[232:235], a[28:31], a[236:239], v[232:235]
    s_waitcnt lgkmcnt(5)
    v_mul_f32 v237, s38, v237
    v_mul_f32 v238, s38, v238
    v_mfma_f32_16x16x32_bf16 v[228:231], a[8:11], a[240:243], v[228:231]
    ds_read_b128 v[204:207], v246 offset:64
    s_waitcnt lgkmcnt(4)
    v_mul_f32 v239, s38, v239
    v_mfma_f32_16x16x32_bf16 v[228:231], a[12:15], a[244:247], v[228:231]
    v_cvt_pk_bf16_f32 v172, v236, v237
    v_cvt_pk_bf16_f32 v173, v238, v239
    v_mfma_f32_16x16x32_bf16 v[228:231], a[16:19], a[216:219], v[228:231]
    s_waitcnt lgkmcnt(3)
    v_exp_f32 v208, v208
    v_mfma_f32_16x16x32_bf16 v[228:231], a[20:23], a[220:223], v[228:231]
    v_exp_f32 v209, v209
    v_mfma_f32_16x16x32_bf16 v[232:235], a[32:35], a[240:243], v[232:235]
    v_exp_f32 v210, v210
    v_mfma_f32_16x16x32_bf16 v[232:235], a[36:39], a[244:247], v[232:235]
    v_exp_f32 v211, v211
    v_mfma_f32_16x16x32_bf16 v[232:235], a[40:43], a[216:219], v[232:235]
    v_cvt_pk_bf16_f32 v182, v208, v209
    v_cvt_pk_bf16_f32 v185, v210, v211
    v_mfma_f32_16x16x32_bf16 v[232:235], a[44:47], a[220:223], v[232:235]
    ds_read_b128 v[208:211], v244 offset:128
    v_cvt_pk_bf16_f32 v96, v228, v229
    v_mfma_f32_16x16x32_bf16 v[212:215], v[6:9], v[180:183], 0
    v_cvt_pk_bf16_f32 v97, v230, v231
    s_waitcnt lgkmcnt(1)
    v_mfma_f32_16x16x32_bf16 v[216:219], v[36:39], v[180:183], 0
    v_exp_f32 v196, v196
    v_mfma_f32_16x16x32_bf16 v[220:223], v[66:69], v[180:183], 0
    v_cvt_pk_bf16_f32 v98, v232, v233
    v_cvt_pk_bf16_f32 v99, v234, v235
    v_mfma_f32_16x16x32_bf16 v[224:227], a[248:251], v[180:183], 0
    v_exp_f32 v197, v197
    v_mfma_f32_16x16x32_bf16 v[204:207], v[150:153], v[174:177], v[204:207]
    v_exp_f32 v198, v198
    v_mfma_f32_16x16x32_bf16 v[236:239], a[48:51], a[232:235], 0
    v_exp_f32 v199, v199
    v_mfma_f32_16x16x32_bf16 v[236:239], a[52:55], a[236:239], v[236:239]
    v_cvt_pk_bf16_f32 v186, v196, v197
    v_cvt_pk_bf16_f32 v189, v198, v199
    v_mfma_f32_16x16x16_bf16 v[204:207], v[154:155], v[178:179], v[204:207]
    ds_read_b128 v[196:199], v245 offset:128
    s_waitcnt lgkmcnt(1)
    v_mfma_f32_16x16x32_bf16 v[208:211], v[108:111], v[174:177], v[208:211]
    v_exp_f32 v200, v200
    v_mfma_f32_16x16x32_bf16 v[236:239], a[56:59], a[240:243], v[236:239]
    v_exp_f32 v201, v201
    v_mfma_f32_16x16x32_bf16 v[236:239], a[60:63], a[244:247], v[236:239]
    v_exp_f32 v202, v202
    v_mfma_f32_16x16x32_bf16 v[236:239], a[64:67], a[216:219], v[236:239]
    v_exp_f32 v203, v203
    v_mfma_f32_16x16x16_bf16 v[208:211], v[112:113], v[178:179], v[208:211]
    v_cvt_pk_bf16_f32 v187, v200, v201
    v_cvt_pk_bf16_f32 v190, v202, v203
    v_mfma_f32_16x16x32_bf16 v[236:239], a[68:71], a[220:223], v[236:239]
    ds_read_b128 v[200:203], v246 offset:128
    v_mfma_f32_16x16x32_bf16 v[212:215], v[10:13], v[184:187], v[212:215]
    v_exp_f32 v204, v204
    v_mfma_f32_16x16x32_bf16 v[216:219], v[40:43], v[184:187], v[216:219]
    v_exp_f32 v205, v205
    v_mfma_f32_16x16x32_bf16 v[220:223], v[70:73], v[184:187], v[220:223]
    s_waitcnt lgkmcnt(1)
    v_exp_f32 v206, v206
    v_mfma_f32_16x16x32_bf16 v[224:227], a[248:251], v[184:187], v[224:227]
    v_cvt_pk_bf16_f32 v100, v236, v237
    v_cvt_pk_bf16_f32 v101, v238, v239
    v_mfma_f32_16x16x32_bf16 v[196:199], v[132:135], v[174:177], v[196:199]
    v_exp_f32 v207, v207
    v_mfma_f32_16x16x32_bf16 v[228:231], a[232:235], a[72:75], 0
    v_cvt_pk_bf16_f32 v188, v204, v205
    v_cvt_pk_bf16_f32 v191, v206, v207
    v_mfma_f32_16x16x32_bf16 v[228:231], a[236:239], a[76:79], v[228:231]
    v_exp_f32 v208, v208
    v_mfma_f32_16x16x32_bf16 v[212:215], v[14:17], v[188:191], v[212:215]
    v_exp_f32 v209, v209
    v_mfma_f32_16x16x32_bf16 v[216:219], v[44:47], v[188:191], v[216:219]
    s_waitcnt lgkmcnt(0)
    v_cvt_pk_bf16_f32 v192, v208, v209
    v_mfma_f32_16x16x32_bf16 v[220:223], v[74:77], v[188:191], v[220:223]
    v_mfma_f32_16x16x32_bf16 v[224:227], a[248:251], v[188:191], v[224:227]
    v_mfma_f32_16x16x16_bf16 v[196:199], v[136:137], v[178:179], v[196:199]
    v_mfma_f32_16x16x32_bf16 v[200:203], v[156:159], v[174:177], v[200:203]
    v_mfma_f32_16x16x32_bf16 v[228:231], a[240:243], a[80:83], v[228:231]
    v_mfma_f32_16x16x32_bf16 v[228:231], a[244:247], a[84:87], v[228:231]
    v_mfma_f32_16x16x32_bf16 v[228:231], a[216:219], a[88:91], v[228:231]
    v_mfma_f32_16x16x32_bf16 v[228:231], a[220:223], a[92:95], v[228:231]
    v_mfma_f32_16x16x32_bf16 v[232:235], a[232:235], a[96:99], 0
    v_mfma_f32_16x16x32_bf16 v[232:235], a[236:239], a[100:103], v[232:235]
    v_mfma_f32_16x16x16_bf16 v[200:203], v[160:161], v[178:179], v[200:203]
    v_exp_f32 v196, v196
    v_mfma_f32_16x16x32_bf16 v[232:235], a[240:243], a[104:107], v[232:235]
    v_exp_f32 v197, v197
    v_mfma_f32_16x16x32_bf16 v[232:235], a[244:247], a[108:111], v[232:235]
    v_cvt_pk_bf16_f32 v193, v196, v197
    v_cvt_pk_bf16_f32 v26, v228, v229
    v_mfma_f32_16x16x32_bf16 v[232:235], a[216:219], a[112:115], v[232:235]
    v_cvt_pk_bf16_f32 v29, v230, v231
    v_mfma_f32_16x16x32_bf16 v[232:235], a[220:223], a[116:119], v[232:235]
    v_exp_f32 v200, v200
    v_mfma_f32_16x16x32_bf16 v[236:239], a[232:235], a[120:123], 0
    ds_read_b128 a[232:235], v254 offset:4736
    v_mfma_f32_16x16x32_bf16 v[236:239], a[236:239], a[124:127], v[236:239]
    ds_read_b128 a[236:239], v255 offset:4736
    v_mfma_f32_16x16x32_bf16 v[236:239], a[240:243], a[128:131], v[236:239]
    ds_read_b128 a[240:243], v254 offset:4864
    v_accvgpr_read_b32 v254, a252
    v_mfma_f32_16x16x32_bf16 v[236:239], a[244:247], a[132:135], v[236:239]
    ds_read_b128 a[244:247], v255 offset:4864
    v_cvt_pk_bf16_f32 v56, v232, v233
    v_mfma_f32_16x16x32_bf16 v[236:239], a[216:219], a[136:139], v[236:239]
    v_cvt_pk_bf16_f32 v59, v234, v235
    v_accvgpr_read_b32 v255, a253
    v_mfma_f32_16x16x32_bf16 v[236:239], a[220:223], a[140:143], v[236:239]
    v_exp_f32 v201, v201
    v_mfma_f32_16x16x32_bf16 v[228:231], a[144:147], a[224:227], 0
    v_cvt_pk_bf16_f32 v194, v200, v201
    v_mfma_f32_16x16x32_bf16 v[228:231], a[148:151], a[228:231], v[228:231]
    v_mfma_f32_16x16x32_bf16 v[232:235], a[168:171], a[224:227], 0
    v_mfma_f32_16x16x32_bf16 v[212:215], v[18:21], v[192:195], v[212:215]
    s_waitcnt lgkmcnt(3)
    v_mfma_f32_16x16x32_bf16 v[216:219], v[48:51], v[192:195], v[216:219]
    v_cvt_pk_bf16_f32 v86, v236, v237
    v_cvt_pk_bf16_f32 v89, v238, v239
    v_mfma_f32_16x16x32_bf16 v[220:223], v[78:81], v[192:195], v[220:223]
    v_mfma_f32_16x16x32_bf16 v[224:227], a[248:251], v[192:195], v[224:227]
    s_waitcnt vmcnt(0) lgkmcnt(0)
    s_barrier
    v_mfma_f32_16x16x32_bf16 v[228:231], a[152:155], a[232:235], v[228:231]
    buffer_load_dwordx4 v254, s[4:7], s44 offen lds
    s_add_u32 m0, s46, 0x400
    v_accvgpr_read_b32 v254, a254
    v_mfma_f32_16x16x32_bf16 v[228:231], a[156:159], a[236:239], v[228:231]
    buffer_load_dwordx4 v255, s[4:7], s44 offen lds
    s_add_u32 m0, s46, 0x800
    v_accvgpr_read_b32 v255, a252
    v_mfma_f32_16x16x32_bf16 v[228:231], a[160:163], a[240:243], v[228:231]
    buffer_load_dwordx4 v254, s[4:7], s44 offen lds
    s_add_u32 m0, s46, 0xc00
    v_accvgpr_read_b32 v254, a253
    v_mfma_f32_16x16x32_bf16 v[228:231], a[164:167], a[244:247], v[228:231]
    buffer_load_dwordx4 v255, s[4:7], s59 offen lds
    s_add_u32 m0, s46, 0x1000
    v_accvgpr_read_b32 v255, a254
    v_mfma_f32_16x16x32_bf16 v[232:235], a[172:175], a[228:231], v[232:235]
    buffer_load_dwordx4 v254, s[4:7], s60 offen lds
    s_add_u32 m0, s46, 0x1400
    v_accvgpr_read_b32 v254, a252
    v_mfma_f32_16x16x32_bf16 v[232:235], a[176:179], a[232:235], v[232:235]
    buffer_load_dwordx4 v255, s[4:7], s61 offen lds
    s_add_u32 m0, s46, 0x1800
    v_mul_f32 v228, s38, v228
    v_mfma_f32_16x16x32_bf16 v[232:235], a[180:183], a[236:239], v[232:235]
    buffer_load_dwordx4 v254, s[4:7], s62 offen lds
    s_add_u32 m0, s46, 0x1a00
    v_mul_f32 v229, s38, v229
    v_mfma_f32_16x16x32_bf16 v[232:235], a[184:187], a[240:243], v[232:235]
    ds_read_b128 v[204:207], v244 offset:0
    s_mov_b32 s59, 0x2000
    v_mul_f32 v230, s38, v230
    v_mfma_f32_16x16x32_bf16 v[232:235], a[188:191], a[244:247], v[232:235]
    ds_read_b128 v[208:211], v245 offset:0
    s_mov_b32 s60, 0x3000
    v_mul_f32 v231, s38, v231
    v_mfma_f32_16x16x32_bf16 v[236:239], a[192:195], a[224:227], 0
    ds_read_b128 v[196:199], v246 offset:0
    s_mov_b32 s61, 0x3000
    v_cvt_pk_bf16_f32 v174, v228, v229
    v_mfma_f32_16x16x32_bf16 v[236:239], a[196:199], a[228:231], v[236:239]
    ds_read_b128 v[200:203], v244 offset:64
    s_mov_b32 s62, 0x3000
    v_cvt_pk_bf16_f32 v175, v230, v231
    v_mfma_f32_16x16x32_bf16 v[236:239], a[200:203], a[232:235], v[236:239]
    ds_write_b64 v247, v[174:175] offset:0
    v_mfma_f32_16x16x32_bf16 v[236:239], a[204:207], a[236:239], v[236:239]
    ds_read_b128 a[216:219], v240 offset:30720
    v_mul_f32 v232, s38, v232
    v_mfma_f32_16x16x32_bf16 v[236:239], a[208:211], a[240:243], v[236:239]
    ds_read_b128 a[220:223], v241 offset:30720
    v_mul_f32 v233, s38, v233
    v_mfma_f32_16x16x32_bf16 v[236:239], a[212:215], a[244:247], v[236:239]
    ds_read_b128 a[224:227], v240 offset:30848
    ds_read_b128 a[228:231], v241 offset:30848
    ds_read_b128 a[232:235], v240 offset:30976
    s_waitcnt lgkmcnt(9)
    v_mfma_f32_16x16x32_bf16 v[204:207], v[102:105], v[168:171], v[204:207]
    ds_read_b128 a[236:239], v241 offset:30976
    v_mul_f32 v234, s38, v234
    s_waitcnt lgkmcnt(9)
    v_mfma_f32_16x16x32_bf16 v[208:211], v[126:129], v[168:171], v[208:211]
    ds_read_b128 a[240:243], v242 offset:30720
    s_waitcnt lgkmcnt(9)
    v_mul_f32 v235, s38, v235
    v_mfma_f32_16x16x16_bf16 v[204:207], v[106:107], v[172:173], v[204:207]
    ds_read_b128 a[244:247], v243 offset:30720
    s_waitcnt lgkmcnt(9)
    v_cvt_pk_bf16_f32 v176, v232, v233
    v_mfma_f32_16x16x16_bf16 v[208:211], v[130:131], v[172:173], v[208:211]
    v_rcp_f32 v252, v224
    v_mfma_f32_16x16x32_bf16 v[196:199], v[150:153], v[168:171], v[196:199]
    v_max3_f32 v248, v248, v224, v252
    v_mul_f32 v212, v212, v252
    v_mfma_f32_16x16x32_bf16 v[200:203], v[108:111], v[168:171], v[200:203]
    s_waitcnt lgkmcnt(7)
    v_mul_f32 v213, v213, v252
    v_mul_f32 v214, v214, v252
    v_mfma_f32_16x16x16_bf16 v[196:199], v[154:155], v[172:173], v[196:199]
    v_mul_f32 v215, v215, v252
    v_cvt_pk_bf16_f32 v212, v212, v213
    v_mfma_f32_16x16x16_bf16 v[200:203], v[112:113], v[172:173], v[200:203]
    v_cvt_pk_bf16_f32 v213, v214, v215
    v_mul_f32 v216, v216, v252
    v_mfma_f32_16x16x32_bf16 v[228:231], a[0:3], a[216:219], 0
    s_waitcnt lgkmcnt(2)
    v_mul_f32 v217, v217, v252
    v_mul_f32 v218, v218, v252
    v_mfma_f32_16x16x32_bf16 v[228:231], a[4:7], a[220:223], v[228:231]
    ds_write_b64 v251, v[212:213] offset:6656
    v_mfma_f32_16x16x32_bf16 v[228:231], a[8:11], a[224:227], v[228:231]
    v_mul_f32 v219, v219, v252
    v_cvt_pk_bf16_f32 v216, v216, v217
    v_mfma_f32_16x16x32_bf16 v[228:231], a[12:15], a[228:231], v[228:231]
    v_cvt_pk_bf16_f32 v217, v218, v219
    v_mul_f32 v220, v220, v252
    v_mfma_f32_16x16x32_bf16 v[228:231], a[16:19], a[232:235], v[228:231]
    ds_write_b64 v251, v[216:217] offset:6688
    v_mfma_f32_16x16x32_bf16 v[228:231], a[20:23], a[236:239], v[228:231]
    v_mul_f32 v221, v221, v252
    v_mul_f32 v222, v222, v252
    v_mul_f32 v223, v223, v252
    v_cvt_pk_bf16_f32 v220, v220, v221
    v_cvt_pk_bf16_f32 v221, v222, v223
    ds_write_b64 v251, v[220:221] offset:6720
    v_cvt_pk_bf16_f32 v177, v234, v235
    v_mfma_f32_16x16x32_bf16 v[232:235], a[24:27], a[216:219], 0
    ds_write_b64 v247, v[176:177] offset:32
    v_mfma_f32_16x16x32_bf16 v[232:235], a[28:31], a[220:223], v[232:235]
    v_mul_f32 v236, s38, v236
    v_mul_f32 v237, s38, v237
    v_mfma_f32_16x16x32_bf16 v[232:235], a[32:35], a[224:227], v[232:235]
    v_mul_f32 v238, s38, v238
    v_mul_f32 v239, s38, v239
    v_mfma_f32_16x16x32_bf16 v[232:235], a[36:39], a[228:231], v[232:235]
    v_cvt_pk_bf16_f32 v178, v236, v237
    v_cvt_pk_bf16_f32 v179, v238, v239
    v_mfma_f32_16x16x32_bf16 v[232:235], a[40:43], a[232:235], v[232:235]
    ds_write_b64 v247, v[178:179] offset:64
    v_mfma_f32_16x16x32_bf16 v[232:235], a[44:47], a[236:239], v[232:235]
    v_accvgpr_read_b32 v255, a255
    v_cvt_pk_bf16_f32 v102, v228, v229
    v_mfma_f32_16x16x32_bf16 v[236:239], a[48:51], a[216:219], 0
    buffer_load_dwordx4 v255, s[4:7], s63 offen lds
    s_mov_b32 s63, 0x3000
    v_cvt_pk_bf16_f32 v103, v230, v231
    v_mfma_f32_16x16x32_bf16 v[236:239], a[52:55], a[220:223], v[236:239]
    v_mbcnt_lo_u32_b32 v254, -1, 0
    v_cvt_pk_bf16_f32 v104, v232, v233
    v_mfma_f32_16x16x32_bf16 v[236:239], a[56:59], a[224:227], v[236:239]
    v_cvt_pk_bf16_f32 v105, v234, v235
    v_mbcnt_hi_u32_b32 v254, -1, v254
    v_mfma_f32_16x16x32_bf16 v[236:239], a[60:63], a[228:231], v[236:239]
    v_lshl_add_u32 v254, v254, 4, s66
    v_mbcnt_lo_u32_b32 v255, -1, 0
    v_mfma_f32_16x16x32_bf16 v[236:239], a[64:67], a[232:235], v[236:239]
    v_mbcnt_hi_u32_b32 v255, -1, v255
    v_and_b32 v249, 15, v255
    v_mfma_f32_16x16x32_bf16 v[236:239], a[68:71], a[236:239], v[236:239]
    v_mul_u32_u24 v249, 0x1a0, v249
    v_lshrrev_b32 v255, 4, v255
    v_mfma_f32_16x16x32_bf16 v[228:231], a[216:219], a[72:75], 0
    v_lshl_add_u32 v249, v255, 4, v249
    v_add_u32 v249, 0x1e000, v249
    v_mfma_f32_16x16x32_bf16 v[228:231], a[220:223], a[76:79], v[228:231]
    v_exp_f32 v204, v204
    v_mfma_f32_16x16x32_bf16 v[228:231], a[224:227], a[80:83], v[228:231]
    v_cvt_pk_bf16_f32 v106, v236, v237
    v_cvt_pk_bf16_f32 v107, v238, v239
    v_mfma_f32_16x16x32_bf16 v[228:231], a[228:231], a[84:87], v[228:231]
    v_exp_f32 v205, v205
    v_mfma_f32_16x16x32_bf16 v[228:231], a[232:235], a[88:91], v[228:231]
    v_exp_f32 v206, v206
    v_mfma_f32_16x16x32_bf16 v[228:231], a[236:239], a[92:95], v[228:231]
    v_exp_f32 v207, v207
    v_mfma_f32_16x16x32_bf16 v[232:235], a[216:219], a[96:99], 0
    v_cvt_pk_bf16_f32 v180, v204, v205
    v_cvt_pk_bf16_f32 v183, v206, v207
    v_mfma_f32_16x16x32_bf16 v[232:235], a[220:223], a[100:103], v[232:235]
    ds_read_b128 v[204:207], v245 offset:64
    v_mfma_f32_16x16x32_bf16 v[232:235], a[224:227], a[104:107], v[232:235]
    v_exp_f32 v208, v208
    v_mfma_f32_16x16x32_bf16 v[232:235], a[228:231], a[108:111], v[232:235]
    v_cvt_pk_bf16_f32 v0, v228, v229
    v_cvt_pk_bf16_f32 v3, v230, v231
    v_mfma_f32_16x16x32_bf16 v[232:235], a[232:235], a[112:115], v[232:235]
    s_waitcnt lgkmcnt(1)
    v_exp_f32 v209, v209
    v_mfma_f32_16x16x32_bf16 v[232:235], a[236:239], a[116:119], v[232:235]
    v_exp_f32 v210, v210
    v_mfma_f32_16x16x32_bf16 v[236:239], a[216:219], a[120:123], 0
    ds_read_b128 a[216:219], v242 offset:30848
    v_cvt_pk_bf16_f32 v181, v208, v209
    v_mfma_f32_16x16x32_bf16 v[236:239], a[220:223], a[124:127], v[236:239]
    ds_read_b128 a[220:223], v243 offset:30848
    v_mfma_f32_16x16x32_bf16 v[236:239], a[224:227], a[128:131], v[236:239]
    ds_read_b128 a[224:227], v242 offset:30976
    v_cvt_pk_bf16_f32 v30, v232, v233
    v_mfma_f32_16x16x32_bf16 v[236:239], a[228:231], a[132:135], v[236:239]
    ds_read_b128 a[228:231], v243 offset:30976
    s_waitcnt lgkmcnt(4)
    v_cvt_pk_bf16_f32 v33, v234, v235
    v_mfma_f32_16x16x32_bf16 v[204:207], v[132:135], v[168:171], v[204:207]
    v_exp_f32 v211, v211
    v_mfma_f32_16x16x32_bf16 v[236:239], a[232:235], a[136:139], v[236:239]
    ds_read_b128 a[232:235], v242 offset:32256
    v_cvt_pk_bf16_f32 v184, v210, v211
    v_mfma_f32_16x16x32_bf16 v[236:239], a[236:239], a[140:143], v[236:239]
    ds_read_b128 v[208:211], v246 offset:64
    v_mfma_f32_16x16x16_bf16 v[204:207], v[136:137], v[172:173], v[204:207]
    ds_read_b128 a[236:239], v243 offset:32256
    v_mfma_f32_16x16x32_bf16 v[228:231], a[144:147], a[240:243], 0
    v_exp_f32 v196, v196
    v_mfma_f32_16x16x32_bf16 v[228:231], a[148:151], a[244:247], v[228:231]
    s_waitcnt lgkmcnt(6)
    v_exp_f32 v197, v197
    v_mfma_f32_16x16x32_bf16 v[228:231], a[152:155], a[216:219], v[228:231]
    s_waitcnt lgkmcnt(5)
    v_cvt_pk_bf16_f32 v60, v236, v237
    v_cvt_pk_bf16_f32 v63, v238, v239
    v_mfma_f32_16x16x32_bf16 v[228:231], a[156:159], a[220:223], v[228:231]
    s_waitcnt lgkmcnt(4)
    v_exp_f32 v198, v198
    v_mfma_f32_16x16x32_bf16 v[228:231], a[160:163], a[224:227], v[228:231]
    s_waitcnt lgkmcnt(3)
    v_exp_f32 v199, v199
    v_mfma_f32_16x16x32_bf16 v[228:231], a[164:167], a[228:231], v[228:231]
    v_cvt_pk_bf16_f32 v182, v196, v197
    v_cvt_pk_bf16_f32 v185, v198, v199
    v_mfma_f32_16x16x32_bf16 v[232:235], a[168:171], a[240:243], 0
    ds_read_b128 v[196:199], v244 offset:128
    s_waitcnt lgkmcnt(2)
    v_mfma_f32_16x16x32_bf16 v[212:215], v[12:15], v[180:183], 0
    v_exp_f32 v200, v200
    v_mfma_f32_16x16x32_bf16 v[216:219], v[42:45], v[180:183], 0
    v_mul_f32 v228, s38, v228
    v_mul_f32 v229, s38, v229
    v_mfma_f32_16x16x32_bf16 v[220:223], v[72:75], v[180:183], 0
    v_mul_f32 v230, s38, v230
    v_mul_f32 v231, s38, v231
    v_mfma_f32_16x16x32_bf16 v[224:227], a[248:251], v[180:183], 0
    v_exp_f32 v201, v201
    v_mfma_f32_16x16x32_bf16 v[208:211], v[156:159], v[168:171], v[208:211]
    v_exp_f32 v202, v202
    v_mfma_f32_16x16x32_bf16 v[232:235], a[172:175], a[244:247], v[232:235]
    v_exp_f32 v203, v203
    v_mfma_f32_16x16x32_bf16 v[232:235], a[176:179], a[216:219], v[232:235]
    v_cvt_pk_bf16_f32 v186, v200, v201
    v_cvt_pk_bf16_f32 v189, v202, v203
    v_mfma_f32_16x16x16_bf16 v[208:211], v[160:161], v[172:173], v[208:211]
    ds_read_b128 v[200:203], v245 offset:128
    s_waitcnt lgkmcnt(1)
    v_mfma_f32_16x16x32_bf16 v[196:199], v[162:165], v[168:171], v[196:199]
    v_exp_f32 v204, v204
    v_mfma_f32_16x16x32_bf16 v[232:235], a[180:183], a[220:223], v[232:235]
    v_exp_f32 v205, v205
    v_mfma_f32_16x16x32_bf16 v[232:235], a[184:187], a[224:227], v[232:235]
    v_exp_f32 v206, v206
    v_mfma_f32_16x16x32_bf16 v[232:235], a[188:191], a[228:231], v[232:235]
    v_exp_f32 v207, v207
    v_mfma_f32_16x16x16_bf16 v[196:199], v[166:167], v[172:173], v[196:199]
    v_cvt_pk_bf16_f32 v187, v204, v205
    v_cvt_pk_bf16_f32 v190, v206, v207
    v_mfma_f32_16x16x32_bf16 v[236:239], a[192:195], a[240:243], 0
    ds_read_b128 v[204:207], v246 offset:128
    v_mfma_f32_16x16x32_bf16 v[212:215], v[16:19], v[184:187], v[212:215]
    ds_read_b128 a[240:243], v242 offset:32384
    v_mul_f32 v232, s38, v232
    v_mfma_f32_16x16x32_bf16 v[216:219], v[46:49], v[184:187], v[216:219]
    v_mul_f32 v233, s38, v233
    v_mul_f32 v234, s38, v234
    v_mfma_f32_16x16x32_bf16 v[220:223], v[76:79], v[184:187], v[220:223]
    s_waitcnt lgkmcnt(2)
    v_mul_f32 v235, s38, v235
    v_mfma_f32_16x16x32_bf16 v[224:227], a[248:251], v[184:187], v[224:227]
    v_exp_f32 v208, v208
    v_mfma_f32_16x16x32_bf16 v[200:203], v[90:93], v[168:171], v[200:203]
    v_exp_f32 v209, v209
    v_mfma_f32_16x16x32_bf16 v[236:239], a[196:199], a[244:247], v[236:239]
    ds_read_b128 a[244:247], v243 offset:32384
    v_cvt_pk_bf16_f32 v188, v208, v209
    v_mfma_f32_16x16x32_bf16 v[236:239], a[200:203], a[216:219], v[236:239]
    ds_read_b128 a[216:219], v242 offset:32512
    v_mfma_f32_16x16x16_bf16 v[200:203], v[94:95], v[172:173], v[200:203]
    v_exp_f32 v210, v210
    v_mfma_f32_16x16x32_bf16 v[236:239], a[204:207], a[220:223], v[236:239]
    ds_read_b128 a[220:223], v243 offset:32512
    s_waitcnt lgkmcnt(3)
    v_mfma_f32_16x16x32_bf16 v[204:207], v[96:99], v[168:171], v[204:207]
    v_cvt_pk_bf16_f32 v168, v228, v229
    v_cvt_pk_bf16_f32 v169, v230, v231
    v_mfma_f32_16x16x32_bf16 v[236:239], a[208:211], a[224:227], v[236:239]
    ds_read_b128 a[224:227], v242 offset:33792
    v_cvt_pk_bf16_f32 v170, v232, v233
    v_mfma_f32_16x16x32_bf16 v[236:239], a[212:215], a[228:231], v[236:239]
    ds_read_b128 a[228:231], v243 offset:33792
    v_cvt_pk_bf16_f32 v171, v234, v235
    v_mfma_f32_16x16x16_bf16 v[204:207], v[100:101], v[172:173], v[204:207]
    v_exp_f32 v211, v211
    v_mfma_f32_16x16x32_bf16 v[228:231], a[144:147], a[232:235], 0
    v_cvt_pk_bf16_f32 v191, v210, v211
    v_mfma_f32_16x16x32_bf16 v[228:231], a[148:151], a[236:239], v[228:231]
    v_exp_f32 v196, v196
    v_mfma_f32_16x16x32_bf16 v[212:215], v[20:23], v[188:191], v[212:215]
    v_mul_f32 v236, s38, v236
    v_mul_f32 v237, s38, v237
    v_mfma_f32_16x16x32_bf16 v[216:219], v[50:53], v[188:191], v[216:219]
    v_mul_f32 v238, s38, v238
    v_mul_f32 v239, s38, v239
    v_mfma_f32_16x16x32_bf16 v[220:223], v[80:83], v[188:191], v[220:223]
    v_cvt_pk_bf16_f32 v172, v236, v237
    v_cvt_pk_bf16_f32 v173, v238, v239
    v_mfma_f32_16x16x32_bf16 v[224:227], a[248:251], v[188:191], v[224:227]
    v_exp_f32 v197, v197
    v_mfma_f32_16x16x32_bf16 v[228:231], a[152:155], a[240:243], v[228:231]
    s_waitcnt lgkmcnt(1)
    v_cvt_pk_bf16_f32 v192, v196, v197
    v_mfma_f32_16x16x32_bf16 v[228:231], a[156:159], a[244:247], v[228:231]
    v_exp_f32 v200, v200
    v_mfma_f32_16x16x32_bf16 v[228:231], a[160:163], a[216:219], v[228:231]
    v_exp_f32 v201, v201
    v_mfma_f32_16x16x32_bf16 v[228:231], a[164:167], a[220:223], v[228:231]
    v_cvt_pk_bf16_f32 v193, v200, v201
    v_mfma_f32_16x16x32_bf16 v[232:235], a[168:171], a[232:235], 0
    v_exp_f32 v204, v204
    v_mfma_f32_16x16x32_bf16 v[232:235], a[172:175], a[236:239], v[232:235]
    v_exp_f32 v205, v205
    v_mfma_f32_16x16x32_bf16 v[232:235], a[176:179], a[240:243], v[232:235]
    v_cvt_pk_bf16_f32 v194, v204, v205
    v_mfma_f32_16x16x32_bf16 v[232:235], a[180:183], a[244:247], v[232:235]
    v_mul_f32 v228, s38, v228
    v_mul_f32 v229, s38, v229
    v_mfma_f32_16x16x32_bf16 v[212:215], v[24:27], v[192:195], v[212:215]
    v_mul_f32 v230, s38, v230
    v_mul_f32 v231, s38, v231
    v_mfma_f32_16x16x32_bf16 v[216:219], v[54:57], v[192:195], v[216:219]
    v_cvt_pk_bf16_f32 v228, v228, v229
    v_cvt_pk_bf16_f32 v229, v230, v231
    v_mfma_f32_16x16x32_bf16 v[220:223], v[84:87], v[192:195], v[220:223]
    ds_write_b64 v247, v[228:229] offset:13312
    v_mfma_f32_16x16x32_bf16 v[224:227], a[248:251], v[192:195], v[224:227]
    v_mfma_f32_16x16x32_bf16 v[232:235], a[184:187], a[216:219], v[232:235]
    v_mfma_f32_16x16x32_bf16 v[232:235], a[188:191], a[220:223], v[232:235]
    v_mfma_f32_16x16x32_bf16 v[236:239], a[192:195], a[232:235], 0
    ds_read_b128 a[232:235], v242 offset:33920
    v_mfma_f32_16x16x32_bf16 v[236:239], a[196:199], a[236:239], v[236:239]
    ds_read_b128 a[236:239], v243 offset:33920
    v_mfma_f32_16x16x32_bf16 v[236:239], a[200:203], a[240:243], v[236:239]
    ds_read_b128 a[240:243], v242 offset:34048
    v_mfma_f32_16x16x32_bf16 v[236:239], a[204:207], a[244:247], v[236:239]
    ds_read_b128 a[244:247], v243 offset:34048
    v_mul_f32 v232, s38, v232
    v_mfma_f32_16x16x32_bf16 v[236:239], a[208:211], a[216:219], v[236:239]
    v_rcp_f32 v252, v224
    v_mfma_f32_16x16x32_bf16 v[236:239], a[212:215], a[220:223], v[236:239]
    v_max3_f32 v248, v248, v224, v252
    v_mul_f32 v212, v212, v252
    v_mfma_f32_16x16x32_bf16 v[228:231], a[144:147], a[224:227], 0
    s_waitcnt lgkmcnt(4)
    v_mul_f32 v213, v213, v252
    v_mul_f32 v214, v214, v252
    v_mfma_f32_16x16x32_bf16 v[228:231], a[148:151], a[228:231], v[228:231]
    v_mul_f32 v215, v215, v252
    v_cvt_pk_bf16_f32 v212, v212, v213
    v_cvt_pk_bf16_f32 v213, v214, v215
    ds_write_b64 v251, v[212:213] offset:13312
    s_waitcnt lgkmcnt(4)
    v_mfma_f32_16x16x32_bf16 v[228:231], a[152:155], a[232:235], v[228:231]
    s_waitcnt lgkmcnt(3)
    v_mul_f32 v216, v216, v252
    v_mul_f32 v217, v217, v252
    v_mfma_f32_16x16x32_bf16 v[228:231], a[156:159], a[236:239], v[228:231]
    s_waitcnt lgkmcnt(2)
    v_mul_f32 v218, v218, v252
    v_mul_f32 v219, v219, v252
    v_mfma_f32_16x16x32_bf16 v[228:231], a[160:163], a[240:243], v[228:231]
    s_waitcnt lgkmcnt(1)
    v_cvt_pk_bf16_f32 v216, v216, v217
    v_cvt_pk_bf16_f32 v217, v218, v219
    v_mfma_f32_16x16x32_bf16 v[228:231], a[164:167], a[244:247], v[228:231]
    ds_write_b64 v251, v[216:217] offset:13344
    s_barrier
    v_mul_f32 v220, v220, v252
    v_mul_f32 v221, v221, v252
    v_mul_f32 v222, v222, v252
    v_mul_f32 v223, v223, v252
    v_cvt_pk_bf16_f32 v220, v220, v221
    v_cvt_pk_bf16_f32 v221, v222, v223
    ds_write_b64 v251, v[220:221] offset:13376
    ds_read_b128 v[208:211], v244 offset:0
    ds_read_b128 v[196:199], v245 offset:0
    ds_read_b128 v[200:203], v246 offset:0
    ds_read_b128 v[204:207], v244 offset:64
    ds_read_b128 a[216:219], v240 offset:32256
    ds_read_b128 a[220:223], v241 offset:32256
    v_mul_f32 v233, s38, v233
    v_mul_f32 v234, s38, v234
    v_mul_f32 v235, s38, v235
    v_cvt_pk_bf16_f32 v232, v232, v233
    v_cvt_pk_bf16_f32 v233, v234, v235
    ds_write_b64 v247, v[232:233] offset:13344
    v_mfma_f32_16x16x32_bf16 v[232:235], a[168:171], a[224:227], 0
    v_mul_f32 v236, s38, v236
    v_mul_f32 v237, s38, v237
    v_mfma_f32_16x16x32_bf16 v[232:235], a[172:175], a[228:231], v[232:235]
    v_mul_f32 v238, s38, v238
    v_mul_f32 v239, s38, v239
    v_mfma_f32_16x16x32_bf16 v[232:235], a[176:179], a[232:235], v[232:235]
    v_cvt_pk_bf16_f32 v236, v236, v237
    v_cvt_pk_bf16_f32 v237, v238, v239
    v_mfma_f32_16x16x32_bf16 v[232:235], a[180:183], a[236:239], v[232:235]
    ds_write_b64 v247, v[236:237] offset:13376
    v_mfma_f32_16x16x32_bf16 v[232:235], a[184:187], a[240:243], v[232:235]
    s_waitcnt lgkmcnt(6)
    v_mul_f32 v228, s38, v228
    v_mul_f32 v229, s38, v229
    v_mfma_f32_16x16x32_bf16 v[208:211], v[108:111], v[174:177], v[208:211]
    s_waitcnt lgkmcnt(4)
    v_mul_f32 v230, s38, v230
    v_mul_f32 v231, s38, v231
    v_mfma_f32_16x16x32_bf16 v[196:199], v[132:135], v[174:177], v[196:199]
    v_cvt_pk_bf16_f32 v228, v228, v229
    v_cvt_pk_bf16_f32 v229, v230, v231
    v_mfma_f32_16x16x16_bf16 v[208:211], v[112:113], v[178:179], v[208:211]
    ds_write_b64 v247, v[228:229] offset:19968
    v_mfma_f32_16x16x32_bf16 v[200:203], v[156:159], v[174:177], v[200:203]
    s_waitcnt lgkmcnt(2)
    v_mfma_f32_16x16x16_bf16 v[196:199], v[136:137], v[178:179], v[196:199]
    v_mfma_f32_16x16x32_bf16 v[204:207], v[162:165], v[174:177], v[204:207]
    v_mfma_f32_16x16x32_bf16 v[232:235], a[188:191], a[244:247], v[232:235]
    v_mfma_f32_16x16x32_bf16 v[236:239], a[192:195], a[224:227], 0
    ds_read_b128 a[224:227], v240 offset:32384
    v_mfma_f32_16x16x16_bf16 v[200:203], v[160:161], v[178:179], v[200:203]
    v_exp_f32 v208, v208
    v_mfma_f32_16x16x32_bf16 v[236:239], a[196:199], a[228:231], v[236:239]
    ds_read_b128 a[228:231], v241 offset:32384
    v_mfma_f32_16x16x16_bf16 v[204:207], v[166:167], v[178:179], v[204:207]
    v_exp_f32 v209, v209
    v_mfma_f32_16x16x32_bf16 v[236:239], a[200:203], a[232:235], v[236:239]
    ds_read_b128 a[232:235], v240 offset:32512
    v_mul_f32 v232, s38, v232
    v_mfma_f32_16x16x32_bf16 v[236:239], a[204:207], a[236:239], v[236:239]
    ds_read_b128 a[236:239], v241 offset:32512
    v_mul_f32 v233, s38, v233
    v_mfma_f32_16x16x32_bf16 v[236:239], a[208:211], a[240:243], v[236:239]
    ds_read_b128 a[240:243], v240 offset:33792
    v_mul_f32 v234, s38, v234
    v_mfma_f32_16x16x32_bf16 v[236:239], a[212:215], a[244:247], v[236:239]
    ds_read_b128 a[244:247], v241 offset:33792
    v_mul_f32 v235, s38, v235
    v_mfma_f32_16x16x32_bf16 v[228:231], a[0:3], a[216:219], 0
    v_cvt_pk_bf16_f32 v232, v232, v233
    v_cvt_pk_bf16_f32 v233, v234, v235
    v_mfma_f32_16x16x32_bf16 v[228:231], a[4:7], a[220:223], v[228:231]
    s_waitcnt lgkmcnt(5)
    v_exp_f32 v210, v210
    v_mfma_f32_16x16x32_bf16 v[228:231], a[8:11], a[224:227], v[228:231]
    ds_write_b64 v247, v[232:233] offset:20000
    v_mfma_f32_16x16x32_bf16 v[232:235], a[24:27], a[216:219], 0
    s_waitcnt lgkmcnt(5)
    v_mul_f32 v236, s38, v236
    v_mul_f32 v237, s38, v237
    v_mfma_f32_16x16x32_bf16 v[228:231], a[12:15], a[228:231], v[228:231]
    s_waitcnt lgkmcnt(4)
    v_mul_f32 v238, s38, v238
    v_mul_f32 v239, s38, v239
    v_mfma_f32_16x16x32_bf16 v[228:231], a[16:19], a[232:235], v[228:231]
    s_waitcnt lgkmcnt(3)
    v_cvt_pk_bf16_f32 v236, v236, v237
    v_cvt_pk_bf16_f32 v237, v238, v239
    v_mfma_f32_16x16x32_bf16 v[228:231], a[20:23], a[236:239], v[228:231]
    ds_write_b64 v247, v[236:237] offset:20032
    v_mfma_f32_16x16x32_bf16 v[232:235], a[28:31], a[220:223], v[232:235]
    v_exp_f32 v211, v211
    v_mfma_f32_16x16x32_bf16 v[232:235], a[32:35], a[224:227], v[232:235]
    v_cvt_pk_bf16_f32 v180, v208, v209
    v_cvt_pk_bf16_f32 v183, v210, v211
    v_mfma_f32_16x16x32_bf16 v[232:235], a[36:39], a[228:231], v[232:235]
    ds_read_b128 v[208:211], v245 offset:64
    v_cvt_pk_bf16_f32 v108, v228, v229
    v_mfma_f32_16x16x32_bf16 v[232:235], a[40:43], a[232:235], v[232:235]
    v_cvt_pk_bf16_f32 v109, v230, v231
    v_mfma_f32_16x16x32_bf16 v[232:235], a[44:47], a[236:239], v[232:235]
    v_exp_f32 v196, v196
    v_mfma_f32_16x16x32_bf16 v[236:239], a[48:51], a[216:219], 0
    v_exp_f32 v197, v197
    v_mfma_f32_16x16x32_bf16 v[236:239], a[52:55], a[220:223], v[236:239]
    v_exp_f32 v198, v198
    v_mfma_f32_16x16x32_bf16 v[236:239], a[56:59], a[224:227], v[236:239]
    v_exp_f32 v199, v199
    v_mfma_f32_16x16x32_bf16 v[236:239], a[60:63], a[228:231], v[236:239]
    v_cvt_pk_bf16_f32 v110, v232, v233
    v_cvt_pk_bf16_f32 v111, v234, v235
    v_mfma_f32_16x16x32_bf16 v[236:239], a[64:67], a[232:235], v[236:239]
    v_cvt_pk_bf16_f32 v181, v196, v197
    v_cvt_pk_bf16_f32 v184, v198, v199
    v_mfma_f32_16x16x32_bf16 v[236:239], a[68:71], a[236:239], v[236:239]
    ds_read_b128 v[196:199], v246 offset:64
    s_waitcnt lgkmcnt(1)
    v_mfma_f32_16x16x32_bf16 v[208:211], v[90:93], v[174:177], v[208:211]
    v_exp_f32 v200, v200
    v_mfma_f32_16x16x32_bf16 v[228:231], a[216:219], a[72:75], 0
    v_exp_f32 v201, v201
    v_mfma_f32_16x16x32_bf16 v[228:231], a[220:223], a[76:79], v[228:231]
    v_exp_f32 v202, v202
    v_mfma_f32_16x16x32_bf16 v[228:231], a[224:227], a[80:83], v[228:231]
    v_cvt_pk_bf16_f32 v112, v236, v237
    v_cvt_pk_bf16_f32 v113, v238, v239
    v_mfma_f32_16x16x16_bf16 v[208:211], v[94:95], v[178:179], v[208:211]
    v_exp_f32 v203, v203
    v_mfma_f32_16x16x32_bf16 v[228:231], a[228:231], a[84:87], v[228:231]
    v_cvt_pk_bf16_f32 v182, v200, v201
    v_cvt_pk_bf16_f32 v185, v202, v203
    v_mfma_f32_16x16x32_bf16 v[228:231], a[232:235], a[88:91], v[228:231]
    v_exp_f32 v204, v204
    v_mfma_f32_16x16x32_bf16 v[212:215], v[18:21], v[180:183], 0
    v_exp_f32 v205, v205
    v_mfma_f32_16x16x32_bf16 v[216:219], v[48:51], v[180:183], 0
    s_waitcnt lgkmcnt(0)
    v_exp_f32 v206, v206
    v_mfma_f32_16x16x32_bf16 v[220:223], v[78:81], v[180:183], 0
    v_exp_f32 v207, v207
    v_mfma_f32_16x16x32_bf16 v[224:227], a[248:251], v[180:183], 0
    v_cvt_pk_bf16_f32 v186, v204, v205
    v_cvt_pk_bf16_f32 v189, v206, v207
    v_mfma_f32_16x16x32_bf16 v[196:199], v[96:99], v[174:177], v[196:199]
    ds_read_b64 v[174:175], v247 offset:13312
    v_mfma_f32_16x16x32_bf16 v[228:231], a[236:239], a[92:95], v[228:231]
    ds_read_b64 v[176:177], v247 offset:13344
    v_mfma_f32_16x16x32_bf16 v[232:235], a[216:219], a[96:99], 0
    v_exp_f32 v208, v208
    v_mfma_f32_16x16x32_bf16 v[232:235], a[220:223], a[100:103], v[232:235]
    v_exp_f32 v209, v209
    v_mfma_f32_16x16x16_bf16 v[196:199], v[100:101], v[178:179], v[196:199]
    ds_read_b64 v[178:179], v247 offset:13376
    v_cvt_pk_bf16_f32 v187, v208, v209
    v_mfma_f32_16x16x32_bf16 v[232:235], a[224:227], a[104:107], v[232:235]
    v_cvt_pk_bf16_f32 v6, v228, v229
    v_cvt_pk_bf16_f32 v9, v230, v231
    v_mfma_f32_16x16x32_bf16 v[212:215], v[22:25], v[184:187], v[212:215]
    v_exp_f32 v210, v210
    v_mfma_f32_16x16x32_bf16 v[216:219], v[52:55], v[184:187], v[216:219]
    v_exp_f32 v211, v211
    v_mfma_f32_16x16x32_bf16 v[220:223], v[82:85], v[184:187], v[220:223]
    v_cvt_pk_bf16_f32 v190, v210, v211
    v_mfma_f32_16x16x32_bf16 v[224:227], a[248:251], v[184:187], v[224:227]
    v_exp_f32 v196, v196
    v_mfma_f32_16x16x32_bf16 v[232:235], a[228:231], a[108:111], v[232:235]
    v_exp_f32 v197, v197
    v_mfma_f32_16x16x32_bf16 v[232:235], a[232:235], a[112:115], v[232:235]
    v_exp_f32 v198, v198
    v_mfma_f32_16x16x32_bf16 v[232:235], a[236:239], a[116:119], v[232:235]
    v_exp_f32 v199, v199
    v_mfma_f32_16x16x32_bf16 v[236:239], a[216:219], a[120:123], 0
    ds_read_b128 a[216:219], v240 offset:33920
    v_cvt_pk_bf16_f32 v188, v196, v197
    v_mfma_f32_16x16x32_bf16 v[236:239], a[220:223], a[124:127], v[236:239]
    ds_read_b128 a[220:223], v241 offset:33920
    v_cvt_pk_bf16_f32 v191, v198, v199
    v_mfma_f32_16x16x32_bf16 v[236:239], a[224:227], a[128:131], v[236:239]
    ds_read_b128 a[224:227], v240 offset:34048
    v_cvt_pk_bf16_f32 v36, v232, v233
    v_mfma_f32_16x16x32_bf16 v[212:215], v[26:29], v[188:191], v[212:215]
    v_cvt_pk_bf16_f32 v39, v234, v235
    v_mfma_f32_16x16x32_bf16 v[216:219], v[56:59], v[188:191], v[216:219]
    v_mfma_f32_16x16x32_bf16 v[220:223], v[86:89], v[188:191], v[220:223]
    v_mfma_f32_16x16x32_bf16 v[224:227], a[248:251], v[188:191], v[224:227]
    v_mov_b32 v191, 0
    v_mfma_f32_16x16x32_bf16 v[236:239], a[228:231], a[132:135], v[236:239]
    ds_read_b128 a[228:231], v241 offset:34048
    v_mfma_f32_16x16x32_bf16 v[236:239], a[232:235], a[136:139], v[236:239]
    ds_read_b128 a[232:235], v242 offset:61440
    v_mfma_f32_16x16x32_bf16 v[236:239], a[236:239], a[140:143], v[236:239]
    ds_read_b128 a[236:239], v243 offset:61440
    v_mfma_f32_16x16x32_bf16 v[228:231], a[0:3], a[240:243], 0
    v_rcp_f32 v252, v224
    v_mfma_f32_16x16x32_bf16 v[228:231], a[4:7], a[244:247], v[228:231]
    s_waitcnt lgkmcnt(3)
    v_max3_f32 v248, v248, v224, v252
    v_mul_f32 v212, v212, v252
    v_mfma_f32_16x16x32_bf16 v[228:231], a[8:11], a[216:219], v[228:231]
    v_mul_f32 v213, v213, v252
    v_mul_f32 v214, v214, v252
    v_mfma_f32_16x16x32_bf16 v[228:231], a[12:15], a[220:223], v[228:231]
    v_mul_f32 v215, v215, v252
    v_cvt_pk_bf16_f32 v212, v212, v213
    v_mfma_f32_16x16x32_bf16 v[228:231], a[16:19], a[224:227], v[228:231]
    v_cvt_pk_bf16_f32 v213, v214, v215
    v_mul_f32 v216, v216, v252
    v_mfma_f32_16x16x32_bf16 v[232:235], a[24:27], a[240:243], 0
    ds_write_b64 v253, v[212:213] offset:0
    v_mfma_f32_16x16x32_bf16 v[232:235], a[28:31], a[244:247], v[232:235]
    s_waitcnt lgkmcnt(2)
    v_mul_f32 v217, v217, v252
    v_mul_f32 v218, v218, v252
    v_mfma_f32_16x16x32_bf16 v[228:231], a[20:23], a[228:231], v[228:231]
    v_mul_f32 v219, v219, v252
    v_cvt_pk_bf16_f32 v216, v216, v217
    v_mfma_f32_16x16x32_bf16 v[232:235], a[32:35], a[216:219], v[232:235]
    v_cvt_pk_bf16_f32 v217, v218, v219
    v_mul_f32 v220, v220, v252
    v_mfma_f32_16x16x32_bf16 v[232:235], a[36:39], a[220:223], v[232:235]
    ds_write_b64 v253, v[216:217] offset:32
    v_mfma_f32_16x16x32_bf16 v[232:235], a[40:43], a[224:227], v[232:235]
    v_mul_f32 v221, v221, v252
    v_mul_f32 v222, v222, v252
    v_mfma_f32_16x16x32_bf16 v[232:235], a[44:47], a[228:231], v[232:235]
    v_mul_f32 v223, v223, v252
    v_cvt_pk_bf16_f32 v220, v220, v221
    v_cvt_pk_bf16_f32 v221, v222, v223
    ds_write_b64 v253, v[220:221] offset:64
    v_cvt_pk_bf16_f32 v66, v236, v237
    v_cvt_pk_bf16_f32 v69, v238, v239
    v_mfma_f32_16x16x32_bf16 v[236:239], a[48:51], a[240:243], 0
    v_cvt_pk_bf16_f32 v162, v228, v229
    v_cvt_pk_bf16_f32 v163, v230, v231
    v_mfma_f32_16x16x32_bf16 v[236:239], a[52:55], a[244:247], v[236:239]
    v_cvt_pk_bf16_f32 v164, v232, v233
    v_cvt_pk_bf16_f32 v165, v234, v235
    v_mfma_f32_16x16x32_bf16 v[236:239], a[56:59], a[216:219], v[236:239]
    v_mbcnt_lo_u32_b32 v253, -1, 0
    v_mbcnt_hi_u32_b32 v253, -1, v253
    v_mfma_f32_16x16x32_bf16 v[236:239], a[60:63], a[220:223], v[236:239]
    v_and_b32 v253, 2, v253
    v_mbcnt_lo_u32_b32 v252, -1, 0
    v_mfma_f32_16x16x32_bf16 v[236:239], a[64:67], a[224:227], v[236:239]
    v_mbcnt_hi_u32_b32 v252, -1, v252
    v_bfe_u32 v200, v252, 2, 2
    v_mfma_f32_16x16x32_bf16 v[236:239], a[68:71], a[228:231], v[236:239]
    v_and_b32 v201, 3, v252
    v_lshrrev_b32 v252, 4, v252
    v_mfma_f32_16x16x32_bf16 v[228:231], a[240:243], a[72:75], 0
    v_sub_u32 v202, v252, v200
    v_mul_i32_i24 v202, 0x1c0, v202
    v_mfma_f32_16x16x32_bf16 v[228:231], a[244:247], a[76:79], v[228:231]
    v_lshlrev_b32 v203, 4, v201
    v_sub_u32 v202, v202, v203
    v_mfma_f32_16x16x32_bf16 v[228:231], a[216:219], a[80:83], v[228:231]
    v_cvt_pk_bf16_f32 v166, v236, v237
    v_cvt_pk_bf16_f32 v167, v238, v239
    v_mfma_f32_16x16x32_bf16 v[228:231], a[220:223], a[84:87], v[228:231]
    v_add_u32 v202, s37, v202
    v_sub_u32 v203, v252, v200
    v_mfma_f32_16x16x32_bf16 v[228:231], a[224:227], a[88:91], v[228:231]
    v_add_u32 v244, 0, v203
    v_cmp_gt_u32 vcc, 7, v244
    v_mfma_f32_16x16x32_bf16 v[228:231], a[228:231], a[92:95], v[228:231]
    v_add_u32 v244, 0xfffdc870, v202
    v_cndmask_b32 v244, 0, v244, vcc
    v_mfma_f32_16x16x32_bf16 v[232:235], a[240:243], a[96:99], 0
    v_add_u32 v244, 0x237c0, v244
    v_add_u32 v245, 4, v203
    v_mfma_f32_16x16x32_bf16 v[232:235], a[244:247], a[100:103], v[232:235]
    ds_read_b128 v[196:199], v244 offset:256
    v_cmp_gt_u32 vcc, 7, v245
    v_mfma_f32_16x16x32_bf16 v[232:235], a[216:219], a[104:107], v[232:235]
    v_cvt_pk_bf16_f32 v12, v228, v229
    v_cvt_pk_bf16_f32 v15, v230, v231
    v_mfma_f32_16x16x32_bf16 v[232:235], a[220:223], a[108:111], v[232:235]
    v_add_u32 v245, 0xfffdcf70, v202
    v_cndmask_b32 v245, 0, v245, vcc
    v_mfma_f32_16x16x32_bf16 v[232:235], a[224:227], a[112:115], v[232:235]
    v_add_u32 v245, 0x237c0, v245
    v_add_u32 v246, 8, v203
    v_mfma_f32_16x16x32_bf16 v[232:235], a[228:231], a[116:119], v[232:235]
    ds_read_b128 v[204:207], v245 offset:192
    v_cmp_gt_u32 vcc, 7, v246
    v_mfma_f32_16x16x32_bf16 v[236:239], a[240:243], a[120:123], 0
    ds_read_b128 a[240:243], v242 offset:61568
    v_add_u32 v246, 0xfffdd670, v202
    v_mfma_f32_16x16x32_bf16 v[236:239], a[244:247], a[124:127], v[236:239]
    ds_read_b128 a[244:247], v243 offset:61568
    v_cndmask_b32 v246, 0, v246, vcc
    v_mfma_f32_16x16x32_bf16 v[236:239], a[216:219], a[128:131], v[236:239]
    ds_read_b128 a[216:219], v242 offset:61696
    v_cvt_pk_bf16_f32 v42, v232, v233
    v_mfma_f32_16x16x32_bf16 v[236:239], a[220:223], a[132:135], v[236:239]
    ds_read_b128 a[220:223], v243 offset:61696
    s_waitcnt lgkmcnt(5)
    v_cvt_pk_bf16_f32 v45, v234, v235
    v_mfma_f32_16x16x32_bf16 v[196:199], v[120:123], v[168:171], v[196:199]
    ds_read_b128 v[200:203], v244 offset:192
    v_cmp_eq_u32 vcc, 2, v253
    v_mfma_f32_16x16x32_bf16 v[236:239], a[224:227], a[136:139], v[236:239]
    ds_read_b128 a[224:227], v242 offset:62976
    v_add_u32 v253, 0xfffdd200, v247
    v_mfma_f32_16x16x32_bf16 v[236:239], a[228:231], a[140:143], v[236:239]
    ds_read_b128 a[228:231], v243 offset:62976
    v_cndmask_b32 v253, 0, v253, vcc
    v_mfma_f32_16x16x16_bf16 v[196:199], v[124:125], v[172:173], v[196:199]
    v_add_u32 v253, 0x22e00, v253
    v_add_u32 v246, 0x237c0, v246
    v_mfma_f32_16x16x32_bf16 v[228:231], a[144:147], a[232:235], 0
    ds_read_b128 v[208:211], v246 offset:192
    s_waitcnt lgkmcnt(7)
    v_cvt_pk_bf16_f32 v72, v236, v237
    v_mfma_f32_16x16x32_bf16 v[204:207], v[138:141], v[168:171], v[204:207]
    v_cvt_pk_bf16_f32 v75, v238, v239
    v_mfma_f32_16x16x32_bf16 v[228:231], a[148:151], a[236:239], v[228:231]
    v_exp_f32 v196, v196
    v_mfma_f32_16x16x32_bf16 v[228:231], a[152:155], a[240:243], v[228:231]
    s_waitcnt lgkmcnt(5)
    v_exp_f32 v197, v197
    v_mfma_f32_16x16x16_bf16 v[204:207], v[142:143], v[172:173], v[204:207]
    v_exp_f32 v198, v198
    v_mfma_f32_16x16x32_bf16 v[228:231], a[156:159], a[244:247], v[228:231]
    s_waitcnt lgkmcnt(3)
    v_exp_f32 v199, v199
    v_mfma_f32_16x16x32_bf16 v[200:203], v[114:117], v[168:171], v[200:203]
    v_cvt_pk_bf16_f32 v183, v196, v197
    v_cvt_pk_bf16_f32 v186, v198, v199
    v_mfma_f32_16x16x32_bf16 v[228:231], a[160:163], a[216:219], v[228:231]
    ds_read_b128 v[196:199], v245 offset:320
    v_mfma_f32_16x16x32_bf16 v[228:231], a[164:167], a[220:223], v[228:231]
    v_exp_f32 v204, v204
    v_mfma_f32_16x16x16_bf16 v[200:203], v[118:119], v[172:173], v[200:203]
    s_waitcnt lgkmcnt(1)
    v_exp_f32 v205, v205
    v_mfma_f32_16x16x32_bf16 v[208:211], v[102:105], v[168:171], v[208:211]
    v_exp_f32 v206, v206
    v_mfma_f32_16x16x32_bf16 v[232:235], a[168:171], a[232:235], 0
    v_exp_f32 v207, v207
    v_mfma_f32_16x16x32_bf16 v[232:235], a[172:175], a[236:239], v[232:235]
    v_mul_f32 v228, s38, v228
    v_mul_f32 v229, s38, v229
    v_mfma_f32_16x16x16_bf16 v[208:211], v[106:107], v[172:173], v[208:211]
    v_mul_f32 v230, s38, v230
    v_mul_f32 v231, s38, v231
    v_mfma_f32_16x16x32_bf16 v[232:235], a[176:179], a[240:243], v[232:235]
    v_cvt_pk_bf16_f32 v228, v228, v229
    v_cvt_pk_bf16_f32 v229, v230, v231
    v_mfma_f32_16x16x32_bf16 v[232:235], a[180:183], a[244:247], v[232:235]
    ds_write_b64 v247, v[228:229] offset:26624
    v_mfma_f32_16x16x32_bf16 v[232:235], a[184:187], a[216:219], v[232:235]
    s_waitcnt lgkmcnt(1)
    v_exp_f32 v200, v200
    v_mfma_f32_16x16x32_bf16 v[196:199], v[150:153], v[168:171], v[196:199]
    v_exp_f32 v201, v201
    v_mfma_f32_16x16x32_bf16 v[232:235], a[188:191], a[220:223], v[232:235]
    v_exp_f32 v202, v202
    v_mfma_f32_16x16x32_bf16 v[236:239], a[192:195], a[232:235], 0
    ds_read_b128 a[232:235], v242 offset:63104
    v_cvt_pk_bf16_f32 v193, v200, v201
    v_mfma_f32_16x16x16_bf16 v[196:199], v[154:155], v[172:173], v[196:199]
    v_exp_f32 v203, v203
    v_mfma_f32_16x16x32_bf16 v[236:239], a[196:199], a[236:239], v[236:239]
    ds_read_b128 a[236:239], v243 offset:63104
    v_mul_f32 v232, s38, v232
    v_mfma_f32_16x16x32_bf16 v[236:239], a[200:203], a[240:243], v[236:239]
    ds_read_b128 a[240:243], v242 offset:63232
    v_mul_f32 v233, s38, v233
    v_mfma_f32_16x16x32_bf16 v[236:239], a[204:207], a[244:247], v[236:239]
    ds_read_b128 a[244:247], v243 offset:63232
    v_mul_f32 v234, s38, v234
    v_mfma_f32_16x16x32_bf16 v[236:239], a[208:211], a[216:219], v[236:239]
    ds_read_b128 a[216:219], v240 offset:35328
    v_mul_f32 v235, s38, v235
    v_mfma_f32_16x16x32_bf16 v[236:239], a[212:215], a[220:223], v[236:239]
    ds_read_b128 a[220:223], v241 offset:35328
    v_cvt_pk_bf16_f32 v232, v232, v233
    v_mfma_f32_16x16x32_bf16 v[228:231], a[144:147], a[224:227], 0
    v_cvt_pk_bf16_f32 v233, v234, v235
    v_cvt_pk_bf16_f32 v180, v202, v203
    v_mfma_f32_16x16x32_bf16 v[228:231], a[148:151], a[228:231], v[228:231]
    ds_write_b64 v247, v[232:233] offset:26656
    v_mfma_f32_16x16x32_bf16 v[232:235], a[168:171], a[224:227], 0
    ds_read_b128 v[200:203], v245 offset:256
    s_waitcnt lgkmcnt(7)
    v_mul_f32 v236, s38, v236
    v_mfma_f32_16x16x32_bf16 v[228:231], a[152:155], a[232:235], v[228:231]
    s_waitcnt lgkmcnt(6)
    v_mul_f32 v237, s38, v237
    v_mul_f32 v238, s38, v238
    v_mfma_f32_16x16x32_bf16 v[228:231], a[156:159], a[236:239], v[228:231]
    s_waitcnt lgkmcnt(5)
    v_mul_f32 v239, s38, v239
    v_cvt_pk_bf16_f32 v236, v236, v237
    v_mfma_f32_16x16x32_bf16 v[228:231], a[160:163], a[240:243], v[228:231]
    s_waitcnt lgkmcnt(4)
    v_cvt_pk_bf16_f32 v237, v238, v239
    v_cvt_pk_bf16_f32 v194, v204, v205
    v_mfma_f32_16x16x32_bf16 v[228:231], a[164:167], a[244:247], v[228:231]
    ds_write_b64 v247, v[236:237] offset:26688
    v_mfma_f32_16x16x32_bf16 v[232:235], a[172:175], a[228:231], v[232:235]
    v_cvt_pk_bf16_f32 v181, v206, v207
    v_mfma_f32_16x16x32_bf16 v[232:235], a[176:179], a[232:235], v[232:235]
    ds_read_b128 v[204:207], v246 offset:256
    v_mfma_f32_16x16x32_bf16 v[232:235], a[180:183], a[236:239], v[232:235]
    v_exp_f32 v208, v208
    v_mfma_f32_16x16x32_bf16 v[232:235], a[184:187], a[240:243], v[232:235]
    s_waitcnt lgkmcnt(2)
    v_mul_f32 v228, s38, v228
    v_mul_f32 v229, s38, v229
    v_mfma_f32_16x16x32_bf16 v[200:203], v[144:147], v[168:171], v[200:203]
    v_mul_f32 v230, s38, v230
    v_mul_f32 v231, s38, v231
    v_mfma_f32_16x16x32_bf16 v[232:235], a[188:191], a[244:247], v[232:235]
    v_cvt_pk_bf16_f32 v228, v228, v229
    v_cvt_pk_bf16_f32 v229, v230, v231
    v_mfma_f32_16x16x32_bf16 v[236:239], a[192:195], a[224:227], 0
    ds_write_b64 v247, v[228:229] offset:33280
    v_mfma_f32_16x16x16_bf16 v[200:203], v[148:149], v[172:173], v[200:203]
    ds_read_b128 a[224:227], v240 offset:35456
    v_mfma_f32_16x16x32_bf16 v[236:239], a[196:199], a[228:231], v[236:239]
    ds_read_b128 a[228:231], v241 offset:35456
    v_mul_f32 v232, s38, v232
    v_mfma_f32_16x16x32_bf16 v[236:239], a[200:203], a[232:235], v[236:239]
    ds_read_b128 a[232:235], v240 offset:35584
    s_waitcnt lgkmcnt(4)
    v_mul_f32 v233, s38, v233
    v_mfma_f32_16x16x32_bf16 v[204:207], v[108:111], v[168:171], v[204:207]
    v_mul_f32 v234, s38, v234
    v_mul_f32 v235, s38, v235
    v_mfma_f32_16x16x32_bf16 v[236:239], a[204:207], a[236:239], v[236:239]
    ds_read_b128 a[236:239], v241 offset:35584
    v_cvt_pk_bf16_f32 v232, v232, v233
    v_mfma_f32_16x16x32_bf16 v[236:239], a[208:211], a[240:243], v[236:239]
    ds_read_b128 a[240:243], v242 offset:64512
    v_cvt_pk_bf16_f32 v233, v234, v235
    v_mfma_f32_16x16x16_bf16 v[204:207], v[112:113], v[172:173], v[204:207]
    ds_write_b64 v247, v[232:233] offset:33312
    v_mfma_f32_16x16x32_bf16 v[236:239], a[212:215], a[244:247], v[236:239]
    ds_read_b128 a[244:247], v243 offset:64512
    v_mfma_f32_16x16x32_bf16 v[228:231], a[0:3], a[216:219], 0
    v_exp_f32 v209, v209
    v_mfma_f32_16x16x32_bf16 v[228:231], a[4:7], a[220:223], v[228:231]
    s_waitcnt lgkmcnt(5)
    v_exp_f32 v210, v210
    v_mfma_f32_16x16x32_bf16 v[228:231], a[8:11], a[224:227], v[228:231]
    v_exp_f32 v211, v211
    v_mfma_f32_16x16x32_bf16 v[228:231], a[12:15], a[228:231], v[228:231]
    s_waitcnt lgkmcnt(4)
    v_mul_f32 v236, s38, v236
    v_mul_f32 v237, s38, v237
    v_mfma_f32_16x16x32_bf16 v[228:231], a[16:19], a[232:235], v[228:231]
    s_waitcnt lgkmcnt(3)
    v_mul_f32 v238, s38, v238
    v_mul_f32 v239, s38, v239
    v_mfma_f32_16x16x32_bf16 v[228:231], a[20:23], a[236:239], v[228:231]
    v_cvt_pk_bf16_f32 v236, v236, v237
    v_cvt_pk_bf16_f32 v237, v238, v239
    v_mfma_f32_16x16x32_bf16 v[232:235], a[24:27], a[216:219], 0
    ds_write_b64 v247, v[236:237] offset:33344
    v_mfma_f32_16x16x32_bf16 v[232:235], a[28:31], a[220:223], v[232:235]
    v_cvt_pk_bf16_f32 v192, v208, v209
    v_cvt_pk_bf16_f32 v195, v210, v211
    v_mfma_f32_16x16x32_bf16 v[232:235], a[32:35], a[224:227], v[232:235]
    ds_read_b128 v[208:211], v244 offset:320
    v_cvt_pk_bf16_f32 v114, v228, v229
    v_mfma_f32_16x16x32_bf16 v[212:215], v[0:3], v[192:195], 0
    v_cvt_pk_bf16_f32 v115, v230, v231
    v_mfma_f32_16x16x32_bf16 v[216:219], v[30:33], v[192:195], 0
    v_exp_f32 v200, v200
    v_mfma_f32_16x16x32_bf16 v[220:223], v[60:63], v[192:195], 0
    v_exp_f32 v201, v201
    v_mfma_f32_16x16x32_bf16 v[224:227], a[248:251], v[192:195], 0
    v_exp_f32 v202, v202
    v_mfma_f32_16x16x32_bf16 v[232:235], a[36:39], a[228:231], v[232:235]
    v_exp_f32 v203, v203
    v_mfma_f32_16x16x32_bf16 v[232:235], a[40:43], a[232:235], v[232:235]
    v_cvt_pk_bf16_f32 v184, v200, v201
    v_cvt_pk_bf16_f32 v187, v202, v203
    v_mfma_f32_16x16x32_bf16 v[232:235], a[44:47], a[236:239], v[232:235]
    ds_read_b128 v[200:203], v246 offset:320
    v_mfma_f32_16x16x32_bf16 v[236:239], a[48:51], a[216:219], 0
    v_exp_f32 v204, v204
    v_mfma_f32_16x16x32_bf16 v[236:239], a[52:55], a[220:223], v[236:239]
    s_waitcnt lgkmcnt(1)
    v_exp_f32 v205, v205
    v_mfma_f32_16x16x32_bf16 v[208:211], v[126:129], v[168:171], v[208:211]
    v_exp_f32 v206, v206
    v_mfma_f32_16x16x32_bf16 v[236:239], a[56:59], a[224:227], v[236:239]
    v_cvt_pk_bf16_f32 v116, v232, v233
    v_cvt_pk_bf16_f32 v117, v234, v235
    v_mfma_f32_16x16x32_bf16 v[236:239], a[60:63], a[228:231], v[236:239]
    v_exp_f32 v207, v207
    v_mfma_f32_16x16x16_bf16 v[208:211], v[130:131], v[172:173], v[208:211]
    v_cvt_pk_bf16_f32 v182, v204, v205
    v_cvt_pk_bf16_f32 v185, v206, v207
    v_mfma_f32_16x16x32_bf16 v[236:239], a[64:67], a[232:235], v[236:239]
    ds_read_b128 v[204:207], v244 offset:0
    v_mfma_f32_16x16x32_bf16 v[212:215], v[4:7], v[180:183], v[212:215]
    v_exp_f32 v196, v196
    v_mfma_f32_16x16x32_bf16 v[216:219], v[34:37], v[180:183], v[216:219]
    s_waitcnt lgkmcnt(1)
    v_exp_f32 v208, v208
    v_mfma_f32_16x16x32_bf16 v[220:223], v[64:67], v[180:183], v[220:223]
    v_exp_f32 v209, v209
    v_mfma_f32_16x16x32_bf16 v[224:227], a[248:251], v[180:183], v[224:227]
    v_cvt_pk_bf16_f32 v189, v208, v209
    v_mfma_f32_16x16x32_bf16 v[212:215], v[8:11], v[184:187], v[212:215]
    ds_read_b128 v[208:211], v245 offset:0
    v_mfma_f32_16x16x32_bf16 v[216:219], v[38:41], v[184:187], v[216:219]
    v_exp_f32 v197, v197
    v_mfma_f32_16x16x32_bf16 v[220:223], v[68:71], v[184:187], v[220:223]
    v_cvt_pk_bf16_f32 v190, v196, v197
    v_mfma_f32_16x16x32_bf16 v[224:227], a[248:251], v[184:187], v[224:227]
    ds_read_b128 v[196:199], v246 offset:0
    s_waitcnt lgkmcnt(2)
    v_mfma_f32_16x16x32_bf16 v[200:203], v[162:165], v[168:171], v[200:203]
    v_mfma_f32_16x16x32_bf16 v[204:207], v[120:123], v[174:177], v[204:207]
    v_mfma_f32_16x16x32_bf16 v[236:239], a[68:71], a[236:239], v[236:239]
    v_mfma_f32_16x16x32_bf16 v[228:231], a[216:219], a[72:75], 0
    v_mfma_f32_16x16x32_bf16 v[228:231], a[220:223], a[76:79], v[228:231]
    v_mfma_f32_16x16x32_bf16 v[228:231], a[224:227], a[80:83], v[228:231]
    s_waitcnt lgkmcnt(1)
    v_mfma_f32_16x16x16_bf16 v[200:203], v[166:167], v[172:173], v[200:203]
    v_mfma_f32_16x16x16_bf16 v[204:207], v[124:125], v[178:179], v[204:207]
    v_mfma_f32_16x16x32_bf16 v[208:211], v[144:147], v[174:177], v[208:211]
    s_waitcnt lgkmcnt(0)
    v_cvt_pk_bf16_f32 v118, v236, v237
    v_cvt_pk_bf16_f32 v119, v238, v239
    v_mfma_f32_16x16x32_bf16 v[196:199], v[108:111], v[174:177], v[196:199]
    v_mfma_f32_16x16x32_bf16 v[228:231], a[228:231], a[84:87], v[228:231]
    v_mfma_f32_16x16x32_bf16 v[228:231], a[232:235], a[88:91], v[228:231]
    v_exp_f32 v200, v200
    v_mfma_f32_16x16x16_bf16 v[208:211], v[148:149], v[178:179], v[208:211]
    v_exp_f32 v201, v201
    v_mfma_f32_16x16x32_bf16 v[228:231], a[236:239], a[92:95], v[228:231]
    v_cvt_pk_bf16_f32 v188, v200, v201
    v_mfma_f32_16x16x16_bf16 v[196:199], v[112:113], v[178:179], v[196:199]
    ds_read_b128 v[200:203], v244 offset:64
    v_mfma_f32_16x16x32_bf16 v[212:215], v[12:15], v[188:191], v[212:215]
    v_exp_f32 v204, v204
    v_mfma_f32_16x16x32_bf16 v[216:219], v[42:45], v[188:191], v[216:219]
    v_exp_f32 v205, v205
    v_mfma_f32_16x16x32_bf16 v[220:223], v[72:75], v[188:191], v[220:223]
    v_cvt_pk_bf16_f32 v18, v228, v229
    v_cvt_pk_bf16_f32 v21, v230, v231
    v_mfma_f32_16x16x32_bf16 v[224:227], a[248:251], v[188:191], v[224:227]
    v_exp_f32 v206, v206
    v_mfma_f32_16x16x32_bf16 v[232:235], a[216:219], a[96:99], 0
    v_exp_f32 v207, v207
    v_mfma_f32_16x16x32_bf16 v[232:235], a[220:223], a[100:103], v[232:235]
    v_cvt_pk_bf16_f32 v193, v204, v205
    v_cvt_pk_bf16_f32 v180, v206, v207
    v_mfma_f32_16x16x32_bf16 v[232:235], a[224:227], a[104:107], v[232:235]
    ds_read_b128 v[204:207], v245 offset:64
    v_mfma_f32_16x16x32_bf16 v[232:235], a[228:231], a[108:111], v[232:235]
    v_rcp_f32 v252, v224
    v_mfma_f32_16x16x32_bf16 v[232:235], a[232:235], a[112:115], v[232:235]
    s_waitcnt lgkmcnt(1)
    v_max3_f32 v248, v248, v224, v252
    v_mul_f32 v212, v212, v252
    v_mfma_f32_16x16x32_bf16 v[200:203], v[126:129], v[174:177], v[200:203]
    v_mul_f32 v213, v213, v252
    v_mul_f32 v214, v214, v252
    v_mfma_f32_16x16x32_bf16 v[232:235], a[236:239], a[116:119], v[232:235]
    v_mul_f32 v215, v215, v252
    v_cvt_pk_bf16_f32 v212, v212, v213
    v_mfma_f32_16x16x32_bf16 v[236:239], a[216:219], a[120:123], 0
    ds_read_b128 a[216:219], v242 offset:64640
    v_cvt_pk_bf16_f32 v213, v214, v215
    v_mfma_f32_16x16x16_bf16 v[200:203], v[130:131], v[178:179], v[200:203]
    ds_write_b64 v247, v[212:213] offset:6656
    v_mfma_f32_16x16x32_bf16 v[236:239], a[220:223], a[124:127], v[236:239]
    ds_read_b128 a[220:223], v243 offset:64640
    v_mul_f32 v216, v216, v252
    v_mfma_f32_16x16x32_bf16 v[236:239], a[224:227], a[128:131], v[236:239]
    ds_read_b128 a[224:227], v242 offset:64768
    s_waitcnt lgkmcnt(4)
    v_mul_f32 v217, v217, v252
    v_mfma_f32_16x16x32_bf16 v[204:207], v[150:153], v[174:177], v[204:207]
    v_mul_f32 v218, v218, v252
    v_mul_f32 v219, v219, v252
    v_mfma_f32_16x16x32_bf16 v[236:239], a[228:231], a[132:135], v[236:239]
    ds_read_b128 a[228:231], v243 offset:64768
    v_cvt_pk_bf16_f32 v216, v216, v217
    v_mfma_f32_16x16x32_bf16 v[236:239], a[232:235], a[136:139], v[236:239]
    v_cvt_pk_bf16_f32 v217, v218, v219
    v_mul_f32 v220, v220, v252
    v_mfma_f32_16x16x16_bf16 v[204:207], v[154:155], v[178:179], v[204:207]
    ds_write_b64 v247, v[216:217] offset:6688
    v_mfma_f32_16x16x32_bf16 v[236:239], a[236:239], a[140:143], v[236:239]
    v_mul_f32 v221, v221, v252
    v_mul_f32 v222, v222, v252
    v_mfma_f32_16x16x32_bf16 v[228:231], a[144:147], a[240:243], 0
    v_mul_f32 v223, v223, v252
    v_cvt_pk_bf16_f32 v220, v220, v221
    v_mfma_f32_16x16x32_bf16 v[228:231], a[148:151], a[244:247], v[228:231]
    s_waitcnt lgkmcnt(3)
    v_cvt_pk_bf16_f32 v221, v222, v223
    v_cvt_pk_bf16_f32 v48, v232, v233
    v_mfma_f32_16x16x32_bf16 v[228:231], a[152:155], a[216:219], v[228:231]
    ds_write_b64 v247, v[220:221] offset:6720
    v_mfma_f32_16x16x32_bf16 v[228:231], a[156:159], a[220:223], v[228:231]
    s_waitcnt lgkmcnt(3)
    v_cvt_pk_bf16_f32 v51, v234, v235
    v_cvt_pk_bf16_f32 v78, v236, v237
    v_mfma_f32_16x16x32_bf16 v[228:231], a[160:163], a[224:227], v[228:231]
    s_waitcnt lgkmcnt(2)
    v_cvt_pk_bf16_f32 v81, v238, v239
    v_add_u32 v242, 0xf000, v242
    v_mfma_f32_16x16x32_bf16 v[228:231], a[164:167], a[228:231], v[228:231]
    ds_read_b128 a[232:235], v242 offset:4608
    v_add_u32 v243, 0xf000, v243
    v_mfma_f32_16x16x32_bf16 v[232:235], a[168:171], a[240:243], 0
    ds_read_b128 a[236:239], v243 offset:4608
    v_mfma_f32_16x16x32_bf16 v[232:235], a[172:175], a[244:247], v[232:235]
    v_exp_f32 v208, v208
    v_mfma_f32_16x16x32_bf16 v[232:235], a[176:179], a[216:219], v[232:235]
    v_exp_f32 v209, v209
    v_mfma_f32_16x16x32_bf16 v[232:235], a[180:183], a[220:223], v[232:235]
    v_mul_f32 v228, s38, v228
    v_mul_f32 v229, s38, v229
    v_mfma_f32_16x16x32_bf16 v[232:235], a[184:187], a[224:227], v[232:235]
    v_mul_f32 v230, s38, v230
    v_mul_f32 v231, s38, v231
    v_mfma_f32_16x16x32_bf16 v[232:235], a[188:191], a[228:231], v[232:235]
    v_cvt_pk_bf16_f32 v228, v228, v229
    v_cvt_pk_bf16_f32 v229, v230, v231
    v_mfma_f32_16x16x32_bf16 v[236:239], a[192:195], a[240:243], 0
    ds_write_b64 v247, v[228:229] offset:39936
    v_mfma_f32_16x16x32_bf16 v[236:239], a[196:199], a[244:247], v[236:239]
    ds_read_b128 a[240:243], v242 offset:4736
    s_waitcnt lgkmcnt(3)
    v_cvt_pk_bf16_f32 v194, v208, v209
    v_mfma_f32_16x16x32_bf16 v[236:239], a[200:203], a[216:219], v[236:239]
    ds_read_b128 a[244:247], v243 offset:4736
    v_mul_f32 v232, s38, v232
    v_mfma_f32_16x16x32_bf16 v[236:239], a[204:207], a[220:223], v[236:239]
    ds_read_b128 a[216:219], v242 offset:4864
    v_mul_f32 v233, s38, v233
    v_mfma_f32_16x16x32_bf16 v[236:239], a[208:211], a[224:227], v[236:239]
    ds_read_b128 a[220:223], v243 offset:4864
    v_mul_f32 v234, s38, v234
    v_mfma_f32_16x16x32_bf16 v[236:239], a[212:215], a[228:231], v[236:239]
    ds_read_b128 a[224:227], v240 offset:36864
    v_mul_f32 v235, s38, v235
    v_mfma_f32_16x16x32_bf16 v[228:231], a[144:147], a[232:235], 0
    s_waitcnt lgkmcnt(6)
    v_cvt_pk_bf16_f32 v232, v232, v233
    v_cvt_pk_bf16_f32 v233, v234, v235
    v_mfma_f32_16x16x32_bf16 v[228:231], a[148:151], a[236:239], v[228:231]
    ds_write_b64 v247, v[232:233] offset:39968
    v_mfma_f32_16x16x32_bf16 v[232:235], a[168:171], a[232:235], 0
    ds_read_b128 a[228:231], v241 offset:36864
    v_mul_f32 v236, s38, v236
    v_mfma_f32_16x16x32_bf16 v[232:235], a[172:175], a[236:239], v[232:235]
    s_waitcnt lgkmcnt(6)
    v_mul_f32 v237, s38, v237
    v_mul_f32 v238, s38, v238
    v_mfma_f32_16x16x32_bf16 v[228:231], a[152:155], a[240:243], v[228:231]
    s_waitcnt lgkmcnt(5)
    v_mul_f32 v239, s38, v239
    v_cvt_pk_bf16_f32 v236, v236, v237
    v_mfma_f32_16x16x32_bf16 v[228:231], a[156:159], a[244:247], v[228:231]
    s_waitcnt lgkmcnt(4)
    v_cvt_pk_bf16_f32 v237, v238, v239
    v_mfma_f32_16x16x32_bf16 v[228:231], a[160:163], a[216:219], v[228:231]
    ds_write_b64 v247, v[236:237] offset:40000
    v_mfma_f32_16x16x32_bf16 v[232:235], a[176:179], a[240:243], v[232:235]
    s_waitcnt lgkmcnt(3)
    v_exp_f32 v210, v210
    v_mfma_f32_16x16x32_bf16 v[228:231], a[164:167], a[220:223], v[228:231]
    v_exp_f32 v211, v211
    v_mfma_f32_16x16x32_bf16 v[232:235], a[180:183], a[244:247], v[232:235]
    v_cvt_pk_bf16_f32 v181, v210, v211
    v_mfma_f32_16x16x32_bf16 v[232:235], a[184:187], a[216:219], v[232:235]
    ds_read_b128 v[208:211], v246 offset:64
    v_mfma_f32_16x16x32_bf16 v[232:235], a[188:191], a[220:223], v[232:235]
    v_exp_f32 v196, v196
    v_mfma_f32_16x16x32_bf16 v[236:239], a[192:195], a[232:235], 0
    ds_read_b128 a[232:235], v240 offset:36992
    v_mul_f32 v228, s38, v228
    v_mfma_f32_16x16x32_bf16 v[236:239], a[196:199], a[236:239], v[236:239]
    ds_read_b128 a[236:239], v241 offset:36992
    v_mul_f32 v229, s38, v229
    v_mfma_f32_16x16x32_bf16 v[236:239], a[200:203], a[240:243], v[236:239]
    ds_read_b128 a[240:243], v240 offset:37120
    v_mul_f32 v230, s38, v230
    v_mfma_f32_16x16x32_bf16 v[236:239], a[204:207], a[244:247], v[236:239]
    ds_read_b128 a[244:247], v241 offset:37120
    v_mul_f32 v231, s38, v231
    v_mfma_f32_16x16x32_bf16 v[236:239], a[208:211], a[216:219], v[236:239]
    v_cvt_pk_bf16_f32 v228, v228, v229
    v_cvt_pk_bf16_f32 v229, v230, v231
    v_mfma_f32_16x16x32_bf16 v[236:239], a[212:215], a[220:223], v[236:239]
    ds_write_b64 v247, v[228:229] offset:46592
    v_mfma_f32_16x16x32_bf16 v[228:231], a[0:3], a[224:227], 0
    s_waitcnt lgkmcnt(5)
    v_mul_f32 v232, s38, v232
    v_mul_f32 v233, s38, v233
    v_mfma_f32_16x16x32_bf16 v[208:211], v[162:165], v[174:177], v[208:211]
    v_mul_f32 v234, s38, v234
    v_mul_f32 v235, s38, v235
    v_mfma_f32_16x16x32_bf16 v[228:231], a[4:7], a[228:231], v[228:231]
    s_waitcnt lgkmcnt(4)
    v_cvt_pk_bf16_f32 v232, v232, v233
    v_cvt_pk_bf16_f32 v233, v234, v235
    v_mfma_f32_16x16x16_bf16 v[208:211], v[166:167], v[178:179], v[208:211]
    ds_write_b64 v247, v[232:233] offset:46624
    v_mfma_f32_16x16x32_bf16 v[228:231], a[8:11], a[232:235], v[228:231]
    s_waitcnt lgkmcnt(3)
    v_mul_f32 v236, s38, v236
    v_mul_f32 v237, s38, v237
    v_mfma_f32_16x16x32_bf16 v[228:231], a[12:15], a[236:239], v[228:231]
    s_waitcnt vmcnt(0) lgkmcnt(2)
    v_mul_f32 v238, s38, v238
    v_mul_f32 v239, s38, v239
    v_mfma_f32_16x16x32_bf16 v[228:231], a[16:19], a[240:243], v[228:231]
    s_barrier
    v_cvt_pk_bf16_f32 v236, v236, v237
    v_cvt_pk_bf16_f32 v237, v238, v239
    v_mfma_f32_16x16x32_bf16 v[228:231], a[20:23], a[244:247], v[228:231]
    ds_write_b64 v247, v[236:237] offset:46656
    v_mfma_f32_16x16x32_bf16 v[232:235], a[24:27], a[224:227], 0
    ds_read_b64 v[168:169], v247 offset:19968
    v_add_u32 v240, 0xffff1000, v240
    v_mfma_f32_16x16x32_bf16 v[232:235], a[28:31], a[228:231], v[232:235]
    ds_read_b64 v[170:171], v247 offset:20000
    v_add_u32 v241, 0xffff1000, v241
    v_mfma_f32_16x16x32_bf16 v[232:235], a[32:35], a[232:235], v[232:235]
    ds_read_b64 v[172:173], v247 offset:20032
    v_cvt_pk_bf16_f32 v120, v228, v229
    v_mfma_f32_16x16x32_bf16 v[232:235], a[36:39], a[236:239], v[232:235]
    v_cvt_pk_bf16_f32 v121, v230, v231
    v_mfma_f32_16x16x32_bf16 v[232:235], a[40:43], a[240:243], v[232:235]
    v_exp_f32 v197, v197
    v_mfma_f32_16x16x32_bf16 v[232:235], a[44:47], a[244:247], v[232:235]
    v_exp_f32 v198, v198
    v_mfma_f32_16x16x32_bf16 v[236:239], a[48:51], a[224:227], 0
    v_exp_f32 v199, v199
    v_mfma_f32_16x16x32_bf16 v[236:239], a[52:55], a[228:231], v[236:239]
    v_cvt_pk_bf16_f32 v192, v196, v197
    v_cvt_pk_bf16_f32 v195, v198, v199
    v_mfma_f32_16x16x32_bf16 v[236:239], a[56:59], a[232:235], v[236:239]
    ds_read_b128 v[196:199], v244 offset:128
    v_cvt_pk_bf16_f32 v122, v232, v233
    v_mfma_f32_16x16x32_bf16 v[212:215], v[6:9], v[192:195], 0
    v_cvt_pk_bf16_f32 v123, v234, v235
    v_mfma_f32_16x16x32_bf16 v[216:219], v[36:39], v[192:195], 0
    v_exp_f32 v200, v200
    v_mfma_f32_16x16x32_bf16 v[220:223], v[66:69], v[192:195], 0
    v_exp_f32 v201, v201
    v_mfma_f32_16x16x32_bf16 v[224:227], a[248:251], v[192:195], 0
    v_exp_f32 v202, v202
    v_mfma_f32_16x16x32_bf16 v[236:239], a[60:63], a[236:239], v[236:239]
    v_exp_f32 v203, v203
    v_mfma_f32_16x16x32_bf16 v[236:239], a[64:67], a[240:243], v[236:239]
    v_cvt_pk_bf16_f32 v183, v200, v201
    v_cvt_pk_bf16_f32 v186, v202, v203
    v_mfma_f32_16x16x32_bf16 v[236:239], a[68:71], a[244:247], v[236:239]
    ds_read_b128 v[200:203], v245 offset:128
    v_mfma_f32_16x16x32_bf16 v[228:231], a[224:227], a[72:75], 0
    v_exp_f32 v204, v204
    v_mfma_f32_16x16x32_bf16 v[228:231], a[228:231], a[76:79], v[228:231]
    s_waitcnt lgkmcnt(1)
    v_exp_f32 v205, v205
    v_mfma_f32_16x16x32_bf16 v[196:199], v[132:135], v[174:177], v[196:199]
    v_exp_f32 v206, v206
    v_mfma_f32_16x16x32_bf16 v[228:231], a[232:235], a[80:83], v[228:231]
    v_cvt_pk_bf16_f32 v124, v236, v237
    v_cvt_pk_bf16_f32 v125, v238, v239
    v_mfma_f32_16x16x32_bf16 v[228:231], a[236:239], a[84:87], v[228:231]
    v_exp_f32 v207, v207
    v_mfma_f32_16x16x16_bf16 v[196:199], v[136:137], v[178:179], v[196:199]
    v_cvt_pk_bf16_f32 v184, v204, v205
    v_cvt_pk_bf16_f32 v187, v206, v207
    v_mfma_f32_16x16x32_bf16 v[228:231], a[240:243], a[88:91], v[228:231]
    ds_read_b128 v[204:207], v246 offset:128
    v_mfma_f32_16x16x32_bf16 v[228:231], a[244:247], a[92:95], v[228:231]
    v_exp_f32 v208, v208
    v_mfma_f32_16x16x32_bf16 v[232:235], a[224:227], a[96:99], 0
    s_waitcnt lgkmcnt(1)
    v_exp_f32 v209, v209
    v_mfma_f32_16x16x32_bf16 v[200:203], v[156:159], v[174:177], v[200:203]
    v_exp_f32 v210, v210
    v_mfma_f32_16x16x32_bf16 v[232:235], a[228:231], a[100:103], v[232:235]
    v_exp_f32 v211, v211
    v_mfma_f32_16x16x32_bf16 v[232:235], a[232:235], a[104:107], v[232:235]
    v_cvt_pk_bf16_f32 v24, v228, v229
    v_cvt_pk_bf16_f32 v27, v230, v231
    v_mfma_f32_16x16x16_bf16 v[200:203], v[160:161], v[178:179], v[200:203]
    v_mbcnt_lo_u32_b32 v228, -1, 0
    v_mbcnt_hi_u32_b32 v228, -1, v228
    v_mfma_f32_16x16x32_bf16 v[232:235], a[236:239], a[108:111], v[232:235]
    v_lshrrev_b32 v229, 4, v228
    v_bfe_u32 v230, v228, 2, 1
    v_mfma_f32_16x16x32_bf16 v[232:235], a[240:243], a[112:115], v[232:235]
    v_add_u32 v230, 15, v230
    v_and_b32 v230, 15, v230
    v_mfma_f32_16x16x32_bf16 v[232:235], a[244:247], a[116:119], v[232:235]
    s_waitcnt lgkmcnt(0)
    v_bfe_u32 v231, v228, 3, 1
    v_and_b32 v228, 3, v228
    v_mfma_f32_16x16x32_bf16 v[204:207], v[114:117], v[174:177], v[204:207]
    ds_read_b64 v[174:175], v247 offset:0
    v_lshl_add_u32 v228, v231, 2, v228
    v_mfma_f32_16x16x32_bf16 v[236:239], a[224:227], a[120:123], 0
    ds_read_b64 v[176:177], v247 offset:32
    v_cvt_pk_bf16_f32 v54, v232, v233
    v_mfma_f32_16x16x32_bf16 v[236:239], a[228:231], a[124:127], v[236:239]
    v_cvt_pk_bf16_f32 v57, v234, v235
    v_add_u32 v228, 3, v228
    v_mfma_f32_16x16x16_bf16 v[204:207], v[118:119], v[178:179], v[204:207]
    ds_read_b64 v[178:179], v247 offset:64
    v_and_b32 v231, 3, v230
    v_mfma_f32_16x16x32_bf16 v[236:239], a[232:235], a[128:131], v[236:239]
    v_mul_u32_u24 v230, 0x1e00, v230
    v_lshlrev_b32 v231, 1, v231
    v_mfma_f32_16x16x32_bf16 v[236:239], a[236:239], a[132:135], v[236:239]
    v_bfe_u32 v243, v228, 1, 1
    v_or_b32 v231, v231, v243
    v_mfma_f32_16x16x32_bf16 v[236:239], a[240:243], a[136:139], v[236:239]
    v_xor_b32 v231, v231, v229
    v_lshl_add_u32 v230, v231, 4, v230
    v_mfma_f32_16x16x32_bf16 v[236:239], a[244:247], a[140:143], v[236:239]
    v_mul_u32_u24 v231, 0x180, v228
    v_add_u32 v242, v230, v231
    v_xor_b32 v243, 64, v242
    ds_read_b128 a[216:219], v242 offset:0
    ds_read_b128 a[220:223], v243 offset:0
    ds_read_b128 a[224:227], v242 offset:128
    ds_read_b128 a[228:231], v243 offset:128
    ds_read_b128 a[232:235], v242 offset:256
    ds_read_b128 a[236:239], v243 offset:256
    ds_read_b128 a[240:243], v242 offset:3072
    ds_read_b128 a[244:247], v243 offset:3072
    v_cvt_pk_bf16_f32 v84, v236, v237
    v_cvt_pk_bf16_f32 v87, v238, v239
    v_cvt_pk_bf16_f32 v182, v208, v209
    v_cvt_pk_bf16_f32 v185, v210, v211
    ds_read_b128 v[208:211], v244 offset:0
    v_mfma_f32_16x16x32_bf16 v[212:215], v[10:13], v[180:183], v[212:215]
    v_exp_f32 v196, v196
    v_mfma_f32_16x16x32_bf16 v[216:219], v[40:43], v[180:183], v[216:219]
    v_exp_f32 v197, v197
    v_mfma_f32_16x16x32_bf16 v[220:223], v[70:73], v[180:183], v[220:223]
    v_cvt_pk_bf16_f32 v189, v196, v197
    v_mfma_f32_16x16x32_bf16 v[224:227], a[248:251], v[180:183], v[224:227]
    ds_read_b128 v[196:199], v245 offset:0
    v_mfma_f32_16x16x32_bf16 v[212:215], v[14:17], v[184:187], v[212:215]
    s_waitcnt lgkmcnt(8)
    v_exp_f32 v200, v200
    v_mfma_f32_16x16x32_bf16 v[216:219], v[44:47], v[184:187], v[216:219]
    v_exp_f32 v201, v201
    v_mfma_f32_16x16x32_bf16 v[220:223], v[74:77], v[184:187], v[220:223]
    v_cvt_pk_bf16_f32 v190, v200, v201
    v_mfma_f32_16x16x32_bf16 v[224:227], a[248:251], v[184:187], v[224:227]
    ds_read_b128 v[200:203], v246 offset:0
    v_mfma_f32_16x16x32_bf16 v[232:235], a[144:147], a[216:219], 0
    s_waitcnt lgkmcnt(2)
    v_exp_f32 v204, v204
    v_mfma_f32_16x16x32_bf16 v[208:211], v[126:129], v[168:171], v[208:211]
    v_exp_f32 v205, v205
    v_mfma_f32_16x16x32_bf16 v[232:235], a[148:151], a[220:223], v[232:235]
    v_cvt_pk_bf16_f32 v188, v204, v205
    v_mfma_f32_16x16x32_bf16 v[232:235], a[152:155], a[224:227], v[232:235]
    ds_read_b128 v[204:207], v244 offset:64
    s_waitcnt lgkmcnt(2)
    v_mfma_f32_16x16x32_bf16 v[212:215], v[18:21], v[188:191], v[212:215]
    v_mfma_f32_16x16x32_bf16 v[216:219], v[48:51], v[188:191], v[216:219]
    v_mfma_f32_16x16x32_bf16 v[220:223], v[78:81], v[188:191], v[220:223]
    v_mfma_f32_16x16x32_bf16 v[224:227], a[248:251], v[188:191], v[224:227]
    v_mfma_f32_16x16x16_bf16 v[208:211], v[130:131], v[172:173], v[208:211]
    s_waitcnt lgkmcnt(1)
    v_mfma_f32_16x16x32_bf16 v[196:199], v[150:153], v[168:171], v[196:199]
    v_mfma_f32_16x16x32_bf16 v[200:203], v[162:165], v[168:171], v[200:203]
    v_mfma_f32_16x16x32_bf16 v[232:235], a[156:159], a[228:231], v[232:235]
    v_mfma_f32_16x16x32_bf16 v[232:235], a[160:163], a[232:235], v[232:235]
    s_waitcnt lgkmcnt(0)
    v_mfma_f32_16x16x32_bf16 v[204:207], v[132:135], v[168:171], v[204:207]
    v_rcp_f32 v252, v224
    v_mfma_f32_16x16x16_bf16 v[196:199], v[154:155], v[172:173], v[196:199]
    v_max3_f32 v248, v248, v224, v252
    v_mul_f32 v212, v212, v252
    v_mfma_f32_16x16x16_bf16 v[200:203], v[166:167], v[172:173], v[200:203]
    v_mul_f32 v213, v213, v252
    v_mul_f32 v214, v214, v252
    v_mfma_f32_16x16x16_bf16 v[204:207], v[136:137], v[172:173], v[204:207]
    v_mul_f32 v215, v215, v252
    v_cvt_pk_bf16_f32 v212, v212, v213
    v_mfma_f32_16x16x32_bf16 v[232:235], a[164:167], a[236:239], v[232:235]
    v_cvt_pk_bf16_f32 v213, v214, v215
    v_mul_f32 v216, v216, v252
    v_mfma_f32_16x16x32_bf16 v[236:239], a[168:171], a[216:219], 0
    ds_write_b64 v247, v[212:213] offset:13312
    v_mfma_f32_16x16x32_bf16 v[236:239], a[172:175], a[220:223], v[236:239]
    v_mul_f32 v217, v217, v252
    v_mul_f32 v218, v218, v252
    v_mfma_f32_16x16x32_bf16 v[236:239], a[176:179], a[224:227], v[236:239]
    v_mul_f32 v219, v219, v252
    v_cvt_pk_bf16_f32 v216, v216, v217
    v_mfma_f32_16x16x32_bf16 v[236:239], a[180:183], a[228:231], v[236:239]
    v_cvt_pk_bf16_f32 v217, v218, v219
    v_mul_f32 v220, v220, v252
    v_mfma_f32_16x16x32_bf16 v[236:239], a[184:187], a[232:235], v[236:239]
    ds_write_b64 v247, v[216:217] offset:13344
    v_mfma_f32_16x16x32_bf16 v[236:239], a[188:191], a[236:239], v[236:239]
    v_mul_f32 v221, v221, v252
    v_mul_f32 v222, v222, v252
    v_mfma_f32_16x16x32_bf16 v[228:231], a[192:195], a[216:219], 0
    ds_read_b128 a[216:219], v242 offset:3200
    v_mul_f32 v223, v223, v252
    v_mfma_f32_16x16x32_bf16 v[228:231], a[196:199], a[220:223], v[228:231]
    ds_read_b128 a[220:223], v243 offset:3200
    v_cvt_pk_bf16_f32 v220, v220, v221
    v_mfma_f32_16x16x32_bf16 v[228:231], a[200:203], a[224:227], v[228:231]
    ds_read_b128 a[224:227], v242 offset:3328
    v_cvt_pk_bf16_f32 v221, v222, v223
    v_mfma_f32_16x16x32_bf16 v[228:231], a[204:207], a[228:231], v[228:231]
    ds_write_b64 v247, v[220:221] offset:13376
    v_mfma_f32_16x16x32_bf16 v[228:231], a[208:211], a[232:235], v[228:231]
    ds_read_b128 a[228:231], v243 offset:3328
    v_mul_f32 v232, s38, v232
    v_mfma_f32_16x16x32_bf16 v[228:231], a[212:215], a[236:239], v[228:231]
    ds_read_b128 a[232:235], v240 offset:0
    ds_read_b128 a[236:239], v241 offset:0
    v_mul_f32 v233, s38, v233
    v_mul_f32 v234, s38, v234
    v_mul_f32 v235, s38, v235
    v_cvt_pk_bf16_f32 v232, v232, v233
    v_cvt_pk_bf16_f32 v233, v234, v235
    ds_write_b64 v247, v[232:233] offset:53248
    v_mfma_f32_16x16x32_bf16 v[232:235], a[144:147], a[240:243], 0
    buffer_load_dwordx4 a[144:147], v254, s[24:27], s64 offen
    s_mov_b32 s64, 0x4000
    v_mul_f32 v236, s38, v236
    v_mfma_f32_16x16x32_bf16 v[232:235], a[148:151], a[244:247], v[232:235]
    s_waitcnt lgkmcnt(6)
    v_mul_f32 v237, s38, v237
    v_mul_f32 v238, s38, v238
    v_mfma_f32_16x16x32_bf16 v[232:235], a[152:155], a[216:219], v[232:235]
    buffer_load_dwordx4 a[148:151], v254, s[24:27], s65 offen offset:1024
    s_mov_b32 s65, 0x4000
    v_mul_f32 v239, s38, v239
    v_mfma_f32_16x16x32_bf16 v[232:235], a[156:159], a[220:223], v[232:235]
    s_waitcnt lgkmcnt(4)
    v_cvt_pk_bf16_f32 v236, v236, v237
    v_cvt_pk_bf16_f32 v237, v238, v239
    v_mfma_f32_16x16x32_bf16 v[232:235], a[160:163], a[224:227], v[232:235]
    s_waitcnt lgkmcnt(3)
    v_mul_f32 v228, s38, v228
    v_mul_f32 v229, s38, v229
    v_mfma_f32_16x16x32_bf16 v[232:235], a[164:167], a[228:231], v[232:235]
    ds_write_b64 v247, v[236:237] offset:53280
    v_mfma_f32_16x16x32_bf16 v[236:239], a[168:171], a[240:243], 0
    buffer_load_dwordx4 a[152:155], v254, s[24:27], s50 offen offset:2048
    s_mul_i32 s50, s30, 3
    v_mul_f32 v230, s38, v230
    v_mfma_f32_16x16x32_bf16 v[236:239], a[172:175], a[244:247], v[236:239]
    buffer_load_dwordx4 a[156:159], v254, s[24:27], s51 offen offset:3072
    s_mul_i32 s51, s31, 3
    v_mul_f32 v231, s38, v231
    v_mfma_f32_16x16x32_bf16 v[236:239], a[176:179], a[216:219], v[236:239]
    buffer_load_dwordx4 a[160:163], v254, s[24:27], s52 offen
    s_add_u32 s50, s50, s51
    v_cvt_pk_bf16_f32 v228, v228, v229
    v_mfma_f32_16x16x32_bf16 v[236:239], a[180:183], a[220:223], v[236:239]
    buffer_load_dwordx4 a[164:167], v254, s[24:27], s53 offen offset:1024
    s_add_u32 s50, s50, s32
    v_cvt_pk_bf16_f32 v229, v230, v231
    v_mfma_f32_16x16x32_bf16 v[236:239], a[184:187], a[224:227], v[236:239]
    ds_write_b64 v247, v[228:229] offset:53312
    v_mfma_f32_16x16x32_bf16 v[236:239], a[188:191], a[228:231], v[236:239]
    buffer_load_dwordx4 a[168:171], v254, s[24:27], s54 offen offset:2048
    s_add_u32 s50, s50, s39
    v_mul_f32 v232, s38, v232
    v_mfma_f32_16x16x32_bf16 v[228:231], a[192:195], a[240:243], 0
    buffer_load_dwordx4 a[172:175], v254, s[24:27], s55 offen offset:3072
    s_mul_i32 s52, s30, 0
    v_mul_f32 v233, s38, v233
    v_mfma_f32_16x16x32_bf16 v[228:231], a[196:199], a[244:247], v[228:231]
    buffer_load_dwordx4 a[176:179], v254, s[24:27], s56 offen
    s_mul_i32 s53, s31, 4
    v_mul_f32 v234, s38, v234
    v_mfma_f32_16x16x32_bf16 v[228:231], a[200:203], a[216:219], v[228:231]
    ds_read_b128 a[240:243], v240 offset:128
    s_add_u32 s52, s52, s53
    v_mul_f32 v235, s38, v235
    v_mfma_f32_16x16x32_bf16 v[228:231], a[204:207], a[220:223], v[228:231]
    ds_read_b128 a[244:247], v241 offset:128
    s_mul_i32 s54, s30, 0
    v_cvt_pk_bf16_f32 v232, v232, v233
    v_mfma_f32_16x16x32_bf16 v[228:231], a[208:211], a[224:227], v[228:231]
    ds_read_b128 a[216:219], v240 offset:256
    s_mul_i32 s55, s31, 4
    v_cvt_pk_bf16_f32 v233, v234, v235
    v_mfma_f32_16x16x32_bf16 v[228:231], a[212:215], a[228:231], v[228:231]
    ds_write_b64 v247, v[232:233] offset:59904
    s_waitcnt lgkmcnt(5)
    v_mfma_f32_16x16x32_bf16 v[232:235], a[0:3], a[232:235], 0
    ds_read_b128 a[220:223], v241 offset:256
    s_add_u32 s54, s54, s55
    v_mul_f32 v236, s38, v236
    v_mfma_f32_16x16x32_bf16 v[232:235], a[4:7], a[236:239], v[232:235]
    ds_read_b128 a[224:227], v249 offset:0
    ds_read_b128 a[228:231], v249 offset:64
    s_mul_i32 s56, s30, 3
    v_mul_f32 v237, s38, v237
    v_mul_f32 v238, s38, v238
    v_mul_f32 v239, s38, v239
    v_cvt_pk_bf16_f32 v236, v236, v237
    v_cvt_pk_bf16_f32 v237, v238, v239
    ds_write_b64 v247, v[236:237] offset:59936
    v_mfma_f32_16x16x32_bf16 v[236:239], a[24:27], a[232:235], 0
    s_mul_i32 s51, s31, 4
    v_mul_f32 v228, s38, v228
    v_mul_f32 v229, s38, v229
    v_mfma_f32_16x16x32_bf16 v[236:239], a[28:31], a[236:239], v[236:239]
    s_waitcnt lgkmcnt(6)
    v_mul_f32 v230, s38, v230
    v_mul_f32 v231, s38, v231
    v_mfma_f32_16x16x32_bf16 v[232:235], a[8:11], a[240:243], v[232:235]
    s_mul_i32 s53, s31, 4
    v_cvt_pk_bf16_f32 v228, v228, v229
    v_cvt_pk_bf16_f32 v229, v230, v231
    v_mfma_f32_16x16x32_bf16 v[232:235], a[12:15], a[244:247], v[232:235]
    ds_write_b64 v247, v[228:229] offset:59968
    v_mfma_f32_16x16x32_bf16 v[236:239], a[32:35], a[240:243], v[236:239]
    s_mul_i32 s55, s31, 15
    v_exp_f32 v208, v208
    v_mfma_f32_16x16x32_bf16 v[236:239], a[36:39], a[244:247], v[236:239]
    s_waitcnt lgkmcnt(2)
    v_exp_f32 v209, v209
    v_mfma_f32_16x16x32_bf16 v[232:235], a[16:19], a[216:219], v[232:235]
    v_exp_f32 v210, v210
    v_mfma_f32_16x16x32_bf16 v[232:235], a[20:23], a[220:223], v[232:235]
    v_exp_f32 v211, v211
    v_mfma_f32_16x16x32_bf16 v[236:239], a[40:43], a[216:219], v[236:239]
    v_cvt_pk_bf16_f32 v193, v208, v209
    v_cvt_pk_bf16_f32 v180, v210, v211
    v_mfma_f32_16x16x32_bf16 v[236:239], a[44:47], a[220:223], v[236:239]
    ds_read_b128 v[208:211], v245 offset:64
    v_mfma_f32_16x16x32_bf16 v[228:231], a[48:51], a[232:235], 0
    v_exp_f32 v196, v196
    v_mfma_f32_16x16x32_bf16 v[228:231], a[52:55], a[236:239], v[228:231]
    v_cvt_pk_bf16_f32 v126, v232, v233
    v_cvt_pk_bf16_f32 v127, v234, v235
    v_mfma_f32_16x16x32_bf16 v[228:231], a[56:59], a[240:243], v[228:231]
    v_exp_f32 v197, v197
    v_mfma_f32_16x16x32_bf16 v[228:231], a[60:63], a[244:247], v[228:231]
    v_cvt_pk_bf16_f32 v128, v236, v237
    v_cvt_pk_bf16_f32 v129, v238, v239
    v_mfma_f32_16x16x32_bf16 v[228:231], a[64:67], a[216:219], v[228:231]
    v_exp_f32 v198, v198
    v_mfma_f32_16x16x32_bf16 v[228:231], a[68:71], a[220:223], v[228:231]
    v_exp_f32 v199, v199
    v_mfma_f32_16x16x32_bf16 v[232:235], a[232:235], a[72:75], 0
    v_cvt_pk_bf16_f32 v194, v196, v197
    v_cvt_pk_bf16_f32 v181, v198, v199
    v_mfma_f32_16x16x32_bf16 v[232:235], a[236:239], a[76:79], v[232:235]
    ds_read_b128 v[196:199], v246 offset:64
    s_waitcnt lgkmcnt(1)
    v_mfma_f32_16x16x32_bf16 v[208:211], v[156:159], v[168:171], v[208:211]
    v_cvt_pk_bf16_f32 v130, v228, v229
    v_cvt_pk_bf16_f32 v131, v230, v231
    v_mfma_f32_16x16x32_bf16 v[232:235], a[240:243], a[80:83], v[232:235]
    v_exp_f32 v200, v200
    v_mfma_f32_16x16x32_bf16 v[232:235], a[244:247], a[84:87], v[232:235]
    v_exp_f32 v201, v201
    v_mfma_f32_16x16x16_bf16 v[208:211], v[160:161], v[172:173], v[208:211]
    v_exp_f32 v202, v202
    v_mfma_f32_16x16x32_bf16 v[232:235], a[216:219], a[88:91], v[232:235]
    v_exp_f32 v203, v203
    v_mfma_f32_16x16x32_bf16 v[232:235], a[220:223], a[92:95], v[232:235]
    v_cvt_pk_bf16_f32 v192, v200, v201
    v_cvt_pk_bf16_f32 v195, v202, v203
    v_mfma_f32_16x16x32_bf16 v[236:239], a[232:235], a[96:99], 0
    ds_read_b128 v[200:203], v244 offset:128
    v_mfma_f32_16x16x32_bf16 v[212:215], v[12:15], v[192:195], 0
    v_exp_f32 v204, v204
    v_mfma_f32_16x16x32_bf16 v[216:219], v[42:45], v[192:195], 0
    s_waitcnt lgkmcnt(1)
    v_cvt_pk_bf16_f32 v1, v232, v233
    v_cvt_pk_bf16_f32 v4, v234, v235
    v_mfma_f32_16x16x32_bf16 v[220:223], v[72:75], v[192:195], 0
    v_exp_f32 v205, v205
    v_mfma_f32_16x16x32_bf16 v[224:227], a[248:251], v[192:195], 0
    v_exp_f32 v206, v206
    v_mfma_f32_16x16x32_bf16 v[196:199], v[114:117], v[168:171], v[196:199]
    v_exp_f32 v207, v207
    v_mfma_f32_16x16x32_bf16 v[236:239], a[236:239], a[100:103], v[236:239]
    v_cvt_pk_bf16_f32 v183, v204, v205
    v_cvt_pk_bf16_f32 v186, v206, v207
    v_mfma_f32_16x16x32_bf16 v[236:239], a[240:243], a[104:107], v[236:239]
    ds_read_b128 v[204:207], v245 offset:128
    v_mfma_f32_16x16x16_bf16 v[196:199], v[118:119], v[172:173], v[196:199]
    v_exp_f32 v208, v208
    v_mfma_f32_16x16x32_bf16 v[236:239], a[244:247], a[108:111], v[236:239]
    buffer_load_dwordx4 a[180:183], v254, s[24:27], s57 offen offset:1024
    s_mul_i32 s57, s31, 15
    s_add_u32 s56, s56, s57
    v_mfma_f32_16x16x32_bf16 v[236:239], a[216:219], a[112:115], v[236:239]
    s_add_u32 s56, s56, s32
    v_exp_f32 v209, v209
    v_mfma_f32_16x16x32_bf16 v[236:239], a[220:223], a[116:119], v[236:239]
    s_add_u32 s56, s56, s39
    v_exp_f32 v210, v210
    v_mfma_f32_16x16x32_bf16 v[228:231], a[232:235], a[120:123], 0
    ds_read_b128 a[232:235], v249 offset:128
    s_mul_i32 s57, s31, 3
    v_cvt_pk_bf16_f32 v184, v208, v209
    v_mfma_f32_16x16x32_bf16 v[228:231], a[236:239], a[124:127], v[228:231]
    ds_read_b128 a[236:239], v249 offset:192
    s_waitcnt vmcnt(9) lgkmcnt(3)
    v_cvt_pk_bf16_f32 v31, v236, v237
    v_mfma_f32_16x16x32_bf16 v[200:203], v[90:93], v[168:171], v[200:203]
    v_cvt_pk_bf16_f32 v34, v238, v239
    v_mfma_f32_16x16x32_bf16 v[228:231], a[240:243], a[128:131], v[228:231]
    ds_read_b128 a[240:243], v249 offset:256
    s_waitcnt lgkmcnt(3)
    v_mfma_f32_16x16x32_bf16 v[204:207], v[96:99], v[168:171], v[204:207]
    buffer_load_dwordx4 a[184:187], v254, s[24:27], s58 offen offset:2048
    s_mul_i32 s58, s30, 7
    v_mfma_f32_16x16x16_bf16 v[200:203], v[94:95], v[172:173], v[200:203]
    v_exp_f32 v211, v211
    v_mfma_f32_16x16x32_bf16 v[228:231], a[244:247], a[132:135], v[228:231]
    ds_read_b128 a[244:247], v249 offset:320
    v_cvt_pk_bf16_f32 v187, v210, v211
    v_mfma_f32_16x16x16_bf16 v[204:207], v[100:101], v[172:173], v[204:207]
    ds_read_b128 v[208:211], v246 offset:128
    v_mfma_f32_16x16x32_bf16 v[228:231], a[216:219], a[136:139], v[228:231]
    ds_read_b128 a[216:219], v249 offset:6656
    v_mfma_f32_16x16x32_bf16 v[228:231], a[220:223], a[140:143], v[228:231]
    ds_read_b128 a[220:223], v249 offset:6720
    v_mfma_f32_16x16x32_bf16 v[232:235], a[144:147], a[224:227], 0
    s_waitcnt vmcnt(9)
    v_exp_f32 v196, v196
    v_mfma_f32_16x16x32_bf16 v[232:235], a[148:151], a[228:231], v[232:235]
    s_waitcnt vmcnt(8) lgkmcnt(5)
    v_exp_f32 v197, v197
    v_mfma_f32_16x16x32_bf16 v[232:235], a[152:155], a[232:235], v[232:235]
    buffer_load_dwordx4 a[188:191], v254, s[24:27], s59 offen offset:3072
    s_mul_i32 s59, s31, 3
    v_cvt_pk_bf16_f32 v61, v228, v229
    v_cvt_pk_bf16_f32 v64, v230, v231
    s_add_u32 s58, s58, s59
    s_add_u32 s58, s58, s32
    s_add_u32 s58, s58, s39
    s_mul_i32 s59, s31, 11
    v_exp_f32 v198, v198
    v_exp_f32 v199, v199
    v_cvt_pk_bf16_f32 v182, v196, v197
    s_waitcnt lgkmcnt(2)
    v_mfma_f32_16x16x32_bf16 v[208:211], v[120:123], v[168:171], v[208:211]
    ds_read_b64 v[168:169], v247 offset:26624
    v_cvt_pk_bf16_f32 v185, v198, v199
    v_mfma_f32_16x16x32_bf16 v[212:215], v[16:19], v[180:183], v[212:215]
    ds_read_b128 v[196:199], v244 offset:32
    v_mfma_f32_16x16x32_bf16 v[216:219], v[46:49], v[180:183], v[216:219]
    buffer_load_dwordx4 a[192:195], v254, s[24:27], s60 offen
    s_mul_i32 s60, s30, 0
    s_waitcnt vmcnt(9)
    v_mfma_f32_16x16x32_bf16 v[220:223], v[76:79], v[180:183], v[220:223]
    ds_read_b64 v[170:171], v247 offset:26656
    v_mfma_f32_16x16x32_bf16 v[224:227], a[248:251], v[180:183], v[224:227]
    v_exp_f32 v200, v200
    v_mfma_f32_16x16x32_bf16 v[212:215], v[20:23], v[184:187], v[212:215]
    v_exp_f32 v201, v201
    v_mfma_f32_16x16x32_bf16 v[216:219], v[50:53], v[184:187], v[216:219]
    v_cvt_pk_bf16_f32 v189, v200, v201
    v_mfma_f32_16x16x32_bf16 v[220:223], v[80:83], v[184:187], v[220:223]
    ds_read_b128 v[200:203], v245 offset:32
    v_mfma_f32_16x16x32_bf16 v[224:227], a[248:251], v[184:187], v[224:227]
    v_exp_f32 v204, v204
    v_mfma_f32_16x16x16_bf16 v[208:211], v[124:125], v[172:173], v[208:211]
    buffer_load_dwordx4 a[196:199], v254, s[24:27], s61 offen offset:1024
    s_mul_i32 s61, s31, 4
    s_add_u32 s60, s60, s61
    v_mfma_f32_16x16x32_bf16 v[232:235], a[156:159], a[236:239], v[232:235]
    s_waitcnt vmcnt(9) lgkmcnt(2)
    v_exp_f32 v205, v205
    v_mfma_f32_16x16x32_bf16 v[196:199], v[132:135], v[174:177], v[196:199]
    ds_read_b64 v[172:173], v247 offset:26688
    v_cvt_pk_bf16_f32 v190, v204, v205
    v_mfma_f32_16x16x32_bf16 v[232:235], a[160:163], a[240:243], v[232:235]
    ds_read_b128 v[204:207], v246 offset:32
    v_exp_f32 v208, v208
    v_exp_f32 v209, v209
    v_mfma_f32_16x16x16_bf16 v[196:199], v[136:137], v[178:179], v[196:199]
    v_cvt_pk_bf16_f32 v188, v208, v209
    ds_read_b128 v[208:211], v244 offset:96
    s_nop 0
    v_mfma_f32_16x16x32_bf16 v[212:215], v[24:27], v[188:191], v[212:215]
    s_waitcnt lgkmcnt(3)
    buffer_load_dwordx4 a[200:203], v254, s[24:27], s62 offen offset:2048
    v_mfma_f32_16x16x32_bf16 v[216:219], v[54:57], v[188:191], v[216:219]
    s_mul_i32 s62, s30, 0
    v_exp_f32 v196, v196
    v_mfma_f32_16x16x32_bf16 v[220:223], v[84:87], v[188:191], v[220:223]
    s_waitcnt vmcnt(9)
    v_exp_f32 v197, v197
    v_mfma_f32_16x16x32_bf16 v[224:227], a[248:251], v[188:191], v[224:227]
    v_exp_f32 v198, v198
    v_mfma_f32_16x16x32_bf16 v[200:203], v[156:159], v[174:177], v[200:203]
    v_exp_f32 v199, v199
    v_mfma_f32_16x16x32_bf16 v[232:235], a[164:167], a[244:247], v[232:235]
    s_waitcnt lgkmcnt(1)
    v_cvt_pk_bf16_f32 v193, v196, v197
    v_cvt_pk_bf16_f32 v180, v198, v199
    v_mfma_f32_16x16x32_bf16 v[204:207], v[114:117], v[174:177], v[204:207]
    ds_read_b128 v[196:199], v245 offset:96
    v_mfma_f32_16x16x16_bf16 v[200:203], v[160:161], v[178:179], v[200:203]
    s_waitcnt vmcnt(8)
    v_rcp_f32 v252, v224
    v_mfma_f32_16x16x32_bf16 v[236:239], a[168:171], a[224:227], 0
    s_waitcnt lgkmcnt(1)
    v_max3_f32 v248, v248, v224, v252
    v_mul_f32 v212, v212, v252
    v_mfma_f32_16x16x16_bf16 v[204:207], v[118:119], v[178:179], v[204:207]
    buffer_load_dwordx4 a[204:207], v254, s[24:27], s63 offen offset:3072
    s_mul_i32 s63, s31, 4
    v_mul_f32 v213, v213, v252
    v_mfma_f32_16x16x32_bf16 v[208:211], v[90:93], v[174:177], v[208:211]
    s_add_u32 s62, s62, s63
    v_mul_f32 v214, v214, v252
    v_mul_f32 v215, v215, v252
    v_cvt_pk_bf16_f32 v212, v212, v213
    v_cvt_pk_bf16_f32 v213, v214, v215
    ds_write_b64 v247, v[212:213] offset:19968
    v_mfma_f32_16x16x16_bf16 v[208:211], v[94:95], v[178:179], v[208:211]
    v_mul_f32 v216, v216, v252
    v_mul_f32 v217, v217, v252
    v_mul_f32 v218, v218, v252
    v_mul_f32 v219, v219, v252
    buffer_load_dwordx4 a[208:211], v254, s[24:27], s64 offen
    s_waitcnt vmcnt(9) lgkmcnt(1)
    v_mfma_f32_16x16x32_bf16 v[196:199], v[96:99], v[174:177], v[196:199]
    s_mul_i32 s64, s30, 4
    v_cvt_pk_bf16_f32 v216, v216, v217
    v_cvt_pk_bf16_f32 v217, v218, v219
    v_mfma_f32_16x16x32_bf16 v[236:239], a[172:175], a[228:231], v[236:239]
    ds_write_b64 v247, v[216:217] offset:20000
    v_mul_f32 v220, v220, v252
    v_mfma_f32_16x16x16_bf16 v[196:199], v[100:101], v[178:179], v[196:199]
    v_mul_f32 v221, v221, v252
    v_mul_f32 v222, v222, v252
    v_mul_f32 v223, v223, v252
    v_cvt_pk_bf16_f32 v220, v220, v221
    v_cvt_pk_bf16_f32 v221, v222, v223
    ds_write_b64 v247, v[220:221] offset:20032
    v_cvt_pk_bf16_f32 v232, v232, v233
    v_cvt_pk_bf16_f32 v233, v234, v235
    buffer_load_dwordx4 a[212:215], v254, s[24:27], s65 offen offset:1024
    s_waitcnt vmcnt(9)
    v_mfma_f32_16x16x32_bf16 v[236:239], a[176:179], a[232:235], v[236:239]
    s_mul_i32 s65, s31, -8
    v_mbcnt_lo_u32_b32 v254, -1, 0
    v_mbcnt_hi_u32_b32 v254, -1, v254
    v_bfe_u32 v255, v254, 2, 2
    v_mul_i32_i24 v250, s30, v255
    v_and_b32 v255, 3, v254
    v_mad_i32_i24 v250, v255, s31, v250
    v_add_u32 v250, s50, v250
    v_lshrrev_b32 v254, 4, v254
    v_lshl_add_u32 v251, v254, 3, v250
    v_lshl_add_u32 v250, v254, 4, v250
    v_mbcnt_lo_u32_b32 v254, -1, 0
    v_mbcnt_hi_u32_b32 v254, -1, v254
    v_bfe_u32 v255, v254, 2, 2
    s_add_u32 s64, s64, s65
    s_mul_i32 s50, s30, 0
    s_add_u32 s50, s50, s51
    v_exp_f32 v200, v200
    v_exp_f32 v201, v201
    v_exp_f32 v202, v202
    v_exp_f32 v203, v203
    v_cvt_pk_bf16_f32 v194, v200, v201
    v_cvt_pk_bf16_f32 v181, v202, v203
    ds_read_b128 v[200:203], v246 offset:96
    s_waitcnt vmcnt(8)
    v_mfma_f32_16x16x32_bf16 v[236:239], a[180:183], a[236:239], v[236:239]
    v_exp_f32 v204, v204
    v_exp_f32 v205, v205
    v_exp_f32 v206, v206
    v_exp_f32 v207, v207
    v_cvt_pk_bf16_f32 v192, v204, v205
    v_cvt_pk_bf16_f32 v195, v206, v207
    ds_read_b128 v[204:207], v244 offset:192
    v_exp_f32 v208, v208
    v_mfma_f32_16x16x32_bf16 v[212:215], v[18:21], v[192:195], 0
    v_exp_f32 v209, v209
    v_mfma_f32_16x16x32_bf16 v[216:219], v[48:51], v[192:195], 0
    s_waitcnt vmcnt(7)
    v_exp_f32 v210, v210
    v_mfma_f32_16x16x32_bf16 v[220:223], v[78:81], v[192:195], 0
    v_exp_f32 v211, v211
    v_mfma_f32_16x16x32_bf16 v[224:227], a[248:251], v[192:195], 0
    v_cvt_pk_bf16_f32 v183, v208, v209
    v_cvt_pk_bf16_f32 v186, v210, v211
    v_mfma_f32_16x16x32_bf16 v[236:239], a[184:187], a[240:243], v[236:239]
    s_waitcnt lgkmcnt(1)
    v_exp_f32 v196, v196
    v_mfma_f32_16x16x32_bf16 v[200:203], v[120:123], v[174:177], v[200:203]
    ds_read_b128 v[208:211], v245 offset:192
    v_exp_f32 v197, v197
    v_exp_f32 v198, v198
    v_exp_f32 v199, v199
    s_waitcnt lgkmcnt(1)
    v_mfma_f32_16x16x32_bf16 v[204:207], v[138:141], v[168:171], v[204:207]
    v_cvt_pk_bf16_f32 v184, v196, v197
    v_cvt_pk_bf16_f32 v187, v198, v199
    v_mfma_f32_16x16x16_bf16 v[200:203], v[124:125], v[178:179], v[200:203]
    s_waitcnt vmcnt(6)
    ds_read_b128 v[196:199], v246 offset:192
    v_mfma_f32_16x16x32_bf16 v[236:239], a[188:191], a[244:247], v[236:239]
    v_mfma_f32_16x16x16_bf16 v[204:207], v[142:143], v[172:173], v[204:207]
    s_nop 3
    v_exp_f32 v200, v200
    v_exp_f32 v201, v201
    v_exp_f32 v202, v202
    v_cvt_pk_bf16_f32 v234, v236, v237
    v_cvt_pk_bf16_f32 v235, v238, v239
    v_mfma_f32_16x16x32_bf16 v[236:239], a[168:171], a[216:219], 0
    buffer_store_dwordx4 v[232:235], v250, s[20:23], 0 offen
    v_mfma_f32_16x16x32_bf16 v[236:239], a[172:175], a[220:223], v[236:239]
    s_waitcnt vmcnt(6) lgkmcnt(1)
    v_add_u32 v250, s52, v250
    v_cvt_pk_bf16_f32 v182, v200, v201
    v_mfma_f32_16x16x32_bf16 v[208:211], v[102:105], v[168:171], v[208:211]
    v_exp_f32 v203, v203
    v_mfma_f32_16x16x32_bf16 v[212:215], v[22:25], v[180:183], v[212:215]
    s_waitcnt lgkmcnt(0)
    v_cvt_pk_bf16_f32 v185, v202, v203
    v_mfma_f32_16x16x32_bf16 v[216:219], v[52:55], v[180:183], v[216:219]
    ds_read_b128 v[200:203], v244 offset:256
    v_mfma_f32_16x16x32_bf16 v[220:223], v[82:85], v[180:183], v[220:223]
    v_exp_f32 v204, v204
    v_mfma_f32_16x16x32_bf16 v[224:227], a[248:251], v[180:183], v[224:227]
    v_exp_f32 v205, v205
    v_mfma_f32_16x16x32_bf16 v[212:215], v[26:29], v[184:187], v[212:215]
    v_exp_f32 v206, v206
    v_mfma_f32_16x16x32_bf16 v[216:219], v[56:59], v[184:187], v[216:219]
    v_exp_f32 v207, v207
    v_mfma_f32_16x16x32_bf16 v[220:223], v[86:89], v[184:187], v[220:223]
    v_cvt_pk_bf16_f32 v190, v204, v205
    v_cvt_pk_bf16_f32 v193, v206, v207
    v_mfma_f32_16x16x32_bf16 v[224:227], a[248:251], v[184:187], v[224:227]
    ds_read_b128 v[204:207], v245 offset:256
    v_mov_b32 v187, 0
    v_mfma_f32_16x16x16_bf16 v[208:211], v[106:107], v[172:173], v[208:211]
    v_mfma_f32_16x16x32_bf16 v[196:199], v[126:129], v[168:171], v[196:199]
    v_mfma_f32_16x16x32_bf16 v[228:231], a[192:195], a[224:227], 0
    ds_read_b128 a[224:227], v249 offset:6784
    s_waitcnt vmcnt(5) lgkmcnt(2)
    v_mfma_f32_16x16x32_bf16 v[200:203], v[144:147], v[168:171], v[200:203]
    v_rcp_f32 v252, v224
    v_mfma_f32_16x16x32_bf16 v[228:231], a[196:199], a[228:231], v[228:231]
    ds_read_b128 a[228:231], v249 offset:6848
    s_waitcnt vmcnt(4)
    v_max3_f32 v248, v248, v224, v252
    v_mfma_f32_16x16x16_bf16 v[196:199], v[130:131], v[172:173], v[196:199]
    v_mul_f32 v212, v212, v252
    v_mul_f32 v213, v213, v252
    v_mfma_f32_16x16x16_bf16 v[200:203], v[148:149], v[172:173], v[200:203]
    v_mul_f32 v214, v214, v252
    v_mul_f32 v215, v215, v252
    v_mfma_f32_16x16x32_bf16 v[228:231], a[200:203], a[232:235], v[228:231]
    ds_read_b128 a[232:235], v249 offset:6912
    s_waitcnt lgkmcnt(3)
    v_cvt_pk_bf16_f32 v212, v212, v213
    v_mfma_f32_16x16x32_bf16 v[204:207], v[108:111], v[168:171], v[204:207]
    v_cvt_pk_bf16_f32 v213, v214, v215
    v_mul_f32 v216, v216, v252
    v_mfma_f32_16x16x32_bf16 v[232:235], a[144:147], a[216:219], 0
    ds_write_b64 v253, v[212:213] offset:0
    v_mfma_f32_16x16x32_bf16 v[232:235], a[148:151], a[220:223], v[232:235]
    s_waitcnt vmcnt(3) lgkmcnt(3)
    v_mul_f32 v217, v217, v252
    v_mul_f32 v218, v218, v252
    v_mfma_f32_16x16x16_bf16 v[204:207], v[112:113], v[172:173], v[204:207]
    v_mul_f32 v219, v219, v252
    v_cvt_pk_bf16_f32 v216, v216, v217
    v_mfma_f32_16x16x32_bf16 v[228:231], a[204:207], a[236:239], v[228:231]
    ds_read_b128 a[236:239], v249 offset:6976
    v_cvt_pk_bf16_f32 v217, v218, v219
    v_mfma_f32_16x16x32_bf16 v[232:235], a[152:155], a[224:227], v[232:235]
    ds_write_b64 v253, v[216:217] offset:32
    v_mfma_f32_16x16x32_bf16 v[236:239], a[176:179], a[224:227], v[236:239]
    s_waitcnt lgkmcnt(4)
    v_mul_f32 v220, v220, v252
    v_mul_f32 v221, v221, v252
    v_mfma_f32_16x16x32_bf16 v[232:235], a[156:159], a[228:231], v[232:235]
    s_waitcnt lgkmcnt(3)
    v_mul_f32 v222, v222, v252
    v_mul_f32 v223, v223, v252
    v_mfma_f32_16x16x32_bf16 v[232:235], a[160:163], a[232:235], v[232:235]
    v_cvt_pk_bf16_f32 v220, v220, v221
    v_cvt_pk_bf16_f32 v221, v222, v223
    v_mfma_f32_16x16x32_bf16 v[236:239], a[180:183], a[228:231], v[236:239]
    ds_write_b64 v253, v[220:221] offset:64
    v_mfma_f32_16x16x32_bf16 v[236:239], a[184:187], a[232:235], v[236:239]
    s_waitcnt vmcnt(2)
    v_exp_f32 v208, v208
    v_mfma_f32_16x16x32_bf16 v[228:231], a[208:211], a[240:243], v[228:231]
    ds_read_b128 a[240:243], v240 offset:1536
    v_exp_f32 v209, v209
    s_waitcnt lgkmcnt(3)
    v_mfma_f32_16x16x32_bf16 v[232:235], a[164:167], a[236:239], v[232:235]
    v_exp_f32 v210, v210
    v_mfma_f32_16x16x32_bf16 v[236:239], a[188:191], a[236:239], v[236:239]
    v_exp_f32 v211, v211
    v_cvt_pk_bf16_f32 v188, v208, v209
    v_cvt_pk_bf16_f32 v191, v210, v211
    ds_read_b128 v[208:211], v246 offset:256
    s_waitcnt vmcnt(1)
    v_mfma_f32_16x16x32_bf16 v[228:231], a[212:215], a[244:247], v[228:231]
    ds_read_b128 a[244:247], v241 offset:1536
    v_cvt_pk_bf16_f32 v232, v232, v233
    v_cvt_pk_bf16_f32 v233, v234, v235
    v_cvt_pk_bf16_f32 v234, v236, v237
    v_cvt_pk_bf16_f32 v235, v238, v239
    buffer_store_dwordx4 v[232:235], v250, s[20:23], 0 offen
    s_waitcnt lgkmcnt(3)
    s_barrier
    v_cvt_pk_bf16_f32 v228, v228, v229
    v_cvt_pk_bf16_f32 v229, v230, v231
    buffer_store_dwordx2 v[228:229], v251, s[20:23], 0 offen offset:64
    v_mfma_f32_16x16x32_bf16 v[228:231], a[192:195], a[216:219], 0
    ds_read_b128 a[216:219], v240 offset:1664
    s_waitcnt lgkmcnt(3)
    v_add_u32 v251, s52, v251
    v_mfma_f32_16x16x32_bf16 v[228:231], a[196:199], a[220:223], v[228:231]
    ds_read_b128 a[220:223], v241 offset:1664
    s_mul_i32 s52, s30, 0
    v_add_u32 v250, s54, v250
    v_mfma_f32_16x16x32_bf16 v[228:231], a[200:203], a[224:227], v[228:231]
    ds_read_b128 a[224:227], v240 offset:1792
    s_add_u32 s52, s52, s53
    v_mfma_f32_16x16x32_bf16 v[228:231], a[204:207], a[228:231], v[228:231]
    ds_read_b128 a[228:231], v241 offset:1792
    v_mfma_f32_16x16x32_bf16 v[228:231], a[208:211], a[232:235], v[228:231]
    ds_read_b128 a[232:235], v240 offset:3072
    v_mfma_f32_16x16x32_bf16 v[228:231], a[212:215], a[236:239], v[228:231]
    ds_read_b128 a[236:239], v241 offset:3072
    v_mfma_f32_16x16x32_bf16 v[232:235], a[0:3], a[240:243], 0
    ds_read_b64 v[174:175], v247 offset:33280
    s_waitcnt lgkmcnt(7)
    v_mfma_f32_16x16x32_bf16 v[232:235], a[4:7], a[244:247], v[232:235]
    ds_read_b64 v[176:177], v247 offset:33312
    v_mfma_f32_16x16x32_bf16 v[236:239], a[24:27], a[240:243], 0
    ds_read_b64 v[178:179], v247 offset:33344
    s_waitcnt lgkmcnt(8)
    v_cvt_pk_bf16_f32 v228, v228, v229
    v_mfma_f32_16x16x32_bf16 v[232:235], a[8:11], a[216:219], v[232:235]
    v_cvt_pk_bf16_f32 v229, v230, v231
    s_waitcnt lgkmcnt(7)
    v_mfma_f32_16x16x32_bf16 v[232:235], a[12:15], a[220:223], v[232:235]
    buffer_store_dwordx2 v[228:229], v251, s[20:23], 0 offen offset:64
    v_mfma_f32_16x16x32_bf16 v[236:239], a[28:31], a[244:247], v[236:239]
    s_waitcnt lgkmcnt(6)
    v_add_u32 v251, s54, v251
    s_mul_i32 s54, s30, 11
    v_mfma_f32_16x16x32_bf16 v[232:235], a[16:19], a[224:227], v[232:235]
    s_add_u32 s54, s54, s55
    v_exp_f32 v196, v196
    v_mfma_f32_16x16x32_bf16 v[236:239], a[32:35], a[216:219], v[236:239]
    s_add_u32 s54, s54, s32
    v_exp_f32 v197, v197
    v_mfma_f32_16x16x32_bf16 v[236:239], a[36:39], a[220:223], v[236:239]
    s_add_u32 s54, s54, s39
    v_exp_f32 v198, v198
    v_mfma_f32_16x16x32_bf16 v[236:239], a[40:43], a[224:227], v[236:239]
    s_waitcnt lgkmcnt(2)
    v_exp_f32 v199, v199
    v_mfma_f32_16x16x32_bf16 v[232:235], a[20:23], a[228:231], v[232:235]
    v_cvt_pk_bf16_f32 v189, v196, v197
    v_cvt_pk_bf16_f32 v192, v198, v199
    v_mfma_f32_16x16x32_bf16 v[236:239], a[44:47], a[228:231], v[236:239]
    ds_read_b128 v[196:199], v244 offset:320
    v_mfma_f32_16x16x32_bf16 v[212:215], v[0:3], v[188:191], 0
    v_exp_f32 v200, v200
    v_mfma_f32_16x16x32_bf16 v[216:219], v[30:33], v[188:191], 0
    v_exp_f32 v201, v201
    v_mfma_f32_16x16x32_bf16 v[220:223], v[60:63], v[188:191], 0
    v_cvt_pk_bf16_f32 v132, v232, v233
    v_cvt_pk_bf16_f32 v133, v234, v235
    v_mfma_f32_16x16x32_bf16 v[224:227], a[248:251], v[188:191], 0
    v_cvt_pk_bf16_f32 v134, v236, v237
    v_cvt_pk_bf16_f32 v135, v238, v239
    v_mfma_f32_16x16x32_bf16 v[228:231], a[48:51], a[240:243], 0
    v_exp_f32 v202, v202
    v_mfma_f32_16x16x32_bf16 v[208:211], v[132:135], v[168:171], v[208:211]
    v_exp_f32 v203, v203
    v_mfma_f32_16x16x32_bf16 v[228:231], a[52:55], a[244:247], v[228:231]
    v_cvt_pk_bf16_f32 v180, v200, v201
    v_cvt_pk_bf16_f32 v183, v202, v203
    v_mfma_f32_16x16x32_bf16 v[228:231], a[56:59], a[216:219], v[228:231]
    ds_read_b128 v[200:203], v245 offset:320
    s_waitcnt lgkmcnt(1)
    v_mfma_f32_16x16x32_bf16 v[196:199], v[150:153], v[168:171], v[196:199]
    v_exp_f32 v204, v204
    v_mfma_f32_16x16x32_bf16 v[228:231], a[60:63], a[220:223], v[228:231]
    v_exp_f32 v205, v205
    v_mfma_f32_16x16x32_bf16 v[228:231], a[64:67], a[224:227], v[228:231]
    v_exp_f32 v206, v206
    v_mfma_f32_16x16x32_bf16 v[228:231], a[68:71], a[228:231], v[228:231]
    v_exp_f32 v207, v207
    v_mfma_f32_16x16x16_bf16 v[196:199], v[154:155], v[172:173], v[196:199]
    v_cvt_pk_bf16_f32 v194, v204, v205
    v_cvt_pk_bf16_f32 v181, v206, v207
    v_mfma_f32_16x16x32_bf16 v[232:235], a[240:243], a[72:75], 0
    ds_read_b128 v[204:207], v246 offset:320
    v_mfma_f32_16x16x32_bf16 v[232:235], a[244:247], a[76:79], v[232:235]
    v_mfma_f32_16x16x32_bf16 v[232:235], a[216:219], a[80:83], v[232:235]
    v_cvt_pk_bf16_f32 v136, v228, v229
    v_cvt_pk_bf16_f32 v137, v230, v231
    v_mfma_f32_16x16x32_bf16 v[232:235], a[220:223], a[84:87], v[232:235]
    s_waitcnt lgkmcnt(1)
    v_exp_f32 v196, v196
    v_mfma_f32_16x16x16_bf16 v[208:211], v[136:137], v[172:173], v[208:211]
    v_exp_f32 v197, v197
    v_mfma_f32_16x16x32_bf16 v[200:203], v[162:165], v[168:171], v[200:203]
    v_cvt_pk_bf16_f32 v186, v196, v197
    v_mfma_f32_16x16x32_bf16 v[232:235], a[224:227], a[88:91], v[232:235]
    ds_read_b128 v[196:199], v245 offset:0
    v_mfma_f32_16x16x32_bf16 v[232:235], a[228:231], a[92:95], v[232:235]
    v_mfma_f32_16x16x32_bf16 v[236:239], a[240:243], a[96:99], 0
    v_mfma_f32_16x16x32_bf16 v[236:239], a[244:247], a[100:103], v[236:239]
    v_exp_f32 v208, v208
    v_mfma_f32_16x16x16_bf16 v[200:203], v[166:167], v[172:173], v[200:203]
    v_exp_f32 v209, v209
    v_mfma_f32_16x16x32_bf16 v[236:239], a[216:219], a[104:107], v[236:239]
    v_exp_f32 v210, v210
    v_mfma_f32_16x16x32_bf16 v[236:239], a[220:223], a[108:111], v[236:239]
    v_cvt_pk_bf16_f32 v7, v232, v233
    v_cvt_pk_bf16_f32 v10, v234, v235
    v_mfma_f32_16x16x32_bf16 v[236:239], a[224:227], a[112:115], v[236:239]
    v_exp_f32 v211, v211
    v_mfma_f32_16x16x32_bf16 v[236:239], a[228:231], a[116:119], v[236:239]
    v_cvt_pk_bf16_f32 v195, v208, v209
    v_cvt_pk_bf16_f32 v182, v210, v211
    v_mfma_f32_16x16x32_bf16 v[228:231], a[240:243], a[120:123], 0
    ds_read_b128 a[240:243], v240 offset:3200
    s_waitcnt lgkmcnt(1)
    v_mfma_f32_16x16x32_bf16 v[212:215], v[4:7], v[192:195], v[212:215]
    ds_read_b128 v[208:211], v244 offset:0
    v_mfma_f32_16x16x32_bf16 v[224:227], a[248:251], v[192:195], v[224:227]
    v_cvt_pk_bf16_f32 v37, v236, v237
    v_cvt_pk_bf16_f32 v40, v238, v239
    v_mfma_f32_16x16x32_bf16 v[212:215], v[8:11], v[180:183], v[212:215]
    v_exp_f32 v200, v200
    v_mfma_f32_16x16x32_bf16 v[216:219], v[34:37], v[192:195], v[216:219]
    v_exp_f32 v201, v201
    v_mfma_f32_16x16x32_bf16 v[216:219], v[38:41], v[180:183], v[216:219]
    v_cvt_pk_bf16_f32 v184, v200, v201
    v_mfma_f32_16x16x32_bf16 v[224:227], a[248:251], v[180:183], v[224:227]
    ds_read_b128 v[200:203], v246 offset:0
    v_mfma_f32_16x16x32_bf16 v[196:199], v[108:111], v[174:177], v[196:199]
    v_mfma_f32_16x16x32_bf16 v[228:231], a[244:247], a[124:127], v[228:231]
    ds_read_b128 a[244:247], v241 offset:3200
    v_mfma_f32_16x16x32_bf16 v[228:231], a[216:219], a[128:131], v[228:231]
    ds_read_b128 a[216:219], v240 offset:3328
    s_waitcnt lgkmcnt(3)
    v_mfma_f32_16x16x32_bf16 v[208:211], v[144:147], v[174:177], v[208:211]
    v_mfma_f32_16x16x16_bf16 v[196:199], v[112:113], v[178:179], v[196:199]
    v_mfma_f32_16x16x32_bf16 v[228:231], a[220:223], a[132:135], v[228:231]
    ds_read_b128 a[220:223], v241 offset:3328
    v_mfma_f32_16x16x32_bf16 v[228:231], a[224:227], a[136:139], v[228:231]
    ds_read_b128 a[224:227], v249 offset:13312
    v_mfma_f32_16x16x32_bf16 v[228:231], a[228:231], a[140:143], v[228:231]
    ds_read_b128 a[228:231], v249 offset:13376
    s_waitcnt lgkmcnt(5)
    v_mfma_f32_16x16x16_bf16 v[208:211], v[148:149], v[178:179], v[208:211]
    v_exp_f32 v196, v196
    v_mfma_f32_16x16x32_bf16 v[200:203], v[132:135], v[174:177], v[200:203]
    v_exp_f32 v197, v197
    v_mfma_f32_16x16x32_bf16 v[232:235], a[0:3], a[232:235], 0
    v_exp_f32 v198, v198
    v_mfma_f32_16x16x32_bf16 v[232:235], a[4:7], a[236:239], v[232:235]
    v_cvt_pk_bf16_f32 v67, v228, v229
    v_cvt_pk_bf16_f32 v70, v230, v231
    v_mfma_f32_16x16x16_bf16 v[200:203], v[136:137], v[178:179], v[200:203]
    v_exp_f32 v208, v208
    v_mfma_f32_16x16x32_bf16 v[220:223], v[64:67], v[192:195], v[220:223]
    v_exp_f32 v209, v209
    v_mfma_f32_16x16x32_bf16 v[220:223], v[68:71], v[180:183], v[220:223]
    v_exp_f32 v210, v210
    v_mfma_f32_16x16x32_bf16 v[232:235], a[8:11], a[240:243], v[232:235]
    s_waitcnt lgkmcnt(1)
    v_exp_f32 v211, v211
    v_mfma_f32_16x16x32_bf16 v[232:235], a[12:15], a[244:247], v[232:235]
    v_cvt_pk_bf16_f32 v190, v208, v209
    v_cvt_pk_bf16_f32 v193, v210, v211
    v_mfma_f32_16x16x32_bf16 v[232:235], a[16:19], a[216:219], v[232:235]
    ds_read_b128 v[208:211], v245 offset:64
    v_cvt_pk_bf16_f32 v188, v196, v197
    v_mfma_f32_16x16x32_bf16 v[232:235], a[20:23], a[220:223], v[232:235]
    v_exp_f32 v199, v199
    v_mfma_f32_16x16x32_bf16 v[236:239], a[24:27], a[232:235], 0
    v_cvt_pk_bf16_f32 v191, v198, v199
    v_mfma_f32_16x16x32_bf16 v[236:239], a[28:31], a[236:239], v[236:239]
    ds_read_b128 v[196:199], v246 offset:64
    v_mfma_f32_16x16x32_bf16 v[236:239], a[32:35], a[240:243], v[236:239]
    v_exp_f32 v200, v200
    v_mfma_f32_16x16x32_bf16 v[236:239], a[36:39], a[244:247], v[236:239]
    v_cvt_pk_bf16_f32 v90, v232, v233
    v_cvt_pk_bf16_f32 v91, v234, v235
    v_mfma_f32_16x16x32_bf16 v[236:239], a[40:43], a[216:219], v[236:239]
    v_exp_f32 v201, v201
    v_mfma_f32_16x16x32_bf16 v[236:239], a[44:47], a[220:223], v[236:239]
    v_exp_f32 v202, v202
    v_mfma_f32_16x16x32_bf16 v[228:231], a[48:51], a[232:235], 0
    v_exp_f32 v203, v203
    v_mfma_f32_16x16x32_bf16 v[228:231], a[52:55], a[236:239], v[228:231]
    s_waitcnt lgkmcnt(1)
    v_cvt_pk_bf16_f32 v189, v200, v201
    v_cvt_pk_bf16_f32 v192, v202, v203
    v_mfma_f32_16x16x32_bf16 v[208:211], v[162:165], v[174:177], v[208:211]
    ds_read_b128 v[200:203], v244 offset:128
    v_cvt_pk_bf16_f32 v92, v236, v237
    v_mfma_f32_16x16x32_bf16 v[228:231], a[56:59], a[240:243], v[228:231]
    v_cvt_pk_bf16_f32 v93, v238, v239
    s_waitcnt lgkmcnt(1)
    v_mfma_f32_16x16x32_bf16 v[228:231], a[60:63], a[244:247], v[228:231]
    v_mfma_f32_16x16x32_bf16 v[204:207], v[90:93], v[168:171], v[204:207]
    ds_read_b64 v[168:169], v247 offset:39936
    v_mfma_f32_16x16x16_bf16 v[208:211], v[166:167], v[178:179], v[208:211]
    ds_read_b64 v[170:171], v247 offset:39968
    v_mfma_f32_16x16x32_bf16 v[196:199], v[90:93], v[174:177], v[196:199]
    v_mfma_f32_16x16x32_bf16 v[228:231], a[64:67], a[216:219], v[228:231]
    v_mfma_f32_16x16x32_bf16 v[228:231], a[68:71], a[220:223], v[228:231]
    v_mfma_f32_16x16x32_bf16 v[232:235], a[232:235], a[72:75], 0
    v_mfma_f32_16x16x32_bf16 v[232:235], a[236:239], a[76:79], v[232:235]
    s_waitcnt lgkmcnt(2)
    v_mfma_f32_16x16x32_bf16 v[200:203], v[156:159], v[174:177], v[200:203]
    v_exp_f32 v208, v208
    v_mfma_f32_16x16x32_bf16 v[232:235], a[240:243], a[80:83], v[232:235]
    v_exp_f32 v209, v209
    v_mfma_f32_16x16x32_bf16 v[232:235], a[244:247], a[84:87], v[232:235]
    v_cvt_pk_bf16_f32 v94, v228, v229
    v_cvt_pk_bf16_f32 v95, v230, v231
    v_mfma_f32_16x16x16_bf16 v[200:203], v[160:161], v[178:179], v[200:203]
    v_exp_f32 v210, v210
    v_mfma_f32_16x16x16_bf16 v[204:207], v[94:95], v[172:173], v[204:207]
    ds_read_b64 v[172:173], v247 offset:40000
    v_cvt_pk_bf16_f32 v194, v208, v209
    v_mfma_f32_16x16x16_bf16 v[196:199], v[94:95], v[178:179], v[196:199]
    v_exp_f32 v211, v211
    v_mfma_f32_16x16x32_bf16 v[232:235], a[216:219], a[88:91], v[232:235]
    v_cvt_pk_bf16_f32 v181, v210, v211
    v_mfma_f32_16x16x32_bf16 v[232:235], a[220:223], a[92:95], v[232:235]
    ds_read_b128 v[208:211], v246 offset:128
    v_mfma_f32_16x16x32_bf16 v[236:239], a[232:235], a[96:99], 0
    v_exp_f32 v204, v204
    v_mfma_f32_16x16x32_bf16 v[236:239], a[236:239], a[100:103], v[236:239]
    v_exp_f32 v205, v205
    v_mfma_f32_16x16x32_bf16 v[236:239], a[240:243], a[104:107], v[236:239]
    v_cvt_pk_bf16_f32 v185, v204, v205
    v_mfma_f32_16x16x32_bf16 v[236:239], a[244:247], a[108:111], v[236:239]
    ds_read_b128 v[204:207], v244 offset:64
    v_cvt_pk_bf16_f32 v13, v232, v233
    v_mfma_f32_16x16x32_bf16 v[224:227], a[248:251], v[184:187], v[224:227]
    v_cvt_pk_bf16_f32 v16, v234, v235
    v_mfma_f32_16x16x32_bf16 v[212:215], v[12:15], v[184:187], v[212:215]
    v_exp_f32 v196, v196
    v_mfma_f32_16x16x32_bf16 v[236:239], a[216:219], a[112:115], v[236:239]
    v_exp_f32 v197, v197
    v_mfma_f32_16x16x32_bf16 v[236:239], a[220:223], a[116:119], v[236:239]
    v_exp_f32 v198, v198
    v_mfma_f32_16x16x32_bf16 v[228:231], a[232:235], a[120:123], 0
    ds_read_b128 a[232:235], v249 offset:13440
    v_cvt_pk_bf16_f32 v195, v196, v197
    v_mfma_f32_16x16x32_bf16 v[228:231], a[236:239], a[124:127], v[228:231]
    ds_read_b128 a[236:239], v249 offset:13504
    v_mfma_f32_16x16x32_bf16 v[228:231], a[240:243], a[128:131], v[228:231]
    ds_read_b128 a[240:243], v249 offset:13568
    v_cvt_pk_bf16_f32 v43, v236, v237
    v_mfma_f32_16x16x32_bf16 v[228:231], a[244:247], a[132:135], v[228:231]
    ds_read_b128 a[244:247], v249 offset:13632
    s_waitcnt lgkmcnt(4)
    v_cvt_pk_bf16_f32 v46, v238, v239
    v_mfma_f32_16x16x32_bf16 v[216:219], v[42:45], v[184:187], v[216:219]
    v_rcp_f32 v252, v224
    v_mfma_f32_16x16x32_bf16 v[204:207], v[150:153], v[174:177], v[204:207]
    v_max3_f32 v248, v248, v224, v252
    v_mul_f32 v212, v212, v252
    v_mfma_f32_16x16x32_bf16 v[224:227], a[248:251], v[188:191], 0
    v_mul_f32 v213, v213, v252
    v_mul_f32 v214, v214, v252
    v_mfma_f32_16x16x32_bf16 v[224:227], a[248:251], v[192:195], v[224:227]
    v_mul_f32 v215, v215, v252
    v_cvt_pk_bf16_f32 v212, v212, v213
    v_mfma_f32_16x16x16_bf16 v[204:207], v[154:155], v[178:179], v[204:207]
    v_cvt_pk_bf16_f32 v213, v214, v215
    v_mul_f32 v216, v216, v252
    v_mfma_f32_16x16x32_bf16 v[228:231], a[216:219], a[136:139], v[228:231]
    ds_write_b64 v247, v[212:213] offset:26624
    v_mfma_f32_16x16x32_bf16 v[212:215], v[6:9], v[188:191], 0
    ds_read_b128 a[216:219], v240 offset:4608
    v_mul_f32 v217, v217, v252
    v_mfma_f32_16x16x32_bf16 v[212:215], v[10:13], v[192:195], v[212:215]
    v_mul_f32 v218, v218, v252
    v_mul_f32 v219, v219, v252
    v_mfma_f32_16x16x32_bf16 v[228:231], a[220:223], a[140:143], v[228:231]
    ds_read_b128 a[220:223], v241 offset:4608
    v_cvt_pk_bf16_f32 v216, v216, v217
    v_mfma_f32_16x16x32_bf16 v[232:235], a[144:147], a[224:227], 0
    v_cvt_pk_bf16_f32 v217, v218, v219
    v_add_u32 v249, 0xfffe9800, v249
    v_mfma_f32_16x16x32_bf16 v[232:235], a[148:151], a[228:231], v[232:235]
    ds_write_b64 v247, v[216:217] offset:26656
    v_mfma_f32_16x16x32_bf16 v[216:219], v[36:39], v[188:191], 0
    s_waitcnt lgkmcnt(4)
    v_cvt_pk_bf16_f32 v73, v228, v229
    v_cvt_pk_bf16_f32 v76, v230, v231
    v_mfma_f32_16x16x32_bf16 v[216:219], v[40:43], v[192:195], v[216:219]
    v_exp_f32 v204, v204
    v_mfma_f32_16x16x32_bf16 v[220:223], v[72:75], v[184:187], v[220:223]
    v_exp_f32 v205, v205
    v_mfma_f32_16x16x32_bf16 v[232:235], a[152:155], a[232:235], v[232:235]
    v_exp_f32 v206, v206
    v_mfma_f32_16x16x32_bf16 v[232:235], a[156:159], a[236:239], v[232:235]
    v_exp_f32 v207, v207
    v_mfma_f32_16x16x32_bf16 v[232:235], a[160:163], a[240:243], v[232:235]
    v_cvt_pk_bf16_f32 v180, v204, v205
    v_cvt_pk_bf16_f32 v183, v206, v207
    v_mfma_f32_16x16x32_bf16 v[232:235], a[164:167], a[244:247], v[232:235]
    ds_read_b128 v[204:207], v245 offset:128
    v_mul_f32 v220, v220, v252
    v_mfma_f32_16x16x32_bf16 v[236:239], a[168:171], a[224:227], 0
    v_mul_f32 v221, v221, v252
    v_mul_f32 v222, v222, v252
    v_mfma_f32_16x16x32_bf16 v[236:239], a[172:175], a[228:231], v[236:239]
    v_mul_f32 v223, v223, v252
    v_cvt_pk_bf16_f32 v220, v220, v221
    v_mfma_f32_16x16x32_bf16 v[236:239], a[176:179], a[232:235], v[236:239]
    v_cvt_pk_bf16_f32 v232, v232, v233
    v_cvt_pk_bf16_f32 v233, v234, v235
    v_mfma_f32_16x16x32_bf16 v[236:239], a[180:183], a[236:239], v[236:239]
    v_cvt_pk_bf16_f32 v221, v222, v223
    v_mfma_f32_16x16x32_bf16 v[236:239], a[184:187], a[240:243], v[236:239]
    ds_write_b64 v247, v[220:221] offset:26688
    v_mfma_f32_16x16x32_bf16 v[220:223], v[66:69], v[188:191], 0
    v_exp_f32 v199, v199
    v_mfma_f32_16x16x32_bf16 v[220:223], v[70:73], v[192:195], v[220:223]
    v_cvt_pk_bf16_f32 v182, v198, v199
    v_mfma_f32_16x16x32_bf16 v[236:239], a[188:191], a[244:247], v[236:239]
    ds_read_b128 v[196:199], v244 offset:0
    s_waitcnt lgkmcnt(2)
    v_mfma_f32_16x16x32_bf16 v[212:215], v[14:17], v[180:183], v[212:215]
    v_exp_f32 v200, v200
    v_mfma_f32_16x16x32_bf16 v[216:219], v[44:47], v[180:183], v[216:219]
    v_exp_f32 v201, v201
    v_mfma_f32_16x16x32_bf16 v[220:223], v[74:77], v[180:183], v[220:223]
    v_cvt_pk_bf16_f32 v186, v200, v201
    v_cvt_pk_bf16_f32 v234, v236, v237
    v_mfma_f32_16x16x32_bf16 v[224:227], a[248:251], v[180:183], v[224:227]
    ds_read_b128 v[200:203], v245 offset:0
    v_cvt_pk_bf16_f32 v235, v238, v239
    v_mfma_f32_16x16x32_bf16 v[204:207], v[114:117], v[174:177], v[204:207]
    buffer_store_dwordx4 v[232:235], v250, s[20:23], 0 offen
    v_mfma_f32_16x16x32_bf16 v[228:231], a[192:195], a[224:227], 0
    ds_read_b128 a[224:227], v240 offset:4736
    v_lshlrev_b32 v250, 1, v254
    v_mfma_f32_16x16x32_bf16 v[228:231], a[196:199], a[228:231], v[228:231]
    ds_read_b128 a[228:231], v241 offset:4736
    v_and_or_b32 v255, v250, 4, v255
    v_mfma_f32_16x16x16_bf16 v[204:207], v[118:119], v[178:179], v[204:207]
    s_waitcnt lgkmcnt(3)
    v_mul_i32_i24 v250, s30, v255
    v_and_b32 v255, 1, v254
    v_mfma_f32_16x16x32_bf16 v[196:199], v[150:153], v[168:171], v[196:199]
    v_mad_i32_i24 v250, v255, s31, v250
    v_add_u32 v250, s56, v250
    v_mfma_f32_16x16x32_bf16 v[228:231], a[200:203], a[232:235], v[228:231]
    ds_read_b128 a[232:235], v240 offset:4864
    s_mul_i32 s56, s30, 15
    v_lshrrev_b32 v254, 4, v254
    v_mfma_f32_16x16x16_bf16 v[196:199], v[154:155], v[172:173], v[196:199]
    s_add_u32 s56, s56, s57
    v_exp_f32 v204, v204
    v_mfma_f32_16x16x32_bf16 v[228:231], a[204:207], a[236:239], v[228:231]
    ds_read_b128 a[236:239], v241 offset:4864
    s_add_u32 s56, s56, s32
    s_add_u32 s56, s56, s39
    v_mfma_f32_16x16x32_bf16 v[228:231], a[208:211], a[240:243], v[228:231]
    ds_read_b128 a[240:243], v249 offset:0
    s_waitcnt lgkmcnt(5)
    v_mfma_f32_16x16x32_bf16 v[200:203], v[162:165], v[168:171], v[200:203]
    v_exp_f32 v205, v205
    v_mfma_f32_16x16x32_bf16 v[228:231], a[212:215], a[244:247], v[228:231]
    ds_read_b128 a[244:247], v249 offset:64
    v_cvt_pk_bf16_f32 v184, v204, v205
    v_mfma_f32_16x16x32_bf16 v[232:235], a[0:3], a[216:219], 0
    ds_read_b128 v[204:207], v246 offset:0
    v_mfma_f32_16x16x16_bf16 v[200:203], v[166:167], v[172:173], v[200:203]
    v_exp_f32 v196, v196
    v_mfma_f32_16x16x32_bf16 v[232:235], a[4:7], a[220:223], v[232:235]
    s_waitcnt lgkmcnt(5)
    v_cvt_pk_bf16_f32 v228, v228, v229
    v_cvt_pk_bf16_f32 v229, v230, v231
    v_mfma_f32_16x16x32_bf16 v[232:235], a[8:11], a[224:227], v[232:235]
    buffer_store_dwordx2 v[228:229], v251, s[20:23], 0 offen offset:64
    v_mfma_f32_16x16x32_bf16 v[232:235], a[12:15], a[228:231], v[232:235]
    s_waitcnt lgkmcnt(4)
    v_lshl_add_u32 v251, v254, 3, v250
    v_lshl_add_u32 v250, v254, 4, v250
    v_mfma_f32_16x16x32_bf16 v[232:235], a[16:19], a[232:235], v[232:235]
    s_waitcnt lgkmcnt(3)
    v_mbcnt_lo_u32_b32 v254, -1, 0
    v_mbcnt_hi_u32_b32 v254, -1, v254
    v_mfma_f32_16x16x32_bf16 v[232:235], a[20:23], a[236:239], v[232:235]
    v_bfe_u32 v255, v254, 2, 2
    v_mfma_f32_16x16x32_bf16 v[236:239], a[24:27], a[216:219], 0
    v_exp_f32 v197, v197
    v_mfma_f32_16x16x32_bf16 v[236:239], a[28:31], a[220:223], v[236:239]
    v_exp_f32 v198, v198
    v_mfma_f32_16x16x32_bf16 v[236:239], a[32:35], a[224:227], v[236:239]
    s_waitcnt lgkmcnt(0)
    v_exp_f32 v199, v199
    v_mfma_f32_16x16x32_bf16 v[204:207], v[90:93], v[168:171], v[204:207]
    v_cvt_pk_bf16_f32 v138, v232, v233
    v_cvt_pk_bf16_f32 v139, v234, v235
    v_mfma_f32_16x16x32_bf16 v[236:239], a[36:39], a[228:231], v[236:239]
    v_cvt_pk_bf16_f32 v190, v196, v197
    v_cvt_pk_bf16_f32 v193, v198, v199
    v_mfma_f32_16x16x32_bf16 v[236:239], a[40:43], a[232:235], v[236:239]
    ds_read_b128 v[196:199], v245 offset:64
    v_mfma_f32_16x16x16_bf16 v[204:207], v[94:95], v[172:173], v[204:207]
    v_exp_f32 v200, v200
    v_mfma_f32_16x16x32_bf16 v[236:239], a[44:47], a[236:239], v[236:239]
    v_exp_f32 v201, v201
    v_mfma_f32_16x16x32_bf16 v[228:231], a[48:51], a[216:219], 0
    v_exp_f32 v202, v202
    v_mfma_f32_16x16x32_bf16 v[228:231], a[52:55], a[220:223], v[228:231]
    v_exp_f32 v203, v203
    v_mfma_f32_16x16x32_bf16 v[228:231], a[56:59], a[224:227], v[228:231]
    v_cvt_pk_bf16_f32 v188, v200, v201
    v_cvt_pk_bf16_f32 v191, v202, v203
    v_mfma_f32_16x16x32_bf16 v[228:231], a[60:63], a[228:231], v[228:231]
    ds_read_b128 v[200:203], v246 offset:64
    v_cvt_pk_bf16_f32 v140, v236, v237
    v_mfma_f32_16x16x32_bf16 v[228:231], a[64:67], a[232:235], v[228:231]
    v_cvt_pk_bf16_f32 v141, v238, v239
    v_mfma_f32_16x16x32_bf16 v[228:231], a[68:71], a[236:239], v[228:231]
    v_exp_f32 v204, v204
    v_mfma_f32_16x16x32_bf16 v[208:211], v[138:141], v[174:177], v[208:211]
    s_waitcnt lgkmcnt(1)
    v_exp_f32 v205, v205
    v_mfma_f32_16x16x32_bf16 v[196:199], v[114:117], v[168:171], v[196:199]
    v_exp_f32 v206, v206
    v_mfma_f32_16x16x32_bf16 v[232:235], a[216:219], a[72:75], 0
    v_exp_f32 v207, v207
    v_mfma_f32_16x16x32_bf16 v[232:235], a[220:223], a[76:79], v[232:235]
    v_cvt_pk_bf16_f32 v142, v228, v229
    v_cvt_pk_bf16_f32 v143, v230, v231
    v_mfma_f32_16x16x16_bf16 v[196:199], v[118:119], v[172:173], v[196:199]
    v_cvt_pk_bf16_f32 v189, v204, v205
    v_cvt_pk_bf16_f32 v192, v206, v207
    v_mfma_f32_16x16x16_bf16 v[208:211], v[142:143], v[178:179], v[208:211]
    ds_read_b128 v[204:207], v244 offset:128
    s_waitcnt lgkmcnt(1)
    v_mfma_f32_16x16x32_bf16 v[200:203], v[138:141], v[168:171], v[200:203]
    v_mfma_f32_16x16x32_bf16 v[232:235], a[224:227], a[80:83], v[232:235]
    v_mfma_f32_16x16x32_bf16 v[232:235], a[228:231], a[84:87], v[232:235]
    v_exp_f32 v196, v196
    v_mfma_f32_16x16x32_bf16 v[232:235], a[232:235], a[88:91], v[232:235]
    v_exp_f32 v197, v197
    v_mfma_f32_16x16x32_bf16 v[232:235], a[236:239], a[92:95], v[232:235]
    v_exp_f32 v208, v208
    v_mfma_f32_16x16x16_bf16 v[200:203], v[142:143], v[172:173], v[200:203]
    v_exp_f32 v209, v209
    v_mfma_f32_16x16x32_bf16 v[236:239], a[216:219], a[96:99], 0
    v_cvt_pk_bf16_f32 v185, v208, v209
    v_cvt_pk_bf16_f32 v194, v196, v197
    v_mfma_f32_16x16x32_bf16 v[236:239], a[220:223], a[100:103], v[236:239]
    ds_read_b128 v[208:211], v244 offset:64
    s_waitcnt lgkmcnt(1)
    v_cvt_pk_bf16_f32 v19, v232, v233
    v_mfma_f32_16x16x32_bf16 v[224:227], a[248:251], v[184:187], v[224:227]
    v_cvt_pk_bf16_f32 v22, v234, v235
    v_mfma_f32_16x16x32_bf16 v[212:215], v[18:21], v[184:187], v[212:215]
    v_exp_f32 v198, v198
    v_mfma_f32_16x16x32_bf16 v[204:207], v[96:99], v[168:171], v[204:207]
    v_exp_f32 v199, v199
    v_mfma_f32_16x16x32_bf16 v[236:239], a[224:227], a[104:107], v[236:239]
    v_cvt_pk_bf16_f32 v181, v198, v199
    v_mfma_f32_16x16x32_bf16 v[236:239], a[228:231], a[108:111], v[236:239]
    ds_read_b128 v[196:199], v246 offset:128
    v_mfma_f32_16x16x32_bf16 v[236:239], a[232:235], a[112:115], v[236:239]
    v_rcp_f32 v252, v224
    v_mfma_f32_16x16x16_bf16 v[204:207], v[100:101], v[172:173], v[204:207]
    v_max3_f32 v248, v248, v224, v252
    v_mul_f32 v212, v212, v252
    v_mfma_f32_16x16x32_bf16 v[224:227], a[248:251], v[188:191], 0
    v_mul_f32 v213, v213, v252
    v_mul_f32 v214, v214, v252
    v_mfma_f32_16x16x32_bf16 v[236:239], a[236:239], a[116:119], v[236:239]
    s_waitcnt lgkmcnt(1)
    v_mul_f32 v215, v215, v252
    v_cvt_pk_bf16_f32 v212, v212, v213
    v_mfma_f32_16x16x32_bf16 v[208:211], v[156:159], v[168:171], v[208:211]
    v_cvt_pk_bf16_f32 v213, v214, v215
    v_mfma_f32_16x16x32_bf16 v[228:231], a[216:219], a[120:123], 0
    ds_read_b128 a[216:219], v249 offset:128
    v_mfma_f32_16x16x32_bf16 v[228:231], a[220:223], a[124:127], v[228:231]
    ds_read_b128 a[220:223], v249 offset:192
    v_cvt_pk_bf16_f32 v49, v236, v237
    v_mfma_f32_16x16x16_bf16 v[208:211], v[160:161], v[172:173], v[208:211]
    ds_write_b64 v247, v[212:213] offset:33280
    v_mfma_f32_16x16x32_bf16 v[216:219], v[48:51], v[184:187], v[216:219]
    v_cvt_pk_bf16_f32 v52, v238, v239
    v_mfma_f32_16x16x32_bf16 v[212:215], v[12:15], v[188:191], 0
    v_exp_f32 v200, v200
    v_mfma_f32_16x16x32_bf16 v[228:231], a[224:227], a[128:131], v[228:231]
    ds_read_b128 a[224:227], v249 offset:256
    v_mfma_f32_16x16x32_bf16 v[228:231], a[228:231], a[132:135], v[228:231]
    ds_read_b128 a[228:231], v249 offset:320
    v_mfma_f32_16x16x32_bf16 v[228:231], a[232:235], a[136:139], v[228:231]
    ds_read_b128 a[232:235], v249 offset:6656
    v_mul_f32 v216, v216, v252
    v_mfma_f32_16x16x32_bf16 v[228:231], a[236:239], a[140:143], v[228:231]
    ds_read_b128 a[236:239], v249 offset:6720
    v_mul_f32 v217, v217, v252
    v_mfma_f32_16x16x32_bf16 v[232:235], a[144:147], a[240:243], 0
    v_mul_f32 v218, v218, v252
    v_mul_f32 v219, v219, v252
    v_mfma_f32_16x16x32_bf16 v[232:235], a[148:151], a[244:247], v[232:235]
    s_waitcnt lgkmcnt(4)
    v_cvt_pk_bf16_f32 v216, v216, v217
    v_cvt_pk_bf16_f32 v79, v228, v229
    v_mfma_f32_16x16x32_bf16 v[232:235], a[152:155], a[216:219], v[232:235]
    v_cvt_pk_bf16_f32 v82, v230, v231
    v_cvt_pk_bf16_f32 v217, v218, v219
    v_mfma_f32_16x16x32_bf16 v[220:223], v[78:81], v[184:187], v[220:223]
    ds_write_b64 v247, v[216:217] offset:33312
    v_mfma_f32_16x16x32_bf16 v[216:219], v[42:45], v[188:191], 0
    v_exp_f32 v208, v208
    v_mfma_f32_16x16x32_bf16 v[232:235], a[156:159], a[220:223], v[232:235]
    s_waitcnt lgkmcnt(3)
    v_exp_f32 v209, v209
    v_mfma_f32_16x16x32_bf16 v[232:235], a[160:163], a[224:227], v[232:235]
    v_exp_f32 v210, v210
    v_mfma_f32_16x16x32_bf16 v[232:235], a[164:167], a[228:231], v[232:235]
    v_mul_f32 v220, v220, v252
    v_mul_f32 v221, v221, v252
    v_mfma_f32_16x16x32_bf16 v[236:239], a[168:171], a[240:243], 0
    v_mul_f32 v222, v222, v252
    v_mul_f32 v223, v223, v252
    v_mfma_f32_16x16x32_bf16 v[236:239], a[172:175], a[244:247], v[236:239]
    v_cvt_pk_bf16_f32 v220, v220, v221
    v_cvt_pk_bf16_f32 v221, v222, v223
    v_mfma_f32_16x16x32_bf16 v[236:239], a[176:179], a[216:219], v[236:239]
    ds_write_b64 v247, v[220:221] offset:33344
    v_mfma_f32_16x16x32_bf16 v[220:223], v[72:75], v[188:191], 0
    v_cvt_pk_bf16_f32 v232, v232, v233
    v_cvt_pk_bf16_f32 v233, v234, v235
    v_mfma_f32_16x16x32_bf16 v[236:239], a[180:183], a[220:223], v[236:239]
    v_exp_f32 v211, v211
    v_mfma_f32_16x16x32_bf16 v[236:239], a[184:187], a[224:227], v[236:239]
    v_cvt_pk_bf16_f32 v180, v208, v209
    v_cvt_pk_bf16_f32 v183, v210, v211
    v_mfma_f32_16x16x32_bf16 v[236:239], a[188:191], a[228:231], v[236:239]
    ds_read_b128 v[208:211], v245 offset:128
    v_mfma_f32_16x16x32_bf16 v[228:231], a[192:195], a[240:243], 0
    ds_read_b128 a[240:243], v249 offset:6784
    v_mfma_f32_16x16x32_bf16 v[228:231], a[196:199], a[244:247], v[228:231]
    ds_read_b128 a[244:247], v249 offset:6848
    v_mfma_f32_16x16x32_bf16 v[228:231], a[200:203], a[216:219], v[228:231]
    ds_read_b128 a[216:219], v249 offset:6912
    v_mfma_f32_16x16x32_bf16 v[228:231], a[204:207], a[220:223], v[228:231]
    ds_read_b128 a[220:223], v249 offset:6976
    s_waitcnt lgkmcnt(5)
    v_cvt_pk_bf16_f32 v234, v236, v237
    v_mfma_f32_16x16x32_bf16 v[228:231], a[208:211], a[224:227], v[228:231]
    ds_read_b128 a[224:227], v240 offset:6144
    s_barrier
    v_cvt_pk_bf16_f32 v235, v238, v239
    v_mfma_f32_16x16x32_bf16 v[228:231], a[212:215], a[228:231], v[228:231]
    buffer_store_dwordx4 v[232:235], v250, s[20:23], 0 offen
    v_mfma_f32_16x16x32_bf16 v[236:239], a[168:171], a[232:235], 0
    ds_read_b128 a[228:231], v241 offset:6144
    v_mul_i32_i24 v250, s30, v255
    v_mfma_f32_16x16x32_bf16 v[232:235], a[144:147], a[232:235], 0
    ds_read_b64 v[174:175], v247 offset:46592
    s_waitcnt lgkmcnt(7)
    v_and_b32 v255, 3, v254
    v_mfma_f32_16x16x32_bf16 v[208:211], v[120:123], v[168:171], v[208:211]
    ds_read_b64 v[176:177], v247 offset:46624
    v_cvt_pk_bf16_f32 v228, v228, v229
    v_mfma_f32_16x16x32_bf16 v[232:235], a[148:151], a[236:239], v[232:235]
    ds_read_b64 v[178:179], v247 offset:46656
    s_waitcnt lgkmcnt(7)
    v_cvt_pk_bf16_f32 v229, v230, v231
    v_mfma_f32_16x16x16_bf16 v[208:211], v[124:125], v[172:173], v[208:211]
    buffer_store_dwordx2 v[228:229], v251, s[20:23], 0 offen offset:64
    v_mfma_f32_16x16x32_bf16 v[232:235], a[152:155], a[240:243], v[232:235]
    v_mad_i32_i24 v250, v255, s31, v250
    v_add_u32 v250, s58, v250
    v_mfma_f32_16x16x32_bf16 v[232:235], a[156:159], a[244:247], v[232:235]
    s_mul_i32 s58, s30, 15
    v_lshrrev_b32 v254, 4, v254
    v_lshl_add_u32 v251, v254, 3, v250
    v_mfma_f32_16x16x32_bf16 v[236:239], a[172:175], a[236:239], v[236:239]
    s_add_u32 s58, s58, s59
    v_lshl_add_u32 v250, v254, 4, v250
    v_mbcnt_lo_u32_b32 v254, -1, 0
    v_mfma_f32_16x16x32_bf16 v[236:239], a[176:179], a[240:243], v[236:239]
    s_add_u32 s58, s58, s32
    v_mbcnt_hi_u32_b32 v254, -1, v254
    v_bfe_u32 v255, v254, 2, 2
    v_mfma_f32_16x16x32_bf16 v[236:239], a[180:183], a[244:247], v[236:239]
    s_add_u32 s58, s58, s39
    v_exp_f32 v201, v201
    v_mfma_f32_16x16x32_bf16 v[228:231], a[192:195], a[232:235], 0
    ds_read_b128 a[232:235], v240 offset:6272
    s_waitcnt lgkmcnt(2)
    v_cvt_pk_bf16_f32 v195, v200, v201
    v_mfma_f32_16x16x32_bf16 v[232:235], a[160:163], a[216:219], v[232:235]
    v_exp_f32 v202, v202
    v_mfma_f32_16x16x32_bf16 v[212:215], v[16:19], v[192:195], v[212:215]
    v_exp_f32 v203, v203
    v_mfma_f32_16x16x32_bf16 v[216:219], v[46:49], v[192:195], v[216:219]
    v_cvt_pk_bf16_f32 v182, v202, v203
    v_mfma_f32_16x16x32_bf16 v[220:223], v[76:79], v[192:195], v[220:223]
    ds_read_b128 v[200:203], v244 offset:0
    v_mfma_f32_16x16x32_bf16 v[224:227], a[248:251], v[192:195], v[224:227]
    v_exp_f32 v204, v204
    v_mfma_f32_16x16x32_bf16 v[212:215], v[20:23], v[180:183], v[212:215]
    v_exp_f32 v205, v205
    v_mfma_f32_16x16x32_bf16 v[216:219], v[50:53], v[180:183], v[216:219]
    v_cvt_pk_bf16_f32 v186, v204, v205
    v_mfma_f32_16x16x32_bf16 v[220:223], v[80:83], v[180:183], v[220:223]
    ds_read_b128 v[204:207], v245 offset:0
    v_mfma_f32_16x16x32_bf16 v[224:227], a[248:251], v[180:183], v[224:227]
    v_exp_f32 v208, v208
    v_mfma_f32_16x16x32_bf16 v[232:235], a[164:167], a[220:223], v[232:235]
    v_exp_f32 v209, v209
    v_mfma_f32_16x16x32_bf16 v[236:239], a[184:187], a[216:219], v[236:239]
    v_cvt_pk_bf16_f32 v184, v208, v209
    v_mfma_f32_16x16x32_bf16 v[236:239], a[188:191], a[220:223], v[236:239]
    ds_read_b128 v[208:211], v246 offset:0
    s_waitcnt lgkmcnt(2)
    v_mfma_f32_16x16x32_bf16 v[200:203], v[156:159], v[174:177], v[200:203]
    v_mfma_f32_16x16x32_bf16 v[228:231], a[196:199], a[236:239], v[228:231]
    ds_read_b128 a[236:239], v241 offset:6272
    v_cvt_pk_bf16_f32 v232, v232, v233
    v_mfma_f32_16x16x32_bf16 v[228:231], a[200:203], a[240:243], v[228:231]
    ds_read_b128 a[240:243], v240 offset:6400
    v_cvt_pk_bf16_f32 v233, v234, v235
    v_mfma_f32_16x16x16_bf16 v[200:203], v[160:161], v[178:179], v[200:203]
    v_cvt_pk_bf16_f32 v234, v236, v237
    v_cvt_pk_bf16_f32 v235, v238, v239
    v_mfma_f32_16x16x32_bf16 v[228:231], a[204:207], a[244:247], v[228:231]
    buffer_store_dwordx4 v[232:235], v250, s[20:23], 0 offen
    v_mfma_f32_16x16x32_bf16 v[228:231], a[208:211], a[216:219], v[228:231]
    ds_read_b128 a[244:247], v241 offset:6400
    s_waitcnt lgkmcnt(4)
    v_add_u32 v250, s60, v250
    v_mfma_f32_16x16x32_bf16 v[204:207], v[114:117], v[174:177], v[204:207]
    ds_read_b128 a[216:219], v249 offset:13312
    v_mfma_f32_16x16x32_bf16 v[228:231], a[212:215], a[220:223], v[228:231]
    ds_read_b128 a[220:223], v249 offset:13376
    s_waitcnt lgkmcnt(5)
    v_mfma_f32_16x16x32_bf16 v[208:211], v[138:141], v[174:177], v[208:211]
    v_exp_f32 v200, v200
    v_mfma_f32_16x16x16_bf16 v[204:207], v[118:119], v[178:179], v[204:207]
    v_exp_f32 v201, v201
    v_mfma_f32_16x16x32_bf16 v[232:235], a[0:3], a[224:227], 0
    v_exp_f32 v202, v202
    v_mfma_f32_16x16x32_bf16 v[232:235], a[4:7], a[228:231], v[232:235]
    v_cvt_pk_bf16_f32 v228, v228, v229
    v_cvt_pk_bf16_f32 v229, v230, v231
    v_mfma_f32_16x16x16_bf16 v[208:211], v[142:143], v[178:179], v[208:211]
    buffer_store_dwordx2 v[228:229], v251, s[20:23], 0 offen offset:64
    v_mfma_f32_16x16x32_bf16 v[232:235], a[8:11], a[232:235], v[232:235]
    s_waitcnt lgkmcnt(3)
    v_add_u32 v251, s60, v251
    v_cvt_pk_bf16_f32 v190, v200, v201
    v_mfma_f32_16x16x32_bf16 v[232:235], a[12:15], a[236:239], v[232:235]
    v_exp_f32 v203, v203
    v_mfma_f32_16x16x32_bf16 v[232:235], a[16:19], a[240:243], v[232:235]
    s_waitcnt lgkmcnt(1)
    v_cvt_pk_bf16_f32 v193, v202, v203
    v_mfma_f32_16x16x32_bf16 v[232:235], a[20:23], a[244:247], v[232:235]
    ds_read_b128 v[200:203], v245 offset:64
    v_mfma_f32_16x16x32_bf16 v[236:239], a[24:27], a[224:227], 0
    v_exp_f32 v204, v204
    v_mfma_f32_16x16x32_bf16 v[236:239], a[28:31], a[228:231], v[236:239]
    v_exp_f32 v205, v205
    v_mfma_f32_16x16x32_bf16 v[236:239], a[32:35], a[232:235], v[236:239]
    v_exp_f32 v206, v206
    v_mfma_f32_16x16x32_bf16 v[236:239], a[36:39], a[236:239], v[236:239]
    v_cvt_pk_bf16_f32 v144, v232, v233
    v_cvt_pk_bf16_f32 v145, v234, v235
    v_mfma_f32_16x16x32_bf16 v[236:239], a[40:43], a[240:243], v[236:239]
    v_exp_f32 v207, v207
    v_mfma_f32_16x16x32_bf16 v[236:239], a[44:47], a[244:247], v[236:239]
    v_cvt_pk_bf16_f32 v188, v204, v205
    v_cvt_pk_bf16_f32 v191, v206, v207
    v_mfma_f32_16x16x32_bf16 v[228:231], a[48:51], a[224:227], 0
    ds_read_b128 v[204:207], v246 offset:64
    v_mfma_f32_16x16x32_bf16 v[228:231], a[52:55], a[228:231], v[228:231]
    v_exp_f32 v208, v208
    v_mfma_f32_16x16x32_bf16 v[228:231], a[56:59], a[232:235], v[228:231]
    s_waitcnt lgkmcnt(1)
    v_cvt_pk_bf16_f32 v146, v236, v237
    v_cvt_pk_bf16_f32 v147, v238, v239
    v_mfma_f32_16x16x32_bf16 v[200:203], v[120:123], v[174:177], v[200:203]
    v_exp_f32 v209, v209
    v_mfma_f32_16x16x32_bf16 v[196:199], v[144:147], v[168:171], v[196:199]
    ds_read_b64 v[168:169], v247 offset:53248
    v_cvt_pk_bf16_f32 v189, v208, v209
    v_mfma_f32_16x16x32_bf16 v[228:231], a[60:63], a[236:239], v[228:231]
    ds_read_b64 v[170:171], v247 offset:53280
    v_mfma_f32_16x16x16_bf16 v[200:203], v[124:125], v[178:179], v[200:203]
    v_exp_f32 v210, v210
    v_mfma_f32_16x16x32_bf16 v[228:231], a[64:67], a[240:243], v[228:231]
    v_exp_f32 v211, v211
    v_mfma_f32_16x16x32_bf16 v[228:231], a[68:71], a[244:247], v[228:231]
    v_cvt_pk_bf16_f32 v192, v210, v211
    s_waitcnt lgkmcnt(2)
    v_mfma_f32_16x16x32_bf16 v[204:207], v[144:147], v[174:177], v[204:207]
    v_mfma_f32_16x16x32_bf16 v[232:235], a[224:227], a[72:75], 0
    v_exp_f32 v200, v200
    v_mfma_f32_16x16x32_bf16 v[232:235], a[228:231], a[76:79], v[232:235]
    v_exp_f32 v201, v201
    v_mfma_f32_16x16x32_bf16 v[232:235], a[232:235], a[80:83], v[232:235]
    v_cvt_pk_bf16_f32 v148, v228, v229
    v_cvt_pk_bf16_f32 v149, v230, v231
    v_mfma_f32_16x16x32_bf16 v[232:235], a[236:239], a[84:87], v[232:235]
    v_exp_f32 v202, v202
    v_mfma_f32_16x16x16_bf16 v[196:199], v[148:149], v[172:173], v[196:199]
    ds_read_b64 v[172:173], v247 offset:53312
    v_cvt_pk_bf16_f32 v194, v200, v201
    v_mfma_f32_16x16x16_bf16 v[204:207], v[148:149], v[178:179], v[204:207]
    v_exp_f32 v203, v203
    v_mfma_f32_16x16x32_bf16 v[232:235], a[240:243], a[88:91], v[232:235]
    v_cvt_pk_bf16_f32 v181, v202, v203
    v_mfma_f32_16x16x32_bf16 v[232:235], a[244:247], a[92:95], v[232:235]
    v_mfma_f32_16x16x32_bf16 v[236:239], a[224:227], a[96:99], 0
    v_exp_f32 v196, v196
    v_mfma_f32_16x16x32_bf16 v[236:239], a[228:231], a[100:103], v[236:239]
    v_exp_f32 v197, v197
    v_mfma_f32_16x16x32_bf16 v[236:239], a[232:235], a[104:107], v[236:239]
    v_cvt_pk_bf16_f32 v185, v196, v197
    v_mfma_f32_16x16x32_bf16 v[236:239], a[236:239], a[108:111], v[236:239]
    ds_read_b128 v[196:199], v244 offset:64
    v_cvt_pk_bf16_f32 v25, v232, v233
    v_mfma_f32_16x16x32_bf16 v[224:227], a[248:251], v[184:187], v[224:227]
    v_cvt_pk_bf16_f32 v28, v234, v235
    v_mfma_f32_16x16x32_bf16 v[212:215], v[24:27], v[184:187], v[212:215]
    v_exp_f32 v204, v204
    v_mfma_f32_16x16x32_bf16 v[236:239], a[240:243], a[112:115], v[236:239]
    v_exp_f32 v205, v205
    v_mfma_f32_16x16x32_bf16 v[236:239], a[244:247], a[116:119], v[236:239]
    v_exp_f32 v206, v206
    v_mfma_f32_16x16x32_bf16 v[228:231], a[224:227], a[120:123], 0
    ds_read_b128 a[224:227], v249 offset:13440
    v_cvt_pk_bf16_f32 v195, v204, v205
    v_mfma_f32_16x16x32_bf16 v[228:231], a[228:231], a[124:127], v[228:231]
    ds_read_b128 a[228:231], v249 offset:13504
    v_mfma_f32_16x16x32_bf16 v[228:231], a[232:235], a[128:131], v[228:231]
    ds_read_b128 a[232:235], v249 offset:13568
    v_cvt_pk_bf16_f32 v55, v236, v237
    v_mfma_f32_16x16x32_bf16 v[228:231], a[236:239], a[132:135], v[228:231]
    ds_read_b128 a[236:239], v249 offset:13632
    s_waitcnt lgkmcnt(4)
    v_cvt_pk_bf16_f32 v58, v238, v239
    v_mfma_f32_16x16x32_bf16 v[216:219], v[54:57], v[184:187], v[216:219]
    v_rcp_f32 v252, v224
    v_mfma_f32_16x16x32_bf16 v[196:199], v[96:99], v[174:177], v[196:199]
    v_max3_f32 v248, v248, v224, v252
    v_mul_f32 v212, v212, v252
    v_mfma_f32_16x16x32_bf16 v[224:227], a[248:251], v[188:191], 0
    v_mul_f32 v213, v213, v252
    v_mul_f32 v214, v214, v252
    v_mfma_f32_16x16x32_bf16 v[224:227], a[248:251], v[192:195], v[224:227]
    v_mul_f32 v215, v215, v252
    v_cvt_pk_bf16_f32 v212, v212, v213
    v_mfma_f32_16x16x16_bf16 v[196:199], v[100:101], v[178:179], v[196:199]
    v_cvt_pk_bf16_f32 v213, v214, v215
    v_mul_f32 v216, v216, v252
    v_mfma_f32_16x16x32_bf16 v[228:231], a[240:243], a[136:139], v[228:231]
    ds_read_b128 a[240:243], v249 offset:19968
    v_mul_f32 v217, v217, v252
    v_mfma_f32_16x16x32_bf16 v[228:231], a[244:247], a[140:143], v[228:231]
    ds_read_b128 a[244:247], v249 offset:20032
    v_mul_f32 v218, v218, v252
    v_mfma_f32_16x16x32_bf16 v[232:235], a[144:147], a[216:219], 0
    ds_write_b64 v247, v[212:213] offset:39936
    v_mfma_f32_16x16x32_bf16 v[212:215], v[18:21], v[188:191], 0
    v_mul_f32 v219, v219, v252
    v_cvt_pk_bf16_f32 v216, v216, v217
    v_mfma_f32_16x16x32_bf16 v[212:215], v[22:25], v[192:195], v[212:215]
    v_cvt_pk_bf16_f32 v85, v228, v229
    v_cvt_pk_bf16_f32 v88, v230, v231
    v_mfma_f32_16x16x32_bf16 v[232:235], a[148:151], a[220:223], v[232:235]
    s_waitcnt lgkmcnt(3)
    v_cvt_pk_bf16_f32 v217, v218, v219
    v_mfma_f32_16x16x32_bf16 v[220:223], v[84:87], v[184:187], v[220:223]
    ds_write_b64 v247, v[216:217] offset:39968
    v_mfma_f32_16x16x32_bf16 v[216:219], v[48:51], v[188:191], 0
    v_exp_f32 v196, v196
    v_mfma_f32_16x16x32_bf16 v[216:219], v[52:55], v[192:195], v[216:219]
    v_exp_f32 v197, v197
    v_mfma_f32_16x16x32_bf16 v[232:235], a[152:155], a[224:227], v[232:235]
    v_exp_f32 v198, v198
    v_mfma_f32_16x16x32_bf16 v[232:235], a[156:159], a[228:231], v[232:235]
    v_mul_f32 v220, v220, v252
    v_mul_f32 v221, v221, v252
    v_mfma_f32_16x16x32_bf16 v[232:235], a[160:163], a[232:235], v[232:235]
    v_mul_f32 v222, v222, v252
    v_mul_f32 v223, v223, v252
    v_mfma_f32_16x16x32_bf16 v[232:235], a[164:167], a[236:239], v[232:235]
    v_cvt_pk_bf16_f32 v220, v220, v221
    v_cvt_pk_bf16_f32 v221, v222, v223
    v_mfma_f32_16x16x32_bf16 v[236:239], a[168:171], a[216:219], 0
    ds_write_b64 v247, v[220:221] offset:40000
    v_mfma_f32_16x16x32_bf16 v[220:223], v[78:81], v[188:191], 0
    v_exp_f32 v199, v199
    v_mfma_f32_16x16x32_bf16 v[220:223], v[82:85], v[192:195], v[220:223]
    v_cvt_pk_bf16_f32 v180, v196, v197
    v_cvt_pk_bf16_f32 v232, v232, v233
    v_mfma_f32_16x16x32_bf16 v[236:239], a[172:175], a[220:223], v[236:239]
    v_cvt_pk_bf16_f32 v233, v234, v235
    v_cvt_pk_bf16_f32 v183, v198, v199
    v_mfma_f32_16x16x32_bf16 v[236:239], a[176:179], a[224:227], v[236:239]
    v_exp_f32 v207, v207
    v_mfma_f32_16x16x32_bf16 v[236:239], a[180:183], a[228:231], v[236:239]
    v_cvt_pk_bf16_f32 v182, v206, v207
    v_mov_b32 v186, 0
    v_mfma_f32_16x16x32_bf16 v[236:239], a[184:187], a[232:235], v[236:239]
    v_mov_b32 v189, 0
    v_mov_b32 v192, 0
    v_mfma_f32_16x16x32_bf16 v[212:215], v[26:29], v[180:183], v[212:215]
    v_mov_b32 v195, 0
    v_mfma_f32_16x16x32_bf16 v[216:219], v[56:59], v[180:183], v[216:219]
    v_mfma_f32_16x16x32_bf16 v[220:223], v[86:89], v[180:183], v[220:223]
    v_mfma_f32_16x16x32_bf16 v[224:227], a[248:251], v[180:183], v[224:227]
    v_mov_b32 v182, 0
    v_mfma_f32_16x16x32_bf16 v[236:239], a[188:191], a[236:239], v[236:239]
    v_mfma_f32_16x16x32_bf16 v[228:231], a[192:195], a[216:219], 0
    ds_read_b128 a[216:219], v249 offset:20096
    v_mfma_f32_16x16x32_bf16 v[228:231], a[196:199], a[220:223], v[228:231]
    ds_read_b128 a[220:223], v249 offset:20160
    v_mfma_f32_16x16x32_bf16 v[228:231], a[200:203], a[224:227], v[228:231]
    ds_read_b128 a[224:227], v249 offset:20224
    v_mfma_f32_16x16x32_bf16 v[228:231], a[204:207], a[228:231], v[228:231]
    ds_read_b128 a[228:231], v249 offset:20288
    v_cvt_pk_bf16_f32 v234, v236, v237
    v_mfma_f32_16x16x32_bf16 v[228:231], a[208:211], a[232:235], v[228:231]
    ds_read_b128 a[232:235], v249 offset:26624
    v_cvt_pk_bf16_f32 v235, v238, v239
    v_mfma_f32_16x16x32_bf16 v[228:231], a[212:215], a[236:239], v[228:231]
    s_waitcnt lgkmcnt(5)
    v_rcp_f32 v252, v224
    v_mfma_f32_16x16x32_bf16 v[236:239], a[168:171], a[240:243], 0
    buffer_store_dwordx4 v[232:235], v250, s[20:23], 0 offen
    v_mfma_f32_16x16x32_bf16 v[236:239], a[172:175], a[244:247], v[236:239]
    ds_read_b128 a[236:239], v249 offset:26688
    v_add_u32 v250, s62, v250
    v_mfma_f32_16x16x32_bf16 v[232:235], a[144:147], a[240:243], 0
    s_waitcnt lgkmcnt(5)
    v_cvt_pk_bf16_f32 v228, v228, v229
    v_cvt_pk_bf16_f32 v229, v230, v231
    v_mfma_f32_16x16x32_bf16 v[232:235], a[148:151], a[244:247], v[232:235]
    buffer_store_dwordx2 v[228:229], v251, s[20:23], 0 offen offset:64
    v_mfma_f32_16x16x32_bf16 v[232:235], a[152:155], a[216:219], v[232:235]
    s_waitcnt lgkmcnt(3)
    v_add_u32 v251, s62, v251
    v_max3_f32 v248, v248, v224, v252
    v_mfma_f32_16x16x32_bf16 v[232:235], a[156:159], a[220:223], v[232:235]
    v_mul_f32 v212, v212, v252
    v_mul_f32 v213, v213, v252
    v_mfma_f32_16x16x32_bf16 v[232:235], a[160:163], a[224:227], v[232:235]
    s_waitcnt lgkmcnt(1)
    v_mul_f32 v214, v214, v252
    v_mul_f32 v215, v215, v252
    v_mfma_f32_16x16x32_bf16 v[232:235], a[164:167], a[228:231], v[232:235]
    v_cvt_pk_bf16_f32 v212, v212, v213
    v_cvt_pk_bf16_f32 v213, v214, v215
    v_mfma_f32_16x16x32_bf16 v[236:239], a[176:179], a[216:219], v[236:239]
    ds_write_b64 v247, v[212:213] offset:46592
    v_mfma_f32_16x16x32_bf16 v[236:239], a[180:183], a[220:223], v[236:239]
    v_mul_f32 v216, v216, v252
    v_mul_f32 v217, v217, v252
    v_mfma_f32_16x16x32_bf16 v[236:239], a[184:187], a[224:227], v[236:239]
    v_cvt_pk_bf16_f32 v232, v232, v233
    v_cvt_pk_bf16_f32 v233, v234, v235
    v_mfma_f32_16x16x32_bf16 v[236:239], a[188:191], a[228:231], v[236:239]
    v_mul_f32 v218, v218, v252
    v_mul_f32 v219, v219, v252
    v_mfma_f32_16x16x32_bf16 v[228:231], a[192:195], a[240:243], 0
    ds_read_b128 a[240:243], v249 offset:26752
    v_cvt_pk_bf16_f32 v216, v216, v217
    v_mfma_f32_16x16x32_bf16 v[228:231], a[196:199], a[244:247], v[228:231]
    ds_read_b128 a[244:247], v249 offset:26816
    v_cvt_pk_bf16_f32 v217, v218, v219
    v_mfma_f32_16x16x32_bf16 v[228:231], a[200:203], a[216:219], v[228:231]
    ds_read_b128 a[216:219], v249 offset:26880
    v_cvt_pk_bf16_f32 v234, v236, v237
    v_mfma_f32_16x16x32_bf16 v[228:231], a[204:207], a[220:223], v[228:231]
    ds_read_b128 a[220:223], v249 offset:26944
    v_cvt_pk_bf16_f32 v235, v238, v239
    v_mfma_f32_16x16x32_bf16 v[228:231], a[208:211], a[224:227], v[228:231]
    buffer_store_dwordx4 v[232:235], v250, s[20:23], 0 offen
    v_mfma_f32_16x16x32_bf16 v[228:231], a[212:215], a[228:231], v[228:231]
    ds_read_b128 a[224:227], v249 offset:33280
    v_add_u32 v250, s64, v250
    v_mfma_f32_16x16x32_bf16 v[232:235], a[144:147], a[232:235], 0
    ds_read_b128 a[228:231], v249 offset:33344
    s_waitcnt lgkmcnt(6)
    v_mul_f32 v220, v220, v252
    v_mfma_f32_16x16x32_bf16 v[232:235], a[148:151], a[236:239], v[232:235]
    ds_write_b64 v247, v[216:217] offset:46624
    v_mfma_f32_16x16x32_bf16 v[236:239], a[168:171], a[232:235], 0
    s_waitcnt lgkmcnt(6)
    v_cvt_pk_bf16_f32 v228, v228, v229
    v_cvt_pk_bf16_f32 v229, v230, v231
    v_mfma_f32_16x16x32_bf16 v[232:235], a[152:155], a[240:243], v[232:235]
    buffer_store_dwordx2 v[228:229], v251, s[20:23], 0 offen offset:64
    v_mfma_f32_16x16x32_bf16 v[236:239], a[172:175], a[236:239], v[236:239]
    s_waitcnt lgkmcnt(4)
    v_add_u32 v251, s64, v251
    v_mul_f32 v221, v221, v252
    v_mfma_f32_16x16x32_bf16 v[232:235], a[156:159], a[244:247], v[232:235]
    v_mul_f32 v222, v222, v252
    v_mul_f32 v223, v223, v252
    v_mfma_f32_16x16x32_bf16 v[232:235], a[160:163], a[216:219], v[232:235]
    s_waitcnt lgkmcnt(3)
    v_cvt_pk_bf16_f32 v220, v220, v221
    v_cvt_pk_bf16_f32 v221, v222, v223
    v_mfma_f32_16x16x32_bf16 v[232:235], a[164:167], a[220:223], v[232:235]
    ds_write_b64 v247, v[220:221] offset:46656
    v_mfma_f32_16x16x32_bf16 v[236:239], a[176:179], a[240:243], v[236:239]
    v_mbcnt_lo_u32_b32 v252, -1, 0
    v_mbcnt_hi_u32_b32 v252, -1, v252
    v_mfma_f32_16x16x32_bf16 v[236:239], a[180:183], a[244:247], v[236:239]
    v_bfe_u32 v208, v252, 2, 1
    v_lshrrev_b32 v209, 1, v252
    v_mfma_f32_16x16x32_bf16 v[236:239], a[184:187], a[216:219], v[236:239]
    v_cvt_pk_bf16_f32 v232, v232, v233
    v_cvt_pk_bf16_f32 v233, v234, v235
    v_mfma_f32_16x16x32_bf16 v[236:239], a[188:191], a[220:223], v[236:239]
    v_and_b32 v209, 4, v209
    v_and_or_b32 v209, v252, 3, v209
    v_mfma_f32_16x16x32_bf16 v[228:231], a[192:195], a[232:235], 0
    ds_read_b128 a[232:235], v249 offset:33408
    v_bfe_u32 v253, v252, 3, 1
    v_mfma_f32_16x16x32_bf16 v[228:231], a[196:199], a[236:239], v[228:231]
    ds_read_b128 a[236:239], v249 offset:33472
    v_lshrrev_b32 v252, 4, v252
    v_mfma_f32_16x16x32_bf16 v[228:231], a[200:203], a[240:243], v[228:231]
    ds_read_b128 a[240:243], v249 offset:33536
    v_cvt_pk_bf16_f32 v234, v236, v237
    v_mfma_f32_16x16x32_bf16 v[228:231], a[204:207], a[244:247], v[228:231]
    ds_read_b128 a[244:247], v249 offset:33600
    s_waitcnt lgkmcnt(4)
    v_cvt_pk_bf16_f32 v235, v238, v239
    v_mfma_f32_16x16x32_bf16 v[228:231], a[208:211], a[216:219], v[228:231]
    buffer_store_dwordx4 v[232:235], v250, s[20:23], 0 offen
    v_mfma_f32_16x16x32_bf16 v[228:231], a[212:215], a[220:223], v[228:231]
    s_barrier
    v_add_u32 v250, s50, v250
    v_sub_u32 v210, v252, v208
    v_mfma_f32_16x16x32_bf16 v[232:235], a[144:147], a[224:227], 0
    ds_read_b128 a[216:219], v249 offset:39936
    v_mul_i32_i24 v210, 0x1c0, v210
    v_mfma_f32_16x16x32_bf16 v[232:235], a[148:151], a[228:231], v[232:235]
    ds_read_b128 a[220:223], v249 offset:40000
    v_cvt_pk_bf16_f32 v228, v228, v229
    v_mfma_f32_16x16x32_bf16 v[236:239], a[168:171], a[224:227], 0
    ds_read_b64 v[174:175], v247 offset:59904
    s_waitcnt lgkmcnt(6)
    v_cvt_pk_bf16_f32 v229, v230, v231
    v_mfma_f32_16x16x32_bf16 v[232:235], a[152:155], a[232:235], v[232:235]
    buffer_store_dwordx2 v[228:229], v251, s[20:23], 0 offen offset:64
    v_mfma_f32_16x16x32_bf16 v[236:239], a[172:175], a[228:231], v[236:239]
    ds_read_b64 v[176:177], v247 offset:59936
    s_waitcnt lgkmcnt(5)
    v_add_u32 v251, s50, v251
    v_mfma_f32_16x16x32_bf16 v[232:235], a[156:159], a[236:239], v[232:235]
    ds_read_b64 v[178:179], v247 offset:59968
    v_lshlrev_b32 v211, 4, v209
    v_mfma_f32_16x16x32_bf16 v[232:235], a[160:163], a[240:243], v[232:235]
    s_waitcnt lgkmcnt(5)
    v_sub_u32 v210, v210, v211
    v_add_u32 v210, s37, v210
    v_mfma_f32_16x16x32_bf16 v[232:235], a[164:167], a[244:247], v[232:235]
    v_sub_u32 v211, v252, v208
    v_add_u32 v244, 0, v211
    v_mfma_f32_16x16x32_bf16 v[236:239], a[176:179], a[232:235], v[236:239]
    v_cmp_gt_u32 vcc, 7, v244
    v_add_u32 v244, 0xfffdc870, v210
    v_mfma_f32_16x16x32_bf16 v[236:239], a[180:183], a[236:239], v[236:239]
    v_cndmask_b32 v244, 0, v244, vcc
    v_add_u32 v244, 0x237c0, v244
    v_mfma_f32_16x16x32_bf16 v[236:239], a[184:187], a[240:243], v[236:239]
    v_cvt_pk_bf16_f32 v232, v232, v233
    v_cvt_pk_bf16_f32 v233, v234, v235
    v_mfma_f32_16x16x32_bf16 v[236:239], a[188:191], a[244:247], v[236:239]
    v_add_u32 v245, 4, v211
    v_cmp_gt_u32 vcc, 7, v245
    v_mfma_f32_16x16x32_bf16 v[228:231], a[192:195], a[224:227], 0
    ds_read_b128 a[224:227], v249 offset:40064
    v_add_u32 v245, 0xfffdcf70, v210
    v_mfma_f32_16x16x32_bf16 v[228:231], a[196:199], a[228:231], v[228:231]
    ds_read_b128 a[228:231], v249 offset:40128
    v_cndmask_b32 v245, 0, v245, vcc
    v_mfma_f32_16x16x32_bf16 v[228:231], a[200:203], a[232:235], v[228:231]
    ds_read_b128 a[232:235], v249 offset:40192
    v_cvt_pk_bf16_f32 v234, v236, v237
    v_mfma_f32_16x16x32_bf16 v[228:231], a[204:207], a[236:239], v[228:231]
    ds_read_b128 a[236:239], v249 offset:40256
    v_cvt_pk_bf16_f32 v235, v238, v239
    v_mfma_f32_16x16x32_bf16 v[228:231], a[208:211], a[240:243], v[228:231]
    buffer_store_dwordx4 v[232:235], v250, s[20:23], 0 offen
    v_mfma_f32_16x16x32_bf16 v[228:231], a[212:215], a[244:247], v[228:231]
    s_waitcnt lgkmcnt(4)
    v_add_u32 v250, s52, v250
    v_add_u32 v245, 0x237c0, v245
    v_mfma_f32_16x16x32_bf16 v[232:235], a[144:147], a[216:219], 0
    ds_read_b128 a[240:243], v249 offset:46592
    v_add_u32 v246, 8, v211
    v_mfma_f32_16x16x32_bf16 v[232:235], a[148:151], a[220:223], v[232:235]
    ds_read_b128 a[244:247], v249 offset:46656
    v_cvt_pk_bf16_f32 v228, v228, v229
    v_mfma_f32_16x16x32_bf16 v[236:239], a[168:171], a[216:219], 0
    s_waitcnt lgkmcnt(5)
    v_cvt_pk_bf16_f32 v229, v230, v231
    v_cmp_gt_u32 vcc, 7, v246
    v_mfma_f32_16x16x32_bf16 v[232:235], a[152:155], a[224:227], v[232:235]
    buffer_store_dwordx2 v[228:229], v251, s[20:23], 0 offen offset:64
    v_mfma_f32_16x16x32_bf16 v[236:239], a[172:175], a[220:223], v[236:239]
    s_waitcnt lgkmcnt(3)
    v_add_u32 v251, s52, v251
    v_add_u32 v246, 0xfffdd670, v210
    v_mfma_f32_16x16x32_bf16 v[232:235], a[156:159], a[228:231], v[232:235]
    v_cndmask_b32 v246, 0, v246, vcc
    v_add_u32 v246, 0x237c0, v246
    v_mfma_f32_16x16x32_bf16 v[232:235], a[160:163], a[232:235], v[232:235]
    s_waitcnt lgkmcnt(2)
    v_xor_b32 v253, 1, v253
    v_mul_u32_u24 v246, 0xc0, v253
    v_mfma_f32_16x16x32_bf16 v[232:235], a[164:167], a[236:239], v[232:235]
    v_mov_b32 v253, 0x5d800000
    v_add_u32 v244, v244, v246
    v_mfma_f32_16x16x32_bf16 v[236:239], a[176:179], a[224:227], v[236:239]
    ds_read_b128 v[208:211], v244 offset:0
    v_add_u32 v245, v245, v246
    v_mfma_f32_16x16x32_bf16 v[236:239], a[180:183], a[228:231], v[236:239]
    ds_read_b128 v[196:199], v245 offset:0
    v_mfma_f32_16x16x32_bf16 v[236:239], a[184:187], a[232:235], v[236:239]
    ds_read_b128 v[200:203], v244 offset:64
    v_cvt_pk_bf16_f32 v232, v232, v233
    v_mfma_f32_16x16x32_bf16 v[236:239], a[188:191], a[236:239], v[236:239]
    ds_read_b128 v[204:207], v245 offset:64
    v_cvt_pk_bf16_f32 v233, v234, v235
    v_mfma_f32_16x16x32_bf16 v[228:231], a[192:195], a[216:219], 0
    ds_read_b128 a[216:219], v249 offset:46720
    v_mfma_f32_16x16x32_bf16 v[228:231], a[196:199], a[220:223], v[228:231]
    ds_read_b128 a[220:223], v249 offset:46784
    v_mfma_f32_16x16x32_bf16 v[228:231], a[200:203], a[224:227], v[228:231]
    ds_read_b128 a[224:227], v249 offset:46848
    v_cvt_pk_bf16_f32 v234, v236, v237
    v_mfma_f32_16x16x32_bf16 v[228:231], a[204:207], a[228:231], v[228:231]
    ds_read_b128 a[228:231], v249 offset:46912
    v_cvt_pk_bf16_f32 v235, v238, v239
    v_mfma_f32_16x16x32_bf16 v[228:231], a[208:211], a[232:235], v[228:231]
    buffer_store_dwordx4 v[232:235], v250, s[20:23], 0 offen
    v_mfma_f32_16x16x32_bf16 v[228:231], a[212:215], a[236:239], v[228:231]
    s_waitcnt lgkmcnt(6)
    v_mul_i32_i24 v250, s30, v255
    v_and_b32 v255, 3, v254
    v_mfma_f32_16x16x32_bf16 v[208:211], v[102:105], v[168:171], v[208:211]
    s_waitcnt lgkmcnt(5)
    v_mad_i32_i24 v250, v255, s31, v250
    v_add_u32 v250, s54, v250
    v_mfma_f32_16x16x32_bf16 v[196:199], v[126:129], v[168:171], v[196:199]
    s_waitcnt lgkmcnt(4)
    v_cvt_pk_bf16_f32 v228, v228, v229
    v_cvt_pk_bf16_f32 v229, v230, v231
    v_mfma_f32_16x16x16_bf16 v[208:211], v[106:107], v[172:173], v[208:211]
    buffer_store_dwordx2 v[228:229], v251, s[20:23], 0 offen offset:64
    v_mfma_f32_16x16x32_bf16 v[200:203], v[108:111], v[168:171], v[200:203]
    v_cmp_gt_u32 vcc, 2, v255
    v_add_u32 v250, 0x80000000, v250
    v_mfma_f32_16x16x16_bf16 v[196:199], v[130:131], v[172:173], v[196:199]
    v_cndmask_b32 v250, 0, v250, vcc
    v_add_u32 v250, 0x80000000, v250
    v_mfma_f32_16x16x32_bf16 v[204:207], v[132:135], v[168:171], v[204:207]
    v_lshrrev_b32 v254, 4, v254
    v_lshl_add_u32 v251, v254, 3, v250
    v_mfma_f32_16x16x16_bf16 v[200:203], v[112:113], v[172:173], v[200:203]
    v_lshl_add_u32 v250, v254, 4, v250
    v_mbcnt_lo_u32_b32 v254, -1, 0
    v_mfma_f32_16x16x32_bf16 v[232:235], a[144:147], a[240:243], 0
    v_mbcnt_hi_u32_b32 v254, -1, v254
    v_bfe_u32 v255, v254, 2, 1
    v_mfma_f32_16x16x16_bf16 v[204:207], v[136:137], v[172:173], v[204:207]
    v_exp_f32 v208, v208
    v_mfma_f32_16x16x32_bf16 v[232:235], a[148:151], a[244:247], v[232:235]
    s_waitcnt lgkmcnt(0)
    v_exp_f32 v209, v209
    v_mfma_f32_16x16x32_bf16 v[232:235], a[152:155], a[216:219], v[232:235]
    v_exp_f32 v210, v210
    v_mfma_f32_16x16x32_bf16 v[232:235], a[156:159], a[220:223], v[232:235]
    v_exp_f32 v211, v211
    v_mfma_f32_16x16x32_bf16 v[232:235], a[160:163], a[224:227], v[232:235]
    v_cvt_pk_bf16_f32 v184, v208, v209
    v_cvt_pk_bf16_f32 v187, v210, v211
    v_mfma_f32_16x16x32_bf16 v[232:235], a[164:167], a[228:231], v[232:235]
    ds_read_b128 v[208:211], v244 offset:128
    v_mfma_f32_16x16x32_bf16 v[236:239], a[168:171], a[240:243], 0
    v_exp_f32 v196, v196
    v_mfma_f32_16x16x32_bf16 v[236:239], a[172:175], a[244:247], v[236:239]
    v_exp_f32 v197, v197
    v_mfma_f32_16x16x32_bf16 v[236:239], a[176:179], a[216:219], v[236:239]
    v_exp_f32 v198, v198
    v_mfma_f32_16x16x32_bf16 v[236:239], a[180:183], a[220:223], v[236:239]
    v_cvt_pk_bf16_f32 v232, v232, v233
    v_cvt_pk_bf16_f32 v233, v234, v235
    v_mfma_f32_16x16x32_bf16 v[236:239], a[184:187], a[224:227], v[236:239]
    v_exp_f32 v199, v199
    v_mfma_f32_16x16x32_bf16 v[236:239], a[188:191], a[228:231], v[236:239]
    v_cvt_pk_bf16_f32 v185, v196, v197
    v_cvt_pk_bf16_f32 v188, v198, v199
    v_mfma_f32_16x16x32_bf16 v[228:231], a[192:195], a[240:243], 0
    ds_read_b128 v[196:199], v245 offset:128
    v_mfma_f32_16x16x32_bf16 v[212:215], v[0:3], v[184:187], 0
    v_exp_f32 v200, v200
    v_mfma_f32_16x16x32_bf16 v[216:219], v[30:33], v[184:187], 0
    s_waitcnt lgkmcnt(1)
    v_cvt_pk_bf16_f32 v234, v236, v237
    v_cvt_pk_bf16_f32 v235, v238, v239
    v_mfma_f32_16x16x32_bf16 v[220:223], v[60:63], v[184:187], 0
    buffer_store_dwordx4 v[232:235], v250, s[20:23], 0 offen
    v_mfma_f32_16x16x32_bf16 v[224:227], a[248:251], v[184:187], 0
    v_exp_f32 v201, v201
    v_mfma_f32_16x16x32_bf16 v[208:211], v[162:165], v[168:171], v[208:211]
    v_mul_i32_i24 v250, s30, v255
    v_lshrrev_b32 v255, 1, v254
    v_mfma_f32_16x16x32_bf16 v[228:231], a[196:199], a[244:247], v[228:231]
    v_and_b32 v255, 4, v255
    v_and_or_b32 v255, v254, 3, v255
    v_mfma_f32_16x16x32_bf16 v[228:231], a[200:203], a[216:219], v[228:231]
    v_mad_i32_i24 v250, v255, s31, v250
    v_add_u32 v250, s56, v250
    v_mfma_f32_16x16x16_bf16 v[208:211], v[166:167], v[172:173], v[208:211]
    s_waitcnt lgkmcnt(0)
    v_lshrrev_b32 v254, 4, v254
    v_cvt_pk_bf16_f32 v190, v200, v201
    v_mfma_f32_16x16x32_bf16 v[196:199], v[90:93], v[168:171], v[196:199]
    v_exp_f32 v202, v202
    v_mfma_f32_16x16x32_bf16 v[228:231], a[204:207], a[220:223], v[228:231]
    v_exp_f32 v203, v203
    v_mfma_f32_16x16x32_bf16 v[228:231], a[208:211], a[224:227], v[228:231]
    v_cvt_pk_bf16_f32 v193, v202, v203
    v_mov_b32 v185, 0
    v_mfma_f32_16x16x16_bf16 v[196:199], v[94:95], v[172:173], v[196:199]
    ds_read_b128 v[200:203], v244 offset:192
    v_sub_u32 v244, v244, v246
    v_mfma_f32_16x16x32_bf16 v[228:231], a[212:215], a[228:231], v[228:231]
    v_exp_f32 v204, v204
    v_exp_f32 v205, v205
    v_exp_f32 v206, v206
    v_exp_f32 v207, v207
    v_cvt_pk_bf16_f32 v191, v204, v205
    v_cvt_pk_bf16_f32 v194, v206, v207
    ds_read_b128 v[204:207], v245 offset:192
    v_mfma_f32_16x16x32_bf16 v[212:215], v[4:7], v[188:191], v[212:215]
    v_cvt_pk_bf16_f32 v228, v228, v229
    v_cvt_pk_bf16_f32 v229, v230, v231
    v_mfma_f32_16x16x32_bf16 v[216:219], v[34:37], v[188:191], v[216:219]
    buffer_store_dwordx2 v[228:229], v251, s[20:23], 0 offen offset:64
    v_mfma_f32_16x16x32_bf16 v[220:223], v[64:67], v[188:191], v[220:223]
    v_lshl_add_u32 v251, v254, 3, v250
    v_lshl_add_u32 v250, v254, 4, v250
    v_mfma_f32_16x16x32_bf16 v[224:227], a[248:251], v[188:191], v[224:227]
    v_mbcnt_lo_u32_b32 v254, -1, 0
    v_mbcnt_hi_u32_b32 v254, -1, v254
    v_mfma_f32_16x16x32_bf16 v[212:215], v[8:11], v[192:195], v[212:215]
    s_waitcnt lgkmcnt(1)
    v_bfe_u32 v255, v254, 2, 1
    v_sub_u32 v245, v245, v246
    v_mfma_f32_16x16x32_bf16 v[216:219], v[38:41], v[192:195], v[216:219]
    v_exp_f32 v208, v208
    v_mfma_f32_16x16x32_bf16 v[220:223], v[68:71], v[192:195], v[220:223]
    v_exp_f32 v209, v209
    v_mfma_f32_16x16x32_bf16 v[224:227], a[248:251], v[192:195], v[224:227]
    v_exp_f32 v210, v210
    v_mfma_f32_16x16x32_bf16 v[200:203], v[114:117], v[168:171], v[200:203]
    s_waitcnt lgkmcnt(0)
    v_exp_f32 v211, v211
    v_mfma_f32_16x16x32_bf16 v[204:207], v[138:141], v[168:171], v[204:207]
    v_cvt_pk_bf16_f32 v180, v208, v209
    v_cvt_pk_bf16_f32 v183, v210, v211
    ds_read_b128 v[208:211], v244 offset:0
    v_mfma_f32_16x16x16_bf16 v[200:203], v[118:119], v[172:173], v[200:203]
    v_exp_f32 v196, v196
    v_exp_f32 v197, v197
    v_mfma_f32_16x16x16_bf16 v[204:207], v[142:143], v[172:173], v[204:207]
    v_exp_f32 v198, v198
    v_exp_f32 v199, v199
    v_cvt_pk_bf16_f32 v181, v196, v197
    v_cvt_pk_bf16_f32 v184, v198, v199
    ds_read_b128 v[196:199], v245 offset:0
    v_mfma_f32_16x16x32_bf16 v[212:215], v[12:15], v[180:183], v[212:215]
    v_exp_f32 v200, v200
    v_mfma_f32_16x16x32_bf16 v[216:219], v[42:45], v[180:183], v[216:219]
    v_exp_f32 v201, v201
    v_mfma_f32_16x16x32_bf16 v[220:223], v[72:75], v[180:183], v[220:223]
    v_cvt_pk_bf16_f32 v186, v200, v201
    v_mov_b32 v190, 0
    v_mfma_f32_16x16x32_bf16 v[224:227], a[248:251], v[180:183], v[224:227]
    ds_read_b128 v[200:203], v244 offset:64
    s_waitcnt lgkmcnt(2)
    v_mov_b32 v193, 0
    v_mfma_f32_16x16x32_bf16 v[208:211], v[162:165], v[174:177], v[208:211]
    v_exp_f32 v204, v204
    v_exp_f32 v205, v205
    v_mov_b32 v180, 0
    v_cvt_pk_bf16_f32 v187, v204, v205
    ds_read_b128 v[204:207], v245 offset:64
    v_mov_b32 v183, 0
    v_mfma_f32_16x16x32_bf16 v[212:215], v[16:19], v[184:187], v[212:215]
    v_mfma_f32_16x16x32_bf16 v[216:219], v[46:49], v[184:187], v[216:219]
    s_waitcnt lgkmcnt(2)
    v_mfma_f32_16x16x32_bf16 v[220:223], v[76:79], v[184:187], v[220:223]
    v_mfma_f32_16x16x32_bf16 v[224:227], a[248:251], v[184:187], v[224:227]
    v_mov_b32 v186, 0
    v_mfma_f32_16x16x16_bf16 v[208:211], v[166:167], v[178:179], v[208:211]
    v_mfma_f32_16x16x32_bf16 v[196:199], v[90:93], v[174:177], v[196:199]
    s_waitcnt lgkmcnt(1)
    v_mfma_f32_16x16x32_bf16 v[200:203], v[114:117], v[174:177], v[200:203]
    s_nop 2
    v_rcp_f32 v252, v224
    v_mfma_f32_16x16x16_bf16 v[196:199], v[94:95], v[178:179], v[196:199]
    s_waitcnt lgkmcnt(0)
    v_max3_f32 v248, v248, v224, v252
    v_mul_f32 v212, v212, v252
    v_mfma_f32_16x16x16_bf16 v[200:203], v[118:119], v[178:179], v[200:203]
    v_mul_f32 v213, v213, v252
    v_mul_f32 v214, v214, v252
    v_mfma_f32_16x16x32_bf16 v[204:207], v[138:141], v[174:177], v[204:207]
    v_mul_f32 v215, v215, v252
    v_cvt_pk_bf16_f32 v212, v212, v213
    v_cvt_pk_bf16_f32 v213, v214, v215
    ds_write_b64 v247, v[212:213] offset:53248
    v_mul_f32 v216, v216, v252
    v_mul_f32 v217, v217, v252
    v_mfma_f32_16x16x16_bf16 v[204:207], v[142:143], v[178:179], v[204:207]
    v_mul_f32 v218, v218, v252
    v_mul_f32 v219, v219, v252
    v_cvt_pk_bf16_f32 v216, v216, v217
    v_cvt_pk_bf16_f32 v217, v218, v219
    ds_write_b64 v247, v[216:217] offset:53280
    v_mul_f32 v220, v220, v252
    v_mul_f32 v221, v221, v252
    v_mul_f32 v222, v222, v252
    v_mul_f32 v223, v223, v252
    v_cvt_pk_bf16_f32 v220, v220, v221
    v_cvt_pk_bf16_f32 v221, v222, v223
    ds_write_b64 v247, v[220:221] offset:53312
    v_exp_f32 v208, v208
    v_exp_f32 v209, v209
    v_exp_f32 v210, v210
    v_exp_f32 v211, v211
    v_cvt_pk_bf16_f32 v188, v208, v209
    v_cvt_pk_bf16_f32 v191, v210, v211
    ds_read_b128 v[208:211], v244 offset:128
    v_exp_f32 v196, v196
    v_exp_f32 v197, v197
    v_exp_f32 v198, v198
    v_exp_f32 v199, v199
    v_cvt_pk_bf16_f32 v189, v196, v197
    v_cvt_pk_bf16_f32 v192, v198, v199
    ds_read_b128 v[196:199], v245 offset:128
    v_mfma_f32_16x16x32_bf16 v[212:215], v[12:15], v[188:191], 0
    v_exp_f32 v200, v200
    v_mfma_f32_16x16x32_bf16 v[216:219], v[42:45], v[188:191], 0
    v_exp_f32 v201, v201
    v_mfma_f32_16x16x32_bf16 v[220:223], v[72:75], v[188:191], 0
    v_exp_f32 v202, v202
    v_mfma_f32_16x16x32_bf16 v[224:227], a[248:251], v[188:191], 0
    v_exp_f32 v203, v203
    v_cvt_pk_bf16_f32 v194, v200, v201
    v_cvt_pk_bf16_f32 v181, v202, v203
    v_exp_f32 v204, v204
    v_exp_f32 v205, v205
    v_exp_f32 v206, v206
    v_exp_f32 v207, v207
    v_cvt_pk_bf16_f32 v195, v204, v205
    s_waitcnt lgkmcnt(1)
    v_mfma_f32_16x16x32_bf16 v[208:211], v[120:123], v[174:177], v[208:211]
    v_cvt_pk_bf16_f32 v182, v206, v207
    v_mov_b32 v189, 0
    v_mfma_f32_16x16x32_bf16 v[212:215], v[16:19], v[192:195], v[212:215]
    s_waitcnt lgkmcnt(0)
    v_mov_b32 v191, 0
    v_mfma_f32_16x16x32_bf16 v[216:219], v[46:49], v[192:195], v[216:219]
    v_mfma_f32_16x16x32_bf16 v[220:223], v[76:79], v[192:195], v[220:223]
    v_mfma_f32_16x16x32_bf16 v[224:227], a[248:251], v[192:195], v[224:227]
    v_mfma_f32_16x16x32_bf16 v[212:215], v[20:23], v[180:183], v[212:215]
    v_mfma_f32_16x16x32_bf16 v[216:219], v[50:53], v[180:183], v[216:219]
    v_mfma_f32_16x16x32_bf16 v[220:223], v[80:83], v[180:183], v[220:223]
    v_mfma_f32_16x16x32_bf16 v[224:227], a[248:251], v[180:183], v[224:227]
    v_mfma_f32_16x16x16_bf16 v[208:211], v[124:125], v[178:179], v[208:211]
    v_mfma_f32_16x16x32_bf16 v[196:199], v[144:147], v[174:177], v[196:199]
    s_nop 5
    v_mfma_f32_16x16x16_bf16 v[196:199], v[148:149], v[178:179], v[196:199]
    v_exp_f32 v208, v208
    v_exp_f32 v209, v209
    v_exp_f32 v210, v210
    v_exp_f32 v211, v211
    v_cvt_pk_bf16_f32 v184, v208, v209
    v_cvt_pk_bf16_f32 v187, v210, v211
    s_nop 1
    v_exp_f32 v196, v196
    v_exp_f32 v197, v197
    v_exp_f32 v198, v198
    v_exp_f32 v199, v199
    v_cvt_pk_bf16_f32 v185, v196, v197
    v_cvt_pk_bf16_f32 v188, v198, v199
    s_nop 0
    v_mfma_f32_16x16x32_bf16 v[212:215], v[24:27], v[184:187], v[212:215]
    v_mfma_f32_16x16x32_bf16 v[216:219], v[54:57], v[184:187], v[216:219]
    v_mfma_f32_16x16x32_bf16 v[220:223], v[84:87], v[184:187], v[220:223]
    v_mfma_f32_16x16x32_bf16 v[224:227], a[248:251], v[184:187], v[224:227]
    v_mfma_f32_16x16x32_bf16 v[212:215], v[28:31], v[188:191], v[212:215]
    v_mfma_f32_16x16x32_bf16 v[216:219], v[58:61], v[188:191], v[216:219]
    v_mfma_f32_16x16x32_bf16 v[220:223], v[88:91], v[188:191], v[220:223]
    v_mfma_f32_16x16x32_bf16 v[224:227], a[248:251], v[188:191], v[224:227]
    s_nop 7
    v_rcp_f32 v252, v224
    s_nop 0
    v_max3_f32 v248, v248, v224, v252
    v_mul_f32 v212, v212, v252
    v_mul_f32 v213, v213, v252
    v_mul_f32 v214, v214, v252
    v_mul_f32 v215, v215, v252
    v_cvt_pk_bf16_f32 v212, v212, v213
    v_cvt_pk_bf16_f32 v213, v214, v215
    ds_write_b64 v247, v[212:213] offset:59904
    v_mul_f32 v216, v216, v252
    v_mul_f32 v217, v217, v252
    v_mul_f32 v218, v218, v252
    v_mul_f32 v219, v219, v252
    v_cvt_pk_bf16_f32 v216, v216, v217
    v_cvt_pk_bf16_f32 v217, v218, v219
    ds_write_b64 v247, v[216:217] offset:59936
    v_mul_f32 v220, v220, v252
    v_mul_f32 v221, v221, v252
    v_mul_f32 v222, v222, v252
    v_mul_f32 v223, v223, v252
    v_cvt_pk_bf16_f32 v220, v220, v221
    v_cvt_pk_bf16_f32 v221, v222, v223
    ds_write_b64 v247, v[220:221] offset:59968
    v_cmp_gt_f32 vcc, v248, v253
    v_mov_b32 v253, s67
    s_nop 0
    s_cmp_lg_u64 vcc, 0
    s_cselect_b32 s66, 1, 0
    v_mov_b32 v252, s66
    ds_write_b32 v253, v252 offset:0
    v_mov_b32 v253, 0x23000
    s_waitcnt lgkmcnt(0)
    s_barrier
    ds_read_b128 a[232:235], v249 offset:53248
    ds_read_b128 a[236:239], v249 offset:53312
    ds_read_b128 a[240:243], v249 offset:53376
    ds_read_b128 a[244:247], v249 offset:53440
    ds_read_b128 a[216:219], v249 offset:53504
    ds_read_b128 a[220:223], v249 offset:53568
    ds_read_b128 a[224:227], v249 offset:59904
    ds_read_b128 a[228:231], v249 offset:59968
    ds_read_b128 v[196:199], v253 offset:0
    s_waitcnt lgkmcnt(8)
    v_mfma_f32_16x16x32_bf16 v[232:235], a[144:147], a[232:235], 0
    s_waitcnt lgkmcnt(7)
    v_mfma_f32_16x16x32_bf16 v[232:235], a[148:151], a[236:239], v[232:235]
    s_waitcnt lgkmcnt(5)
    v_mfma_f32_16x16x32_bf16 v[232:235], a[152:155], a[240:243], v[232:235]
    v_mfma_f32_16x16x32_bf16 v[232:235], a[156:159], a[244:247], v[232:235]
    s_waitcnt lgkmcnt(1)
    v_mfma_f32_16x16x32_bf16 v[232:235], a[160:163], a[216:219], v[232:235]
    s_waitcnt lgkmcnt(0)
    v_or3_b32 v252, v196, v197, v198
    v_or_b32 v252, v252, v199
    v_mfma_f32_16x16x32_bf16 v[232:235], a[164:167], a[220:223], v[232:235]
    v_readfirstlane_b32 s47, v252
    v_mfma_f32_16x16x32_bf16 v[236:239], a[168:171], a[232:235], 0
    v_mfma_f32_16x16x32_bf16 v[236:239], a[172:175], a[236:239], v[236:239]
    v_mfma_f32_16x16x32_bf16 v[236:239], a[176:179], a[240:243], v[236:239]
    v_mfma_f32_16x16x32_bf16 v[236:239], a[180:183], a[244:247], v[236:239]
    v_mfma_f32_16x16x32_bf16 v[236:239], a[184:187], a[216:219], v[236:239]
    v_mfma_f32_16x16x32_bf16 v[236:239], a[188:191], a[220:223], v[236:239]
    v_mfma_f32_16x16x32_bf16 v[228:231], a[192:195], a[232:235], 0
    ds_read_b128 a[232:235], v249 offset:60032
    v_cvt_pk_bf16_f32 v232, v232, v233
    v_mfma_f32_16x16x32_bf16 v[228:231], a[196:199], a[236:239], v[228:231]
    ds_read_b128 a[236:239], v249 offset:60096
    v_cvt_pk_bf16_f32 v233, v234, v235
    v_mfma_f32_16x16x32_bf16 v[228:231], a[200:203], a[240:243], v[228:231]
    ds_read_b128 a[240:243], v249 offset:60160
    v_cvt_pk_bf16_f32 v234, v236, v237
    v_mfma_f32_16x16x32_bf16 v[228:231], a[204:207], a[244:247], v[228:231]
    ds_read_b128 a[244:247], v249 offset:60224
    v_cvt_pk_bf16_f32 v235, v238, v239
    v_mfma_f32_16x16x32_bf16 v[228:231], a[208:211], a[216:219], v[228:231]
    buffer_store_dwordx4 v[232:235], v250, s[20:23], 0 offen
    v_mfma_f32_16x16x32_bf16 v[228:231], a[212:215], a[220:223], v[228:231]
    v_mfma_f32_16x16x32_bf16 v[236:239], a[168:171], a[224:227], 0
    v_mul_i32_i24 v250, s30, v255
    v_lshrrev_b32 v255, 1, v254
    v_mfma_f32_16x16x32_bf16 v[232:235], a[144:147], a[224:227], 0
    v_and_b32 v255, 4, v255
    v_and_or_b32 v255, v254, 3, v255
    v_mfma_f32_16x16x32_bf16 v[232:235], a[148:151], a[228:231], v[232:235]
    s_waitcnt lgkmcnt(3)
    v_cvt_pk_bf16_f32 v228, v228, v229
    v_cvt_pk_bf16_f32 v229, v230, v231
    v_mfma_f32_16x16x32_bf16 v[232:235], a[152:155], a[232:235], v[232:235]
    buffer_store_dwordx2 v[228:229], v251, s[20:23], 0 offen offset:64
    v_mfma_f32_16x16x32_bf16 v[236:239], a[172:175], a[228:231], v[236:239]
    s_waitcnt lgkmcnt(1)
    v_mad_i32_i24 v250, v255, s31, v250
    v_add_u32 v250, s58, v250
    v_mfma_f32_16x16x32_bf16 v[232:235], a[156:159], a[236:239], v[232:235]
    v_cmp_gt_u32 vcc, 6, v255
    v_add_u32 v250, 0x80000000, v250
    v_mfma_f32_16x16x32_bf16 v[232:235], a[160:163], a[240:243], v[232:235]
    s_waitcnt lgkmcnt(0)
    v_cndmask_b32 v250, 0, v250, vcc
    v_add_u32 v250, 0x80000000, v250
    v_mfma_f32_16x16x32_bf16 v[232:235], a[164:167], a[244:247], v[232:235]
    v_lshrrev_b32 v254, 4, v254
    v_lshl_add_u32 v251, v254, 3, v250
    v_mfma_f32_16x16x32_bf16 v[236:239], a[176:179], a[232:235], v[236:239]
    v_lshl_add_u32 v250, v254, 4, v250
    v_mfma_f32_16x16x32_bf16 v[236:239], a[180:183], a[236:239], v[236:239]
    v_mfma_f32_16x16x32_bf16 v[236:239], a[184:187], a[240:243], v[236:239]
    v_mfma_f32_16x16x32_bf16 v[236:239], a[188:191], a[244:247], v[236:239]
    v_mfma_f32_16x16x32_bf16 v[228:231], a[192:195], a[224:227], 0
    v_cvt_pk_bf16_f32 v232, v232, v233
    v_cvt_pk_bf16_f32 v233, v234, v235
    v_mfma_f32_16x16x32_bf16 v[228:231], a[196:199], a[228:231], v[228:231]
    v_mfma_f32_16x16x32_bf16 v[228:231], a[200:203], a[232:235], v[228:231]
    v_mfma_f32_16x16x32_bf16 v[228:231], a[204:207], a[236:239], v[228:231]
    v_mfma_f32_16x16x32_bf16 v[228:231], a[208:211], a[240:243], v[228:231]
    v_mfma_f32_16x16x32_bf16 v[228:231], a[212:215], a[244:247], v[228:231]
    v_cvt_pk_bf16_f32 v234, v236, v237
    v_cvt_pk_bf16_f32 v235, v238, v239
    buffer_store_dwordx4 v[232:235], v250, s[20:23], 0 offen
    s_nop 4
    v_cvt_pk_bf16_f32 v228, v228, v229
    v_cvt_pk_bf16_f32 v229, v230, v231
    buffer_store_dwordx2 v[228:229], v251, s[20:23], 0 offen offset:64
    s_nop 4
    s_cmp_lg_u32 s47, 0
    s_cbranch_scc1 L_safe
L_exit:
    s_endpgm
L_safe:
    s_waitcnt vmcnt(0) lgkmcnt(0)
    s_nop 7
    s_barrier
    v_mbcnt_lo_u32_b32 v1, -1, 0
    v_mbcnt_hi_u32_b32 v1, -1, v1
    s_lshl_b32 s50, s28, 1
    s_mul_i32 s51, s36, 7
    v_add_u32 v2, 0, v1
    v_mul_u32_u24 v3, 0xaab, v2
    v_lshrrev_b32 v3, 16, v3
    v_mul_u32_u24 v4, 24, v3
    v_sub_u32 v2, v2, v4
    v_bfe_u32 v4, v3, 1, 1
    v_or_b32 v4, s50, v4
    v_xor_b32 v2, v2, v4
    v_xor_b32 v3, s51, v3
    v_mul_u32_u24 v3, 0x300, v3
    v_lshl_add_u32 v168, v2, 4, v3
    v_add_u32 v2, 64, v1
    v_mul_u32_u24 v3, 0xaab, v2
    v_lshrrev_b32 v3, 16, v3
    v_mul_u32_u24 v4, 24, v3
    v_sub_u32 v2, v2, v4
    v_bfe_u32 v4, v3, 1, 1
    v_or_b32 v4, s50, v4
    v_xor_b32 v2, v2, v4
    v_xor_b32 v3, s51, v3
    v_mul_u32_u24 v3, 0x300, v3
    v_lshl_add_u32 v169, v2, 4, v3
    v_add_u32 v2, 0x80, v1
    v_mul_u32_u24 v3, 0xaab, v2
    v_lshrrev_b32 v3, 16, v3
    v_mul_u32_u24 v4, 24, v3
    v_sub_u32 v2, v2, v4
    v_bfe_u32 v4, v3, 1, 1
    v_or_b32 v4, s50, v4
    v_xor_b32 v2, v2, v4
    v_xor_b32 v3, s51, v3
    v_mul_u32_u24 v3, 0x300, v3
    v_lshl_add_u32 v170, v2, 4, v3
    v_add_u32 v2, 32, v1
    v_mul_u32_u24 v3, 0xaab, v2
    v_lshrrev_b32 v3, 16, v3
    v_mul_u32_u24 v4, 24, v3
    v_sub_u32 v2, v2, v4
    v_bfe_u32 v4, v3, 1, 1
    v_or_b32 v4, s50, v4
    v_xor_b32 v2, v2, v4
    v_xor_b32 v3, s51, v3
    v_mul_u32_u24 v3, 0x300, v3
    v_lshl_add_u32 v171, v2, 4, v3
    v_add_u32 v2, 0, v1
    v_mul_u32_u24 v3, 0x2aab, v2
    v_lshrrev_b32 v3, 16, v3
    v_mul_u32_u24 v4, 6, v3
    v_sub_u32 v2, v2, v4
    v_lshrrev_b32 v4, 1, v3
    v_and_b32 v4, 4, v4
    v_xor_b32 v3, v3, v4
    v_mul_u32_u24 v3, 0x480, v3
    v_lshl_add_u32 v172, v2, 4, v3
    v_add_u32 v2, 64, v1
    v_mul_u32_u24 v3, 0x2aab, v2
    v_lshrrev_b32 v3, 16, v3
    v_mul_u32_u24 v4, 6, v3
    v_sub_u32 v2, v2, v4
    v_lshrrev_b32 v4, 1, v3
    v_and_b32 v4, 4, v4
    v_xor_b32 v3, v3, v4
    v_mul_u32_u24 v3, 0x480, v3
    v_lshl_add_u32 v173, v2, 4, v3
    v_add_u32 v2, 0x80, v1
    v_mul_u32_u24 v3, 0x2aab, v2
    v_lshrrev_b32 v3, 16, v3
    v_mul_u32_u24 v4, 6, v3
    v_sub_u32 v2, v2, v4
    v_lshrrev_b32 v4, 1, v3
    v_and_b32 v4, 4, v4
    v_xor_b32 v3, v3, v4
    v_mul_u32_u24 v3, 0x480, v3
    v_lshl_add_u32 v174, v2, 4, v3
L_safe2:
    s_add_u32 s51, s39, 0x180
    s_add_u32 m0, s29, 0
    v_add_u32 v5, s40, v168
    buffer_load_dwordx4 v172, s[8:11], s51 offen lds
    s_add_u32 m0, s29, 0x400
    v_max_i32 v5, 0, v5
    buffer_load_dwordx4 v173, s[8:11], s51 offen lds
    s_add_u32 m0, s29, 0x800
    v_add_u32 v6, s40, v169
    buffer_load_dwordx4 v174, s[8:11], s51 offen lds
    s_add_u32 m0, s46, 0
    v_max_i32 v6, 0, v6
    buffer_load_dwordx4 v5, s[4:7], 0 offen lds
    s_add_u32 m0, s46, 0x400
    v_add_u32 v7, s40, v170
    buffer_load_dwordx4 v6, s[4:7], 0 offen lds
    s_add_u32 m0, s46, 0x800
    v_max_i32 v7, 0, v7
    buffer_load_dwordx4 v7, s[4:7], 0 offen lds
    s_add_u32 s52, s40, s45
    s_add_u32 m0, s46, 0xc00
    s_add_u32 s53, s40, s45
    buffer_load_dwordx4 v168, s[4:7], s52 offen lds
    s_add_u32 m0, s46, 0x1000
    s_add_u32 s54, s40, s45
    buffer_load_dwordx4 v169, s[4:7], s53 offen lds
    s_add_u32 m0, s46, 0x1400
    s_lshl1_add_u32 s55, s45, s40
    buffer_load_dwordx4 v170, s[4:7], s54 offen lds
    s_add_u32 m0, s46, 0x1800
    s_lshl1_add_u32 s56, s45, s40
    s_add_u32 s57, s39, 0x9180
    s_add_u32 s58, s39, 0x12180
    s_add_u32 s59, s39, 0x1b180
    v_and_b32 v13, 15, v1
    v_lshrrev_b32 v14, 4, v1
    v_lshrrev_b32 v15, 2, v13
    v_and_b32 v16, 3, v13
    v_and_b32 v17, 1, v14
    v_lshl_add_u32 v18, v14, 3, v15
    v_xor_b32 v19, 0, v17
    v_lshl_add_u32 v19, v19, 2, v18
    v_mul_u32_u24 v19, 0x60, v19
    v_lshl_add_u32 v19, v16, 3, v19
    v_add_u32 v249, s29, v19
    v_xor_b32 v19, 1, v17
    v_lshl_add_u32 v19, v19, 2, v18
    v_mul_u32_u24 v19, 0x60, v19
    v_lshl_add_u32 v19, v16, 3, v19
    v_add_u32 v250, s29, v19
    v_mov_b32 v17, v15
    v_and_b32 v18, 3, v17
    v_mul_u32_u24 v17, 0x1e00, v17
    v_lshlrev_b32 v18, 1, v18
    v_bfe_u32 v241, v16, 1, 1
    v_or_b32 v18, v18, v241
    v_xor_b32 v18, v18, v14
    v_lshl_add_u32 v17, v18, 4, v17
    v_mul_u32_u24 v18, 0x180, v16
    v_add_u32 v240, v17, v18
    v_xor_b32 v241, 64, v240
    s_add_u32 s54, s39, 0x24180
    v_mbcnt_lo_u32_b32 v24, -1, 0
    v_mbcnt_hi_u32_b32 v24, -1, v24
    v_add_u32 v25, 0, v24
    v_mul_u32_u24 v26, 0x2aab, v25
    v_lshrrev_b32 v26, 16, v26
    v_mul_u32_u24 v27, 6, v26
    v_sub_u32 v25, v25, v27
    v_lshrrev_b32 v27, 1, v26
    v_and_b32 v27, 4, v27
    v_xor_b32 v26, v26, v27
    v_mul_u32_u24 v26, 0x180, v26
    v_lshl_add_u32 v28, v25, 4, v26
    v_add_u32 v25, 64, v24
    v_mul_u32_u24 v26, 0x2aab, v25
    v_lshrrev_b32 v26, 16, v26
    v_mul_u32_u24 v27, 6, v26
    v_sub_u32 v25, v25, v27
    v_lshrrev_b32 v27, 1, v26
    v_and_b32 v27, 4, v27
    v_xor_b32 v26, v26, v27
    v_mul_u32_u24 v26, 0x180, v26
    v_lshl_add_u32 v29, v25, 4, v26
    v_add_u32 v25, 0x80, v24
    v_mul_u32_u24 v26, 0x2aab, v25
    v_lshrrev_b32 v26, 16, v26
    v_mul_u32_u24 v27, 6, v26
    v_sub_u32 v25, v25, v27
    v_lshrrev_b32 v27, 1, v26
    v_and_b32 v27, 4, v27
    v_xor_b32 v26, v26, v27
    v_mul_u32_u24 v26, 0x180, v26
    v_lshl_add_u32 v58, v25, 4, v26
    v_mbcnt_lo_u32_b32 v253, -1, 0
    v_mbcnt_hi_u32_b32 v253, -1, v253
    v_and_b32 v253, 2, v253
    v_add_u32 v17, 3, v15
    v_add_u32 v19, 3, v16
    v_and_b32 v18, 3, v17
    v_mul_u32_u24 v17, 0x1e00, v17
    v_lshlrev_b32 v18, 1, v18
    v_bfe_u32 v243, v19, 1, 1
    v_or_b32 v18, v18, v243
    v_xor_b32 v18, v18, v14
    v_lshl_add_u32 v17, v18, 4, v17
    v_mul_u32_u24 v18, 0x180, v19
    v_add_u32 v242, v17, v18
    v_xor_b32 v243, 64, v242
    v_accvgpr_write_b32 a252, v168
    v_accvgpr_read_b32 v254, a252
    v_accvgpr_write_b32 a253, v169
    v_accvgpr_read_b32 v255, a253
    v_accvgpr_write_b32 a254, v170
    v_accvgpr_write_b32 a255, v171
    v_mov_b32 v17, 0x3f803f80
    v_accvgpr_write_b32 a248, v17
    v_accvgpr_write_b32 a249, v17
    v_accvgpr_write_b32 a250, v17
    v_accvgpr_write_b32 a251, v17
    v_mov_b32 v248, 0
    v_mul_u32_u24 v17, 0x1a0, v13
    v_lshl_add_u32 v17, v14, 3, v17
    v_add_u32 v17, s39, v17
    v_add_u32 v247, 0x7800, v17
    v_add_u32 v251, 0x1e000, v17
    v_sub_u32 v17, v14, v15
    v_mul_i32_i24 v17, 0x1c0, v17
    v_lshlrev_b32 v18, 4, v16
    v_sub_u32 v17, v17, v18
    v_add_u32 v17, s37, v17
    v_max_u32 v18, s33, v15
    v_sub_u32 v18, v14, v18
    v_add_u32 v244, 0, v18
    v_cmp_gt_u32 vcc, 7, v244
    v_add_u32 v244, 0xfffdc870, v17
    v_add_u32 v245, 4, v18
    v_cndmask_b32 v244, 0, v244, vcc
    v_add_u32 v244, 0x237c0, v244
    v_cmp_gt_u32 vcc, 7, v245
    v_add_u32 v245, 0xfffdcf70, v17
    v_add_u32 v246, 8, v18
    v_cndmask_b32 v245, 0, v245, vcc
    v_add_u32 v245, 0x237c0, v245
    v_cmp_gt_u32 vcc, 7, v246
    v_add_u32 v246, 0xfffdd670, v17
    v_min_u32 v20, 55, v1
    v_cndmask_b32 v246, 0, v246, vcc
    v_add_u32 v246, 0x237c0, v246
    v_lshlrev_b32 v62, 3, v20
    v_add_u32 v62, s37, v62
    v_lshrrev_b32 v21, 1, v20
    v_and_b32 v20, 1, v20
    v_lshlrev_b32 v20, 1, v20
    v_add_u32 v22, -12, v21
    v_cmp_lt_u32 vcc, 11, v21
    v_mov_b32 v23, s34
    s_lshl_b32 s66, s36, 1
    v_cndmask_b32 v22, v21, v22, vcc
    v_cndmask_b32 v23, 0, v23, vcc
    s_sub_u32 s66, 1, s66
    v_add_u32 v63, 0, v20
    v_add3_u32 v64, v22, v63, -6
    v_add_u32 v65, 3, v64
    v_and_b32 v66, 12, v22
    v_add3_u32 v66, v66, v63, -3
    v_cmp_ne_u32 vcc, 0, v23
    v_mul_i32_i24 v64, s66, v64
    v_add_lshl_u32 v64, v64, 6, 1
    v_cndmask_b32 v65, v65, v66, vcc
    v_cmp_gt_u32 vcc, 7, v65
    v_mov_b32 v65, 0xf149f2ca
    v_add_u32 v63, 1, v20
    v_cndmask_b32 v50, 0, v64, vcc
    v_mov_b32 v64, 0x3fb8aa3b
    v_cndmask_b32 v52, 0, v64, vcc
    v_mov_b32 v64, 0
    v_cndmask_b32 v60, v65, v64, vcc
    v_add3_u32 v64, v22, v63, -6
    v_add_u32 v65, 3, v64
    v_and_b32 v66, 12, v22
    v_add3_u32 v66, v66, v63, -3
    v_cmp_ne_u32 vcc, 0, v23
    v_mul_i32_i24 v64, s66, v64
    s_mul_i32 s66, s28, 0x4800
    v_lshl_add_u32 v89, v24, 4, s66
    v_and_b32 v24, 3, v24
    v_lshl_add_u32 v59, v24, 3, v249
    v_lshl_add_u32 v88, v24, 3, v250
    s_mul_i32 s66, s28, 0x4800
    v_cndmask_b32 v65, v65, v66, vcc
    v_cmp_gt_u32 vcc, 7, v65
    v_add_lshl_u32 v64, v64, 6, 1
    v_mov_b32 v65, 0xf149f2ca
    v_cndmask_b32 v51, 0, v64, vcc
    v_mov_b32 v64, 0x3fb8aa3b
    v_cndmask_b32 v53, 0, v64, vcc
    v_mov_b32 v64, 0
    v_cndmask_b32 v61, v65, v64, vcc
    v_cmp_eq_u32 vcc, 0, v253
    v_add_u32 v253, 0xfffdd200, v247
    s_mul_i32 s60, s49, 0
    v_cndmask_b32 v253, 0, v253, vcc
    v_add_u32 v253, 0x22e00, v253
    s_add_u32 s60, s60, s48
    buffer_load_ushort v30, v50, s[16:19], s60 offen
    buffer_load_ushort v31, v51, s[16:19], s60 offen
    s_lshl1_add_u32 s60, s45, s41
    s_mul_i32 s61, s49, 1
    s_add_u32 s61, s61, s48
    buffer_load_ushort v32, v50, s[16:19], s61 offen
    buffer_load_ushort v33, v51, s[16:19], s61 offen
    s_add_u32 s61, s39, 0x300
    s_mul_i32 s62, s49, 2
    s_add_u32 s62, s62, s48
    buffer_load_ushort v34, v50, s[16:19], s62 offen
    buffer_load_ushort v35, v51, s[16:19], s62 offen
    s_add_u32 s62, s39, 0x9300
    s_mul_i32 s63, s49, 3
    s_add_u32 s63, s63, s48
    buffer_load_ushort v36, v50, s[16:19], s63 offen
    buffer_load_ushort v37, v51, s[16:19], s63 offen
    buffer_load_dwordx4 v168, s[4:7], s55 offen lds
    s_add_u32 m0, s46, 0x1a00
    s_add_u32 s55, s39, 0x2d180
    s_add_u32 s63, s39, 0x12300
    s_mul_i32 s64, s49, 4
    s_add_u32 s64, s64, s48
    buffer_load_ushort v38, v50, s[16:19], s64 offen
    buffer_load_ushort v39, v51, s[16:19], s64 offen
    s_add_u32 s64, s39, 0x1b300
    s_mul_i32 s65, s49, 5
    s_add_u32 s65, s65, s48
    buffer_load_ushort v40, v50, s[16:19], s65 offen
    buffer_load_ushort v41, v51, s[16:19], s65 offen
    s_add_u32 s65, s42, s45
    s_mul_i32 s50, s49, 6
    s_add_u32 s50, s50, s48
    buffer_load_ushort v42, v50, s[16:19], s50 offen
    buffer_load_ushort v43, v51, s[16:19], s50 offen
    s_add_u32 s50, s42, s45
    s_mul_i32 s51, s49, 7
    s_add_u32 s51, s51, s48
    buffer_load_ushort v44, v50, s[16:19], s51 offen
    buffer_load_ushort v45, v51, s[16:19], s51 offen
    s_add_u32 s51, s42, s45
    s_mul_i32 s52, s49, 8
    s_add_u32 s52, s52, s48
    buffer_load_ushort v46, v50, s[16:19], s52 offen
    buffer_load_dwordx4 v171, s[4:7], s56 offen lds
    s_add_u32 m0, s29, 0xc00
    s_add_u32 s56, s41, s45
    buffer_load_ushort v47, v51, s[16:19], s52 offen
    s_lshl1_add_u32 s52, s45, s42
    s_mul_i32 s53, s49, 9
    s_add_u32 s53, s53, s48
    buffer_load_ushort v48, v50, s[16:19], s53 offen
    buffer_load_ushort v49, v51, s[16:19], s53 offen
    s_lshl1_add_u32 s53, s45, s42
    v_mov_b32 v64, 0xf149f2ca
    v_mov_b32 v65, 0xf149f2ca
    v_lshlrev_b32 v63, 3, v1
    v_add_u32 v63, 0x237c0, v63
    ds_write_b64 v63, v[64:65] offset:0
    buffer_load_dwordx4 v172, s[8:11], s57 offen lds
    s_waitcnt vmcnt(29)
    s_add_u32 m0, s29, 0x1000
    ds_read_b64_tr_b16 a[0:1], v249 offset:0
    ds_read_b64_tr_b16 a[2:3], v250 offset:0
    ds_read_b64_tr_b16 a[24:25], v249 offset:32
    ds_read_b64_tr_b16 a[26:27], v250 offset:32
    ds_read_b64_tr_b16 a[48:49], v249 offset:64
    ds_read_b64_tr_b16 a[50:51], v250 offset:64
    buffer_load_dwordx4 v173, s[8:11], s57 offen lds
    s_add_u32 m0, s29, 0x1400
    s_nop 0
    buffer_load_dwordx4 v174, s[8:11], s57 offen lds
    s_add_u32 m0, s29, 0x1800
    s_add_u32 s57, s41, s45
    buffer_load_dwordx4 v172, s[8:11], s58 offen lds
    s_add_u32 m0, s29, 0x1c00
    s_nop 0
    buffer_load_dwordx4 v173, s[8:11], s58 offen lds
    s_add_u32 m0, s29, 0x2000
    s_nop 0
    buffer_load_dwordx4 v174, s[8:11], s58 offen lds
    s_add_u32 m0, s29, 0x2400
    s_add_u32 s58, s41, s45
    buffer_load_dwordx4 v172, s[8:11], s59 offen lds
    s_add_u32 m0, s29, 0x2800
    s_nop 0
    s_waitcnt vmcnt(28)
    v_lshlrev_b32 v30, 16, v30
    v_fma_f32 v30, v30, v52, v60
    s_waitcnt vmcnt(27)
    v_lshlrev_b32 v31, 16, v31
    v_fma_f32 v31, v31, v53, v61
    ds_write_b64 v62, v[30:31] offset:0
    s_waitcnt vmcnt(26)
    v_lshlrev_b32 v32, 16, v32
    v_fma_f32 v32, v32, v52, v60
    s_waitcnt vmcnt(25)
    v_lshlrev_b32 v33, 16, v33
    v_fma_f32 v33, v33, v53, v61
    ds_write_b64 v62, v[32:33] offset:448
    s_waitcnt vmcnt(23)
    v_lshlrev_b32 v34, 16, v34
    v_fma_f32 v34, v34, v52, v60
    v_lshlrev_b32 v35, 16, v35
    v_fma_f32 v35, v35, v53, v61
    ds_write_b64 v62, v[34:35] offset:896
    s_waitcnt vmcnt(21)
    v_lshlrev_b32 v36, 16, v36
    v_fma_f32 v36, v36, v52, v60
    v_lshlrev_b32 v37, 16, v37
    v_fma_f32 v37, v37, v53, v61
    ds_write_b64 v62, v[36:37] offset:1344
    buffer_load_dwordx4 v173, s[8:11], s59 offen lds
    s_add_u32 m0, s29, 0x2c00
    s_nop 0
    s_waitcnt vmcnt(20)
    v_lshlrev_b32 v38, 16, v38
    v_fma_f32 v38, v38, v52, v60
    s_waitcnt vmcnt(19)
    v_lshlrev_b32 v39, 16, v39
    v_fma_f32 v39, v39, v53, v61
    ds_write_b64 v62, v[38:39] offset:1792
    s_waitcnt vmcnt(18)
    v_lshlrev_b32 v40, 16, v40
    v_fma_f32 v40, v40, v52, v60
    s_waitcnt vmcnt(17)
    v_lshlrev_b32 v41, 16, v41
    v_fma_f32 v41, v41, v53, v61
    ds_write_b64 v62, v[40:41] offset:2240
    s_waitcnt vmcnt(15)
    v_lshlrev_b32 v42, 16, v42
    v_fma_f32 v42, v42, v52, v60
    v_lshlrev_b32 v43, 16, v43
    v_fma_f32 v43, v43, v53, v61
    ds_write_b64 v62, v[42:43] offset:2688
    s_waitcnt vmcnt(13)
    v_lshlrev_b32 v44, 16, v44
    v_fma_f32 v44, v44, v52, v60
    v_lshlrev_b32 v45, 16, v45
    v_fma_f32 v45, v45, v53, v61
    ds_write_b64 v62, v[44:45] offset:3136
    s_waitcnt vmcnt(12)
    v_lshlrev_b32 v46, 16, v46
    v_fma_f32 v46, v46, v52, v60
    buffer_load_dwordx4 v174, s[8:11], s59 offen lds
    s_waitcnt vmcnt(12)
    s_add_u32 m0, s29, 0
    s_lshl1_add_u32 s59, s45, s41
    s_barrier
    ds_read_b128 a[216:219], v240 offset:0
    s_waitcnt vmcnt(11) lgkmcnt(2)
    ds_read_b128 a[220:223], v240 offset:1536
    s_waitcnt vmcnt(10)
    ds_read_b128 a[224:227], v240 offset:3072
    ds_read_b128 a[228:231], v240 offset:4608
    s_waitcnt vmcnt(9)
    ds_read_b128 a[232:235], v241 offset:0
    ds_read_b128 a[236:239], v241 offset:1536
    ds_read_b128 a[240:243], v241 offset:3072
    ds_read_b128 a[244:247], v241 offset:4608
    v_lshlrev_b32 v47, 16, v47
    v_fma_f32 v47, v47, v53, v61
    ds_write_b64 v62, v[46:47] offset:3584
    v_lshlrev_b32 v48, 16, v48
    v_fma_f32 v48, v48, v52, v60
    v_lshlrev_b32 v49, 16, v49
    v_fma_f32 v49, v49, v53, v61
    ds_write_b64 v62, v[48:49] offset:4032
    s_waitcnt lgkmcnt(9)
    v_mfma_f32_16x16x32_bf16 v[180:183], a[0:3], a[216:219], 0
    buffer_load_dwordx4 v172, s[8:11], s54 offen lds
    s_add_u32 m0, s29, 0x400
    s_waitcnt lgkmcnt(7)
    v_mfma_f32_16x16x32_bf16 v[184:187], a[24:27], a[216:219], 0
    s_waitcnt lgkmcnt(6)
    v_mfma_f32_16x16x32_bf16 v[188:191], a[48:51], a[216:219], 0
    ds_read_b128 a[216:219], v240 offset:128
    v_mfma_f32_16x16x32_bf16 v[192:195], a[0:3], a[220:223], 0
    v_mfma_f32_16x16x32_bf16 v[196:199], a[24:27], a[220:223], 0
    v_mfma_f32_16x16x32_bf16 v[200:203], a[48:51], a[220:223], 0
    ds_read_b128 a[220:223], v240 offset:1664
    v_mfma_f32_16x16x32_bf16 v[204:207], a[0:3], a[224:227], 0
    v_mfma_f32_16x16x32_bf16 v[208:211], a[24:27], a[224:227], 0
    buffer_load_dwordx4 v173, s[8:11], s54 offen lds
    s_add_u32 m0, s29, 0x800
    v_mfma_f32_16x16x32_bf16 v[212:215], a[48:51], a[224:227], 0
    ds_read_b128 a[224:227], v240 offset:3200
    v_mfma_f32_16x16x32_bf16 v[216:219], a[0:3], a[228:231], 0
    v_mfma_f32_16x16x32_bf16 v[220:223], a[24:27], a[228:231], 0
    v_mfma_f32_16x16x32_bf16 v[224:227], a[48:51], a[228:231], 0
    ds_read_b128 a[228:231], v240 offset:4736
    buffer_load_dwordx4 v174, s[8:11], s54 offen lds
    s_waitcnt vmcnt(9)
    ds_read_b64_tr_b16 a[4:5], v249 offset:3072
    ds_read_b64_tr_b16 a[6:7], v250 offset:3072
    ds_read_b64_tr_b16 a[28:29], v249 offset:3104
    ds_read_b64_tr_b16 a[30:31], v250 offset:3104
    ds_read_b64_tr_b16 a[52:53], v249 offset:3136
    ds_read_b64_tr_b16 a[54:55], v250 offset:3136
    s_add_u32 m0, s29, 0xc00
    s_add_u32 s54, s39, 0x24300
    s_waitcnt lgkmcnt(4)
    v_mfma_f32_16x16x32_bf16 v[180:183], a[4:7], a[232:235], v[180:183]
    v_mfma_f32_16x16x32_bf16 v[192:195], a[4:7], a[236:239], v[192:195]
    s_waitcnt lgkmcnt(1)
    v_mfma_f32_16x16x32_bf16 v[184:187], a[28:31], a[232:235], v[184:187]
    s_waitcnt lgkmcnt(0)
    buffer_load_dwordx4 v172, s[8:11], s55 offen lds
    v_mfma_f32_16x16x32_bf16 v[188:191], a[52:55], a[232:235], v[188:191]
    ds_read_b128 a[232:235], v241 offset:128
    s_add_u32 m0, s29, 0x1000
    v_mfma_f32_16x16x32_bf16 v[196:199], a[28:31], a[236:239], v[196:199]
    v_mfma_f32_16x16x32_bf16 v[200:203], a[52:55], a[236:239], v[200:203]
    buffer_load_dwordx4 v173, s[8:11], s55 offen lds
    s_add_u32 m0, s29, 0x1400
    v_mfma_f32_16x16x32_bf16 v[204:207], a[4:7], a[240:243], v[204:207]
    ds_read_b128 a[236:239], v241 offset:1664
    v_mfma_f32_16x16x32_bf16 v[208:211], a[28:31], a[240:243], v[208:211]
    v_mfma_f32_16x16x32_bf16 v[212:215], a[52:55], a[240:243], v[212:215]
    ds_read_b128 a[240:243], v241 offset:3200
    v_mfma_f32_16x16x32_bf16 v[216:219], a[4:7], a[244:247], v[216:219]
    v_mfma_f32_16x16x32_bf16 v[220:223], a[28:31], a[244:247], v[220:223]
    v_mfma_f32_16x16x32_bf16 v[224:227], a[52:55], a[244:247], v[224:227]
    s_waitcnt vmcnt(8)
    buffer_load_dwordx4 v174, s[8:11], s55 offen lds
    s_add_u32 m0, s46, 0x7800
    ds_read_b64_tr_b16 a[8:9], v249 offset:6144
    ds_read_b64_tr_b16 a[10:11], v250 offset:6144
    ds_read_b64_tr_b16 a[32:33], v249 offset:6176
    ds_read_b64_tr_b16 a[34:35], v250 offset:6176
    ds_read_b64_tr_b16 a[56:57], v249 offset:6208
    ds_read_b64_tr_b16 a[58:59], v250 offset:6208
    ds_read_b128 a[244:247], v241 offset:4736
    s_add_u32 s55, s39, 0x2d300
    buffer_load_dwordx4 v168, s[4:7], s41 offen lds
    s_add_u32 m0, s46, 0x7c00
    s_nop 0
    s_waitcnt lgkmcnt(5)
    v_mfma_f32_16x16x32_bf16 v[180:183], a[8:11], a[216:219], v[180:183]
    v_mfma_f32_16x16x32_bf16 v[192:195], a[8:11], a[220:223], v[192:195]
    s_waitcnt lgkmcnt(2)
    v_mfma_f32_16x16x32_bf16 v[184:187], a[32:35], a[216:219], v[184:187]
    s_waitcnt lgkmcnt(0)
    v_mfma_f32_16x16x32_bf16 v[188:191], a[56:59], a[216:219], v[188:191]
    ds_read_b128 a[216:219], v240 offset:256
    v_mfma_f32_16x16x32_bf16 v[196:199], a[32:35], a[220:223], v[196:199]
    buffer_load_dwordx4 v169, s[4:7], s41 offen lds
    s_add_u32 m0, s46, 0x8000
    v_mfma_f32_16x16x32_bf16 v[200:203], a[56:59], a[220:223], v[200:203]
    ds_read_b128 a[220:223], v240 offset:1792
    v_mfma_f32_16x16x32_bf16 v[204:207], a[8:11], a[224:227], v[204:207]
    v_mfma_f32_16x16x32_bf16 v[208:211], a[32:35], a[224:227], v[208:211]
    v_mfma_f32_16x16x32_bf16 v[212:215], a[56:59], a[224:227], v[212:215]
    ds_read_b128 a[224:227], v240 offset:3328
    v_mfma_f32_16x16x32_bf16 v[216:219], a[8:11], a[228:231], v[216:219]
    v_mfma_f32_16x16x32_bf16 v[220:223], a[32:35], a[228:231], v[220:223]
    v_mfma_f32_16x16x32_bf16 v[224:227], a[56:59], a[228:231], v[224:227]
    s_waitcnt vmcnt(8)
    buffer_load_dwordx4 v170, s[4:7], s41 offen lds
    s_add_u32 m0, s46, 0x8400
    ds_read_b64_tr_b16 a[12:13], v249 offset:9216
    ds_read_b64_tr_b16 a[14:15], v250 offset:9216
    ds_read_b64_tr_b16 a[36:37], v249 offset:9248
    ds_read_b64_tr_b16 a[38:39], v250 offset:9248
    ds_read_b64_tr_b16 a[60:61], v249 offset:9280
    ds_read_b64_tr_b16 a[62:63], v250 offset:9280
    ds_read_b128 a[228:231], v240 offset:4864
    buffer_load_dwordx4 v168, s[4:7], s56 offen lds
    s_add_u32 m0, s46, 0x8800
    s_add_u32 s56, s39, 0
    s_waitcnt lgkmcnt(5)
    v_mfma_f32_16x16x32_bf16 v[180:183], a[12:15], a[232:235], v[180:183]
    v_mfma_f32_16x16x32_bf16 v[192:195], a[12:15], a[236:239], v[192:195]
    s_waitcnt lgkmcnt(2)
    v_mfma_f32_16x16x32_bf16 v[184:187], a[36:39], a[232:235], v[184:187]
    s_waitcnt lgkmcnt(0)
    v_mfma_f32_16x16x32_bf16 v[188:191], a[60:63], a[232:235], v[188:191]
    ds_read_b128 a[232:235], v241 offset:256
    v_mfma_f32_16x16x32_bf16 v[196:199], a[36:39], a[236:239], v[196:199]
    buffer_load_dwordx4 v169, s[4:7], s57 offen lds
    s_add_u32 m0, s46, 0x8c00
    s_add_u32 s57, s39, 0x9000
    v_mfma_f32_16x16x32_bf16 v[200:203], a[60:63], a[236:239], v[200:203]
    ds_read_b128 a[236:239], v241 offset:1792
    v_mfma_f32_16x16x32_bf16 v[204:207], a[12:15], a[240:243], v[204:207]
    v_mfma_f32_16x16x32_bf16 v[208:211], a[36:39], a[240:243], v[208:211]
    v_mfma_f32_16x16x32_bf16 v[212:215], a[60:63], a[240:243], v[212:215]
    ds_read_b128 a[240:243], v241 offset:3328
    v_mfma_f32_16x16x32_bf16 v[216:219], a[12:15], a[244:247], v[216:219]
    v_mfma_f32_16x16x32_bf16 v[220:223], a[36:39], a[244:247], v[220:223]
    v_mfma_f32_16x16x32_bf16 v[224:227], a[60:63], a[244:247], v[224:227]
    s_waitcnt vmcnt(8)
    buffer_load_dwordx4 v170, s[4:7], s58 offen lds
    s_add_u32 m0, s46, 0x9000
    ds_read_b64_tr_b16 a[16:17], v249 offset:0
    ds_read_b64_tr_b16 a[18:19], v250 offset:0
    ds_read_b64_tr_b16 a[40:41], v249 offset:32
    ds_read_b64_tr_b16 a[42:43], v250 offset:32
    ds_read_b64_tr_b16 a[64:65], v249 offset:64
    ds_read_b64_tr_b16 a[66:67], v250 offset:64
    ds_read_b128 a[244:247], v241 offset:4864
    s_add_u32 s58, s39, 0x12000
    buffer_load_dwordx4 v168, s[4:7], s59 offen lds
    s_add_u32 m0, s46, 0x9200
    s_add_u32 s59, s39, 0x1b000
    s_waitcnt lgkmcnt(5)
    v_mfma_f32_16x16x32_bf16 v[180:183], a[16:19], a[216:219], v[180:183]
    v_mfma_f32_16x16x32_bf16 v[192:195], a[16:19], a[220:223], v[192:195]
    s_waitcnt lgkmcnt(2)
    v_mfma_f32_16x16x32_bf16 v[184:187], a[40:43], a[216:219], v[184:187]
    s_waitcnt lgkmcnt(0)
    v_mfma_f32_16x16x32_bf16 v[188:191], a[64:67], a[216:219], v[188:191]
    v_mfma_f32_16x16x32_bf16 v[196:199], a[40:43], a[220:223], v[196:199]
    buffer_load_dwordx4 v171, s[4:7], s60 offen lds
    s_add_u32 m0, s29, 0x1800
    s_add_u32 s60, s39, 0x24000
    v_mfma_f32_16x16x32_bf16 v[200:203], a[64:67], a[220:223], v[200:203]
    v_mfma_f32_16x16x32_bf16 v[204:207], a[16:19], a[224:227], v[204:207]
    v_mfma_f32_16x16x32_bf16 v[208:211], a[40:43], a[224:227], v[208:211]
    v_mfma_f32_16x16x32_bf16 v[212:215], a[64:67], a[224:227], v[212:215]
    v_mfma_f32_16x16x32_bf16 v[216:219], a[16:19], a[228:231], v[216:219]
    v_mfma_f32_16x16x32_bf16 v[220:223], a[40:43], a[228:231], v[220:223]
    v_mfma_f32_16x16x32_bf16 v[224:227], a[64:67], a[228:231], v[224:227]
    s_waitcnt vmcnt(8)
    buffer_load_dwordx4 v172, s[8:11], s61 offen lds
    s_add_u32 m0, s29, 0x1c00
    ds_read_b64_tr_b16 a[20:21], v249 offset:3072
    ds_read_b64_tr_b16 a[22:23], v250 offset:3072
    ds_read_b64_tr_b16 a[44:45], v249 offset:3104
    ds_read_b64_tr_b16 a[46:47], v250 offset:3104
    ds_read_b64_tr_b16 a[68:69], v249 offset:3136
    ds_read_b64_tr_b16 a[70:71], v250 offset:3136
    buffer_load_dwordx4 v173, s[8:11], s61 offen lds
    s_add_u32 m0, s29, 0x2000
    s_nop 0
    s_waitcnt lgkmcnt(4)
    v_mfma_f32_16x16x32_bf16 v[180:183], a[20:23], a[232:235], v[180:183]
    v_mfma_f32_16x16x32_bf16 v[192:195], a[20:23], a[236:239], v[192:195]
    s_waitcnt lgkmcnt(1)
    v_mfma_f32_16x16x32_bf16 v[184:187], a[44:47], a[232:235], v[184:187]
    s_waitcnt lgkmcnt(0)
    v_mfma_f32_16x16x32_bf16 v[188:191], a[68:71], a[232:235], v[188:191]
    v_mfma_f32_16x16x32_bf16 v[196:199], a[44:47], a[236:239], v[196:199]
    buffer_load_dwordx4 v174, s[8:11], s61 offen lds
    s_add_u32 m0, s29, 0x2400
    v_cvt_pk_bf16_f32 v90, v180, v181
    v_mfma_f32_16x16x32_bf16 v[200:203], a[68:71], a[236:239], v[200:203]
    s_add_u32 s61, s39, 0x2d000
    v_cvt_pk_bf16_f32 v91, v182, v183
    v_cvt_pk_bf16_f32 v92, v184, v185
    v_mfma_f32_16x16x32_bf16 v[204:207], a[20:23], a[240:243], v[204:207]
    v_cvt_pk_bf16_f32 v93, v186, v187
    v_cvt_pk_bf16_f32 v94, v188, v189
    v_mfma_f32_16x16x32_bf16 v[208:211], a[44:47], a[240:243], v[208:211]
    v_cvt_pk_bf16_f32 v95, v190, v191
    v_cvt_pk_bf16_f32 v96, v192, v193
    v_mfma_f32_16x16x32_bf16 v[212:215], a[68:71], a[240:243], v[212:215]
    v_cvt_pk_bf16_f32 v97, v194, v195
    v_cvt_pk_bf16_f32 v98, v196, v197
    v_mfma_f32_16x16x32_bf16 v[216:219], a[20:23], a[244:247], v[216:219]
    v_cvt_pk_bf16_f32 v99, v198, v199
    v_cvt_pk_bf16_f32 v100, v200, v201
    v_mfma_f32_16x16x32_bf16 v[220:223], a[44:47], a[244:247], v[220:223]
    buffer_load_dwordx4 v172, s[8:11], s62 offen lds
    s_add_u32 m0, s29, 0x2800
    v_cvt_pk_bf16_f32 v101, v202, v203
    v_mfma_f32_16x16x32_bf16 v[224:227], a[68:71], a[244:247], v[224:227]
    v_cvt_pk_bf16_f32 v102, v204, v205
    v_cvt_pk_bf16_f32 v103, v206, v207
    v_cvt_pk_bf16_f32 v104, v208, v209
    v_cvt_pk_bf16_f32 v105, v210, v211
    v_cvt_pk_bf16_f32 v106, v212, v213
    v_cvt_pk_bf16_f32 v107, v214, v215
    v_cvt_pk_bf16_f32 v108, v216, v217
    v_cvt_pk_bf16_f32 v109, v218, v219
    v_cvt_pk_bf16_f32 v110, v220, v221
    v_cvt_pk_bf16_f32 v111, v222, v223
    v_cvt_pk_bf16_f32 v112, v224, v225
    v_cvt_pk_bf16_f32 v113, v226, v227
    buffer_load_dwordx4 v173, s[8:11], s62 offen lds
    s_add_u32 m0, s29, 0x2c00
    s_nop 0
    buffer_load_dwordx4 v174, s[8:11], s62 offen lds
    s_add_u32 m0, s29, 0
    s_add_u32 s62, s39, 0
    buffer_load_dwordx4 v172, s[8:11], s63 offen lds
    s_add_u32 m0, s29, 0x400
    s_nop 0
    buffer_load_dwordx4 v173, s[8:11], s63 offen lds
    s_add_u32 m0, s29, 0x800
    s_nop 0
    buffer_load_dwordx4 v174, s[8:11], s63 offen lds
    s_waitcnt vmcnt(9)
    s_add_u32 m0, s29, 0xc00
    s_barrier
    ds_read_b128 a[216:219], v240 offset:30720
    ds_read_b128 a[220:223], v241 offset:30720
    ds_read_b128 a[224:227], v240 offset:30848
    ds_read_b128 a[228:231], v241 offset:30848
    ds_read_b128 a[232:235], v240 offset:30976
    ds_read_b128 a[236:239], v241 offset:30976
    ds_read_b128 a[240:243], v240 offset:32256
    ds_read_b128 a[244:247], v241 offset:32256
    s_add_u32 s63, s39, 0x3000
    buffer_load_dwordx4 v172, s[8:11], s64 offen lds
    s_add_u32 m0, s29, 0x1000
    s_nop 0
    s_waitcnt lgkmcnt(7)
    v_mfma_f32_16x16x32_bf16 v[180:183], a[0:3], a[216:219], 0
    s_waitcnt lgkmcnt(6)
    v_mfma_f32_16x16x32_bf16 v[184:187], a[24:27], a[216:219], 0
    v_mfma_f32_16x16x32_bf16 v[188:191], a[48:51], a[216:219], 0
    ds_read_b128 a[216:219], v240 offset:32384
    v_mfma_f32_16x16x32_bf16 v[180:183], a[4:7], a[220:223], v[180:183]
    s_waitcnt lgkmcnt(1)
    v_mfma_f32_16x16x32_bf16 v[184:187], a[28:31], a[220:223], v[184:187]
    v_mfma_f32_16x16x32_bf16 v[188:191], a[52:55], a[220:223], v[188:191]
    buffer_load_dwordx4 v173, s[8:11], s64 offen lds
    s_add_u32 m0, s29, 0x1400
    v_mfma_f32_16x16x32_bf16 v[180:183], a[8:11], a[224:227], v[180:183]
    ds_read_b128 a[220:223], v241 offset:32384
    v_mfma_f32_16x16x32_bf16 v[184:187], a[32:35], a[224:227], v[184:187]
    v_mfma_f32_16x16x32_bf16 v[188:191], a[56:59], a[224:227], v[188:191]
    ds_read_b128 a[224:227], v240 offset:32512
    v_mfma_f32_16x16x32_bf16 v[180:183], a[12:15], a[228:231], v[180:183]
    v_mfma_f32_16x16x32_bf16 v[184:187], a[36:39], a[228:231], v[184:187]
    v_mfma_f32_16x16x32_bf16 v[188:191], a[60:63], a[228:231], v[188:191]
    buffer_load_dwordx4 v174, s[8:11], s64 offen lds
    s_add_u32 m0, s46, 0xf000
    s_add_u32 s64, s39, 0x6000
    v_mfma_f32_16x16x32_bf16 v[180:183], a[16:19], a[232:235], v[180:183]
    ds_read_b128 a[228:231], v241 offset:32512
    s_waitcnt vmcnt(9)
    v_mfma_f32_16x16x32_bf16 v[184:187], a[40:43], a[232:235], v[184:187]
    ds_read_b64_tr_b16 a[72:73], v249 offset:6144
    v_mfma_f32_16x16x32_bf16 v[188:191], a[64:67], a[232:235], v[188:191]
    ds_read_b128 a[232:235], v240 offset:33792
    v_mfma_f32_16x16x32_bf16 v[180:183], a[20:23], a[236:239], v[180:183]
    ds_read_b64_tr_b16 a[74:75], v250 offset:6144
    v_mfma_f32_16x16x32_bf16 v[184:187], a[44:47], a[236:239], v[184:187]
    ds_read_b64_tr_b16 a[96:97], v249 offset:6176
    v_mfma_f32_16x16x32_bf16 v[188:191], a[68:71], a[236:239], v[188:191]
    ds_read_b128 a[236:239], v241 offset:33792
    v_mfma_f32_16x16x32_bf16 v[192:195], a[0:3], a[240:243], 0
    buffer_load_dwordx4 v168, s[4:7], s42 offen lds
    s_add_u32 m0, s46, 0xf400
    v_cvt_pk_bf16_f32 v114, v180, v181
    v_mfma_f32_16x16x32_bf16 v[196:199], a[24:27], a[240:243], 0
    ds_read_b64_tr_b16 a[98:99], v250 offset:6176
    v_cvt_pk_bf16_f32 v115, v182, v183
    v_mfma_f32_16x16x32_bf16 v[200:203], a[48:51], a[240:243], 0
    ds_read_b128 a[240:243], v240 offset:33920
    v_cvt_pk_bf16_f32 v116, v184, v185
    v_mfma_f32_16x16x32_bf16 v[192:195], a[4:7], a[244:247], v[192:195]
    ds_read_b64_tr_b16 a[120:121], v249 offset:6208
    s_waitcnt lgkmcnt(7)
    v_cvt_pk_bf16_f32 v117, v186, v187
    v_mfma_f32_16x16x32_bf16 v[196:199], a[28:31], a[244:247], v[196:199]
    ds_read_b64_tr_b16 a[122:123], v250 offset:6208
    s_waitcnt lgkmcnt(7)
    v_cvt_pk_bf16_f32 v118, v188, v189
    v_mfma_f32_16x16x32_bf16 v[200:203], a[52:55], a[244:247], v[200:203]
    ds_read_b128 a[244:247], v241 offset:33920
    v_cvt_pk_bf16_f32 v119, v190, v191
    v_mfma_f32_16x16x32_bf16 v[192:195], a[8:11], a[216:219], v[192:195]
    v_mfma_f32_16x16x32_bf16 v[196:199], a[32:35], a[216:219], v[196:199]
    buffer_load_dwordx4 v169, s[4:7], s42 offen lds
    s_add_u32 m0, s46, 0xf800
    v_mfma_f32_16x16x32_bf16 v[200:203], a[56:59], a[216:219], v[200:203]
    ds_read_b128 a[216:219], v240 offset:34048
    v_mfma_f32_16x16x32_bf16 v[192:195], a[12:15], a[220:223], v[192:195]
    v_mfma_f32_16x16x32_bf16 v[196:199], a[36:39], a[220:223], v[196:199]
    v_mfma_f32_16x16x32_bf16 v[200:203], a[60:63], a[220:223], v[200:203]
    ds_read_b128 a[220:223], v241 offset:34048
    v_mfma_f32_16x16x32_bf16 v[192:195], a[16:19], a[224:227], v[192:195]
    v_mfma_f32_16x16x32_bf16 v[196:199], a[40:43], a[224:227], v[196:199]
    v_mfma_f32_16x16x32_bf16 v[200:203], a[64:67], a[224:227], v[200:203]
    buffer_load_dwordx4 v170, s[4:7], s42 offen lds
    s_add_u32 m0, s46, 0xfc00
    s_waitcnt vmcnt(9)
    v_mfma_f32_16x16x32_bf16 v[192:195], a[20:23], a[228:231], v[192:195]
    ds_read_b128 a[224:227], v240 offset:35328
    v_mfma_f32_16x16x32_bf16 v[196:199], a[44:47], a[228:231], v[196:199]
    ds_read_b64_tr_b16 a[76:77], v249 offset:9216
    v_mfma_f32_16x16x32_bf16 v[200:203], a[68:71], a[228:231], v[200:203]
    ds_read_b128 a[228:231], v241 offset:35328
    v_mfma_f32_16x16x32_bf16 v[204:207], a[0:3], a[232:235], 0
    ds_read_b64_tr_b16 a[78:79], v250 offset:9216
    s_waitcnt lgkmcnt(5)
    v_cvt_pk_bf16_f32 v120, v192, v193
    v_mfma_f32_16x16x32_bf16 v[208:211], a[24:27], a[232:235], 0
    ds_read_b64_tr_b16 a[100:101], v249 offset:9248
    v_cvt_pk_bf16_f32 v121, v194, v195
    v_mfma_f32_16x16x32_bf16 v[212:215], a[48:51], a[232:235], 0
    ds_read_b128 a[232:235], v240 offset:35456
    v_cvt_pk_bf16_f32 v122, v196, v197
    v_mfma_f32_16x16x32_bf16 v[204:207], a[4:7], a[236:239], v[204:207]
    buffer_load_dwordx4 v168, s[4:7], s65 offen lds
    s_add_u32 m0, s46, 0x10000
    v_cvt_pk_bf16_f32 v123, v198, v199
    v_mfma_f32_16x16x32_bf16 v[208:211], a[28:31], a[236:239], v[208:211]
    ds_read_b64_tr_b16 a[102:103], v250 offset:9248
    s_add_u32 s65, s39, 0x9000
    v_cvt_pk_bf16_f32 v124, v200, v201
    v_mfma_f32_16x16x32_bf16 v[212:215], a[52:55], a[236:239], v[212:215]
    ds_read_b128 a[236:239], v241 offset:35456
    s_waitcnt lgkmcnt(7)
    v_cvt_pk_bf16_f32 v125, v202, v203
    v_mfma_f32_16x16x32_bf16 v[204:207], a[8:11], a[240:243], v[204:207]
    ds_read_b64_tr_b16 a[124:125], v249 offset:9280
    v_mfma_f32_16x16x32_bf16 v[208:211], a[32:35], a[240:243], v[208:211]
    ds_read_b64_tr_b16 a[126:127], v250 offset:9280
    v_mfma_f32_16x16x32_bf16 v[212:215], a[56:59], a[240:243], v[212:215]
    ds_read_b128 a[240:243], v240 offset:35584
    v_mfma_f32_16x16x32_bf16 v[204:207], a[12:15], a[244:247], v[204:207]
    v_mfma_f32_16x16x32_bf16 v[208:211], a[36:39], a[244:247], v[208:211]
    buffer_load_dwordx4 v169, s[4:7], s50 offen lds
    s_add_u32 m0, s46, 0x10400
    s_mov_b32 s50, 0
    v_mfma_f32_16x16x32_bf16 v[212:215], a[60:63], a[244:247], v[212:215]
    ds_read_b128 a[244:247], v241 offset:35584
    v_mfma_f32_16x16x32_bf16 v[204:207], a[16:19], a[216:219], v[204:207]
    v_mfma_f32_16x16x32_bf16 v[208:211], a[40:43], a[216:219], v[208:211]
    v_mfma_f32_16x16x32_bf16 v[212:215], a[64:67], a[216:219], v[212:215]
    v_mfma_f32_16x16x32_bf16 v[204:207], a[20:23], a[220:223], v[204:207]
    v_mfma_f32_16x16x32_bf16 v[208:211], a[44:47], a[220:223], v[208:211]
    v_mfma_f32_16x16x32_bf16 v[212:215], a[68:71], a[220:223], v[212:215]
    buffer_load_dwordx4 v170, s[4:7], s51 offen lds
    s_add_u32 m0, s46, 0x10800
    s_mov_b32 s51, 0x1800
    v_mfma_f32_16x16x32_bf16 v[216:219], a[0:3], a[224:227], 0
    s_waitcnt vmcnt(9) lgkmcnt(1)
    ds_read_b64_tr_b16 a[80:81], v249 offset:0
    v_mfma_f32_16x16x32_bf16 v[220:223], a[24:27], a[224:227], 0
    ds_read_b64_tr_b16 a[82:83], v250 offset:0
    v_cvt_pk_bf16_f32 v126, v204, v205
    v_mfma_f32_16x16x32_bf16 v[224:227], a[48:51], a[224:227], 0
    ds_read_b64_tr_b16 a[104:105], v249 offset:32
    v_cvt_pk_bf16_f32 v127, v206, v207
    v_mfma_f32_16x16x32_bf16 v[216:219], a[4:7], a[228:231], v[216:219]
    ds_read_b64_tr_b16 a[106:107], v250 offset:32
    v_cvt_pk_bf16_f32 v128, v208, v209
    v_mfma_f32_16x16x32_bf16 v[220:223], a[28:31], a[228:231], v[220:223]
    ds_read_b64_tr_b16 a[128:129], v249 offset:64
    v_cvt_pk_bf16_f32 v129, v210, v211
    v_mfma_f32_16x16x32_bf16 v[224:227], a[52:55], a[228:231], v[224:227]
    ds_read_b64_tr_b16 a[130:131], v250 offset:64
    v_cvt_pk_bf16_f32 v130, v212, v213
    v_mfma_f32_16x16x32_bf16 v[216:219], a[8:11], a[232:235], v[216:219]
    buffer_load_dwordx4 v168, s[4:7], s52 offen lds
    s_add_u32 m0, s46, 0x10a00
    v_cvt_pk_bf16_f32 v131, v214, v215
    v_mfma_f32_16x16x32_bf16 v[220:223], a[32:35], a[232:235], v[220:223]
    s_mov_b32 s52, 0x3000
    v_mfma_f32_16x16x32_bf16 v[224:227], a[56:59], a[232:235], v[224:227]
    v_mfma_f32_16x16x32_bf16 v[216:219], a[12:15], a[236:239], v[216:219]
    v_mfma_f32_16x16x32_bf16 v[220:223], a[36:39], a[236:239], v[220:223]
    v_mfma_f32_16x16x32_bf16 v[224:227], a[60:63], a[236:239], v[224:227]
    v_mfma_f32_16x16x32_bf16 v[216:219], a[16:19], a[240:243], v[216:219]
    buffer_load_dwordx4 v171, s[4:7], s53 offen lds
    s_add_u32 m0, s29, 0x1800
    s_add_u32 s53, s39, 0xc000
    v_mfma_f32_16x16x32_bf16 v[220:223], a[40:43], a[240:243], v[220:223]
    s_waitcnt lgkmcnt(1)
    v_mfma_f32_16x16x32_bf16 v[224:227], a[64:67], a[240:243], v[224:227]
    v_mfma_f32_16x16x32_bf16 v[216:219], a[20:23], a[244:247], v[216:219]
    v_mfma_f32_16x16x32_bf16 v[220:223], a[44:47], a[244:247], v[220:223]
    v_mfma_f32_16x16x32_bf16 v[224:227], a[68:71], a[244:247], v[224:227]
    s_nop 5
    v_cvt_pk_bf16_f32 v132, v216, v217
    v_cvt_pk_bf16_f32 v133, v218, v219
    v_cvt_pk_bf16_f32 v134, v220, v221
    v_cvt_pk_bf16_f32 v135, v222, v223
    v_cvt_pk_bf16_f32 v136, v224, v225
    v_cvt_pk_bf16_f32 v137, v226, v227
    buffer_load_dwordx4 v172, s[8:11], s54 offen lds
    s_waitcnt vmcnt(9)
    s_add_u32 m0, s29, 0x1c00
    ds_read_b64_tr_b16 a[84:85], v249 offset:3072
    ds_read_b64_tr_b16 a[86:87], v250 offset:3072
    ds_read_b64_tr_b16 a[108:109], v249 offset:3104
    ds_read_b64_tr_b16 a[110:111], v250 offset:3104
    ds_read_b64_tr_b16 a[132:133], v249 offset:3136
    ds_read_b64_tr_b16 a[134:135], v250 offset:3136
    buffer_load_dwordx4 v173, s[8:11], s54 offen lds
    s_add_u32 m0, s29, 0x2000
    s_nop 0
    buffer_load_dwordx4 v174, s[8:11], s54 offen lds
    s_add_u32 m0, s29, 0x2400
    s_mov_b32 s54, 0x400
    buffer_load_dwordx4 v172, s[8:11], s55 offen lds
    s_add_u32 m0, s29, 0x2800
    s_nop 0
    buffer_load_dwordx4 v173, s[8:11], s55 offen lds
    s_add_u32 m0, s29, 0x2c00
    s_nop 0
    buffer_load_dwordx4 v174, s[8:11], s55 offen lds
    s_add_u32 m0, s29, 0
    s_mov_b32 s55, 0x1c00
    s_waitcnt lgkmcnt(0)
    buffer_load_dwordx4 v172, s[8:11], s56 offen lds
    s_add_u32 m0, s29, 0x400
    s_nop 0
    buffer_load_dwordx4 v173, s[8:11], s56 offen lds
    s_add_u32 m0, s29, 0x800
    s_nop 0
    buffer_load_dwordx4 v174, s[8:11], s56 offen lds
    s_waitcnt vmcnt(9)
    s_add_u32 m0, s29, 0xc00
    s_barrier
    ds_read_b128 a[216:219], v240 offset:61440
    ds_read_b128 a[220:223], v241 offset:61440
    ds_read_b128 a[224:227], v240 offset:61568
    ds_read_b128 a[228:231], v241 offset:61568
    ds_read_b128 a[232:235], v240 offset:61696
    ds_read_b128 a[236:239], v241 offset:61696
    ds_read_b128 a[240:243], v240 offset:62976
    ds_read_b128 a[244:247], v241 offset:62976
    s_mov_b32 s56, 0x3400
    buffer_load_dwordx4 v172, s[8:11], s57 offen lds
    s_add_u32 m0, s29, 0x1000
    s_nop 0
    s_waitcnt lgkmcnt(7)
    v_mfma_f32_16x16x32_bf16 v[180:183], a[0:3], a[216:219], 0
    s_waitcnt lgkmcnt(6)
    v_mfma_f32_16x16x32_bf16 v[184:187], a[24:27], a[216:219], 0
    v_mfma_f32_16x16x32_bf16 v[188:191], a[48:51], a[216:219], 0
    ds_read_b128 a[216:219], v240 offset:63104
    v_mfma_f32_16x16x32_bf16 v[180:183], a[4:7], a[220:223], v[180:183]
    s_waitcnt lgkmcnt(1)
    v_mfma_f32_16x16x32_bf16 v[184:187], a[28:31], a[220:223], v[184:187]
    v_mfma_f32_16x16x32_bf16 v[188:191], a[52:55], a[220:223], v[188:191]
    buffer_load_dwordx4 v173, s[8:11], s57 offen lds
    s_add_u32 m0, s29, 0x1400
    v_mfma_f32_16x16x32_bf16 v[180:183], a[8:11], a[224:227], v[180:183]
    ds_read_b128 a[220:223], v241 offset:63104
    v_mfma_f32_16x16x32_bf16 v[184:187], a[32:35], a[224:227], v[184:187]
    v_mfma_f32_16x16x32_bf16 v[188:191], a[56:59], a[224:227], v[188:191]
    ds_read_b128 a[224:227], v240 offset:63232
    v_mfma_f32_16x16x32_bf16 v[180:183], a[12:15], a[228:231], v[180:183]
    v_mfma_f32_16x16x32_bf16 v[184:187], a[36:39], a[228:231], v[184:187]
    v_mfma_f32_16x16x32_bf16 v[188:191], a[60:63], a[228:231], v[188:191]
    buffer_load_dwordx4 v174, s[8:11], s57 offen lds
    s_add_u32 m0, s29, 0x1800
    s_add_u32 s57, s39, 0xf000
    v_mfma_f32_16x16x32_bf16 v[180:183], a[16:19], a[232:235], v[180:183]
    ds_read_b128 a[228:231], v241 offset:63232
    s_waitcnt vmcnt(9)
    v_mfma_f32_16x16x32_bf16 v[184:187], a[40:43], a[232:235], v[184:187]
    ds_read_b64_tr_b16 a[88:89], v249 offset:6144
    v_mfma_f32_16x16x32_bf16 v[188:191], a[64:67], a[232:235], v[188:191]
    ds_read_b64_tr_b16 a[90:91], v250 offset:6144
    v_mfma_f32_16x16x32_bf16 v[180:183], a[20:23], a[236:239], v[180:183]
    ds_read_b64_tr_b16 a[112:113], v249 offset:6176
    v_mfma_f32_16x16x32_bf16 v[184:187], a[44:47], a[236:239], v[184:187]
    ds_read_b64_tr_b16 a[114:115], v250 offset:6176
    v_mfma_f32_16x16x32_bf16 v[188:191], a[68:71], a[236:239], v[188:191]
    ds_read_b64_tr_b16 a[136:137], v249 offset:6208
    v_mfma_f32_16x16x32_bf16 v[192:195], a[0:3], a[240:243], 0
    ds_read_b64_tr_b16 a[138:139], v250 offset:6208
    v_mfma_f32_16x16x32_bf16 v[196:199], a[24:27], a[240:243], 0
    ds_read_b128 a[232:235], v240 offset:64512
    v_cvt_pk_bf16_f32 v138, v180, v181
    v_mfma_f32_16x16x32_bf16 v[200:203], a[48:51], a[240:243], 0
    ds_read_b128 a[236:239], v241 offset:64512
    v_cvt_pk_bf16_f32 v139, v182, v183
    v_mfma_f32_16x16x32_bf16 v[192:195], a[4:7], a[244:247], v[192:195]
    ds_read_b128 a[240:243], v240 offset:64640
    s_waitcnt lgkmcnt(8)
    v_cvt_pk_bf16_f32 v140, v184, v185
    v_mfma_f32_16x16x32_bf16 v[196:199], a[28:31], a[244:247], v[196:199]
    v_cvt_pk_bf16_f32 v141, v186, v187
    v_cvt_pk_bf16_f32 v142, v188, v189
    v_mfma_f32_16x16x32_bf16 v[200:203], a[52:55], a[244:247], v[200:203]
    ds_read_b128 a[244:247], v241 offset:64640
    v_cvt_pk_bf16_f32 v143, v190, v191
    v_mfma_f32_16x16x32_bf16 v[192:195], a[8:11], a[216:219], v[192:195]
    v_mfma_f32_16x16x32_bf16 v[196:199], a[32:35], a[216:219], v[196:199]
    v_mfma_f32_16x16x32_bf16 v[200:203], a[56:59], a[216:219], v[200:203]
    ds_read_b128 a[216:219], v240 offset:64768
    s_waitcnt lgkmcnt(5)
    v_add_u32 v240, 0xf000, v240
    v_mfma_f32_16x16x32_bf16 v[192:195], a[12:15], a[220:223], v[192:195]
    buffer_load_dwordx4 v172, s[8:11], s58 offen lds
    s_add_u32 m0, s29, 0x1c00
    s_waitcnt lgkmcnt(4)
    v_mfma_f32_16x16x32_bf16 v[196:199], a[36:39], a[220:223], v[196:199]
    buffer_load_dwordx4 v173, s[8:11], s58 offen lds
    s_add_u32 m0, s29, 0x2000
    v_mfma_f32_16x16x32_bf16 v[200:203], a[60:63], a[220:223], v[200:203]
    ds_read_b128 a[220:223], v241 offset:64768
    v_add_u32 v241, 0xf000, v241
    v_mfma_f32_16x16x32_bf16 v[192:195], a[16:19], a[224:227], v[192:195]
    v_mfma_f32_16x16x32_bf16 v[196:199], a[40:43], a[224:227], v[196:199]
    v_mfma_f32_16x16x32_bf16 v[200:203], a[64:67], a[224:227], v[200:203]
    buffer_load_dwordx4 v174, s[8:11], s58 offen lds
    s_add_u32 m0, s29, 0x2400
    s_mov_b32 s58, 0x800
    v_mfma_f32_16x16x32_bf16 v[192:195], a[20:23], a[228:231], v[192:195]
    ds_read_b128 a[224:227], v240 offset:4608
    s_waitcnt vmcnt(9)
    v_mfma_f32_16x16x32_bf16 v[196:199], a[44:47], a[228:231], v[196:199]
    ds_read_b64_tr_b16 a[92:93], v249 offset:9216
    v_mfma_f32_16x16x32_bf16 v[200:203], a[68:71], a[228:231], v[200:203]
    ds_read_b64_tr_b16 a[94:95], v250 offset:9216
    v_mfma_f32_16x16x32_bf16 v[204:207], a[0:3], a[232:235], 0
    ds_read_b64_tr_b16 a[116:117], v249 offset:9248
    s_waitcnt lgkmcnt(5)
    v_cvt_pk_bf16_f32 v144, v192, v193
    v_mfma_f32_16x16x32_bf16 v[208:211], a[24:27], a[232:235], 0
    ds_read_b64_tr_b16 a[118:119], v250 offset:9248
    v_cvt_pk_bf16_f32 v145, v194, v195
    v_mfma_f32_16x16x32_bf16 v[212:215], a[48:51], a[232:235], 0
    ds_read_b64_tr_b16 a[140:141], v249 offset:9280
    v_cvt_pk_bf16_f32 v146, v196, v197
    v_mfma_f32_16x16x32_bf16 v[204:207], a[4:7], a[236:239], v[204:207]
    ds_read_b64_tr_b16 a[142:143], v250 offset:9280
    v_cvt_pk_bf16_f32 v147, v198, v199
    v_mfma_f32_16x16x32_bf16 v[208:211], a[28:31], a[236:239], v[208:211]
    ds_read_b128 a[228:231], v241 offset:4608
    v_cvt_pk_bf16_f32 v148, v200, v201
    v_mfma_f32_16x16x32_bf16 v[212:215], a[52:55], a[236:239], v[212:215]
    ds_read_b128 a[232:235], v240 offset:4736
    s_waitcnt lgkmcnt(8)
    v_cvt_pk_bf16_f32 v149, v202, v203
    v_mfma_f32_16x16x32_bf16 v[204:207], a[8:11], a[240:243], v[204:207]
    ds_read_b128 a[236:239], v241 offset:4736
    v_mfma_f32_16x16x32_bf16 v[208:211], a[32:35], a[240:243], v[208:211]
    v_mfma_f32_16x16x32_bf16 v[212:215], a[56:59], a[240:243], v[212:215]
    ds_read_b128 a[240:243], v240 offset:4864
    v_add_u32 v240, 0xffff1000, v240
    v_mfma_f32_16x16x32_bf16 v[204:207], a[12:15], a[244:247], v[204:207]
    v_mfma_f32_16x16x32_bf16 v[208:211], a[36:39], a[244:247], v[208:211]
    v_mfma_f32_16x16x32_bf16 v[212:215], a[60:63], a[244:247], v[212:215]
    ds_read_b128 a[244:247], v241 offset:4864
    s_waitcnt lgkmcnt(5)
    v_add_u32 v241, 0xffff1000, v241
    v_mfma_f32_16x16x32_bf16 v[204:207], a[16:19], a[216:219], v[204:207]
    buffer_load_dwordx4 v172, s[8:11], s59 offen lds
    s_add_u32 m0, s29, 0x2800
    v_mfma_f32_16x16x32_bf16 v[208:211], a[40:43], a[216:219], v[208:211]
    buffer_load_dwordx4 v173, s[8:11], s59 offen lds
    s_add_u32 m0, s29, 0x2c00
    v_mfma_f32_16x16x32_bf16 v[212:215], a[64:67], a[216:219], v[212:215]
    ds_read_b128 a[216:219], v240 offset:0
    v_mfma_f32_16x16x32_bf16 v[204:207], a[20:23], a[220:223], v[204:207]
    v_mfma_f32_16x16x32_bf16 v[208:211], a[44:47], a[220:223], v[208:211]
    v_mfma_f32_16x16x32_bf16 v[212:215], a[68:71], a[220:223], v[212:215]
    buffer_load_dwordx4 v174, s[8:11], s59 offen lds
    s_add_u32 m0, s29, 0
    s_mov_b32 s59, 0x2000
    v_mfma_f32_16x16x32_bf16 v[216:219], a[0:3], a[224:227], 0
    ds_read_b128 a[220:223], v241 offset:0
    s_waitcnt vmcnt(9) lgkmcnt(3)
    v_cvt_pk_bf16_f32 v150, v204, v205
    v_mfma_f32_16x16x32_bf16 v[220:223], a[24:27], a[224:227], 0
    ds_read_b64_tr_b16 a[144:145], v249 offset:0
    v_cvt_pk_bf16_f32 v151, v206, v207
    v_mfma_f32_16x16x32_bf16 v[224:227], a[48:51], a[224:227], 0
    ds_read_b64_tr_b16 a[146:147], v250 offset:0
    v_cvt_pk_bf16_f32 v152, v208, v209
    v_mfma_f32_16x16x32_bf16 v[216:219], a[4:7], a[228:231], v[216:219]
    ds_read_b64_tr_b16 a[168:169], v249 offset:32
    v_cvt_pk_bf16_f32 v153, v210, v211
    v_mfma_f32_16x16x32_bf16 v[220:223], a[28:31], a[228:231], v[220:223]
    ds_read_b64_tr_b16 a[170:171], v250 offset:32
    s_waitcnt lgkmcnt(5)
    v_cvt_pk_bf16_f32 v154, v212, v213
    v_mfma_f32_16x16x32_bf16 v[224:227], a[52:55], a[228:231], v[224:227]
    ds_read_b64_tr_b16 a[192:193], v249 offset:64
    v_cvt_pk_bf16_f32 v155, v214, v215
    v_mfma_f32_16x16x32_bf16 v[216:219], a[8:11], a[232:235], v[216:219]
    ds_read_b64_tr_b16 a[194:195], v250 offset:64
    v_mfma_f32_16x16x32_bf16 v[220:223], a[32:35], a[232:235], v[220:223]
    ds_read_b128 a[224:227], v240 offset:128
    v_mfma_f32_16x16x32_bf16 v[224:227], a[56:59], a[232:235], v[224:227]
    ds_read_b128 a[228:231], v241 offset:128
    v_mfma_f32_16x16x32_bf16 v[216:219], a[12:15], a[236:239], v[216:219]
    ds_read_b128 a[232:235], v240 offset:256
    v_mfma_f32_16x16x32_bf16 v[220:223], a[36:39], a[236:239], v[220:223]
    v_mfma_f32_16x16x32_bf16 v[224:227], a[60:63], a[236:239], v[224:227]
    ds_read_b128 a[236:239], v241 offset:256
    v_mfma_f32_16x16x32_bf16 v[216:219], a[16:19], a[240:243], v[216:219]
    v_mfma_f32_16x16x32_bf16 v[220:223], a[40:43], a[240:243], v[220:223]
    v_mfma_f32_16x16x32_bf16 v[224:227], a[64:67], a[240:243], v[224:227]
    ds_read_b128 a[240:243], v240 offset:1536
    s_waitcnt lgkmcnt(5)
    v_mfma_f32_16x16x32_bf16 v[216:219], a[20:23], a[244:247], v[216:219]
    buffer_load_dwordx4 v172, s[8:11], s60 offen lds
    s_add_u32 m0, s29, 0x400
    v_mfma_f32_16x16x32_bf16 v[220:223], a[44:47], a[244:247], v[220:223]
    buffer_load_dwordx4 v173, s[8:11], s60 offen lds
    s_add_u32 m0, s29, 0x800
    v_mfma_f32_16x16x32_bf16 v[224:227], a[68:71], a[244:247], v[224:227]
    ds_read_b128 a[244:247], v241 offset:1536
    v_mfma_f32_16x16x32_bf16 v[180:183], a[216:219], a[72:75], 0
    v_cvt_pk_bf16_f32 v156, v216, v217
    v_cvt_pk_bf16_f32 v157, v218, v219
    v_mfma_f32_16x16x32_bf16 v[184:187], a[216:219], a[96:99], 0
    buffer_load_dwordx4 v174, s[8:11], s60 offen lds
    s_add_u32 m0, s29, 0xc00
    v_cvt_pk_bf16_f32 v158, v220, v221
    v_mfma_f32_16x16x32_bf16 v[188:191], a[216:219], a[120:123], 0
    ds_read_b128 a[216:219], v240 offset:1664
    s_mov_b32 s60, 0x3800
    v_cvt_pk_bf16_f32 v159, v222, v223
    v_mfma_f32_16x16x32_bf16 v[180:183], a[220:223], a[76:79], v[180:183]
    s_waitcnt vmcnt(9) lgkmcnt(3)
    v_cvt_pk_bf16_f32 v160, v224, v225
    v_cvt_pk_bf16_f32 v161, v226, v227
    v_mfma_f32_16x16x32_bf16 v[184:187], a[220:223], a[100:103], v[184:187]
    ds_read_b64_tr_b16 a[148:149], v249 offset:3072
    s_waitcnt lgkmcnt(3)
    v_mfma_f32_16x16x32_bf16 v[188:191], a[220:223], a[124:127], v[188:191]
    ds_read_b64_tr_b16 a[150:151], v250 offset:3072
    v_mfma_f32_16x16x32_bf16 v[180:183], a[224:227], a[80:83], v[180:183]
    ds_read_b64_tr_b16 a[172:173], v249 offset:3104
    v_mfma_f32_16x16x32_bf16 v[184:187], a[224:227], a[104:107], v[184:187]
    ds_read_b64_tr_b16 a[174:175], v250 offset:3104
    v_mfma_f32_16x16x32_bf16 v[188:191], a[224:227], a[128:131], v[188:191]
    ds_read_b64_tr_b16 a[196:197], v249 offset:3136
    v_mfma_f32_16x16x32_bf16 v[180:183], a[228:231], a[84:87], v[180:183]
    ds_read_b64_tr_b16 a[198:199], v250 offset:3136
    v_mfma_f32_16x16x32_bf16 v[184:187], a[228:231], a[108:111], v[184:187]
    ds_read_b128 a[220:223], v241 offset:1664
    v_mfma_f32_16x16x32_bf16 v[188:191], a[228:231], a[132:135], v[188:191]
    ds_read_b128 a[224:227], v240 offset:1792
    v_mfma_f32_16x16x32_bf16 v[180:183], a[232:235], a[88:91], v[180:183]
    ds_read_b128 a[228:231], v241 offset:1792
    v_mfma_f32_16x16x32_bf16 v[184:187], a[232:235], a[112:115], v[184:187]
    v_mfma_f32_16x16x32_bf16 v[188:191], a[232:235], a[136:139], v[188:191]
    ds_read_b128 a[232:235], v240 offset:3072
    v_mfma_f32_16x16x32_bf16 v[180:183], a[236:239], a[92:95], v[180:183]
    v_mfma_f32_16x16x32_bf16 v[184:187], a[236:239], a[116:119], v[184:187]
    v_mfma_f32_16x16x32_bf16 v[188:191], a[236:239], a[140:143], v[188:191]
    ds_read_b128 a[236:239], v241 offset:3072
    s_waitcnt lgkmcnt(5)
    v_mfma_f32_16x16x32_bf16 v[192:195], a[240:243], a[72:75], 0
    buffer_load_dwordx4 v172, s[8:11], s61 offen lds
    s_add_u32 m0, s29, 0x1000
    v_mfma_f32_16x16x32_bf16 v[196:199], a[240:243], a[96:99], 0
    buffer_load_dwordx4 v173, s[8:11], s61 offen lds
    s_add_u32 m0, s29, 0x1400
    v_cvt_pk_bf16_f32 v0, v180, v181
    v_mfma_f32_16x16x32_bf16 v[200:203], a[240:243], a[120:123], 0
    ds_read_b128 a[240:243], v240 offset:3200
    v_cvt_pk_bf16_f32 v3, v182, v183
    v_mfma_f32_16x16x32_bf16 v[192:195], a[244:247], a[76:79], v[192:195]
    v_cvt_pk_bf16_f32 v30, v184, v185
    v_cvt_pk_bf16_f32 v33, v186, v187
    v_mfma_f32_16x16x32_bf16 v[196:199], a[244:247], a[100:103], v[196:199]
    v_cvt_pk_bf16_f32 v60, v188, v189
    v_cvt_pk_bf16_f32 v63, v190, v191
    v_mfma_f32_16x16x32_bf16 v[200:203], a[244:247], a[124:127], v[200:203]
    ds_read_b128 a[244:247], v241 offset:3200
    s_waitcnt lgkmcnt(3)
    v_mfma_f32_16x16x32_bf16 v[192:195], a[216:219], a[80:83], v[192:195]
    v_mfma_f32_16x16x32_bf16 v[196:199], a[216:219], a[104:107], v[196:199]
    buffer_load_dwordx4 v174, s[8:11], s61 offen lds
    s_add_u32 m0, s29, 0x1800
    s_mov_b32 s61, 0xc00
    v_mfma_f32_16x16x32_bf16 v[200:203], a[216:219], a[128:131], v[200:203]
    ds_read_b128 a[216:219], v240 offset:3328
    s_waitcnt vmcnt(9)
    v_mfma_f32_16x16x32_bf16 v[192:195], a[220:223], a[84:87], v[192:195]
    ds_read_b64_tr_b16 a[152:153], v249 offset:6144
    v_mfma_f32_16x16x32_bf16 v[196:199], a[220:223], a[108:111], v[196:199]
    ds_read_b64_tr_b16 a[154:155], v250 offset:6144
    v_mfma_f32_16x16x32_bf16 v[200:203], a[220:223], a[132:135], v[200:203]
    ds_read_b64_tr_b16 a[176:177], v249 offset:6176
    v_mfma_f32_16x16x32_bf16 v[192:195], a[224:227], a[88:91], v[192:195]
    ds_read_b64_tr_b16 a[178:179], v250 offset:6176
    v_mfma_f32_16x16x32_bf16 v[196:199], a[224:227], a[112:115], v[196:199]
    ds_read_b64_tr_b16 a[200:201], v249 offset:6208
    v_mfma_f32_16x16x32_bf16 v[200:203], a[224:227], a[136:139], v[200:203]
    ds_read_b64_tr_b16 a[202:203], v250 offset:6208
    v_mfma_f32_16x16x32_bf16 v[192:195], a[228:231], a[92:95], v[192:195]
    ds_read_b128 a[220:223], v241 offset:3328
    v_mfma_f32_16x16x32_bf16 v[196:199], a[228:231], a[116:119], v[196:199]
    ds_read_b128 a[224:227], v240 offset:30720
    v_mfma_f32_16x16x32_bf16 v[200:203], a[228:231], a[140:143], v[200:203]
    ds_read_b128 a[228:231], v241 offset:30720
    v_mfma_f32_16x16x32_bf16 v[204:207], a[232:235], a[72:75], 0
    s_waitcnt lgkmcnt(8)
    v_mfma_f32_16x16x32_bf16 v[208:211], a[232:235], a[96:99], 0
    v_cvt_pk_bf16_f32 v6, v192, v193
    v_cvt_pk_bf16_f32 v9, v194, v195
    v_mfma_f32_16x16x32_bf16 v[212:215], a[232:235], a[120:123], 0
    ds_read_b128 a[232:235], v240 offset:30848
    v_cvt_pk_bf16_f32 v36, v196, v197
    v_mfma_f32_16x16x32_bf16 v[204:207], a[236:239], a[76:79], v[204:207]
    v_cvt_pk_bf16_f32 v39, v198, v199
    v_cvt_pk_bf16_f32 v66, v200, v201
    v_mfma_f32_16x16x32_bf16 v[208:211], a[236:239], a[100:103], v[208:211]
    v_cvt_pk_bf16_f32 v69, v202, v203
    s_waitcnt lgkmcnt(4)
    v_mfma_f32_16x16x32_bf16 v[212:215], a[236:239], a[124:127], v[212:215]
    buffer_load_dwordx4 v28, s[12:15], s62 offen lds
    s_add_u32 m0, s29, 0x1c00
    v_mfma_f32_16x16x32_bf16 v[204:207], a[240:243], a[80:83], v[204:207]
    buffer_load_dwordx4 v29, s[12:15], s62 offen lds
    s_add_u32 m0, s29, 0x2000
    s_waitcnt lgkmcnt(2)
    v_mfma_f32_16x16x32_bf16 v[208:211], a[240:243], a[104:107], v[208:211]
    ds_read_b128 a[236:239], v241 offset:30848
    v_mfma_f32_16x16x32_bf16 v[212:215], a[240:243], a[128:131], v[212:215]
    ds_read_b128 a[240:243], v240 offset:30976
    v_mfma_f32_16x16x32_bf16 v[204:207], a[244:247], a[84:87], v[204:207]
    v_mfma_f32_16x16x32_bf16 v[208:211], a[244:247], a[108:111], v[208:211]
    buffer_load_dwordx4 v58, s[12:15], s62 offen lds
    s_add_u32 m0, s29, 0x2400
    s_mov_b32 s62, 0x2400
    v_mfma_f32_16x16x32_bf16 v[212:215], a[244:247], a[132:135], v[212:215]
    ds_read_b128 a[244:247], v241 offset:30976
    s_waitcnt vmcnt(9)
    v_mfma_f32_16x16x32_bf16 v[204:207], a[216:219], a[88:91], v[204:207]
    ds_read_b64_tr_b16 a[156:157], v249 offset:9216
    v_mfma_f32_16x16x32_bf16 v[208:211], a[216:219], a[112:115], v[208:211]
    ds_read_b64_tr_b16 a[158:159], v250 offset:9216
    v_mfma_f32_16x16x32_bf16 v[212:215], a[216:219], a[136:139], v[212:215]
    ds_read_b64_tr_b16 a[180:181], v249 offset:9248
    v_mfma_f32_16x16x32_bf16 v[204:207], a[220:223], a[92:95], v[204:207]
    ds_read_b64_tr_b16 a[182:183], v250 offset:9248
    v_mfma_f32_16x16x32_bf16 v[208:211], a[220:223], a[116:119], v[208:211]
    ds_read_b64_tr_b16 a[204:205], v249 offset:9280
    v_mfma_f32_16x16x32_bf16 v[212:215], a[220:223], a[140:143], v[212:215]
    ds_read_b64_tr_b16 a[206:207], v250 offset:9280
    v_mfma_f32_16x16x32_bf16 v[216:219], a[224:227], a[72:75], 0
    ds_read_b128 a[216:219], v240 offset:32256
    s_waitcnt lgkmcnt(8)
    v_cvt_pk_bf16_f32 v12, v204, v205
    v_mfma_f32_16x16x32_bf16 v[220:223], a[224:227], a[96:99], 0
    ds_read_b128 a[220:223], v241 offset:32256
    v_cvt_pk_bf16_f32 v15, v206, v207
    v_mfma_f32_16x16x32_bf16 v[224:227], a[224:227], a[120:123], 0
    ds_read_b128 a[224:227], v240 offset:32384
    v_cvt_pk_bf16_f32 v42, v208, v209
    v_mfma_f32_16x16x32_bf16 v[216:219], a[228:231], a[76:79], v[216:219]
    v_cvt_pk_bf16_f32 v45, v210, v211
    v_cvt_pk_bf16_f32 v72, v212, v213
    v_mfma_f32_16x16x32_bf16 v[220:223], a[228:231], a[100:103], v[220:223]
    v_cvt_pk_bf16_f32 v75, v214, v215
    v_mfma_f32_16x16x32_bf16 v[224:227], a[228:231], a[124:127], v[224:227]
    ds_read_b128 a[228:231], v241 offset:32384
    v_mfma_f32_16x16x32_bf16 v[216:219], a[232:235], a[80:83], v[216:219]
    v_mfma_f32_16x16x32_bf16 v[220:223], a[232:235], a[104:107], v[220:223]
    v_mfma_f32_16x16x32_bf16 v[224:227], a[232:235], a[128:131], v[224:227]
    ds_read_b128 a[232:235], v240 offset:32512
    s_waitcnt lgkmcnt(4)
    v_mfma_f32_16x16x32_bf16 v[216:219], a[236:239], a[84:87], v[216:219]
    buffer_load_dwordx4 v28, s[12:15], s63 offen lds
    s_add_u32 m0, s29, 0x2800
    v_mfma_f32_16x16x32_bf16 v[220:223], a[236:239], a[108:111], v[220:223]
    buffer_load_dwordx4 v29, s[12:15], s63 offen lds
    s_add_u32 m0, s29, 0x2c00
    v_mfma_f32_16x16x32_bf16 v[224:227], a[236:239], a[132:135], v[224:227]
    ds_read_b128 a[236:239], v241 offset:32512
    v_mfma_f32_16x16x32_bf16 v[216:219], a[240:243], a[88:91], v[216:219]
    v_mfma_f32_16x16x32_bf16 v[220:223], a[240:243], a[112:115], v[220:223]
    buffer_load_dwordx4 v58, s[12:15], s63 offen lds
    s_add_u32 m0, s29, 0
    s_mov_b32 s63, 0x3c00
    v_mfma_f32_16x16x32_bf16 v[224:227], a[240:243], a[136:139], v[224:227]
    ds_read_b128 a[240:243], v240 offset:33792
    s_waitcnt vmcnt(9)
    v_mfma_f32_16x16x32_bf16 v[216:219], a[244:247], a[92:95], v[216:219]
    ds_read_b64_tr_b16 a[160:161], v249 offset:0
    v_mfma_f32_16x16x32_bf16 v[220:223], a[244:247], a[116:119], v[220:223]
    ds_read_b64_tr_b16 a[162:163], v250 offset:0
    v_mfma_f32_16x16x32_bf16 v[224:227], a[244:247], a[140:143], v[224:227]
    ds_read_b64_tr_b16 a[184:185], v249 offset:32
    v_mfma_f32_16x16x32_bf16 v[180:183], a[216:219], a[72:75], 0
    ds_read_b64_tr_b16 a[186:187], v250 offset:32
    s_waitcnt lgkmcnt(6)
    v_cvt_pk_bf16_f32 v1, v216, v217
    v_mfma_f32_16x16x32_bf16 v[184:187], a[216:219], a[96:99], 0
    ds_read_b64_tr_b16 a[208:209], v249 offset:64
    v_cvt_pk_bf16_f32 v4, v218, v219
    v_mfma_f32_16x16x32_bf16 v[188:191], a[216:219], a[120:123], 0
    ds_read_b64_tr_b16 a[210:211], v250 offset:64
    v_cvt_pk_bf16_f32 v31, v220, v221
    v_mfma_f32_16x16x32_bf16 v[180:183], a[220:223], a[76:79], v[180:183]
    ds_read_b128 a[244:247], v241 offset:33792
    v_cvt_pk_bf16_f32 v34, v222, v223
    v_mfma_f32_16x16x32_bf16 v[184:187], a[220:223], a[100:103], v[184:187]
    ds_read_b128 a[216:219], v240 offset:33920
    s_waitcnt lgkmcnt(8)
    v_cvt_pk_bf16_f32 v61, v224, v225
    v_mfma_f32_16x16x32_bf16 v[188:191], a[220:223], a[124:127], v[188:191]
    ds_read_b128 a[220:223], v241 offset:33920
    v_cvt_pk_bf16_f32 v64, v226, v227
    v_mfma_f32_16x16x32_bf16 v[180:183], a[224:227], a[80:83], v[180:183]
    v_mfma_f32_16x16x32_bf16 v[184:187], a[224:227], a[104:107], v[184:187]
    v_mfma_f32_16x16x32_bf16 v[188:191], a[224:227], a[128:131], v[188:191]
    ds_read_b128 a[224:227], v240 offset:34048
    v_mfma_f32_16x16x32_bf16 v[180:183], a[228:231], a[84:87], v[180:183]
    v_mfma_f32_16x16x32_bf16 v[184:187], a[228:231], a[108:111], v[184:187]
    v_mfma_f32_16x16x32_bf16 v[188:191], a[228:231], a[132:135], v[188:191]
    ds_read_b128 a[228:231], v241 offset:34048
    s_waitcnt lgkmcnt(4)
    v_mfma_f32_16x16x32_bf16 v[180:183], a[232:235], a[88:91], v[180:183]
    buffer_load_dwordx4 v28, s[12:15], s64 offen lds
    s_add_u32 m0, s29, 0x400
    v_mfma_f32_16x16x32_bf16 v[184:187], a[232:235], a[112:115], v[184:187]
    buffer_load_dwordx4 v29, s[12:15], s64 offen lds
    s_add_u32 m0, s29, 0x800
    v_mfma_f32_16x16x32_bf16 v[188:191], a[232:235], a[136:139], v[188:191]
    ds_read_b128 a[232:235], v240 offset:61440
    v_mfma_f32_16x16x32_bf16 v[180:183], a[236:239], a[92:95], v[180:183]
    v_mfma_f32_16x16x32_bf16 v[184:187], a[236:239], a[116:119], v[184:187]
    buffer_load_dwordx4 v58, s[12:15], s64 offen lds
    s_add_u32 m0, s29, 0xc00
    s_mov_b32 s64, 0x1000
    v_mfma_f32_16x16x32_bf16 v[188:191], a[236:239], a[140:143], v[188:191]
    ds_read_b128 a[236:239], v241 offset:61440
    s_waitcnt vmcnt(9)
    v_mfma_f32_16x16x32_bf16 v[192:195], a[240:243], a[72:75], 0
    ds_read_b64_tr_b16 a[164:165], v249 offset:3072
    v_cvt_pk_bf16_f32 v7, v180, v181
    v_mfma_f32_16x16x32_bf16 v[196:199], a[240:243], a[96:99], 0
    ds_read_b64_tr_b16 a[166:167], v250 offset:3072
    v_cvt_pk_bf16_f32 v10, v182, v183
    v_mfma_f32_16x16x32_bf16 v[200:203], a[240:243], a[120:123], 0
    ds_read_b64_tr_b16 a[188:189], v249 offset:3104
    v_cvt_pk_bf16_f32 v37, v184, v185
    v_mfma_f32_16x16x32_bf16 v[192:195], a[244:247], a[76:79], v[192:195]
    ds_read_b64_tr_b16 a[190:191], v250 offset:3104
    s_waitcnt lgkmcnt(6)
    v_cvt_pk_bf16_f32 v40, v186, v187
    v_mfma_f32_16x16x32_bf16 v[196:199], a[244:247], a[100:103], v[196:199]
    ds_read_b64_tr_b16 a[212:213], v249 offset:3136
    s_waitcnt lgkmcnt(6)
    v_cvt_pk_bf16_f32 v67, v188, v189
    v_mfma_f32_16x16x32_bf16 v[200:203], a[244:247], a[124:127], v[200:203]
    ds_read_b64_tr_b16 a[214:215], v250 offset:3136
    v_cvt_pk_bf16_f32 v70, v190, v191
    v_mfma_f32_16x16x32_bf16 v[192:195], a[216:219], a[80:83], v[192:195]
    ds_read_b128 a[240:243], v240 offset:61568
    v_mfma_f32_16x16x32_bf16 v[196:199], a[216:219], a[104:107], v[196:199]
    ds_read_b128 a[244:247], v241 offset:61568
    v_mfma_f32_16x16x32_bf16 v[200:203], a[216:219], a[128:131], v[200:203]
    ds_read_b128 a[216:219], v240 offset:61696
    v_mfma_f32_16x16x32_bf16 v[192:195], a[220:223], a[84:87], v[192:195]
    v_mfma_f32_16x16x32_bf16 v[196:199], a[220:223], a[108:111], v[196:199]
    v_mfma_f32_16x16x32_bf16 v[200:203], a[220:223], a[132:135], v[200:203]
    ds_read_b128 a[220:223], v241 offset:61696
    v_mfma_f32_16x16x32_bf16 v[192:195], a[224:227], a[88:91], v[192:195]
    v_mfma_f32_16x16x32_bf16 v[196:199], a[224:227], a[112:115], v[196:199]
    v_mfma_f32_16x16x32_bf16 v[200:203], a[224:227], a[136:139], v[200:203]
    ds_read_b128 a[224:227], v240 offset:62976
    s_waitcnt lgkmcnt(4)
    v_mfma_f32_16x16x32_bf16 v[192:195], a[228:231], a[92:95], v[192:195]
    buffer_load_dwordx4 v28, s[12:15], s65 offen lds
    s_add_u32 m0, s29, 0x1000
    v_mfma_f32_16x16x32_bf16 v[196:199], a[228:231], a[116:119], v[196:199]
    buffer_load_dwordx4 v29, s[12:15], s65 offen lds
    s_add_u32 m0, s29, 0x1400
    v_mfma_f32_16x16x32_bf16 v[200:203], a[228:231], a[140:143], v[200:203]
    ds_read_b128 a[228:231], v241 offset:62976
    v_mfma_f32_16x16x32_bf16 v[204:207], a[232:235], a[72:75], 0
    v_cvt_pk_bf16_f32 v13, v192, v193
    v_cvt_pk_bf16_f32 v16, v194, v195
    v_mfma_f32_16x16x32_bf16 v[208:211], a[232:235], a[96:99], 0
    v_cvt_pk_bf16_f32 v43, v196, v197
    v_cvt_pk_bf16_f32 v46, v198, v199
    v_mfma_f32_16x16x32_bf16 v[212:215], a[232:235], a[120:123], 0
    ds_read_b128 a[232:235], v240 offset:63104
    v_cvt_pk_bf16_f32 v73, v200, v201
    v_mfma_f32_16x16x32_bf16 v[204:207], a[236:239], a[76:79], v[204:207]
    buffer_load_dwordx4 v58, s[12:15], s65 offen lds
    s_add_u32 m0, s29, 0x1800
    v_cvt_pk_bf16_f32 v76, v202, v203
    v_mfma_f32_16x16x32_bf16 v[208:211], a[236:239], a[100:103], v[208:211]
    s_mov_b32 s65, 0x2800
    v_mov_b32 v195, 0
    s_waitcnt vmcnt(9) lgkmcnt(2)
    v_mfma_f32_16x16x32_bf16 v[212:215], a[236:239], a[124:127], v[212:215]
    ds_read_b128 a[236:239], v241 offset:63104
    v_mfma_f32_16x16x32_bf16 v[204:207], a[240:243], a[80:83], v[204:207]
    ds_read_b64_tr_b16 v[24:25], v59 offset:6144
    v_mfma_f32_16x16x32_bf16 v[208:211], a[240:243], a[104:107], v[208:211]
    ds_read_b64_tr_b16 v[26:27], v88 offset:6144
    v_mfma_f32_16x16x32_bf16 v[212:215], a[240:243], a[128:131], v[212:215]
    ds_read_b128 a[240:243], v240 offset:63232
    v_mfma_f32_16x16x32_bf16 v[204:207], a[244:247], a[84:87], v[204:207]
    ds_read_b64_tr_b16 v[54:55], v59 offset:6152
    v_mfma_f32_16x16x32_bf16 v[208:211], a[244:247], a[108:111], v[208:211]
    ds_read_b64_tr_b16 v[56:57], v88 offset:6152
    v_mfma_f32_16x16x32_bf16 v[212:215], a[244:247], a[132:135], v[212:215]
    ds_read_b128 a[244:247], v241 offset:63232
    v_mfma_f32_16x16x32_bf16 v[204:207], a[216:219], a[88:91], v[204:207]
    ds_read_b64_tr_b16 v[84:85], v249 offset:6208
    v_mfma_f32_16x16x32_bf16 v[208:211], a[216:219], a[112:115], v[208:211]
    ds_read_b64_tr_b16 v[86:87], v250 offset:6208
    v_mfma_f32_16x16x32_bf16 v[212:215], a[216:219], a[136:139], v[212:215]
    ds_read_b128 a[216:219], v240 offset:64512
    v_mfma_f32_16x16x32_bf16 v[204:207], a[220:223], a[92:95], v[204:207]
    v_mfma_f32_16x16x32_bf16 v[208:211], a[220:223], a[116:119], v[208:211]
    s_waitcnt lgkmcnt(7)
    v_mfma_f32_16x16x32_bf16 v[212:215], a[220:223], a[140:143], v[212:215]
    ds_read_b128 a[220:223], v241 offset:64512
    v_mfma_f32_16x16x32_bf16 v[216:219], a[224:227], a[72:75], 0
    buffer_store_dwordx4 v[24:27], v89, s[24:27], s50 offen
    v_mfma_f32_16x16x32_bf16 v[220:223], a[224:227], a[96:99], 0
    s_mov_b32 s50, 0x4000
    v_cvt_pk_bf16_f32 v2, v204, v205
    v_cvt_pk_bf16_f32 v5, v206, v207
    v_mfma_f32_16x16x32_bf16 v[224:227], a[224:227], a[120:123], 0
    ds_read_b128 a[224:227], v240 offset:64640
    s_waitcnt lgkmcnt(4)
    v_cvt_pk_bf16_f32 v32, v208, v209
    v_mfma_f32_16x16x32_bf16 v[216:219], a[228:231], a[76:79], v[216:219]
    buffer_store_dwordx4 v[54:57], v89, s[24:27], s51 offen
    v_mfma_f32_16x16x32_bf16 v[220:223], a[228:231], a[100:103], v[220:223]
    s_mov_b32 s51, 0x1400
    v_cvt_pk_bf16_f32 v35, v210, v211
    v_cvt_pk_bf16_f32 v62, v212, v213
    v_mfma_f32_16x16x32_bf16 v[224:227], a[228:231], a[124:127], v[224:227]
    ds_read_b128 a[228:231], v241 offset:64640
    s_waitcnt lgkmcnt(3)
    v_cvt_pk_bf16_f32 v65, v214, v215
    v_mfma_f32_16x16x32_bf16 v[216:219], a[232:235], a[80:83], v[216:219]
    v_mfma_f32_16x16x32_bf16 v[220:223], a[232:235], a[104:107], v[220:223]
    buffer_load_dwordx4 v28, s[12:15], s53 offen lds
    s_add_u32 m0, s29, 0x1c00
    s_waitcnt vmcnt(9)
    v_mfma_f32_16x16x32_bf16 v[224:227], a[232:235], a[128:131], v[224:227]
    ds_read_b128 a[232:235], v240 offset:64768
    v_mfma_f32_16x16x32_bf16 v[216:219], a[236:239], a[84:87], v[216:219]
    ds_read_b64_tr_b16 v[24:25], v59 offset:9216
    v_mfma_f32_16x16x32_bf16 v[220:223], a[236:239], a[108:111], v[220:223]
    ds_read_b64_tr_b16 v[26:27], v88 offset:9216
    v_mfma_f32_16x16x32_bf16 v[224:227], a[236:239], a[132:135], v[224:227]
    ds_read_b128 a[236:239], v241 offset:64768
    v_mfma_f32_16x16x32_bf16 v[216:219], a[240:243], a[88:91], v[216:219]
    ds_read_b64_tr_b16 v[54:55], v59 offset:9224
    v_mfma_f32_16x16x32_bf16 v[220:223], a[240:243], a[112:115], v[220:223]
    ds_read_b64_tr_b16 v[56:57], v88 offset:9224
    v_mfma_f32_16x16x32_bf16 v[224:227], a[240:243], a[136:139], v[224:227]
    buffer_load_dwordx4 v29, s[12:15], s53 offen lds
    s_add_u32 m0, s29, 0x2000
    v_mfma_f32_16x16x32_bf16 v[216:219], a[244:247], a[92:95], v[216:219]
    ds_read_b128 a[240:243], v242 offset:0
    v_mfma_f32_16x16x32_bf16 v[220:223], a[244:247], a[116:119], v[220:223]
    v_mfma_f32_16x16x32_bf16 v[224:227], a[244:247], a[140:143], v[224:227]
    ds_read_b128 a[244:247], v243 offset:0
    v_mfma_f32_16x16x32_bf16 v[180:183], a[216:219], a[72:75], 0
    s_waitcnt lgkmcnt(6)
    s_waitcnt lgkmcnt(5)
    v_mfma_f32_16x16x32_bf16 v[184:187], a[216:219], a[96:99], 0
    v_cvt_pk_bf16_f32 v8, v216, v217
    v_cvt_pk_bf16_f32 v11, v218, v219
    v_mfma_f32_16x16x32_bf16 v[188:191], a[216:219], a[120:123], 0
    ds_read_b128 a[216:219], v242 offset:128
    v_cvt_pk_bf16_f32 v38, v220, v221
    v_mfma_f32_16x16x32_bf16 v[180:183], a[220:223], a[76:79], v[180:183]
    buffer_load_dwordx4 v58, s[12:15], s53 offen lds
    s_add_u32 m0, s29, 0x2400
    v_cvt_pk_bf16_f32 v41, v222, v223
    v_mfma_f32_16x16x32_bf16 v[184:187], a[220:223], a[100:103], v[184:187]
    s_mov_b32 s53, 0x4400
    v_cvt_pk_bf16_f32 v68, v224, v225
    v_cvt_pk_bf16_f32 v71, v226, v227
    v_mfma_f32_16x16x32_bf16 v[188:191], a[220:223], a[124:127], v[188:191]
    ds_read_b128 a[220:223], v243 offset:128
    s_waitcnt lgkmcnt(3)
    v_mfma_f32_16x16x32_bf16 v[180:183], a[224:227], a[80:83], v[180:183]
    v_mfma_f32_16x16x32_bf16 v[184:187], a[224:227], a[104:107], v[184:187]
    v_mfma_f32_16x16x32_bf16 v[188:191], a[224:227], a[128:131], v[188:191]
    ds_read_b128 a[224:227], v242 offset:256
    v_mfma_f32_16x16x32_bf16 v[180:183], a[228:231], a[84:87], v[180:183]
    v_mfma_f32_16x16x32_bf16 v[184:187], a[228:231], a[108:111], v[184:187]
    buffer_store_dwordx4 v[84:87], v89, s[24:27], s52 offen
    v_mfma_f32_16x16x32_bf16 v[188:191], a[228:231], a[132:135], v[188:191]
    ds_read_b128 a[228:231], v243 offset:256
    s_mov_b32 s52, 0x2c00
    v_mfma_f32_16x16x32_bf16 v[180:183], a[232:235], a[88:91], v[180:183]
    ds_read_b64_tr_b16 v[84:85], v249 offset:9280
    v_mfma_f32_16x16x32_bf16 v[184:187], a[232:235], a[112:115], v[184:187]
    ds_read_b64_tr_b16 v[86:87], v250 offset:9280
    v_mfma_f32_16x16x32_bf16 v[188:191], a[232:235], a[136:139], v[188:191]
    ds_read_b128 a[232:235], v240 offset:4608
    v_mfma_f32_16x16x32_bf16 v[180:183], a[236:239], a[92:95], v[180:183]
    v_mfma_f32_16x16x32_bf16 v[184:187], a[236:239], a[116:119], v[184:187]
    v_mfma_f32_16x16x32_bf16 v[188:191], a[236:239], a[140:143], v[188:191]
    ds_read_b128 a[236:239], v241 offset:4608
    v_mfma_f32_16x16x32_bf16 v[228:231], a[144:147], a[240:243], 0
    buffer_store_dwordx4 v[24:27], v89, s[24:27], s54 offen
    v_mfma_f32_16x16x32_bf16 v[232:235], a[168:171], a[240:243], 0
    s_add_u32 s54, s43, s45
    s_waitcnt vmcnt(9) lgkmcnt(4)
    v_cvt_pk_bf16_f32 v14, v180, v181
    v_mfma_f32_16x16x32_bf16 v[228:231], a[148:151], a[244:247], v[228:231]
    ds_read_b64_tr_b16 v[24:25], v59 offset:0
    v_cvt_pk_bf16_f32 v17, v182, v183
    v_mfma_f32_16x16x32_bf16 v[228:231], a[152:155], a[216:219], v[228:231]
    ds_read_b64_tr_b16 v[26:27], v88 offset:0
    s_waitcnt lgkmcnt(4)
    v_cvt_pk_bf16_f32 v44, v184, v185
    v_mfma_f32_16x16x32_bf16 v[228:231], a[156:159], a[220:223], v[228:231]
    v_cvt_pk_bf16_f32 v47, v186, v187
    v_cvt_pk_bf16_f32 v74, v188, v189
    v_mfma_f32_16x16x32_bf16 v[228:231], a[160:163], a[224:227], v[228:231]
    v_cvt_pk_bf16_f32 v77, v190, v191
    v_mfma_f32_16x16x32_bf16 v[228:231], a[164:167], a[228:231], v[228:231]
    buffer_load_dwordx4 v28, s[12:15], s57 offen lds
    s_add_u32 m0, s29, 0x2800
    v_mfma_f32_16x16x32_bf16 v[232:235], a[172:175], a[244:247], v[232:235]
    v_mfma_f32_16x16x32_bf16 v[232:235], a[176:179], a[216:219], v[232:235]
    v_mfma_f32_16x16x32_bf16 v[232:235], a[180:183], a[220:223], v[232:235]
    v_mfma_f32_16x16x32_bf16 v[232:235], a[184:187], a[224:227], v[232:235]
    v_mfma_f32_16x16x32_bf16 v[232:235], a[188:191], a[228:231], v[232:235]
    v_mfma_f32_16x16x32_bf16 v[236:239], a[192:195], a[240:243], 0
    buffer_load_dwordx4 v29, s[12:15], s57 offen lds
    s_add_u32 m0, s29, 0x2c00
    v_mul_f32 v228, s38, v228
    v_mfma_f32_16x16x32_bf16 v[236:239], a[196:199], a[244:247], v[236:239]
    ds_read_b128 a[240:243], v240 offset:4736
    s_waitcnt lgkmcnt(1)
    v_mul_f32 v229, s38, v229
    v_mfma_f32_16x16x32_bf16 v[236:239], a[200:203], a[216:219], v[236:239]
    ds_read_b128 a[244:247], v241 offset:4736
    v_mul_f32 v230, s38, v230
    v_mfma_f32_16x16x32_bf16 v[236:239], a[204:207], a[220:223], v[236:239]
    ds_read_b128 a[216:219], v240 offset:4864
    v_mul_f32 v231, s38, v231
    v_mfma_f32_16x16x32_bf16 v[236:239], a[208:211], a[224:227], v[236:239]
    ds_read_b128 a[220:223], v241 offset:4864
    v_cvt_pk_bf16_f32 v168, v228, v229
    v_mfma_f32_16x16x32_bf16 v[236:239], a[212:215], a[228:231], v[236:239]
    ds_read_b128 a[224:227], v240 offset:35328
    ds_read_b128 a[228:231], v241 offset:35328
    v_cvt_pk_bf16_f32 v169, v230, v231
    v_mfma_f32_16x16x32_bf16 v[228:231], a[232:235], a[72:75], 0
    v_mul_f32 v232, s38, v232
    v_mul_f32 v233, s38, v233
    v_mfma_f32_16x16x32_bf16 v[228:231], a[236:239], a[76:79], v[228:231]
    buffer_load_dwordx4 v58, s[12:15], s57 offen lds
    s_add_u32 m0, s46, 0x16800
    v_mul_f32 v234, s38, v234
    v_mul_f32 v235, s38, v235
    v_cvt_pk_bf16_f32 v170, v232, v233
    v_cvt_pk_bf16_f32 v171, v234, v235
    v_mfma_f32_16x16x32_bf16 v[232:235], a[232:235], a[96:99], 0
    s_lshl1_add_u32 s57, s45, s43
    v_mul_f32 v236, s38, v236
    v_mul_f32 v237, s38, v237
    v_mfma_f32_16x16x32_bf16 v[232:235], a[236:239], a[100:103], v[232:235]
    s_waitcnt lgkmcnt(5)
    v_mul_f32 v238, s38, v238
    v_mul_f32 v239, s38, v239
    v_mfma_f32_16x16x32_bf16 v[228:231], a[240:243], a[80:83], v[228:231]
    s_waitcnt lgkmcnt(4)
    v_cvt_pk_bf16_f32 v172, v236, v237
    v_cvt_pk_bf16_f32 v173, v238, v239
    v_mfma_f32_16x16x32_bf16 v[228:231], a[244:247], a[84:87], v[228:231]
    s_waitcnt lgkmcnt(3)
    v_mfma_f32_16x16x32_bf16 v[228:231], a[216:219], a[88:91], v[228:231]
    s_waitcnt lgkmcnt(2)
    v_mfma_f32_16x16x32_bf16 v[228:231], a[220:223], a[92:95], v[228:231]
    v_mfma_f32_16x16x32_bf16 v[232:235], a[240:243], a[104:107], v[232:235]
    buffer_store_dwordx4 v[54:57], v89, s[24:27], s55 offen
    v_mfma_f32_16x16x32_bf16 v[232:235], a[244:247], a[108:111], v[232:235]
    s_add_u32 s55, s43, s45
    ds_read_b64_tr_b16 v[54:55], v59 offset:8
    v_mfma_f32_16x16x32_bf16 v[232:235], a[216:219], a[112:115], v[232:235]
    ds_read_b64_tr_b16 v[56:57], v88 offset:8
    v_mfma_f32_16x16x32_bf16 v[232:235], a[220:223], a[116:119], v[232:235]
    v_cvt_pk_bf16_f32 v18, v228, v229
    v_cvt_pk_bf16_f32 v21, v230, v231
    v_mfma_f32_16x16x32_bf16 v[236:239], a[232:235], a[120:123], 0
    ds_read_b128 a[232:235], v240 offset:35456
    s_waitcnt lgkmcnt(3)
    v_mfma_f32_16x16x32_bf16 v[236:239], a[236:239], a[124:127], v[236:239]
    ds_read_b128 a[236:239], v241 offset:35456
    v_mfma_f32_16x16x32_bf16 v[236:239], a[240:243], a[128:131], v[236:239]
    ds_read_b128 a[240:243], v240 offset:35584
    v_cvt_pk_bf16_f32 v48, v232, v233
    v_mfma_f32_16x16x32_bf16 v[236:239], a[244:247], a[132:135], v[236:239]
    ds_read_b128 a[244:247], v241 offset:35584
    v_cvt_pk_bf16_f32 v51, v234, v235
    v_mfma_f32_16x16x32_bf16 v[236:239], a[216:219], a[136:139], v[236:239]
    buffer_store_dwordx4 v[84:87], v89, s[24:27], s56 offen
    v_mfma_f32_16x16x32_bf16 v[236:239], a[220:223], a[140:143], v[236:239]
    s_add_u32 s56, s43, s45
    v_add_u32 v240, 0xf000, v240
    v_add_u32 v241, 0xf000, v241
    v_mfma_f32_16x16x32_bf16 v[228:231], a[224:227], a[72:75], 0
    ds_read_b128 a[216:219], v240 offset:4608
    s_waitcnt lgkmcnt(5)
    v_mfma_f32_16x16x32_bf16 v[228:231], a[228:231], a[76:79], v[228:231]
    ds_read_b128 a[220:223], v241 offset:4608
    v_cvt_pk_bf16_f32 v78, v236, v237
    v_mfma_f32_16x16x32_bf16 v[232:235], a[224:227], a[96:99], 0
    ds_read_b64_tr_b16 v[84:85], v249 offset:64
    s_waitcnt lgkmcnt(6)
    v_cvt_pk_bf16_f32 v81, v238, v239
    v_mfma_f32_16x16x32_bf16 v[228:231], a[232:235], a[80:83], v[228:231]
    buffer_store_dwordx4 v[24:27], v89, s[24:27], s58 offen
    v_mfma_f32_16x16x32_bf16 v[232:235], a[228:231], a[100:103], v[232:235]
    ds_read_b64_tr_b16 v[86:87], v250 offset:64
    s_lshl1_add_u32 s58, s45, s43
    s_waitcnt vmcnt(9) lgkmcnt(5)
    v_mfma_f32_16x16x32_bf16 v[228:231], a[236:239], a[84:87], v[228:231]
    ds_read_b64_tr_b16 v[24:25], v59 offset:3072
    v_mfma_f32_16x16x32_bf16 v[228:231], a[240:243], a[88:91], v[228:231]
    ds_read_b64_tr_b16 v[26:27], v88 offset:3072
    s_waitcnt lgkmcnt(6)
    v_mfma_f32_16x16x32_bf16 v[228:231], a[244:247], a[92:95], v[228:231]
    v_mfma_f32_16x16x32_bf16 v[232:235], a[232:235], a[104:107], v[232:235]
    v_mfma_f32_16x16x32_bf16 v[232:235], a[236:239], a[108:111], v[232:235]
    buffer_store_dwordx4 v[54:57], v89, s[24:27], s59 offen
    v_mfma_f32_16x16x32_bf16 v[232:235], a[240:243], a[112:115], v[232:235]
    s_add_u32 s59, s44, s45
    ds_read_b64_tr_b16 v[54:55], v59 offset:3080
    v_mfma_f32_16x16x32_bf16 v[232:235], a[244:247], a[116:119], v[232:235]
    ds_read_b64_tr_b16 v[56:57], v88 offset:3080
    v_cvt_pk_bf16_f32 v19, v228, v229
    v_mfma_f32_16x16x32_bf16 v[236:239], a[224:227], a[120:123], 0
    ds_read_b128 a[224:227], v240 offset:4736
    s_waitcnt lgkmcnt(5)
    v_cvt_pk_bf16_f32 v22, v230, v231
    v_mfma_f32_16x16x32_bf16 v[236:239], a[228:231], a[124:127], v[236:239]
    ds_read_b128 a[228:231], v241 offset:4736
    v_cvt_pk_bf16_f32 v49, v232, v233
    v_mfma_f32_16x16x32_bf16 v[236:239], a[232:235], a[128:131], v[236:239]
    ds_read_b128 a[232:235], v240 offset:4864
    s_waitcnt lgkmcnt(5)
    v_cvt_pk_bf16_f32 v52, v234, v235
    v_mfma_f32_16x16x32_bf16 v[236:239], a[236:239], a[132:135], v[236:239]
    ds_read_b128 a[236:239], v241 offset:4864
    v_add_u32 v240, 0xffff1000, v240
    v_mfma_f32_16x16x32_bf16 v[236:239], a[240:243], a[136:139], v[236:239]
    ds_read_b128 a[240:243], v240 offset:6144
    v_add_u32 v241, 0xffff1000, v241
    v_mfma_f32_16x16x32_bf16 v[236:239], a[244:247], a[140:143], v[236:239]
    ds_read_b128 a[244:247], v241 offset:6144
    v_mfma_f32_16x16x32_bf16 v[228:231], a[216:219], a[72:75], 0
    buffer_store_dwordx4 v[84:87], v89, s[24:27], s60 offen
    v_mfma_f32_16x16x32_bf16 v[228:231], a[220:223], a[76:79], v[228:231]
    s_add_u32 s60, s44, s45
    ds_read_b64_tr_b16 v[84:85], v249 offset:3136
    v_mfma_f32_16x16x32_bf16 v[232:235], a[216:219], a[96:99], 0
    ds_read_b64_tr_b16 v[86:87], v250 offset:3136
    s_waitcnt lgkmcnt(7)
    v_cvt_pk_bf16_f32 v79, v236, v237
    v_mfma_f32_16x16x32_bf16 v[228:231], a[224:227], a[80:83], v[228:231]
    s_waitcnt lgkmcnt(6)
    v_cvt_pk_bf16_f32 v82, v238, v239
    v_mfma_f32_16x16x32_bf16 v[228:231], a[228:231], a[84:87], v[228:231]
    s_waitcnt lgkmcnt(5)
    v_mfma_f32_16x16x32_bf16 v[228:231], a[232:235], a[88:91], v[228:231]
    buffer_store_dwordx4 v[24:27], v89, s[24:27], s61 offen
    v_mfma_f32_16x16x32_bf16 v[232:235], a[220:223], a[100:103], v[232:235]
    s_add_u32 s61, s44, s45
    s_waitcnt vmcnt(9) lgkmcnt(3)
    v_mfma_f32_16x16x32_bf16 v[228:231], a[236:239], a[92:95], v[228:231]
    ds_read_b64_tr_b16 v[24:25], v59 offset:6144
    v_mfma_f32_16x16x32_bf16 v[232:235], a[224:227], a[104:107], v[232:235]
    ds_read_b64_tr_b16 v[26:27], v88 offset:6144
    v_mfma_f32_16x16x32_bf16 v[232:235], a[228:231], a[108:111], v[232:235]
    v_mfma_f32_16x16x32_bf16 v[232:235], a[232:235], a[112:115], v[232:235]
    s_waitcnt lgkmcnt(2)
    v_mfma_f32_16x16x32_bf16 v[232:235], a[236:239], a[116:119], v[232:235]
    buffer_store_dwordx4 v[54:57], v89, s[24:27], s62 offen
    v_mfma_f32_16x16x32_bf16 v[236:239], a[216:219], a[120:123], 0
    ds_read_b128 a[216:219], v240 offset:6272
    s_lshl1_add_u32 s62, s45, s44
    v_cvt_pk_bf16_f32 v20, v228, v229
    v_mfma_f32_16x16x32_bf16 v[236:239], a[220:223], a[124:127], v[236:239]
    ds_read_b128 a[220:223], v241 offset:6272
    v_cvt_pk_bf16_f32 v23, v230, v231
    v_mfma_f32_16x16x32_bf16 v[236:239], a[224:227], a[128:131], v[236:239]
    ds_read_b128 a[224:227], v240 offset:6400
    v_cvt_pk_bf16_f32 v50, v232, v233
    v_mfma_f32_16x16x32_bf16 v[236:239], a[228:231], a[132:135], v[236:239]
    ds_read_b128 a[228:231], v241 offset:6400
    v_cvt_pk_bf16_f32 v53, v234, v235
    v_mfma_f32_16x16x32_bf16 v[236:239], a[232:235], a[136:139], v[236:239]
    ds_read_b128 a[232:235], v242 offset:1536
    s_waitcnt lgkmcnt(5)
    v_mfma_f32_16x16x32_bf16 v[236:239], a[236:239], a[140:143], v[236:239]
    ds_read_b128 a[236:239], v243 offset:1536
    v_mfma_f32_16x16x32_bf16 v[228:231], a[0:3], a[240:243], 0
    buffer_store_dwordx4 v[84:87], v89, s[24:27], s63 offen
    v_mfma_f32_16x16x32_bf16 v[228:231], a[4:7], a[244:247], v[228:231]
    ds_read_b64_tr_b16 v[54:55], v59 offset:6152
    s_lshl1_add_u32 s63, s45, s44
    v_mfma_f32_16x16x32_bf16 v[232:235], a[24:27], a[240:243], 0
    ds_read_b64_tr_b16 v[56:57], v88 offset:6152
    s_waitcnt lgkmcnt(7)
    v_cvt_pk_bf16_f32 v80, v236, v237
    v_mfma_f32_16x16x32_bf16 v[228:231], a[8:11], a[216:219], v[228:231]
    ds_read_b64_tr_b16 v[84:85], v249 offset:6208
    s_waitcnt lgkmcnt(7)
    v_cvt_pk_bf16_f32 v83, v238, v239
    v_mfma_f32_16x16x32_bf16 v[228:231], a[12:15], a[220:223], v[228:231]
    ds_read_b64_tr_b16 v[86:87], v250 offset:6208
    s_waitcnt lgkmcnt(7)
    v_mfma_f32_16x16x32_bf16 v[228:231], a[16:19], a[224:227], v[228:231]
    s_waitcnt lgkmcnt(6)
    v_mfma_f32_16x16x32_bf16 v[228:231], a[20:23], a[228:231], v[228:231]
    v_mfma_f32_16x16x32_bf16 v[232:235], a[28:31], a[244:247], v[232:235]
    buffer_store_dwordx4 v[24:27], v89, s[24:27], s64 offen
    v_mfma_f32_16x16x32_bf16 v[232:235], a[32:35], a[216:219], v[232:235]
    s_mov_b32 s64, 0
    s_waitcnt vmcnt(9)
    v_mfma_f32_16x16x32_bf16 v[232:235], a[36:39], a[220:223], v[232:235]
    ds_read_b64_tr_b16 v[24:25], v59 offset:9216
    v_mfma_f32_16x16x32_bf16 v[232:235], a[40:43], a[224:227], v[232:235]
    ds_read_b64_tr_b16 v[26:27], v88 offset:9216
    s_waitcnt lgkmcnt(4)
    v_cvt_pk_bf16_f32 v162, v228, v229
    v_mfma_f32_16x16x32_bf16 v[232:235], a[44:47], a[228:231], v[232:235]
    v_cvt_pk_bf16_f32 v163, v230, v231
    v_mfma_f32_16x16x32_bf16 v[236:239], a[48:51], a[240:243], 0
    ds_read_b128 a[240:243], v242 offset:1664
    s_waitcnt lgkmcnt(3)
    v_mfma_f32_16x16x32_bf16 v[236:239], a[52:55], a[244:247], v[236:239]
    ds_read_b128 a[244:247], v243 offset:1664
    v_mfma_f32_16x16x32_bf16 v[236:239], a[56:59], a[216:219], v[236:239]
    ds_read_b128 a[216:219], v242 offset:1792
    v_cvt_pk_bf16_f32 v164, v232, v233
    v_mfma_f32_16x16x32_bf16 v[236:239], a[60:63], a[220:223], v[236:239]
    ds_read_b128 a[220:223], v243 offset:1792
    v_cvt_pk_bf16_f32 v165, v234, v235
    v_mfma_f32_16x16x32_bf16 v[236:239], a[64:67], a[224:227], v[236:239]
    buffer_store_dwordx4 v[54:57], v89, s[24:27], s65 offen
    v_mfma_f32_16x16x32_bf16 v[236:239], a[68:71], a[228:231], v[236:239]
    s_mov_b32 s65, 0
    ds_read_b64_tr_b16 v[54:55], v59 offset:9224
    v_mfma_f32_16x16x32_bf16 v[228:231], a[144:147], a[232:235], 0
    ds_read_b64_tr_b16 v[56:57], v88 offset:9224
    s_waitcnt lgkmcnt(6)
    v_mfma_f32_16x16x32_bf16 v[228:231], a[148:151], a[236:239], v[228:231]
    v_mfma_f32_16x16x32_bf16 v[232:235], a[168:171], a[232:235], 0
    buffer_store_dwordx4 v[84:87], v89, s[24:27], s50 offen
    v_mfma_f32_16x16x32_bf16 v[232:235], a[172:175], a[236:239], v[232:235]
    s_waitcnt lgkmcnt(4)
    v_cvt_pk_bf16_f32 v166, v236, v237
    v_cvt_pk_bf16_f32 v167, v238, v239
    v_mfma_f32_16x16x32_bf16 v[228:231], a[152:155], a[240:243], v[228:231]
    ds_read_b64_tr_b16 v[84:85], v249 offset:9280
    s_mov_b32 s50, 0
    v_mfma_f32_16x16x32_bf16 v[228:231], a[156:159], a[244:247], v[228:231]
    ds_read_b64_tr_b16 v[86:87], v250 offset:9280
    s_waitcnt lgkmcnt(4)
    v_mfma_f32_16x16x32_bf16 v[228:231], a[160:163], a[216:219], v[228:231]
    v_mfma_f32_16x16x32_bf16 v[228:231], a[164:167], a[220:223], v[228:231]
    v_mfma_f32_16x16x32_bf16 v[232:235], a[176:179], a[240:243], v[232:235]
    buffer_store_dwordx4 v[24:27], v89, s[24:27], s51 offen
    v_mfma_f32_16x16x32_bf16 v[232:235], a[180:183], a[244:247], v[232:235]
    s_mov_b32 s51, 0
    s_waitcnt lgkmcnt(2)
    v_mfma_f32_16x16x32_bf16 v[232:235], a[184:187], a[216:219], v[232:235]
    v_mfma_f32_16x16x32_bf16 v[232:235], a[188:191], a[220:223], v[232:235]
    v_mfma_f32_16x16x32_bf16 v[236:239], a[192:195], a[232:235], 0
    v_mul_f32 v228, s38, v228
    v_mul_f32 v229, s38, v229
    v_mfma_f32_16x16x32_bf16 v[236:239], a[196:199], a[236:239], v[236:239]
    s_waitcnt lgkmcnt(0)
    v_mul_f32 v230, s38, v230
    v_mul_f32 v231, s38, v231
    v_mfma_f32_16x16x32_bf16 v[236:239], a[200:203], a[240:243], v[236:239]
    s_barrier
    v_cvt_pk_bf16_f32 v174, v228, v229
    v_cvt_pk_bf16_f32 v175, v230, v231
    v_mfma_f32_16x16x32_bf16 v[236:239], a[204:207], a[244:247], v[236:239]
    ds_read_b128 v[196:199], v244 offset:192
    v_mul_f32 v232, s38, v232
    v_mfma_f32_16x16x32_bf16 v[236:239], a[208:211], a[216:219], v[236:239]
    ds_read_b128 v[200:203], v245 offset:192
    v_mul_f32 v233, s38, v233
    v_mfma_f32_16x16x32_bf16 v[236:239], a[212:215], a[220:223], v[236:239]
    ds_read_b128 v[204:207], v246 offset:192
    ds_read_b128 v[208:211], v244 offset:256
    buffer_load_dwordx4 v254, s[4:7], s43 offen lds
    s_add_u32 m0, s46, 0x16c00
    v_mul_f32 v234, s38, v234
    v_mul_f32 v235, s38, v235
    v_cvt_pk_bf16_f32 v176, v232, v233
    v_cvt_pk_bf16_f32 v177, v234, v235
    v_mul_f32 v236, s38, v236
    v_mul_f32 v237, s38, v237
    v_mul_f32 v238, s38, v238
    v_mul_f32 v239, s38, v239
    v_cvt_pk_bf16_f32 v178, v236, v237
    v_cvt_pk_bf16_f32 v179, v238, v239
    v_accvgpr_read_b32 v254, a254
    ds_read_b128 a[224:227], v240 offset:6144
    ds_read_b128 a[228:231], v241 offset:6144
    buffer_load_dwordx4 v255, s[4:7], s43 offen lds
    s_add_u32 m0, s46, 0x17000
    v_accvgpr_read_b32 v255, a252
    ds_read_b128 a[232:235], v240 offset:6272
    ds_read_b128 a[236:239], v241 offset:6272
    s_waitcnt lgkmcnt(7)
    v_mfma_f32_16x16x32_bf16 v[196:199], v[90:93], v[168:171], v[196:199]
    ds_read_b128 a[240:243], v240 offset:6400
    ds_read_b128 a[244:247], v241 offset:6400
    s_waitcnt lgkmcnt(8)
    v_mfma_f32_16x16x32_bf16 v[200:203], v[114:117], v[168:171], v[200:203]
    ds_read_b128 a[216:219], v240 offset:36864
    s_waitcnt lgkmcnt(8)
    v_mfma_f32_16x16x16_bf16 v[196:199], v[94:95], v[172:173], v[196:199]
    ds_read_b128 a[220:223], v241 offset:36864
    s_waitcnt lgkmcnt(8)
    v_mfma_f32_16x16x32_bf16 v[204:207], v[138:141], v[168:171], v[204:207]
    v_mfma_f32_16x16x16_bf16 v[200:203], v[118:119], v[172:173], v[200:203]
    v_mfma_f32_16x16x32_bf16 v[208:211], v[96:99], v[168:171], v[208:211]
    buffer_load_dwordx4 v254, s[4:7], s43 offen lds
    s_add_u32 m0, s46, 0x17400
    s_waitcnt lgkmcnt(7)
    v_mfma_f32_16x16x32_bf16 v[228:231], a[224:227], a[72:75], 0
    s_waitcnt lgkmcnt(6)
    v_accvgpr_read_b32 v254, a253
    v_max_f32 v248, v196, v197
    v_mfma_f32_16x16x16_bf16 v[204:207], v[142:143], v[172:173], v[204:207]
    v_max3_f32 v248, v248, v198, v199
    v_max3_f32 v248, v248, v200, v201
    v_mfma_f32_16x16x16_bf16 v[208:211], v[100:101], v[172:173], v[208:211]
    ds_read_b128 v[196:199], v245 offset:256
    v_max3_f32 v248, v248, v202, v203
    v_mfma_f32_16x16x32_bf16 v[228:231], a[228:231], a[76:79], v[228:231]
    ds_read_b128 v[200:203], v246 offset:256
    s_waitcnt lgkmcnt(3)
    v_max3_f32 v248, v248, v204, v205
    v_mfma_f32_16x16x32_bf16 v[228:231], a[232:235], a[80:83], v[228:231]
    v_max3_f32 v248, v248, v206, v207
    v_max3_f32 v248, v248, v208, v209
    v_mfma_f32_16x16x32_bf16 v[228:231], a[236:239], a[84:87], v[228:231]
    ds_read_b128 v[204:207], v244 offset:320
    v_max3_f32 v248, v248, v210, v211
    v_mfma_f32_16x16x32_bf16 v[228:231], a[240:243], a[88:91], v[228:231]
    ds_read_b128 v[208:211], v245 offset:320
    v_mfma_f32_16x16x32_bf16 v[228:231], a[244:247], a[92:95], v[228:231]
    buffer_load_dwordx4 v255, s[4:7], s54 offen lds
    s_add_u32 m0, s46, 0x17800
    v_accvgpr_read_b32 v255, a254
    v_mfma_f32_16x16x32_bf16 v[232:235], a[224:227], a[96:99], 0
    s_mov_b32 s54, 0x1000
    v_mfma_f32_16x16x32_bf16 v[232:235], a[228:231], a[100:103], v[232:235]
    v_mfma_f32_16x16x32_bf16 v[232:235], a[232:235], a[104:107], v[232:235]
    v_mfma_f32_16x16x32_bf16 v[232:235], a[236:239], a[108:111], v[232:235]
    s_waitcnt lgkmcnt(3)
    v_cvt_pk_bf16_f32 v24, v228, v229
    v_cvt_pk_bf16_f32 v27, v230, v231
    v_mfma_f32_16x16x32_bf16 v[196:199], v[120:123], v[168:171], v[196:199]
    s_waitcnt lgkmcnt(2)
    buffer_load_dwordx4 v254, s[4:7], s55 offen lds
    v_mfma_f32_16x16x32_bf16 v[200:203], v[144:147], v[168:171], v[200:203]
    s_add_u32 m0, s46, 0x17c00
    v_accvgpr_read_b32 v254, a252
    s_mov_b32 s55, 0x1000
    v_mfma_f32_16x16x16_bf16 v[196:199], v[124:125], v[172:173], v[196:199]
    s_waitcnt lgkmcnt(1)
    s_waitcnt lgkmcnt(0)
    v_mfma_f32_16x16x16_bf16 v[200:203], v[148:149], v[172:173], v[200:203]
    v_mfma_f32_16x16x32_bf16 v[204:207], v[102:105], v[168:171], v[204:207]
    v_mfma_f32_16x16x32_bf16 v[208:211], v[126:129], v[168:171], v[208:211]
    v_mfma_f32_16x16x32_bf16 v[232:235], a[240:243], a[112:115], v[232:235]
    v_mfma_f32_16x16x32_bf16 v[232:235], a[244:247], a[116:119], v[232:235]
    v_mfma_f32_16x16x32_bf16 v[236:239], a[224:227], a[120:123], 0
    buffer_load_dwordx4 v255, s[4:7], s56 offen lds
    s_add_u32 m0, s46, 0x18000
    v_accvgpr_read_b32 v255, a255
    v_mfma_f32_16x16x16_bf16 v[204:207], v[106:107], v[172:173], v[204:207]
    ds_read_b128 a[224:227], v240 offset:36992
    s_mov_b32 s56, 0x2000
    v_max3_f32 v248, v248, v196, v197
    v_mfma_f32_16x16x16_bf16 v[208:211], v[130:131], v[172:173], v[208:211]
    v_max3_f32 v248, v248, v198, v199
    v_max3_f32 v248, v248, v200, v201
    v_mfma_f32_16x16x32_bf16 v[236:239], a[228:231], a[124:127], v[236:239]
    ds_read_b128 v[196:199], v246 offset:320
    v_max3_f32 v248, v248, v202, v203
    v_mfma_f32_16x16x32_bf16 v[236:239], a[232:235], a[128:131], v[236:239]
    ds_read_b128 v[200:203], v244 offset:192
    v_max3_f32 v248, v248, v204, v205
    v_mfma_f32_16x16x32_bf16 v[236:239], a[236:239], a[132:135], v[236:239]
    ds_read_b128 v[204:207], v245 offset:192
    v_max3_f32 v248, v248, v208, v209
    v_mfma_f32_16x16x32_bf16 v[236:239], a[240:243], a[136:139], v[236:239]
    ds_read_b128 v[208:211], v246 offset:192
    v_mfma_f32_16x16x32_bf16 v[236:239], a[244:247], a[140:143], v[236:239]
    buffer_load_dwordx4 v254, s[4:7], s57 offen lds
    s_add_u32 m0, s46, 0x18200
    v_mbcnt_lo_u32_b32 v254, -1, 0
    v_mfma_f32_16x16x32_bf16 v[228:231], a[0:3], a[216:219], 0
    ds_read_b128 a[228:231], v241 offset:36992
    s_mov_b32 s57, 0x2000
    v_mbcnt_hi_u32_b32 v254, -1, v254
    v_mfma_f32_16x16x32_bf16 v[228:231], a[4:7], a[220:223], v[228:231]
    ds_read_b128 a[232:235], v240 offset:37120
    s_waitcnt lgkmcnt(6)
    v_add_u32 v240, 0xf000, v240
    v_mfma_f32_16x16x32_bf16 v[228:231], a[8:11], a[224:227], v[228:231]
    ds_read_b128 a[236:239], v241 offset:37120
    ds_read_b128 a[240:243], v242 offset:3072
    ds_read_b128 a[244:247], v243 offset:3072
    v_add_u32 v241, 0xf000, v241
    v_bfe_u32 v254, v254, 1, 1
    s_waitcnt lgkmcnt(8)
    v_mfma_f32_16x16x32_bf16 v[196:199], v[150:153], v[168:171], v[196:199]
    s_waitcnt lgkmcnt(7)
    v_mfma_f32_16x16x32_bf16 v[200:203], v[90:93], v[168:171], v[200:203]
    s_waitcnt lgkmcnt(6)
    buffer_load_dwordx4 v255, s[4:7], s58 offen lds
    v_mfma_f32_16x16x32_bf16 v[204:207], v[114:117], v[168:171], v[204:207]
    s_waitcnt lgkmcnt(5)
    v_lshlrev_b32 v255, 4, v254
    v_xor_b32 v255, v255, v242
    v_mfma_f32_16x16x16_bf16 v[196:199], v[154:155], v[172:173], v[196:199]
    s_add_u32 m0, s46, 0
    v_mul_u32_u24 v254, 0x7500, v254
    v_add_u32 v254, v254, v255
    v_mfma_f32_16x16x16_bf16 v[200:203], v[94:95], v[172:173], v[200:203]
    s_mov_b32 s58, 0x2000
    v_xor_b32 v255, 64, v254
    s_waitcnt lgkmcnt(4)
    v_mfma_f32_16x16x16_bf16 v[204:207], v[118:119], v[172:173], v[204:207]
    v_max3_f32 v248, v248, v196, v197
    v_mov_b32 v252, v248
    v_mfma_f32_16x16x32_bf16 v[208:211], v[138:141], v[168:171], v[208:211]
    ds_read_b128 v[196:199], v244 offset:256
    v_permlane16_swap_b32 v248, v252
    v_mfma_f32_16x16x32_bf16 v[228:231], a[12:15], a[228:231], v[228:231]
    s_waitcnt lgkmcnt(1)
    v_max_f32 v248, v248, v252
    v_mov_b32 v252, v248
    v_mfma_f32_16x16x16_bf16 v[208:211], v[142:143], v[172:173], v[208:211]
    buffer_store_dwordx4 v[54:57], v89, s[24:27], s52 offen
    v_mfma_f32_16x16x32_bf16 v[228:231], a[16:19], a[232:235], v[228:231]
    s_mov_b32 s52, 0x1000
    v_cvt_pk_bf16_f32 v54, v232, v233
    v_cvt_pk_bf16_f32 v57, v234, v235
    v_mfma_f32_16x16x32_bf16 v[228:231], a[20:23], a[236:239], v[228:231]
    v_permlane32_swap_b32 v248, v252
    v_max_f32 v248, v248, v252
    v_mfma_f32_16x16x32_bf16 v[232:235], a[24:27], a[216:219], 0
    v_sub_f32 v200, v200, v248
    v_sub_f32 v201, v201, v248
    v_mfma_f32_16x16x32_bf16 v[232:235], a[28:31], a[220:223], v[232:235]
    v_exp_f32 v200, v200
    v_mfma_f32_16x16x32_bf16 v[232:235], a[32:35], a[224:227], v[232:235]
    v_cvt_pk_bf16_f32 v90, v228, v229
    v_cvt_pk_bf16_f32 v91, v230, v231
    v_mfma_f32_16x16x32_bf16 v[232:235], a[36:39], a[228:231], v[232:235]
    s_waitcnt lgkmcnt(0)
    v_exp_f32 v201, v201
    v_mfma_f32_16x16x32_bf16 v[196:199], v[96:99], v[168:171], v[196:199]
    buffer_store_dwordx4 v[84:87], v89, s[24:27], s53 offen
    v_mfma_f32_16x16x32_bf16 v[232:235], a[40:43], a[232:235], v[232:235]
    s_mov_b32 s53, 0x1000
    v_cvt_pk_bf16_f32 v84, v236, v237
    v_cvt_pk_bf16_f32 v87, v238, v239
    v_mfma_f32_16x16x32_bf16 v[232:235], a[44:47], a[236:239], v[232:235]
    v_sub_f32 v202, v202, v248
    v_sub_f32 v203, v203, v248
    v_mfma_f32_16x16x16_bf16 v[196:199], v[100:101], v[172:173], v[196:199]
    v_exp_f32 v202, v202
    v_mfma_f32_16x16x32_bf16 v[236:239], a[48:51], a[216:219], 0
    v_exp_f32 v203, v203
    v_mfma_f32_16x16x32_bf16 v[236:239], a[52:55], a[220:223], v[236:239]
    v_cvt_pk_bf16_f32 v180, v200, v201
    v_cvt_pk_bf16_f32 v92, v232, v233
    v_mfma_f32_16x16x32_bf16 v[236:239], a[56:59], a[224:227], v[236:239]
    v_cvt_pk_bf16_f32 v93, v234, v235
    v_cvt_pk_bf16_f32 v183, v202, v203
    v_mfma_f32_16x16x32_bf16 v[236:239], a[60:63], a[228:231], v[236:239]
    ds_read_b128 v[200:203], v245 offset:256
    v_sub_f32 v204, v204, v248
    v_mfma_f32_16x16x32_bf16 v[236:239], a[64:67], a[232:235], v[236:239]
    v_exp_f32 v204, v204
    v_mfma_f32_16x16x32_bf16 v[236:239], a[68:71], a[236:239], v[236:239]
    v_sub_f32 v205, v205, v248
    v_sub_f32 v206, v206, v248
    v_mfma_f32_16x16x32_bf16 v[228:231], a[216:219], a[72:75], 0
    v_exp_f32 v205, v205
    v_mfma_f32_16x16x32_bf16 v[228:231], a[220:223], a[76:79], v[228:231]
    v_exp_f32 v206, v206
    v_mfma_f32_16x16x32_bf16 v[228:231], a[224:227], a[80:83], v[228:231]
    v_sub_f32 v207, v207, v248
    v_cvt_pk_bf16_f32 v94, v236, v237
    v_mfma_f32_16x16x32_bf16 v[228:231], a[228:231], a[84:87], v[228:231]
    v_cvt_pk_bf16_f32 v95, v238, v239
    v_cvt_pk_bf16_f32 v181, v204, v205
    v_mfma_f32_16x16x32_bf16 v[228:231], a[232:235], a[88:91], v[228:231]
    v_exp_f32 v207, v207
    v_mfma_f32_16x16x32_bf16 v[228:231], a[236:239], a[92:95], v[228:231]
    v_cvt_pk_bf16_f32 v184, v206, v207
    v_sub_f32 v208, v208, v248
    v_mfma_f32_16x16x32_bf16 v[232:235], a[216:219], a[96:99], 0
    ds_read_b128 v[204:207], v246 offset:256
    s_waitcnt lgkmcnt(1)
    v_sub_f32 v209, v209, v248
    v_mfma_f32_16x16x32_bf16 v[200:203], v[120:123], v[168:171], v[200:203]
    v_exp_f32 v208, v208
    v_mfma_f32_16x16x32_bf16 v[232:235], a[220:223], a[100:103], v[232:235]
    v_cvt_pk_bf16_f32 v25, v228, v229
    v_cvt_pk_bf16_f32 v28, v230, v231
    v_mfma_f32_16x16x32_bf16 v[232:235], a[224:227], a[104:107], v[232:235]
    v_exp_f32 v209, v209
    v_mfma_f32_16x16x16_bf16 v[200:203], v[124:125], v[172:173], v[200:203]
    v_sub_f32 v210, v210, v248
    v_sub_f32 v211, v211, v248
    v_mfma_f32_16x16x32_bf16 v[232:235], a[228:231], a[108:111], v[232:235]
    v_exp_f32 v210, v210
    v_mfma_f32_16x16x32_bf16 v[232:235], a[232:235], a[112:115], v[232:235]
    v_exp_f32 v211, v211
    v_mfma_f32_16x16x32_bf16 v[232:235], a[236:239], a[116:119], v[232:235]
    v_cvt_pk_bf16_f32 v182, v208, v209
    v_cvt_pk_bf16_f32 v185, v210, v211
    v_mfma_f32_16x16x32_bf16 v[236:239], a[216:219], a[120:123], 0
    ds_read_b128 v[208:211], v244 offset:320
    s_waitcnt lgkmcnt(1)
    v_sub_f32 v196, v196, v248
    v_mfma_f32_16x16x32_bf16 v[212:215], v[0:3], v[180:183], 0
    ds_read_b128 a[216:219], v242 offset:3200
    v_cvt_pk_bf16_f32 v55, v232, v233
    v_mfma_f32_16x16x32_bf16 v[216:219], v[30:33], v[180:183], 0
    v_cvt_pk_bf16_f32 v58, v234, v235
    v_sub_f32 v197, v197, v248
    v_mfma_f32_16x16x32_bf16 v[220:223], v[60:63], v[180:183], 0
    v_exp_f32 v196, v196
    v_mfma_f32_16x16x32_bf16 v[224:227], a[248:251], v[180:183], 0
    v_exp_f32 v197, v197
    v_mfma_f32_16x16x32_bf16 v[204:207], v[144:147], v[168:171], v[204:207]
    v_sub_f32 v198, v198, v248
    v_sub_f32 v199, v199, v248
    v_mfma_f32_16x16x32_bf16 v[236:239], a[220:223], a[124:127], v[236:239]
    ds_read_b128 a[220:223], v243 offset:3200
    v_cvt_pk_bf16_f32 v186, v196, v197
    v_mfma_f32_16x16x32_bf16 v[236:239], a[224:227], a[128:131], v[236:239]
    ds_read_b128 a[224:227], v242 offset:3328
    v_sub_f32 v200, v200, v248
    v_mfma_f32_16x16x16_bf16 v[204:207], v[148:149], v[172:173], v[204:207]
    v_exp_f32 v198, v198
    v_mfma_f32_16x16x32_bf16 v[236:239], a[228:231], a[132:135], v[236:239]
    ds_read_b128 a[228:231], v243 offset:3328
    s_waitcnt lgkmcnt(3)
    v_sub_f32 v201, v201, v248
    v_mfma_f32_16x16x32_bf16 v[208:211], v[102:105], v[168:171], v[208:211]
    v_exp_f32 v199, v199
    v_mfma_f32_16x16x32_bf16 v[236:239], a[232:235], a[136:139], v[236:239]
    ds_read_b128 a[232:235], v240 offset:6144
    v_cvt_pk_bf16_f32 v189, v198, v199
    v_mfma_f32_16x16x32_bf16 v[236:239], a[236:239], a[140:143], v[236:239]
    ds_read_b128 v[196:199], v245 offset:320
    v_sub_f32 v202, v202, v248
    v_mfma_f32_16x16x16_bf16 v[208:211], v[106:107], v[172:173], v[208:211]
    ds_read_b128 a[236:239], v241 offset:6144
    v_sub_f32 v203, v203, v248
    v_mfma_f32_16x16x32_bf16 v[228:231], a[144:147], a[240:243], 0
    v_exp_f32 v200, v200
    v_mfma_f32_16x16x32_bf16 v[228:231], a[148:151], a[244:247], v[228:231]
    v_cvt_pk_bf16_f32 v85, v236, v237
    v_cvt_pk_bf16_f32 v88, v238, v239
    v_mfma_f32_16x16x32_bf16 v[228:231], a[152:155], a[216:219], v[228:231]
    s_waitcnt lgkmcnt(4)
    v_exp_f32 v201, v201
    v_mfma_f32_16x16x32_bf16 v[228:231], a[156:159], a[220:223], v[228:231]
    v_exp_f32 v202, v202
    v_mfma_f32_16x16x32_bf16 v[228:231], a[160:163], a[224:227], v[228:231]
    s_waitcnt lgkmcnt(3)
    v_exp_f32 v203, v203
    v_mfma_f32_16x16x32_bf16 v[228:231], a[164:167], a[228:231], v[228:231]
    v_cvt_pk_bf16_f32 v187, v200, v201
    v_cvt_pk_bf16_f32 v190, v202, v203
    v_mfma_f32_16x16x32_bf16 v[232:235], a[168:171], a[240:243], 0
    ds_read_b128 v[200:203], v246 offset:320
    s_waitcnt lgkmcnt(2)
    v_sub_f32 v204, v204, v248
    v_mfma_f32_16x16x32_bf16 v[212:215], v[4:7], v[184:187], v[212:215]
    v_exp_f32 v204, v204
    v_mfma_f32_16x16x32_bf16 v[216:219], v[34:37], v[184:187], v[216:219]
    v_mul_f32 v228, s38, v228
    v_mul_f32 v229, s38, v229
    v_mfma_f32_16x16x32_bf16 v[220:223], v[64:67], v[184:187], v[220:223]
    v_mul_f32 v230, s38, v230
    v_mul_f32 v231, s38, v231
    v_mfma_f32_16x16x32_bf16 v[224:227], a[248:251], v[184:187], v[224:227]
    v_sub_f32 v205, v205, v248
    v_sub_f32 v206, v206, v248
    v_mfma_f32_16x16x32_bf16 v[196:199], v[126:129], v[168:171], v[196:199]
    v_exp_f32 v205, v205
    v_mfma_f32_16x16x32_bf16 v[232:235], a[172:175], a[244:247], v[232:235]
    v_exp_f32 v206, v206
    v_mfma_f32_16x16x32_bf16 v[232:235], a[176:179], a[216:219], v[232:235]
    v_sub_f32 v207, v207, v248
    v_cvt_pk_bf16_f32 v188, v204, v205
    v_mfma_f32_16x16x16_bf16 v[196:199], v[130:131], v[172:173], v[196:199]
    v_exp_f32 v207, v207
    v_mfma_f32_16x16x32_bf16 v[232:235], a[180:183], a[220:223], v[232:235]
    s_waitcnt lgkmcnt(0)
    v_cvt_pk_bf16_f32 v191, v206, v207
    v_sub_f32 v208, v208, v248
    v_mfma_f32_16x16x32_bf16 v[200:203], v[150:153], v[168:171], v[200:203]
    ds_read_b128 v[204:207], v244 offset:0
    v_cvt_pk_bf16_f32 v168, v228, v229
    v_mfma_f32_16x16x32_bf16 v[212:215], v[8:11], v[188:191], v[212:215]
    v_cvt_pk_bf16_f32 v169, v230, v231
    v_sub_f32 v209, v209, v248
    v_mfma_f32_16x16x32_bf16 v[216:219], v[38:41], v[188:191], v[216:219]
    v_exp_f32 v208, v208
    v_mfma_f32_16x16x32_bf16 v[220:223], v[68:71], v[188:191], v[220:223]
    v_exp_f32 v209, v209
    v_mfma_f32_16x16x32_bf16 v[224:227], a[248:251], v[188:191], v[224:227]
    v_cvt_pk_bf16_f32 v192, v208, v209
    v_sub_f32 v196, v196, v248
    v_mfma_f32_16x16x16_bf16 v[200:203], v[154:155], v[172:173], v[200:203]
    ds_read_b128 v[208:211], v245 offset:0
    v_sub_f32 v197, v197, v248
    v_mfma_f32_16x16x32_bf16 v[232:235], a[184:187], a[224:227], v[232:235]
    v_exp_f32 v196, v196
    v_mfma_f32_16x16x32_bf16 v[232:235], a[188:191], a[228:231], v[232:235]
    v_exp_f32 v197, v197
    v_mfma_f32_16x16x32_bf16 v[236:239], a[192:195], a[240:243], 0
    ds_read_b128 a[240:243], v240 offset:6272
    s_waitcnt lgkmcnt(2)
    v_cvt_pk_bf16_f32 v193, v196, v197
    v_mfma_f32_16x16x32_bf16 v[204:207], v[96:99], v[174:177], v[204:207]
    ds_read_b128 v[196:199], v246 offset:0
    v_sub_f32 v200, v200, v248
    v_mfma_f32_16x16x32_bf16 v[236:239], a[196:199], a[244:247], v[236:239]
    ds_read_b128 a[244:247], v241 offset:6272
    v_mul_f32 v232, s38, v232
    v_mfma_f32_16x16x32_bf16 v[236:239], a[200:203], a[216:219], v[236:239]
    ds_read_b128 a[216:219], v240 offset:6400
    v_mul_f32 v233, s38, v233
    v_mfma_f32_16x16x16_bf16 v[204:207], v[100:101], v[178:179], v[204:207]
    v_mul_f32 v234, s38, v234
    v_mul_f32 v235, s38, v235
    v_mfma_f32_16x16x32_bf16 v[236:239], a[204:207], a[220:223], v[236:239]
    ds_read_b128 a[220:223], v241 offset:6400
    s_waitcnt lgkmcnt(5)
    v_cvt_pk_bf16_f32 v170, v232, v233
    v_mfma_f32_16x16x32_bf16 v[208:211], v[120:123], v[174:177], v[208:211]
    v_cvt_pk_bf16_f32 v171, v234, v235
    v_sub_f32 v201, v201, v248
    v_mfma_f32_16x16x32_bf16 v[236:239], a[208:211], a[224:227], v[236:239]
    ds_read_b128 a[224:227], v254 offset:4608
    v_max_f32 v248, v204, v205
    v_mfma_f32_16x16x32_bf16 v[236:239], a[212:215], a[228:231], v[236:239]
    ds_read_b128 a[228:231], v255 offset:4608
    v_max3_f32 v248, v248, v206, v207
    v_mfma_f32_16x16x16_bf16 v[208:211], v[124:125], v[178:179], v[208:211]
    ds_read_b128 v[204:207], v245 offset:64
    s_waitcnt lgkmcnt(6)
    v_mfma_f32_16x16x32_bf16 v[196:199], v[144:147], v[174:177], v[196:199]
    v_exp_f32 v200, v200
    v_mfma_f32_16x16x32_bf16 v[228:231], a[0:3], a[232:235], 0
    v_mul_f32 v236, s38, v236
    v_mul_f32 v237, s38, v237
    v_mfma_f32_16x16x32_bf16 v[228:231], a[4:7], a[236:239], v[228:231]
    v_mul_f32 v238, s38, v238
    v_mul_f32 v239, s38, v239
    v_mfma_f32_16x16x16_bf16 v[196:199], v[148:149], v[178:179], v[196:199]
    v_cvt_pk_bf16_f32 v172, v236, v237
    v_cvt_pk_bf16_f32 v173, v238, v239
    v_mfma_f32_16x16x32_bf16 v[228:231], a[8:11], a[240:243], v[228:231]
    s_waitcnt lgkmcnt(3)
    v_exp_f32 v201, v201
    v_mfma_f32_16x16x32_bf16 v[228:231], a[12:15], a[244:247], v[228:231]
    v_cvt_pk_bf16_f32 v194, v200, v201
    v_max3_f32 v248, v248, v208, v209
    v_mfma_f32_16x16x32_bf16 v[228:231], a[16:19], a[216:219], v[228:231]
    ds_read_b128 v[200:203], v244 offset:64
    v_max3_f32 v248, v248, v210, v211
    v_mfma_f32_16x16x32_bf16 v[212:215], v[12:15], v[192:195], v[212:215]
    ds_read_b128 v[208:211], v246 offset:64
    s_waitcnt lgkmcnt(2)
    v_max3_f32 v248, v248, v196, v197
    v_mfma_f32_16x16x32_bf16 v[216:219], v[42:45], v[192:195], v[216:219]
    v_max3_f32 v248, v248, v198, v199
    v_mfma_f32_16x16x32_bf16 v[220:223], v[72:75], v[192:195], v[220:223]
    ds_read_b128 v[196:199], v244 offset:128
    v_mfma_f32_16x16x32_bf16 v[224:227], a[248:251], v[192:195], v[224:227]
    v_mfma_f32_16x16x32_bf16 v[204:207], v[126:129], v[174:177], v[204:207]
    v_mfma_f32_16x16x32_bf16 v[228:231], a[20:23], a[220:223], v[228:231]
    v_mfma_f32_16x16x32_bf16 v[232:235], a[24:27], a[232:235], 0
    v_mfma_f32_16x16x32_bf16 v[232:235], a[28:31], a[236:239], v[232:235]
    v_mfma_f32_16x16x32_bf16 v[232:235], a[32:35], a[240:243], v[232:235]
    s_waitcnt lgkmcnt(2)
    s_waitcnt lgkmcnt(1)
    v_mfma_f32_16x16x32_bf16 v[200:203], v[102:105], v[174:177], v[200:203]
    v_rcp_f32 v252, v224
    v_mfma_f32_16x16x16_bf16 v[204:207], v[130:131], v[178:179], v[204:207]
    v_mul_f32 v212, v212, v252
    v_mul_f32 v213, v213, v252
    v_mfma_f32_16x16x32_bf16 v[208:211], v[150:153], v[174:177], v[208:211]
    s_waitcnt lgkmcnt(0)
    v_mul_f32 v214, v214, v252
    v_mul_f32 v215, v215, v252
    v_mfma_f32_16x16x16_bf16 v[200:203], v[106:107], v[178:179], v[200:203]
    v_cvt_pk_bf16_f32 v212, v212, v213
    v_cvt_pk_bf16_f32 v213, v214, v215
    v_mfma_f32_16x16x16_bf16 v[208:211], v[154:155], v[178:179], v[208:211]
    ds_write_b64 v251, v[212:213] offset:0
    v_mfma_f32_16x16x32_bf16 v[196:199], v[108:111], v[174:177], v[196:199]
    v_mul_f32 v216, v216, v252
    v_mul_f32 v217, v217, v252
    v_mfma_f32_16x16x32_bf16 v[232:235], a[36:39], a[244:247], v[232:235]
    v_mul_f32 v218, v218, v252
    v_mul_f32 v219, v219, v252
    v_mfma_f32_16x16x32_bf16 v[232:235], a[40:43], a[216:219], v[232:235]
    v_cvt_pk_bf16_f32 v216, v216, v217
    v_cvt_pk_bf16_f32 v217, v218, v219
    v_mfma_f32_16x16x16_bf16 v[196:199], v[112:113], v[178:179], v[196:199]
    ds_write_b64 v251, v[216:217] offset:32
    v_mfma_f32_16x16x32_bf16 v[232:235], a[44:47], a[220:223], v[232:235]
    v_mul_f32 v220, v220, v252
    v_mul_f32 v221, v221, v252
    v_mfma_f32_16x16x32_bf16 v[236:239], a[48:51], a[232:235], 0
    v_mul_f32 v222, v222, v252
    v_mul_f32 v223, v223, v252
    v_mfma_f32_16x16x32_bf16 v[236:239], a[52:55], a[236:239], v[236:239]
    v_cvt_pk_bf16_f32 v220, v220, v221
    v_cvt_pk_bf16_f32 v221, v222, v223
    v_mfma_f32_16x16x32_bf16 v[236:239], a[56:59], a[240:243], v[236:239]
    ds_write_b64 v251, v[220:221] offset:64
    v_mfma_f32_16x16x32_bf16 v[236:239], a[60:63], a[244:247], v[236:239]
    v_max3_f32 v248, v248, v200, v201
    v_max3_f32 v248, v248, v202, v203
    v_mfma_f32_16x16x32_bf16 v[236:239], a[64:67], a[216:219], v[236:239]
    ds_read_b128 v[200:203], v245 offset:128
    v_max3_f32 v248, v248, v204, v205
    v_mfma_f32_16x16x32_bf16 v[236:239], a[68:71], a[220:223], v[236:239]
    v_max3_f32 v248, v248, v206, v207
    ds_read_b128 v[204:207], v246 offset:128
    v_max3_f32 v248, v248, v208, v209
    v_max3_f32 v248, v248, v210, v211
    ds_read_b128 v[208:211], v244 offset:0
    v_max3_f32 v248, v248, v196, v197
    ds_read_b128 v[196:199], v245 offset:0
    s_waitcnt lgkmcnt(3)
    v_mfma_f32_16x16x32_bf16 v[200:203], v[132:135], v[174:177], v[200:203]
    s_nop 5
    v_mfma_f32_16x16x16_bf16 v[200:203], v[136:137], v[178:179], v[200:203]
    s_waitcnt lgkmcnt(2)
    v_mfma_f32_16x16x32_bf16 v[204:207], v[156:159], v[174:177], v[204:207]
    s_waitcnt lgkmcnt(1)
    v_mfma_f32_16x16x32_bf16 v[208:211], v[96:99], v[174:177], v[208:211]
    s_waitcnt lgkmcnt(0)
    v_cvt_pk_bf16_f32 v96, v228, v229
    v_cvt_pk_bf16_f32 v97, v230, v231
    v_mfma_f32_16x16x32_bf16 v[196:199], v[120:123], v[174:177], v[196:199]
    v_cvt_pk_bf16_f32 v98, v232, v233
    v_cvt_pk_bf16_f32 v99, v234, v235
    v_mfma_f32_16x16x16_bf16 v[204:207], v[160:161], v[178:179], v[204:207]
    v_max3_f32 v248, v248, v200, v201
    v_mfma_f32_16x16x16_bf16 v[208:211], v[100:101], v[178:179], v[208:211]
    ds_read_b128 v[200:203], v246 offset:0
    v_cvt_pk_bf16_f32 v100, v236, v237
    v_mfma_f32_16x16x16_bf16 v[196:199], v[124:125], v[178:179], v[196:199]
    v_cvt_pk_bf16_f32 v101, v238, v239
    v_mfma_f32_16x16x32_bf16 v[228:231], a[232:235], a[72:75], 0
    v_mfma_f32_16x16x32_bf16 v[228:231], a[236:239], a[76:79], v[228:231]
    v_max3_f32 v248, v248, v204, v205
    v_mov_b32 v252, v248
    v_mfma_f32_16x16x32_bf16 v[228:231], a[240:243], a[80:83], v[228:231]
    ds_read_b128 v[204:207], v244 offset:64
    v_permlane16_swap_b32 v248, v252
    v_mfma_f32_16x16x32_bf16 v[228:231], a[244:247], a[84:87], v[228:231]
    v_max_f32 v248, v248, v252
    v_mov_b32 v252, v248
    v_mfma_f32_16x16x32_bf16 v[228:231], a[216:219], a[88:91], v[228:231]
    v_mfma_f32_16x16x32_bf16 v[228:231], a[220:223], a[92:95], v[228:231]
    v_permlane32_swap_b32 v248, v252
    v_max_f32 v248, v248, v252
    v_mfma_f32_16x16x32_bf16 v[232:235], a[232:235], a[96:99], 0
    v_sub_f32 v208, v208, v248
    v_sub_f32 v209, v209, v248
    v_mfma_f32_16x16x32_bf16 v[232:235], a[236:239], a[100:103], v[232:235]
    s_waitcnt lgkmcnt(1)
    v_exp_f32 v208, v208
    v_mfma_f32_16x16x32_bf16 v[200:203], v[144:147], v[174:177], v[200:203]
    v_cvt_pk_bf16_f32 v26, v228, v229
    v_cvt_pk_bf16_f32 v29, v230, v231
    v_mfma_f32_16x16x32_bf16 v[232:235], a[240:243], a[104:107], v[232:235]
    v_exp_f32 v209, v209
    v_mfma_f32_16x16x32_bf16 v[232:235], a[244:247], a[108:111], v[232:235]
    v_sub_f32 v210, v210, v248
    v_sub_f32 v211, v211, v248
    v_mfma_f32_16x16x16_bf16 v[200:203], v[148:149], v[178:179], v[200:203]
    s_waitcnt lgkmcnt(0)
    v_exp_f32 v210, v210
    v_mfma_f32_16x16x32_bf16 v[204:207], v[102:105], v[174:177], v[204:207]
    v_exp_f32 v211, v211
    v_mfma_f32_16x16x32_bf16 v[232:235], a[216:219], a[112:115], v[232:235]
    v_cvt_pk_bf16_f32 v180, v208, v209
    v_cvt_pk_bf16_f32 v183, v210, v211
    v_mfma_f32_16x16x32_bf16 v[232:235], a[220:223], a[116:119], v[232:235]
    ds_read_b128 v[208:211], v245 offset:64
    v_sub_f32 v196, v196, v248
    v_mfma_f32_16x16x16_bf16 v[204:207], v[106:107], v[178:179], v[204:207]
    v_exp_f32 v196, v196
    v_mfma_f32_16x16x32_bf16 v[236:239], a[232:235], a[120:123], 0
    ds_read_b128 a[232:235], v254 offset:4736
    v_sub_f32 v197, v197, v248
    v_mfma_f32_16x16x32_bf16 v[236:239], a[236:239], a[124:127], v[236:239]
    ds_read_b128 a[236:239], v255 offset:4736
    v_cvt_pk_bf16_f32 v56, v232, v233
    v_mfma_f32_16x16x32_bf16 v[236:239], a[240:243], a[128:131], v[236:239]
    ds_read_b128 a[240:243], v254 offset:4864
    v_cvt_pk_bf16_f32 v59, v234, v235
    v_mfma_f32_16x16x32_bf16 v[236:239], a[244:247], a[132:135], v[236:239]
    ds_read_b128 a[244:247], v255 offset:4864
    v_accvgpr_read_b32 v254, a252
    v_mfma_f32_16x16x32_bf16 v[236:239], a[216:219], a[136:139], v[236:239]
    v_accvgpr_read_b32 v255, a253
    v_sub_f32 v198, v198, v248
    v_mfma_f32_16x16x32_bf16 v[236:239], a[220:223], a[140:143], v[236:239]
    v_exp_f32 v197, v197
    v_mfma_f32_16x16x32_bf16 v[228:231], a[144:147], a[224:227], 0
    v_exp_f32 v198, v198
    v_mfma_f32_16x16x32_bf16 v[228:231], a[148:151], a[228:231], v[228:231]
    s_waitcnt lgkmcnt(4)
    v_sub_f32 v199, v199, v248
    v_cvt_pk_bf16_f32 v181, v196, v197
    v_mfma_f32_16x16x32_bf16 v[208:211], v[126:129], v[174:177], v[208:211]
    v_cvt_pk_bf16_f32 v86, v236, v237
    v_cvt_pk_bf16_f32 v89, v238, v239
    v_mfma_f32_16x16x32_bf16 v[232:235], a[168:171], a[224:227], 0
    s_waitcnt lgkmcnt(3)
    v_exp_f32 v199, v199
    v_mfma_f32_16x16x32_bf16 v[228:231], a[152:155], a[232:235], v[228:231]
    s_waitcnt lgkmcnt(2)
    v_cvt_pk_bf16_f32 v184, v198, v199
    v_sub_f32 v200, v200, v248
    v_mfma_f32_16x16x16_bf16 v[208:211], v[130:131], v[178:179], v[208:211]
    ds_read_b128 v[196:199], v246 offset:64
    s_waitcnt vmcnt(0) lgkmcnt(1)
    v_sub_f32 v201, v201, v248
    v_mfma_f32_16x16x32_bf16 v[228:231], a[156:159], a[236:239], v[228:231]
    s_barrier
    v_exp_f32 v200, v200
    v_mfma_f32_16x16x32_bf16 v[228:231], a[160:163], a[240:243], v[228:231]
    buffer_load_dwordx4 v254, s[4:7], s44 offen lds
    s_add_u32 m0, s46, 0x400
    v_accvgpr_read_b32 v254, a254
    v_mfma_f32_16x16x32_bf16 v[228:231], a[164:167], a[244:247], v[228:231]
    buffer_load_dwordx4 v255, s[4:7], s44 offen lds
    s_add_u32 m0, s46, 0x800
    v_accvgpr_read_b32 v255, a252
    v_mfma_f32_16x16x32_bf16 v[232:235], a[172:175], a[228:231], v[232:235]
    buffer_load_dwordx4 v254, s[4:7], s44 offen lds
    s_add_u32 m0, s46, 0xc00
    v_accvgpr_read_b32 v254, a253
    v_mfma_f32_16x16x32_bf16 v[232:235], a[176:179], a[232:235], v[232:235]
    buffer_load_dwordx4 v255, s[4:7], s59 offen lds
    s_add_u32 m0, s46, 0x1000
    v_mul_f32 v228, s38, v228
    v_mfma_f32_16x16x32_bf16 v[232:235], a[180:183], a[236:239], v[232:235]
    buffer_load_dwordx4 v254, s[4:7], s60 offen lds
    s_add_u32 m0, s46, 0x1400
    v_mul_f32 v229, s38, v229
    v_mfma_f32_16x16x32_bf16 v[232:235], a[184:187], a[240:243], v[232:235]
    ds_read_b128 a[216:219], v240 offset:30720
    s_mov_b32 s59, 0x2000
    v_mul_f32 v230, s38, v230
    v_mfma_f32_16x16x32_bf16 v[232:235], a[188:191], a[244:247], v[232:235]
    ds_read_b128 a[220:223], v241 offset:30720
    s_mov_b32 s60, 0x3000
    v_mul_f32 v231, s38, v231
    v_mfma_f32_16x16x32_bf16 v[236:239], a[192:195], a[224:227], 0
    ds_read_b128 a[224:227], v240 offset:30848
    s_waitcnt lgkmcnt(3)
    v_accvgpr_read_b32 v255, a254
    v_mfma_f32_16x16x32_bf16 v[196:199], v[150:153], v[174:177], v[196:199]
    buffer_load_dwordx4 v255, s[4:7], s61 offen lds
    s_add_u32 m0, s46, 0x1800
    v_mul_f32 v232, s38, v232
    v_mfma_f32_16x16x32_bf16 v[236:239], a[196:199], a[228:231], v[236:239]
    ds_read_b128 a[228:231], v241 offset:30848
    s_mov_b32 s61, 0x3000
    v_mul_f32 v233, s38, v233
    v_mfma_f32_16x16x16_bf16 v[196:199], v[154:155], v[178:179], v[196:199]
    v_mul_f32 v234, s38, v234
    v_mul_f32 v235, s38, v235
    v_mfma_f32_16x16x32_bf16 v[236:239], a[200:203], a[232:235], v[236:239]
    ds_read_b128 a[232:235], v240 offset:30976
    v_accvgpr_read_b32 v254, a252
    v_mfma_f32_16x16x32_bf16 v[236:239], a[204:207], a[236:239], v[236:239]
    buffer_load_dwordx4 v254, s[4:7], s62 offen lds
    s_add_u32 m0, s46, 0x1a00
    v_accvgpr_read_b32 v255, a255
    v_mfma_f32_16x16x32_bf16 v[236:239], a[208:211], a[240:243], v[236:239]
    buffer_load_dwordx4 v255, s[4:7], s63 offen lds
    s_mov_b32 s62, 0x3000
    v_mbcnt_lo_u32_b32 v254, -1, 0
    v_mfma_f32_16x16x32_bf16 v[236:239], a[212:215], a[244:247], v[236:239]
    ds_read_b128 a[236:239], v241 offset:30976
    ds_read_b128 a[240:243], v242 offset:30720
    ds_read_b128 a[244:247], v243 offset:30720
    s_mov_b32 s63, 0x3000
    v_mbcnt_hi_u32_b32 v254, -1, v254
    v_lshl_add_u32 v254, v254, 4, s66
    v_mbcnt_lo_u32_b32 v255, -1, 0
    v_mbcnt_hi_u32_b32 v255, -1, v255
    v_mul_f32 v236, s38, v236
    v_mul_f32 v237, s38, v237
    v_mul_f32 v238, s38, v238
    v_mul_f32 v239, s38, v239
    v_and_b32 v249, 15, v255
    v_mul_u32_u24 v249, 0x1a0, v249
    v_lshrrev_b32 v255, 4, v255
    v_lshl_add_u32 v249, v255, 4, v249
    v_add_u32 v249, 0x1e000, v249
    v_exp_f32 v201, v201
    v_sub_f32 v202, v202, v248
    v_exp_f32 v202, v202
    v_sub_f32 v203, v203, v248
    v_exp_f32 v203, v203
    v_cvt_pk_bf16_f32 v182, v200, v201
    v_cvt_pk_bf16_f32 v185, v202, v203
    ds_read_b128 v[200:203], v244 offset:128
    v_mfma_f32_16x16x32_bf16 v[212:215], v[6:9], v[180:183], 0
    v_sub_f32 v204, v204, v248
    v_sub_f32 v205, v205, v248
    v_mfma_f32_16x16x32_bf16 v[216:219], v[36:39], v[180:183], 0
    v_exp_f32 v204, v204
    v_mfma_f32_16x16x32_bf16 v[220:223], v[66:69], v[180:183], 0
    v_exp_f32 v205, v205
    v_mfma_f32_16x16x32_bf16 v[224:227], a[248:251], v[180:183], 0
    v_sub_f32 v206, v206, v248
    v_exp_f32 v206, v206
    v_sub_f32 v207, v207, v248
    v_exp_f32 v207, v207
    v_cvt_pk_bf16_f32 v186, v204, v205
    v_cvt_pk_bf16_f32 v189, v206, v207
    ds_read_b128 v[204:207], v245 offset:128
    v_sub_f32 v208, v208, v248
    v_exp_f32 v208, v208
    v_sub_f32 v209, v209, v248
    v_exp_f32 v209, v209
    v_sub_f32 v210, v210, v248
    v_exp_f32 v210, v210
    v_sub_f32 v211, v211, v248
    v_exp_f32 v211, v211
    v_cvt_pk_bf16_f32 v187, v208, v209
    s_waitcnt lgkmcnt(1)
    v_mfma_f32_16x16x32_bf16 v[200:203], v[108:111], v[174:177], v[200:203]
    v_cvt_pk_bf16_f32 v190, v210, v211
    v_sub_f32 v196, v196, v248
    v_mfma_f32_16x16x32_bf16 v[212:215], v[10:13], v[184:187], v[212:215]
    ds_read_b128 v[208:211], v246 offset:128
    v_sub_f32 v197, v197, v248
    v_mfma_f32_16x16x32_bf16 v[216:219], v[40:43], v[184:187], v[216:219]
    v_exp_f32 v196, v196
    v_mfma_f32_16x16x32_bf16 v[220:223], v[70:73], v[184:187], v[220:223]
    v_exp_f32 v197, v197
    v_mfma_f32_16x16x32_bf16 v[224:227], a[248:251], v[184:187], v[224:227]
    s_waitcnt lgkmcnt(1)
    v_sub_f32 v198, v198, v248
    v_sub_f32 v199, v199, v248
    v_mfma_f32_16x16x16_bf16 v[200:203], v[112:113], v[178:179], v[200:203]
    v_exp_f32 v198, v198
    v_mfma_f32_16x16x32_bf16 v[204:207], v[132:135], v[174:177], v[204:207]
    v_exp_f32 v199, v199
    v_cvt_pk_bf16_f32 v188, v196, v197
    v_cvt_pk_bf16_f32 v191, v198, v199
    ds_read_b128 v[196:199], v244 offset:0
    s_nop 0
    v_mfma_f32_16x16x32_bf16 v[212:215], v[14:17], v[188:191], v[212:215]
    v_sub_f32 v200, v200, v248
    v_sub_f32 v201, v201, v248
    v_mfma_f32_16x16x32_bf16 v[216:219], v[44:47], v[188:191], v[216:219]
    s_waitcnt lgkmcnt(1)
    v_exp_f32 v200, v200
    v_mfma_f32_16x16x32_bf16 v[220:223], v[74:77], v[188:191], v[220:223]
    v_exp_f32 v201, v201
    v_mfma_f32_16x16x32_bf16 v[224:227], a[248:251], v[188:191], v[224:227]
    v_cvt_pk_bf16_f32 v192, v200, v201
    v_mfma_f32_16x16x16_bf16 v[204:207], v[136:137], v[178:179], v[204:207]
    ds_read_b128 v[200:203], v245 offset:0
    v_mfma_f32_16x16x32_bf16 v[208:211], v[156:159], v[174:177], v[208:211]
    v_cvt_pk_bf16_f32 v174, v228, v229
    v_cvt_pk_bf16_f32 v175, v230, v231
    v_mfma_f32_16x16x32_bf16 v[228:231], a[0:3], a[216:219], 0
    ds_write_b64 v247, v[174:175] offset:0
    v_mfma_f32_16x16x32_bf16 v[228:231], a[4:7], a[220:223], v[228:231]
    v_cvt_pk_bf16_f32 v176, v232, v233
    v_cvt_pk_bf16_f32 v177, v234, v235
    v_mfma_f32_16x16x16_bf16 v[208:211], v[160:161], v[178:179], v[208:211]
    ds_write_b64 v247, v[176:177] offset:32
    v_mfma_f32_16x16x32_bf16 v[228:231], a[8:11], a[224:227], v[228:231]
    s_waitcnt lgkmcnt(3)
    v_cvt_pk_bf16_f32 v178, v236, v237
    v_cvt_pk_bf16_f32 v179, v238, v239
    v_mfma_f32_16x16x32_bf16 v[196:199], v[102:105], v[168:171], v[196:199]
    ds_write_b64 v247, v[178:179] offset:64
    v_mfma_f32_16x16x32_bf16 v[228:231], a[12:15], a[228:231], v[228:231]
    v_sub_f32 v204, v204, v248
    v_sub_f32 v205, v205, v248
    v_mfma_f32_16x16x32_bf16 v[228:231], a[16:19], a[232:235], v[228:231]
    s_waitcnt lgkmcnt(3)
    v_exp_f32 v204, v204
    v_mfma_f32_16x16x16_bf16 v[196:199], v[106:107], v[172:173], v[196:199]
    v_exp_f32 v205, v205
    v_mfma_f32_16x16x32_bf16 v[200:203], v[126:129], v[168:171], v[200:203]
    v_cvt_pk_bf16_f32 v193, v204, v205
    v_sub_f32 v208, v208, v248
    v_mfma_f32_16x16x32_bf16 v[228:231], a[20:23], a[236:239], v[228:231]
    ds_read_b128 v[204:207], v246 offset:0
    v_sub_f32 v209, v209, v248
    v_mfma_f32_16x16x32_bf16 v[232:235], a[24:27], a[216:219], 0
    v_exp_f32 v208, v208
    v_mfma_f32_16x16x16_bf16 v[200:203], v[130:131], v[172:173], v[200:203]
    v_exp_f32 v209, v209
    v_mfma_f32_16x16x32_bf16 v[232:235], a[28:31], a[220:223], v[232:235]
    v_cvt_pk_bf16_f32 v194, v208, v209
    v_max_f32 v248, v196, v197
    v_mfma_f32_16x16x32_bf16 v[232:235], a[32:35], a[224:227], v[232:235]
    ds_read_b128 v[208:211], v244 offset:64
    v_max3_f32 v248, v248, v198, v199
    v_mfma_f32_16x16x32_bf16 v[212:215], v[18:21], v[192:195], v[212:215]
    ds_read_b128 v[196:199], v245 offset:64
    v_max3_f32 v248, v248, v200, v201
    v_mfma_f32_16x16x32_bf16 v[216:219], v[48:51], v[192:195], v[216:219]
    v_max3_f32 v248, v248, v202, v203
    v_mfma_f32_16x16x32_bf16 v[220:223], v[78:81], v[192:195], v[220:223]
    ds_read_b128 v[200:203], v246 offset:64
    v_mfma_f32_16x16x32_bf16 v[224:227], a[248:251], v[192:195], v[224:227]
    v_mfma_f32_16x16x32_bf16 v[232:235], a[36:39], a[228:231], v[232:235]
    s_waitcnt lgkmcnt(3)
    v_mfma_f32_16x16x32_bf16 v[204:207], v[150:153], v[168:171], v[204:207]
    v_mfma_f32_16x16x32_bf16 v[232:235], a[40:43], a[232:235], v[232:235]
    v_mfma_f32_16x16x32_bf16 v[232:235], a[44:47], a[236:239], v[232:235]
    v_mfma_f32_16x16x32_bf16 v[236:239], a[48:51], a[216:219], 0
    s_waitcnt lgkmcnt(2)
    s_waitcnt lgkmcnt(1)
    v_mfma_f32_16x16x32_bf16 v[208:211], v[108:111], v[168:171], v[208:211]
    v_rcp_f32 v252, v224
    v_mfma_f32_16x16x16_bf16 v[204:207], v[154:155], v[172:173], v[204:207]
    v_mul_f32 v212, v212, v252
    v_mul_f32 v213, v213, v252
    v_mfma_f32_16x16x32_bf16 v[196:199], v[132:135], v[168:171], v[196:199]
    s_waitcnt lgkmcnt(0)
    v_mul_f32 v214, v214, v252
    v_mul_f32 v215, v215, v252
    v_mfma_f32_16x16x16_bf16 v[208:211], v[112:113], v[172:173], v[208:211]
    v_cvt_pk_bf16_f32 v212, v212, v213
    v_cvt_pk_bf16_f32 v213, v214, v215
    v_mfma_f32_16x16x16_bf16 v[196:199], v[136:137], v[172:173], v[196:199]
    ds_write_b64 v251, v[212:213] offset:6656
    v_mfma_f32_16x16x32_bf16 v[200:203], v[156:159], v[168:171], v[200:203]
    v_mul_f32 v216, v216, v252
    v_mul_f32 v217, v217, v252
    v_mfma_f32_16x16x32_bf16 v[236:239], a[52:55], a[220:223], v[236:239]
    v_mul_f32 v218, v218, v252
    v_mul_f32 v219, v219, v252
    v_mfma_f32_16x16x32_bf16 v[236:239], a[56:59], a[224:227], v[236:239]
    v_cvt_pk_bf16_f32 v216, v216, v217
    v_cvt_pk_bf16_f32 v217, v218, v219
    v_mfma_f32_16x16x16_bf16 v[200:203], v[160:161], v[172:173], v[200:203]
    ds_write_b64 v251, v[216:217] offset:6688
    v_mfma_f32_16x16x32_bf16 v[236:239], a[60:63], a[228:231], v[236:239]
    v_mul_f32 v220, v220, v252
    v_mul_f32 v221, v221, v252
    v_mfma_f32_16x16x32_bf16 v[236:239], a[64:67], a[232:235], v[236:239]
    v_mul_f32 v222, v222, v252
    v_mul_f32 v223, v223, v252
    v_mfma_f32_16x16x32_bf16 v[236:239], a[68:71], a[236:239], v[236:239]
    v_cvt_pk_bf16_f32 v220, v220, v221
    v_cvt_pk_bf16_f32 v221, v222, v223
    ds_write_b64 v251, v[220:221] offset:6720
    v_max3_f32 v248, v248, v204, v205
    v_max3_f32 v248, v248, v206, v207
    ds_read_b128 v[204:207], v244 offset:128
    v_max3_f32 v248, v248, v208, v209
    v_max3_f32 v248, v248, v210, v211
    ds_read_b128 v[208:211], v245 offset:128
    v_max3_f32 v248, v248, v196, v197
    v_max3_f32 v248, v248, v198, v199
    ds_read_b128 v[196:199], v246 offset:128
    v_max3_f32 v248, v248, v200, v201
    v_max3_f32 v248, v248, v202, v203
    ds_read_b128 v[200:203], v244 offset:0
    s_waitcnt lgkmcnt(3)
    v_mfma_f32_16x16x32_bf16 v[204:207], v[162:165], v[168:171], v[204:207]
    s_nop 5
    v_mfma_f32_16x16x16_bf16 v[204:207], v[166:167], v[172:173], v[204:207]
    s_waitcnt lgkmcnt(2)
    s_waitcnt lgkmcnt(1)
    v_mfma_f32_16x16x32_bf16 v[208:211], v[90:93], v[168:171], v[208:211]
    v_mfma_f32_16x16x32_bf16 v[196:199], v[96:99], v[168:171], v[196:199]
    s_waitcnt lgkmcnt(0)
    v_mfma_f32_16x16x32_bf16 v[200:203], v[102:105], v[168:171], v[200:203]
    v_cvt_pk_bf16_f32 v102, v228, v229
    v_cvt_pk_bf16_f32 v103, v230, v231
    v_mfma_f32_16x16x32_bf16 v[228:231], a[216:219], a[72:75], 0
    v_cvt_pk_bf16_f32 v104, v232, v233
    v_cvt_pk_bf16_f32 v105, v234, v235
    v_mfma_f32_16x16x16_bf16 v[208:211], v[94:95], v[172:173], v[208:211]
    v_max3_f32 v248, v248, v204, v205
    v_mfma_f32_16x16x16_bf16 v[196:199], v[100:101], v[172:173], v[196:199]
    ds_read_b128 v[204:207], v245 offset:0
    v_mfma_f32_16x16x16_bf16 v[200:203], v[106:107], v[172:173], v[200:203]
    v_cvt_pk_bf16_f32 v106, v236, v237
    v_cvt_pk_bf16_f32 v107, v238, v239
    v_mfma_f32_16x16x32_bf16 v[228:231], a[220:223], a[76:79], v[228:231]
    v_mfma_f32_16x16x32_bf16 v[228:231], a[224:227], a[80:83], v[228:231]
    v_max3_f32 v248, v248, v208, v209
    v_mfma_f32_16x16x32_bf16 v[228:231], a[228:231], a[84:87], v[228:231]
    ds_read_b128 v[208:211], v246 offset:0
    v_max3_f32 v248, v248, v196, v197
    v_mfma_f32_16x16x32_bf16 v[228:231], a[232:235], a[88:91], v[228:231]
    ds_read_b128 v[196:199], v244 offset:64
    v_mov_b32 v252, v248
    v_mfma_f32_16x16x32_bf16 v[228:231], a[236:239], a[92:95], v[228:231]
    v_mfma_f32_16x16x32_bf16 v[232:235], a[216:219], a[96:99], 0
    v_permlane16_swap_b32 v248, v252
    v_max_f32 v248, v248, v252
    v_mfma_f32_16x16x32_bf16 v[232:235], a[220:223], a[100:103], v[232:235]
    v_mov_b32 v252, v248
    s_waitcnt lgkmcnt(2)
    v_mfma_f32_16x16x32_bf16 v[204:207], v[126:129], v[168:171], v[204:207]
    v_permlane32_swap_b32 v248, v252
    v_cvt_pk_bf16_f32 v0, v228, v229
    v_mfma_f32_16x16x32_bf16 v[232:235], a[224:227], a[104:107], v[232:235]
    v_cvt_pk_bf16_f32 v3, v230, v231
    v_max_f32 v248, v248, v252
    v_mfma_f32_16x16x32_bf16 v[232:235], a[228:231], a[108:111], v[232:235]
    v_sub_f32 v200, v200, v248
    v_sub_f32 v201, v201, v248
    v_mfma_f32_16x16x16_bf16 v[204:207], v[130:131], v[172:173], v[204:207]
    v_exp_f32 v200, v200
    v_mfma_f32_16x16x32_bf16 v[232:235], a[232:235], a[112:115], v[232:235]
    s_waitcnt lgkmcnt(1)
    v_exp_f32 v201, v201
    v_mfma_f32_16x16x32_bf16 v[208:211], v[150:153], v[168:171], v[208:211]
    s_waitcnt lgkmcnt(0)
    v_sub_f32 v202, v202, v248
    v_sub_f32 v203, v203, v248
    v_mfma_f32_16x16x32_bf16 v[196:199], v[108:111], v[168:171], v[196:199]
    v_exp_f32 v202, v202
    v_mfma_f32_16x16x32_bf16 v[232:235], a[236:239], a[116:119], v[232:235]
    v_exp_f32 v203, v203
    v_mfma_f32_16x16x16_bf16 v[208:211], v[154:155], v[172:173], v[208:211]
    v_cvt_pk_bf16_f32 v180, v200, v201
    v_cvt_pk_bf16_f32 v183, v202, v203
    v_mfma_f32_16x16x16_bf16 v[196:199], v[112:113], v[172:173], v[196:199]
    ds_read_b128 v[200:203], v245 offset:64
    v_sub_f32 v204, v204, v248
    v_mfma_f32_16x16x32_bf16 v[236:239], a[216:219], a[120:123], 0
    ds_read_b128 a[216:219], v242 offset:30848
    v_cvt_pk_bf16_f32 v30, v232, v233
    v_mfma_f32_16x16x32_bf16 v[236:239], a[220:223], a[124:127], v[236:239]
    ds_read_b128 a[220:223], v243 offset:30848
    v_cvt_pk_bf16_f32 v33, v234, v235
    v_mfma_f32_16x16x32_bf16 v[236:239], a[224:227], a[128:131], v[236:239]
    ds_read_b128 a[224:227], v242 offset:30976
    v_sub_f32 v205, v205, v248
    v_mfma_f32_16x16x32_bf16 v[236:239], a[228:231], a[132:135], v[236:239]
    ds_read_b128 a[228:231], v243 offset:30976
    v_sub_f32 v206, v206, v248
    v_mfma_f32_16x16x32_bf16 v[236:239], a[232:235], a[136:139], v[236:239]
    ds_read_b128 a[232:235], v242 offset:32256
    v_sub_f32 v207, v207, v248
    v_mfma_f32_16x16x32_bf16 v[236:239], a[236:239], a[140:143], v[236:239]
    ds_read_b128 a[236:239], v243 offset:32256
    v_sub_f32 v208, v208, v248
    v_mfma_f32_16x16x32_bf16 v[228:231], a[144:147], a[240:243], 0
    v_exp_f32 v204, v204
    v_mfma_f32_16x16x32_bf16 v[228:231], a[148:151], a[244:247], v[228:231]
    v_exp_f32 v205, v205
    v_mfma_f32_16x16x32_bf16 v[232:235], a[168:171], a[240:243], 0
    s_waitcnt lgkmcnt(6)
    v_cvt_pk_bf16_f32 v60, v236, v237
    v_cvt_pk_bf16_f32 v63, v238, v239
    v_mfma_f32_16x16x32_bf16 v[200:203], v[132:135], v[168:171], v[200:203]
    s_waitcnt lgkmcnt(5)
    v_exp_f32 v206, v206
    v_mfma_f32_16x16x32_bf16 v[228:231], a[152:155], a[216:219], v[228:231]
    s_waitcnt lgkmcnt(4)
    v_exp_f32 v207, v207
    v_mfma_f32_16x16x32_bf16 v[228:231], a[156:159], a[220:223], v[228:231]
    s_waitcnt lgkmcnt(3)
    v_cvt_pk_bf16_f32 v181, v204, v205
    v_cvt_pk_bf16_f32 v184, v206, v207
    v_mfma_f32_16x16x16_bf16 v[200:203], v[136:137], v[172:173], v[200:203]
    ds_read_b128 v[204:207], v246 offset:64
    v_sub_f32 v209, v209, v248
    v_mfma_f32_16x16x32_bf16 v[228:231], a[160:163], a[224:227], v[228:231]
    s_waitcnt lgkmcnt(2)
    v_exp_f32 v208, v208
    v_mfma_f32_16x16x32_bf16 v[228:231], a[164:167], a[228:231], v[228:231]
    v_exp_f32 v209, v209
    v_mfma_f32_16x16x32_bf16 v[232:235], a[172:175], a[244:247], v[232:235]
    v_sub_f32 v210, v210, v248
    v_sub_f32 v211, v211, v248
    v_mfma_f32_16x16x32_bf16 v[232:235], a[176:179], a[216:219], v[232:235]
    v_exp_f32 v210, v210
    v_mfma_f32_16x16x32_bf16 v[232:235], a[180:183], a[220:223], v[232:235]
    v_exp_f32 v211, v211
    v_mfma_f32_16x16x32_bf16 v[232:235], a[184:187], a[224:227], v[232:235]
    v_mul_f32 v228, s38, v228
    v_mul_f32 v229, s38, v229
    v_mfma_f32_16x16x32_bf16 v[232:235], a[188:191], a[228:231], v[232:235]
    v_mul_f32 v230, s38, v230
    v_mul_f32 v231, s38, v231
    v_mfma_f32_16x16x32_bf16 v[236:239], a[192:195], a[240:243], 0
    ds_read_b128 a[240:243], v242 offset:32384
    s_waitcnt lgkmcnt(1)
    v_cvt_pk_bf16_f32 v182, v208, v209
    v_mfma_f32_16x16x32_bf16 v[204:207], v[156:159], v[168:171], v[204:207]
    v_cvt_pk_bf16_f32 v185, v210, v211
    v_mul_f32 v232, s38, v232
    v_mfma_f32_16x16x32_bf16 v[212:215], v[12:15], v[180:183], 0
    ds_read_b128 v[208:211], v244 offset:128
    v_mul_f32 v233, s38, v233
    v_mfma_f32_16x16x32_bf16 v[216:219], v[42:45], v[180:183], 0
    v_mul_f32 v234, s38, v234
    v_mul_f32 v235, s38, v235
    v_mfma_f32_16x16x32_bf16 v[220:223], v[72:75], v[180:183], 0
    v_sub_f32 v196, v196, v248
    v_sub_f32 v197, v197, v248
    v_mfma_f32_16x16x32_bf16 v[224:227], a[248:251], v[180:183], 0
    v_exp_f32 v196, v196
    v_mfma_f32_16x16x16_bf16 v[204:207], v[160:161], v[172:173], v[204:207]
    v_exp_f32 v197, v197
    v_mfma_f32_16x16x32_bf16 v[236:239], a[196:199], a[244:247], v[236:239]
    ds_read_b128 a[244:247], v243 offset:32384
    v_sub_f32 v198, v198, v248
    v_mfma_f32_16x16x32_bf16 v[236:239], a[200:203], a[216:219], v[236:239]
    ds_read_b128 a[216:219], v242 offset:32512
    v_sub_f32 v199, v199, v248
    v_mfma_f32_16x16x32_bf16 v[236:239], a[204:207], a[220:223], v[236:239]
    ds_read_b128 a[220:223], v243 offset:32512
    v_cvt_pk_bf16_f32 v186, v196, v197
    v_mfma_f32_16x16x32_bf16 v[236:239], a[208:211], a[224:227], v[236:239]
    ds_read_b128 a[224:227], v242 offset:33792
    s_waitcnt lgkmcnt(4)
    v_sub_f32 v200, v200, v248
    v_mfma_f32_16x16x32_bf16 v[208:211], v[162:165], v[168:171], v[208:211]
    v_exp_f32 v198, v198
    v_mfma_f32_16x16x32_bf16 v[236:239], a[212:215], a[228:231], v[236:239]
    ds_read_b128 a[228:231], v243 offset:33792
    v_sub_f32 v201, v201, v248
    v_exp_f32 v199, v199
    v_exp_f32 v200, v200
    v_mfma_f32_16x16x16_bf16 v[208:211], v[166:167], v[172:173], v[208:211]
    v_cvt_pk_bf16_f32 v189, v198, v199
    ds_read_b128 v[196:199], v245 offset:128
    v_exp_f32 v201, v201
    v_mul_f32 v236, s38, v236
    v_mul_f32 v237, s38, v237
    v_mul_f32 v238, s38, v238
    v_mul_f32 v239, s38, v239
    v_sub_f32 v202, v202, v248
    v_exp_f32 v202, v202
    v_sub_f32 v203, v203, v248
    v_exp_f32 v203, v203
    v_cvt_pk_bf16_f32 v187, v200, v201
    v_cvt_pk_bf16_f32 v190, v202, v203
    ds_read_b128 v[200:203], v246 offset:128
    v_mfma_f32_16x16x32_bf16 v[212:215], v[16:19], v[184:187], v[212:215]
    v_sub_f32 v204, v204, v248
    v_sub_f32 v205, v205, v248
    v_mfma_f32_16x16x32_bf16 v[216:219], v[46:49], v[184:187], v[216:219]
    v_exp_f32 v204, v204
    v_mfma_f32_16x16x32_bf16 v[220:223], v[76:79], v[184:187], v[220:223]
    v_exp_f32 v205, v205
    v_mfma_f32_16x16x32_bf16 v[224:227], a[248:251], v[184:187], v[224:227]
    v_sub_f32 v206, v206, v248
    s_waitcnt lgkmcnt(1)
    v_mfma_f32_16x16x32_bf16 v[196:199], v[90:93], v[168:171], v[196:199]
    v_exp_f32 v206, v206
    v_sub_f32 v207, v207, v248
    v_exp_f32 v207, v207
    v_cvt_pk_bf16_f32 v188, v204, v205
    v_cvt_pk_bf16_f32 v191, v206, v207
    v_sub_f32 v208, v208, v248
    v_mfma_f32_16x16x16_bf16 v[196:199], v[94:95], v[172:173], v[196:199]
    v_exp_f32 v208, v208
    v_mfma_f32_16x16x32_bf16 v[212:215], v[20:23], v[188:191], v[212:215]
    s_waitcnt lgkmcnt(0)
    v_sub_f32 v209, v209, v248
    v_mfma_f32_16x16x32_bf16 v[216:219], v[50:53], v[188:191], v[216:219]
    v_exp_f32 v209, v209
    v_mfma_f32_16x16x32_bf16 v[220:223], v[80:83], v[188:191], v[220:223]
    v_cvt_pk_bf16_f32 v192, v208, v209
    v_sub_f32 v196, v196, v248
    v_mfma_f32_16x16x32_bf16 v[224:227], a[248:251], v[188:191], v[224:227]
    v_exp_f32 v196, v196
    v_mfma_f32_16x16x32_bf16 v[200:203], v[96:99], v[168:171], v[200:203]
    v_cvt_pk_bf16_f32 v168, v228, v229
    v_cvt_pk_bf16_f32 v169, v230, v231
    v_mfma_f32_16x16x32_bf16 v[228:231], a[144:147], a[232:235], 0
    v_cvt_pk_bf16_f32 v170, v232, v233
    v_cvt_pk_bf16_f32 v171, v234, v235
    v_mfma_f32_16x16x32_bf16 v[228:231], a[148:151], a[236:239], v[228:231]
    v_sub_f32 v197, v197, v248
    v_mfma_f32_16x16x16_bf16 v[200:203], v[100:101], v[172:173], v[200:203]
    v_cvt_pk_bf16_f32 v172, v236, v237
    v_cvt_pk_bf16_f32 v173, v238, v239
    v_mfma_f32_16x16x32_bf16 v[228:231], a[152:155], a[240:243], v[228:231]
    v_exp_f32 v197, v197
    v_mfma_f32_16x16x32_bf16 v[228:231], a[156:159], a[244:247], v[228:231]
    v_cvt_pk_bf16_f32 v193, v196, v197
    v_mfma_f32_16x16x32_bf16 v[228:231], a[160:163], a[216:219], v[228:231]
    v_mfma_f32_16x16x32_bf16 v[228:231], a[164:167], a[220:223], v[228:231]
    v_sub_f32 v200, v200, v248
    v_sub_f32 v201, v201, v248
    v_mfma_f32_16x16x32_bf16 v[232:235], a[168:171], a[232:235], 0
    v_exp_f32 v200, v200
    v_mfma_f32_16x16x32_bf16 v[232:235], a[172:175], a[236:239], v[232:235]
    v_exp_f32 v201, v201
    v_mfma_f32_16x16x32_bf16 v[232:235], a[176:179], a[240:243], v[232:235]
    v_cvt_pk_bf16_f32 v194, v200, v201
    v_mul_f32 v228, s38, v228
    v_mfma_f32_16x16x32_bf16 v[232:235], a[180:183], a[244:247], v[232:235]
    v_mul_f32 v229, s38, v229
    v_mul_f32 v230, s38, v230
    v_mfma_f32_16x16x32_bf16 v[212:215], v[24:27], v[192:195], v[212:215]
    v_mul_f32 v231, s38, v231
    v_cvt_pk_bf16_f32 v228, v228, v229
    v_mfma_f32_16x16x32_bf16 v[216:219], v[54:57], v[192:195], v[216:219]
    v_cvt_pk_bf16_f32 v229, v230, v231
    v_mfma_f32_16x16x32_bf16 v[220:223], v[84:87], v[192:195], v[220:223]
    ds_write_b64 v247, v[228:229] offset:13312
    v_mfma_f32_16x16x32_bf16 v[224:227], a[248:251], v[192:195], v[224:227]
    v_mfma_f32_16x16x32_bf16 v[232:235], a[184:187], a[216:219], v[232:235]
    v_mfma_f32_16x16x32_bf16 v[232:235], a[188:191], a[220:223], v[232:235]
    v_mfma_f32_16x16x32_bf16 v[236:239], a[192:195], a[232:235], 0
    ds_read_b128 a[232:235], v242 offset:33920
    v_mfma_f32_16x16x32_bf16 v[236:239], a[196:199], a[236:239], v[236:239]
    ds_read_b128 a[236:239], v243 offset:33920
    v_mfma_f32_16x16x32_bf16 v[236:239], a[200:203], a[240:243], v[236:239]
    ds_read_b128 a[240:243], v242 offset:34048
    v_mfma_f32_16x16x32_bf16 v[236:239], a[204:207], a[244:247], v[236:239]
    ds_read_b128 a[244:247], v243 offset:34048
    v_mul_f32 v232, s38, v232
    v_mfma_f32_16x16x32_bf16 v[236:239], a[208:211], a[216:219], v[236:239]
    v_rcp_f32 v252, v224
    v_mfma_f32_16x16x32_bf16 v[236:239], a[212:215], a[220:223], v[236:239]
    v_mul_f32 v212, v212, v252
    v_mul_f32 v213, v213, v252
    v_mfma_f32_16x16x32_bf16 v[228:231], a[144:147], a[224:227], 0
    v_mul_f32 v214, v214, v252
    v_mul_f32 v215, v215, v252
    v_mfma_f32_16x16x32_bf16 v[228:231], a[148:151], a[228:231], v[228:231]
    v_cvt_pk_bf16_f32 v212, v212, v213
    v_cvt_pk_bf16_f32 v213, v214, v215
    ds_write_b64 v251, v[212:213] offset:13312
    s_waitcnt lgkmcnt(4)
    v_mfma_f32_16x16x32_bf16 v[228:231], a[152:155], a[232:235], v[228:231]
    s_waitcnt lgkmcnt(3)
    v_mul_f32 v216, v216, v252
    v_mul_f32 v217, v217, v252
    v_mfma_f32_16x16x32_bf16 v[228:231], a[156:159], a[236:239], v[228:231]
    s_waitcnt lgkmcnt(2)
    v_mul_f32 v218, v218, v252
    v_mul_f32 v219, v219, v252
    v_mfma_f32_16x16x32_bf16 v[228:231], a[160:163], a[240:243], v[228:231]
    s_waitcnt lgkmcnt(1)
    v_cvt_pk_bf16_f32 v216, v216, v217
    v_cvt_pk_bf16_f32 v217, v218, v219
    v_mfma_f32_16x16x32_bf16 v[228:231], a[164:167], a[244:247], v[228:231]
    ds_write_b64 v251, v[216:217] offset:13344
    s_barrier
    v_mul_f32 v220, v220, v252
    v_mul_f32 v221, v221, v252
    v_mul_f32 v222, v222, v252
    v_mul_f32 v223, v223, v252
    v_cvt_pk_bf16_f32 v220, v220, v221
    v_cvt_pk_bf16_f32 v221, v222, v223
    ds_write_b64 v251, v[220:221] offset:13376
    ds_read_b128 v[204:207], v244 offset:0
    ds_read_b128 v[208:211], v245 offset:0
    ds_read_b128 v[196:199], v246 offset:0
    ds_read_b128 v[200:203], v244 offset:64
    ds_read_b128 a[216:219], v240 offset:32256
    ds_read_b128 a[220:223], v241 offset:32256
    v_mul_f32 v233, s38, v233
    v_mul_f32 v234, s38, v234
    v_mul_f32 v235, s38, v235
    v_cvt_pk_bf16_f32 v232, v232, v233
    v_cvt_pk_bf16_f32 v233, v234, v235
    ds_write_b64 v247, v[232:233] offset:13344
    v_mfma_f32_16x16x32_bf16 v[232:235], a[168:171], a[224:227], 0
    v_mul_f32 v236, s38, v236
    v_mul_f32 v237, s38, v237
    v_mfma_f32_16x16x32_bf16 v[232:235], a[172:175], a[228:231], v[232:235]
    v_mul_f32 v238, s38, v238
    v_mul_f32 v239, s38, v239
    v_mfma_f32_16x16x32_bf16 v[232:235], a[176:179], a[232:235], v[232:235]
    v_cvt_pk_bf16_f32 v236, v236, v237
    v_cvt_pk_bf16_f32 v237, v238, v239
    v_mfma_f32_16x16x32_bf16 v[232:235], a[180:183], a[236:239], v[232:235]
    ds_write_b64 v247, v[236:237] offset:13376
    v_mfma_f32_16x16x32_bf16 v[232:235], a[184:187], a[240:243], v[232:235]
    s_waitcnt lgkmcnt(6)
    v_mul_f32 v228, s38, v228
    v_mul_f32 v229, s38, v229
    v_mfma_f32_16x16x32_bf16 v[204:207], v[108:111], v[174:177], v[204:207]
    s_waitcnt lgkmcnt(4)
    v_mul_f32 v230, s38, v230
    v_mul_f32 v231, s38, v231
    v_mfma_f32_16x16x32_bf16 v[208:211], v[132:135], v[174:177], v[208:211]
    v_cvt_pk_bf16_f32 v228, v228, v229
    v_cvt_pk_bf16_f32 v229, v230, v231
    v_mfma_f32_16x16x16_bf16 v[204:207], v[112:113], v[178:179], v[204:207]
    ds_write_b64 v247, v[228:229] offset:19968
    v_mfma_f32_16x16x32_bf16 v[196:199], v[156:159], v[174:177], v[196:199]
    s_waitcnt lgkmcnt(2)
    v_mfma_f32_16x16x16_bf16 v[208:211], v[136:137], v[178:179], v[208:211]
    v_mfma_f32_16x16x32_bf16 v[200:203], v[162:165], v[174:177], v[200:203]
    v_mfma_f32_16x16x32_bf16 v[232:235], a[188:191], a[244:247], v[232:235]
    v_mfma_f32_16x16x32_bf16 v[236:239], a[192:195], a[224:227], 0
    ds_read_b128 a[224:227], v240 offset:32384
    v_max_f32 v248, v204, v205
    v_mfma_f32_16x16x16_bf16 v[196:199], v[160:161], v[178:179], v[196:199]
    v_max3_f32 v248, v248, v206, v207
    v_mfma_f32_16x16x16_bf16 v[200:203], v[166:167], v[178:179], v[200:203]
    ds_read_b128 v[204:207], v245 offset:64
    v_max3_f32 v248, v248, v208, v209
    v_mfma_f32_16x16x32_bf16 v[236:239], a[196:199], a[228:231], v[236:239]
    ds_read_b128 a[228:231], v241 offset:32384
    v_mul_f32 v232, s38, v232
    v_mfma_f32_16x16x32_bf16 v[236:239], a[200:203], a[232:235], v[236:239]
    ds_read_b128 a[232:235], v240 offset:32512
    v_mul_f32 v233, s38, v233
    v_mfma_f32_16x16x32_bf16 v[236:239], a[204:207], a[236:239], v[236:239]
    ds_read_b128 a[236:239], v241 offset:32512
    v_mul_f32 v234, s38, v234
    v_mfma_f32_16x16x32_bf16 v[236:239], a[208:211], a[240:243], v[236:239]
    ds_read_b128 a[240:243], v240 offset:33792
    v_mul_f32 v235, s38, v235
    v_mfma_f32_16x16x32_bf16 v[236:239], a[212:215], a[244:247], v[236:239]
    ds_read_b128 a[244:247], v241 offset:33792
    v_cvt_pk_bf16_f32 v232, v232, v233
    v_mfma_f32_16x16x32_bf16 v[228:231], a[0:3], a[216:219], 0
    v_cvt_pk_bf16_f32 v233, v234, v235
    v_max3_f32 v248, v248, v210, v211
    v_mfma_f32_16x16x32_bf16 v[228:231], a[4:7], a[220:223], v[228:231]
    s_waitcnt lgkmcnt(6)
    v_max3_f32 v248, v248, v196, v197
    v_mul_f32 v236, s38, v236
    v_mfma_f32_16x16x32_bf16 v[228:231], a[8:11], a[224:227], v[228:231]
    ds_write_b64 v247, v[232:233] offset:20000
    v_mfma_f32_16x16x32_bf16 v[232:235], a[24:27], a[216:219], 0
    ds_read_b128 v[208:211], v246 offset:64
    s_waitcnt lgkmcnt(6)
    v_mul_f32 v237, s38, v237
    v_mfma_f32_16x16x32_bf16 v[204:207], v[90:93], v[174:177], v[204:207]
    v_mul_f32 v238, s38, v238
    v_mul_f32 v239, s38, v239
    v_mfma_f32_16x16x32_bf16 v[228:231], a[12:15], a[228:231], v[228:231]
    s_waitcnt lgkmcnt(4)
    v_cvt_pk_bf16_f32 v236, v236, v237
    v_cvt_pk_bf16_f32 v237, v238, v239
    v_mfma_f32_16x16x16_bf16 v[204:207], v[94:95], v[178:179], v[204:207]
    ds_write_b64 v247, v[236:237] offset:20032
    v_mfma_f32_16x16x32_bf16 v[228:231], a[16:19], a[232:235], v[228:231]
    v_max3_f32 v248, v248, v198, v199
    v_max3_f32 v248, v248, v200, v201
    v_mfma_f32_16x16x32_bf16 v[228:231], a[20:23], a[236:239], v[228:231]
    ds_read_b128 v[196:199], v244 offset:0
    v_max3_f32 v248, v248, v202, v203
    v_mfma_f32_16x16x32_bf16 v[232:235], a[28:31], a[220:223], v[232:235]
    ds_read_b128 v[200:203], v245 offset:0
    v_max3_f32 v248, v248, v204, v205
    v_mfma_f32_16x16x32_bf16 v[232:235], a[32:35], a[224:227], v[232:235]
    v_max3_f32 v248, v248, v206, v207
    v_mfma_f32_16x16x32_bf16 v[232:235], a[36:39], a[228:231], v[232:235]
    ds_read_b128 v[204:207], v246 offset:0
    s_waitcnt lgkmcnt(4)
    v_mfma_f32_16x16x32_bf16 v[208:211], v[96:99], v[174:177], v[208:211]
    v_mfma_f32_16x16x32_bf16 v[232:235], a[40:43], a[232:235], v[232:235]
    v_mfma_f32_16x16x32_bf16 v[232:235], a[44:47], a[236:239], v[232:235]
    v_mfma_f32_16x16x32_bf16 v[236:239], a[48:51], a[216:219], 0
    v_mfma_f32_16x16x32_bf16 v[236:239], a[52:55], a[220:223], v[236:239]
    v_mfma_f32_16x16x32_bf16 v[236:239], a[56:59], a[224:227], v[236:239]
    s_waitcnt lgkmcnt(2)
    s_waitcnt lgkmcnt(1)
    v_mfma_f32_16x16x16_bf16 v[208:211], v[100:101], v[178:179], v[208:211]
    v_mfma_f32_16x16x32_bf16 v[196:199], v[108:111], v[174:177], v[196:199]
    v_cvt_pk_bf16_f32 v108, v228, v229
    v_cvt_pk_bf16_f32 v109, v230, v231
    v_mfma_f32_16x16x32_bf16 v[200:203], v[132:135], v[174:177], v[200:203]
    s_waitcnt lgkmcnt(0)
    v_cvt_pk_bf16_f32 v110, v232, v233
    v_cvt_pk_bf16_f32 v111, v234, v235
    v_mfma_f32_16x16x16_bf16 v[196:199], v[112:113], v[178:179], v[196:199]
    v_max3_f32 v248, v248, v208, v209
    v_max3_f32 v248, v248, v210, v211
    v_mfma_f32_16x16x16_bf16 v[200:203], v[136:137], v[178:179], v[200:203]
    ds_read_b128 v[208:211], v244 offset:64
    v_mov_b32 v252, v248
    v_mfma_f32_16x16x32_bf16 v[204:207], v[156:159], v[174:177], v[204:207]
    v_mfma_f32_16x16x32_bf16 v[236:239], a[60:63], a[228:231], v[236:239]
    v_permlane16_swap_b32 v248, v252
    v_max_f32 v248, v248, v252
    v_mfma_f32_16x16x32_bf16 v[236:239], a[64:67], a[232:235], v[236:239]
    v_mov_b32 v252, v248
    v_mfma_f32_16x16x32_bf16 v[236:239], a[68:71], a[236:239], v[236:239]
    v_mfma_f32_16x16x16_bf16 v[204:207], v[160:161], v[178:179], v[204:207]
    v_permlane32_swap_b32 v248, v252
    v_max_f32 v248, v248, v252
    v_mfma_f32_16x16x32_bf16 v[228:231], a[216:219], a[72:75], 0
    v_sub_f32 v196, v196, v248
    v_sub_f32 v197, v197, v248
    v_mfma_f32_16x16x32_bf16 v[228:231], a[220:223], a[76:79], v[228:231]
    v_exp_f32 v196, v196
    v_mfma_f32_16x16x32_bf16 v[228:231], a[224:227], a[80:83], v[228:231]
    v_cvt_pk_bf16_f32 v112, v236, v237
    v_cvt_pk_bf16_f32 v113, v238, v239
    v_mfma_f32_16x16x32_bf16 v[228:231], a[228:231], a[84:87], v[228:231]
    s_waitcnt lgkmcnt(0)
    v_exp_f32 v197, v197
    v_mfma_f32_16x16x32_bf16 v[208:211], v[162:165], v[174:177], v[208:211]
    v_sub_f32 v198, v198, v248
    v_sub_f32 v199, v199, v248
    v_mfma_f32_16x16x32_bf16 v[228:231], a[232:235], a[88:91], v[228:231]
    v_exp_f32 v198, v198
    v_mfma_f32_16x16x32_bf16 v[228:231], a[236:239], a[92:95], v[228:231]
    v_exp_f32 v199, v199
    v_mfma_f32_16x16x16_bf16 v[208:211], v[166:167], v[178:179], v[208:211]
    v_cvt_pk_bf16_f32 v180, v196, v197
    v_cvt_pk_bf16_f32 v183, v198, v199
    v_mfma_f32_16x16x32_bf16 v[232:235], a[216:219], a[96:99], 0
    ds_read_b128 v[196:199], v245 offset:64
    v_sub_f32 v200, v200, v248
    v_mfma_f32_16x16x32_bf16 v[232:235], a[220:223], a[100:103], v[232:235]
    v_cvt_pk_bf16_f32 v6, v228, v229
    v_cvt_pk_bf16_f32 v9, v230, v231
    v_mfma_f32_16x16x32_bf16 v[232:235], a[224:227], a[104:107], v[232:235]
    v_exp_f32 v200, v200
    v_mfma_f32_16x16x32_bf16 v[232:235], a[228:231], a[108:111], v[232:235]
    v_sub_f32 v201, v201, v248
    v_sub_f32 v202, v202, v248
    v_mfma_f32_16x16x32_bf16 v[232:235], a[232:235], a[112:115], v[232:235]
    v_exp_f32 v201, v201
    v_mfma_f32_16x16x32_bf16 v[232:235], a[236:239], a[116:119], v[232:235]
    v_exp_f32 v202, v202
    v_mfma_f32_16x16x32_bf16 v[236:239], a[216:219], a[120:123], 0
    ds_read_b128 a[216:219], v240 offset:33920
    v_sub_f32 v203, v203, v248
    v_mfma_f32_16x16x32_bf16 v[236:239], a[220:223], a[124:127], v[236:239]
    ds_read_b128 a[220:223], v241 offset:33920
    v_cvt_pk_bf16_f32 v181, v200, v201
    v_mfma_f32_16x16x32_bf16 v[236:239], a[224:227], a[128:131], v[236:239]
    ds_read_b128 a[224:227], v240 offset:34048
    s_waitcnt lgkmcnt(3)
    v_cvt_pk_bf16_f32 v36, v232, v233
    v_mfma_f32_16x16x32_bf16 v[196:199], v[90:93], v[174:177], v[196:199]
    v_cvt_pk_bf16_f32 v39, v234, v235
    v_sub_f32 v204, v204, v248
    v_mfma_f32_16x16x32_bf16 v[236:239], a[228:231], a[132:135], v[236:239]
    ds_read_b128 a[228:231], v241 offset:34048
    v_sub_f32 v205, v205, v248
    v_mfma_f32_16x16x32_bf16 v[236:239], a[232:235], a[136:139], v[236:239]
    ds_read_b128 a[232:235], v242 offset:61440
    v_sub_f32 v206, v206, v248
    v_mfma_f32_16x16x16_bf16 v[196:199], v[94:95], v[178:179], v[196:199]
    v_exp_f32 v203, v203
    v_mfma_f32_16x16x32_bf16 v[236:239], a[236:239], a[140:143], v[236:239]
    ds_read_b128 a[236:239], v243 offset:61440
    v_cvt_pk_bf16_f32 v184, v202, v203
    v_mfma_f32_16x16x32_bf16 v[228:231], a[0:3], a[240:243], 0
    ds_read_b128 v[200:203], v246 offset:64
    v_sub_f32 v207, v207, v248
    v_mfma_f32_16x16x32_bf16 v[228:231], a[4:7], a[244:247], v[228:231]
    s_waitcnt lgkmcnt(6)
    v_exp_f32 v204, v204
    v_mfma_f32_16x16x32_bf16 v[228:231], a[8:11], a[216:219], v[228:231]
    s_waitcnt lgkmcnt(5)
    v_cvt_pk_bf16_f32 v66, v236, v237
    v_cvt_pk_bf16_f32 v69, v238, v239
    v_mfma_f32_16x16x32_bf16 v[228:231], a[12:15], a[220:223], v[228:231]
    s_waitcnt lgkmcnt(4)
    v_exp_f32 v205, v205
    v_mfma_f32_16x16x32_bf16 v[228:231], a[16:19], a[224:227], v[228:231]
    v_exp_f32 v206, v206
    v_mfma_f32_16x16x32_bf16 v[232:235], a[24:27], a[240:243], 0
    s_waitcnt lgkmcnt(3)
    v_exp_f32 v207, v207
    v_mfma_f32_16x16x32_bf16 v[228:231], a[20:23], a[228:231], v[228:231]
    v_cvt_pk_bf16_f32 v182, v204, v205
    v_cvt_pk_bf16_f32 v185, v206, v207
    v_mfma_f32_16x16x32_bf16 v[232:235], a[28:31], a[244:247], v[232:235]
    v_sub_f32 v208, v208, v248
    v_sub_f32 v209, v209, v248
    v_mfma_f32_16x16x32_bf16 v[212:215], v[18:21], v[180:183], 0
    v_exp_f32 v208, v208
    v_mfma_f32_16x16x32_bf16 v[216:219], v[48:51], v[180:183], 0
    s_waitcnt lgkmcnt(0)
    v_cvt_pk_bf16_f32 v162, v228, v229
    v_cvt_pk_bf16_f32 v163, v230, v231
    v_mfma_f32_16x16x32_bf16 v[220:223], v[78:81], v[180:183], 0
    v_exp_f32 v209, v209
    v_mfma_f32_16x16x32_bf16 v[224:227], a[248:251], v[180:183], 0
    v_sub_f32 v210, v210, v248
    v_sub_f32 v211, v211, v248
    v_mfma_f32_16x16x32_bf16 v[200:203], v[96:99], v[174:177], v[200:203]
    ds_read_b64 v[174:175], v247 offset:13312
    v_cvt_pk_bf16_f32 v186, v208, v209
    v_mfma_f32_16x16x32_bf16 v[232:235], a[32:35], a[216:219], v[232:235]
    ds_read_b64 v[176:177], v247 offset:13344
    v_sub_f32 v196, v196, v248
    v_mfma_f32_16x16x32_bf16 v[232:235], a[36:39], a[220:223], v[232:235]
    v_exp_f32 v210, v210
    v_mfma_f32_16x16x16_bf16 v[200:203], v[100:101], v[178:179], v[200:203]
    ds_read_b64 v[178:179], v247 offset:13376
    v_sub_f32 v197, v197, v248
    v_mfma_f32_16x16x32_bf16 v[232:235], a[40:43], a[224:227], v[232:235]
    v_exp_f32 v211, v211
    v_mfma_f32_16x16x32_bf16 v[232:235], a[44:47], a[228:231], v[232:235]
    v_cvt_pk_bf16_f32 v189, v210, v211
    v_sub_f32 v198, v198, v248
    v_mfma_f32_16x16x32_bf16 v[236:239], a[48:51], a[240:243], 0
    v_exp_f32 v196, v196
    v_mfma_f32_16x16x32_bf16 v[236:239], a[52:55], a[244:247], v[236:239]
    v_exp_f32 v197, v197
    v_mfma_f32_16x16x32_bf16 v[236:239], a[56:59], a[216:219], v[236:239]
    v_exp_f32 v198, v198
    v_mfma_f32_16x16x32_bf16 v[236:239], a[60:63], a[220:223], v[236:239]
    v_cvt_pk_bf16_f32 v164, v232, v233
    v_cvt_pk_bf16_f32 v165, v234, v235
    v_mfma_f32_16x16x32_bf16 v[236:239], a[64:67], a[224:227], v[236:239]
    v_sub_f32 v199, v199, v248
    v_cvt_pk_bf16_f32 v187, v196, v197
    v_mfma_f32_16x16x32_bf16 v[236:239], a[68:71], a[228:231], v[236:239]
    v_exp_f32 v199, v199
    v_mfma_f32_16x16x32_bf16 v[212:215], v[22:25], v[184:187], v[212:215]
    v_cvt_pk_bf16_f32 v190, v198, v199
    v_sub_f32 v200, v200, v248
    v_mfma_f32_16x16x32_bf16 v[216:219], v[52:55], v[184:187], v[216:219]
    v_exp_f32 v200, v200
    v_mfma_f32_16x16x32_bf16 v[220:223], v[82:85], v[184:187], v[220:223]
    v_sub_f32 v201, v201, v248
    v_cvt_pk_bf16_f32 v166, v236, v237
    v_mfma_f32_16x16x32_bf16 v[224:227], a[248:251], v[184:187], v[224:227]
    v_cvt_pk_bf16_f32 v167, v238, v239
    v_sub_f32 v202, v202, v248
    v_mfma_f32_16x16x32_bf16 v[228:231], a[240:243], a[72:75], 0
    v_exp_f32 v201, v201
    v_mfma_f32_16x16x32_bf16 v[228:231], a[244:247], a[76:79], v[228:231]
    v_exp_f32 v202, v202
    v_mfma_f32_16x16x32_bf16 v[228:231], a[216:219], a[80:83], v[228:231]
    v_sub_f32 v203, v203, v248
    v_cvt_pk_bf16_f32 v188, v200, v201
    v_mfma_f32_16x16x32_bf16 v[228:231], a[220:223], a[84:87], v[228:231]
    v_exp_f32 v203, v203
    v_mfma_f32_16x16x32_bf16 v[228:231], a[224:227], a[88:91], v[228:231]
    v_cvt_pk_bf16_f32 v191, v202, v203
    v_mfma_f32_16x16x32_bf16 v[228:231], a[228:231], a[92:95], v[228:231]
    v_mfma_f32_16x16x32_bf16 v[232:235], a[240:243], a[96:99], 0
    v_mfma_f32_16x16x32_bf16 v[212:215], v[26:29], v[188:191], v[212:215]
    v_mfma_f32_16x16x32_bf16 v[216:219], v[56:59], v[188:191], v[216:219]
    v_mfma_f32_16x16x32_bf16 v[220:223], v[86:89], v[188:191], v[220:223]
    v_mfma_f32_16x16x32_bf16 v[224:227], a[248:251], v[188:191], v[224:227]
    v_mov_b32 v191, 0
    v_mfma_f32_16x16x32_bf16 v[232:235], a[244:247], a[100:103], v[232:235]
    v_mfma_f32_16x16x32_bf16 v[232:235], a[216:219], a[104:107], v[232:235]
    v_cvt_pk_bf16_f32 v12, v228, v229
    v_cvt_pk_bf16_f32 v15, v230, v231
    v_mfma_f32_16x16x32_bf16 v[232:235], a[220:223], a[108:111], v[232:235]
    v_mfma_f32_16x16x32_bf16 v[232:235], a[224:227], a[112:115], v[232:235]
    v_mfma_f32_16x16x32_bf16 v[232:235], a[228:231], a[116:119], v[232:235]
    v_rcp_f32 v252, v224
    v_mfma_f32_16x16x32_bf16 v[236:239], a[240:243], a[120:123], 0
    ds_read_b128 a[240:243], v242 offset:61568
    v_mul_f32 v212, v212, v252
    v_mfma_f32_16x16x32_bf16 v[236:239], a[244:247], a[124:127], v[236:239]
    ds_read_b128 a[244:247], v243 offset:61568
    v_mul_f32 v213, v213, v252
    v_mfma_f32_16x16x32_bf16 v[236:239], a[216:219], a[128:131], v[236:239]
    ds_read_b128 a[216:219], v242 offset:61696
    v_mul_f32 v214, v214, v252
    v_mfma_f32_16x16x32_bf16 v[236:239], a[220:223], a[132:135], v[236:239]
    ds_read_b128 a[220:223], v243 offset:61696
    v_mul_f32 v215, v215, v252
    v_mfma_f32_16x16x32_bf16 v[236:239], a[224:227], a[136:139], v[236:239]
    ds_read_b128 a[224:227], v242 offset:62976
    v_cvt_pk_bf16_f32 v212, v212, v213
    v_mfma_f32_16x16x32_bf16 v[236:239], a[228:231], a[140:143], v[236:239]
    ds_read_b128 a[228:231], v243 offset:62976
    v_cvt_pk_bf16_f32 v213, v214, v215
    v_mfma_f32_16x16x32_bf16 v[228:231], a[144:147], a[232:235], 0
    ds_write_b64 v253, v[212:213] offset:0
    v_mfma_f32_16x16x32_bf16 v[228:231], a[148:151], a[236:239], v[228:231]
    v_mul_f32 v216, v216, v252
    v_mul_f32 v217, v217, v252
    v_mul_f32 v218, v218, v252
    v_mul_f32 v219, v219, v252
    v_cvt_pk_bf16_f32 v216, v216, v217
    v_cvt_pk_bf16_f32 v217, v218, v219
    ds_write_b64 v253, v[216:217] offset:32
    s_waitcnt lgkmcnt(6)
    v_mfma_f32_16x16x32_bf16 v[228:231], a[152:155], a[240:243], v[228:231]
    v_mul_f32 v220, v220, v252
    v_mul_f32 v221, v221, v252
    v_mfma_f32_16x16x32_bf16 v[228:231], a[156:159], a[244:247], v[228:231]
    s_waitcnt lgkmcnt(4)
    v_mul_f32 v222, v222, v252
    v_mul_f32 v223, v223, v252
    v_mfma_f32_16x16x32_bf16 v[228:231], a[160:163], a[216:219], v[228:231]
    v_cvt_pk_bf16_f32 v220, v220, v221
    v_cvt_pk_bf16_f32 v221, v222, v223
    v_mfma_f32_16x16x32_bf16 v[228:231], a[164:167], a[220:223], v[228:231]
    ds_write_b64 v253, v[220:221] offset:64
    v_cvt_pk_bf16_f32 v42, v232, v233
    v_cvt_pk_bf16_f32 v45, v234, v235
    v_mfma_f32_16x16x32_bf16 v[232:235], a[168:171], a[232:235], 0
    v_cvt_pk_bf16_f32 v72, v236, v237
    v_cvt_pk_bf16_f32 v75, v238, v239
    v_mfma_f32_16x16x32_bf16 v[232:235], a[172:175], a[236:239], v[232:235]
    v_mbcnt_lo_u32_b32 v253, -1, 0
    v_mul_f32 v228, s38, v228
    v_mfma_f32_16x16x32_bf16 v[232:235], a[176:179], a[240:243], v[232:235]
    v_mul_f32 v229, s38, v229
    v_mul_f32 v230, s38, v230
    v_mfma_f32_16x16x32_bf16 v[232:235], a[180:183], a[244:247], v[232:235]
    v_mul_f32 v231, s38, v231
    v_cvt_pk_bf16_f32 v228, v228, v229
    v_mfma_f32_16x16x32_bf16 v[232:235], a[184:187], a[216:219], v[232:235]
    v_cvt_pk_bf16_f32 v229, v230, v231
    v_mbcnt_hi_u32_b32 v253, -1, v253
    v_mfma_f32_16x16x32_bf16 v[232:235], a[188:191], a[220:223], v[232:235]
    ds_write_b64 v247, v[228:229] offset:26624
    v_mfma_f32_16x16x32_bf16 v[236:239], a[192:195], a[232:235], 0
    ds_read_b128 a[232:235], v242 offset:63104
    s_waitcnt lgkmcnt(2)
    v_and_b32 v253, 2, v253
    v_mfma_f32_16x16x32_bf16 v[236:239], a[196:199], a[236:239], v[236:239]
    ds_read_b128 a[236:239], v243 offset:63104
    v_mbcnt_lo_u32_b32 v252, -1, 0
    v_mfma_f32_16x16x32_bf16 v[236:239], a[200:203], a[240:243], v[236:239]
    ds_read_b128 a[240:243], v242 offset:63232
    v_mul_f32 v232, s38, v232
    v_mfma_f32_16x16x32_bf16 v[236:239], a[204:207], a[244:247], v[236:239]
    ds_read_b128 a[244:247], v243 offset:63232
    v_mul_f32 v233, s38, v233
    v_mfma_f32_16x16x32_bf16 v[236:239], a[208:211], a[216:219], v[236:239]
    ds_read_b128 a[216:219], v240 offset:35328
    v_mul_f32 v234, s38, v234
    v_mfma_f32_16x16x32_bf16 v[236:239], a[212:215], a[220:223], v[236:239]
    ds_read_b128 a[220:223], v241 offset:35328
    v_mul_f32 v235, s38, v235
    v_mfma_f32_16x16x32_bf16 v[228:231], a[144:147], a[224:227], 0
    v_cvt_pk_bf16_f32 v232, v232, v233
    v_cvt_pk_bf16_f32 v233, v234, v235
    v_mfma_f32_16x16x32_bf16 v[228:231], a[148:151], a[228:231], v[228:231]
    ds_write_b64 v247, v[232:233] offset:26656
    v_mfma_f32_16x16x32_bf16 v[232:235], a[168:171], a[224:227], 0
    s_waitcnt lgkmcnt(6)
    v_mul_f32 v236, s38, v236
    v_mul_f32 v237, s38, v237
    v_mfma_f32_16x16x32_bf16 v[228:231], a[152:155], a[232:235], v[228:231]
    s_waitcnt lgkmcnt(5)
    v_mul_f32 v238, s38, v238
    v_mul_f32 v239, s38, v239
    v_mfma_f32_16x16x32_bf16 v[228:231], a[156:159], a[236:239], v[228:231]
    s_waitcnt lgkmcnt(4)
    v_cvt_pk_bf16_f32 v236, v236, v237
    v_cvt_pk_bf16_f32 v237, v238, v239
    v_mfma_f32_16x16x32_bf16 v[228:231], a[160:163], a[240:243], v[228:231]
    ds_write_b64 v247, v[236:237] offset:26688
    v_mfma_f32_16x16x32_bf16 v[232:235], a[172:175], a[228:231], v[232:235]
    s_waitcnt lgkmcnt(3)
    v_mbcnt_hi_u32_b32 v252, -1, v252
    v_bfe_u32 v204, v252, 2, 2
    v_mfma_f32_16x16x32_bf16 v[228:231], a[164:167], a[244:247], v[228:231]
    v_and_b32 v205, 3, v252
    v_lshrrev_b32 v252, 4, v252
    v_mfma_f32_16x16x32_bf16 v[232:235], a[176:179], a[232:235], v[232:235]
    v_sub_u32 v206, v252, v204
    v_mul_i32_i24 v206, 0x1c0, v206
    v_mfma_f32_16x16x32_bf16 v[232:235], a[180:183], a[236:239], v[232:235]
    v_lshlrev_b32 v207, 4, v205
    v_sub_u32 v206, v206, v207
    v_mfma_f32_16x16x32_bf16 v[232:235], a[184:187], a[240:243], v[232:235]
    v_mul_f32 v228, s38, v228
    v_mul_f32 v229, s38, v229
    v_mfma_f32_16x16x32_bf16 v[232:235], a[188:191], a[244:247], v[232:235]
    v_mul_f32 v230, s38, v230
    v_mul_f32 v231, s38, v231
    v_mfma_f32_16x16x32_bf16 v[236:239], a[192:195], a[224:227], 0
    ds_read_b128 a[224:227], v240 offset:35456
    v_cvt_pk_bf16_f32 v228, v228, v229
    v_mfma_f32_16x16x32_bf16 v[236:239], a[196:199], a[228:231], v[236:239]
    ds_read_b128 a[228:231], v241 offset:35456
    v_cvt_pk_bf16_f32 v229, v230, v231
    v_mfma_f32_16x16x32_bf16 v[236:239], a[200:203], a[232:235], v[236:239]
    ds_write_b64 v247, v[228:229] offset:33280
    v_mfma_f32_16x16x32_bf16 v[236:239], a[204:207], a[236:239], v[236:239]
    ds_read_b128 a[232:235], v240 offset:35584
    v_mul_f32 v232, s38, v232
    v_mfma_f32_16x16x32_bf16 v[236:239], a[208:211], a[240:243], v[236:239]
    ds_read_b128 a[236:239], v241 offset:35584
    v_mul_f32 v233, s38, v233
    v_mfma_f32_16x16x32_bf16 v[236:239], a[212:215], a[244:247], v[236:239]
    ds_read_b128 a[240:243], v242 offset:64512
    v_mul_f32 v234, s38, v234
    v_mfma_f32_16x16x32_bf16 v[228:231], a[0:3], a[216:219], 0
    s_waitcnt lgkmcnt(6)
    v_mul_f32 v235, s38, v235
    v_cvt_pk_bf16_f32 v232, v232, v233
    v_mfma_f32_16x16x32_bf16 v[228:231], a[4:7], a[220:223], v[228:231]
    ds_read_b128 a[244:247], v243 offset:64512
    v_cvt_pk_bf16_f32 v233, v234, v235
    ds_write_b64 v247, v[232:233] offset:33312
    v_mfma_f32_16x16x32_bf16 v[232:235], a[24:27], a[216:219], 0
    s_waitcnt lgkmcnt(6)
    v_mul_f32 v236, s38, v236
    v_mul_f32 v237, s38, v237
    v_mfma_f32_16x16x32_bf16 v[228:231], a[8:11], a[224:227], v[228:231]
    v_mul_f32 v238, s38, v238
    v_mul_f32 v239, s38, v239
    v_mfma_f32_16x16x32_bf16 v[228:231], a[12:15], a[228:231], v[228:231]
    s_waitcnt lgkmcnt(4)
    v_cvt_pk_bf16_f32 v236, v236, v237
    v_cvt_pk_bf16_f32 v237, v238, v239
    v_mfma_f32_16x16x32_bf16 v[228:231], a[16:19], a[232:235], v[228:231]
    ds_write_b64 v247, v[236:237] offset:33344
    v_mfma_f32_16x16x32_bf16 v[232:235], a[28:31], a[220:223], v[232:235]
    s_waitcnt lgkmcnt(3)
    v_add_u32 v206, s37, v206
    v_sub_u32 v207, v252, v204
    v_mfma_f32_16x16x32_bf16 v[228:231], a[20:23], a[236:239], v[228:231]
    v_add_u32 v244, 0, v207
    v_cmp_gt_u32 vcc, 7, v244
    v_mfma_f32_16x16x32_bf16 v[232:235], a[32:35], a[224:227], v[232:235]
    v_add_u32 v244, 0xfffdc870, v206
    v_cndmask_b32 v244, 0, v244, vcc
    v_mfma_f32_16x16x32_bf16 v[232:235], a[36:39], a[228:231], v[232:235]
    v_add_u32 v244, 0x237c0, v244
    v_add_u32 v245, 4, v207
    v_mfma_f32_16x16x32_bf16 v[232:235], a[40:43], a[232:235], v[232:235]
    ds_read_b128 v[200:203], v244 offset:256
    v_cmp_gt_u32 vcc, 7, v245
    v_mfma_f32_16x16x32_bf16 v[232:235], a[44:47], a[236:239], v[232:235]
    v_add_u32 v245, 0xfffdcf70, v206
    v_cndmask_b32 v245, 0, v245, vcc
    v_mfma_f32_16x16x32_bf16 v[236:239], a[48:51], a[216:219], 0
    v_add_u32 v245, 0x237c0, v245
    v_add_u32 v246, 8, v207
    v_mfma_f32_16x16x32_bf16 v[236:239], a[52:55], a[220:223], v[236:239]
    ds_read_b128 v[208:211], v245 offset:192
    v_cmp_gt_u32 vcc, 7, v246
    v_mfma_f32_16x16x32_bf16 v[236:239], a[56:59], a[224:227], v[236:239]
    v_add_u32 v246, 0xfffdd670, v206
    v_cndmask_b32 v246, 0, v246, vcc
    v_mfma_f32_16x16x32_bf16 v[236:239], a[60:63], a[228:231], v[236:239]
    ds_read_b128 v[204:207], v244 offset:192
    v_cmp_eq_u32 vcc, 2, v253
    v_mfma_f32_16x16x32_bf16 v[236:239], a[64:67], a[232:235], v[236:239]
    v_add_u32 v253, 0xfffdd200, v247
    v_cndmask_b32 v253, 0, v253, vcc
    v_mfma_f32_16x16x32_bf16 v[236:239], a[68:71], a[236:239], v[236:239]
    v_add_u32 v253, 0x22e00, v253
    v_add_u32 v246, 0x237c0, v246
    ds_read_b128 v[196:199], v246 offset:192
    s_waitcnt lgkmcnt(3)
    v_mfma_f32_16x16x32_bf16 v[200:203], v[120:123], v[168:171], v[200:203]
    s_nop 5
    v_mfma_f32_16x16x16_bf16 v[200:203], v[124:125], v[172:173], v[200:203]
    s_waitcnt lgkmcnt(2)
    v_mfma_f32_16x16x32_bf16 v[208:211], v[138:141], v[168:171], v[208:211]
    s_nop 5
    v_mfma_f32_16x16x16_bf16 v[208:211], v[142:143], v[172:173], v[208:211]
    s_waitcnt lgkmcnt(1)
    v_mfma_f32_16x16x32_bf16 v[204:207], v[114:117], v[168:171], v[204:207]
    s_nop 5
    v_mfma_f32_16x16x16_bf16 v[204:207], v[118:119], v[172:173], v[204:207]
    s_waitcnt lgkmcnt(0)
    v_mfma_f32_16x16x32_bf16 v[196:199], v[102:105], v[168:171], v[196:199]
    s_nop 5
    v_mfma_f32_16x16x16_bf16 v[196:199], v[106:107], v[172:173], v[196:199]
    v_max_f32 v248, v204, v205
    v_max3_f32 v248, v248, v206, v207
    ds_read_b128 v[204:207], v245 offset:256
    v_max3_f32 v248, v248, v208, v209
    v_max3_f32 v248, v248, v210, v211
    ds_read_b128 v[208:211], v246 offset:256
    s_nop 1
    v_max3_f32 v248, v248, v196, v197
    v_max3_f32 v248, v248, v198, v199
    ds_read_b128 v[196:199], v244 offset:320
    v_max3_f32 v248, v248, v200, v201
    v_max3_f32 v248, v248, v202, v203
    ds_read_b128 v[200:203], v245 offset:320
    s_waitcnt lgkmcnt(3)
    v_mfma_f32_16x16x32_bf16 v[204:207], v[144:147], v[168:171], v[204:207]
    s_nop 5
    v_mfma_f32_16x16x16_bf16 v[204:207], v[148:149], v[172:173], v[204:207]
    s_waitcnt lgkmcnt(2)
    v_mfma_f32_16x16x32_bf16 v[208:211], v[108:111], v[168:171], v[208:211]
    s_waitcnt lgkmcnt(1)
    v_mfma_f32_16x16x32_bf16 v[196:199], v[126:129], v[168:171], v[196:199]
    s_waitcnt lgkmcnt(0)
    v_mfma_f32_16x16x32_bf16 v[200:203], v[150:153], v[168:171], v[200:203]
    s_nop 1
    v_max3_f32 v248, v248, v204, v205
    v_mfma_f32_16x16x16_bf16 v[208:211], v[112:113], v[172:173], v[208:211]
    v_max3_f32 v248, v248, v206, v207
    v_mfma_f32_16x16x16_bf16 v[196:199], v[130:131], v[172:173], v[196:199]
    ds_read_b128 v[204:207], v246 offset:320
    v_mfma_f32_16x16x16_bf16 v[200:203], v[154:155], v[172:173], v[200:203]
    s_nop 3
    v_max3_f32 v248, v248, v208, v209
    v_max3_f32 v248, v248, v210, v211
    ds_read_b128 v[208:211], v244 offset:192
    v_max3_f32 v248, v248, v196, v197
    ds_read_b128 v[196:199], v245 offset:192
    v_max3_f32 v248, v248, v200, v201
    ds_read_b128 v[200:203], v246 offset:192
    s_waitcnt lgkmcnt(3)
    v_mfma_f32_16x16x32_bf16 v[204:207], v[162:165], v[168:171], v[204:207]
    s_nop 5
    v_mfma_f32_16x16x16_bf16 v[204:207], v[166:167], v[172:173], v[204:207]
    s_nop 7
    s_waitcnt lgkmcnt(1)
    v_mfma_f32_16x16x32_bf16 v[208:211], v[114:117], v[168:171], v[208:211]
    s_waitcnt lgkmcnt(0)
    v_cvt_pk_bf16_f32 v114, v228, v229
    v_cvt_pk_bf16_f32 v115, v230, v231
    v_mfma_f32_16x16x32_bf16 v[196:199], v[138:141], v[168:171], v[196:199]
    v_cvt_pk_bf16_f32 v116, v232, v233
    v_cvt_pk_bf16_f32 v117, v234, v235
    v_mfma_f32_16x16x16_bf16 v[208:211], v[118:119], v[172:173], v[208:211]
    v_cvt_pk_bf16_f32 v118, v236, v237
    v_cvt_pk_bf16_f32 v119, v238, v239
    v_mfma_f32_16x16x32_bf16 v[200:203], v[102:105], v[168:171], v[200:203]
    v_max3_f32 v248, v248, v204, v205
    v_mov_b32 v252, v248
    v_mfma_f32_16x16x16_bf16 v[196:199], v[142:143], v[172:173], v[196:199]
    ds_read_b128 v[204:207], v244 offset:256
    v_permlane16_swap_b32 v248, v252
    v_mfma_f32_16x16x32_bf16 v[228:231], a[216:219], a[72:75], 0
    v_max_f32 v248, v248, v252
    v_mov_b32 v252, v248
    v_mfma_f32_16x16x16_bf16 v[200:203], v[106:107], v[172:173], v[200:203]
    v_mfma_f32_16x16x32_bf16 v[228:231], a[220:223], a[76:79], v[228:231]
    v_permlane32_swap_b32 v248, v252
    v_max_f32 v248, v248, v252
    v_mfma_f32_16x16x32_bf16 v[228:231], a[224:227], a[80:83], v[228:231]
    v_sub_f32 v208, v208, v248
    v_sub_f32 v209, v209, v248
    v_mfma_f32_16x16x32_bf16 v[228:231], a[228:231], a[84:87], v[228:231]
    v_exp_f32 v208, v208
    v_mfma_f32_16x16x32_bf16 v[228:231], a[232:235], a[88:91], v[228:231]
    v_exp_f32 v209, v209
    v_mfma_f32_16x16x32_bf16 v[228:231], a[236:239], a[92:95], v[228:231]
    v_sub_f32 v210, v210, v248
    v_sub_f32 v211, v211, v248
    v_mfma_f32_16x16x32_bf16 v[232:235], a[216:219], a[96:99], 0
    v_exp_f32 v210, v210
    v_mfma_f32_16x16x32_bf16 v[232:235], a[220:223], a[100:103], v[232:235]
    s_waitcnt lgkmcnt(0)
    v_exp_f32 v211, v211
    v_mfma_f32_16x16x32_bf16 v[204:207], v[120:123], v[168:171], v[204:207]
    v_cvt_pk_bf16_f32 v18, v228, v229
    v_cvt_pk_bf16_f32 v21, v230, v231
    v_mfma_f32_16x16x32_bf16 v[232:235], a[224:227], a[104:107], v[232:235]
    v_cvt_pk_bf16_f32 v193, v208, v209
    v_cvt_pk_bf16_f32 v180, v210, v211
    v_mfma_f32_16x16x32_bf16 v[232:235], a[228:231], a[108:111], v[232:235]
    ds_read_b128 v[208:211], v245 offset:256
    v_sub_f32 v196, v196, v248
    v_mfma_f32_16x16x16_bf16 v[204:207], v[124:125], v[172:173], v[204:207]
    v_exp_f32 v196, v196
    v_mfma_f32_16x16x32_bf16 v[232:235], a[232:235], a[112:115], v[232:235]
    v_sub_f32 v197, v197, v248
    v_sub_f32 v198, v198, v248
    v_mfma_f32_16x16x32_bf16 v[232:235], a[236:239], a[116:119], v[232:235]
    v_exp_f32 v197, v197
    v_mfma_f32_16x16x32_bf16 v[236:239], a[216:219], a[120:123], 0
    ds_read_b128 a[216:219], v242 offset:64640
    v_sub_f32 v199, v199, v248
    v_mfma_f32_16x16x32_bf16 v[236:239], a[220:223], a[124:127], v[236:239]
    ds_read_b128 a[220:223], v243 offset:64640
    v_cvt_pk_bf16_f32 v194, v196, v197
    v_mfma_f32_16x16x32_bf16 v[236:239], a[224:227], a[128:131], v[236:239]
    ds_read_b128 a[224:227], v242 offset:64768
    v_cvt_pk_bf16_f32 v48, v232, v233
    v_mfma_f32_16x16x32_bf16 v[236:239], a[228:231], a[132:135], v[236:239]
    ds_read_b128 a[228:231], v243 offset:64768
    v_cvt_pk_bf16_f32 v51, v234, v235
    v_mfma_f32_16x16x32_bf16 v[236:239], a[232:235], a[136:139], v[236:239]
    v_add_u32 v242, 0xf000, v242
    v_add_u32 v243, 0xf000, v243
    v_mfma_f32_16x16x32_bf16 v[236:239], a[236:239], a[140:143], v[236:239]
    ds_read_b128 a[232:235], v242 offset:4608
    s_waitcnt lgkmcnt(5)
    v_sub_f32 v200, v200, v248
    v_mfma_f32_16x16x32_bf16 v[208:211], v[144:147], v[168:171], v[208:211]
    ds_read_b128 a[236:239], v243 offset:4608
    v_sub_f32 v201, v201, v248
    v_mfma_f32_16x16x32_bf16 v[228:231], a[144:147], a[240:243], 0
    v_exp_f32 v198, v198
    v_mfma_f32_16x16x32_bf16 v[228:231], a[148:151], a[244:247], v[228:231]
    v_cvt_pk_bf16_f32 v78, v236, v237
    v_cvt_pk_bf16_f32 v81, v238, v239
    v_mfma_f32_16x16x16_bf16 v[208:211], v[148:149], v[172:173], v[208:211]
    s_waitcnt lgkmcnt(5)
    v_exp_f32 v199, v199
    v_mfma_f32_16x16x32_bf16 v[228:231], a[152:155], a[216:219], v[228:231]
    s_waitcnt lgkmcnt(4)
    v_cvt_pk_bf16_f32 v181, v198, v199
    v_sub_f32 v202, v202, v248
    v_mfma_f32_16x16x32_bf16 v[228:231], a[156:159], a[220:223], v[228:231]
    ds_read_b128 v[196:199], v246 offset:256
    s_waitcnt lgkmcnt(3)
    v_sub_f32 v203, v203, v248
    v_mfma_f32_16x16x32_bf16 v[228:231], a[160:163], a[224:227], v[228:231]
    v_exp_f32 v200, v200
    v_mfma_f32_16x16x32_bf16 v[228:231], a[164:167], a[228:231], v[228:231]
    v_exp_f32 v201, v201
    v_mfma_f32_16x16x32_bf16 v[232:235], a[168:171], a[240:243], 0
    v_exp_f32 v202, v202
    v_mfma_f32_16x16x32_bf16 v[232:235], a[172:175], a[244:247], v[232:235]
    v_exp_f32 v203, v203
    v_mfma_f32_16x16x32_bf16 v[232:235], a[176:179], a[216:219], v[232:235]
    v_cvt_pk_bf16_f32 v192, v200, v201
    v_cvt_pk_bf16_f32 v195, v202, v203
    v_mfma_f32_16x16x32_bf16 v[232:235], a[180:183], a[220:223], v[232:235]
    ds_read_b128 v[200:203], v244 offset:320
    v_mul_f32 v228, s38, v228
    v_mfma_f32_16x16x32_bf16 v[212:215], v[0:3], v[192:195], 0
    v_mul_f32 v229, s38, v229
    v_mul_f32 v230, s38, v230
    v_mfma_f32_16x16x32_bf16 v[216:219], v[30:33], v[192:195], 0
    v_mul_f32 v231, s38, v231
    v_cvt_pk_bf16_f32 v228, v228, v229
    v_mfma_f32_16x16x32_bf16 v[220:223], v[60:63], v[192:195], 0
    s_waitcnt lgkmcnt(1)
    v_cvt_pk_bf16_f32 v229, v230, v231
    v_sub_f32 v204, v204, v248
    v_mfma_f32_16x16x32_bf16 v[224:227], a[248:251], v[192:195], 0
    ds_write_b64 v247, v[228:229] offset:39936
    v_mfma_f32_16x16x32_bf16 v[196:199], v[108:111], v[168:171], v[196:199]
    v_exp_f32 v204, v204
    v_mfma_f32_16x16x32_bf16 v[232:235], a[184:187], a[224:227], v[232:235]
    v_sub_f32 v205, v205, v248
    v_sub_f32 v206, v206, v248
    v_mfma_f32_16x16x32_bf16 v[232:235], a[188:191], a[228:231], v[232:235]
    v_exp_f32 v205, v205
    v_mfma_f32_16x16x16_bf16 v[196:199], v[112:113], v[172:173], v[196:199]
    s_waitcnt lgkmcnt(1)
    v_exp_f32 v206, v206
    v_mfma_f32_16x16x32_bf16 v[200:203], v[126:129], v[168:171], v[200:203]
    v_sub_f32 v207, v207, v248
    v_cvt_pk_bf16_f32 v183, v204, v205
    v_mfma_f32_16x16x32_bf16 v[236:239], a[192:195], a[240:243], 0
    ds_read_b128 a[240:243], v242 offset:4736
    v_mul_f32 v232, s38, v232
    v_mfma_f32_16x16x32_bf16 v[236:239], a[196:199], a[244:247], v[236:239]
    ds_read_b128 a[244:247], v243 offset:4736
    v_mul_f32 v233, s38, v233
    v_mfma_f32_16x16x16_bf16 v[200:203], v[130:131], v[172:173], v[200:203]
    v_mul_f32 v234, s38, v234
    v_mul_f32 v235, s38, v235
    v_mfma_f32_16x16x32_bf16 v[236:239], a[200:203], a[216:219], v[236:239]
    ds_read_b128 a[216:219], v242 offset:4864
    v_cvt_pk_bf16_f32 v232, v232, v233
    v_mfma_f32_16x16x32_bf16 v[236:239], a[204:207], a[220:223], v[236:239]
    ds_read_b128 a[220:223], v243 offset:4864
    v_cvt_pk_bf16_f32 v233, v234, v235
    v_mfma_f32_16x16x32_bf16 v[236:239], a[208:211], a[224:227], v[236:239]
    ds_write_b64 v247, v[232:233] offset:39968
    v_mfma_f32_16x16x32_bf16 v[236:239], a[212:215], a[228:231], v[236:239]
    ds_read_b128 a[224:227], v240 offset:36864
    v_sub_f32 v208, v208, v248
    v_mfma_f32_16x16x32_bf16 v[228:231], a[144:147], a[232:235], 0
    ds_read_b128 a[228:231], v241 offset:36864
    v_sub_f32 v209, v209, v248
    v_mfma_f32_16x16x32_bf16 v[228:231], a[148:151], a[236:239], v[228:231]
    s_waitcnt lgkmcnt(6)
    v_exp_f32 v207, v207
    v_mfma_f32_16x16x32_bf16 v[228:231], a[152:155], a[240:243], v[228:231]
    s_waitcnt lgkmcnt(5)
    v_mul_f32 v236, s38, v236
    v_mul_f32 v237, s38, v237
    v_mfma_f32_16x16x32_bf16 v[228:231], a[156:159], a[244:247], v[228:231]
    v_mul_f32 v238, s38, v238
    v_mul_f32 v239, s38, v239
    v_mfma_f32_16x16x32_bf16 v[232:235], a[168:171], a[232:235], 0
    s_waitcnt lgkmcnt(4)
    v_cvt_pk_bf16_f32 v236, v236, v237
    v_cvt_pk_bf16_f32 v237, v238, v239
    v_mfma_f32_16x16x32_bf16 v[228:231], a[160:163], a[216:219], v[228:231]
    ds_write_b64 v247, v[236:237] offset:40000
    v_mfma_f32_16x16x32_bf16 v[232:235], a[172:175], a[236:239], v[232:235]
    s_waitcnt lgkmcnt(3)
    v_cvt_pk_bf16_f32 v186, v206, v207
    v_sub_f32 v210, v210, v248
    v_mfma_f32_16x16x32_bf16 v[228:231], a[164:167], a[220:223], v[228:231]
    ds_read_b128 v[204:207], v245 offset:320
    v_sub_f32 v211, v211, v248
    v_mfma_f32_16x16x32_bf16 v[232:235], a[176:179], a[240:243], v[232:235]
    v_exp_f32 v208, v208
    v_mfma_f32_16x16x32_bf16 v[232:235], a[180:183], a[244:247], v[232:235]
    v_exp_f32 v209, v209
    v_mfma_f32_16x16x32_bf16 v[232:235], a[184:187], a[216:219], v[232:235]
    v_exp_f32 v210, v210
    v_mfma_f32_16x16x32_bf16 v[232:235], a[188:191], a[220:223], v[232:235]
    v_mul_f32 v228, s38, v228
    v_mul_f32 v229, s38, v229
    v_mfma_f32_16x16x32_bf16 v[236:239], a[192:195], a[232:235], 0
    ds_read_b128 a[232:235], v240 offset:36992
    v_mul_f32 v230, s38, v230
    v_mfma_f32_16x16x32_bf16 v[236:239], a[196:199], a[236:239], v[236:239]
    ds_read_b128 a[236:239], v241 offset:36992
    v_mul_f32 v231, s38, v231
    v_mfma_f32_16x16x32_bf16 v[236:239], a[200:203], a[240:243], v[236:239]
    ds_read_b128 a[240:243], v240 offset:37120
    v_cvt_pk_bf16_f32 v228, v228, v229
    v_mfma_f32_16x16x32_bf16 v[236:239], a[204:207], a[244:247], v[236:239]
    ds_read_b128 a[244:247], v241 offset:37120
    s_waitcnt lgkmcnt(4)
    v_cvt_pk_bf16_f32 v229, v230, v231
    v_mfma_f32_16x16x32_bf16 v[204:207], v[150:153], v[168:171], v[204:207]
    ds_write_b64 v247, v[228:229] offset:46592
    v_mfma_f32_16x16x32_bf16 v[236:239], a[208:211], a[216:219], v[236:239]
    v_mul_f32 v232, s38, v232
    v_mul_f32 v233, s38, v233
    v_mfma_f32_16x16x32_bf16 v[236:239], a[212:215], a[220:223], v[236:239]
    v_mul_f32 v234, s38, v234
    v_mul_f32 v235, s38, v235
    v_mfma_f32_16x16x16_bf16 v[204:207], v[154:155], v[172:173], v[204:207]
    v_cvt_pk_bf16_f32 v232, v232, v233
    v_cvt_pk_bf16_f32 v233, v234, v235
    v_mfma_f32_16x16x32_bf16 v[228:231], a[0:3], a[224:227], 0
    ds_write_b64 v247, v[232:233] offset:46624
    v_mfma_f32_16x16x32_bf16 v[228:231], a[4:7], a[228:231], v[228:231]
    s_waitcnt lgkmcnt(4)
    v_mul_f32 v236, s38, v236
    v_mul_f32 v237, s38, v237
    v_mfma_f32_16x16x32_bf16 v[228:231], a[8:11], a[232:235], v[228:231]
    v_mul_f32 v238, s38, v238
    v_mul_f32 v239, s38, v239
    v_mfma_f32_16x16x32_bf16 v[228:231], a[12:15], a[236:239], v[228:231]
    s_waitcnt vmcnt(0) lgkmcnt(2)
    v_cvt_pk_bf16_f32 v236, v236, v237
    v_cvt_pk_bf16_f32 v237, v238, v239
    v_mfma_f32_16x16x32_bf16 v[228:231], a[16:19], a[240:243], v[228:231]
    ds_write_b64 v247, v[236:237] offset:46656
    v_mfma_f32_16x16x32_bf16 v[228:231], a[20:23], a[244:247], v[228:231]
    s_barrier
    v_add_u32 v240, 0xffff1000, v240
    v_add_u32 v241, 0xffff1000, v241
    v_mfma_f32_16x16x32_bf16 v[232:235], a[24:27], a[224:227], 0
    v_exp_f32 v211, v211
    v_mfma_f32_16x16x32_bf16 v[232:235], a[28:31], a[228:231], v[232:235]
    v_cvt_pk_bf16_f32 v184, v208, v209
    v_cvt_pk_bf16_f32 v187, v210, v211
    v_mfma_f32_16x16x32_bf16 v[232:235], a[32:35], a[232:235], v[232:235]
    ds_read_b128 v[208:211], v246 offset:320
    v_sub_f32 v196, v196, v248
    v_mfma_f32_16x16x32_bf16 v[232:235], a[36:39], a[236:239], v[232:235]
    v_exp_f32 v196, v196
    v_mfma_f32_16x16x32_bf16 v[232:235], a[40:43], a[240:243], v[232:235]
    v_sub_f32 v197, v197, v248
    v_sub_f32 v198, v198, v248
    v_mfma_f32_16x16x32_bf16 v[232:235], a[44:47], a[244:247], v[232:235]
    v_exp_f32 v197, v197
    v_mfma_f32_16x16x32_bf16 v[236:239], a[48:51], a[224:227], 0
    v_exp_f32 v198, v198
    v_mfma_f32_16x16x32_bf16 v[236:239], a[52:55], a[228:231], v[236:239]
    v_sub_f32 v199, v199, v248
    v_cvt_pk_bf16_f32 v182, v196, v197
    v_mfma_f32_16x16x32_bf16 v[236:239], a[56:59], a[232:235], v[236:239]
    v_exp_f32 v199, v199
    v_mfma_f32_16x16x32_bf16 v[212:215], v[4:7], v[180:183], v[212:215]
    v_cvt_pk_bf16_f32 v185, v198, v199
    v_sub_f32 v200, v200, v248
    v_mfma_f32_16x16x32_bf16 v[216:219], v[34:37], v[180:183], v[216:219]
    ds_read_b128 v[196:199], v244 offset:0
    s_waitcnt lgkmcnt(1)
    v_sub_f32 v201, v201, v248
    v_mfma_f32_16x16x32_bf16 v[220:223], v[64:67], v[180:183], v[220:223]
    v_exp_f32 v200, v200
    v_mfma_f32_16x16x32_bf16 v[224:227], a[248:251], v[180:183], v[224:227]
    v_exp_f32 v201, v201
    v_mfma_f32_16x16x32_bf16 v[212:215], v[8:11], v[184:187], v[212:215]
    v_cvt_pk_bf16_f32 v189, v200, v201
    v_sub_f32 v204, v204, v248
    v_mfma_f32_16x16x32_bf16 v[216:219], v[38:41], v[184:187], v[216:219]
    ds_read_b128 v[200:203], v245 offset:0
    v_sub_f32 v205, v205, v248
    v_mfma_f32_16x16x32_bf16 v[220:223], v[68:71], v[184:187], v[220:223]
    v_exp_f32 v204, v204
    v_mfma_f32_16x16x32_bf16 v[224:227], a[248:251], v[184:187], v[224:227]
    v_exp_f32 v205, v205
    v_mfma_f32_16x16x32_bf16 v[208:211], v[162:165], v[168:171], v[208:211]
    ds_read_b64 v[168:169], v247 offset:19968
    v_cvt_pk_bf16_f32 v190, v204, v205
    v_mfma_f32_16x16x32_bf16 v[236:239], a[60:63], a[236:239], v[236:239]
    ds_read_b128 v[204:207], v246 offset:0
    s_waitcnt lgkmcnt(3)
    v_mfma_f32_16x16x32_bf16 v[196:199], v[120:123], v[174:177], v[196:199]
    ds_read_b64 v[170:171], v247 offset:20000
    v_mfma_f32_16x16x16_bf16 v[208:211], v[166:167], v[172:173], v[208:211]
    ds_read_b64 v[172:173], v247 offset:20032
    v_mfma_f32_16x16x32_bf16 v[236:239], a[64:67], a[240:243], v[236:239]
    v_mfma_f32_16x16x32_bf16 v[236:239], a[68:71], a[244:247], v[236:239]
    s_nop 0
    s_waitcnt lgkmcnt(4)
    v_mfma_f32_16x16x16_bf16 v[196:199], v[124:125], v[178:179], v[196:199]
    v_mfma_f32_16x16x32_bf16 v[200:203], v[144:147], v[174:177], v[200:203]
    s_nop 0
    v_sub_f32 v208, v208, v248
    v_sub_f32 v209, v209, v248
    v_exp_f32 v208, v208
    v_exp_f32 v209, v209
    s_nop 0
    v_mfma_f32_16x16x16_bf16 v[200:203], v[148:149], v[178:179], v[200:203]
    s_waitcnt lgkmcnt(2)
    v_cvt_pk_bf16_f32 v188, v208, v209
    v_max_f32 v248, v196, v197
    v_mfma_f32_16x16x32_bf16 v[204:207], v[108:111], v[174:177], v[204:207]
    ds_read_b128 v[208:211], v244 offset:64
    v_max3_f32 v248, v248, v198, v199
    v_mfma_f32_16x16x32_bf16 v[212:215], v[12:15], v[188:191], v[212:215]
    ds_read_b128 v[196:199], v245 offset:64
    v_max3_f32 v248, v248, v200, v201
    v_mfma_f32_16x16x32_bf16 v[216:219], v[42:45], v[188:191], v[216:219]
    v_max3_f32 v248, v248, v202, v203
    v_mfma_f32_16x16x32_bf16 v[220:223], v[72:75], v[188:191], v[220:223]
    ds_read_b128 v[200:203], v246 offset:64
    v_mfma_f32_16x16x32_bf16 v[224:227], a[248:251], v[188:191], v[224:227]
    v_mfma_f32_16x16x16_bf16 v[204:207], v[112:113], v[178:179], v[204:207]
    s_nop 6
    v_rcp_f32 v252, v224
    v_max3_f32 v248, v248, v204, v205
    v_mul_f32 v212, v212, v252
    v_mul_f32 v213, v213, v252
    v_mul_f32 v214, v214, v252
    v_mul_f32 v215, v215, v252
    v_cvt_pk_bf16_f32 v212, v212, v213
    v_cvt_pk_bf16_f32 v213, v214, v215
    ds_write_b64 v247, v[212:213] offset:6656
    s_waitcnt lgkmcnt(2)
    v_mfma_f32_16x16x32_bf16 v[208:211], v[126:129], v[174:177], v[208:211]
    v_mul_f32 v216, v216, v252
    v_mul_f32 v217, v217, v252
    v_mfma_f32_16x16x32_bf16 v[196:199], v[150:153], v[174:177], v[196:199]
    s_waitcnt lgkmcnt(1)
    v_mul_f32 v218, v218, v252
    v_mul_f32 v219, v219, v252
    v_mfma_f32_16x16x16_bf16 v[208:211], v[130:131], v[178:179], v[208:211]
    v_cvt_pk_bf16_f32 v216, v216, v217
    v_cvt_pk_bf16_f32 v217, v218, v219
    v_mfma_f32_16x16x16_bf16 v[196:199], v[154:155], v[178:179], v[196:199]
    ds_write_b64 v247, v[216:217] offset:6688
    v_mfma_f32_16x16x32_bf16 v[200:203], v[162:165], v[174:177], v[200:203]
    v_mul_f32 v220, v220, v252
    v_mul_f32 v221, v221, v252
    v_mul_f32 v222, v222, v252
    v_mul_f32 v223, v223, v252
    v_cvt_pk_bf16_f32 v220, v220, v221
    v_cvt_pk_bf16_f32 v221, v222, v223
    v_mfma_f32_16x16x16_bf16 v[200:203], v[166:167], v[178:179], v[200:203]
    ds_write_b64 v247, v[220:221] offset:6720
    v_max3_f32 v248, v248, v206, v207
    ds_read_b128 v[204:207], v244 offset:128
    v_max3_f32 v248, v248, v208, v209
    v_max3_f32 v248, v248, v210, v211
    ds_read_b128 v[208:211], v245 offset:128
    v_max3_f32 v248, v248, v196, v197
    v_max3_f32 v248, v248, v198, v199
    ds_read_b128 v[196:199], v246 offset:128
    v_max3_f32 v248, v248, v200, v201
    v_max3_f32 v248, v248, v202, v203
    ds_read_b128 v[200:203], v244 offset:0
    s_waitcnt lgkmcnt(3)
    v_mfma_f32_16x16x32_bf16 v[204:207], v[132:135], v[174:177], v[204:207]
    s_nop 5
    v_mfma_f32_16x16x16_bf16 v[204:207], v[136:137], v[178:179], v[204:207]
    s_waitcnt lgkmcnt(2)
    s_waitcnt lgkmcnt(1)
    v_mfma_f32_16x16x32_bf16 v[208:211], v[156:159], v[174:177], v[208:211]
    v_mfma_f32_16x16x32_bf16 v[196:199], v[114:117], v[174:177], v[196:199]
    s_waitcnt lgkmcnt(0)
    v_mfma_f32_16x16x32_bf16 v[200:203], v[120:123], v[174:177], v[200:203]
    v_cvt_pk_bf16_f32 v120, v228, v229
    v_cvt_pk_bf16_f32 v121, v230, v231
    v_mfma_f32_16x16x32_bf16 v[228:231], a[224:227], a[72:75], 0
    v_cvt_pk_bf16_f32 v122, v232, v233
    v_cvt_pk_bf16_f32 v123, v234, v235
    v_mfma_f32_16x16x16_bf16 v[208:211], v[160:161], v[178:179], v[208:211]
    v_max3_f32 v248, v248, v204, v205
    v_mfma_f32_16x16x16_bf16 v[196:199], v[118:119], v[178:179], v[196:199]
    ds_read_b128 v[204:207], v245 offset:0
    v_mfma_f32_16x16x16_bf16 v[200:203], v[124:125], v[178:179], v[200:203]
    v_cvt_pk_bf16_f32 v124, v236, v237
    v_cvt_pk_bf16_f32 v125, v238, v239
    v_mfma_f32_16x16x32_bf16 v[228:231], a[228:231], a[76:79], v[228:231]
    v_mfma_f32_16x16x32_bf16 v[228:231], a[232:235], a[80:83], v[228:231]
    v_max3_f32 v248, v248, v208, v209
    v_mfma_f32_16x16x32_bf16 v[228:231], a[236:239], a[84:87], v[228:231]
    ds_read_b128 v[208:211], v246 offset:0
    v_max3_f32 v248, v248, v196, v197
    v_mfma_f32_16x16x32_bf16 v[228:231], a[240:243], a[88:91], v[228:231]
    ds_read_b128 v[196:199], v244 offset:64
    v_mov_b32 v252, v248
    v_mfma_f32_16x16x32_bf16 v[228:231], a[244:247], a[92:95], v[228:231]
    v_mfma_f32_16x16x32_bf16 v[232:235], a[224:227], a[96:99], 0
    v_permlane16_swap_b32 v248, v252
    v_max_f32 v248, v248, v252
    v_mfma_f32_16x16x32_bf16 v[232:235], a[228:231], a[100:103], v[232:235]
    v_mov_b32 v252, v248
    s_waitcnt lgkmcnt(2)
    v_mfma_f32_16x16x32_bf16 v[204:207], v[144:147], v[174:177], v[204:207]
    v_permlane32_swap_b32 v248, v252
    v_cvt_pk_bf16_f32 v24, v228, v229
    v_mfma_f32_16x16x32_bf16 v[232:235], a[232:235], a[104:107], v[232:235]
    v_cvt_pk_bf16_f32 v27, v230, v231
    v_mbcnt_lo_u32_b32 v228, -1, 0
    v_mfma_f32_16x16x32_bf16 v[232:235], a[236:239], a[108:111], v[232:235]
    v_mbcnt_hi_u32_b32 v228, -1, v228
    v_lshrrev_b32 v229, 4, v228
    v_mfma_f32_16x16x16_bf16 v[204:207], v[148:149], v[178:179], v[204:207]
    v_bfe_u32 v230, v228, 2, 1
    v_add_u32 v230, 15, v230
    v_mfma_f32_16x16x32_bf16 v[232:235], a[240:243], a[112:115], v[232:235]
    s_waitcnt lgkmcnt(1)
    v_and_b32 v230, 15, v230
    v_bfe_u32 v231, v228, 3, 1
    v_mfma_f32_16x16x32_bf16 v[208:211], v[108:111], v[174:177], v[208:211]
    s_waitcnt lgkmcnt(0)
    v_and_b32 v228, 3, v228
    v_lshl_add_u32 v228, v231, 2, v228
    v_mfma_f32_16x16x32_bf16 v[196:199], v[126:129], v[174:177], v[196:199]
    v_add_u32 v228, 3, v228
    v_and_b32 v231, 3, v230
    v_mfma_f32_16x16x16_bf16 v[208:211], v[112:113], v[178:179], v[208:211]
    v_mul_u32_u24 v230, 0x1e00, v230
    v_lshlrev_b32 v231, 1, v231
    v_mfma_f32_16x16x32_bf16 v[232:235], a[244:247], a[116:119], v[232:235]
    v_bfe_u32 v243, v228, 1, 1
    v_or_b32 v231, v231, v243
    v_mfma_f32_16x16x16_bf16 v[196:199], v[130:131], v[178:179], v[196:199]
    v_xor_b32 v231, v231, v229
    v_lshl_add_u32 v230, v231, 4, v230
    v_mfma_f32_16x16x32_bf16 v[236:239], a[224:227], a[120:123], 0
    v_mul_u32_u24 v231, 0x180, v228
    v_add_u32 v242, v230, v231
    v_mfma_f32_16x16x32_bf16 v[236:239], a[228:231], a[124:127], v[236:239]
    ds_read_b128 a[216:219], v242 offset:0
    v_cvt_pk_bf16_f32 v54, v232, v233
    v_mfma_f32_16x16x32_bf16 v[236:239], a[232:235], a[128:131], v[236:239]
    ds_read_b128 a[224:227], v242 offset:128
    v_cvt_pk_bf16_f32 v57, v234, v235
    v_mfma_f32_16x16x32_bf16 v[236:239], a[236:239], a[132:135], v[236:239]
    ds_read_b128 a[232:235], v242 offset:256
    v_xor_b32 v243, 64, v242
    v_mfma_f32_16x16x32_bf16 v[236:239], a[240:243], a[136:139], v[236:239]
    ds_read_b128 a[220:223], v243 offset:0
    v_max_f32 v248, v248, v252
    v_mfma_f32_16x16x32_bf16 v[236:239], a[244:247], a[140:143], v[236:239]
    ds_read_b128 a[228:231], v243 offset:128
    ds_read_b128 a[236:239], v243 offset:256
    ds_read_b128 a[240:243], v242 offset:3072
    ds_read_b128 a[244:247], v243 offset:3072
    v_sub_f32 v200, v200, v248
    v_exp_f32 v200, v200
    v_sub_f32 v201, v201, v248
    v_exp_f32 v201, v201
    v_cvt_pk_bf16_f32 v84, v236, v237
    v_cvt_pk_bf16_f32 v87, v238, v239
    v_sub_f32 v202, v202, v248
    v_exp_f32 v202, v202
    v_sub_f32 v203, v203, v248
    v_exp_f32 v203, v203
    v_cvt_pk_bf16_f32 v193, v200, v201
    v_cvt_pk_bf16_f32 v180, v202, v203
    ds_read_b128 v[200:203], v245 offset:64
    s_waitcnt lgkmcnt(7)
    v_mfma_f32_16x16x32_bf16 v[232:235], a[144:147], a[216:219], 0
    v_sub_f32 v204, v204, v248
    v_sub_f32 v205, v205, v248
    v_mfma_f32_16x16x32_bf16 v[236:239], a[168:171], a[216:219], 0
    s_waitcnt lgkmcnt(5)
    v_exp_f32 v204, v204
    v_mfma_f32_16x16x32_bf16 v[232:235], a[148:151], a[220:223], v[232:235]
    v_exp_f32 v205, v205
    v_mfma_f32_16x16x32_bf16 v[232:235], a[152:155], a[224:227], v[232:235]
    s_waitcnt lgkmcnt(2)
    v_sub_f32 v206, v206, v248
    v_sub_f32 v207, v207, v248
    v_mfma_f32_16x16x32_bf16 v[232:235], a[156:159], a[228:231], v[232:235]
    v_exp_f32 v206, v206
    v_mfma_f32_16x16x32_bf16 v[232:235], a[160:163], a[232:235], v[232:235]
    v_exp_f32 v207, v207
    v_mfma_f32_16x16x32_bf16 v[232:235], a[164:167], a[236:239], v[232:235]
    v_cvt_pk_bf16_f32 v194, v204, v205
    v_cvt_pk_bf16_f32 v181, v206, v207
    v_mfma_f32_16x16x32_bf16 v[236:239], a[172:175], a[220:223], v[236:239]
    ds_read_b128 v[204:207], v246 offset:64
    v_sub_f32 v208, v208, v248
    v_mfma_f32_16x16x32_bf16 v[236:239], a[176:179], a[224:227], v[236:239]
    s_waitcnt lgkmcnt(1)
    v_exp_f32 v208, v208
    v_mfma_f32_16x16x32_bf16 v[200:203], v[150:153], v[174:177], v[200:203]
    v_mul_f32 v232, s38, v232
    v_mul_f32 v233, s38, v233
    v_mfma_f32_16x16x32_bf16 v[236:239], a[180:183], a[228:231], v[236:239]
    v_mul_f32 v234, s38, v234
    v_mul_f32 v235, s38, v235
    v_mfma_f32_16x16x32_bf16 v[236:239], a[184:187], a[232:235], v[236:239]
    v_cvt_pk_bf16_f32 v232, v232, v233
    v_cvt_pk_bf16_f32 v233, v234, v235
    v_mfma_f32_16x16x16_bf16 v[200:203], v[154:155], v[178:179], v[200:203]
    ds_write_b64 v247, v[232:233] offset:53248
    v_mfma_f32_16x16x32_bf16 v[236:239], a[188:191], a[236:239], v[236:239]
    v_sub_f32 v209, v209, v248
    v_sub_f32 v210, v210, v248
    v_mfma_f32_16x16x32_bf16 v[228:231], a[192:195], a[216:219], 0
    ds_read_b128 a[216:219], v242 offset:3200
    v_sub_f32 v211, v211, v248
    v_mfma_f32_16x16x32_bf16 v[228:231], a[196:199], a[220:223], v[228:231]
    ds_read_b128 a[220:223], v243 offset:3200
    s_waitcnt lgkmcnt(3)
    v_mul_f32 v236, s38, v236
    v_mfma_f32_16x16x32_bf16 v[204:207], v[162:165], v[174:177], v[204:207]
    v_mul_f32 v237, s38, v237
    v_mul_f32 v238, s38, v238
    v_mfma_f32_16x16x32_bf16 v[228:231], a[200:203], a[224:227], v[228:231]
    ds_read_b128 a[224:227], v242 offset:3328
    v_mul_f32 v239, s38, v239
    v_mfma_f32_16x16x32_bf16 v[228:231], a[204:207], a[228:231], v[228:231]
    ds_read_b128 a[228:231], v243 offset:3328
    v_cvt_pk_bf16_f32 v236, v236, v237
    v_mfma_f32_16x16x16_bf16 v[204:207], v[166:167], v[178:179], v[204:207]
    v_cvt_pk_bf16_f32 v237, v238, v239
    v_sub_f32 v196, v196, v248
    v_mfma_f32_16x16x32_bf16 v[228:231], a[208:211], a[232:235], v[228:231]
    ds_write_b64 v247, v[236:237] offset:53280
    v_mfma_f32_16x16x32_bf16 v[228:231], a[212:215], a[236:239], v[228:231]
    ds_read_b128 a[232:235], v240 offset:0
    v_sub_f32 v197, v197, v248
    v_mfma_f32_16x16x32_bf16 v[232:235], a[144:147], a[240:243], 0
    buffer_load_dwordx4 a[144:147], v254, s[24:27], s64 offen
    s_mov_b32 s64, 0x4000
    v_sub_f32 v198, v198, v248
    v_mfma_f32_16x16x32_bf16 v[232:235], a[148:151], a[244:247], v[232:235]
    buffer_load_dwordx4 a[148:151], v254, s[24:27], s65 offen offset:1024
    s_mov_b32 s65, 0x4000
    v_mul_f32 v228, s38, v228
    v_mfma_f32_16x16x32_bf16 v[236:239], a[168:171], a[240:243], 0
    buffer_load_dwordx4 a[168:171], v254, s[24:27], s54 offen offset:2048
    s_mul_i32 s54, s30, 0
    v_mul_f32 v229, s38, v229
    v_mfma_f32_16x16x32_bf16 v[236:239], a[172:175], a[244:247], v[236:239]
    s_waitcnt lgkmcnt(3)
    v_mul_f32 v230, s38, v230
    v_mul_f32 v231, s38, v231
    v_mfma_f32_16x16x32_bf16 v[232:235], a[152:155], a[216:219], v[232:235]
    buffer_load_dwordx4 a[152:155], v254, s[24:27], s50 offen offset:2048
    s_mul_i32 s50, s30, 3
    v_cvt_pk_bf16_f32 v228, v228, v229
    v_mfma_f32_16x16x32_bf16 v[232:235], a[156:159], a[220:223], v[232:235]
    buffer_load_dwordx4 a[156:159], v254, s[24:27], s51 offen offset:3072
    s_mul_i32 s51, s31, 3
    v_cvt_pk_bf16_f32 v229, v230, v231
    v_mfma_f32_16x16x32_bf16 v[232:235], a[160:163], a[224:227], v[232:235]
    ds_write_b64 v247, v[228:229] offset:53312
    v_mfma_f32_16x16x32_bf16 v[236:239], a[176:179], a[216:219], v[236:239]
    buffer_load_dwordx4 a[160:163], v254, s[24:27], s52 offen
    s_add_u32 s50, s50, s51
    v_sub_f32 v199, v199, v248
    v_mfma_f32_16x16x32_bf16 v[236:239], a[180:183], a[220:223], v[236:239]
    buffer_load_dwordx4 a[172:175], v254, s[24:27], s55 offen offset:3072
    s_add_u32 s50, s50, s32
    v_sub_f32 v200, v200, v248
    v_mfma_f32_16x16x32_bf16 v[236:239], a[184:187], a[224:227], v[236:239]
    buffer_load_dwordx4 a[176:179], v254, s[24:27], s56 offen
    s_add_u32 s50, s50, s39
    v_sub_f32 v201, v201, v248
    v_mfma_f32_16x16x32_bf16 v[228:231], a[192:195], a[240:243], 0
    buffer_load_dwordx4 a[180:183], v254, s[24:27], s57 offen offset:1024
    s_mul_i32 s52, s30, 0
    v_sub_f32 v202, v202, v248
    v_mfma_f32_16x16x32_bf16 v[228:231], a[196:199], a[244:247], v[228:231]
    ds_read_b128 a[236:239], v241 offset:0
    s_mul_i32 s55, s31, 4
    v_sub_f32 v203, v203, v248
    v_mfma_f32_16x16x32_bf16 v[228:231], a[200:203], a[216:219], v[228:231]
    ds_read_b128 a[240:243], v240 offset:128
    s_add_u32 s54, s54, s55
    v_sub_f32 v204, v204, v248
    v_mfma_f32_16x16x32_bf16 v[228:231], a[204:207], a[220:223], v[228:231]
    ds_read_b128 a[244:247], v241 offset:128
    s_mul_i32 s56, s30, 3
    v_sub_f32 v205, v205, v248
    v_mfma_f32_16x16x32_bf16 v[228:231], a[208:211], a[224:227], v[228:231]
    s_waitcnt lgkmcnt(3)
    v_exp_f32 v209, v209
    v_mfma_f32_16x16x32_bf16 v[232:235], a[164:167], a[228:231], v[232:235]
    ds_read_b128 a[216:219], v240 offset:256
    s_mul_i32 s57, s31, 15
    v_cvt_pk_bf16_f32 v192, v208, v209
    v_mfma_f32_16x16x32_bf16 v[236:239], a[188:191], a[228:231], v[236:239]
    ds_read_b128 a[220:223], v241 offset:256
    s_add_u32 s56, s56, s57
    v_sub_f32 v206, v206, v248
    v_mfma_f32_16x16x32_bf16 v[228:231], a[212:215], a[228:231], v[228:231]
    ds_read_b128 a[224:227], v249 offset:0
    ds_read_b128 a[228:231], v249 offset:64
    s_add_u32 s56, s56, s32
    v_mul_f32 v232, s38, v232
    v_mul_f32 v233, s38, v233
    v_mul_f32 v234, s38, v234
    v_mul_f32 v235, s38, v235
    v_cvt_pk_bf16_f32 v232, v232, v233
    v_cvt_pk_bf16_f32 v233, v234, v235
    ds_write_b64 v247, v[232:233] offset:59904
    v_mfma_f32_16x16x32_bf16 v[232:235], a[0:3], a[232:235], 0
    s_waitcnt lgkmcnt(6)
    v_mul_f32 v236, s38, v236
    v_mul_f32 v237, s38, v237
    v_mfma_f32_16x16x32_bf16 v[232:235], a[4:7], a[236:239], v[232:235]
    s_add_u32 s56, s56, s39
    v_mul_f32 v238, s38, v238
    v_mul_f32 v239, s38, v239
    v_mfma_f32_16x16x32_bf16 v[232:235], a[8:11], a[240:243], v[232:235]
    s_waitcnt lgkmcnt(5)
    v_cvt_pk_bf16_f32 v236, v236, v237
    v_cvt_pk_bf16_f32 v237, v238, v239
    v_mfma_f32_16x16x32_bf16 v[232:235], a[12:15], a[244:247], v[232:235]
    s_waitcnt lgkmcnt(4)
    v_mul_f32 v228, s38, v228
    v_mul_f32 v229, s38, v229
    v_mfma_f32_16x16x32_bf16 v[232:235], a[16:19], a[216:219], v[232:235]
    s_waitcnt lgkmcnt(3)
    v_mul_f32 v230, s38, v230
    v_mul_f32 v231, s38, v231
    v_mfma_f32_16x16x32_bf16 v[232:235], a[20:23], a[220:223], v[232:235]
    ds_write_b64 v247, v[236:237] offset:59936
    v_mfma_f32_16x16x32_bf16 v[236:239], a[24:27], a[232:235], 0
    s_mul_i32 s51, s31, 4
    v_cvt_pk_bf16_f32 v228, v228, v229
    v_cvt_pk_bf16_f32 v229, v230, v231
    v_mfma_f32_16x16x32_bf16 v[236:239], a[28:31], a[236:239], v[236:239]
    ds_write_b64 v247, v[228:229] offset:59968
    v_mfma_f32_16x16x32_bf16 v[236:239], a[32:35], a[240:243], v[236:239]
    s_mul_i32 s55, s31, 15
    v_exp_f32 v210, v210
    v_mfma_f32_16x16x32_bf16 v[236:239], a[36:39], a[244:247], v[236:239]
    s_mul_i32 s57, s31, 3
    v_exp_f32 v211, v211
    v_mfma_f32_16x16x32_bf16 v[236:239], a[40:43], a[216:219], v[236:239]
    v_cvt_pk_bf16_f32 v195, v210, v211
    v_sub_f32 v207, v207, v248
    v_mfma_f32_16x16x32_bf16 v[236:239], a[44:47], a[220:223], v[236:239]
    ds_read_b128 v[208:211], v244 offset:128
    v_mfma_f32_16x16x32_bf16 v[212:215], v[6:9], v[192:195], 0
    v_exp_f32 v196, v196
    v_mfma_f32_16x16x32_bf16 v[216:219], v[36:39], v[192:195], 0
    v_exp_f32 v197, v197
    v_mfma_f32_16x16x32_bf16 v[220:223], v[66:69], v[192:195], 0
    v_exp_f32 v198, v198
    v_mfma_f32_16x16x32_bf16 v[224:227], a[248:251], v[192:195], 0
    v_exp_f32 v199, v199
    v_mfma_f32_16x16x32_bf16 v[228:231], a[48:51], a[232:235], 0
    v_cvt_pk_bf16_f32 v183, v196, v197
    v_cvt_pk_bf16_f32 v186, v198, v199
    v_mfma_f32_16x16x32_bf16 v[228:231], a[52:55], a[236:239], v[228:231]
    ds_read_b128 v[196:199], v245 offset:128
    v_mfma_f32_16x16x32_bf16 v[228:231], a[56:59], a[240:243], v[228:231]
    v_exp_f32 v200, v200
    v_mfma_f32_16x16x32_bf16 v[228:231], a[60:63], a[244:247], v[228:231]
    v_exp_f32 v201, v201
    v_mfma_f32_16x16x32_bf16 v[228:231], a[64:67], a[216:219], v[228:231]
    s_waitcnt lgkmcnt(1)
    v_exp_f32 v202, v202
    v_mfma_f32_16x16x32_bf16 v[208:211], v[132:135], v[174:177], v[208:211]
    v_exp_f32 v203, v203
    v_mfma_f32_16x16x32_bf16 v[228:231], a[68:71], a[220:223], v[228:231]
    v_cvt_pk_bf16_f32 v184, v200, v201
    v_cvt_pk_bf16_f32 v187, v202, v203
    ds_read_b128 v[200:203], v246 offset:128
    v_exp_f32 v204, v204
    v_mfma_f32_16x16x16_bf16 v[208:211], v[136:137], v[178:179], v[208:211]
    v_exp_f32 v205, v205
    v_exp_f32 v206, v206
    v_exp_f32 v207, v207
    v_cvt_pk_bf16_f32 v182, v204, v205
    s_waitcnt lgkmcnt(1)
    v_mfma_f32_16x16x32_bf16 v[196:199], v[156:159], v[174:177], v[196:199]
    v_cvt_pk_bf16_f32 v185, v206, v207
    v_mfma_f32_16x16x32_bf16 v[212:215], v[10:13], v[180:183], v[212:215]
    ds_read_b128 v[204:207], v244 offset:0
    v_sub_f32 v208, v208, v248
    v_mfma_f32_16x16x32_bf16 v[216:219], v[40:43], v[180:183], v[216:219]
    v_exp_f32 v208, v208
    v_mfma_f32_16x16x32_bf16 v[220:223], v[70:73], v[180:183], v[220:223]
    v_sub_f32 v209, v209, v248
    v_mfma_f32_16x16x32_bf16 v[224:227], a[248:251], v[180:183], v[224:227]
    v_exp_f32 v209, v209
    v_mfma_f32_16x16x32_bf16 v[212:215], v[14:17], v[184:187], v[212:215]
    s_waitcnt lgkmcnt(1)
    v_cvt_pk_bf16_f32 v189, v208, v209
    v_mfma_f32_16x16x32_bf16 v[216:219], v[44:47], v[184:187], v[216:219]
    ds_read_b128 v[208:211], v245 offset:0
    v_mfma_f32_16x16x32_bf16 v[220:223], v[74:77], v[184:187], v[220:223]
    v_mfma_f32_16x16x32_bf16 v[224:227], a[248:251], v[184:187], v[224:227]
    buffer_load_dwordx4 a[164:167], v254, s[24:27], s53 offen offset:1024
    s_mul_i32 s53, s31, 4
    s_add_u32 s52, s52, s53
    v_mfma_f32_16x16x16_bf16 v[196:199], v[160:161], v[178:179], v[196:199]
    s_mul_i32 s53, s31, 4
    s_waitcnt lgkmcnt(1)
    v_mfma_f32_16x16x32_bf16 v[200:203], v[114:117], v[174:177], v[200:203]
    ds_read_b64 v[174:175], v247 offset:0
    v_mfma_f32_16x16x32_bf16 v[204:207], v[126:129], v[168:171], v[204:207]
    ds_read_b64 v[176:177], v247 offset:32
    s_nop 1
    v_sub_f32 v196, v196, v248
    v_mfma_f32_16x16x16_bf16 v[200:203], v[118:119], v[178:179], v[200:203]
    ds_read_b64 v[178:179], v247 offset:64
    v_sub_f32 v197, v197, v248
    v_mfma_f32_16x16x16_bf16 v[204:207], v[130:131], v[172:173], v[204:207]
    v_exp_f32 v196, v196
    v_exp_f32 v197, v197
    s_waitcnt lgkmcnt(3)
    v_mfma_f32_16x16x32_bf16 v[208:211], v[150:153], v[168:171], v[208:211]
    buffer_load_dwordx4 a[184:187], v254, s[24:27], s58 offen offset:2048
    s_mul_i32 s58, s30, 7
    v_cvt_pk_bf16_f32 v190, v196, v197
    ds_read_b128 v[196:199], v246 offset:0
    v_sub_f32 v200, v200, v248
    v_exp_f32 v200, v200
    v_mfma_f32_16x16x16_bf16 v[208:211], v[154:155], v[172:173], v[208:211]
    v_sub_f32 v201, v201, v248
    v_exp_f32 v201, v201
    v_max_f32 v248, v204, v205
    v_cvt_pk_bf16_f32 v188, v200, v201
    ds_read_b128 v[200:203], v244 offset:64
    v_max3_f32 v248, v248, v206, v207
    v_mfma_f32_16x16x32_bf16 v[212:215], v[18:21], v[188:191], v[212:215]
    ds_read_b128 v[204:207], v245 offset:64
    v_max3_f32 v248, v248, v208, v209
    v_mfma_f32_16x16x32_bf16 v[216:219], v[48:51], v[188:191], v[216:219]
    v_max3_f32 v248, v248, v210, v211
    v_mfma_f32_16x16x32_bf16 v[220:223], v[78:81], v[188:191], v[220:223]
    buffer_load_dwordx4 a[188:191], v254, s[24:27], s59 offen offset:3072
    s_mul_i32 s59, s31, 3
    s_add_u32 s58, s58, s59
    v_mfma_f32_16x16x32_bf16 v[224:227], a[248:251], v[188:191], v[224:227]
    ds_read_b128 v[208:211], v246 offset:64
    s_add_u32 s58, s58, s32
    s_add_u32 s58, s58, s39
    s_mul_i32 s59, s31, 11
    s_waitcnt lgkmcnt(3)
    v_mfma_f32_16x16x32_bf16 v[196:199], v[162:165], v[168:171], v[196:199]
    s_nop 1
    v_rcp_f32 v252, v224
    s_nop 0
    v_mul_f32 v212, v212, v252
    v_mul_f32 v213, v213, v252
    v_mfma_f32_16x16x16_bf16 v[196:199], v[166:167], v[172:173], v[196:199]
    v_mul_f32 v214, v214, v252
    v_mul_f32 v215, v215, v252
    s_waitcnt lgkmcnt(2)
    v_mfma_f32_16x16x32_bf16 v[200:203], v[132:135], v[168:171], v[200:203]
    v_cvt_pk_bf16_f32 v212, v212, v213
    s_waitcnt lgkmcnt(1)
    v_mfma_f32_16x16x32_bf16 v[204:207], v[156:159], v[168:171], v[204:207]
    buffer_load_dwordx4 a[192:195], v254, s[24:27], s60 offen
    s_mul_i32 s60, s30, 0
    v_cvt_pk_bf16_f32 v213, v214, v215
    v_mfma_f32_16x16x16_bf16 v[200:203], v[136:137], v[172:173], v[200:203]
    ds_write_b64 v247, v[212:213] offset:13312
    v_mul_f32 v216, v216, v252
    v_mfma_f32_16x16x16_bf16 v[204:207], v[160:161], v[172:173], v[204:207]
    s_waitcnt lgkmcnt(1)
    v_mul_f32 v217, v217, v252
    v_mul_f32 v218, v218, v252
    v_mfma_f32_16x16x32_bf16 v[208:211], v[114:117], v[168:171], v[208:211]
    v_mul_f32 v219, v219, v252
    v_cvt_pk_bf16_f32 v216, v216, v217
    v_cvt_pk_bf16_f32 v217, v218, v219
    ds_write_b64 v247, v[216:217] offset:13344
    v_mul_f32 v220, v220, v252
    v_mul_f32 v221, v221, v252
    v_mfma_f32_16x16x16_bf16 v[208:211], v[118:119], v[172:173], v[208:211]
    buffer_load_dwordx4 a[196:199], v254, s[24:27], s61 offen offset:1024
    s_mul_i32 s61, s31, 4
    v_mul_f32 v222, v222, v252
    v_mul_f32 v223, v223, v252
    v_cvt_pk_bf16_f32 v220, v220, v221
    v_cvt_pk_bf16_f32 v221, v222, v223
    ds_write_b64 v247, v[220:221] offset:13376
    s_add_u32 s60, s60, s61
    v_max3_f32 v248, v248, v196, v197
    v_max3_f32 v248, v248, v198, v199
    ds_read_b128 v[196:199], v244 offset:128
    v_max3_f32 v248, v248, v200, v201
    v_max3_f32 v248, v248, v202, v203
    ds_read_b128 v[200:203], v245 offset:128
    v_max3_f32 v248, v248, v204, v205
    v_max3_f32 v248, v248, v206, v207
    ds_read_b128 v[204:207], v246 offset:128
    v_max3_f32 v248, v248, v208, v209
    v_max3_f32 v248, v248, v210, v211
    buffer_load_dwordx4 a[200:203], v254, s[24:27], s62 offen offset:2048
    ds_read_b128 v[208:211], v244 offset:0
    s_mul_i32 s62, s30, 0
    s_waitcnt lgkmcnt(3)
    v_mfma_f32_16x16x32_bf16 v[196:199], v[90:93], v[168:171], v[196:199]
    s_nop 5
    v_mfma_f32_16x16x16_bf16 v[196:199], v[94:95], v[172:173], v[196:199]
    s_waitcnt lgkmcnt(2)
    buffer_load_dwordx4 a[204:207], v254, s[24:27], s63 offen offset:3072
    v_mfma_f32_16x16x32_bf16 v[200:203], v[96:99], v[168:171], v[200:203]
    s_waitcnt lgkmcnt(1)
    s_mul_i32 s63, s31, 4
    s_add_u32 s62, s62, s63
    v_mfma_f32_16x16x32_bf16 v[204:207], v[120:123], v[168:171], v[204:207]
    s_waitcnt lgkmcnt(0)
    v_max3_f32 v248, v248, v196, v197
    v_mfma_f32_16x16x16_bf16 v[200:203], v[100:101], v[172:173], v[200:203]
    ds_read_b128 v[196:199], v245 offset:0
    v_mfma_f32_16x16x32_bf16 v[208:211], v[126:129], v[168:171], v[208:211]
    v_cvt_pk_bf16_f32 v126, v232, v233
    v_cvt_pk_bf16_f32 v127, v234, v235
    v_mfma_f32_16x16x16_bf16 v[204:207], v[124:125], v[172:173], v[204:207]
    v_cvt_pk_bf16_f32 v128, v236, v237
    v_cvt_pk_bf16_f32 v129, v238, v239
    v_mfma_f32_16x16x32_bf16 v[232:235], a[232:235], a[72:75], 0
    v_max3_f32 v248, v248, v200, v201
    v_mfma_f32_16x16x16_bf16 v[208:211], v[130:131], v[172:173], v[208:211]
    buffer_load_dwordx4 a[208:211], v254, s[24:27], s64 offen
    s_mul_i32 s64, s30, 4
    v_cvt_pk_bf16_f32 v130, v228, v229
    v_mfma_f32_16x16x32_bf16 v[232:235], a[236:239], a[76:79], v[232:235]
    ds_read_b128 v[200:203], v246 offset:0
    v_cvt_pk_bf16_f32 v131, v230, v231
    v_mfma_f32_16x16x32_bf16 v[232:235], a[240:243], a[80:83], v[232:235]
    v_max3_f32 v248, v248, v204, v205
    v_mov_b32 v252, v248
    v_mfma_f32_16x16x32_bf16 v[232:235], a[244:247], a[84:87], v[232:235]
    ds_read_b128 v[204:207], v244 offset:64
    v_permlane16_swap_b32 v248, v252
    v_mfma_f32_16x16x32_bf16 v[232:235], a[216:219], a[88:91], v[232:235]
    v_max_f32 v248, v248, v252
    v_mov_b32 v252, v248
    v_mfma_f32_16x16x32_bf16 v[232:235], a[220:223], a[92:95], v[232:235]
    s_waitcnt lgkmcnt(2)
    v_permlane32_swap_b32 v248, v252
    v_max_f32 v248, v248, v252
    v_mfma_f32_16x16x32_bf16 v[196:199], v[150:153], v[168:171], v[196:199]
    v_sub_f32 v208, v208, v248
    v_sub_f32 v209, v209, v248
    v_mfma_f32_16x16x32_bf16 v[236:239], a[232:235], a[96:99], 0
    buffer_load_dwordx4 a[212:215], v254, s[24:27], s65 offen offset:1024
    s_mul_i32 s65, s31, -8
    v_cvt_pk_bf16_f32 v1, v232, v233
    v_mfma_f32_16x16x16_bf16 v[196:199], v[154:155], v[172:173], v[196:199]
    s_add_u32 s64, s64, s65
    v_cvt_pk_bf16_f32 v4, v234, v235
    v_mbcnt_lo_u32_b32 v254, -1, 0
    v_mfma_f32_16x16x32_bf16 v[236:239], a[236:239], a[100:103], v[236:239]
    s_waitcnt vmcnt(9)
    v_mbcnt_hi_u32_b32 v254, -1, v254
    v_bfe_u32 v255, v254, 2, 2
    v_mfma_f32_16x16x32_bf16 v[236:239], a[240:243], a[104:107], v[236:239]
    s_waitcnt lgkmcnt(1)
    v_mul_i32_i24 v250, s30, v255
    v_and_b32 v255, 3, v254
    v_mfma_f32_16x16x32_bf16 v[200:203], v[162:165], v[168:171], v[200:203]
    v_mad_i32_i24 v250, v255, s31, v250
    v_add_u32 v250, s50, v250
    v_mfma_f32_16x16x32_bf16 v[236:239], a[244:247], a[108:111], v[236:239]
    s_mul_i32 s50, s30, 0
    v_lshrrev_b32 v254, 4, v254
    v_lshl_add_u32 v251, v254, 3, v250
    v_mfma_f32_16x16x16_bf16 v[200:203], v[166:167], v[172:173], v[200:203]
    s_add_u32 s50, s50, s51
    v_lshl_add_u32 v250, v254, 4, v250
    v_mbcnt_lo_u32_b32 v254, -1, 0
    v_mfma_f32_16x16x32_bf16 v[236:239], a[216:219], a[112:115], v[236:239]
    s_waitcnt lgkmcnt(0)
    v_mbcnt_hi_u32_b32 v254, -1, v254
    v_bfe_u32 v255, v254, 2, 2
    v_mfma_f32_16x16x32_bf16 v[204:207], v[132:135], v[168:171], v[204:207]
    v_exp_f32 v208, v208
    v_mfma_f32_16x16x32_bf16 v[236:239], a[220:223], a[116:119], v[236:239]
    v_exp_f32 v209, v209
    v_mfma_f32_16x16x32_bf16 v[228:231], a[232:235], a[120:123], 0
    ds_read_b128 a[232:235], v249 offset:128
    v_sub_f32 v210, v210, v248
    v_mfma_f32_16x16x16_bf16 v[204:207], v[136:137], v[172:173], v[204:207]
    v_exp_f32 v210, v210
    v_mfma_f32_16x16x32_bf16 v[228:231], a[236:239], a[124:127], v[228:231]
    ds_read_b128 a[236:239], v249 offset:192
    v_cvt_pk_bf16_f32 v31, v236, v237
    v_mfma_f32_16x16x32_bf16 v[228:231], a[240:243], a[128:131], v[228:231]
    ds_read_b128 a[240:243], v249 offset:256
    v_cvt_pk_bf16_f32 v34, v238, v239
    v_mfma_f32_16x16x32_bf16 v[228:231], a[244:247], a[132:135], v[228:231]
    ds_read_b128 a[244:247], v249 offset:320
    v_sub_f32 v211, v211, v248
    v_mfma_f32_16x16x32_bf16 v[228:231], a[216:219], a[136:139], v[228:231]
    ds_read_b128 a[216:219], v249 offset:6656
    v_cvt_pk_bf16_f32 v193, v208, v209
    v_mfma_f32_16x16x32_bf16 v[228:231], a[220:223], a[140:143], v[228:231]
    ds_read_b128 a[220:223], v249 offset:6720
    v_sub_f32 v196, v196, v248
    v_mfma_f32_16x16x32_bf16 v[232:235], a[144:147], a[224:227], 0
    v_exp_f32 v211, v211
    v_mfma_f32_16x16x32_bf16 v[232:235], a[148:151], a[228:231], v[232:235]
    v_cvt_pk_bf16_f32 v180, v210, v211
    v_sub_f32 v197, v197, v248
    v_mfma_f32_16x16x32_bf16 v[236:239], a[168:171], a[224:227], 0
    ds_read_b128 v[208:211], v245 offset:64
    s_waitcnt lgkmcnt(6)
    v_cvt_pk_bf16_f32 v61, v228, v229
    v_mfma_f32_16x16x32_bf16 v[232:235], a[152:155], a[232:235], v[232:235]
    v_cvt_pk_bf16_f32 v64, v230, v231
    v_sub_f32 v198, v198, v248
    v_mfma_f32_16x16x32_bf16 v[236:239], a[172:175], a[228:231], v[236:239]
    s_waitcnt lgkmcnt(5)
    v_exp_f32 v196, v196
    v_mfma_f32_16x16x32_bf16 v[232:235], a[156:159], a[236:239], v[232:235]
    s_waitcnt lgkmcnt(4)
    v_exp_f32 v197, v197
    v_mfma_f32_16x16x32_bf16 v[232:235], a[160:163], a[240:243], v[232:235]
    s_waitcnt vmcnt(6) lgkmcnt(3)
    v_exp_f32 v198, v198
    v_mfma_f32_16x16x32_bf16 v[232:235], a[164:167], a[244:247], v[232:235]
    v_sub_f32 v199, v199, v248
    v_cvt_pk_bf16_f32 v194, v196, v197
    v_mfma_f32_16x16x32_bf16 v[236:239], a[176:179], a[232:235], v[236:239]
    v_exp_f32 v199, v199
    v_mfma_f32_16x16x32_bf16 v[236:239], a[180:183], a[236:239], v[236:239]
    v_cvt_pk_bf16_f32 v181, v198, v199
    v_sub_f32 v200, v200, v248
    v_mfma_f32_16x16x32_bf16 v[236:239], a[184:187], a[240:243], v[236:239]
    ds_read_b128 v[196:199], v246 offset:64
    s_waitcnt vmcnt(5) lgkmcnt(1)
    v_cvt_pk_bf16_f32 v232, v232, v233
    v_mfma_f32_16x16x32_bf16 v[208:211], v[156:159], v[168:171], v[208:211]
    v_cvt_pk_bf16_f32 v233, v234, v235
    v_sub_f32 v201, v201, v248
    v_mfma_f32_16x16x32_bf16 v[236:239], a[188:191], a[244:247], v[236:239]
    v_exp_f32 v200, v200
    v_mfma_f32_16x16x32_bf16 v[228:231], a[192:195], a[224:227], 0
    ds_read_b128 a[224:227], v249 offset:6784
    v_sub_f32 v202, v202, v248
    v_mfma_f32_16x16x16_bf16 v[208:211], v[160:161], v[172:173], v[208:211]
    v_exp_f32 v201, v201
    v_exp_f32 v202, v202
    v_sub_f32 v203, v203, v248
    v_cvt_pk_bf16_f32 v234, v236, v237
    v_cvt_pk_bf16_f32 v235, v238, v239
    v_mfma_f32_16x16x32_bf16 v[236:239], a[168:171], a[216:219], 0
    buffer_store_dwordx4 v[232:235], v250, s[20:23], 0 offen
    v_mfma_f32_16x16x32_bf16 v[236:239], a[172:175], a[220:223], v[236:239]
    s_waitcnt vmcnt(5)
    v_add_u32 v250, s52, v250
    v_cvt_pk_bf16_f32 v192, v200, v201
    v_mfma_f32_16x16x32_bf16 v[228:231], a[196:199], a[228:231], v[228:231]
    ds_read_b128 a[228:231], v249 offset:6848
    s_waitcnt lgkmcnt(2)
    v_sub_f32 v204, v204, v248
    v_mfma_f32_16x16x32_bf16 v[196:199], v[114:117], v[168:171], v[196:199]
    v_exp_f32 v203, v203
    v_mfma_f32_16x16x32_bf16 v[232:235], a[144:147], a[216:219], 0
    v_cvt_pk_bf16_f32 v195, v202, v203
    v_sub_f32 v205, v205, v248
    v_mfma_f32_16x16x32_bf16 v[232:235], a[148:151], a[220:223], v[232:235]
    ds_read_b128 v[200:203], v244 offset:128
    s_waitcnt lgkmcnt(2)
    v_sub_f32 v206, v206, v248
    v_mfma_f32_16x16x32_bf16 v[212:215], v[12:15], v[192:195], 0
    v_exp_f32 v204, v204
    v_mfma_f32_16x16x32_bf16 v[216:219], v[42:45], v[192:195], 0
    v_exp_f32 v205, v205
    v_mfma_f32_16x16x32_bf16 v[220:223], v[72:75], v[192:195], 0
    s_waitcnt vmcnt(4)
    v_exp_f32 v206, v206
    v_mfma_f32_16x16x32_bf16 v[224:227], a[248:251], v[192:195], 0
    v_sub_f32 v207, v207, v248
    v_cvt_pk_bf16_f32 v183, v204, v205
    v_mfma_f32_16x16x16_bf16 v[196:199], v[118:119], v[172:173], v[196:199]
    v_exp_f32 v207, v207
    v_mfma_f32_16x16x32_bf16 v[228:231], a[200:203], a[232:235], v[228:231]
    ds_read_b128 a[232:235], v249 offset:6912
    v_cvt_pk_bf16_f32 v186, v206, v207
    v_mfma_f32_16x16x32_bf16 v[232:235], a[152:155], a[224:227], v[232:235]
    ds_read_b128 v[204:207], v245 offset:128
    s_waitcnt lgkmcnt(3)
    v_sub_f32 v208, v208, v248
    v_mfma_f32_16x16x32_bf16 v[232:235], a[156:159], a[228:231], v[232:235]
    v_exp_f32 v208, v208
    v_mfma_f32_16x16x32_bf16 v[236:239], a[176:179], a[224:227], v[236:239]
    s_waitcnt lgkmcnt(2)
    v_sub_f32 v209, v209, v248
    v_sub_f32 v210, v210, v248
    v_mfma_f32_16x16x32_bf16 v[200:203], v[90:93], v[168:171], v[200:203]
    s_waitcnt vmcnt(3)
    v_exp_f32 v209, v209
    v_mfma_f32_16x16x32_bf16 v[228:231], a[204:207], a[236:239], v[228:231]
    ds_read_b128 a[236:239], v249 offset:6976
    v_sub_f32 v211, v211, v248
    v_mfma_f32_16x16x32_bf16 v[236:239], a[180:183], a[228:231], v[236:239]
    v_exp_f32 v210, v210
    v_mfma_f32_16x16x16_bf16 v[200:203], v[94:95], v[172:173], v[200:203]
    v_exp_f32 v211, v211
    v_cvt_pk_bf16_f32 v184, v208, v209
    v_cvt_pk_bf16_f32 v187, v210, v211
    ds_read_b128 v[208:211], v246 offset:128
    s_waitcnt lgkmcnt(3)
    v_mfma_f32_16x16x32_bf16 v[232:235], a[160:163], a[232:235], v[232:235]
    s_waitcnt lgkmcnt(2)
    v_sub_f32 v196, v196, v248
    v_sub_f32 v197, v197, v248
    v_mfma_f32_16x16x32_bf16 v[204:207], v[96:99], v[168:171], v[204:207]
    s_waitcnt vmcnt(2)
    v_exp_f32 v196, v196
    v_mfma_f32_16x16x32_bf16 v[228:231], a[208:211], a[240:243], v[228:231]
    ds_read_b128 a[240:243], v240 offset:1536
    v_sub_f32 v198, v198, v248
    v_mfma_f32_16x16x32_bf16 v[236:239], a[184:187], a[232:235], v[236:239]
    v_exp_f32 v197, v197
    v_mfma_f32_16x16x16_bf16 v[204:207], v[100:101], v[172:173], v[204:207]
    s_waitcnt lgkmcnt(2)
    v_exp_f32 v198, v198
    v_mfma_f32_16x16x32_bf16 v[232:235], a[164:167], a[236:239], v[232:235]
    v_sub_f32 v199, v199, v248
    v_cvt_pk_bf16_f32 v182, v196, v197
    v_mfma_f32_16x16x32_bf16 v[236:239], a[188:191], a[236:239], v[236:239]
    v_exp_f32 v199, v199
    v_mfma_f32_16x16x32_bf16 v[212:215], v[16:19], v[180:183], v[212:215]
    v_cvt_pk_bf16_f32 v185, v198, v199
    v_sub_f32 v200, v200, v248
    v_mfma_f32_16x16x32_bf16 v[216:219], v[46:49], v[180:183], v[216:219]
    ds_read_b128 v[196:199], v244 offset:32
    s_waitcnt vmcnt(1) lgkmcnt(2)
    v_cvt_pk_bf16_f32 v232, v232, v233
    v_mfma_f32_16x16x32_bf16 v[220:223], v[76:79], v[180:183], v[220:223]
    v_cvt_pk_bf16_f32 v233, v234, v235
    v_cvt_pk_bf16_f32 v234, v236, v237
    v_mfma_f32_16x16x32_bf16 v[224:227], a[248:251], v[180:183], v[224:227]
    v_cvt_pk_bf16_f32 v235, v238, v239
    v_sub_f32 v201, v201, v248
    v_mfma_f32_16x16x32_bf16 v[212:215], v[20:23], v[184:187], v[212:215]
    buffer_store_dwordx4 v[232:235], v250, s[20:23], 0 offen
    v_mfma_f32_16x16x32_bf16 v[216:219], v[50:53], v[184:187], v[216:219]
    s_waitcnt lgkmcnt(1)
    v_add_u32 v250, s54, v250
    v_sub_f32 v204, v204, v248
    v_mfma_f32_16x16x32_bf16 v[220:223], v[80:83], v[184:187], v[220:223]
    v_exp_f32 v200, v200
    v_mfma_f32_16x16x32_bf16 v[224:227], a[248:251], v[184:187], v[224:227]
    v_exp_f32 v201, v201
    v_mfma_f32_16x16x32_bf16 v[208:211], v[120:123], v[168:171], v[208:211]
    ds_read_b64 v[168:169], v247 offset:26624
    v_cvt_pk_bf16_f32 v189, v200, v201
    v_mfma_f32_16x16x32_bf16 v[228:231], a[212:215], a[244:247], v[228:231]
    ds_read_b128 v[200:203], v245 offset:32
    s_waitcnt lgkmcnt(2)
    v_sub_f32 v205, v205, v248
    v_mfma_f32_16x16x16_bf16 v[208:211], v[124:125], v[172:173], v[208:211]
    ds_read_b128 a[244:247], v241 offset:1536
    v_mfma_f32_16x16x32_bf16 v[196:199], v[132:135], v[174:177], v[196:199]
    ds_read_b64 v[170:171], v247 offset:26656
    v_mfma_f32_16x16x32_bf16 v[232:235], a[0:3], a[240:243], 0
    ds_read_b64 v[172:173], v247 offset:26688
    v_cvt_pk_bf16_f32 v228, v228, v229
    v_mfma_f32_16x16x32_bf16 v[236:239], a[24:27], a[240:243], 0
    v_cvt_pk_bf16_f32 v229, v230, v231
    v_sub_f32 v208, v208, v248
    v_mfma_f32_16x16x16_bf16 v[196:199], v[136:137], v[178:179], v[196:199]
    buffer_store_dwordx2 v[228:229], v251, s[20:23], 0 offen offset:64
    v_mfma_f32_16x16x32_bf16 v[228:231], a[192:195], a[216:219], 0
    ds_read_b128 a[216:219], v240 offset:1664
    v_add_u32 v251, s52, v251
    v_mfma_f32_16x16x32_bf16 v[228:231], a[196:199], a[220:223], v[228:231]
    ds_read_b128 a[220:223], v241 offset:1664
    s_mul_i32 s52, s30, 0
    v_sub_f32 v209, v209, v248
    v_mfma_f32_16x16x32_bf16 v[228:231], a[200:203], a[224:227], v[228:231]
    ds_read_b128 a[224:227], v240 offset:1792
    s_add_u32 s52, s52, s53
    v_max_f32 v248, v196, v197
    v_mfma_f32_16x16x32_bf16 v[228:231], a[204:207], a[228:231], v[228:231]
    ds_read_b128 a[228:231], v241 offset:1792
    s_waitcnt lgkmcnt(6)
    v_max3_f32 v248, v248, v198, v199
    v_mfma_f32_16x16x32_bf16 v[200:203], v[156:159], v[174:177], v[200:203]
    ds_read_b128 v[196:199], v245 offset:96
    v_mfma_f32_16x16x32_bf16 v[228:231], a[208:211], a[232:235], v[228:231]
    ds_read_b128 a[232:235], v240 offset:3072
    v_mfma_f32_16x16x32_bf16 v[228:231], a[212:215], a[236:239], v[228:231]
    ds_read_b128 a[236:239], v241 offset:3072
    v_mfma_f32_16x16x32_bf16 v[232:235], a[4:7], a[244:247], v[232:235]
    v_exp_f32 v204, v204
    v_mfma_f32_16x16x16_bf16 v[200:203], v[160:161], v[178:179], v[200:203]
    v_exp_f32 v205, v205
    v_mfma_f32_16x16x32_bf16 v[236:239], a[28:31], a[244:247], v[236:239]
    s_waitcnt lgkmcnt(6)
    v_cvt_pk_bf16_f32 v190, v204, v205
    v_cvt_pk_bf16_f32 v228, v228, v229
    v_mfma_f32_16x16x32_bf16 v[232:235], a[8:11], a[216:219], v[232:235]
    ds_read_b128 v[204:207], v246 offset:32
    s_waitcnt lgkmcnt(5)
    v_cvt_pk_bf16_f32 v229, v230, v231
    v_mfma_f32_16x16x32_bf16 v[232:235], a[12:15], a[220:223], v[232:235]
    buffer_store_dwordx2 v[228:229], v251, s[20:23], 0 offen offset:64
    v_mfma_f32_16x16x32_bf16 v[232:235], a[16:19], a[224:227], v[232:235]
    s_waitcnt lgkmcnt(4)
    v_add_u32 v251, s54, v251
    v_max3_f32 v248, v248, v200, v201
    v_mfma_f32_16x16x32_bf16 v[232:235], a[20:23], a[228:231], v[232:235]
    s_mul_i32 s54, s30, 11
    v_exp_f32 v208, v208
    v_mfma_f32_16x16x32_bf16 v[236:239], a[32:35], a[216:219], v[236:239]
    s_add_u32 s54, s54, s55
    v_exp_f32 v209, v209
    v_mfma_f32_16x16x32_bf16 v[236:239], a[36:39], a[220:223], v[236:239]
    s_add_u32 s54, s54, s32
    v_cvt_pk_bf16_f32 v188, v208, v209
    v_max3_f32 v248, v248, v202, v203
    v_mfma_f32_16x16x32_bf16 v[236:239], a[40:43], a[224:227], v[236:239]
    ds_read_b128 v[208:211], v244 offset:96
    s_add_u32 s54, s54, s39
    s_waitcnt lgkmcnt(2)
    v_mfma_f32_16x16x32_bf16 v[212:215], v[24:27], v[188:191], v[212:215]
    ds_read_b128 v[200:203], v246 offset:96
    v_mfma_f32_16x16x32_bf16 v[216:219], v[54:57], v[188:191], v[216:219]
    v_mfma_f32_16x16x32_bf16 v[220:223], v[84:87], v[188:191], v[220:223]
    s_waitcnt lgkmcnt(2)
    v_mfma_f32_16x16x32_bf16 v[224:227], a[248:251], v[188:191], v[224:227]
    v_mfma_f32_16x16x32_bf16 v[204:207], v[114:117], v[174:177], v[204:207]
    v_mfma_f32_16x16x32_bf16 v[196:199], v[96:99], v[174:177], v[196:199]
    v_mfma_f32_16x16x32_bf16 v[236:239], a[44:47], a[228:231], v[236:239]
    v_mfma_f32_16x16x32_bf16 v[228:231], a[48:51], a[240:243], 0
    v_mfma_f32_16x16x32_bf16 v[228:231], a[52:55], a[244:247], v[228:231]
    s_waitcnt lgkmcnt(1)
    s_waitcnt lgkmcnt(0)
    v_mfma_f32_16x16x16_bf16 v[204:207], v[118:119], v[178:179], v[204:207]
    v_rcp_f32 v252, v224
    v_mfma_f32_16x16x32_bf16 v[208:211], v[90:93], v[174:177], v[208:211]
    v_mul_f32 v212, v212, v252
    v_mul_f32 v213, v213, v252
    v_mfma_f32_16x16x16_bf16 v[196:199], v[100:101], v[178:179], v[196:199]
    v_mul_f32 v214, v214, v252
    v_mul_f32 v215, v215, v252
    v_mfma_f32_16x16x32_bf16 v[200:203], v[120:123], v[174:177], v[200:203]
    v_cvt_pk_bf16_f32 v212, v212, v213
    v_cvt_pk_bf16_f32 v213, v214, v215
    v_mfma_f32_16x16x16_bf16 v[208:211], v[94:95], v[178:179], v[208:211]
    ds_write_b64 v247, v[212:213] offset:19968
    v_mfma_f32_16x16x32_bf16 v[228:231], a[56:59], a[216:219], v[228:231]
    v_mul_f32 v216, v216, v252
    v_mul_f32 v217, v217, v252
    v_mfma_f32_16x16x16_bf16 v[200:203], v[124:125], v[178:179], v[200:203]
    v_mul_f32 v218, v218, v252
    v_mul_f32 v219, v219, v252
    v_mfma_f32_16x16x32_bf16 v[228:231], a[60:63], a[220:223], v[228:231]
    v_cvt_pk_bf16_f32 v216, v216, v217
    v_cvt_pk_bf16_f32 v217, v218, v219
    v_mfma_f32_16x16x32_bf16 v[228:231], a[64:67], a[224:227], v[228:231]
    ds_write_b64 v247, v[216:217] offset:20000
    v_mfma_f32_16x16x32_bf16 v[228:231], a[68:71], a[228:231], v[228:231]
    v_mul_f32 v220, v220, v252
    v_mul_f32 v221, v221, v252
    v_mul_f32 v222, v222, v252
    v_mul_f32 v223, v223, v252
    v_cvt_pk_bf16_f32 v220, v220, v221
    v_cvt_pk_bf16_f32 v221, v222, v223
    ds_write_b64 v247, v[220:221] offset:20032
    v_max3_f32 v248, v248, v204, v205
    v_max3_f32 v248, v248, v206, v207
    ds_read_b128 v[204:207], v244 offset:32
    v_max3_f32 v248, v248, v208, v209
    v_max3_f32 v248, v248, v210, v211
    ds_read_b128 v[208:211], v245 offset:32
    v_max3_f32 v248, v248, v196, v197
    v_max3_f32 v248, v248, v198, v199
    ds_read_b128 v[196:199], v246 offset:32
    v_max3_f32 v248, v248, v200, v201
    v_max3_f32 v248, v248, v202, v203
    ds_read_b128 v[200:203], v244 offset:96
    v_mov_b32 v252, v248
    s_nop 1
    v_permlane16_swap_b32 v248, v252
    v_max_f32 v248, v248, v252
    v_mov_b32 v252, v248
    s_nop 1
    v_permlane32_swap_b32 v248, v252
    v_max_f32 v248, v248, v252
    s_waitcnt lgkmcnt(3)
    v_mfma_f32_16x16x32_bf16 v[204:207], v[132:135], v[174:177], v[204:207]
    v_cvt_pk_bf16_f32 v132, v232, v233
    v_cvt_pk_bf16_f32 v133, v234, v235
    v_mfma_f32_16x16x32_bf16 v[232:235], a[240:243], a[72:75], 0
    s_waitcnt lgkmcnt(2)
    v_cvt_pk_bf16_f32 v134, v236, v237
    v_cvt_pk_bf16_f32 v135, v238, v239
    v_mfma_f32_16x16x16_bf16 v[204:207], v[136:137], v[178:179], v[204:207]
    s_waitcnt lgkmcnt(1)
    v_cvt_pk_bf16_f32 v136, v228, v229
    v_cvt_pk_bf16_f32 v137, v230, v231
    v_mfma_f32_16x16x32_bf16 v[208:211], v[156:159], v[174:177], v[208:211]
    v_mfma_f32_16x16x32_bf16 v[196:199], v[114:117], v[174:177], v[196:199]
    s_waitcnt lgkmcnt(0)
    v_mfma_f32_16x16x32_bf16 v[200:203], v[90:93], v[174:177], v[200:203]
    v_mfma_f32_16x16x32_bf16 v[232:235], a[244:247], a[76:79], v[232:235]
    v_sub_f32 v204, v204, v248
    v_sub_f32 v205, v205, v248
    v_mfma_f32_16x16x16_bf16 v[208:211], v[160:161], v[178:179], v[208:211]
    v_exp_f32 v204, v204
    v_mfma_f32_16x16x16_bf16 v[196:199], v[118:119], v[178:179], v[196:199]
    v_exp_f32 v205, v205
    v_mfma_f32_16x16x16_bf16 v[200:203], v[94:95], v[178:179], v[200:203]
    v_sub_f32 v206, v206, v248
    v_sub_f32 v207, v207, v248
    v_mfma_f32_16x16x32_bf16 v[232:235], a[216:219], a[80:83], v[232:235]
    v_exp_f32 v206, v206
    v_mfma_f32_16x16x32_bf16 v[232:235], a[220:223], a[84:87], v[232:235]
    v_exp_f32 v207, v207
    v_mfma_f32_16x16x32_bf16 v[232:235], a[224:227], a[88:91], v[232:235]
    v_cvt_pk_bf16_f32 v193, v204, v205
    v_cvt_pk_bf16_f32 v180, v206, v207
    v_mfma_f32_16x16x32_bf16 v[232:235], a[228:231], a[92:95], v[232:235]
    ds_read_b128 v[204:207], v245 offset:96
    v_sub_f32 v208, v208, v248
    v_mfma_f32_16x16x32_bf16 v[236:239], a[240:243], a[96:99], 0
    v_exp_f32 v208, v208
    v_mfma_f32_16x16x32_bf16 v[236:239], a[244:247], a[100:103], v[236:239]
    v_sub_f32 v209, v209, v248
    v_sub_f32 v210, v210, v248
    v_mfma_f32_16x16x32_bf16 v[236:239], a[216:219], a[104:107], v[236:239]
    v_cvt_pk_bf16_f32 v7, v232, v233
    v_cvt_pk_bf16_f32 v10, v234, v235
    v_mfma_f32_16x16x32_bf16 v[236:239], a[220:223], a[108:111], v[236:239]
    v_exp_f32 v209, v209
    v_mfma_f32_16x16x32_bf16 v[236:239], a[224:227], a[112:115], v[236:239]
    v_exp_f32 v210, v210
    v_mfma_f32_16x16x32_bf16 v[236:239], a[228:231], a[116:119], v[236:239]
    v_sub_f32 v211, v211, v248
    v_cvt_pk_bf16_f32 v194, v208, v209
    v_mfma_f32_16x16x32_bf16 v[228:231], a[240:243], a[120:123], 0
    ds_read_b128 a[240:243], v240 offset:3200
    v_sub_f32 v196, v196, v248
    v_mfma_f32_16x16x32_bf16 v[228:231], a[244:247], a[124:127], v[228:231]
    ds_read_b128 a[244:247], v241 offset:3200
    s_waitcnt lgkmcnt(2)
    v_cvt_pk_bf16_f32 v37, v236, v237
    v_mfma_f32_16x16x32_bf16 v[204:207], v[96:99], v[174:177], v[204:207]
    v_cvt_pk_bf16_f32 v40, v238, v239
    v_sub_f32 v197, v197, v248
    v_mfma_f32_16x16x32_bf16 v[228:231], a[216:219], a[128:131], v[228:231]
    ds_read_b128 a[216:219], v240 offset:3328
    v_sub_f32 v198, v198, v248
    v_mfma_f32_16x16x32_bf16 v[228:231], a[220:223], a[132:135], v[228:231]
    ds_read_b128 a[220:223], v241 offset:3328
    v_sub_f32 v199, v199, v248
    v_mfma_f32_16x16x16_bf16 v[204:207], v[100:101], v[178:179], v[204:207]
    v_exp_f32 v211, v211
    v_mfma_f32_16x16x32_bf16 v[228:231], a[224:227], a[136:139], v[228:231]
    ds_read_b128 a[224:227], v249 offset:13312
    v_cvt_pk_bf16_f32 v181, v210, v211
    v_mfma_f32_16x16x32_bf16 v[228:231], a[228:231], a[140:143], v[228:231]
    ds_read_b128 v[208:211], v246 offset:96
    v_sub_f32 v200, v200, v248
    v_mfma_f32_16x16x32_bf16 v[232:235], a[0:3], a[232:235], 0
    ds_read_b128 a[228:231], v249 offset:13376
    v_sub_f32 v201, v201, v248
    v_mfma_f32_16x16x32_bf16 v[232:235], a[4:7], a[236:239], v[232:235]
    s_waitcnt lgkmcnt(6)
    v_exp_f32 v196, v196
    v_mfma_f32_16x16x32_bf16 v[232:235], a[8:11], a[240:243], v[232:235]
    s_waitcnt lgkmcnt(5)
    v_cvt_pk_bf16_f32 v67, v228, v229
    v_cvt_pk_bf16_f32 v70, v230, v231
    v_mfma_f32_16x16x32_bf16 v[232:235], a[12:15], a[244:247], v[232:235]
    v_exp_f32 v197, v197
    v_mfma_f32_16x16x32_bf16 v[236:239], a[24:27], a[232:235], 0
    s_waitcnt lgkmcnt(4)
    v_exp_f32 v198, v198
    v_mfma_f32_16x16x32_bf16 v[232:235], a[16:19], a[216:219], v[232:235]
    s_waitcnt lgkmcnt(3)
    v_exp_f32 v199, v199
    v_mfma_f32_16x16x32_bf16 v[232:235], a[20:23], a[220:223], v[232:235]
    v_cvt_pk_bf16_f32 v192, v196, v197
    v_cvt_pk_bf16_f32 v195, v198, v199
    v_mfma_f32_16x16x32_bf16 v[236:239], a[28:31], a[236:239], v[236:239]
    ds_read_b128 v[196:199], v244 offset:192
    s_waitcnt lgkmcnt(2)
    v_sub_f32 v202, v202, v248
    v_mfma_f32_16x16x32_bf16 v[212:215], v[18:21], v[192:195], 0
    v_exp_f32 v200, v200
    v_mfma_f32_16x16x32_bf16 v[216:219], v[48:51], v[192:195], 0
    v_cvt_pk_bf16_f32 v90, v232, v233
    v_cvt_pk_bf16_f32 v91, v234, v235
    v_mfma_f32_16x16x32_bf16 v[220:223], v[78:81], v[192:195], 0
    v_exp_f32 v201, v201
    v_mfma_f32_16x16x32_bf16 v[224:227], a[248:251], v[192:195], 0
    v_exp_f32 v202, v202
    v_mfma_f32_16x16x32_bf16 v[208:211], v[120:123], v[174:177], v[208:211]
    v_sub_f32 v203, v203, v248
    v_cvt_pk_bf16_f32 v183, v200, v201
    v_mfma_f32_16x16x32_bf16 v[236:239], a[32:35], a[240:243], v[236:239]
    v_exp_f32 v203, v203
    v_mfma_f32_16x16x32_bf16 v[236:239], a[36:39], a[244:247], v[236:239]
    v_cvt_pk_bf16_f32 v186, v202, v203
    v_sub_f32 v204, v204, v248
    v_mfma_f32_16x16x16_bf16 v[208:211], v[124:125], v[178:179], v[208:211]
    ds_read_b128 v[200:203], v245 offset:192
    s_waitcnt lgkmcnt(1)
    v_sub_f32 v205, v205, v248
    v_mfma_f32_16x16x32_bf16 v[196:199], v[138:141], v[168:171], v[196:199]
    v_exp_f32 v204, v204
    v_mfma_f32_16x16x32_bf16 v[236:239], a[40:43], a[216:219], v[236:239]
    v_exp_f32 v205, v205
    v_mfma_f32_16x16x32_bf16 v[236:239], a[44:47], a[220:223], v[236:239]
    v_sub_f32 v206, v206, v248
    v_sub_f32 v207, v207, v248
    v_mfma_f32_16x16x16_bf16 v[196:199], v[142:143], v[172:173], v[196:199]
    v_exp_f32 v206, v206
    v_mfma_f32_16x16x32_bf16 v[228:231], a[48:51], a[232:235], 0
    v_exp_f32 v207, v207
    v_mfma_f32_16x16x32_bf16 v[228:231], a[52:55], a[236:239], v[228:231]
    v_cvt_pk_bf16_f32 v184, v204, v205
    v_cvt_pk_bf16_f32 v92, v236, v237
    v_mfma_f32_16x16x32_bf16 v[228:231], a[56:59], a[240:243], v[228:231]
    v_cvt_pk_bf16_f32 v93, v238, v239
    v_cvt_pk_bf16_f32 v187, v206, v207
    v_mfma_f32_16x16x32_bf16 v[228:231], a[60:63], a[244:247], v[228:231]
    ds_read_b128 v[204:207], v246 offset:192
    s_waitcnt lgkmcnt(1)
    v_sub_f32 v208, v208, v248
    v_mfma_f32_16x16x32_bf16 v[200:203], v[102:105], v[168:171], v[200:203]
    v_exp_f32 v208, v208
    v_mfma_f32_16x16x32_bf16 v[228:231], a[64:67], a[216:219], v[228:231]
    v_sub_f32 v209, v209, v248
    v_sub_f32 v210, v210, v248
    v_mfma_f32_16x16x32_bf16 v[228:231], a[68:71], a[220:223], v[228:231]
    v_exp_f32 v209, v209
    v_mfma_f32_16x16x16_bf16 v[200:203], v[106:107], v[172:173], v[200:203]
    v_exp_f32 v210, v210
    v_mfma_f32_16x16x32_bf16 v[232:235], a[232:235], a[72:75], 0
    v_sub_f32 v211, v211, v248
    v_cvt_pk_bf16_f32 v182, v208, v209
    v_mfma_f32_16x16x32_bf16 v[232:235], a[236:239], a[76:79], v[232:235]
    v_exp_f32 v211, v211
    v_mfma_f32_16x16x32_bf16 v[212:215], v[22:25], v[180:183], v[212:215]
    v_cvt_pk_bf16_f32 v94, v228, v229
    v_cvt_pk_bf16_f32 v95, v230, v231
    v_mfma_f32_16x16x32_bf16 v[216:219], v[52:55], v[180:183], v[216:219]
    v_cvt_pk_bf16_f32 v185, v210, v211
    v_max_f32 v248, v196, v197
    v_mfma_f32_16x16x32_bf16 v[220:223], v[82:85], v[180:183], v[220:223]
    ds_read_b128 v[208:211], v244 offset:256
    s_waitcnt lgkmcnt(1)
    v_max3_f32 v248, v248, v198, v199
    v_mfma_f32_16x16x32_bf16 v[224:227], a[248:251], v[180:183], v[224:227]
    ds_read_b128 v[196:199], v245 offset:256
    v_max3_f32 v248, v248, v200, v201
    v_mfma_f32_16x16x32_bf16 v[212:215], v[26:29], v[184:187], v[212:215]
    v_max3_f32 v248, v248, v202, v203
    v_mfma_f32_16x16x32_bf16 v[216:219], v[56:59], v[184:187], v[216:219]
    ds_read_b128 v[200:203], v246 offset:256
    v_mfma_f32_16x16x32_bf16 v[220:223], v[86:89], v[184:187], v[220:223]
    v_mfma_f32_16x16x32_bf16 v[224:227], a[248:251], v[184:187], v[224:227]
    v_mov_b32 v187, 0
    v_mfma_f32_16x16x32_bf16 v[204:207], v[126:129], v[168:171], v[204:207]
    v_mfma_f32_16x16x32_bf16 v[232:235], a[240:243], a[80:83], v[232:235]
    v_mfma_f32_16x16x32_bf16 v[232:235], a[244:247], a[84:87], v[232:235]
    v_mfma_f32_16x16x32_bf16 v[232:235], a[216:219], a[88:91], v[232:235]
    s_waitcnt lgkmcnt(2)
    s_waitcnt lgkmcnt(1)
    v_mfma_f32_16x16x32_bf16 v[208:211], v[144:147], v[168:171], v[208:211]
    v_rcp_f32 v252, v224
    v_mfma_f32_16x16x16_bf16 v[204:207], v[130:131], v[172:173], v[204:207]
    v_mul_f32 v212, v212, v252
    v_mul_f32 v213, v213, v252
    v_mfma_f32_16x16x32_bf16 v[196:199], v[108:111], v[168:171], v[196:199]
    s_waitcnt lgkmcnt(0)
    v_mul_f32 v214, v214, v252
    v_mul_f32 v215, v215, v252
    v_mfma_f32_16x16x16_bf16 v[208:211], v[148:149], v[172:173], v[208:211]
    v_cvt_pk_bf16_f32 v212, v212, v213
    v_cvt_pk_bf16_f32 v213, v214, v215
    v_mfma_f32_16x16x16_bf16 v[196:199], v[112:113], v[172:173], v[196:199]
    ds_write_b64 v253, v[212:213] offset:0
    v_mfma_f32_16x16x32_bf16 v[200:203], v[132:135], v[168:171], v[200:203]
    v_mul_f32 v216, v216, v252
    v_mul_f32 v217, v217, v252
    v_mfma_f32_16x16x32_bf16 v[232:235], a[220:223], a[92:95], v[232:235]
    v_mul_f32 v218, v218, v252
    v_mul_f32 v219, v219, v252
    v_mfma_f32_16x16x32_bf16 v[236:239], a[232:235], a[96:99], 0
    v_cvt_pk_bf16_f32 v216, v216, v217
    v_cvt_pk_bf16_f32 v217, v218, v219
    v_mfma_f32_16x16x16_bf16 v[200:203], v[136:137], v[172:173], v[200:203]
    ds_write_b64 v253, v[216:217] offset:32
    v_mfma_f32_16x16x32_bf16 v[236:239], a[236:239], a[100:103], v[236:239]
    v_mul_f32 v220, v220, v252
    v_mul_f32 v221, v221, v252
    v_mfma_f32_16x16x32_bf16 v[236:239], a[240:243], a[104:107], v[236:239]
    v_mul_f32 v222, v222, v252
    v_mul_f32 v223, v223, v252
    v_mfma_f32_16x16x32_bf16 v[236:239], a[244:247], a[108:111], v[236:239]
    v_cvt_pk_bf16_f32 v220, v220, v221
    v_cvt_pk_bf16_f32 v221, v222, v223
    v_mfma_f32_16x16x32_bf16 v[236:239], a[216:219], a[112:115], v[236:239]
    ds_write_b64 v253, v[220:221] offset:64
    v_mfma_f32_16x16x32_bf16 v[236:239], a[220:223], a[116:119], v[236:239]
    v_cvt_pk_bf16_f32 v13, v232, v233
    v_cvt_pk_bf16_f32 v16, v234, v235
    v_mfma_f32_16x16x32_bf16 v[228:231], a[232:235], a[120:123], 0
    ds_read_b128 a[232:235], v249 offset:13440
    v_max3_f32 v248, v248, v204, v205
    v_mfma_f32_16x16x32_bf16 v[228:231], a[236:239], a[124:127], v[228:231]
    ds_read_b128 a[236:239], v249 offset:13504
    v_max3_f32 v248, v248, v206, v207
    v_mfma_f32_16x16x32_bf16 v[228:231], a[240:243], a[128:131], v[228:231]
    ds_read_b128 a[240:243], v249 offset:13568
    v_cvt_pk_bf16_f32 v43, v236, v237
    v_mfma_f32_16x16x32_bf16 v[228:231], a[244:247], a[132:135], v[228:231]
    ds_read_b128 a[244:247], v249 offset:13632
    v_cvt_pk_bf16_f32 v46, v238, v239
    v_mfma_f32_16x16x32_bf16 v[228:231], a[216:219], a[136:139], v[228:231]
    ds_read_b128 v[204:207], v244 offset:320
    v_add_u32 v249, 0xfffe9800, v249
    v_mfma_f32_16x16x32_bf16 v[228:231], a[220:223], a[140:143], v[228:231]
    v_max3_f32 v248, v248, v208, v209
    v_max3_f32 v248, v248, v210, v211
    v_mfma_f32_16x16x32_bf16 v[232:235], a[144:147], a[224:227], 0
    ds_read_b128 v[208:211], v245 offset:320
    s_waitcnt lgkmcnt(6)
    v_max3_f32 v248, v248, v196, v197
    v_mfma_f32_16x16x32_bf16 v[232:235], a[148:151], a[228:231], v[232:235]
    s_barrier
    v_cvt_pk_bf16_f32 v73, v228, v229
    v_cvt_pk_bf16_f32 v76, v230, v231
    v_mfma_f32_16x16x32_bf16 v[236:239], a[168:171], a[224:227], 0
    ds_read_b128 a[216:219], v240 offset:4608
    s_waitcnt lgkmcnt(6)
    v_max3_f32 v248, v248, v198, v199
    v_mfma_f32_16x16x32_bf16 v[232:235], a[152:155], a[232:235], v[232:235]
    ds_read_b128 v[196:199], v246 offset:320
    s_waitcnt lgkmcnt(6)
    v_max3_f32 v248, v248, v200, v201
    v_mfma_f32_16x16x32_bf16 v[232:235], a[156:159], a[236:239], v[232:235]
    ds_read_b128 a[220:223], v241 offset:4608
    s_waitcnt lgkmcnt(6)
    v_max3_f32 v248, v248, v202, v203
    v_mfma_f32_16x16x32_bf16 v[232:235], a[160:163], a[240:243], v[232:235]
    ds_read_b128 v[200:203], v244 offset:192
    s_waitcnt lgkmcnt(6)
    v_mfma_f32_16x16x32_bf16 v[232:235], a[164:167], a[244:247], v[232:235]
    ds_read_b64 v[174:175], v247 offset:33280
    s_waitcnt lgkmcnt(6)
    v_mfma_f32_16x16x32_bf16 v[204:207], v[150:153], v[168:171], v[204:207]
    ds_read_b64 v[176:177], v247 offset:33312
    v_mfma_f32_16x16x32_bf16 v[236:239], a[172:175], a[228:231], v[236:239]
    ds_read_b64 v[178:179], v247 offset:33344
    s_waitcnt lgkmcnt(7)
    v_mfma_f32_16x16x32_bf16 v[208:211], v[162:165], v[168:171], v[208:211]
    v_cvt_pk_bf16_f32 v232, v232, v233
    v_cvt_pk_bf16_f32 v233, v234, v235
    v_mfma_f32_16x16x16_bf16 v[204:207], v[154:155], v[172:173], v[204:207]
    v_mfma_f32_16x16x32_bf16 v[236:239], a[176:179], a[232:235], v[236:239]
    v_mfma_f32_16x16x32_bf16 v[236:239], a[180:183], a[236:239], v[236:239]
    s_waitcnt lgkmcnt(5)
    v_mfma_f32_16x16x16_bf16 v[208:211], v[166:167], v[172:173], v[208:211]
    v_mfma_f32_16x16x32_bf16 v[196:199], v[90:93], v[168:171], v[196:199]
    s_waitcnt lgkmcnt(3)
    v_mfma_f32_16x16x32_bf16 v[200:203], v[138:141], v[168:171], v[200:203]
    v_mfma_f32_16x16x32_bf16 v[236:239], a[184:187], a[240:243], v[236:239]
    v_max3_f32 v248, v248, v204, v205
    v_mfma_f32_16x16x32_bf16 v[236:239], a[188:191], a[244:247], v[236:239]
    ds_read_b128 v[204:207], v245 offset:192
    v_mfma_f32_16x16x16_bf16 v[196:199], v[94:95], v[172:173], v[196:199]
    v_max3_f32 v248, v248, v208, v209
    v_mfma_f32_16x16x16_bf16 v[200:203], v[142:143], v[172:173], v[200:203]
    ds_read_b128 v[208:211], v246 offset:192
    v_mfma_f32_16x16x32_bf16 v[228:231], a[192:195], a[224:227], 0
    ds_read_b128 a[224:227], v240 offset:4736
    v_mfma_f32_16x16x32_bf16 v[228:231], a[196:199], a[228:231], v[228:231]
    ds_read_b128 a[228:231], v241 offset:4736
    v_cvt_pk_bf16_f32 v234, v236, v237
    v_mfma_f32_16x16x32_bf16 v[228:231], a[200:203], a[232:235], v[228:231]
    ds_read_b128 a[232:235], v240 offset:4864
    v_cvt_pk_bf16_f32 v235, v238, v239
    v_mfma_f32_16x16x32_bf16 v[228:231], a[204:207], a[236:239], v[228:231]
    buffer_store_dwordx4 v[232:235], v250, s[20:23], 0 offen
    v_mfma_f32_16x16x32_bf16 v[228:231], a[208:211], a[240:243], v[228:231]
    ds_read_b128 a[236:239], v241 offset:4864
    v_lshlrev_b32 v250, 1, v254
    v_mfma_f32_16x16x32_bf16 v[228:231], a[212:215], a[244:247], v[228:231]
    ds_read_b128 a[240:243], v249 offset:0
    s_waitcnt lgkmcnt(6)
    v_and_or_b32 v255, v250, 4, v255
    v_mfma_f32_16x16x32_bf16 v[204:207], v[102:105], v[168:171], v[204:207]
    ds_read_b128 a[244:247], v249 offset:64
    v_mul_i32_i24 v250, s30, v255
    v_mfma_f32_16x16x32_bf16 v[232:235], a[0:3], a[216:219], 0
    s_waitcnt lgkmcnt(6)
    v_cvt_pk_bf16_f32 v228, v228, v229
    v_cvt_pk_bf16_f32 v229, v230, v231
    v_mfma_f32_16x16x16_bf16 v[204:207], v[106:107], v[172:173], v[204:207]
    buffer_store_dwordx2 v[228:229], v251, s[20:23], 0 offen offset:64
    v_mfma_f32_16x16x32_bf16 v[208:211], v[126:129], v[168:171], v[208:211]
    v_and_b32 v255, 1, v254
    v_mad_i32_i24 v250, v255, s31, v250
    v_mfma_f32_16x16x32_bf16 v[232:235], a[4:7], a[220:223], v[232:235]
    s_waitcnt lgkmcnt(3)
    v_add_u32 v250, s56, v250
    v_lshrrev_b32 v254, 4, v254
    v_mfma_f32_16x16x16_bf16 v[208:211], v[130:131], v[172:173], v[208:211]
    s_mul_i32 s56, s30, 15
    v_lshl_add_u32 v251, v254, 3, v250
    v_lshl_add_u32 v250, v254, 4, v250
    v_mfma_f32_16x16x32_bf16 v[232:235], a[8:11], a[224:227], v[232:235]
    s_add_u32 s56, s56, s57
    v_mbcnt_lo_u32_b32 v254, -1, 0
    v_mbcnt_hi_u32_b32 v254, -1, v254
    v_mfma_f32_16x16x32_bf16 v[232:235], a[12:15], a[228:231], v[232:235]
    s_add_u32 s56, s56, s32
    v_bfe_u32 v255, v254, 2, 2
    v_max3_f32 v248, v248, v196, v197
    v_mfma_f32_16x16x32_bf16 v[232:235], a[16:19], a[232:235], v[232:235]
    ds_read_b128 v[196:199], v244 offset:256
    s_add_u32 s56, s56, s39
    v_mov_b32 v252, v248
    v_mfma_f32_16x16x32_bf16 v[236:239], a[24:27], a[216:219], 0
    s_waitcnt lgkmcnt(1)
    v_permlane16_swap_b32 v248, v252
    v_max_f32 v248, v248, v252
    v_mfma_f32_16x16x32_bf16 v[232:235], a[20:23], a[236:239], v[232:235]
    v_mov_b32 v252, v248
    v_mfma_f32_16x16x32_bf16 v[236:239], a[28:31], a[220:223], v[236:239]
    v_mfma_f32_16x16x32_bf16 v[236:239], a[32:35], a[224:227], v[236:239]
    v_permlane32_swap_b32 v248, v252
    v_max_f32 v248, v248, v252
    v_mfma_f32_16x16x32_bf16 v[236:239], a[36:39], a[228:231], v[236:239]
    v_sub_f32 v200, v200, v248
    v_sub_f32 v201, v201, v248
    v_mfma_f32_16x16x32_bf16 v[236:239], a[40:43], a[232:235], v[236:239]
    v_cvt_pk_bf16_f32 v138, v232, v233
    v_cvt_pk_bf16_f32 v139, v234, v235
    v_mfma_f32_16x16x32_bf16 v[236:239], a[44:47], a[236:239], v[236:239]
    v_exp_f32 v200, v200
    v_mfma_f32_16x16x32_bf16 v[228:231], a[48:51], a[216:219], 0
    v_exp_f32 v201, v201
    v_mfma_f32_16x16x32_bf16 v[228:231], a[52:55], a[220:223], v[228:231]
    s_waitcnt lgkmcnt(0)
    v_sub_f32 v202, v202, v248
    v_sub_f32 v203, v203, v248
    v_mfma_f32_16x16x32_bf16 v[196:199], v[144:147], v[168:171], v[196:199]
    v_cvt_pk_bf16_f32 v140, v236, v237
    v_cvt_pk_bf16_f32 v141, v238, v239
    v_mfma_f32_16x16x32_bf16 v[228:231], a[56:59], a[224:227], v[228:231]
    v_exp_f32 v202, v202
    v_mfma_f32_16x16x32_bf16 v[228:231], a[60:63], a[228:231], v[228:231]
    v_exp_f32 v203, v203
    v_mfma_f32_16x16x16_bf16 v[196:199], v[148:149], v[172:173], v[196:199]
    v_cvt_pk_bf16_f32 v190, v200, v201
    v_cvt_pk_bf16_f32 v193, v202, v203
    v_mfma_f32_16x16x32_bf16 v[228:231], a[64:67], a[232:235], v[228:231]
    ds_read_b128 v[200:203], v245 offset:256
    v_sub_f32 v204, v204, v248
    v_mfma_f32_16x16x32_bf16 v[228:231], a[68:71], a[236:239], v[228:231]
    v_exp_f32 v204, v204
    v_mfma_f32_16x16x32_bf16 v[232:235], a[216:219], a[72:75], 0
    v_sub_f32 v205, v205, v248
    v_sub_f32 v206, v206, v248
    v_mfma_f32_16x16x32_bf16 v[232:235], a[220:223], a[76:79], v[232:235]
    v_exp_f32 v205, v205
    v_mfma_f32_16x16x32_bf16 v[232:235], a[224:227], a[80:83], v[232:235]
    v_exp_f32 v206, v206
    v_mfma_f32_16x16x32_bf16 v[232:235], a[228:231], a[84:87], v[232:235]
    v_cvt_pk_bf16_f32 v142, v228, v229
    v_cvt_pk_bf16_f32 v143, v230, v231
    v_mfma_f32_16x16x32_bf16 v[232:235], a[232:235], a[88:91], v[232:235]
    v_sub_f32 v207, v207, v248
    v_cvt_pk_bf16_f32 v188, v204, v205
    v_mfma_f32_16x16x32_bf16 v[232:235], a[236:239], a[92:95], v[232:235]
    v_exp_f32 v207, v207
    v_mfma_f32_16x16x32_bf16 v[236:239], a[216:219], a[96:99], 0
    v_cvt_pk_bf16_f32 v191, v206, v207
    v_sub_f32 v208, v208, v248
    v_mfma_f32_16x16x32_bf16 v[236:239], a[220:223], a[100:103], v[236:239]
    ds_read_b128 v[204:207], v246 offset:256
    s_waitcnt lgkmcnt(1)
    v_sub_f32 v209, v209, v248
    v_mfma_f32_16x16x32_bf16 v[200:203], v[108:111], v[168:171], v[200:203]
    v_cvt_pk_bf16_f32 v19, v232, v233
    v_cvt_pk_bf16_f32 v22, v234, v235
    v_mfma_f32_16x16x32_bf16 v[236:239], a[224:227], a[104:107], v[236:239]
    v_exp_f32 v208, v208
    v_mfma_f32_16x16x32_bf16 v[236:239], a[228:231], a[108:111], v[236:239]
    v_exp_f32 v209, v209
    v_mfma_f32_16x16x16_bf16 v[200:203], v[112:113], v[172:173], v[200:203]
    v_sub_f32 v210, v210, v248
    v_sub_f32 v211, v211, v248
    v_mfma_f32_16x16x32_bf16 v[236:239], a[232:235], a[112:115], v[236:239]
    v_exp_f32 v210, v210
    v_mfma_f32_16x16x32_bf16 v[236:239], a[236:239], a[116:119], v[236:239]
    v_exp_f32 v211, v211
    v_mfma_f32_16x16x32_bf16 v[228:231], a[216:219], a[120:123], 0
    ds_read_b128 a[216:219], v249 offset:128
    v_cvt_pk_bf16_f32 v189, v208, v209
    v_mfma_f32_16x16x32_bf16 v[228:231], a[220:223], a[124:127], v[228:231]
    ds_read_b128 a[220:223], v249 offset:192
    s_waitcnt lgkmcnt(2)
    v_cvt_pk_bf16_f32 v192, v210, v211
    v_mfma_f32_16x16x32_bf16 v[212:215], v[0:3], v[188:191], 0
    ds_read_b128 v[208:211], v244 offset:320
    v_cvt_pk_bf16_f32 v49, v236, v237
    v_mfma_f32_16x16x32_bf16 v[216:219], v[30:33], v[188:191], 0
    v_cvt_pk_bf16_f32 v52, v238, v239
    v_sub_f32 v196, v196, v248
    v_mfma_f32_16x16x32_bf16 v[220:223], v[60:63], v[188:191], 0
    v_exp_f32 v196, v196
    v_mfma_f32_16x16x32_bf16 v[224:227], a[248:251], v[188:191], 0
    v_sub_f32 v197, v197, v248
    v_sub_f32 v198, v198, v248
    v_mfma_f32_16x16x32_bf16 v[204:207], v[132:135], v[168:171], v[204:207]
    v_exp_f32 v197, v197
    v_mfma_f32_16x16x32_bf16 v[228:231], a[224:227], a[128:131], v[228:231]
    ds_read_b128 a[224:227], v249 offset:256
    v_sub_f32 v199, v199, v248
    v_mfma_f32_16x16x32_bf16 v[228:231], a[228:231], a[132:135], v[228:231]
    ds_read_b128 a[228:231], v249 offset:320
    v_cvt_pk_bf16_f32 v180, v196, v197
    v_mfma_f32_16x16x16_bf16 v[204:207], v[136:137], v[172:173], v[204:207]
    v_exp_f32 v198, v198
    v_mfma_f32_16x16x32_bf16 v[228:231], a[232:235], a[136:139], v[228:231]
    ds_read_b128 a[232:235], v249 offset:6656
    s_waitcnt lgkmcnt(3)
    v_sub_f32 v200, v200, v248
    v_mfma_f32_16x16x32_bf16 v[208:211], v[150:153], v[168:171], v[208:211]
    v_exp_f32 v199, v199
    v_mfma_f32_16x16x32_bf16 v[228:231], a[236:239], a[140:143], v[228:231]
    ds_read_b128 a[236:239], v249 offset:6720
    v_cvt_pk_bf16_f32 v183, v198, v199
    v_mfma_f32_16x16x32_bf16 v[232:235], a[144:147], a[240:243], 0
    ds_read_b128 v[196:199], v245 offset:320
    v_sub_f32 v201, v201, v248
    v_mfma_f32_16x16x16_bf16 v[208:211], v[154:155], v[172:173], v[208:211]
    v_exp_f32 v200, v200
    v_mfma_f32_16x16x32_bf16 v[232:235], a[148:151], a[244:247], v[232:235]
    v_cvt_pk_bf16_f32 v79, v228, v229
    v_cvt_pk_bf16_f32 v82, v230, v231
    v_mfma_f32_16x16x32_bf16 v[232:235], a[152:155], a[216:219], v[232:235]
    v_exp_f32 v201, v201
    v_mfma_f32_16x16x32_bf16 v[232:235], a[156:159], a[220:223], v[232:235]
    s_waitcnt lgkmcnt(3)
    v_sub_f32 v202, v202, v248
    v_sub_f32 v203, v203, v248
    v_mfma_f32_16x16x32_bf16 v[232:235], a[160:163], a[224:227], v[232:235]
    v_exp_f32 v202, v202
    v_mfma_f32_16x16x32_bf16 v[232:235], a[164:167], a[228:231], v[232:235]
    v_exp_f32 v203, v203
    v_mfma_f32_16x16x32_bf16 v[236:239], a[168:171], a[240:243], 0
    v_cvt_pk_bf16_f32 v194, v200, v201
    v_cvt_pk_bf16_f32 v181, v202, v203
    v_mfma_f32_16x16x32_bf16 v[236:239], a[172:175], a[244:247], v[236:239]
    ds_read_b128 v[200:203], v246 offset:320
    s_waitcnt lgkmcnt(1)
    v_sub_f32 v204, v204, v248
    v_mfma_f32_16x16x32_bf16 v[196:199], v[162:165], v[168:171], v[196:199]
    v_cvt_pk_bf16_f32 v232, v232, v233
    v_cvt_pk_bf16_f32 v233, v234, v235
    v_mfma_f32_16x16x32_bf16 v[236:239], a[176:179], a[216:219], v[236:239]
    v_exp_f32 v204, v204
    v_mfma_f32_16x16x32_bf16 v[236:239], a[180:183], a[220:223], v[236:239]
    v_sub_f32 v205, v205, v248
    v_sub_f32 v206, v206, v248
    v_mfma_f32_16x16x16_bf16 v[196:199], v[166:167], v[172:173], v[196:199]
    v_exp_f32 v205, v205
    v_mfma_f32_16x16x32_bf16 v[236:239], a[184:187], a[224:227], v[236:239]
    v_exp_f32 v206, v206
    v_mfma_f32_16x16x32_bf16 v[236:239], a[188:191], a[228:231], v[236:239]
    v_sub_f32 v207, v207, v248
    v_cvt_pk_bf16_f32 v195, v204, v205
    v_mfma_f32_16x16x32_bf16 v[228:231], a[192:195], a[240:243], 0
    ds_read_b128 a[240:243], v249 offset:6784
    v_sub_f32 v208, v208, v248
    v_mfma_f32_16x16x32_bf16 v[212:215], v[4:7], v[192:195], v[212:215]
    v_exp_f32 v207, v207
    v_mfma_f32_16x16x32_bf16 v[216:219], v[34:37], v[192:195], v[216:219]
    s_waitcnt lgkmcnt(1)
    v_cvt_pk_bf16_f32 v234, v236, v237
    v_cvt_pk_bf16_f32 v235, v238, v239
    v_mfma_f32_16x16x32_bf16 v[220:223], v[64:67], v[192:195], v[220:223]
    buffer_store_dwordx4 v[232:235], v250, s[20:23], 0 offen
    v_mfma_f32_16x16x32_bf16 v[224:227], a[248:251], v[192:195], v[224:227]
    v_cvt_pk_bf16_f32 v182, v206, v207
    v_mul_i32_i24 v250, s30, v255
    v_mfma_f32_16x16x32_bf16 v[200:203], v[90:93], v[168:171], v[200:203]
    ds_read_b128 v[204:207], v244 offset:0
    v_and_b32 v255, 3, v254
    v_mfma_f32_16x16x32_bf16 v[212:215], v[8:11], v[180:183], v[212:215]
    ds_read_b64 v[168:169], v247 offset:39936
    v_mad_i32_i24 v250, v255, s31, v250
    v_mfma_f32_16x16x32_bf16 v[216:219], v[38:41], v[180:183], v[216:219]
    ds_read_b64 v[170:171], v247 offset:39968
    v_add_u32 v250, s58, v250
    v_mfma_f32_16x16x32_bf16 v[220:223], v[68:71], v[180:183], v[220:223]
    s_mul_i32 s58, s30, 15
    v_lshrrev_b32 v254, 4, v254
    v_sub_f32 v209, v209, v248
    v_mfma_f32_16x16x32_bf16 v[224:227], a[248:251], v[180:183], v[224:227]
    s_add_u32 s58, s58, s59
    v_exp_f32 v208, v208
    v_mfma_f32_16x16x16_bf16 v[200:203], v[94:95], v[172:173], v[200:203]
    ds_read_b64 v[172:173], v247 offset:40000
    s_add_u32 s58, s58, s32
    v_sub_f32 v196, v196, v248
    v_mfma_f32_16x16x32_bf16 v[228:231], a[196:199], a[244:247], v[228:231]
    ds_read_b128 a[244:247], v249 offset:6848
    s_add_u32 s58, s58, s39
    v_sub_f32 v197, v197, v248
    v_mfma_f32_16x16x32_bf16 v[228:231], a[200:203], a[216:219], v[228:231]
    ds_read_b128 a[216:219], v249 offset:6912
    v_sub_f32 v200, v200, v248
    v_mfma_f32_16x16x32_bf16 v[228:231], a[204:207], a[220:223], v[228:231]
    ds_read_b128 a[220:223], v249 offset:6976
    s_waitcnt lgkmcnt(6)
    v_sub_f32 v201, v201, v248
    v_mfma_f32_16x16x32_bf16 v[204:207], v[144:147], v[174:177], v[204:207]
    v_exp_f32 v209, v209
    v_mfma_f32_16x16x32_bf16 v[228:231], a[208:211], a[224:227], v[228:231]
    ds_read_b128 a[224:227], v240 offset:6144
    v_cvt_pk_bf16_f32 v186, v208, v209
    v_mfma_f32_16x16x32_bf16 v[228:231], a[212:215], a[228:231], v[228:231]
    ds_read_b128 v[208:211], v245 offset:0
    v_mfma_f32_16x16x16_bf16 v[204:207], v[148:149], v[178:179], v[204:207]
    ds_read_b128 a[228:231], v241 offset:6144
    v_mfma_f32_16x16x32_bf16 v[232:235], a[144:147], a[232:235], 0
    v_exp_f32 v196, v196
    v_mfma_f32_16x16x32_bf16 v[232:235], a[148:151], a[236:239], v[232:235]
    v_exp_f32 v197, v197
    v_mfma_f32_16x16x32_bf16 v[232:235], a[152:155], a[240:243], v[232:235]
    s_waitcnt lgkmcnt(5)
    v_cvt_pk_bf16_f32 v228, v228, v229
    v_cvt_pk_bf16_f32 v229, v230, v231
    v_mfma_f32_16x16x32_bf16 v[232:235], a[156:159], a[244:247], v[232:235]
    buffer_store_dwordx2 v[228:229], v251, s[20:23], 0 offen offset:64
    v_mfma_f32_16x16x32_bf16 v[236:239], a[168:171], a[232:235], 0
    s_waitcnt lgkmcnt(3)
    v_lshl_add_u32 v251, v254, 3, v250
    v_lshl_add_u32 v250, v254, 4, v250
    v_mfma_f32_16x16x32_bf16 v[232:235], a[160:163], a[216:219], v[232:235]
    v_mbcnt_lo_u32_b32 v254, -1, 0
    v_mbcnt_hi_u32_b32 v254, -1, v254
    v_mfma_f32_16x16x32_bf16 v[232:235], a[164:167], a[220:223], v[232:235]
    v_bfe_u32 v255, v254, 2, 2
    v_cvt_pk_bf16_f32 v184, v196, v197
    v_mfma_f32_16x16x32_bf16 v[236:239], a[172:175], a[236:239], v[236:239]
    ds_read_b128 v[196:199], v246 offset:0
    s_waitcnt lgkmcnt(1)
    v_max_f32 v248, v204, v205
    v_mfma_f32_16x16x32_bf16 v[208:211], v[108:111], v[174:177], v[208:211]
    v_exp_f32 v200, v200
    v_mfma_f32_16x16x32_bf16 v[236:239], a[176:179], a[240:243], v[236:239]
    v_cvt_pk_bf16_f32 v232, v232, v233
    v_cvt_pk_bf16_f32 v233, v234, v235
    v_mfma_f32_16x16x32_bf16 v[236:239], a[180:183], a[244:247], v[236:239]
    v_exp_f32 v201, v201
    v_mfma_f32_16x16x16_bf16 v[208:211], v[112:113], v[178:179], v[208:211]
    v_cvt_pk_bf16_f32 v185, v200, v201
    v_max3_f32 v248, v248, v206, v207
    v_mfma_f32_16x16x32_bf16 v[236:239], a[184:187], a[216:219], v[236:239]
    ds_read_b128 v[200:203], v244 offset:64
    v_mfma_f32_16x16x32_bf16 v[212:215], v[12:15], v[184:187], v[212:215]
    ds_read_b128 v[204:207], v245 offset:64
    v_mfma_f32_16x16x32_bf16 v[216:219], v[42:45], v[184:187], v[216:219]
    v_mfma_f32_16x16x32_bf16 v[220:223], v[72:75], v[184:187], v[220:223]
    v_max3_f32 v248, v248, v208, v209
    v_max3_f32 v248, v248, v210, v211
    v_mfma_f32_16x16x32_bf16 v[224:227], a[248:251], v[184:187], v[224:227]
    ds_read_b128 v[208:211], v246 offset:64
    s_waitcnt lgkmcnt(3)
    v_mfma_f32_16x16x32_bf16 v[196:199], v[132:135], v[174:177], v[196:199]
    v_mfma_f32_16x16x32_bf16 v[236:239], a[188:191], a[220:223], v[236:239]
    v_mfma_f32_16x16x32_bf16 v[228:231], a[192:195], a[232:235], 0
    ds_read_b128 a[232:235], v240 offset:6272
    v_mfma_f32_16x16x32_bf16 v[228:231], a[196:199], a[236:239], v[228:231]
    ds_read_b128 a[236:239], v241 offset:6272
    s_waitcnt lgkmcnt(4)
    v_mfma_f32_16x16x16_bf16 v[196:199], v[136:137], v[178:179], v[196:199]
    v_rcp_f32 v252, v224
    v_mfma_f32_16x16x32_bf16 v[200:203], v[150:153], v[174:177], v[200:203]
    s_waitcnt lgkmcnt(3)
    v_mul_f32 v212, v212, v252
    v_mul_f32 v213, v213, v252
    v_mfma_f32_16x16x32_bf16 v[204:207], v[162:165], v[174:177], v[204:207]
    v_mul_f32 v214, v214, v252
    v_mul_f32 v215, v215, v252
    v_mfma_f32_16x16x16_bf16 v[200:203], v[154:155], v[178:179], v[200:203]
    v_cvt_pk_bf16_f32 v212, v212, v213
    v_cvt_pk_bf16_f32 v213, v214, v215
    v_mfma_f32_16x16x32_bf16 v[228:231], a[200:203], a[240:243], v[228:231]
    ds_write_b64 v247, v[212:213] offset:26624
    v_mfma_f32_16x16x16_bf16 v[204:207], v[166:167], v[178:179], v[204:207]
    ds_read_b128 a[240:243], v240 offset:6400
    s_waitcnt lgkmcnt(4)
    v_mul_f32 v216, v216, v252
    v_mfma_f32_16x16x32_bf16 v[208:211], v[90:93], v[174:177], v[208:211]
    v_mul_f32 v217, v217, v252
    v_mul_f32 v218, v218, v252
    v_mfma_f32_16x16x32_bf16 v[228:231], a[204:207], a[244:247], v[228:231]
    ds_read_b128 a[244:247], v241 offset:6400
    v_mul_f32 v219, v219, v252
    v_mfma_f32_16x16x32_bf16 v[228:231], a[208:211], a[216:219], v[228:231]
    ds_read_b128 a[216:219], v249 offset:13312
    v_cvt_pk_bf16_f32 v216, v216, v217
    v_mfma_f32_16x16x16_bf16 v[208:211], v[94:95], v[178:179], v[208:211]
    v_cvt_pk_bf16_f32 v217, v218, v219
    v_mul_f32 v220, v220, v252
    v_mfma_f32_16x16x32_bf16 v[228:231], a[212:215], a[220:223], v[228:231]
    ds_write_b64 v247, v[216:217] offset:26656
    ds_read_b128 a[220:223], v249 offset:13376
    v_mul_f32 v221, v221, v252
    v_mul_f32 v222, v222, v252
    v_mul_f32 v223, v223, v252
    v_cvt_pk_bf16_f32 v220, v220, v221
    v_cvt_pk_bf16_f32 v221, v222, v223
    ds_write_b64 v247, v[220:221] offset:26688
    v_cvt_pk_bf16_f32 v234, v236, v237
    v_cvt_pk_bf16_f32 v235, v238, v239
    v_mfma_f32_16x16x32_bf16 v[236:239], a[24:27], a[224:227], 0
    buffer_store_dwordx4 v[232:235], v250, s[20:23], 0 offen
    v_mfma_f32_16x16x32_bf16 v[236:239], a[28:31], a[228:231], v[236:239]
    s_waitcnt lgkmcnt(4)
    v_cvt_pk_bf16_f32 v228, v228, v229
    v_cvt_pk_bf16_f32 v229, v230, v231
    v_mfma_f32_16x16x32_bf16 v[232:235], a[0:3], a[224:227], 0
    buffer_store_dwordx2 v[228:229], v251, s[20:23], 0 offen offset:64
    v_mfma_f32_16x16x32_bf16 v[232:235], a[4:7], a[228:231], v[232:235]
    v_add_u32 v250, s60, v250
    v_add_u32 v251, s60, v251
    v_mfma_f32_16x16x32_bf16 v[232:235], a[8:11], a[232:235], v[232:235]
    v_max3_f32 v248, v248, v196, v197
    v_max3_f32 v248, v248, v198, v199
    v_mfma_f32_16x16x32_bf16 v[232:235], a[12:15], a[236:239], v[232:235]
    ds_read_b128 v[196:199], v244 offset:128
    v_max3_f32 v248, v248, v200, v201
    v_mfma_f32_16x16x32_bf16 v[232:235], a[16:19], a[240:243], v[232:235]
    v_max3_f32 v248, v248, v202, v203
    v_max3_f32 v248, v248, v204, v205
    v_mfma_f32_16x16x32_bf16 v[232:235], a[20:23], a[244:247], v[232:235]
    ds_read_b128 v[200:203], v245 offset:128
    v_max3_f32 v248, v248, v206, v207
    v_mfma_f32_16x16x32_bf16 v[236:239], a[32:35], a[232:235], v[236:239]
    ds_read_b128 v[204:207], v246 offset:128
    v_max3_f32 v248, v248, v208, v209
    v_mfma_f32_16x16x32_bf16 v[236:239], a[36:39], a[236:239], v[236:239]
    v_max3_f32 v248, v248, v210, v211
    v_mfma_f32_16x16x32_bf16 v[236:239], a[40:43], a[240:243], v[236:239]
    ds_read_b128 v[208:211], v244 offset:0
    v_mfma_f32_16x16x32_bf16 v[236:239], a[44:47], a[244:247], v[236:239]
    v_mfma_f32_16x16x32_bf16 v[228:231], a[48:51], a[224:227], 0
    v_mfma_f32_16x16x32_bf16 v[228:231], a[52:55], a[228:231], v[228:231]
    v_mfma_f32_16x16x32_bf16 v[228:231], a[56:59], a[232:235], v[228:231]
    s_waitcnt lgkmcnt(3)
    v_mfma_f32_16x16x32_bf16 v[196:199], v[156:159], v[174:177], v[196:199]
    v_mfma_f32_16x16x32_bf16 v[228:231], a[60:63], a[236:239], v[228:231]
    s_waitcnt lgkmcnt(2)
    s_waitcnt lgkmcnt(1)
    v_mfma_f32_16x16x32_bf16 v[200:203], v[114:117], v[174:177], v[200:203]
    v_mfma_f32_16x16x32_bf16 v[204:207], v[138:141], v[174:177], v[204:207]
    v_mfma_f32_16x16x32_bf16 v[228:231], a[64:67], a[240:243], v[228:231]
    s_waitcnt lgkmcnt(0)
    v_mfma_f32_16x16x16_bf16 v[196:199], v[160:161], v[178:179], v[196:199]
    v_mfma_f32_16x16x32_bf16 v[208:211], v[144:147], v[174:177], v[208:211]
    v_cvt_pk_bf16_f32 v144, v232, v233
    v_cvt_pk_bf16_f32 v145, v234, v235
    v_mfma_f32_16x16x16_bf16 v[200:203], v[118:119], v[178:179], v[200:203]
    v_cvt_pk_bf16_f32 v146, v236, v237
    v_cvt_pk_bf16_f32 v147, v238, v239
    v_mfma_f32_16x16x16_bf16 v[204:207], v[142:143], v[178:179], v[204:207]
    v_mfma_f32_16x16x16_bf16 v[208:211], v[148:149], v[178:179], v[208:211]
    v_max3_f32 v248, v248, v196, v197
    v_mfma_f32_16x16x32_bf16 v[228:231], a[68:71], a[244:247], v[228:231]
    ds_read_b128 v[196:199], v245 offset:0
    v_mfma_f32_16x16x32_bf16 v[232:235], a[224:227], a[72:75], 0
    v_max3_f32 v248, v248, v200, v201
    v_mfma_f32_16x16x32_bf16 v[232:235], a[228:231], a[76:79], v[232:235]
    ds_read_b128 v[200:203], v246 offset:0
    v_max3_f32 v248, v248, v204, v205
    v_mfma_f32_16x16x32_bf16 v[232:235], a[232:235], a[80:83], v[232:235]
    ds_read_b128 v[204:207], v244 offset:64
    v_cvt_pk_bf16_f32 v148, v228, v229
    v_mfma_f32_16x16x32_bf16 v[232:235], a[236:239], a[84:87], v[232:235]
    v_cvt_pk_bf16_f32 v149, v230, v231
    v_mov_b32 v252, v248
    v_mfma_f32_16x16x32_bf16 v[232:235], a[240:243], a[88:91], v[232:235]
    v_mfma_f32_16x16x32_bf16 v[232:235], a[244:247], a[92:95], v[232:235]
    v_permlane16_swap_b32 v248, v252
    v_max_f32 v248, v248, v252
    v_mfma_f32_16x16x32_bf16 v[236:239], a[224:227], a[96:99], 0
    v_mov_b32 v252, v248
    v_mfma_f32_16x16x32_bf16 v[236:239], a[228:231], a[100:103], v[236:239]
    v_mfma_f32_16x16x32_bf16 v[236:239], a[232:235], a[104:107], v[236:239]
    s_waitcnt lgkmcnt(2)
    v_permlane32_swap_b32 v248, v252
    v_cvt_pk_bf16_f32 v25, v232, v233
    v_mfma_f32_16x16x32_bf16 v[196:199], v[108:111], v[174:177], v[196:199]
    v_cvt_pk_bf16_f32 v28, v234, v235
    v_max_f32 v248, v248, v252
    v_mfma_f32_16x16x32_bf16 v[236:239], a[236:239], a[108:111], v[236:239]
    s_waitcnt lgkmcnt(1)
    v_sub_f32 v208, v208, v248
    v_sub_f32 v209, v209, v248
    v_mfma_f32_16x16x16_bf16 v[196:199], v[112:113], v[178:179], v[196:199]
    s_waitcnt lgkmcnt(0)
    v_exp_f32 v208, v208
    v_mfma_f32_16x16x32_bf16 v[200:203], v[132:135], v[174:177], v[200:203]
    v_exp_f32 v209, v209
    v_mfma_f32_16x16x32_bf16 v[204:207], v[150:153], v[174:177], v[204:207]
    v_sub_f32 v210, v210, v248
    v_sub_f32 v211, v211, v248
    v_mfma_f32_16x16x32_bf16 v[236:239], a[240:243], a[112:115], v[236:239]
    v_exp_f32 v210, v210
    v_mfma_f32_16x16x16_bf16 v[200:203], v[136:137], v[178:179], v[200:203]
    v_exp_f32 v211, v211
    v_mfma_f32_16x16x16_bf16 v[204:207], v[154:155], v[178:179], v[204:207]
    v_cvt_pk_bf16_f32 v190, v208, v209
    v_cvt_pk_bf16_f32 v193, v210, v211
    v_mfma_f32_16x16x32_bf16 v[236:239], a[244:247], a[116:119], v[236:239]
    ds_read_b128 v[208:211], v245 offset:64
    v_sub_f32 v196, v196, v248
    v_mfma_f32_16x16x32_bf16 v[228:231], a[224:227], a[120:123], 0
    ds_read_b128 a[224:227], v249 offset:13440
    v_sub_f32 v197, v197, v248
    v_mfma_f32_16x16x32_bf16 v[228:231], a[228:231], a[124:127], v[228:231]
    ds_read_b128 a[228:231], v249 offset:13504
    v_sub_f32 v198, v198, v248
    v_mfma_f32_16x16x32_bf16 v[228:231], a[232:235], a[128:131], v[228:231]
    ds_read_b128 a[232:235], v249 offset:13568
    v_cvt_pk_bf16_f32 v55, v236, v237
    v_mfma_f32_16x16x32_bf16 v[228:231], a[236:239], a[132:135], v[228:231]
    ds_read_b128 a[236:239], v249 offset:13632
    v_cvt_pk_bf16_f32 v58, v238, v239
    v_mfma_f32_16x16x32_bf16 v[228:231], a[240:243], a[136:139], v[228:231]
    ds_read_b128 a[240:243], v249 offset:19968
    v_sub_f32 v199, v199, v248
    v_mfma_f32_16x16x32_bf16 v[228:231], a[244:247], a[140:143], v[228:231]
    ds_read_b128 a[244:247], v249 offset:20032
    v_sub_f32 v200, v200, v248
    v_mfma_f32_16x16x32_bf16 v[232:235], a[144:147], a[216:219], 0
    v_exp_f32 v196, v196
    v_mfma_f32_16x16x32_bf16 v[232:235], a[148:151], a[220:223], v[232:235]
    v_exp_f32 v197, v197
    v_mfma_f32_16x16x32_bf16 v[236:239], a[168:171], a[216:219], 0
    s_waitcnt lgkmcnt(6)
    v_cvt_pk_bf16_f32 v85, v228, v229
    v_cvt_pk_bf16_f32 v88, v230, v231
    v_mfma_f32_16x16x32_bf16 v[208:211], v[162:165], v[174:177], v[208:211]
    s_waitcnt lgkmcnt(5)
    v_exp_f32 v198, v198
    v_mfma_f32_16x16x32_bf16 v[232:235], a[152:155], a[224:227], v[232:235]
    s_waitcnt lgkmcnt(4)
    v_exp_f32 v199, v199
    v_mfma_f32_16x16x32_bf16 v[232:235], a[156:159], a[228:231], v[232:235]
    s_waitcnt lgkmcnt(3)
    v_cvt_pk_bf16_f32 v188, v196, v197
    v_cvt_pk_bf16_f32 v191, v198, v199
    v_mfma_f32_16x16x16_bf16 v[208:211], v[166:167], v[178:179], v[208:211]
    ds_read_b128 v[196:199], v246 offset:64
    v_sub_f32 v201, v201, v248
    v_mfma_f32_16x16x32_bf16 v[232:235], a[160:163], a[232:235], v[232:235]
    s_waitcnt lgkmcnt(2)
    v_exp_f32 v200, v200
    v_mfma_f32_16x16x32_bf16 v[232:235], a[164:167], a[236:239], v[232:235]
    v_exp_f32 v201, v201
    v_mfma_f32_16x16x32_bf16 v[236:239], a[172:175], a[220:223], v[236:239]
    v_sub_f32 v202, v202, v248
    v_sub_f32 v203, v203, v248
    v_mfma_f32_16x16x32_bf16 v[236:239], a[176:179], a[224:227], v[236:239]
    v_exp_f32 v202, v202
    v_mfma_f32_16x16x32_bf16 v[236:239], a[180:183], a[228:231], v[236:239]
    v_exp_f32 v203, v203
    v_mfma_f32_16x16x32_bf16 v[236:239], a[184:187], a[232:235], v[236:239]
    v_cvt_pk_bf16_f32 v232, v232, v233
    v_cvt_pk_bf16_f32 v233, v234, v235
    v_mfma_f32_16x16x32_bf16 v[236:239], a[188:191], a[236:239], v[236:239]
    v_cvt_pk_bf16_f32 v189, v200, v201
    v_cvt_pk_bf16_f32 v192, v202, v203
    v_mfma_f32_16x16x32_bf16 v[228:231], a[192:195], a[216:219], 0
    ds_read_b128 v[200:203], v244 offset:128
    s_waitcnt lgkmcnt(1)
    v_sub_f32 v204, v204, v248
    v_mfma_f32_16x16x32_bf16 v[212:215], v[6:9], v[188:191], 0
    ds_read_b128 a[216:219], v249 offset:20096
    v_cvt_pk_bf16_f32 v234, v236, v237
    v_mfma_f32_16x16x32_bf16 v[216:219], v[36:39], v[188:191], 0
    v_cvt_pk_bf16_f32 v235, v238, v239
    v_sub_f32 v205, v205, v248
    v_mfma_f32_16x16x32_bf16 v[220:223], v[66:69], v[188:191], 0
    buffer_store_dwordx4 v[232:235], v250, s[20:23], 0 offen
    v_mfma_f32_16x16x32_bf16 v[224:227], a[248:251], v[188:191], 0
    v_exp_f32 v204, v204
    v_mfma_f32_16x16x32_bf16 v[196:199], v[90:93], v[174:177], v[196:199]
    v_add_u32 v250, s62, v250
    v_sub_f32 v206, v206, v248
    v_mfma_f32_16x16x32_bf16 v[228:231], a[196:199], a[220:223], v[228:231]
    ds_read_b128 a[220:223], v249 offset:20160
    v_sub_f32 v207, v207, v248
    v_mfma_f32_16x16x32_bf16 v[228:231], a[200:203], a[224:227], v[228:231]
    ds_read_b128 a[224:227], v249 offset:20224
    v_sub_f32 v208, v208, v248
    v_mfma_f32_16x16x16_bf16 v[196:199], v[94:95], v[178:179], v[196:199]
    s_waitcnt lgkmcnt(3)
    v_exp_f32 v205, v205
    v_mfma_f32_16x16x32_bf16 v[200:203], v[156:159], v[174:177], v[200:203]
    v_exp_f32 v206, v206
    v_mfma_f32_16x16x32_bf16 v[228:231], a[204:207], a[228:231], v[228:231]
    ds_read_b128 a[228:231], v249 offset:20288
    v_cvt_pk_bf16_f32 v180, v204, v205
    v_mfma_f32_16x16x32_bf16 v[228:231], a[208:211], a[232:235], v[228:231]
    v_exp_f32 v207, v207
    v_mfma_f32_16x16x16_bf16 v[200:203], v[160:161], v[178:179], v[200:203]
    v_cvt_pk_bf16_f32 v183, v206, v207
    v_sub_f32 v209, v209, v248
    v_mfma_f32_16x16x32_bf16 v[228:231], a[212:215], a[236:239], v[228:231]
    ds_read_b128 v[204:207], v245 offset:128
    v_sub_f32 v210, v210, v248
    v_mfma_f32_16x16x32_bf16 v[232:235], a[144:147], a[240:243], 0
    v_exp_f32 v208, v208
    v_mfma_f32_16x16x32_bf16 v[232:235], a[148:151], a[244:247], v[232:235]
    s_waitcnt lgkmcnt(3)
    v_exp_f32 v209, v209
    v_mfma_f32_16x16x32_bf16 v[232:235], a[152:155], a[216:219], v[232:235]
    v_cvt_pk_bf16_f32 v228, v228, v229
    v_cvt_pk_bf16_f32 v229, v230, v231
    v_mfma_f32_16x16x32_bf16 v[232:235], a[156:159], a[220:223], v[232:235]
    buffer_store_dwordx2 v[228:229], v251, s[20:23], 0 offen offset:64
    v_mfma_f32_16x16x32_bf16 v[236:239], a[168:171], a[240:243], 0
    s_waitcnt lgkmcnt(2)
    v_add_u32 v251, s62, v251
    v_sub_f32 v211, v211, v248
    v_mfma_f32_16x16x32_bf16 v[232:235], a[160:163], a[224:227], v[232:235]
    s_waitcnt lgkmcnt(1)
    v_exp_f32 v210, v210
    v_mfma_f32_16x16x32_bf16 v[232:235], a[164:167], a[228:231], v[232:235]
    v_exp_f32 v211, v211
    v_mfma_f32_16x16x32_bf16 v[236:239], a[172:175], a[244:247], v[236:239]
    v_cvt_pk_bf16_f32 v194, v208, v209
    v_cvt_pk_bf16_f32 v181, v210, v211
    v_mfma_f32_16x16x32_bf16 v[236:239], a[176:179], a[216:219], v[236:239]
    ds_read_b128 v[208:211], v246 offset:128
    s_waitcnt lgkmcnt(1)
    v_sub_f32 v196, v196, v248
    v_mfma_f32_16x16x32_bf16 v[204:207], v[114:117], v[174:177], v[204:207]
    v_cvt_pk_bf16_f32 v232, v232, v233
    v_cvt_pk_bf16_f32 v233, v234, v235
    v_mfma_f32_16x16x32_bf16 v[236:239], a[180:183], a[220:223], v[236:239]
    v_exp_f32 v196, v196
    v_mfma_f32_16x16x32_bf16 v[236:239], a[184:187], a[224:227], v[236:239]
    v_sub_f32 v197, v197, v248
    v_sub_f32 v198, v198, v248
    v_mfma_f32_16x16x16_bf16 v[204:207], v[118:119], v[178:179], v[204:207]
    v_exp_f32 v197, v197
    v_mfma_f32_16x16x32_bf16 v[236:239], a[188:191], a[228:231], v[236:239]
    v_exp_f32 v198, v198
    v_mfma_f32_16x16x32_bf16 v[228:231], a[192:195], a[240:243], 0
    v_sub_f32 v199, v199, v248
    v_cvt_pk_bf16_f32 v195, v196, v197
    v_mfma_f32_16x16x32_bf16 v[228:231], a[196:199], a[244:247], v[228:231]
    v_exp_f32 v199, v199
    v_mfma_f32_16x16x32_bf16 v[212:215], v[10:13], v[192:195], v[212:215]
    v_cvt_pk_bf16_f32 v182, v198, v199
    v_cvt_pk_bf16_f32 v234, v236, v237
    v_mfma_f32_16x16x32_bf16 v[216:219], v[40:43], v[192:195], v[216:219]
    ds_read_b128 v[196:199], v244 offset:0
    s_waitcnt lgkmcnt(1)
    v_cvt_pk_bf16_f32 v235, v238, v239
    v_mfma_f32_16x16x32_bf16 v[220:223], v[70:73], v[192:195], v[220:223]
    buffer_store_dwordx4 v[232:235], v250, s[20:23], 0 offen
    v_mfma_f32_16x16x32_bf16 v[224:227], a[248:251], v[192:195], v[224:227]
    v_sub_f32 v200, v200, v248
    v_add_u32 v250, s64, v250
    v_mfma_f32_16x16x32_bf16 v[212:215], v[14:17], v[180:183], v[212:215]
    v_exp_f32 v200, v200
    v_mfma_f32_16x16x32_bf16 v[216:219], v[44:47], v[180:183], v[216:219]
    v_sub_f32 v201, v201, v248
    v_sub_f32 v204, v204, v248
    v_mfma_f32_16x16x32_bf16 v[220:223], v[74:77], v[180:183], v[220:223]
    v_exp_f32 v201, v201
    v_mfma_f32_16x16x32_bf16 v[224:227], a[248:251], v[180:183], v[224:227]
    v_cvt_pk_bf16_f32 v186, v200, v201
    v_sub_f32 v205, v205, v248
    v_mfma_f32_16x16x32_bf16 v[208:211], v[138:141], v[174:177], v[208:211]
    ds_read_b128 v[200:203], v245 offset:0
    v_mfma_f32_16x16x32_bf16 v[228:231], a[200:203], a[216:219], v[228:231]
    s_waitcnt lgkmcnt(1)
    v_exp_f32 v204, v204
    v_mfma_f32_16x16x32_bf16 v[196:199], v[150:153], v[168:171], v[196:199]
    v_exp_f32 v205, v205
    v_mfma_f32_16x16x16_bf16 v[208:211], v[142:143], v[178:179], v[208:211]
    v_cvt_pk_bf16_f32 v184, v204, v205
    v_mfma_f32_16x16x32_bf16 v[228:231], a[204:207], a[220:223], v[228:231]
    ds_read_b128 v[204:207], v246 offset:0
    v_mfma_f32_16x16x32_bf16 v[228:231], a[208:211], a[224:227], v[228:231]
    v_mfma_f32_16x16x16_bf16 v[196:199], v[154:155], v[172:173], v[196:199]
    v_mfma_f32_16x16x32_bf16 v[228:231], a[212:215], a[228:231], v[228:231]
    s_nop 1
    v_sub_f32 v208, v208, v248
    v_exp_f32 v208, v208
    v_sub_f32 v209, v209, v248
    v_exp_f32 v209, v209
    s_waitcnt lgkmcnt(1)
    v_mfma_f32_16x16x32_bf16 v[200:203], v[162:165], v[168:171], v[200:203]
    v_cvt_pk_bf16_f32 v228, v228, v229
    v_cvt_pk_bf16_f32 v229, v230, v231
    buffer_store_dwordx2 v[228:229], v251, s[20:23], 0 offen offset:64
    v_add_u32 v251, s64, v251
    v_cvt_pk_bf16_f32 v185, v208, v209
    ds_read_b128 v[208:211], v244 offset:64
    v_mfma_f32_16x16x16_bf16 v[200:203], v[166:167], v[172:173], v[200:203]
    s_waitcnt lgkmcnt(1)
    v_max_f32 v248, v196, v197
    v_max3_f32 v248, v248, v198, v199
    v_mfma_f32_16x16x32_bf16 v[212:215], v[18:21], v[184:187], v[212:215]
    ds_read_b128 v[196:199], v245 offset:64
    v_mfma_f32_16x16x32_bf16 v[216:219], v[48:51], v[184:187], v[216:219]
    v_mfma_f32_16x16x32_bf16 v[220:223], v[78:81], v[184:187], v[220:223]
    v_mfma_f32_16x16x32_bf16 v[224:227], a[248:251], v[184:187], v[224:227]
    v_max3_f32 v248, v248, v200, v201
    v_max3_f32 v248, v248, v202, v203
    v_mfma_f32_16x16x32_bf16 v[204:207], v[90:93], v[168:171], v[204:207]
    ds_read_b128 v[200:203], v246 offset:64
    s_nop 3
    v_rcp_f32 v252, v224
    v_mfma_f32_16x16x16_bf16 v[204:207], v[94:95], v[172:173], v[204:207]
    v_mul_f32 v212, v212, v252
    s_waitcnt lgkmcnt(2)
    v_mfma_f32_16x16x32_bf16 v[208:211], v[156:159], v[168:171], v[208:211]
    v_mul_f32 v213, v213, v252
    v_mul_f32 v214, v214, v252
    v_mul_f32 v215, v215, v252
    v_cvt_pk_bf16_f32 v212, v212, v213
    s_waitcnt lgkmcnt(1)
    v_mfma_f32_16x16x32_bf16 v[196:199], v[114:117], v[168:171], v[196:199]
    v_cvt_pk_bf16_f32 v213, v214, v215
    v_mul_f32 v216, v216, v252
    v_mfma_f32_16x16x16_bf16 v[208:211], v[160:161], v[172:173], v[208:211]
    ds_write_b64 v247, v[212:213] offset:33280
    v_mul_f32 v217, v217, v252
    v_mul_f32 v218, v218, v252
    v_mfma_f32_16x16x16_bf16 v[196:199], v[118:119], v[172:173], v[196:199]
    v_mul_f32 v219, v219, v252
    v_cvt_pk_bf16_f32 v216, v216, v217
    s_waitcnt lgkmcnt(1)
    v_mfma_f32_16x16x32_bf16 v[200:203], v[138:141], v[168:171], v[200:203]
    v_cvt_pk_bf16_f32 v217, v218, v219
    v_mul_f32 v220, v220, v252
    ds_write_b64 v247, v[216:217] offset:33312
    v_mul_f32 v221, v221, v252
    v_mul_f32 v222, v222, v252
    v_mul_f32 v223, v223, v252
    v_mfma_f32_16x16x16_bf16 v[200:203], v[142:143], v[172:173], v[200:203]
    v_cvt_pk_bf16_f32 v220, v220, v221
    v_cvt_pk_bf16_f32 v221, v222, v223
    ds_write_b64 v247, v[220:221] offset:33344
    v_max3_f32 v248, v248, v204, v205
    v_max3_f32 v248, v248, v206, v207
    ds_read_b128 v[204:207], v244 offset:128
    v_max3_f32 v248, v248, v208, v209
    v_max3_f32 v248, v248, v210, v211
    ds_read_b128 v[208:211], v245 offset:128
    v_max3_f32 v248, v248, v196, v197
    v_max3_f32 v248, v248, v198, v199
    ds_read_b128 v[196:199], v246 offset:128
    v_max3_f32 v248, v248, v200, v201
    v_max3_f32 v248, v248, v202, v203
    ds_read_b128 v[200:203], v244 offset:0
    s_waitcnt lgkmcnt(4)
    s_barrier
    ds_read_b128 a[232:235], v249 offset:26624
    ds_read_b128 a[236:239], v249 offset:26688
    ds_read_b128 a[240:243], v249 offset:26752
    ds_read_b128 a[244:247], v249 offset:26816
    ds_read_b128 a[216:219], v249 offset:26880
    s_waitcnt lgkmcnt(8)
    v_mfma_f32_16x16x32_bf16 v[204:207], v[96:99], v[168:171], v[204:207]
    ds_read_b128 a[220:223], v249 offset:26944
    ds_read_b128 a[224:227], v249 offset:33280
    s_waitcnt lgkmcnt(9)
    v_mfma_f32_16x16x32_bf16 v[208:211], v[120:123], v[168:171], v[208:211]
    ds_read_b128 a[228:231], v249 offset:33344
    ds_read_b64 v[174:175], v247 offset:46592
    v_mfma_f32_16x16x16_bf16 v[204:207], v[100:101], v[172:173], v[204:207]
    s_waitcnt lgkmcnt(10)
    ds_read_b64 v[176:177], v247 offset:46624
    v_mfma_f32_16x16x32_bf16 v[196:199], v[144:147], v[168:171], v[196:199]
    ds_read_b64 v[178:179], v247 offset:46656
    s_waitcnt lgkmcnt(11)
    v_mfma_f32_16x16x16_bf16 v[208:211], v[124:125], v[172:173], v[208:211]
    v_mfma_f32_16x16x32_bf16 v[200:203], v[150:153], v[168:171], v[200:203]
    s_nop 0
    v_max3_f32 v248, v248, v204, v205
    v_mfma_f32_16x16x16_bf16 v[196:199], v[148:149], v[172:173], v[196:199]
    s_waitcnt lgkmcnt(10)
    ds_read_b128 v[204:207], v245 offset:0
    v_mfma_f32_16x16x32_bf16 v[232:235], a[144:147], a[232:235], 0
    s_waitcnt lgkmcnt(9)
    v_max3_f32 v248, v248, v208, v209
    v_mfma_f32_16x16x16_bf16 v[200:203], v[154:155], v[172:173], v[200:203]
    ds_read_b128 v[208:211], v246 offset:0
    v_mfma_f32_16x16x32_bf16 v[232:235], a[148:151], a[236:239], v[232:235]
    v_max3_f32 v248, v248, v196, v197
    v_mov_b32 v252, v248
    v_mfma_f32_16x16x32_bf16 v[232:235], a[152:155], a[240:243], v[232:235]
    ds_read_b128 v[196:199], v244 offset:64
    s_waitcnt lgkmcnt(5)
    v_permlane16_swap_b32 v248, v252
    v_mfma_f32_16x16x32_bf16 v[232:235], a[156:159], a[244:247], v[232:235]
    v_max_f32 v248, v248, v252
    v_mov_b32 v252, v248
    v_mfma_f32_16x16x32_bf16 v[232:235], a[160:163], a[216:219], v[232:235]
    v_mfma_f32_16x16x32_bf16 v[232:235], a[164:167], a[220:223], v[232:235]
    v_permlane32_swap_b32 v248, v252
    v_max_f32 v248, v248, v252
    v_mfma_f32_16x16x32_bf16 v[236:239], a[168:171], a[232:235], 0
    v_sub_f32 v200, v200, v248
    v_sub_f32 v201, v201, v248
    v_mfma_f32_16x16x32_bf16 v[236:239], a[172:175], a[236:239], v[236:239]
    s_waitcnt lgkmcnt(2)
    v_exp_f32 v200, v200
    v_mfma_f32_16x16x32_bf16 v[204:207], v[162:165], v[168:171], v[204:207]
    v_cvt_pk_bf16_f32 v232, v232, v233
    v_cvt_pk_bf16_f32 v233, v234, v235
    v_mfma_f32_16x16x32_bf16 v[236:239], a[176:179], a[240:243], v[236:239]
    s_waitcnt lgkmcnt(1)
    v_exp_f32 v201, v201
    v_mfma_f32_16x16x32_bf16 v[208:211], v[90:93], v[168:171], v[208:211]
    v_sub_f32 v202, v202, v248
    v_sub_f32 v203, v203, v248
    v_mfma_f32_16x16x16_bf16 v[204:207], v[166:167], v[172:173], v[204:207]
    s_waitcnt lgkmcnt(0)
    v_exp_f32 v202, v202
    v_mfma_f32_16x16x32_bf16 v[196:199], v[156:159], v[168:171], v[196:199]
    v_exp_f32 v203, v203
    v_mfma_f32_16x16x16_bf16 v[208:211], v[94:95], v[172:173], v[208:211]
    v_cvt_pk_bf16_f32 v190, v200, v201
    v_cvt_pk_bf16_f32 v193, v202, v203
    v_mfma_f32_16x16x32_bf16 v[236:239], a[180:183], a[244:247], v[236:239]
    ds_read_b128 v[200:203], v245 offset:64
    v_sub_f32 v204, v204, v248
    v_mfma_f32_16x16x16_bf16 v[196:199], v[160:161], v[172:173], v[196:199]
    v_exp_f32 v204, v204
    v_mfma_f32_16x16x32_bf16 v[236:239], a[184:187], a[216:219], v[236:239]
    v_sub_f32 v205, v205, v248
    v_sub_f32 v206, v206, v248
    v_mfma_f32_16x16x32_bf16 v[236:239], a[188:191], a[220:223], v[236:239]
    v_exp_f32 v205, v205
    v_mfma_f32_16x16x32_bf16 v[228:231], a[192:195], a[232:235], 0
    ds_read_b128 a[232:235], v249 offset:33408
    v_sub_f32 v207, v207, v248
    v_mfma_f32_16x16x32_bf16 v[228:231], a[196:199], a[236:239], v[228:231]
    ds_read_b128 a[236:239], v249 offset:33472
    v_cvt_pk_bf16_f32 v188, v204, v205
    v_mfma_f32_16x16x32_bf16 v[228:231], a[200:203], a[240:243], v[228:231]
    ds_read_b128 a[240:243], v249 offset:33536
    v_cvt_pk_bf16_f32 v234, v236, v237
    v_mfma_f32_16x16x32_bf16 v[228:231], a[204:207], a[244:247], v[228:231]
    ds_read_b128 a[244:247], v249 offset:33600
    v_cvt_pk_bf16_f32 v235, v238, v239
    v_mfma_f32_16x16x32_bf16 v[228:231], a[208:211], a[216:219], v[228:231]
    buffer_store_dwordx4 v[232:235], v250, s[20:23], 0 offen
    v_mfma_f32_16x16x32_bf16 v[228:231], a[212:215], a[220:223], v[228:231]
    s_waitcnt lgkmcnt(4)
    v_add_u32 v250, s50, v250
    v_sub_f32 v208, v208, v248
    v_mfma_f32_16x16x32_bf16 v[200:203], v[114:117], v[168:171], v[200:203]
    v_exp_f32 v206, v206
    v_mfma_f32_16x16x32_bf16 v[232:235], a[144:147], a[224:227], 0
    v_exp_f32 v207, v207
    v_mfma_f32_16x16x32_bf16 v[232:235], a[148:151], a[228:231], v[232:235]
    s_waitcnt lgkmcnt(3)
    v_cvt_pk_bf16_f32 v228, v228, v229
    v_cvt_pk_bf16_f32 v229, v230, v231
    v_mfma_f32_16x16x16_bf16 v[200:203], v[118:119], v[172:173], v[200:203]
    buffer_store_dwordx2 v[228:229], v251, s[20:23], 0 offen offset:64
    v_mfma_f32_16x16x32_bf16 v[232:235], a[152:155], a[232:235], v[232:235]
    s_waitcnt lgkmcnt(1)
    v_add_u32 v251, s50, v251
    v_cvt_pk_bf16_f32 v191, v206, v207
    v_mfma_f32_16x16x32_bf16 v[232:235], a[156:159], a[236:239], v[232:235]
    ds_read_b128 v[204:207], v246 offset:64
    v_sub_f32 v209, v209, v248
    v_mfma_f32_16x16x32_bf16 v[232:235], a[160:163], a[240:243], v[232:235]
    s_waitcnt lgkmcnt(1)
    v_exp_f32 v208, v208
    v_mfma_f32_16x16x32_bf16 v[232:235], a[164:167], a[244:247], v[232:235]
    v_exp_f32 v209, v209
    v_mfma_f32_16x16x32_bf16 v[236:239], a[168:171], a[224:227], 0
    v_sub_f32 v210, v210, v248
    v_sub_f32 v211, v211, v248
    v_mfma_f32_16x16x32_bf16 v[236:239], a[172:175], a[228:231], v[236:239]
    v_exp_f32 v210, v210
    v_mfma_f32_16x16x32_bf16 v[236:239], a[176:179], a[232:235], v[236:239]
    v_exp_f32 v211, v211
    v_mfma_f32_16x16x32_bf16 v[236:239], a[180:183], a[236:239], v[236:239]
    v_cvt_pk_bf16_f32 v232, v232, v233
    v_cvt_pk_bf16_f32 v233, v234, v235
    v_mfma_f32_16x16x32_bf16 v[236:239], a[184:187], a[240:243], v[236:239]
    v_cvt_pk_bf16_f32 v189, v208, v209
    v_cvt_pk_bf16_f32 v192, v210, v211
    v_mfma_f32_16x16x32_bf16 v[236:239], a[188:191], a[244:247], v[236:239]
    ds_read_b128 v[208:211], v244 offset:128
    s_waitcnt lgkmcnt(1)
    v_sub_f32 v196, v196, v248
    v_mfma_f32_16x16x32_bf16 v[212:215], v[12:15], v[188:191], 0
    v_exp_f32 v196, v196
    v_mfma_f32_16x16x32_bf16 v[216:219], v[42:45], v[188:191], 0
    v_sub_f32 v197, v197, v248
    v_sub_f32 v198, v198, v248
    v_mfma_f32_16x16x32_bf16 v[220:223], v[72:75], v[188:191], 0
    v_cvt_pk_bf16_f32 v234, v236, v237
    v_cvt_pk_bf16_f32 v235, v238, v239
    v_mfma_f32_16x16x32_bf16 v[224:227], a[248:251], v[188:191], 0
    buffer_store_dwordx4 v[232:235], v250, s[20:23], 0 offen
    v_mfma_f32_16x16x32_bf16 v[204:207], v[138:141], v[168:171], v[204:207]
    v_exp_f32 v197, v197
    v_mfma_f32_16x16x32_bf16 v[228:231], a[192:195], a[224:227], 0
    v_add_u32 v250, s52, v250
    v_sub_f32 v199, v199, v248
    v_mfma_f32_16x16x32_bf16 v[228:231], a[196:199], a[228:231], v[228:231]
    v_exp_f32 v198, v198
    v_mfma_f32_16x16x16_bf16 v[204:207], v[142:143], v[172:173], v[204:207]
    s_waitcnt lgkmcnt(0)
    v_exp_f32 v199, v199
    v_mfma_f32_16x16x32_bf16 v[208:211], v[96:99], v[168:171], v[208:211]
    v_cvt_pk_bf16_f32 v180, v196, v197
    v_cvt_pk_bf16_f32 v183, v198, v199
    v_mfma_f32_16x16x32_bf16 v[228:231], a[200:203], a[232:235], v[228:231]
    ds_read_b128 v[196:199], v245 offset:128
    v_sub_f32 v200, v200, v248
    v_mfma_f32_16x16x32_bf16 v[228:231], a[204:207], a[236:239], v[228:231]
    v_exp_f32 v200, v200
    v_mfma_f32_16x16x16_bf16 v[208:211], v[100:101], v[172:173], v[208:211]
    v_sub_f32 v201, v201, v248
    v_sub_f32 v202, v202, v248
    v_mfma_f32_16x16x32_bf16 v[228:231], a[208:211], a[240:243], v[228:231]
    v_exp_f32 v201, v201
    v_mfma_f32_16x16x32_bf16 v[228:231], a[212:215], a[244:247], v[228:231]
    v_exp_f32 v202, v202
    v_sub_f32 v203, v203, v248
    v_exp_f32 v203, v203
    v_cvt_pk_bf16_f32 v194, v200, v201
    v_cvt_pk_bf16_f32 v181, v202, v203
    ds_read_b128 v[200:203], v246 offset:128
    v_sub_f32 v204, v204, v248
    v_exp_f32 v204, v204
    v_cvt_pk_bf16_f32 v228, v228, v229
    v_cvt_pk_bf16_f32 v229, v230, v231
    buffer_store_dwordx2 v[228:229], v251, s[20:23], 0 offen offset:64
    s_waitcnt lgkmcnt(1)
    v_mfma_f32_16x16x32_bf16 v[196:199], v[120:123], v[168:171], v[196:199]
    v_add_u32 v251, s52, v251
    v_sub_f32 v205, v205, v248
    v_exp_f32 v205, v205
    v_sub_f32 v206, v206, v248
    v_exp_f32 v206, v206
    v_sub_f32 v207, v207, v248
    v_mfma_f32_16x16x16_bf16 v[196:199], v[124:125], v[172:173], v[196:199]
    v_exp_f32 v207, v207
    v_cvt_pk_bf16_f32 v195, v204, v205
    v_cvt_pk_bf16_f32 v182, v206, v207
    ds_read_b128 v[204:207], v244 offset:0
    v_mfma_f32_16x16x32_bf16 v[212:215], v[16:19], v[192:195], v[212:215]
    v_sub_f32 v208, v208, v248
    v_sub_f32 v209, v209, v248
    v_mfma_f32_16x16x32_bf16 v[216:219], v[46:49], v[192:195], v[216:219]
    s_waitcnt lgkmcnt(1)
    v_exp_f32 v208, v208
    v_mfma_f32_16x16x32_bf16 v[220:223], v[76:79], v[192:195], v[220:223]
    v_exp_f32 v209, v209
    v_mfma_f32_16x16x32_bf16 v[224:227], a[248:251], v[192:195], v[224:227]
    v_cvt_pk_bf16_f32 v186, v208, v209
    v_sub_f32 v196, v196, v248
    v_mfma_f32_16x16x32_bf16 v[212:215], v[20:23], v[180:183], v[212:215]
    ds_read_b128 v[208:211], v245 offset:0
    v_sub_f32 v197, v197, v248
    v_mfma_f32_16x16x32_bf16 v[216:219], v[50:53], v[180:183], v[216:219]
    v_exp_f32 v196, v196
    v_mfma_f32_16x16x32_bf16 v[220:223], v[80:83], v[180:183], v[220:223]
    v_exp_f32 v197, v197
    v_mfma_f32_16x16x32_bf16 v[224:227], a[248:251], v[180:183], v[224:227]
    v_cvt_pk_bf16_f32 v184, v196, v197
    s_waitcnt lgkmcnt(1)
    v_mfma_f32_16x16x32_bf16 v[200:203], v[144:147], v[168:171], v[200:203]
    ds_read_b128 v[196:199], v246 offset:0
    v_mfma_f32_16x16x32_bf16 v[204:207], v[156:159], v[174:177], v[204:207]
    ds_read_b64 v[168:169], v247 offset:53248
    ds_read_b64 v[170:171], v247 offset:53280
    s_nop 1
    v_mfma_f32_16x16x16_bf16 v[200:203], v[148:149], v[172:173], v[200:203]
    ds_read_b64 v[172:173], v247 offset:53312
    v_mfma_f32_16x16x16_bf16 v[204:207], v[160:161], v[178:179], v[204:207]
    s_nop 5
    v_sub_f32 v200, v200, v248
    v_exp_f32 v200, v200
    v_sub_f32 v201, v201, v248
    v_exp_f32 v201, v201
    v_max_f32 v248, v204, v205
    v_cvt_pk_bf16_f32 v185, v200, v201
    s_waitcnt lgkmcnt(4)
    v_mfma_f32_16x16x32_bf16 v[208:211], v[114:117], v[174:177], v[208:211]
    ds_read_b128 v[200:203], v244 offset:64
    v_max3_f32 v248, v248, v206, v207
    v_mfma_f32_16x16x32_bf16 v[212:215], v[24:27], v[184:187], v[212:215]
    ds_read_b128 v[204:207], v245 offset:64
    s_waitcnt lgkmcnt(5)
    v_mfma_f32_16x16x32_bf16 v[216:219], v[54:57], v[184:187], v[216:219]
    v_mfma_f32_16x16x32_bf16 v[220:223], v[84:87], v[184:187], v[220:223]
    v_mfma_f32_16x16x32_bf16 v[224:227], a[248:251], v[184:187], v[224:227]
    v_mov_b32 v186, 0
    v_mfma_f32_16x16x16_bf16 v[208:211], v[118:119], v[178:179], v[208:211]
    v_mfma_f32_16x16x32_bf16 v[196:199], v[138:141], v[174:177], v[196:199]
    s_nop 4
    v_rcp_f32 v252, v224
    v_mfma_f32_16x16x16_bf16 v[196:199], v[142:143], v[178:179], v[196:199]
    v_mul_f32 v212, v212, v252
    s_waitcnt lgkmcnt(1)
    v_mfma_f32_16x16x32_bf16 v[200:203], v[96:99], v[174:177], v[200:203]
    v_mul_f32 v213, v213, v252
    s_waitcnt lgkmcnt(0)
    v_mfma_f32_16x16x32_bf16 v[204:207], v[120:123], v[174:177], v[204:207]
    v_mul_f32 v214, v214, v252
    v_mul_f32 v215, v215, v252
    v_cvt_pk_bf16_f32 v212, v212, v213
    v_mfma_f32_16x16x16_bf16 v[200:203], v[100:101], v[178:179], v[200:203]
    v_cvt_pk_bf16_f32 v213, v214, v215
    v_mul_f32 v216, v216, v252
    v_mfma_f32_16x16x16_bf16 v[204:207], v[124:125], v[178:179], v[204:207]
    ds_write_b64 v247, v[212:213] offset:39936
    v_mul_f32 v217, v217, v252
    v_mul_f32 v218, v218, v252
    v_mul_f32 v219, v219, v252
    v_cvt_pk_bf16_f32 v216, v216, v217
    v_cvt_pk_bf16_f32 v217, v218, v219
    ds_write_b64 v247, v[216:217] offset:39968
    v_mul_f32 v220, v220, v252
    v_mul_f32 v221, v221, v252
    v_mul_f32 v222, v222, v252
    v_mul_f32 v223, v223, v252
    v_cvt_pk_bf16_f32 v220, v220, v221
    v_cvt_pk_bf16_f32 v221, v222, v223
    ds_write_b64 v247, v[220:221] offset:40000
    v_max3_f32 v248, v248, v208, v209
    v_max3_f32 v248, v248, v210, v211
    ds_read_b128 v[208:211], v246 offset:64
    v_max3_f32 v248, v248, v196, v197
    v_max3_f32 v248, v248, v198, v199
    ds_read_b128 v[196:199], v244 offset:0
    v_max3_f32 v248, v248, v200, v201
    v_max3_f32 v248, v248, v202, v203
    ds_read_b128 v[200:203], v245 offset:0
    v_max3_f32 v248, v248, v204, v205
    v_max3_f32 v248, v248, v206, v207
    ds_read_b128 v[204:207], v246 offset:0
    s_waitcnt lgkmcnt(3)
    v_mfma_f32_16x16x32_bf16 v[208:211], v[144:147], v[174:177], v[208:211]
    s_nop 5
    v_mfma_f32_16x16x16_bf16 v[208:211], v[148:149], v[178:179], v[208:211]
    s_waitcnt lgkmcnt(2)
    s_waitcnt lgkmcnt(1)
    v_mfma_f32_16x16x32_bf16 v[196:199], v[156:159], v[174:177], v[196:199]
    v_mfma_f32_16x16x32_bf16 v[200:203], v[114:117], v[174:177], v[200:203]
    s_waitcnt lgkmcnt(0)
    v_mfma_f32_16x16x32_bf16 v[204:207], v[138:141], v[174:177], v[204:207]
    s_nop 1
    v_max3_f32 v248, v248, v208, v209
    v_mfma_f32_16x16x16_bf16 v[196:199], v[160:161], v[178:179], v[196:199]
    v_max3_f32 v248, v248, v210, v211
    v_mov_b32 v252, v248
    v_mfma_f32_16x16x16_bf16 v[200:203], v[118:119], v[178:179], v[200:203]
    ds_read_b128 v[208:211], v244 offset:64
    v_permlane16_swap_b32 v248, v252
    v_mfma_f32_16x16x16_bf16 v[204:207], v[142:143], v[178:179], v[204:207]
    v_max_f32 v248, v248, v252
    v_mov_b32 v252, v248
    s_nop 1
    v_permlane32_swap_b32 v248, v252
    v_max_f32 v248, v248, v252
    v_sub_f32 v196, v196, v248
    v_exp_f32 v196, v196
    v_sub_f32 v197, v197, v248
    v_exp_f32 v197, v197
    v_sub_f32 v198, v198, v248
    v_exp_f32 v198, v198
    v_sub_f32 v199, v199, v248
    v_exp_f32 v199, v199
    v_cvt_pk_bf16_f32 v190, v196, v197
    v_cvt_pk_bf16_f32 v193, v198, v199
    ds_read_b128 v[196:199], v245 offset:64
    v_sub_f32 v200, v200, v248
    v_exp_f32 v200, v200
    v_sub_f32 v201, v201, v248
    v_exp_f32 v201, v201
    v_sub_f32 v202, v202, v248
    v_exp_f32 v202, v202
    v_sub_f32 v203, v203, v248
    v_exp_f32 v203, v203
    v_cvt_pk_bf16_f32 v188, v200, v201
    v_cvt_pk_bf16_f32 v191, v202, v203
    ds_read_b128 v[200:203], v246 offset:64
    s_waitcnt lgkmcnt(2)
    v_mfma_f32_16x16x32_bf16 v[208:211], v[96:99], v[174:177], v[208:211]
    v_sub_f32 v204, v204, v248
    v_sub_f32 v205, v205, v248
    v_exp_f32 v204, v204
    v_exp_f32 v205, v205
    v_sub_f32 v206, v206, v248
    v_exp_f32 v206, v206
    v_mfma_f32_16x16x16_bf16 v[208:211], v[100:101], v[178:179], v[208:211]
    v_sub_f32 v207, v207, v248
    s_waitcnt lgkmcnt(1)
    v_mfma_f32_16x16x32_bf16 v[196:199], v[120:123], v[174:177], v[196:199]
    v_exp_f32 v207, v207
    v_cvt_pk_bf16_f32 v189, v204, v205
    v_cvt_pk_bf16_f32 v192, v206, v207
    s_nop 0
    v_mfma_f32_16x16x32_bf16 v[212:215], v[18:21], v[188:191], 0
    v_sub_f32 v208, v208, v248
    v_sub_f32 v209, v209, v248
    v_mfma_f32_16x16x32_bf16 v[216:219], v[48:51], v[188:191], 0
    v_exp_f32 v208, v208
    v_mfma_f32_16x16x32_bf16 v[220:223], v[78:81], v[188:191], 0
    s_waitcnt lgkmcnt(0)
    v_exp_f32 v209, v209
    v_mfma_f32_16x16x32_bf16 v[224:227], a[248:251], v[188:191], 0
    v_sub_f32 v210, v210, v248
    v_sub_f32 v211, v211, v248
    v_mfma_f32_16x16x16_bf16 v[196:199], v[124:125], v[178:179], v[196:199]
    v_exp_f32 v210, v210
    v_mfma_f32_16x16x32_bf16 v[200:203], v[144:147], v[174:177], v[200:203]
    v_exp_f32 v211, v211
    v_cvt_pk_bf16_f32 v180, v208, v209
    v_cvt_pk_bf16_f32 v183, v210, v211
    v_mov_b32 v189, 0
    s_nop 1
    v_mfma_f32_16x16x16_bf16 v[200:203], v[148:149], v[178:179], v[200:203]
    v_sub_f32 v196, v196, v248
    v_exp_f32 v196, v196
    v_sub_f32 v197, v197, v248
    v_exp_f32 v197, v197
    v_sub_f32 v198, v198, v248
    v_exp_f32 v198, v198
    v_sub_f32 v199, v199, v248
    v_exp_f32 v199, v199
    v_cvt_pk_bf16_f32 v194, v196, v197
    v_cvt_pk_bf16_f32 v181, v198, v199
    v_sub_f32 v200, v200, v248
    v_exp_f32 v200, v200
    v_sub_f32 v201, v201, v248
    v_exp_f32 v201, v201
    v_sub_f32 v202, v202, v248
    v_exp_f32 v202, v202
    v_sub_f32 v203, v203, v248
    v_exp_f32 v203, v203
    v_cvt_pk_bf16_f32 v195, v200, v201
    v_cvt_pk_bf16_f32 v182, v202, v203
    s_nop 0
    v_mfma_f32_16x16x32_bf16 v[212:215], v[22:25], v[192:195], v[212:215]
    v_mfma_f32_16x16x32_bf16 v[216:219], v[52:55], v[192:195], v[216:219]
    v_mfma_f32_16x16x32_bf16 v[220:223], v[82:85], v[192:195], v[220:223]
    v_mfma_f32_16x16x32_bf16 v[224:227], a[248:251], v[192:195], v[224:227]
    v_mov_b32 v192, 0
    v_mov_b32 v195, 0
    v_mfma_f32_16x16x32_bf16 v[212:215], v[26:29], v[180:183], v[212:215]
    v_mfma_f32_16x16x32_bf16 v[216:219], v[56:59], v[180:183], v[216:219]
    v_mfma_f32_16x16x32_bf16 v[220:223], v[86:89], v[180:183], v[220:223]
    v_mfma_f32_16x16x32_bf16 v[224:227], a[248:251], v[180:183], v[224:227]
    v_mov_b32 v182, 0
    s_nop 6
    v_rcp_f32 v252, v224
    s_nop 0
    v_mul_f32 v212, v212, v252
    v_mul_f32 v213, v213, v252
    v_mul_f32 v214, v214, v252
    v_mul_f32 v215, v215, v252
    v_cvt_pk_bf16_f32 v212, v212, v213
    v_cvt_pk_bf16_f32 v213, v214, v215
    ds_write_b64 v247, v[212:213] offset:46592
    v_mul_f32 v216, v216, v252
    v_mul_f32 v217, v217, v252
    v_mul_f32 v218, v218, v252
    v_mul_f32 v219, v219, v252
    v_cvt_pk_bf16_f32 v216, v216, v217
    v_cvt_pk_bf16_f32 v217, v218, v219
    ds_write_b64 v247, v[216:217] offset:46624
    v_mul_f32 v220, v220, v252
    v_mul_f32 v221, v221, v252
    v_mul_f32 v222, v222, v252
    v_mul_f32 v223, v223, v252
    v_cvt_pk_bf16_f32 v220, v220, v221
    v_cvt_pk_bf16_f32 v221, v222, v223
    ds_write_b64 v247, v[220:221] offset:46656
    v_mbcnt_lo_u32_b32 v252, -1, 0
    v_mbcnt_hi_u32_b32 v252, -1, v252
    v_bfe_u32 v204, v252, 2, 1
    v_lshrrev_b32 v205, 1, v252
    v_and_b32 v205, 4, v205
    v_and_or_b32 v205, v252, 3, v205
    v_bfe_u32 v253, v252, 3, 1
    v_lshrrev_b32 v252, 4, v252
    v_sub_u32 v206, v252, v204
    v_mul_i32_i24 v206, 0x1c0, v206
    v_lshlrev_b32 v207, 4, v205
    v_sub_u32 v206, v206, v207
    v_add_u32 v206, s37, v206
    v_sub_u32 v207, v252, v204
    v_add_u32 v244, 0, v207
    v_cmp_gt_u32 vcc, 7, v244
    v_add_u32 v244, 0xfffdc870, v206
    v_add_u32 v245, 4, v207
    v_cndmask_b32 v244, 0, v244, vcc
    v_add_u32 v244, 0x237c0, v244
    v_cmp_gt_u32 vcc, 7, v245
    v_add_u32 v245, 0xfffdcf70, v206
    v_add_u32 v246, 8, v207
    v_cndmask_b32 v245, 0, v245, vcc
    v_add_u32 v245, 0x237c0, v245
    v_cmp_gt_u32 vcc, 7, v246
    v_add_u32 v246, 0xfffdd670, v206
    v_xor_b32 v253, 1, v253
    v_cndmask_b32 v246, 0, v246, vcc
    v_add_u32 v246, 0x237c0, v246
    v_mul_u32_u24 v246, 0xc0, v253
    v_add_u32 v244, v244, v246
    ds_read_b128 v[204:207], v244 offset:0
    s_waitcnt lgkmcnt(1)
    ds_read_b128 v[196:199], v244 offset:64
    s_barrier
    ds_read_b128 a[216:219], v249 offset:39936
    ds_read_b128 a[220:223], v249 offset:40000
    ds_read_b128 a[224:227], v249 offset:40064
    ds_read_b128 a[228:231], v249 offset:40128
    ds_read_b128 a[232:235], v249 offset:40192
    ds_read_b128 a[236:239], v249 offset:40256
    ds_read_b128 a[240:243], v249 offset:46592
    ds_read_b128 a[244:247], v249 offset:46656
    ds_read_b64 v[174:175], v247 offset:59904
    ds_read_b64 v[176:177], v247 offset:59936
    ds_read_b64 v[178:179], v247 offset:59968
    v_add_u32 v245, v245, v246
    ds_read_b128 v[208:211], v245 offset:0
    ds_read_b128 v[200:203], v245 offset:64
    s_waitcnt lgkmcnt(14)
    v_mfma_f32_16x16x32_bf16 v[204:207], v[102:105], v[168:171], v[204:207]
    s_waitcnt lgkmcnt(13)
    v_mfma_f32_16x16x32_bf16 v[196:199], v[108:111], v[168:171], v[196:199]
    s_waitcnt lgkmcnt(11)
    v_mfma_f32_16x16x32_bf16 v[232:235], a[144:147], a[216:219], 0
    v_mfma_f32_16x16x32_bf16 v[232:235], a[148:151], a[220:223], v[232:235]
    s_waitcnt lgkmcnt(7)
    v_mfma_f32_16x16x16_bf16 v[204:207], v[106:107], v[172:173], v[204:207]
    v_mfma_f32_16x16x32_bf16 v[232:235], a[152:155], a[224:227], v[232:235]
    v_mfma_f32_16x16x16_bf16 v[196:199], v[112:113], v[172:173], v[196:199]
    s_waitcnt lgkmcnt(1)
    v_mfma_f32_16x16x32_bf16 v[208:211], v[126:129], v[168:171], v[208:211]
    s_waitcnt lgkmcnt(0)
    v_mfma_f32_16x16x32_bf16 v[200:203], v[132:135], v[168:171], v[200:203]
    v_mfma_f32_16x16x32_bf16 v[232:235], a[156:159], a[228:231], v[232:235]
    v_mfma_f32_16x16x32_bf16 v[232:235], a[160:163], a[232:235], v[232:235]
    v_max_f32 v248, v204, v205
    v_max3_f32 v248, v248, v206, v207
    v_mfma_f32_16x16x16_bf16 v[208:211], v[130:131], v[172:173], v[208:211]
    ds_read_b128 v[204:207], v244 offset:128
    v_mfma_f32_16x16x16_bf16 v[200:203], v[136:137], v[172:173], v[200:203]
    v_mfma_f32_16x16x32_bf16 v[232:235], a[164:167], a[236:239], v[232:235]
    v_mfma_f32_16x16x32_bf16 v[236:239], a[168:171], a[216:219], 0
    v_mfma_f32_16x16x32_bf16 v[236:239], a[172:175], a[220:223], v[236:239]
    v_mfma_f32_16x16x32_bf16 v[236:239], a[176:179], a[224:227], v[236:239]
    v_mfma_f32_16x16x32_bf16 v[236:239], a[180:183], a[228:231], v[236:239]
    v_mfma_f32_16x16x32_bf16 v[236:239], a[184:187], a[232:235], v[236:239]
    v_max3_f32 v248, v248, v208, v209
    v_max3_f32 v248, v248, v210, v211
    v_mfma_f32_16x16x32_bf16 v[236:239], a[188:191], a[236:239], v[236:239]
    ds_read_b128 v[208:211], v245 offset:128
    s_waitcnt lgkmcnt(1)
    v_cvt_pk_bf16_f32 v232, v232, v233
    v_mfma_f32_16x16x32_bf16 v[204:207], v[162:165], v[168:171], v[204:207]
    v_cvt_pk_bf16_f32 v233, v234, v235
    v_max3_f32 v248, v248, v196, v197
    v_mfma_f32_16x16x32_bf16 v[228:231], a[192:195], a[216:219], 0
    ds_read_b128 a[216:219], v249 offset:46720
    v_cvt_pk_bf16_f32 v234, v236, v237
    v_mfma_f32_16x16x32_bf16 v[228:231], a[196:199], a[220:223], v[228:231]
    ds_read_b128 a[220:223], v249 offset:46784
    v_cvt_pk_bf16_f32 v235, v238, v239
    v_mfma_f32_16x16x16_bf16 v[204:207], v[166:167], v[172:173], v[204:207]
    buffer_store_dwordx4 v[232:235], v250, s[20:23], 0 offen
    v_mfma_f32_16x16x32_bf16 v[228:231], a[200:203], a[224:227], v[228:231]
    ds_read_b128 a[224:227], v249 offset:46848
    v_mul_i32_i24 v250, s30, v255
    v_mfma_f32_16x16x32_bf16 v[228:231], a[204:207], a[228:231], v[228:231]
    ds_read_b128 a[228:231], v249 offset:46912
    v_and_b32 v255, 3, v254
    v_mfma_f32_16x16x32_bf16 v[228:231], a[208:211], a[232:235], v[228:231]
    v_mad_i32_i24 v250, v255, s31, v250
    v_add_u32 v250, s54, v250
    v_mfma_f32_16x16x32_bf16 v[228:231], a[212:215], a[236:239], v[228:231]
    s_waitcnt lgkmcnt(4)
    v_cmp_gt_u32 vcc, 2, v255
    v_add_u32 v250, 0x80000000, v250
    v_mfma_f32_16x16x32_bf16 v[208:211], v[90:93], v[168:171], v[208:211]
    v_cndmask_b32 v250, 0, v250, vcc
    v_add_u32 v250, 0x80000000, v250
    v_mfma_f32_16x16x32_bf16 v[232:235], a[144:147], a[240:243], 0
    v_lshrrev_b32 v254, 4, v254
    v_cvt_pk_bf16_f32 v228, v228, v229
    v_mfma_f32_16x16x32_bf16 v[232:235], a[148:151], a[244:247], v[232:235]
    s_waitcnt lgkmcnt(2)
    v_cvt_pk_bf16_f32 v229, v230, v231
    v_max3_f32 v248, v248, v198, v199
    v_mfma_f32_16x16x16_bf16 v[208:211], v[94:95], v[172:173], v[208:211]
    ds_read_b128 v[196:199], v244 offset:192
    v_max3_f32 v248, v248, v200, v201
    v_mfma_f32_16x16x32_bf16 v[232:235], a[152:155], a[216:219], v[232:235]
    buffer_store_dwordx2 v[228:229], v251, s[20:23], 0 offen offset:64
    v_mfma_f32_16x16x32_bf16 v[232:235], a[156:159], a[220:223], v[232:235]
    s_waitcnt lgkmcnt(2)
    v_lshl_add_u32 v251, v254, 3, v250
    v_lshl_add_u32 v250, v254, 4, v250
    v_mfma_f32_16x16x32_bf16 v[232:235], a[160:163], a[224:227], v[232:235]
    s_waitcnt lgkmcnt(1)
    v_mbcnt_lo_u32_b32 v254, -1, 0
    v_mbcnt_hi_u32_b32 v254, -1, v254
    v_mfma_f32_16x16x32_bf16 v[232:235], a[164:167], a[228:231], v[232:235]
    v_bfe_u32 v255, v254, 2, 1
    v_max3_f32 v248, v248, v202, v203
    v_mfma_f32_16x16x32_bf16 v[236:239], a[168:171], a[240:243], 0
    ds_read_b128 v[200:203], v245 offset:192
    v_max3_f32 v248, v248, v204, v205
    v_mfma_f32_16x16x32_bf16 v[236:239], a[172:175], a[244:247], v[236:239]
    v_max3_f32 v248, v248, v206, v207
    v_max3_f32 v248, v248, v208, v209
    v_mfma_f32_16x16x32_bf16 v[236:239], a[176:179], a[216:219], v[236:239]
    ds_read_b128 v[204:207], v244 offset:0
    v_cvt_pk_bf16_f32 v232, v232, v233
    v_mfma_f32_16x16x32_bf16 v[236:239], a[180:183], a[220:223], v[236:239]
    v_cvt_pk_bf16_f32 v233, v234, v235
    v_max3_f32 v248, v248, v210, v211
    v_mfma_f32_16x16x32_bf16 v[236:239], a[184:187], a[224:227], v[236:239]
    ds_read_b128 v[208:211], v245 offset:0
    s_waitcnt lgkmcnt(3)
    v_mfma_f32_16x16x32_bf16 v[196:199], v[114:117], v[168:171], v[196:199]
    v_mfma_f32_16x16x32_bf16 v[236:239], a[188:191], a[228:231], v[236:239]
    v_mfma_f32_16x16x32_bf16 v[228:231], a[192:195], a[240:243], 0
    v_mfma_f32_16x16x32_bf16 v[228:231], a[196:199], a[244:247], v[228:231]
    v_mfma_f32_16x16x32_bf16 v[228:231], a[200:203], a[216:219], v[228:231]
    s_waitcnt lgkmcnt(2)
    v_mfma_f32_16x16x32_bf16 v[200:203], v[138:141], v[168:171], v[200:203]
    v_mfma_f32_16x16x16_bf16 v[196:199], v[118:119], v[172:173], v[196:199]
    s_waitcnt lgkmcnt(1)
    v_mfma_f32_16x16x32_bf16 v[204:207], v[102:105], v[168:171], v[204:207]
    v_cvt_pk_bf16_f32 v234, v236, v237
    v_cvt_pk_bf16_f32 v235, v238, v239
    v_mfma_f32_16x16x32_bf16 v[228:231], a[204:207], a[220:223], v[228:231]
    buffer_store_dwordx4 v[232:235], v250, s[20:23], 0 offen
    v_mfma_f32_16x16x16_bf16 v[200:203], v[142:143], v[172:173], v[200:203]
    s_waitcnt lgkmcnt(0)
    v_mul_i32_i24 v250, s30, v255
    v_lshrrev_b32 v255, 1, v254
    v_mfma_f32_16x16x16_bf16 v[204:207], v[106:107], v[172:173], v[204:207]
    v_and_b32 v255, 4, v255
    v_and_or_b32 v255, v254, 3, v255
    v_mfma_f32_16x16x32_bf16 v[208:211], v[126:129], v[168:171], v[208:211]
    v_mad_i32_i24 v250, v255, s31, v250
    v_add_u32 v250, s56, v250
    v_mfma_f32_16x16x32_bf16 v[228:231], a[208:211], a[224:227], v[228:231]
    v_lshrrev_b32 v254, 4, v254
    v_max3_f32 v248, v248, v196, v197
    v_mfma_f32_16x16x32_bf16 v[228:231], a[212:215], a[228:231], v[228:231]
    ds_read_b128 v[196:199], v244 offset:64
    v_max3_f32 v248, v248, v200, v201
    v_mfma_f32_16x16x16_bf16 v[208:211], v[130:131], v[172:173], v[208:211]
    ds_read_b128 v[200:203], v245 offset:64
    v_mov_b32 v252, v248
    s_nop 1
    v_permlane16_swap_b32 v248, v252
    v_cvt_pk_bf16_f32 v228, v228, v229
    v_cvt_pk_bf16_f32 v229, v230, v231
    buffer_store_dwordx2 v[228:229], v251, s[20:23], 0 offen offset:64
    v_lshl_add_u32 v251, v254, 3, v250
    v_lshl_add_u32 v250, v254, 4, v250
    v_mbcnt_lo_u32_b32 v254, -1, 0
    v_mbcnt_hi_u32_b32 v254, -1, v254
    v_bfe_u32 v255, v254, 2, 1
    v_max_f32 v248, v248, v252
    v_mov_b32 v252, v248
    s_nop 1
    v_permlane32_swap_b32 v248, v252
    v_max_f32 v248, v248, v252
    v_sub_f32 v204, v204, v248
    v_exp_f32 v204, v204
    v_sub_f32 v205, v205, v248
    v_exp_f32 v205, v205
    v_sub_f32 v206, v206, v248
    v_exp_f32 v206, v206
    v_sub_f32 v207, v207, v248
    v_exp_f32 v207, v207
    v_cvt_pk_bf16_f32 v184, v204, v205
    v_cvt_pk_bf16_f32 v187, v206, v207
    ds_read_b128 v[204:207], v244 offset:128
    s_waitcnt lgkmcnt(1)
    v_mfma_f32_16x16x32_bf16 v[196:199], v[108:111], v[168:171], v[196:199]
    v_sub_f32 v208, v208, v248
    v_sub_f32 v209, v209, v248
    v_mfma_f32_16x16x32_bf16 v[200:203], v[132:135], v[168:171], v[200:203]
    v_exp_f32 v208, v208
    v_exp_f32 v209, v209
    v_sub_f32 v210, v210, v248
    v_mfma_f32_16x16x16_bf16 v[196:199], v[112:113], v[172:173], v[196:199]
    v_exp_f32 v210, v210
    v_sub_f32 v211, v211, v248
    v_mfma_f32_16x16x16_bf16 v[200:203], v[136:137], v[172:173], v[200:203]
    v_exp_f32 v211, v211
    v_cvt_pk_bf16_f32 v185, v208, v209
    v_cvt_pk_bf16_f32 v188, v210, v211
    ds_read_b128 v[208:211], v245 offset:128
    v_mfma_f32_16x16x32_bf16 v[212:215], v[0:3], v[184:187], 0
    v_sub_f32 v196, v196, v248
    v_sub_f32 v197, v197, v248
    v_mfma_f32_16x16x32_bf16 v[216:219], v[30:33], v[184:187], 0
    v_exp_f32 v196, v196
    v_mfma_f32_16x16x32_bf16 v[220:223], v[60:63], v[184:187], 0
    s_waitcnt lgkmcnt(1)
    v_exp_f32 v197, v197
    v_mfma_f32_16x16x32_bf16 v[224:227], a[248:251], v[184:187], 0
    v_sub_f32 v198, v198, v248
    v_sub_f32 v199, v199, v248
    v_mfma_f32_16x16x32_bf16 v[204:207], v[162:165], v[168:171], v[204:207]
    v_exp_f32 v198, v198
    v_exp_f32 v199, v199
    v_cvt_pk_bf16_f32 v190, v196, v197
    v_cvt_pk_bf16_f32 v193, v198, v199
    ds_read_b128 v[196:199], v244 offset:192
    v_sub_f32 v200, v200, v248
    v_mfma_f32_16x16x16_bf16 v[204:207], v[166:167], v[172:173], v[204:207]
    v_exp_f32 v200, v200
    s_waitcnt lgkmcnt(1)
    v_mfma_f32_16x16x32_bf16 v[208:211], v[90:93], v[168:171], v[208:211]
    v_sub_f32 v201, v201, v248
    v_sub_f32 v202, v202, v248
    v_exp_f32 v201, v201
    v_exp_f32 v202, v202
    v_sub_f32 v203, v203, v248
    v_exp_f32 v203, v203
    v_mfma_f32_16x16x16_bf16 v[208:211], v[94:95], v[172:173], v[208:211]
    v_cvt_pk_bf16_f32 v191, v200, v201
    v_cvt_pk_bf16_f32 v194, v202, v203
    ds_read_b128 v[200:203], v245 offset:192
    v_mfma_f32_16x16x32_bf16 v[212:215], v[4:7], v[188:191], v[212:215]
    v_sub_f32 v204, v204, v248
    v_sub_f32 v205, v205, v248
    v_mfma_f32_16x16x32_bf16 v[216:219], v[34:37], v[188:191], v[216:219]
    v_exp_f32 v204, v204
    v_mfma_f32_16x16x32_bf16 v[220:223], v[64:67], v[188:191], v[220:223]
    s_waitcnt lgkmcnt(1)
    v_exp_f32 v205, v205
    v_mfma_f32_16x16x32_bf16 v[224:227], a[248:251], v[188:191], v[224:227]
    v_sub_f32 v206, v206, v248
    v_sub_f32 v207, v207, v248
    v_mfma_f32_16x16x32_bf16 v[212:215], v[8:11], v[192:195], v[212:215]
    v_exp_f32 v206, v206
    v_mfma_f32_16x16x32_bf16 v[216:219], v[38:41], v[192:195], v[216:219]
    v_exp_f32 v207, v207
    v_mfma_f32_16x16x32_bf16 v[220:223], v[68:71], v[192:195], v[220:223]
    v_cvt_pk_bf16_f32 v180, v204, v205
    v_cvt_pk_bf16_f32 v183, v206, v207
    v_mfma_f32_16x16x32_bf16 v[224:227], a[248:251], v[192:195], v[224:227]
    v_sub_f32 v208, v208, v248
    v_sub_f32 v209, v209, v248
    v_mfma_f32_16x16x32_bf16 v[196:199], v[114:117], v[168:171], v[196:199]
    s_waitcnt lgkmcnt(0)
    v_exp_f32 v208, v208
    v_mfma_f32_16x16x32_bf16 v[200:203], v[138:141], v[168:171], v[200:203]
    v_exp_f32 v209, v209
    v_sub_f32 v210, v210, v248
    v_exp_f32 v210, v210
    v_mfma_f32_16x16x16_bf16 v[196:199], v[118:119], v[172:173], v[196:199]
    v_sub_f32 v211, v211, v248
    v_cvt_pk_bf16_f32 v181, v208, v209
    v_mfma_f32_16x16x16_bf16 v[200:203], v[142:143], v[172:173], v[200:203]
    v_exp_f32 v211, v211
    v_mfma_f32_16x16x32_bf16 v[212:215], v[12:15], v[180:183], v[212:215]
    v_cvt_pk_bf16_f32 v184, v210, v211
    v_mov_b32 v185, 0
    v_mfma_f32_16x16x32_bf16 v[216:219], v[42:45], v[180:183], v[216:219]
    v_sub_f32 v196, v196, v248
    v_sub_f32 v197, v197, v248
    v_mfma_f32_16x16x32_bf16 v[220:223], v[72:75], v[180:183], v[220:223]
    v_exp_f32 v196, v196
    v_mfma_f32_16x16x32_bf16 v[224:227], a[248:251], v[180:183], v[224:227]
    v_exp_f32 v197, v197
    v_sub_f32 v200, v200, v248
    v_cvt_pk_bf16_f32 v186, v196, v197
    v_exp_f32 v200, v200
    v_sub_f32 v201, v201, v248
    v_exp_f32 v201, v201
    v_sub_u32 v244, v244, v246
    ds_read_b128 v[204:207], v244 offset:0
    ds_read_b128 v[196:199], v244 offset:64
    v_cvt_pk_bf16_f32 v187, v200, v201
    v_sub_u32 v245, v245, v246
    ds_read_b128 v[208:211], v245 offset:0
    v_mfma_f32_16x16x32_bf16 v[212:215], v[16:19], v[184:187], v[212:215]
    ds_read_b128 v[200:203], v245 offset:64
    v_mov_b32 v190, 0
    v_mfma_f32_16x16x32_bf16 v[216:219], v[46:49], v[184:187], v[216:219]
    v_mov_b32 v193, 0
    v_mov_b32 v180, 0
    v_mfma_f32_16x16x32_bf16 v[220:223], v[76:79], v[184:187], v[220:223]
    v_mov_b32 v183, 0
    v_mfma_f32_16x16x32_bf16 v[224:227], a[248:251], v[184:187], v[224:227]
    v_mov_b32 v186, 0
    s_nop 6
    v_rcp_f32 v252, v224
    s_nop 0
    v_mul_f32 v212, v212, v252
    v_mul_f32 v213, v213, v252
    v_mul_f32 v214, v214, v252
    v_mul_f32 v215, v215, v252
    v_cvt_pk_bf16_f32 v212, v212, v213
    v_cvt_pk_bf16_f32 v213, v214, v215
    ds_write_b64 v247, v[212:213] offset:53248
    s_waitcnt lgkmcnt(1)
    v_mfma_f32_16x16x32_bf16 v[204:207], v[162:165], v[174:177], v[204:207]
    v_mul_f32 v216, v216, v252
    v_mul_f32 v217, v217, v252
    v_mfma_f32_16x16x32_bf16 v[208:211], v[90:93], v[174:177], v[208:211]
    v_mul_f32 v218, v218, v252
    v_mul_f32 v219, v219, v252
    v_mfma_f32_16x16x32_bf16 v[196:199], v[114:117], v[174:177], v[196:199]
    v_cvt_pk_bf16_f32 v216, v216, v217
    v_cvt_pk_bf16_f32 v217, v218, v219
    v_mfma_f32_16x16x16_bf16 v[204:207], v[166:167], v[178:179], v[204:207]
    ds_write_b64 v247, v[216:217] offset:53280
    v_mfma_f32_16x16x16_bf16 v[208:211], v[94:95], v[178:179], v[208:211]
    v_mul_f32 v220, v220, v252
    v_mul_f32 v221, v221, v252
    v_mfma_f32_16x16x16_bf16 v[196:199], v[118:119], v[178:179], v[196:199]
    v_mul_f32 v222, v222, v252
    v_mul_f32 v223, v223, v252
    v_mfma_f32_16x16x32_bf16 v[200:203], v[138:141], v[174:177], v[200:203]
    v_cvt_pk_bf16_f32 v220, v220, v221
    v_cvt_pk_bf16_f32 v221, v222, v223
    ds_write_b64 v247, v[220:221] offset:53312
    v_max_f32 v248, v204, v205
    v_max3_f32 v248, v248, v206, v207
    ds_read_b128 v[204:207], v244 offset:128
    v_mfma_f32_16x16x16_bf16 v[200:203], v[142:143], v[178:179], v[200:203]
    v_max3_f32 v248, v248, v208, v209
    v_max3_f32 v248, v248, v210, v211
    ds_read_b128 v[208:211], v245 offset:128
    v_max3_f32 v248, v248, v196, v197
    v_max3_f32 v248, v248, v198, v199
    ds_read_b128 v[196:199], v244 offset:0
    s_nop 1
    v_max3_f32 v248, v248, v200, v201
    v_max3_f32 v248, v248, v202, v203
    ds_read_b128 v[200:203], v245 offset:0
    s_waitcnt lgkmcnt(3)
    v_mfma_f32_16x16x32_bf16 v[204:207], v[120:123], v[174:177], v[204:207]
    s_nop 5
    v_mfma_f32_16x16x16_bf16 v[204:207], v[124:125], v[178:179], v[204:207]
    s_waitcnt lgkmcnt(2)
    v_mfma_f32_16x16x32_bf16 v[208:211], v[144:147], v[174:177], v[208:211]
    s_waitcnt lgkmcnt(1)
    v_mfma_f32_16x16x32_bf16 v[196:199], v[162:165], v[174:177], v[196:199]
    s_nop 3
    v_mfma_f32_16x16x16_bf16 v[208:211], v[148:149], v[178:179], v[208:211]
    s_waitcnt lgkmcnt(0)
    v_max3_f32 v248, v248, v204, v205
    v_max3_f32 v248, v248, v206, v207
    v_mfma_f32_16x16x16_bf16 v[196:199], v[166:167], v[178:179], v[196:199]
    ds_read_b128 v[204:207], v244 offset:64
    v_mfma_f32_16x16x32_bf16 v[200:203], v[90:93], v[174:177], v[200:203]
    s_nop 1
    v_max3_f32 v248, v248, v208, v209
    v_max3_f32 v248, v248, v210, v211
    ds_read_b128 v[208:211], v245 offset:64
    v_mov_b32 v252, v248
    v_mfma_f32_16x16x16_bf16 v[200:203], v[94:95], v[178:179], v[200:203]
    s_nop 0
    v_permlane16_swap_b32 v248, v252
    v_max_f32 v248, v248, v252
    v_mov_b32 v252, v248
    s_nop 1
    v_permlane32_swap_b32 v248, v252
    v_max_f32 v248, v248, v252
    v_sub_f32 v196, v196, v248
    v_exp_f32 v196, v196
    v_sub_f32 v197, v197, v248
    v_exp_f32 v197, v197
    v_sub_f32 v198, v198, v248
    v_exp_f32 v198, v198
    v_sub_f32 v199, v199, v248
    v_exp_f32 v199, v199
    v_cvt_pk_bf16_f32 v188, v196, v197
    v_cvt_pk_bf16_f32 v191, v198, v199
    ds_read_b128 v[196:199], v244 offset:128
    s_waitcnt lgkmcnt(2)
    v_mfma_f32_16x16x32_bf16 v[204:207], v[114:117], v[174:177], v[204:207]
    v_sub_f32 v200, v200, v248
    v_sub_f32 v201, v201, v248
    s_waitcnt lgkmcnt(1)
    v_mfma_f32_16x16x32_bf16 v[208:211], v[138:141], v[174:177], v[208:211]
    v_exp_f32 v200, v200
    v_exp_f32 v201, v201
    v_mfma_f32_16x16x16_bf16 v[204:207], v[118:119], v[178:179], v[204:207]
    v_sub_f32 v202, v202, v248
    v_sub_f32 v203, v203, v248
    v_exp_f32 v202, v202
    v_mfma_f32_16x16x16_bf16 v[208:211], v[142:143], v[178:179], v[208:211]
    v_exp_f32 v203, v203
    v_cvt_pk_bf16_f32 v189, v200, v201
    v_cvt_pk_bf16_f32 v192, v202, v203
    ds_read_b128 v[200:203], v245 offset:128
    v_mfma_f32_16x16x32_bf16 v[212:215], v[12:15], v[188:191], 0
    v_sub_f32 v204, v204, v248
    v_sub_f32 v205, v205, v248
    v_mfma_f32_16x16x32_bf16 v[216:219], v[42:45], v[188:191], 0
    s_waitcnt lgkmcnt(1)
    v_exp_f32 v204, v204
    v_mfma_f32_16x16x32_bf16 v[220:223], v[72:75], v[188:191], 0
    v_exp_f32 v205, v205
    v_mfma_f32_16x16x32_bf16 v[224:227], a[248:251], v[188:191], 0
    v_sub_f32 v206, v206, v248
    v_sub_f32 v207, v207, v248
    v_mfma_f32_16x16x32_bf16 v[196:199], v[120:123], v[174:177], v[196:199]
    v_exp_f32 v206, v206
    v_exp_f32 v207, v207
    v_cvt_pk_bf16_f32 v194, v204, v205
    v_cvt_pk_bf16_f32 v181, v206, v207
    v_sub_f32 v208, v208, v248
    v_exp_f32 v208, v208
    v_mfma_f32_16x16x16_bf16 v[196:199], v[124:125], v[178:179], v[196:199]
    v_sub_f32 v209, v209, v248
    v_sub_f32 v210, v210, v248
    s_waitcnt lgkmcnt(0)
    v_mfma_f32_16x16x32_bf16 v[200:203], v[144:147], v[174:177], v[200:203]
    v_exp_f32 v209, v209
    v_exp_f32 v210, v210
    v_sub_f32 v211, v211, v248
    v_exp_f32 v211, v211
    v_cvt_pk_bf16_f32 v195, v208, v209
    v_cvt_pk_bf16_f32 v182, v210, v211
    v_mfma_f32_16x16x16_bf16 v[200:203], v[148:149], v[178:179], v[200:203]
    v_sub_f32 v196, v196, v248
    v_sub_f32 v197, v197, v248
    v_mfma_f32_16x16x32_bf16 v[212:215], v[16:19], v[192:195], v[212:215]
    v_exp_f32 v196, v196
    v_mfma_f32_16x16x32_bf16 v[216:219], v[46:49], v[192:195], v[216:219]
    v_exp_f32 v197, v197
    v_mfma_f32_16x16x32_bf16 v[220:223], v[76:79], v[192:195], v[220:223]
    v_sub_f32 v198, v198, v248
    v_sub_f32 v199, v199, v248
    v_mfma_f32_16x16x32_bf16 v[224:227], a[248:251], v[192:195], v[224:227]
    v_exp_f32 v198, v198
    v_mfma_f32_16x16x32_bf16 v[212:215], v[20:23], v[180:183], v[212:215]
    v_exp_f32 v199, v199
    v_mfma_f32_16x16x32_bf16 v[216:219], v[50:53], v[180:183], v[216:219]
    v_cvt_pk_bf16_f32 v184, v196, v197
    v_cvt_pk_bf16_f32 v187, v198, v199
    v_mfma_f32_16x16x32_bf16 v[220:223], v[80:83], v[180:183], v[220:223]
    v_sub_f32 v200, v200, v248
    v_sub_f32 v201, v201, v248
    v_mfma_f32_16x16x32_bf16 v[224:227], a[248:251], v[180:183], v[224:227]
    v_exp_f32 v200, v200
    v_exp_f32 v201, v201
    v_sub_f32 v202, v202, v248
    v_exp_f32 v202, v202
    v_sub_f32 v203, v203, v248
    v_exp_f32 v203, v203
    v_cvt_pk_bf16_f32 v185, v200, v201
    v_cvt_pk_bf16_f32 v188, v202, v203
    v_mov_b32 v189, 0
    v_mfma_f32_16x16x32_bf16 v[212:215], v[24:27], v[184:187], v[212:215]
    v_mov_b32 v191, 0
    v_mfma_f32_16x16x32_bf16 v[216:219], v[54:57], v[184:187], v[216:219]
    v_mfma_f32_16x16x32_bf16 v[220:223], v[84:87], v[184:187], v[220:223]
    v_mfma_f32_16x16x32_bf16 v[224:227], a[248:251], v[184:187], v[224:227]
    v_mfma_f32_16x16x32_bf16 v[212:215], v[28:31], v[188:191], v[212:215]
    v_mfma_f32_16x16x32_bf16 v[216:219], v[58:61], v[188:191], v[216:219]
    v_mfma_f32_16x16x32_bf16 v[220:223], v[88:91], v[188:191], v[220:223]
    v_mfma_f32_16x16x32_bf16 v[224:227], a[248:251], v[188:191], v[224:227]
    s_nop 7
    v_rcp_f32 v252, v224
    s_nop 0
    v_mul_f32 v212, v212, v252
    v_mul_f32 v213, v213, v252
    v_mul_f32 v214, v214, v252
    v_mul_f32 v215, v215, v252
    v_cvt_pk_bf16_f32 v212, v212, v213
    v_cvt_pk_bf16_f32 v213, v214, v215
    ds_write_b64 v247, v[212:213] offset:59904
    v_mul_f32 v216, v216, v252
    v_mul_f32 v217, v217, v252
    v_mul_f32 v218, v218, v252
    v_mul_f32 v219, v219, v252
    v_cvt_pk_bf16_f32 v216, v216, v217
    v_cvt_pk_bf16_f32 v217, v218, v219
    ds_write_b64 v247, v[216:217] offset:59936
    v_mul_f32 v220, v220, v252
    v_mul_f32 v221, v221, v252
    v_mul_f32 v222, v222, v252
    v_mul_f32 v223, v223, v252
    v_cvt_pk_bf16_f32 v220, v220, v221
    v_cvt_pk_bf16_f32 v221, v222, v223
    ds_write_b64 v247, v[220:221] offset:59968
    s_waitcnt lgkmcnt(0)
    s_barrier
    ds_read_b128 a[232:235], v249 offset:53248
    ds_read_b128 a[236:239], v249 offset:53312
    ds_read_b128 a[240:243], v249 offset:53376
    ds_read_b128 a[244:247], v249 offset:53440
    ds_read_b128 a[216:219], v249 offset:53504
    ds_read_b128 a[220:223], v249 offset:53568
    ds_read_b128 a[224:227], v249 offset:59904
    ds_read_b128 a[228:231], v249 offset:59968
    s_waitcnt lgkmcnt(7)
    v_mfma_f32_16x16x32_bf16 v[232:235], a[144:147], a[232:235], 0
    s_waitcnt lgkmcnt(6)
    v_mfma_f32_16x16x32_bf16 v[232:235], a[148:151], a[236:239], v[232:235]
    s_waitcnt lgkmcnt(4)
    v_mfma_f32_16x16x32_bf16 v[232:235], a[152:155], a[240:243], v[232:235]
    v_mfma_f32_16x16x32_bf16 v[232:235], a[156:159], a[244:247], v[232:235]
    s_waitcnt lgkmcnt(0)
    v_mfma_f32_16x16x32_bf16 v[232:235], a[160:163], a[216:219], v[232:235]
    v_mfma_f32_16x16x32_bf16 v[232:235], a[164:167], a[220:223], v[232:235]
    v_mfma_f32_16x16x32_bf16 v[236:239], a[168:171], a[232:235], 0
    v_mfma_f32_16x16x32_bf16 v[236:239], a[172:175], a[236:239], v[236:239]
    v_mfma_f32_16x16x32_bf16 v[236:239], a[176:179], a[240:243], v[236:239]
    v_mfma_f32_16x16x32_bf16 v[236:239], a[180:183], a[244:247], v[236:239]
    v_mfma_f32_16x16x32_bf16 v[236:239], a[184:187], a[216:219], v[236:239]
    v_mfma_f32_16x16x32_bf16 v[236:239], a[188:191], a[220:223], v[236:239]
    v_mfma_f32_16x16x32_bf16 v[228:231], a[192:195], a[232:235], 0
    ds_read_b128 a[232:235], v249 offset:60032
    v_cvt_pk_bf16_f32 v232, v232, v233
    v_mfma_f32_16x16x32_bf16 v[228:231], a[196:199], a[236:239], v[228:231]
    ds_read_b128 a[236:239], v249 offset:60096
    v_cvt_pk_bf16_f32 v233, v234, v235
    v_mfma_f32_16x16x32_bf16 v[228:231], a[200:203], a[240:243], v[228:231]
    ds_read_b128 a[240:243], v249 offset:60160
    v_cvt_pk_bf16_f32 v234, v236, v237
    v_mfma_f32_16x16x32_bf16 v[228:231], a[204:207], a[244:247], v[228:231]
    ds_read_b128 a[244:247], v249 offset:60224
    v_cvt_pk_bf16_f32 v235, v238, v239
    v_mfma_f32_16x16x32_bf16 v[228:231], a[208:211], a[216:219], v[228:231]
    buffer_store_dwordx4 v[232:235], v250, s[20:23], 0 offen
    v_mfma_f32_16x16x32_bf16 v[228:231], a[212:215], a[220:223], v[228:231]
    v_mfma_f32_16x16x32_bf16 v[236:239], a[168:171], a[224:227], 0
    v_mul_i32_i24 v250, s30, v255
    v_lshrrev_b32 v255, 1, v254
    v_mfma_f32_16x16x32_bf16 v[232:235], a[144:147], a[224:227], 0
    v_and_b32 v255, 4, v255
    v_and_or_b32 v255, v254, 3, v255
    v_mfma_f32_16x16x32_bf16 v[232:235], a[148:151], a[228:231], v[232:235]
    s_waitcnt lgkmcnt(3)
    v_cvt_pk_bf16_f32 v228, v228, v229
    v_cvt_pk_bf16_f32 v229, v230, v231
    v_mfma_f32_16x16x32_bf16 v[232:235], a[152:155], a[232:235], v[232:235]
    buffer_store_dwordx2 v[228:229], v251, s[20:23], 0 offen offset:64
    v_mfma_f32_16x16x32_bf16 v[236:239], a[172:175], a[228:231], v[236:239]
    s_waitcnt lgkmcnt(1)
    v_mad_i32_i24 v250, v255, s31, v250
    v_add_u32 v250, s58, v250
    v_mfma_f32_16x16x32_bf16 v[232:235], a[156:159], a[236:239], v[232:235]
    v_cmp_gt_u32 vcc, 6, v255
    v_add_u32 v250, 0x80000000, v250
    v_mfma_f32_16x16x32_bf16 v[232:235], a[160:163], a[240:243], v[232:235]
    s_waitcnt lgkmcnt(0)
    v_cndmask_b32 v250, 0, v250, vcc
    v_add_u32 v250, 0x80000000, v250
    v_mfma_f32_16x16x32_bf16 v[232:235], a[164:167], a[244:247], v[232:235]
    v_lshrrev_b32 v254, 4, v254
    v_lshl_add_u32 v251, v254, 3, v250
    v_mfma_f32_16x16x32_bf16 v[236:239], a[176:179], a[232:235], v[236:239]
    v_lshl_add_u32 v250, v254, 4, v250
    v_mfma_f32_16x16x32_bf16 v[236:239], a[180:183], a[236:239], v[236:239]
    v_mfma_f32_16x16x32_bf16 v[236:239], a[184:187], a[240:243], v[236:239]
    v_mfma_f32_16x16x32_bf16 v[236:239], a[188:191], a[244:247], v[236:239]
    v_mfma_f32_16x16x32_bf16 v[228:231], a[192:195], a[224:227], 0
    v_cvt_pk_bf16_f32 v232, v232, v233
    v_cvt_pk_bf16_f32 v233, v234, v235
    v_mfma_f32_16x16x32_bf16 v[228:231], a[196:199], a[228:231], v[228:231]
    v_mfma_f32_16x16x32_bf16 v[228:231], a[200:203], a[232:235], v[228:231]
    v_mfma_f32_16x16x32_bf16 v[228:231], a[204:207], a[236:239], v[228:231]
    v_mfma_f32_16x16x32_bf16 v[228:231], a[208:211], a[240:243], v[228:231]
    v_mfma_f32_16x16x32_bf16 v[228:231], a[212:215], a[244:247], v[228:231]
    v_cvt_pk_bf16_f32 v234, v236, v237
    v_cvt_pk_bf16_f32 v235, v238, v239
    buffer_store_dwordx4 v[232:235], v250, s[20:23], 0 offen
    s_nop 4
    v_cvt_pk_bf16_f32 v228, v228, v229
    v_cvt_pk_bf16_f32 v229, v230, v231
    buffer_store_dwordx2 v[228:229], v251, s[20:23], 0 offen offset:64
    s_endpgm
.section .rodata,"a"
.p2align 6
.amdhsa_kernel standalone__neighborhood_dinat__vision_kernel
  .amdhsa_next_free_vgpr 512
  .amdhsa_next_free_sgpr 102
  .amdhsa_accum_offset 256
  .amdhsa_group_segment_fixed_size 0
  .amdhsa_kernarg_size 56
  .amdhsa_user_sgpr_count 2
  .amdhsa_user_sgpr_kernarg_segment_ptr 1
  .amdhsa_system_sgpr_workgroup_id_x 1
.end_amdhsa_kernel
```

```asm
; @launch grid=(256,1,1) block=(256,1,1) lds=163840
.amdgcn_target "amdgcn-amd-amdhsa--gfx950"
.text
.globl standalone__neighborhood_dinat__vision_kernel
.p2align 8
.type standalone__neighborhood_dinat__vision_kernel,@function
standalone__neighborhood_dinat__vision_kernel:
    s_cmp_ge_u32 s2, 0x100
    s_cbranch_scc1 L_exit
    s_load_dwordx2 s[4:5], s[0:1], 0
    s_load_dwordx2 s[8:9], s[0:1], 8
    s_load_dwordx2 s[12:13], s[0:1], 16
    s_load_dwordx2 s[16:17], s[0:1], 24
    s_load_dwordx2 s[20:21], s[0:1], 32
    s_load_dwordx2 s[24:25], s[0:1], 48
    s_getpc_b64 s[68:69]
    s_bfe_u32 s3, s2, 0x30003
    s_lshl_b32 s3, s3, 13
    v_lshl_add_u32 v12, v0, 5, s3
    global_load_dword v10, v12, s[68:69]
    s_mov_b32 s6, 0x1260000
    s_mov_b32 s7, 0x20000
    s_mov_b32 s10, 0x36000
    s_mov_b32 s11, 0x20000
    s_mov_b32 s14, 0x12000
    s_mov_b32 s15, 0x20000
    s_mov_b32 s18, 0x548
    s_mov_b32 s19, 0x20000
    s_mov_b32 s22, 0x1260000
    s_mov_b32 s23, 0x20000
    s_mov_b32 s26, 0x12000
    s_mov_b32 s27, 0x20000
    v_lshrrev_b32 v4, 6, v0
    s_nop 0
    v_readfirstlane_b32 s28, v4
    s_lshr_b32 s67, s2, 6
    s_and_b32 s3, s2, 1
    s_lshl_b32 s3, s3, 2
    s_or_b32 s64, s67, s3
    s_bfe_u32 s65, s2, 0x30003
    s_bfe_u32 s67, s2, 0x10002
    s_mul_i32 s66, s67, 0x15000
    s_bfe_u32 s67, s2, 0x10001
    s_mul_i32 s67, s67, 0x180
    s_add_u32 s66, s66, s67
    s_mul_i32 s67, s64, 14
    s_sub_u32 s67, s67, 3
    s_cmp_eq_u32 s64, 7
    s_cselect_b32 s35, 1, 0
    s_cselect_b32 s67, 0x72, s67
    s_mov_b32 s3, 0x2a000
    s_cselect_b32 s30, 0xfffd6000, s3
    s_cselect_b32 s33, 3, 0
    s_cselect_b32 s49, -1, 1
    s_mul_i32 s49, s49, 0x1c0
    s_cselect_b32 s48, 0, 0x4e
    s_cmp_eq_u32 s64, 0
    s_cselect_b32 s33, 3, s33
    s_mul_i32 s32, s67, 0x2a000
    s_mul_i32 s67, s65, 14
    s_sub_u32 s67, s67, 3
    s_cmp_eq_u32 s65, 7
    s_cselect_b32 s36, 1, 0
    s_cselect_b32 s34, 1, 0
    s_cselect_b32 s64, 0x6b, s67
    s_cselect_b32 s67, 0x72, s67
    s_mov_b32 s3, 0x300
    s_cselect_b32 s31, 0xfffffd00, s3
    s_cmp_eq_u32 s65, 0
    s_cselect_b32 s34, 1, s34
    s_lshl_b32 s45, s31, 3
    s_mul_i32 s64, s64, 0x300
    s_add_u32 s64, s64, s66
    s_mul_i32 s3, s30, s28
    s_add_u32 s3, s3, s32
    s_max_i32 s40, s3, 0
    s_min_i32 s40, s40, 0x1236000
    s_add_u32 s40, s40, s64
    s_add_u32 s3, s3, s64
    s_lshl2_add_u32 s3, s30, s3
    s_mov_b32 s41, s3
    s_lshl2_add_u32 s3, s30, s3
    s_mov_b32 s42, s3
    s_lshl2_add_u32 s3, s30, s3
    s_mov_b32 s43, s3
    s_lshl2_add_u32 s3, s30, s3
    s_mov_b32 s44, s3
    s_mul_i32 s67, s67, 0x300
    s_add_u32 s32, s32, s67
    s_add_u32 s32, s32, s66
    s_mul_i32 s46, s28, 0x1e00
    s_mul_i32 s29, s28, 0x3000
    s_add_u32 s29, s29, 0x16800
    s_mul_i32 s39, s28, 0x60
    s_mul_i32 s37, s28, 0x1180
    s_add_u32 s37, s37, 0x239c0
    s_mul_i32 s67, s28, 0x152
    s_add_u32 s48, s48, s67
    s_mov_b32 s38, 0x3e553b95
    s_mov_b32 s3, 0x3dd53b95
    v_mbcnt_lo_u32_b32 v1, -1, 0
    v_mbcnt_hi_u32_b32 v1, -1, v1
    s_lshl_b32 s50, s28, 1
    s_mul_i32 s51, s36, 7
    v_add_u32 v2, 0, v1
    v_mul_u32_u24 v3, 0xaab, v2
    v_lshrrev_b32 v3, 16, v3
    v_mul_u32_u24 v4, 24, v3
    v_sub_u32 v2, v2, v4
    v_bfe_u32 v4, v3, 1, 1
    v_or_b32 v4, s50, v4
    v_xor_b32 v2, v2, v4
    v_xor_b32 v3, s51, v3
    v_mul_u32_u24 v3, 0x300, v3
    v_lshl_add_u32 v168, v2, 4, v3
    v_add_u32 v5, s40, v168
    v_max_i32 v5, 0, v5
    v_add_u32 v2, 64, v1
    v_mul_u32_u24 v3, 0xaab, v2
    v_lshrrev_b32 v3, 16, v3
    v_mul_u32_u24 v4, 24, v3
    v_sub_u32 v2, v2, v4
    v_bfe_u32 v4, v3, 1, 1
    v_or_b32 v4, s50, v4
    v_xor_b32 v2, v2, v4
    v_xor_b32 v3, s51, v3
    v_mul_u32_u24 v3, 0x300, v3
    v_lshl_add_u32 v169, v2, 4, v3
    v_add_u32 v6, s40, v169
    v_max_i32 v6, 0, v6
    v_add_u32 v2, 0x80, v1
    v_mul_u32_u24 v3, 0xaab, v2
    v_lshrrev_b32 v3, 16, v3
    v_mul_u32_u24 v4, 24, v3
    v_sub_u32 v2, v2, v4
    v_bfe_u32 v4, v3, 1, 1
    v_or_b32 v4, s50, v4
    v_xor_b32 v2, v2, v4
    v_xor_b32 v3, s51, v3
    v_mul_u32_u24 v3, 0x300, v3
    v_lshl_add_u32 v170, v2, 4, v3
    v_add_u32 v7, s40, v170
    v_max_i32 v7, 0, v7
    v_add_u32 v2, 32, v1
    v_mul_u32_u24 v3, 0xaab, v2
    v_lshrrev_b32 v3, 16, v3
    v_mul_u32_u24 v4, 24, v3
    v_sub_u32 v2, v2, v4
    v_bfe_u32 v4, v3, 1, 1
    v_or_b32 v4, s50, v4
    v_xor_b32 v2, v2, v4
    v_xor_b32 v3, s51, v3
    v_mul_u32_u24 v3, 0x300, v3
    v_lshl_add_u32 v171, v2, 4, v3
    v_add_u32 v2, 0, v1
    v_mul_u32_u24 v3, 0x2aab, v2
    v_lshrrev_b32 v3, 16, v3
    v_mul_u32_u24 v4, 6, v3
    v_sub_u32 v2, v2, v4
    v_lshrrev_b32 v4, 1, v3
    v_and_b32 v4, 4, v4
    v_xor_b32 v3, v3, v4
    v_mul_u32_u24 v3, 0x480, v3
    v_lshl_add_u32 v172, v2, 4, v3
    v_add_u32 v2, 64, v1
    v_mul_u32_u24 v3, 0x2aab, v2
    v_lshrrev_b32 v3, 16, v3
    v_mul_u32_u24 v4, 6, v3
    v_sub_u32 v2, v2, v4
    v_lshrrev_b32 v4, 1, v3
    v_and_b32 v4, 4, v4
    v_xor_b32 v3, v3, v4
    v_mul_u32_u24 v3, 0x480, v3
    v_lshl_add_u32 v173, v2, 4, v3
    v_add_u32 v2, 0x80, v1
    v_mul_u32_u24 v3, 0x2aab, v2
    v_lshrrev_b32 v3, 16, v3
    v_mul_u32_u24 v4, 6, v3
    v_sub_u32 v2, v2, v4
    v_lshrrev_b32 v4, 1, v3
    v_and_b32 v4, 4, v4
    v_xor_b32 v3, v3, v4
    v_mul_u32_u24 v3, 0x480, v3
    v_lshl_add_u32 v174, v2, 4, v3
    s_waitcnt lgkmcnt(0)
    s_add_u32 m0, s46, 0
    s_add_u32 s51, s40, s45
    buffer_load_dwordx4 v5, s[4:7], 0 offen lds
    s_add_u32 m0, s46, 0x400
    s_add_u32 s52, s40, s45
    buffer_load_dwordx4 v6, s[4:7], 0 offen lds
    s_add_u32 m0, s46, 0x800
    s_add_u32 s53, s40, s45
    buffer_load_dwordx4 v7, s[4:7], 0 offen lds
    s_add_u32 m0, s46, 0xc00
    s_lshl1_add_u32 s54, s45, s40
    buffer_load_dwordx4 v168, s[4:7], s51 offen lds
    s_add_u32 m0, s46, 0x1000
    s_lshl1_add_u32 s55, s45, s40
    buffer_load_dwordx4 v169, s[4:7], s52 offen lds
    s_add_u32 m0, s46, 0x1400
    s_add_u32 s60, s39, 0x180
    buffer_load_dwordx4 v170, s[4:7], s53 offen lds
    s_add_u32 m0, s46, 0x1800
    v_and_b32 v13, 15, v1
    buffer_load_dwordx4 v168, s[4:7], s54 offen lds
    s_add_u32 m0, s46, 0x1a00
    v_lshrrev_b32 v14, 4, v1
    buffer_load_dwordx4 v171, s[4:7], s55 offen lds
    s_add_u32 m0, s29, 0
    v_lshrrev_b32 v15, 2, v13
    buffer_load_dwordx4 v172, s[8:11], s60 offen lds
    s_add_u32 m0, s29, 0x400
    v_and_b32 v16, 3, v13
    buffer_load_dwordx4 v173, s[8:11], s60 offen lds
    s_add_u32 m0, s29, 0x800
    v_and_b32 v17, 1, v14
    buffer_load_dwordx4 v174, s[8:11], s60 offen lds
    v_lshl_add_u32 v18, v14, 3, v15
    v_xor_b32 v19, 0, v17
    v_lshl_add_u32 v19, v19, 2, v18
    v_mul_u32_u24 v19, 0x60, v19
    v_lshl_add_u32 v19, v16, 3, v19
    v_add_u32 v249, s29, v19
    v_add_u32 v19, s46, v19
    v_add_u32 v175, 0xf000, v19
    v_xor_b32 v19, 1, v17
    v_lshl_add_u32 v19, v19, 2, v18
    v_mul_u32_u24 v19, 0x60, v19
    v_lshl_add_u32 v19, v16, 3, v19
    v_add_u32 v250, s29, v19
    v_add_u32 v19, s46, v19
    v_add_u32 v176, 0xf000, v19
    v_mov_b32 v17, v15
    v_and_b32 v18, 3, v17
    v_mul_u32_u24 v17, 0x1e00, v17
    v_lshlrev_b32 v18, 1, v18
    v_bfe_u32 v241, v16, 1, 1
    v_or_b32 v18, v18, v241
    v_xor_b32 v18, v18, v14
    v_lshl_add_u32 v17, v18, 4, v17
    v_mul_u32_u24 v18, 0x180, v16
    v_add_u32 v240, v17, v18
    v_xor_b32 v241, 64, v240
    s_add_u32 m0, s46, 0x7800
    s_add_u32 s61, s39, 0x9180
    buffer_load_dwordx4 v168, s[4:7], s41 offen lds
    s_add_u32 m0, s29, 0xc00
    s_add_u32 s62, s39, 0x12180
    s_add_u32 s56, s41, s45
    s_add_u32 s63, s39, 0x1b180
    s_add_u32 s57, s41, s45
    s_add_u32 s60, s39, 0x24180
    s_add_u32 s58, s41, s45
    s_lshl1_add_u32 s59, s45, s41
    s_lshl1_add_u32 s50, s45, s41
    v_lshlrev_b32 v12, 4, v1
    s_and_b32 s65, s48, 0xfff0
    s_add_u32 s51, s42, s45
    s_add_u32 s52, s42, s45
    s_add_u32 s53, s42, s45
    s_lshl1_add_u32 s54, s45, s42
    s_lshl1_add_u32 s55, s45, s42
    v_add_u32 v17, 3, v15
    v_add_u32 v19, 3, v16
    v_and_b32 v18, 3, v17
    v_mul_u32_u24 v17, 0x1e00, v17
    v_lshlrev_b32 v18, 1, v18
    v_bfe_u32 v243, v19, 1, 1
    v_or_b32 v18, v18, v243
    v_xor_b32 v18, v18, v14
    v_lshl_add_u32 v17, v18, 4, v17
    v_mul_u32_u24 v18, 0x180, v19
    v_add_u32 v242, v17, v18
    v_xor_b32 v243, 64, v242
    v_accvgpr_write_b32 a252, v168
    v_accvgpr_read_b32 v254, a252
    v_accvgpr_write_b32 a253, v169
    v_accvgpr_read_b32 v255, a253
    v_accvgpr_write_b32 a254, v170
    v_accvgpr_write_b32 a255, v171
    v_mov_b32 v17, 0x3f803f80
    v_accvgpr_write_b32 a248, v17
    v_accvgpr_write_b32 a249, v17
    v_accvgpr_write_b32 a250, v17
    v_accvgpr_write_b32 a251, v17
    v_mov_b32 v248, 0
    s_and_b32 s66, s28, 1
    s_lshl_b32 s66, s66, 2
    s_lshr_b32 s67, s28, 1
    s_lshl_b32 s67, s67, 3
    v_lshrrev_b32 v18, 1, v13
    v_xor_b32 v18, v14, v18
    v_xor_b32 v18, s66, v18
    v_mul_u32_u24 v17, 0x180, v13
    v_lshl_add_u32 v17, v18, 4, v17
    v_add_u32 v17, s67, v17
    s_mul_i32 s67, s28, 0x600
    v_add_u32 v247, 0x7800, v17
    v_add_u32 v251, 0x1e000, v17
    v_sub_u32 v17, v14, v15
    v_mul_i32_i24 v17, 0x1c0, v17
    v_lshlrev_b32 v18, 4, v16
    v_sub_u32 v17, v17, v18
    v_add_u32 v17, s37, v17
    v_max_u32 v18, s33, v15
    v_sub_u32 v18, v14, v18
    v_add_u32 v244, 0, v18
    v_cmp_gt_u32 vcc, 7, v244
    v_add_u32 v244, 0xfffdc870, v17
    v_add_u32 v245, 4, v18
    v_cndmask_b32 v244, 0, v244, vcc
    v_add_u32 v244, 0x237c0, v244
    v_cmp_gt_u32 vcc, 7, v245
    v_add_u32 v245, 0xfffdcf70, v17
    v_add_u32 v246, 8, v18
    v_cndmask_b32 v245, 0, v245, vcc
    v_add_u32 v245, 0x237c0, v245
    v_cmp_gt_u32 vcc, 7, v246
    v_add_u32 v246, 0xfffdd670, v17
    v_min_u32 v20, 55, v1
    v_cndmask_b32 v246, 0, v246, vcc
    v_add_u32 v246, 0x237c0, v246
    v_lshlrev_b32 v62, 3, v20
    s_mul_i32 s64, s35, 0xfc0
    s_add_u32 s64, s64, s37
    v_add_u32 v62, s64, v62
    v_lshrrev_b32 v21, 1, v20
    v_and_b32 v20, 1, v20
    v_lshlrev_b32 v20, 1, v20
    v_add_u32 v22, -12, v21
    v_cmp_lt_u32 vcc, 11, v21
    v_mov_b32 v23, s34
    s_lshl_b32 s66, s36, 1
    v_cndmask_b32 v22, v21, v22, vcc
    v_cndmask_b32 v23, 0, v23, vcc
    s_sub_u32 s66, 1, s66
    v_add_u32 v63, 0, v20
    v_add3_u32 v64, v22, v63, -6
    v_add_u32 v65, 3, v64
    v_and_b32 v66, 12, v22
    v_add3_u32 v66, v66, v63, -3
    v_cmp_ne_u32 vcc, 0, v23
    v_mul_i32_i24 v64, s66, v64
    v_add_lshl_u32 v64, v64, 6, 1
    v_cndmask_b32 v65, v65, v66, vcc
    v_cmp_gt_u32 vcc, 7, v65
    v_mov_b32 v65, 0xf149f2ca
    v_add_u32 v63, 1, v20
    v_cndmask_b32 v50, 0, v64, vcc
    v_mov_b32 v64, 0x3fb8aa3b
    v_cndmask_b32 v52, 0, v64, vcc
    v_mov_b32 v64, 0
    v_cndmask_b32 v60, v65, v64, vcc
    v_add3_u32 v64, v22, v63, -6
    v_add_u32 v65, 3, v64
    v_and_b32 v66, 12, v22
    v_add3_u32 v66, v66, v63, -3
    v_cmp_ne_u32 vcc, 0, v23
    v_mul_i32_i24 v64, s66, v64
    v_add_lshl_u32 v64, v64, 6, 1
    v_cndmask_b32 v65, v65, v66, vcc
    v_cmp_gt_u32 vcc, 7, v65
    v_mov_b32 v65, 0xf149f2ca
    v_mbcnt_lo_u32_b32 v24, -1, 0
    v_cndmask_b32 v51, 0, v64, vcc
    v_mov_b32 v64, 0x3fb8aa3b
    v_cndmask_b32 v53, 0, v64, vcc
    v_mov_b32 v64, 0
    v_cndmask_b32 v61, v65, v64, vcc
    buffer_load_dwordx4 v172, s[8:11], s61 offen lds
    s_add_u32 m0, s29, 0x1000
    v_mbcnt_hi_u32_b32 v24, -1, v24
    v_add_u32 v25, 0, v24
    v_mul_u32_u24 v26, 0x2aab, v25
    v_lshrrev_b32 v26, 16, v26
    v_mul_u32_u24 v27, 6, v26
    v_sub_u32 v25, v25, v27
    v_lshrrev_b32 v27, 1, v26
    v_and_b32 v27, 4, v27
    v_xor_b32 v26, v26, v27
    v_bfe_u32 v27, v26, 2, 1
    v_mul_u32_u24 v28, 0x60, v27
    v_lshrrev_b32 v27, 3, v26
    v_lshl_add_u32 v28, v27, 2, v28
    v_and_or_b32 v26, v26, 3, v28
    buffer_load_dwordx4 v173, s[8:11], s61 offen lds
    s_add_u32 m0, s46, 0x7c00
    v_lshrrev_b32 v27, 1, v25
    v_and_b32 v25, 1, v25
    v_lshl_add_u32 v25, v27, 3, v25
    v_mul_u32_u24 v26, 0x180, v26
    v_lshl_add_u32 v28, v25, 4, v26
    v_add_u32 v25, 64, v24
    v_mul_u32_u24 v26, 0x2aab, v25
    v_lshrrev_b32 v26, 16, v26
    v_mul_u32_u24 v27, 6, v26
    v_sub_u32 v25, v25, v27
    v_lshrrev_b32 v27, 1, v26
    v_and_b32 v27, 4, v27
    v_xor_b32 v26, v26, v27
    v_bfe_u32 v27, v26, 2, 1
    buffer_load_dwordx4 v169, s[4:7], s41 offen lds
    s_add_u32 m0, s29, 0x1400
    v_mul_u32_u24 v29, 0x60, v27
    v_lshrrev_b32 v27, 3, v26
    v_lshl_add_u32 v29, v27, 2, v29
    v_and_or_b32 v26, v26, 3, v29
    v_lshrrev_b32 v27, 1, v25
    v_and_b32 v25, 1, v25
    v_lshl_add_u32 v25, v27, 3, v25
    v_mul_u32_u24 v26, 0x180, v26
    v_lshl_add_u32 v29, v25, 4, v26
    v_add_u32 v25, 0x80, v24
    v_mul_u32_u24 v26, 0x2aab, v25
    v_lshrrev_b32 v26, 16, v26
    v_mul_u32_u24 v27, 6, v26
    v_sub_u32 v25, v25, v27
    buffer_load_dwordx4 v174, s[8:11], s61 offen lds
    s_add_u32 m0, s29, 0x1800
    s_add_u32 s61, s39, 0x2d180
    v_lshrrev_b32 v27, 1, v26
    v_and_b32 v27, 4, v27
    v_xor_b32 v26, v26, v27
    v_bfe_u32 v27, v26, 2, 1
    v_mul_u32_u24 v58, 0x60, v27
    v_lshrrev_b32 v27, 3, v26
    v_lshl_add_u32 v58, v27, 2, v58
    v_and_or_b32 v26, v26, 3, v58
    v_lshrrev_b32 v27, 1, v25
    v_and_b32 v25, 1, v25
    v_lshl_add_u32 v25, v27, 3, v25
    v_mul_u32_u24 v26, 0x180, v26
    v_lshl_add_u32 v58, v25, 4, v26
    buffer_load_dwordx4 v172, s[8:11], s62 offen lds
    s_add_u32 m0, s46, 0x8000
    s_mul_i32 s66, s28, 0x4800
    v_lshl_add_u32 v89, v24, 4, s66
    s_mul_i32 s66, s28, 0x4800
    s_and_b32 s64, s48, 15
    s_add_u32 s64, s64, s37
    v_add_u32 v50, s64, v50
    v_add_u32 v51, s64, v51
    v_mov_b32 v64, 0xf149f2ca
    v_mov_b32 v65, 0xf149f2ca
    v_lshlrev_b32 v63, 3, v1
    v_add_u32 v63, 0x237c0, v63
    ds_write_b64 v63, v[64:65] offset:0
    buffer_load_dwordx4 v170, s[4:7], s41 offen lds
    s_add_u32 m0, s29, 0x1c00
    s_nop 0
    buffer_load_dwordx4 v173, s[8:11], s62 offen lds
    s_add_u32 m0, s29, 0x2000
    s_nop 0
    s_waitcnt vmcnt(11)
    s_barrier
    ds_read_b128 a[216:219], v240 offset:0
    ds_read_b128 a[220:223], v240 offset:1536
    ds_read_b128 a[224:227], v240 offset:3072
    ds_read_b128 a[228:231], v240 offset:4608
    ds_read_b128 a[232:235], v241 offset:0
    ds_read_b128 a[236:239], v241 offset:1536
    ds_read_b128 a[240:243], v241 offset:3072
    ds_read_b128 a[244:247], v241 offset:4608
    buffer_load_dwordx4 v174, s[8:11], s62 offen lds
    s_add_u32 m0, s46, 0x8400
    s_add_u32 s62, s39, 0x300
    buffer_load_dwordx4 v168, s[4:7], s56 offen lds
    s_add_u32 m0, s29, 0x2400
    s_mov_b32 s56, 0
    buffer_load_dwordx4 v172, s[8:11], s63 offen lds
    s_add_u32 m0, s29, 0x2800
    s_nop 0
    s_waitcnt vmcnt(11)
    ds_read_b64_tr_b16 a[0:1], v249 offset:0
    ds_read_b64_tr_b16 a[2:3], v250 offset:0
    ds_read_b64_tr_b16 a[24:25], v249 offset:32
    ds_read_b64_tr_b16 a[26:27], v250 offset:32
    ds_read_b64_tr_b16 a[48:49], v249 offset:64
    ds_read_b64_tr_b16 a[50:51], v250 offset:64
    buffer_load_dwordx4 v173, s[8:11], s63 offen lds
    s_add_u32 m0, s46, 0x8800
    s_nop 0
    buffer_load_dwordx4 v169, s[4:7], s57 offen lds
    s_add_u32 m0, s29, 0x2c00
    s_mov_b32 s57, 0x1800
    s_waitcnt lgkmcnt(4)
    v_mfma_f32_16x16x32_bf16 v[180:183], a[0:3], a[216:219], 0
    v_mfma_f32_16x16x32_bf16 v[192:195], a[0:3], a[220:223], 0
    s_waitcnt lgkmcnt(1)
    v_mfma_f32_16x16x32_bf16 v[184:187], a[24:27], a[216:219], 0
    s_waitcnt lgkmcnt(0)
    v_mfma_f32_16x16x32_bf16 v[188:191], a[48:51], a[216:219], 0
    ds_read_b128 a[216:219], v240 offset:128
    v_mfma_f32_16x16x32_bf16 v[196:199], a[24:27], a[220:223], 0
    buffer_load_dwordx4 v174, s[8:11], s63 offen lds
    s_add_u32 m0, s46, 0xf000
    v_mfma_f32_16x16x32_bf16 v[200:203], a[48:51], a[220:223], 0
    ds_read_b128 a[220:223], v240 offset:1664
    s_add_u32 s63, s39, 0x9300
    v_mfma_f32_16x16x32_bf16 v[204:207], a[0:3], a[224:227], 0
    v_mfma_f32_16x16x32_bf16 v[208:211], a[24:27], a[224:227], 0
    v_mfma_f32_16x16x32_bf16 v[212:215], a[48:51], a[224:227], 0
    ds_read_b128 a[224:227], v240 offset:3200
    v_mfma_f32_16x16x32_bf16 v[216:219], a[0:3], a[228:231], 0
    buffer_load_dwordx4 v172, s[8:11], s60 offen lds
    s_add_u32 m0, s46, 0x8c00
    v_mfma_f32_16x16x32_bf16 v[220:223], a[24:27], a[228:231], 0
    v_mfma_f32_16x16x32_bf16 v[224:227], a[48:51], a[228:231], 0
    ds_read_b128 a[228:231], v240 offset:4736
    s_waitcnt vmcnt(10)
    ds_read_b64_tr_b16 a[4:5], v249 offset:3072
    buffer_load_dwordx4 v170, s[4:7], s58 offen lds
    s_add_u32 m0, s46, 0xf400
    ds_read_b64_tr_b16 a[6:7], v250 offset:3072
    ds_read_b64_tr_b16 a[28:29], v249 offset:3104
    ds_read_b64_tr_b16 a[30:31], v250 offset:3104
    ds_read_b64_tr_b16 a[52:53], v249 offset:3136
    ds_read_b64_tr_b16 a[54:55], v250 offset:3136
    s_mov_b32 s58, 0x3000
    buffer_load_dwordx4 v173, s[8:11], s60 offen lds
    s_add_u32 m0, s46, 0xf800
    s_nop 0
    s_waitcnt lgkmcnt(4)
    v_mfma_f32_16x16x32_bf16 v[180:183], a[4:7], a[232:235], v[180:183]
    buffer_load_dwordx4 v174, s[8:11], s60 offen lds
    s_add_u32 m0, s46, 0x9000
    v_mfma_f32_16x16x32_bf16 v[192:195], a[4:7], a[236:239], v[192:195]
    s_add_u32 s60, s39, 0x12300
    s_waitcnt lgkmcnt(1)
    s_waitcnt lgkmcnt(0)
    v_mfma_f32_16x16x32_bf16 v[184:187], a[28:31], a[232:235], v[184:187]
    v_mfma_f32_16x16x32_bf16 v[188:191], a[52:55], a[232:235], v[188:191]
    ds_read_b128 a[232:235], v241 offset:128
    v_mfma_f32_16x16x32_bf16 v[196:199], a[28:31], a[236:239], v[196:199]
    v_mfma_f32_16x16x32_bf16 v[200:203], a[52:55], a[236:239], v[200:203]
    ds_read_b128 a[236:239], v241 offset:1664
    v_mfma_f32_16x16x32_bf16 v[204:207], a[4:7], a[240:243], v[204:207]
    buffer_load_dwordx4 v168, s[4:7], s59 offen lds
    s_add_u32 m0, s46, 0xfc00
    v_mfma_f32_16x16x32_bf16 v[208:211], a[28:31], a[240:243], v[208:211]
    s_mov_b32 s59, 0x400
    v_mfma_f32_16x16x32_bf16 v[212:215], a[52:55], a[240:243], v[212:215]
    ds_read_b128 a[240:243], v241 offset:3200
    s_waitcnt vmcnt(10)
    v_mfma_f32_16x16x32_bf16 v[216:219], a[4:7], a[244:247], v[216:219]
    ds_read_b64_tr_b16 a[8:9], v249 offset:6144
    v_mfma_f32_16x16x32_bf16 v[220:223], a[28:31], a[244:247], v[220:223]
    ds_read_b64_tr_b16 a[10:11], v250 offset:6144
    v_mfma_f32_16x16x32_bf16 v[224:227], a[52:55], a[244:247], v[224:227]
    ds_read_b128 a[244:247], v241 offset:4736
    buffer_load_dwordx4 v172, s[8:11], s61 offen lds
    s_add_u32 m0, s46, 0x10000
    ds_read_b64_tr_b16 a[32:33], v249 offset:6176
    ds_read_b64_tr_b16 a[34:35], v250 offset:6176
    ds_read_b64_tr_b16 a[56:57], v249 offset:6208
    ds_read_b64_tr_b16 a[58:59], v250 offset:6208
    buffer_load_dwordx4 v173, s[8:11], s61 offen lds
    s_add_u32 m0, s46, 0x9200
    s_nop 0
    s_waitcnt lgkmcnt(5)
    v_mfma_f32_16x16x32_bf16 v[180:183], a[8:11], a[216:219], v[180:183]
    v_mfma_f32_16x16x32_bf16 v[192:195], a[8:11], a[220:223], v[192:195]
    v_mfma_f32_16x16x32_bf16 v[204:207], a[8:11], a[224:227], v[204:207]
    buffer_load_dwordx4 v171, s[4:7], s50 offen lds
    s_add_u32 m0, s46, 0x10400
    v_mfma_f32_16x16x32_bf16 v[216:219], a[8:11], a[228:231], v[216:219]
    s_waitcnt lgkmcnt(1)
    s_mov_b32 s50, 0x1c00
    s_waitcnt lgkmcnt(0)
    v_mfma_f32_16x16x32_bf16 v[184:187], a[32:35], a[216:219], v[184:187]
    v_mfma_f32_16x16x32_bf16 v[188:191], a[56:59], a[216:219], v[188:191]
    ds_read_b128 a[216:219], v240 offset:256
    v_mfma_f32_16x16x32_bf16 v[196:199], a[32:35], a[220:223], v[196:199]
    v_mfma_f32_16x16x32_bf16 v[200:203], a[56:59], a[220:223], v[200:203]
    ds_read_b128 a[220:223], v240 offset:1792
    v_mfma_f32_16x16x32_bf16 v[208:211], a[32:35], a[224:227], v[208:211]
    buffer_load_dwordx4 v174, s[8:11], s61 offen lds
    s_add_u32 m0, s37, 0xd80
    v_mfma_f32_16x16x32_bf16 v[212:215], a[56:59], a[224:227], v[212:215]
    ds_read_b128 a[224:227], v240 offset:3328
    s_add_u32 s61, s39, 0x1b300
    v_mfma_f32_16x16x32_bf16 v[220:223], a[32:35], a[228:231], v[220:223]
    v_mfma_f32_16x16x32_bf16 v[224:227], a[56:59], a[228:231], v[224:227]
    ds_read_b128 a[228:231], v240 offset:4864
    buffer_load_dwordx4 v12, s[16:19], s65 offen lds
    s_add_u32 m0, s46, 0xf000
    s_waitcnt vmcnt(10)
    ds_read_b64_tr_b16 a[12:13], v249 offset:9216
    ds_read_b64_tr_b16 a[14:15], v250 offset:9216
    ds_read_b64_tr_b16 a[36:37], v249 offset:9248
    ds_read_b64_tr_b16 a[38:39], v250 offset:9248
    ds_read_b64_tr_b16 a[60:61], v249 offset:9280
    ds_read_b64_tr_b16 a[62:63], v250 offset:9280
    s_waitcnt lgkmcnt(4)
    v_mfma_f32_16x16x32_bf16 v[180:183], a[12:15], a[232:235], v[180:183]
    v_mfma_f32_16x16x32_bf16 v[192:195], a[12:15], a[236:239], v[192:195]
    s_waitcnt lgkmcnt(1)
    v_mfma_f32_16x16x32_bf16 v[184:187], a[36:39], a[232:235], v[184:187]
    s_waitcnt lgkmcnt(0)
    v_mfma_f32_16x16x32_bf16 v[188:191], a[60:63], a[232:235], v[188:191]
    ds_read_b128 a[232:235], v241 offset:256
    v_mfma_f32_16x16x32_bf16 v[196:199], a[36:39], a[236:239], v[196:199]
    v_mfma_f32_16x16x32_bf16 v[200:203], a[60:63], a[236:239], v[200:203]
    ds_read_b128 a[236:239], v241 offset:1792
    v_mfma_f32_16x16x32_bf16 v[204:207], a[12:15], a[240:243], v[204:207]
    v_mfma_f32_16x16x32_bf16 v[208:211], a[36:39], a[240:243], v[208:211]
    v_mfma_f32_16x16x32_bf16 v[212:215], a[60:63], a[240:243], v[212:215]
    ds_read_b128 a[240:243], v241 offset:3328
    v_mfma_f32_16x16x32_bf16 v[216:219], a[12:15], a[244:247], v[216:219]
    s_waitcnt vmcnt(6)
    ds_read_b64_tr_b16 a[16:17], v175 offset:0
    v_mfma_f32_16x16x32_bf16 v[220:223], a[36:39], a[244:247], v[220:223]
    ds_read_b64_tr_b16 a[18:19], v176 offset:0
    v_mfma_f32_16x16x32_bf16 v[224:227], a[60:63], a[244:247], v[224:227]
    ds_read_b128 a[244:247], v241 offset:4864
    ds_read_b64_tr_b16 a[40:41], v175 offset:32
    ds_read_b64_tr_b16 a[42:43], v176 offset:32
    ds_read_b64_tr_b16 a[64:65], v175 offset:64
    ds_read_b64_tr_b16 a[66:67], v176 offset:64
    s_waitcnt lgkmcnt(5)
    v_mfma_f32_16x16x32_bf16 v[180:183], a[16:19], a[216:219], v[180:183]
    v_mfma_f32_16x16x32_bf16 v[192:195], a[16:19], a[220:223], v[192:195]
    v_mfma_f32_16x16x32_bf16 v[204:207], a[16:19], a[224:227], v[204:207]
    s_waitcnt lgkmcnt(1)
    v_mfma_f32_16x16x32_bf16 v[184:187], a[40:43], a[216:219], v[184:187]
    s_waitcnt lgkmcnt(0)
    buffer_load_dwordx4 v168, s[4:7], s42 offen lds
    v_mfma_f32_16x16x32_bf16 v[188:191], a[64:67], a[216:219], v[188:191]
    s_add_u32 m0, s29, 0
    v_mfma_f32_16x16x32_bf16 v[196:199], a[40:43], a[220:223], v[196:199]
    v_mfma_f32_16x16x32_bf16 v[200:203], a[64:67], a[220:223], v[200:203]
    v_mfma_f32_16x16x32_bf16 v[208:211], a[40:43], a[224:227], v[208:211]
    v_mfma_f32_16x16x32_bf16 v[212:215], a[64:67], a[224:227], v[212:215]
    buffer_load_dwordx4 v172, s[8:11], s62 offen lds
    s_add_u32 m0, s29, 0x400
    v_mfma_f32_16x16x32_bf16 v[216:219], a[16:19], a[228:231], v[216:219]
    v_mfma_f32_16x16x32_bf16 v[220:223], a[40:43], a[228:231], v[220:223]
    v_mfma_f32_16x16x32_bf16 v[224:227], a[64:67], a[228:231], v[224:227]
    s_waitcnt vmcnt(4)
    s_barrier
    ds_read_b128 a[216:219], v240 offset:30720
    ds_read_b128 a[220:223], v241 offset:30720
    ds_read_b128 a[224:227], v240 offset:30848
    ds_read_b128 a[228:231], v241 offset:30848
    buffer_load_dwordx4 v173, s[8:11], s62 offen lds
    s_add_u32 m0, s46, 0xf400
    s_nop 0
    buffer_load_dwordx4 v169, s[4:7], s42 offen lds
    s_add_u32 m0, s29, 0x800
    s_waitcnt vmcnt(5)
    ds_read_b64_tr_b16 a[20:21], v175 offset:3072
    ds_read_b64_tr_b16 a[22:23], v176 offset:3072
    ds_read_b64_tr_b16 a[44:45], v175 offset:3104
    ds_read_b64_tr_b16 a[46:47], v176 offset:3104
    ds_read_b64_tr_b16 a[68:69], v175 offset:3136
    ds_read_b64_tr_b16 a[70:71], v176 offset:3136
    buffer_load_dwordx4 v174, s[8:11], s62 offen lds
    s_add_u32 m0, s29, 0xc00
    s_add_u32 s62, s39, 0x24300
    buffer_load_dwordx4 v172, s[8:11], s63 offen lds
    s_add_u32 m0, s46, 0xf800
    s_waitcnt vmcnt(6) lgkmcnt(4)
    v_mfma_f32_16x16x32_bf16 v[180:183], a[20:23], a[232:235], v[180:183]
    ds_read_u16 v30, v50 offset:3456
    s_waitcnt lgkmcnt(3)
    v_mfma_f32_16x16x32_bf16 v[184:187], a[44:47], a[232:235], v[184:187]
    ds_read_u16 v31, v51 offset:3456
    s_waitcnt lgkmcnt(2)
    v_mfma_f32_16x16x32_bf16 v[188:191], a[68:71], a[232:235], v[188:191]
    ds_read_b128 a[232:235], v240 offset:30976
    v_mfma_f32_16x16x32_bf16 v[192:195], a[20:23], a[236:239], v[192:195]
    ds_read_u16 v32, v50 offset:3482
    v_cvt_pk_bf16_f32 v90, v180, v181
    v_mfma_f32_16x16x32_bf16 v[196:199], a[44:47], a[236:239], v[196:199]
    buffer_load_dwordx4 v170, s[4:7], s42 offen lds
    v_cvt_pk_bf16_f32 v91, v182, v183
    v_mfma_f32_16x16x32_bf16 v[200:203], a[68:71], a[236:239], v[200:203]
    ds_read_b128 a[236:239], v241 offset:30976
    v_cvt_pk_bf16_f32 v92, v184, v185
    v_mfma_f32_16x16x32_bf16 v[204:207], a[20:23], a[240:243], v[204:207]
    ds_read_u16 v33, v51 offset:3482
    v_cvt_pk_bf16_f32 v93, v186, v187
    v_mfma_f32_16x16x32_bf16 v[208:211], a[44:47], a[240:243], v[208:211]
    ds_read_u16 v34, v50 offset:3508
    v_cvt_pk_bf16_f32 v94, v188, v189
    v_mfma_f32_16x16x32_bf16 v[212:215], a[68:71], a[240:243], v[212:215]
    ds_read_b128 a[240:243], v240 offset:32256
    v_cvt_pk_bf16_f32 v95, v190, v191
    v_mfma_f32_16x16x32_bf16 v[216:219], a[20:23], a[244:247], v[216:219]
    ds_read_u16 v35, v51 offset:3508
    v_cvt_pk_bf16_f32 v96, v192, v193
    v_mfma_f32_16x16x32_bf16 v[220:223], a[44:47], a[244:247], v[220:223]
    ds_read_u16 v36, v50 offset:3534
    v_cvt_pk_bf16_f32 v97, v194, v195
    v_mfma_f32_16x16x32_bf16 v[224:227], a[68:71], a[244:247], v[224:227]
    ds_read_b128 a[244:247], v241 offset:32256
    v_cvt_pk_bf16_f32 v98, v196, v197
    v_mfma_f32_16x16x32_bf16 v[180:183], a[0:3], a[216:219], 0
    ds_read_u16 v37, v51 offset:3534
    v_cvt_pk_bf16_f32 v99, v198, v199
    v_mfma_f32_16x16x32_bf16 v[184:187], a[24:27], a[216:219], 0
    ds_read_u16 v38, v50 offset:3560
    v_cvt_pk_bf16_f32 v100, v200, v201
    v_mfma_f32_16x16x32_bf16 v[188:191], a[48:51], a[216:219], 0
    ds_read_b128 a[216:219], v240 offset:32384
    v_cvt_pk_bf16_f32 v101, v202, v203
    v_mfma_f32_16x16x32_bf16 v[180:183], a[4:7], a[220:223], v[180:183]
    ds_read_u16 v39, v51 offset:3560
    v_cvt_pk_bf16_f32 v102, v204, v205
    v_mfma_f32_16x16x32_bf16 v[184:187], a[28:31], a[220:223], v[184:187]
    ds_read_u16 v40, v50 offset:3586
    v_cvt_pk_bf16_f32 v103, v206, v207
    v_mfma_f32_16x16x32_bf16 v[188:191], a[52:55], a[220:223], v[188:191]
    ds_read_b128 a[220:223], v241 offset:32384
    v_cvt_pk_bf16_f32 v104, v208, v209
    v_mfma_f32_16x16x32_bf16 v[180:183], a[8:11], a[224:227], v[180:183]
    ds_read_u16 v41, v51 offset:3586
    v_cvt_pk_bf16_f32 v105, v210, v211
    v_mfma_f32_16x16x32_bf16 v[184:187], a[32:35], a[224:227], v[184:187]
    ds_read_u16 v42, v50 offset:3612
    v_cvt_pk_bf16_f32 v106, v212, v213
    v_mfma_f32_16x16x32_bf16 v[188:191], a[56:59], a[224:227], v[188:191]
    ds_read_b128 a[224:227], v240 offset:32512
    v_cvt_pk_bf16_f32 v107, v214, v215
    v_mfma_f32_16x16x32_bf16 v[180:183], a[12:15], a[228:231], v[180:183]
    ds_read_u16 v43, v51 offset:3612
    v_cvt_pk_bf16_f32 v108, v216, v217
    v_mfma_f32_16x16x32_bf16 v[184:187], a[36:39], a[228:231], v[184:187]
    ds_read_u16 v44, v50 offset:3638
    v_cvt_pk_bf16_f32 v109, v218, v219
    v_mfma_f32_16x16x32_bf16 v[188:191], a[60:63], a[228:231], v[188:191]
    s_waitcnt lgkmcnt(8)
    v_cvt_pk_bf16_f32 v110, v220, v221
    v_cvt_pk_bf16_f32 v111, v222, v223
    v_mfma_f32_16x16x32_bf16 v[180:183], a[16:19], a[232:235], v[180:183]
    ds_read_b128 a[228:231], v241 offset:32512
    v_cvt_pk_bf16_f32 v112, v224, v225
    v_mfma_f32_16x16x32_bf16 v[184:187], a[40:43], a[232:235], v[184:187]
    ds_read_u16 v45, v51 offset:3638
    v_cvt_pk_bf16_f32 v113, v226, v227
    v_mfma_f32_16x16x32_bf16 v[188:191], a[64:67], a[232:235], v[188:191]
    ds_read_b128 a[232:235], v240 offset:33792
    v_lshlrev_b32 v30, 16, v30
    v_mfma_f32_16x16x32_bf16 v[180:183], a[20:23], a[236:239], v[180:183]
    ds_read_u16 v46, v50 offset:3664
    v_fma_f32 v30, v30, v52, v60
    v_mfma_f32_16x16x32_bf16 v[184:187], a[44:47], a[236:239], v[184:187]
    ds_read_u16 v47, v51 offset:3664
    v_lshlrev_b32 v31, 16, v31
    v_mfma_f32_16x16x32_bf16 v[188:191], a[68:71], a[236:239], v[188:191]
    ds_read_b128 a[236:239], v241 offset:33792
    v_fma_f32 v31, v31, v53, v61
    v_mfma_f32_16x16x32_bf16 v[192:195], a[0:3], a[240:243], 0
    ds_read_u16 v48, v50 offset:3690
    v_cvt_pk_bf16_f32 v114, v180, v181
    v_mfma_f32_16x16x32_bf16 v[196:199], a[24:27], a[240:243], 0
    ds_read_u16 v49, v51 offset:3690
    v_cvt_pk_bf16_f32 v115, v182, v183
    v_mfma_f32_16x16x32_bf16 v[200:203], a[48:51], a[240:243], 0
    ds_read_b128 a[240:243], v240 offset:33920
    v_cvt_pk_bf16_f32 v116, v184, v185
    v_mfma_f32_16x16x32_bf16 v[192:195], a[4:7], a[244:247], v[192:195]
    ds_write_b64 v62, v[30:31] offset:0
    v_mfma_f32_16x16x32_bf16 v[196:199], a[28:31], a[244:247], v[196:199]
    s_add_u32 m0, s29, 0x1000
    v_cvt_pk_bf16_f32 v117, v186, v187
    v_cvt_pk_bf16_f32 v118, v188, v189
    v_mfma_f32_16x16x32_bf16 v[200:203], a[52:55], a[244:247], v[200:203]
    ds_read_b128 a[244:247], v241 offset:33920
    v_cvt_pk_bf16_f32 v119, v190, v191
    v_mfma_f32_16x16x32_bf16 v[192:195], a[8:11], a[216:219], v[192:195]
    buffer_load_dwordx4 v173, s[8:11], s63 offen lds
    v_add_u32 v62, s49, v62
    v_mfma_f32_16x16x32_bf16 v[196:199], a[32:35], a[216:219], v[196:199]
    s_add_u32 m0, s29, 0x1400
    v_lshlrev_b32 v32, 16, v32
    v_fma_f32 v32, v32, v52, v60
    v_mfma_f32_16x16x32_bf16 v[200:203], a[56:59], a[216:219], v[200:203]
    s_waitcnt lgkmcnt(4)
    v_lshlrev_b32 v33, 16, v33
    v_fma_f32 v33, v33, v53, v61
    v_mfma_f32_16x16x32_bf16 v[192:195], a[12:15], a[220:223], v[192:195]
    ds_read_b128 a[216:219], v240 offset:34048
    v_lshlrev_b32 v34, 16, v34
    v_mfma_f32_16x16x32_bf16 v[196:199], a[36:39], a[220:223], v[196:199]
    ds_write_b64 v62, v[32:33] offset:0
    v_mfma_f32_16x16x32_bf16 v[200:203], a[60:63], a[220:223], v[200:203]
    ds_read_b128 a[220:223], v241 offset:34048
    v_add_u32 v62, s49, v62
    v_mfma_f32_16x16x32_bf16 v[192:195], a[16:19], a[224:227], v[192:195]
    buffer_load_dwordx4 v174, s[8:11], s63 offen lds
    v_fma_f32 v34, v34, v52, v60
    v_mfma_f32_16x16x32_bf16 v[196:199], a[40:43], a[224:227], v[196:199]
    s_add_u32 m0, s46, 0xfc00
    v_lshlrev_b32 v35, 16, v35
    v_fma_f32 v35, v35, v53, v61
    v_mfma_f32_16x16x32_bf16 v[200:203], a[64:67], a[224:227], v[200:203]
    ds_read_b128 a[224:227], v240 offset:35328
    v_lshlrev_b32 v36, 16, v36
    v_mfma_f32_16x16x32_bf16 v[192:195], a[20:23], a[228:231], v[192:195]
    ds_write_b64 v62, v[34:35] offset:0
    v_mfma_f32_16x16x32_bf16 v[196:199], a[44:47], a[228:231], v[196:199]
    buffer_load_dwordx4 v168, s[4:7], s51 offen lds
    v_add_u32 v62, s49, v62
    v_mfma_f32_16x16x32_bf16 v[200:203], a[68:71], a[228:231], v[200:203]
    ds_read_b128 a[228:231], v241 offset:35328
    v_fma_f32 v36, v36, v52, v60
    v_mfma_f32_16x16x32_bf16 v[204:207], a[0:3], a[232:235], 0
    s_add_u32 m0, s29, 0x1800
    v_cvt_pk_bf16_f32 v120, v192, v193
    v_cvt_pk_bf16_f32 v121, v194, v195
    v_mfma_f32_16x16x32_bf16 v[208:211], a[24:27], a[232:235], 0
    s_add_u32 s63, s39, 0x2d300
    v_cvt_pk_bf16_f32 v122, v196, v197
    v_cvt_pk_bf16_f32 v123, v198, v199
    v_mfma_f32_16x16x32_bf16 v[212:215], a[48:51], a[232:235], 0
    ds_read_b128 a[232:235], v240 offset:35456
    v_cvt_pk_bf16_f32 v124, v200, v201
    v_mfma_f32_16x16x32_bf16 v[204:207], a[4:7], a[236:239], v[204:207]
    buffer_load_dwordx4 v172, s[8:11], s60 offen lds
    v_cvt_pk_bf16_f32 v125, v202, v203
    v_mfma_f32_16x16x32_bf16 v[208:211], a[28:31], a[236:239], v[208:211]
    s_add_u32 m0, s29, 0x1c00
    v_lshlrev_b32 v37, 16, v37
    v_fma_f32 v37, v37, v53, v61
    v_mfma_f32_16x16x32_bf16 v[212:215], a[52:55], a[236:239], v[212:215]
    s_waitcnt vmcnt(6) lgkmcnt(3)
    v_lshlrev_b32 v38, 16, v38
    v_fma_f32 v38, v38, v52, v60
    v_mfma_f32_16x16x32_bf16 v[204:207], a[8:11], a[240:243], v[204:207]
    ds_read_b128 a[236:239], v241 offset:35456
    v_lshlrev_b32 v39, 16, v39
    v_mfma_f32_16x16x32_bf16 v[208:211], a[32:35], a[240:243], v[208:211]
    ds_read_b64_tr_b16 a[72:73], v249 offset:0
    v_fma_f32 v39, v39, v53, v61
    v_mfma_f32_16x16x32_bf16 v[212:215], a[56:59], a[240:243], v[212:215]
    ds_read_b128 a[240:243], v240 offset:35584
    v_lshlrev_b32 v40, 16, v40
    v_mfma_f32_16x16x32_bf16 v[204:207], a[12:15], a[244:247], v[204:207]
    buffer_load_dwordx4 v173, s[8:11], s60 offen lds
    v_fma_f32 v40, v40, v52, v60
    v_mfma_f32_16x16x32_bf16 v[208:211], a[36:39], a[244:247], v[208:211]
    ds_read_b64_tr_b16 a[74:75], v250 offset:0
    v_lshlrev_b32 v41, 16, v41
    v_mfma_f32_16x16x32_bf16 v[212:215], a[60:63], a[244:247], v[212:215]
    ds_read_b128 a[244:247], v241 offset:35584
    v_fma_f32 v41, v41, v53, v61
    v_mfma_f32_16x16x32_bf16 v[204:207], a[16:19], a[216:219], v[204:207]
    ds_read_b64_tr_b16 a[96:97], v249 offset:32
    v_lshlrev_b32 v42, 16, v42
    v_mfma_f32_16x16x32_bf16 v[208:211], a[40:43], a[216:219], v[208:211]
    ds_read_b64_tr_b16 a[98:99], v250 offset:32
    v_fma_f32 v42, v42, v52, v60
    v_mfma_f32_16x16x32_bf16 v[212:215], a[64:67], a[216:219], v[212:215]
    ds_read_b128 a[216:219], v240 offset:0
    v_lshlrev_b32 v43, 16, v43
    v_mfma_f32_16x16x32_bf16 v[204:207], a[20:23], a[220:223], v[204:207]
    ds_read_b64_tr_b16 a[120:121], v249 offset:64
    v_fma_f32 v43, v43, v53, v61
    v_mfma_f32_16x16x32_bf16 v[208:211], a[44:47], a[220:223], v[208:211]
    ds_read_b64_tr_b16 a[122:123], v250 offset:64
    v_lshlrev_b32 v44, 16, v44
    v_mfma_f32_16x16x32_bf16 v[212:215], a[68:71], a[220:223], v[212:215]
    ds_read_b128 a[220:223], v240 offset:1536
    v_fma_f32 v44, v44, v52, v60
    v_mfma_f32_16x16x32_bf16 v[216:219], a[0:3], a[224:227], 0
    ds_write_b64 v62, v[36:37] offset:0
    v_mfma_f32_16x16x32_bf16 v[220:223], a[24:27], a[224:227], 0
    s_add_u32 m0, s46, 0x10000
    v_cvt_pk_bf16_f32 v126, v204, v205
    v_cvt_pk_bf16_f32 v127, v206, v207
    v_mfma_f32_16x16x32_bf16 v[224:227], a[48:51], a[224:227], 0
    s_waitcnt lgkmcnt(6)
    v_cvt_pk_bf16_f32 v128, v208, v209
    v_cvt_pk_bf16_f32 v129, v210, v211
    v_mfma_f32_16x16x32_bf16 v[216:219], a[4:7], a[228:231], v[216:219]
    ds_read_b128 a[224:227], v240 offset:3072
    v_cvt_pk_bf16_f32 v130, v212, v213
    v_mfma_f32_16x16x32_bf16 v[220:223], a[28:31], a[228:231], v[220:223]
    buffer_load_dwordx4 v169, s[4:7], s52 offen lds
    v_cvt_pk_bf16_f32 v131, v214, v215
    v_mfma_f32_16x16x32_bf16 v[224:227], a[52:55], a[228:231], v[224:227]
    ds_read_b128 a[228:231], v241 offset:0
    v_add_u32 v62, s49, v62
    v_mfma_f32_16x16x32_bf16 v[216:219], a[8:11], a[232:235], v[216:219]
    ds_write_b64 v62, v[38:39] offset:0
    v_mfma_f32_16x16x32_bf16 v[220:223], a[32:35], a[232:235], v[220:223]
    s_add_u32 m0, s29, 0x2000
    v_add_u32 v62, s49, v62
    v_lshlrev_b32 v45, 16, v45
    v_mfma_f32_16x16x32_bf16 v[224:227], a[56:59], a[232:235], v[224:227]
    ds_read_b128 a[232:235], v241 offset:1536
    v_fma_f32 v45, v45, v53, v61
    v_mfma_f32_16x16x32_bf16 v[216:219], a[12:15], a[236:239], v[216:219]
    buffer_load_dwordx4 v174, s[8:11], s60 offen lds
    v_lshlrev_b32 v46, 16, v46
    v_mfma_f32_16x16x32_bf16 v[220:223], a[36:39], a[236:239], v[220:223]
    ds_write_b64 v62, v[40:41] offset:0
    v_mfma_f32_16x16x32_bf16 v[224:227], a[60:63], a[236:239], v[224:227]
    ds_read_b128 a[236:239], v241 offset:3072
    v_add_u32 v62, s49, v62
    v_mfma_f32_16x16x32_bf16 v[216:219], a[16:19], a[240:243], v[216:219]
    ds_write_b64 v62, v[42:43] offset:0
    v_mfma_f32_16x16x32_bf16 v[220:223], a[40:43], a[240:243], v[220:223]
    s_add_u32 m0, s29, 0x2400
    v_add_u32 v62, s49, v62
    v_fma_f32 v46, v46, v52, v60
    v_mfma_f32_16x16x32_bf16 v[224:227], a[64:67], a[240:243], v[224:227]
    ds_read_b128 a[240:243], v240 offset:128
    v_lshlrev_b32 v47, 16, v47
    v_mfma_f32_16x16x32_bf16 v[216:219], a[20:23], a[244:247], v[216:219]
    buffer_load_dwordx4 v172, s[8:11], s61 offen lds
    v_fma_f32 v47, v47, v53, v61
    v_mfma_f32_16x16x32_bf16 v[220:223], a[44:47], a[244:247], v[220:223]
    ds_write_b64 v62, v[44:45] offset:0
    v_mfma_f32_16x16x32_bf16 v[224:227], a[68:71], a[244:247], v[224:227]
    s_waitcnt lgkmcnt(5)
    v_add_u32 v62, s49, v62
    v_lshlrev_b32 v48, 16, v48
    v_mfma_f32_16x16x32_bf16 v[180:183], a[216:219], a[72:75], 0
    ds_read_b128 a[244:247], v240 offset:1664
    v_cvt_pk_bf16_f32 v132, v216, v217
    v_mfma_f32_16x16x32_bf16 v[184:187], a[216:219], a[96:99], 0
    ds_write_b64 v62, v[46:47] offset:0
    v_mfma_f32_16x16x32_bf16 v[188:191], a[216:219], a[120:123], 0
    ds_read_b128 a[216:219], v240 offset:3200
    v_cvt_pk_bf16_f32 v133, v218, v219
    v_mfma_f32_16x16x32_bf16 v[192:195], a[220:223], a[72:75], 0
    s_add_u32 m0, s46, 0x10400
    v_cvt_pk_bf16_f32 v134, v220, v221
    v_cvt_pk_bf16_f32 v135, v222, v223
    v_mfma_f32_16x16x32_bf16 v[196:199], a[220:223], a[96:99], 0
    buffer_load_dwordx4 v170, s[4:7], s53 offen lds
    v_cvt_pk_bf16_f32 v136, v224, v225
    v_mfma_f32_16x16x32_bf16 v[200:203], a[220:223], a[120:123], 0
    ds_read_b128 a[220:223], v241 offset:128
    v_cvt_pk_bf16_f32 v137, v226, v227
    v_mfma_f32_16x16x32_bf16 v[204:207], a[224:227], a[72:75], 0
    s_add_u32 m0, s29, 0x2800
    v_add_u32 v62, s49, v62
    v_fma_f32 v48, v48, v52, v60
    v_mfma_f32_16x16x32_bf16 v[208:211], a[224:227], a[96:99], 0
    s_add_u32 s60, s39, 0
    v_lshlrev_b32 v49, 16, v49
    v_fma_f32 v49, v49, v53, v61
    v_mfma_f32_16x16x32_bf16 v[212:215], a[224:227], a[120:123], 0
    s_waitcnt vmcnt(7)
    ds_read_b128 a[224:227], v241 offset:1664
    buffer_load_dwordx4 v173, s[8:11], s61 offen lds
    s_add_u32 m0, s29, 0x2c00
    ds_read_b64_tr_b16 a[76:77], v249 offset:3072
    ds_read_b64_tr_b16 a[78:79], v250 offset:3072
    ds_read_b64_tr_b16 a[100:101], v249 offset:3104
    ds_read_b64_tr_b16 a[102:103], v250 offset:3104
    ds_read_b64_tr_b16 a[124:125], v249 offset:3136
    ds_read_b64_tr_b16 a[126:127], v250 offset:3136
    s_mov_b32 s51, 0x3400
    s_mov_b32 s52, 0x800
    s_mov_b32 s53, 0x2000
    ds_write_b64 v62, v[48:49] offset:0
    buffer_load_dwordx4 v174, s[8:11], s61 offen lds
    s_add_u32 m0, s46, 0x10800
    s_add_u32 s61, s39, 0x9000
    v_add_u32 v62, s49, v62
    buffer_load_dwordx4 v168, s[4:7], s54 offen lds
    s_add_u32 m0, s29, 0
    s_mov_b32 s54, 0x3800
    s_waitcnt lgkmcnt(4)
    v_mfma_f32_16x16x32_bf16 v[180:183], a[228:231], a[76:79], v[180:183]
    s_waitcnt lgkmcnt(3)
    v_mfma_f32_16x16x32_bf16 v[184:187], a[228:231], a[100:103], v[184:187]
    s_waitcnt lgkmcnt(1)
    v_mfma_f32_16x16x32_bf16 v[188:191], a[228:231], a[124:127], v[188:191]
    ds_read_b128 a[228:231], v241 offset:3200
    v_mfma_f32_16x16x32_bf16 v[192:195], a[232:235], a[76:79], v[192:195]
    buffer_load_dwordx4 v172, s[8:11], s62 offen lds
    s_add_u32 m0, s29, 0x400
    v_mfma_f32_16x16x32_bf16 v[196:199], a[232:235], a[100:103], v[196:199]
    v_mfma_f32_16x16x32_bf16 v[200:203], a[232:235], a[124:127], v[200:203]
    ds_read_b128 a[232:235], v240 offset:256
    v_mfma_f32_16x16x32_bf16 v[204:207], a[236:239], a[76:79], v[204:207]
    v_mfma_f32_16x16x32_bf16 v[208:211], a[236:239], a[100:103], v[208:211]
    v_mfma_f32_16x16x32_bf16 v[212:215], a[236:239], a[124:127], v[212:215]
    ds_read_b128 a[236:239], v240 offset:1792
    buffer_load_dwordx4 v173, s[8:11], s62 offen lds
    s_add_u32 m0, s46, 0x10a00
    s_nop 0
    buffer_load_dwordx4 v171, s[4:7], s55 offen lds
    s_add_u32 m0, s29, 0x800
    s_mov_b32 s55, 0xc00
    buffer_load_dwordx4 v174, s[8:11], s62 offen lds
    s_add_u32 m0, s29, 0xc00
    s_add_u32 s62, s39, 0x12000
    s_waitcnt vmcnt(9)
    ds_read_b64_tr_b16 a[80:81], v249 offset:6144
    buffer_load_dwordx4 v172, s[8:11], s63 offen lds
    s_add_u32 m0, s29, 0x1000
    ds_read_b64_tr_b16 a[82:83], v250 offset:6144
    ds_read_b64_tr_b16 a[104:105], v249 offset:6176
    ds_read_b64_tr_b16 a[106:107], v250 offset:6176
    ds_read_b64_tr_b16 a[128:129], v249 offset:6208
    ds_read_b64_tr_b16 a[130:131], v250 offset:6208
    buffer_load_dwordx4 v173, s[8:11], s63 offen lds
    s_add_u32 m0, s29, 0x1400
    s_nop 0
    s_waitcnt lgkmcnt(4)
    v_mfma_f32_16x16x32_bf16 v[180:183], a[240:243], a[80:83], v[180:183]
    buffer_load_dwordx4 v174, s[8:11], s63 offen lds
    s_add_u32 m0, s29, 0x1800
    v_mfma_f32_16x16x32_bf16 v[192:195], a[244:247], a[80:83], v[192:195]
    s_add_u32 s63, s39, 0x1b000
    s_waitcnt lgkmcnt(1)
    s_waitcnt lgkmcnt(0)
    v_mfma_f32_16x16x32_bf16 v[184:187], a[240:243], a[104:107], v[184:187]
    v_mfma_f32_16x16x32_bf16 v[188:191], a[240:243], a[128:131], v[188:191]
    ds_read_b128 a[240:243], v240 offset:3328
    v_mfma_f32_16x16x32_bf16 v[196:199], a[244:247], a[104:107], v[196:199]
    v_mfma_f32_16x16x32_bf16 v[200:203], a[244:247], a[128:131], v[200:203]
    ds_read_b128 a[244:247], v241 offset:256
    v_mfma_f32_16x16x32_bf16 v[204:207], a[216:219], a[80:83], v[204:207]
    buffer_load_dwordx4 v172, s[8:11], s60 offen lds
    s_add_u32 m0, s29, 0x1c00
    v_mfma_f32_16x16x32_bf16 v[208:211], a[216:219], a[104:107], v[208:211]
    v_mfma_f32_16x16x32_bf16 v[212:215], a[216:219], a[128:131], v[212:215]
    ds_read_b128 a[216:219], v241 offset:1792
    buffer_load_dwordx4 v173, s[8:11], s60 offen lds
    s_add_u32 m0, s29, 0x2000
    s_nop 0
    s_waitcnt vmcnt(10)
    ds_read_b64_tr_b16 a[84:85], v249 offset:9216
    ds_read_b64_tr_b16 a[86:87], v250 offset:9216
    ds_read_b64_tr_b16 a[108:109], v249 offset:9248
    ds_read_b64_tr_b16 a[110:111], v250 offset:9248
    buffer_load_dwordx4 v174, s[8:11], s60 offen lds
    ds_read_b64_tr_b16 a[132:133], v249 offset:9280
    ds_read_b64_tr_b16 a[134:135], v250 offset:9280
    s_add_u32 m0, s29, 0x2400
    s_add_u32 s60, s39, 0x24000
    s_waitcnt lgkmcnt(4)
    v_mfma_f32_16x16x32_bf16 v[180:183], a[220:223], a[84:87], v[180:183]
    v_mfma_f32_16x16x32_bf16 v[192:195], a[224:227], a[84:87], v[192:195]
    s_waitcnt lgkmcnt(1)
    v_mfma_f32_16x16x32_bf16 v[184:187], a[220:223], a[108:111], v[184:187]
    s_waitcnt lgkmcnt(0)
    buffer_load_dwordx4 v172, s[8:11], s61 offen lds
    v_mfma_f32_16x16x32_bf16 v[188:191], a[220:223], a[132:135], v[188:191]
    ds_read_b128 a[220:223], v241 offset:3328
    s_add_u32 m0, s29, 0x2800
    v_mfma_f32_16x16x32_bf16 v[196:199], a[224:227], a[108:111], v[196:199]
    v_mfma_f32_16x16x32_bf16 v[200:203], a[224:227], a[132:135], v[200:203]
    ds_read_b128 a[224:227], v240 offset:30720
    v_mfma_f32_16x16x32_bf16 v[204:207], a[228:231], a[84:87], v[204:207]
    v_mfma_f32_16x16x32_bf16 v[208:211], a[228:231], a[108:111], v[208:211]
    buffer_load_dwordx4 v173, s[8:11], s61 offen lds
    s_add_u32 m0, s29, 0x2c00
    v_mfma_f32_16x16x32_bf16 v[212:215], a[228:231], a[132:135], v[212:215]
    ds_read_b128 a[228:231], v241 offset:30720
    s_waitcnt vmcnt(9)
    s_barrier
    buffer_load_dwordx4 v174, s[8:11], s61 offen lds
    s_add_u32 m0, s29, 0
    s_add_u32 s61, s39, 0x2d000
    s_waitcnt lgkmcnt(1)
    v_mfma_f32_16x16x32_bf16 v[216:219], a[224:227], a[72:75], 0
    v_mfma_f32_16x16x32_bf16 v[220:223], a[224:227], a[96:99], 0
    s_waitcnt vmcnt(9)
    ds_read_b64_tr_b16 a[88:89], v249 offset:0
    v_mfma_f32_16x16x32_bf16 v[224:227], a[224:227], a[120:123], 0
    ds_read_b128 a[224:227], v240 offset:32384
    s_waitcnt lgkmcnt(2)
    v_mfma_f32_16x16x32_bf16 v[216:219], a[228:231], a[76:79], v[216:219]
    ds_read_b64_tr_b16 a[90:91], v250 offset:0
    v_mfma_f32_16x16x32_bf16 v[220:223], a[228:231], a[100:103], v[220:223]
    ds_read_b64_tr_b16 a[112:113], v249 offset:32
    v_mfma_f32_16x16x32_bf16 v[224:227], a[228:231], a[124:127], v[224:227]
    ds_read_b128 a[228:231], v241 offset:32384
    ds_read_b64_tr_b16 a[114:115], v250 offset:32
    ds_read_b64_tr_b16 a[136:137], v249 offset:64
    ds_read_b64_tr_b16 a[138:139], v250 offset:64
    s_waitcnt lgkmcnt(5)
    v_mfma_f32_16x16x32_bf16 v[180:183], a[232:235], a[88:91], v[180:183]
    v_mfma_f32_16x16x32_bf16 v[192:195], a[236:239], a[88:91], v[192:195]
    v_mfma_f32_16x16x32_bf16 v[204:207], a[240:243], a[88:91], v[204:207]
    s_waitcnt lgkmcnt(2)
    s_waitcnt vmcnt(6)
    v_mfma_f32_16x16x32_bf16 v[184:187], a[232:235], a[112:115], v[184:187]
    ds_read_b64_tr_b16 a[92:93], v249 offset:3072
    s_waitcnt lgkmcnt(1)
    v_mfma_f32_16x16x32_bf16 v[188:191], a[232:235], a[136:139], v[188:191]
    ds_read_b128 a[232:235], v240 offset:30848
    v_mfma_f32_16x16x32_bf16 v[196:199], a[236:239], a[112:115], v[196:199]
    buffer_load_dwordx4 v172, s[8:11], s62 offen lds
    s_add_u32 m0, s29, 0x400
    v_mfma_f32_16x16x32_bf16 v[200:203], a[236:239], a[136:139], v[200:203]
    ds_read_b128 a[236:239], v241 offset:30848
    v_mfma_f32_16x16x32_bf16 v[208:211], a[240:243], a[112:115], v[208:211]
    ds_read_b64_tr_b16 a[94:95], v250 offset:3072
    v_mfma_f32_16x16x32_bf16 v[212:215], a[240:243], a[136:139], v[212:215]
    ds_read_b128 a[240:243], v240 offset:30976
    ds_read_b64_tr_b16 a[116:117], v249 offset:3104
    ds_read_b64_tr_b16 a[118:119], v250 offset:3104
    ds_read_b64_tr_b16 a[140:141], v249 offset:3136
    buffer_load_dwordx4 v173, s[8:11], s62 offen lds
    s_add_u32 m0, s29, 0x800
    ds_read_b64_tr_b16 a[142:143], v250 offset:3136
    s_waitcnt lgkmcnt(7)
    v_mfma_f32_16x16x32_bf16 v[216:219], a[232:235], a[80:83], v[216:219]
    v_mfma_f32_16x16x32_bf16 v[220:223], a[232:235], a[104:107], v[220:223]
    v_mfma_f32_16x16x32_bf16 v[224:227], a[232:235], a[128:131], v[224:227]
    s_waitcnt lgkmcnt(6)
    ds_read_b128 a[232:235], v240 offset:32512
    v_mfma_f32_16x16x32_bf16 v[216:219], a[236:239], a[84:87], v[216:219]
    buffer_load_dwordx4 v174, s[8:11], s62 offen lds
    s_add_u32 m0, s29, 0xc00
    v_mfma_f32_16x16x32_bf16 v[220:223], a[236:239], a[108:111], v[220:223]
    s_lshl_b32 s62, s28, 5
    s_add_u32 s62, s62, 0
    s_waitcnt vmcnt(6) lgkmcnt(3)
    v_mfma_f32_16x16x32_bf16 v[180:183], a[244:247], a[92:95], v[180:183]
    ds_read_b64_tr_b16 a[144:145], v249 offset:6144
    s_waitcnt lgkmcnt(2)
    v_mfma_f32_16x16x32_bf16 v[184:187], a[244:247], a[116:119], v[184:187]
    ds_read_b64_tr_b16 a[146:147], v250 offset:6144
    v_mfma_f32_16x16x32_bf16 v[188:191], a[244:247], a[140:143], v[188:191]
    ds_read_b128 a[244:247], v241 offset:30976
    v_mfma_f32_16x16x32_bf16 v[192:195], a[216:219], a[92:95], v[192:195]
    buffer_load_dwordx4 v172, s[8:11], s63 offen lds
    v_cvt_pk_bf16_f32 v0, v180, v181
    v_mfma_f32_16x16x32_bf16 v[196:199], a[216:219], a[116:119], v[196:199]
    ds_read_b64_tr_b16 a[168:169], v249 offset:6176
    v_cvt_pk_bf16_f32 v3, v182, v183
    v_mfma_f32_16x16x32_bf16 v[200:203], a[216:219], a[140:143], v[200:203]
    ds_read_b128 a[216:219], v240 offset:32256
    v_cvt_pk_bf16_f32 v30, v184, v185
    v_mfma_f32_16x16x32_bf16 v[204:207], a[220:223], a[92:95], v[204:207]
    ds_read_b64_tr_b16 a[170:171], v250 offset:6176
    v_cvt_pk_bf16_f32 v33, v186, v187
    v_mfma_f32_16x16x32_bf16 v[208:211], a[220:223], a[116:119], v[208:211]
    ds_read_b64_tr_b16 a[192:193], v249 offset:6208
    v_cvt_pk_bf16_f32 v60, v188, v189
    v_mfma_f32_16x16x32_bf16 v[212:215], a[220:223], a[140:143], v[212:215]
    ds_read_b128 a[220:223], v241 offset:32256
    v_cvt_pk_bf16_f32 v63, v190, v191
    v_mfma_f32_16x16x32_bf16 v[224:227], a[236:239], a[132:135], v[224:227]
    ds_read_b128 a[236:239], v241 offset:32512
    v_cvt_pk_bf16_f32 v6, v192, v193
    v_mfma_f32_16x16x32_bf16 v[216:219], a[240:243], a[88:91], v[216:219]
    ds_read_b64_tr_b16 a[194:195], v250 offset:6208
    v_cvt_pk_bf16_f32 v9, v194, v195
    v_mfma_f32_16x16x32_bf16 v[220:223], a[240:243], a[112:115], v[220:223]
    s_add_u32 m0, s29, 0x1000
    v_cvt_pk_bf16_f32 v36, v196, v197
    v_cvt_pk_bf16_f32 v39, v198, v199
    v_mfma_f32_16x16x32_bf16 v[224:227], a[240:243], a[136:139], v[224:227]
    s_waitcnt lgkmcnt(7)
    v_cvt_pk_bf16_f32 v66, v200, v201
    v_cvt_pk_bf16_f32 v69, v202, v203
    v_mfma_f32_16x16x32_bf16 v[216:219], a[244:247], a[92:95], v[216:219]
    ds_read_b128 a[240:243], v240 offset:33792
    v_cvt_pk_bf16_f32 v12, v204, v205
    v_mfma_f32_16x16x32_bf16 v[220:223], a[244:247], a[116:119], v[220:223]
    buffer_load_dwordx4 v173, s[8:11], s63 offen lds
    v_cvt_pk_bf16_f32 v15, v206, v207
    v_mfma_f32_16x16x32_bf16 v[224:227], a[244:247], a[140:143], v[224:227]
    s_waitcnt lgkmcnt(5)
    v_cvt_pk_bf16_f32 v42, v208, v209
    v_cvt_pk_bf16_f32 v45, v210, v211
    v_mfma_f32_16x16x32_bf16 v[180:183], a[216:219], a[72:75], 0
    ds_read_b128 a[244:247], v241 offset:33792
    v_cvt_pk_bf16_f32 v72, v212, v213
    v_mfma_f32_16x16x32_bf16 v[184:187], a[216:219], a[96:99], 0
    s_add_u32 m0, s29, 0x1400
    v_cvt_pk_bf16_f32 v75, v214, v215
    v_cvt_pk_bf16_f32 v1, v216, v217
    v_mfma_f32_16x16x32_bf16 v[188:191], a[216:219], a[120:123], 0
    s_waitcnt lgkmcnt(3)
    v_cvt_pk_bf16_f32 v4, v218, v219
    v_cvt_pk_bf16_f32 v31, v220, v221
    v_mfma_f32_16x16x32_bf16 v[180:183], a[220:223], a[76:79], v[180:183]
    ds_read_b128 a[216:219], v240 offset:33920
    v_cvt_pk_bf16_f32 v34, v222, v223
    v_mfma_f32_16x16x32_bf16 v[184:187], a[220:223], a[100:103], v[184:187]
    buffer_load_dwordx4 v174, s[8:11], s63 offen lds
    v_cvt_pk_bf16_f32 v61, v224, v225
    v_mfma_f32_16x16x32_bf16 v[188:191], a[220:223], a[124:127], v[188:191]
    ds_read_b128 a[220:223], v241 offset:33920
    v_cvt_pk_bf16_f32 v64, v226, v227
    v_mfma_f32_16x16x32_bf16 v[180:183], a[224:227], a[80:83], v[180:183]
    s_add_u32 m0, s29, 0x1800
    s_lshl_b32 s63, s28, 5
    s_add_u32 s63, s63, 0x4800
    v_mfma_f32_16x16x32_bf16 v[184:187], a[224:227], a[104:107], v[184:187]
    s_waitcnt vmcnt(6) lgkmcnt(3)
    ds_read_b64_tr_b16 a[148:149], v249 offset:9216
    v_mfma_f32_16x16x32_bf16 v[188:191], a[224:227], a[128:131], v[188:191]
    ds_read_b128 a[224:227], v240 offset:34048
    v_mfma_f32_16x16x32_bf16 v[180:183], a[228:231], a[84:87], v[180:183]
    buffer_load_dwordx4 v172, s[8:11], s60 offen lds
    s_add_u32 m0, s29, 0x1c00
    v_mfma_f32_16x16x32_bf16 v[184:187], a[228:231], a[108:111], v[184:187]
    ds_read_b64_tr_b16 a[150:151], v250 offset:9216
    v_mfma_f32_16x16x32_bf16 v[188:191], a[228:231], a[132:135], v[188:191]
    ds_read_b128 a[228:231], v241 offset:34048
    v_mfma_f32_16x16x32_bf16 v[180:183], a[232:235], a[88:91], v[180:183]
    ds_read_b64_tr_b16 a[172:173], v249 offset:9248
    v_mfma_f32_16x16x32_bf16 v[184:187], a[232:235], a[112:115], v[184:187]
    ds_read_b64_tr_b16 a[174:175], v250 offset:9248
    v_mfma_f32_16x16x32_bf16 v[188:191], a[232:235], a[136:139], v[188:191]
    ds_read_b128 a[232:235], v240 offset:61440
    v_mfma_f32_16x16x32_bf16 v[180:183], a[236:239], a[92:95], v[180:183]
    buffer_load_dwordx4 v173, s[8:11], s60 offen lds
    s_add_u32 m0, s29, 0x2000
    v_mfma_f32_16x16x32_bf16 v[184:187], a[236:239], a[116:119], v[184:187]
    ds_read_b64_tr_b16 a[196:197], v249 offset:9280
    v_mfma_f32_16x16x32_bf16 v[188:191], a[236:239], a[140:143], v[188:191]
    ds_read_b128 a[236:239], v241 offset:61440
    v_mfma_f32_16x16x32_bf16 v[192:195], a[240:243], a[72:75], 0
    ds_read_b64_tr_b16 a[198:199], v250 offset:9280
    v_cvt_pk_bf16_f32 v7, v180, v181
    v_mfma_f32_16x16x32_bf16 v[196:199], a[240:243], a[96:99], 0
    s_waitcnt lgkmcnt(7)
    v_cvt_pk_bf16_f32 v10, v182, v183
    v_cvt_pk_bf16_f32 v37, v184, v185
    v_mfma_f32_16x16x32_bf16 v[200:203], a[240:243], a[120:123], 0
    ds_read_b128 a[240:243], v240 offset:61568
    v_cvt_pk_bf16_f32 v40, v186, v187
    v_mfma_f32_16x16x32_bf16 v[192:195], a[244:247], a[76:79], v[192:195]
    buffer_load_dwordx4 v174, s[8:11], s60 offen lds
    v_cvt_pk_bf16_f32 v67, v188, v189
    v_mfma_f32_16x16x32_bf16 v[196:199], a[244:247], a[100:103], v[196:199]
    s_add_u32 m0, s29, 0x2400
    v_cvt_pk_bf16_f32 v70, v190, v191
    s_lshl_b32 s60, s28, 5
    v_mfma_f32_16x16x32_bf16 v[200:203], a[244:247], a[124:127], v[200:203]
    ds_read_b128 a[244:247], v241 offset:61568
    s_add_u32 s60, s60, 0x1800
    v_mfma_f32_16x16x32_bf16 v[192:195], a[216:219], a[80:83], v[192:195]
    s_waitcnt lgkmcnt(5)
    v_mfma_f32_16x16x32_bf16 v[196:199], a[216:219], a[104:107], v[196:199]
    v_mfma_f32_16x16x32_bf16 v[200:203], a[216:219], a[128:131], v[200:203]
    ds_read_b128 a[216:219], v240 offset:61696
    s_waitcnt lgkmcnt(3)
    v_mfma_f32_16x16x32_bf16 v[192:195], a[220:223], a[84:87], v[192:195]
    buffer_load_dwordx4 v172, s[8:11], s61 offen lds
    s_add_u32 m0, s29, 0x2800
    v_mfma_f32_16x16x32_bf16 v[196:199], a[220:223], a[108:111], v[196:199]
    v_mfma_f32_16x16x32_bf16 v[200:203], a[220:223], a[132:135], v[200:203]
    ds_read_b128 a[220:223], v241 offset:61696
    v_mfma_f32_16x16x32_bf16 v[192:195], a[224:227], a[88:91], v[192:195]
    v_mfma_f32_16x16x32_bf16 v[196:199], a[224:227], a[112:115], v[196:199]
    v_mfma_f32_16x16x32_bf16 v[200:203], a[224:227], a[136:139], v[200:203]
    ds_read_b128 a[224:227], v240 offset:62976
    s_waitcnt vmcnt(7)
    v_mfma_f32_16x16x32_bf16 v[192:195], a[228:231], a[92:95], v[192:195]
    buffer_load_dwordx4 v173, s[8:11], s61 offen lds
    s_add_u32 m0, s29, 0x2c00
    v_mfma_f32_16x16x32_bf16 v[196:199], a[228:231], a[116:119], v[196:199]
    ds_read_b64_tr_b16 a[152:153], v249 offset:0
    v_mfma_f32_16x16x32_bf16 v[200:203], a[228:231], a[140:143], v[200:203]
    ds_read_b128 a[228:231], v241 offset:62976
    v_mfma_f32_16x16x32_bf16 v[204:207], a[0:3], a[232:235], 0
    ds_read_b64_tr_b16 a[154:155], v250 offset:0
    v_cvt_pk_bf16_f32 v13, v192, v193
    v_mfma_f32_16x16x32_bf16 v[208:211], a[24:27], a[232:235], 0
    ds_read_b64_tr_b16 a[176:177], v249 offset:32
    v_cvt_pk_bf16_f32 v16, v194, v195
    v_mfma_f32_16x16x32_bf16 v[212:215], a[48:51], a[232:235], 0
    ds_read_b128 a[232:235], v240 offset:63104
    v_cvt_pk_bf16_f32 v43, v196, v197
    v_mfma_f32_16x16x32_bf16 v[204:207], a[4:7], a[236:239], v[204:207]
    buffer_load_dwordx4 v174, s[8:11], s61 offen lds
    v_cvt_pk_bf16_f32 v46, v198, v199
    v_mfma_f32_16x16x32_bf16 v[208:211], a[28:31], a[236:239], v[208:211]
    ds_read_b64_tr_b16 a[178:179], v250 offset:32
    v_cvt_pk_bf16_f32 v73, v200, v201
    v_mfma_f32_16x16x32_bf16 v[212:215], a[52:55], a[236:239], v[212:215]
    s_waitcnt lgkmcnt(6)
    v_cvt_pk_bf16_f32 v76, v202, v203
    s_add_u32 m0, s29, 0
    v_mfma_f32_16x16x32_bf16 v[204:207], a[8:11], a[240:243], v[204:207]
    ds_read_b128 a[236:239], v241 offset:63104
    s_lshl_b32 s61, s28, 5
    v_mfma_f32_16x16x32_bf16 v[208:211], a[32:35], a[240:243], v[208:211]
    ds_read_b64_tr_b16 a[200:201], v249 offset:64
    s_add_u32 s61, s61, 0x6000
    v_mfma_f32_16x16x32_bf16 v[212:215], a[56:59], a[240:243], v[212:215]
    ds_read_b128 a[240:243], v240 offset:63232
    v_mfma_f32_16x16x32_bf16 v[204:207], a[12:15], a[244:247], v[204:207]
    ds_read_b64_tr_b16 a[202:203], v250 offset:64
    v_mfma_f32_16x16x32_bf16 v[208:211], a[36:39], a[244:247], v[208:211]
    v_mfma_f32_16x16x32_bf16 v[212:215], a[60:63], a[244:247], v[212:215]
    ds_read_b128 a[244:247], v241 offset:63232
    v_mfma_f32_16x16x32_bf16 v[204:207], a[16:19], a[216:219], v[204:207]
    v_mfma_f32_16x16x32_bf16 v[208:211], a[40:43], a[216:219], v[208:211]
    v_mfma_f32_16x16x32_bf16 v[212:215], a[64:67], a[216:219], v[212:215]
    ds_read_b128 a[216:219], v240 offset:64512
    v_mfma_f32_16x16x32_bf16 v[204:207], a[20:23], a[220:223], v[204:207]
    v_mfma_f32_16x16x32_bf16 v[208:211], a[44:47], a[220:223], v[208:211]
    v_mfma_f32_16x16x32_bf16 v[212:215], a[68:71], a[220:223], v[212:215]
    ds_read_b128 a[220:223], v241 offset:64512
    s_waitcnt lgkmcnt(3)
    v_mfma_f32_16x16x32_bf16 v[216:219], a[0:3], a[224:227], 0
    buffer_load_dwordx4 v28, s[12:15], s62 offen lds
    s_add_u32 m0, s29, 0x400
    v_mfma_f32_16x16x32_bf16 v[220:223], a[24:27], a[224:227], 0
    s_waitcnt vmcnt(7)
    v_cvt_pk_bf16_f32 v138, v204, v205
    v_cvt_pk_bf16_f32 v139, v206, v207
    v_mfma_f32_16x16x32_bf16 v[224:227], a[48:51], a[224:227], 0
    ds_read_b128 a[224:227], v240 offset:64640
    v_cvt_pk_bf16_f32 v140, v208, v209
    v_mfma_f32_16x16x32_bf16 v[216:219], a[4:7], a[228:231], v[216:219]
    ds_read_b64_tr_b16 a[156:157], v249 offset:3072
    v_cvt_pk_bf16_f32 v141, v210, v211
    v_mfma_f32_16x16x32_bf16 v[220:223], a[28:31], a[228:231], v[220:223]
    ds_read_b64_tr_b16 a[158:159], v250 offset:3072
    v_cvt_pk_bf16_f32 v142, v212, v213
    v_mfma_f32_16x16x32_bf16 v[224:227], a[52:55], a[228:231], v[224:227]
    ds_read_b128 a[228:231], v241 offset:64640
    v_cvt_pk_bf16_f32 v143, v214, v215
    v_mfma_f32_16x16x32_bf16 v[216:219], a[8:11], a[232:235], v[216:219]
    buffer_load_dwordx4 v29, s[12:15], s62 offen lds
    s_add_u32 m0, s29, 0x800
    v_mfma_f32_16x16x32_bf16 v[220:223], a[32:35], a[232:235], v[220:223]
    ds_read_b64_tr_b16 a[180:181], v249 offset:3104
    s_waitcnt lgkmcnt(5)
    v_mfma_f32_16x16x32_bf16 v[224:227], a[56:59], a[232:235], v[224:227]
    ds_read_b128 a[232:235], v240 offset:64768
    v_add_u32 v240, 0xf000, v240
    v_mfma_f32_16x16x32_bf16 v[216:219], a[12:15], a[236:239], v[216:219]
    ds_read_b64_tr_b16 a[182:183], v250 offset:3104
    v_mfma_f32_16x16x32_bf16 v[220:223], a[36:39], a[236:239], v[220:223]
    ds_read_b64_tr_b16 a[204:205], v249 offset:3136
    v_mfma_f32_16x16x32_bf16 v[224:227], a[60:63], a[236:239], v[224:227]
    ds_read_b128 a[236:239], v241 offset:64768
    v_add_u32 v241, 0xf000, v241
    v_mfma_f32_16x16x32_bf16 v[216:219], a[16:19], a[240:243], v[216:219]
    buffer_load_dwordx4 v58, s[12:15], s62 offen lds
    s_add_u32 m0, s29, 0xc00
    v_mfma_f32_16x16x32_bf16 v[220:223], a[40:43], a[240:243], v[220:223]
    ds_read_b64_tr_b16 a[206:207], v250 offset:3136
    s_lshl_b32 s62, s28, 5
    v_mfma_f32_16x16x32_bf16 v[224:227], a[64:67], a[240:243], v[224:227]
    ds_read_b128 a[240:243], v240 offset:4608
    s_add_u32 s62, s62, 0x3000
    v_mfma_f32_16x16x32_bf16 v[216:219], a[20:23], a[244:247], v[216:219]
    v_mfma_f32_16x16x32_bf16 v[220:223], a[44:47], a[244:247], v[220:223]
    v_mfma_f32_16x16x32_bf16 v[224:227], a[68:71], a[244:247], v[224:227]
    ds_read_b128 a[244:247], v241 offset:4608
    s_waitcnt vmcnt(6)
    v_mfma_f32_16x16x32_bf16 v[180:183], a[0:3], a[216:219], 0
    ds_read_b64_tr_b16 a[160:161], v249 offset:6144
    v_mfma_f32_16x16x32_bf16 v[184:187], a[24:27], a[216:219], 0
    ds_read_b64_tr_b16 a[162:163], v250 offset:6144
    v_cvt_pk_bf16_f32 v144, v216, v217
    v_mfma_f32_16x16x32_bf16 v[188:191], a[48:51], a[216:219], 0
    ds_read_b128 a[216:219], v240 offset:4736
    v_cvt_pk_bf16_f32 v145, v218, v219
    v_mfma_f32_16x16x32_bf16 v[180:183], a[4:7], a[220:223], v[180:183]
    ds_read_b64_tr_b16 a[184:185], v249 offset:6176
    v_cvt_pk_bf16_f32 v146, v220, v221
    v_mfma_f32_16x16x32_bf16 v[184:187], a[28:31], a[220:223], v[184:187]
    ds_read_b64_tr_b16 a[186:187], v250 offset:6176
    v_cvt_pk_bf16_f32 v147, v222, v223
    v_mfma_f32_16x16x32_bf16 v[188:191], a[52:55], a[220:223], v[188:191]
    s_waitcnt lgkmcnt(6)
    v_cvt_pk_bf16_f32 v148, v224, v225
    v_cvt_pk_bf16_f32 v149, v226, v227
    v_mfma_f32_16x16x32_bf16 v[180:183], a[8:11], a[224:227], v[180:183]
    ds_read_b128 a[220:223], v241 offset:4736
    v_mfma_f32_16x16x32_bf16 v[184:187], a[32:35], a[224:227], v[184:187]
    buffer_load_dwordx4 v28, s[12:15], s63 offen lds
    s_add_u32 m0, s29, 0x1000
    v_mfma_f32_16x16x32_bf16 v[188:191], a[56:59], a[224:227], v[188:191]
    ds_read_b128 a[224:227], v240 offset:4864
    v_mfma_f32_16x16x32_bf16 v[180:183], a[12:15], a[228:231], v[180:183]
    ds_read_b64_tr_b16 a[208:209], v249 offset:6208
    v_mfma_f32_16x16x32_bf16 v[184:187], a[36:39], a[228:231], v[184:187]
    ds_read_b64_tr_b16 a[210:211], v250 offset:6208
    v_mfma_f32_16x16x32_bf16 v[188:191], a[60:63], a[228:231], v[188:191]
    ds_read_b128 a[228:231], v241 offset:4864
    v_mfma_f32_16x16x32_bf16 v[180:183], a[16:19], a[232:235], v[180:183]
    buffer_load_dwordx4 v29, s[12:15], s63 offen lds
    s_add_u32 m0, s29, 0x1400
    v_mfma_f32_16x16x32_bf16 v[184:187], a[40:43], a[232:235], v[184:187]
    v_mfma_f32_16x16x32_bf16 v[188:191], a[64:67], a[232:235], v[188:191]
    ds_read_b128 a[232:235], v240 offset:0
    v_mfma_f32_16x16x32_bf16 v[180:183], a[20:23], a[236:239], v[180:183]
    v_mfma_f32_16x16x32_bf16 v[184:187], a[44:47], a[236:239], v[184:187]
    v_mfma_f32_16x16x32_bf16 v[188:191], a[68:71], a[236:239], v[188:191]
    ds_read_b128 a[236:239], v241 offset:0
    s_waitcnt vmcnt(5)
    v_mfma_f32_16x16x32_bf16 v[192:195], a[0:3], a[240:243], 0
    buffer_load_dwordx4 v58, s[12:15], s63 offen lds
    s_add_u32 m0, s29, 0x1800
    v_mfma_f32_16x16x32_bf16 v[196:199], a[24:27], a[240:243], 0
    ds_read_b64_tr_b16 a[164:165], v249 offset:9216
    v_cvt_pk_bf16_f32 v150, v180, v181
    v_mfma_f32_16x16x32_bf16 v[200:203], a[48:51], a[240:243], 0
    s_waitcnt lgkmcnt(3)
    v_cvt_pk_bf16_f32 v151, v182, v183
    v_cvt_pk_bf16_f32 v152, v184, v185
    v_mfma_f32_16x16x32_bf16 v[192:195], a[4:7], a[244:247], v[192:195]
    ds_read_b128 a[240:243], v240 offset:128
    v_cvt_pk_bf16_f32 v153, v186, v187
    v_mfma_f32_16x16x32_bf16 v[196:199], a[28:31], a[244:247], v[196:199]
    ds_read_b64_tr_b16 a[166:167], v250 offset:9216
    v_cvt_pk_bf16_f32 v154, v188, v189
    v_mfma_f32_16x16x32_bf16 v[200:203], a[52:55], a[244:247], v[200:203]
    ds_read_b128 a[244:247], v241 offset:128
    v_cvt_pk_bf16_f32 v155, v190, v191
    v_mfma_f32_16x16x32_bf16 v[192:195], a[8:11], a[216:219], v[192:195]
    buffer_load_dwordx4 v28, s[12:15], s60 offen lds
    s_add_u32 m0, s29, 0x1c00
    v_mfma_f32_16x16x32_bf16 v[196:199], a[32:35], a[216:219], v[196:199]
    ds_read_b64_tr_b16 a[188:189], v249 offset:9248
    s_lshl_b32 s63, s28, 5
    v_mfma_f32_16x16x32_bf16 v[200:203], a[56:59], a[216:219], v[200:203]
    ds_read_b128 a[216:219], v240 offset:256
    s_add_u32 s63, s63, 0x7800
    v_mfma_f32_16x16x32_bf16 v[192:195], a[12:15], a[220:223], v[192:195]
    ds_read_b64_tr_b16 a[190:191], v250 offset:9248
    s_waitcnt lgkmcnt(6)
    v_mfma_f32_16x16x32_bf16 v[196:199], a[36:39], a[220:223], v[196:199]
    ds_read_b64_tr_b16 a[212:213], v249 offset:9280
    v_mfma_f32_16x16x32_bf16 v[200:203], a[60:63], a[220:223], v[200:203]
    ds_read_b128 a[220:223], v241 offset:256
    v_mfma_f32_16x16x32_bf16 v[192:195], a[16:19], a[224:227], v[192:195]
    buffer_load_dwordx4 v29, s[12:15], s60 offen lds
    s_add_u32 m0, s29, 0x2000
    v_mfma_f32_16x16x32_bf16 v[196:199], a[40:43], a[224:227], v[196:199]
    ds_read_b64_tr_b16 a[214:215], v250 offset:9280
    v_mfma_f32_16x16x32_bf16 v[200:203], a[64:67], a[224:227], v[200:203]
    ds_read_b128 a[224:227], v240 offset:1536
    v_mfma_f32_16x16x32_bf16 v[192:195], a[20:23], a[228:231], v[192:195]
    v_mfma_f32_16x16x32_bf16 v[196:199], a[44:47], a[228:231], v[196:199]
    v_mfma_f32_16x16x32_bf16 v[200:203], a[68:71], a[228:231], v[200:203]
    ds_read_b128 a[228:231], v241 offset:1536
    v_mfma_f32_16x16x32_bf16 v[204:207], a[232:235], a[72:75], 0
    buffer_load_dwordx4 v58, s[12:15], s60 offen lds
    s_add_u32 m0, s29, 0x2400
    v_mfma_f32_16x16x32_bf16 v[208:211], a[232:235], a[96:99], 0
    v_mfma_f32_16x16x32_bf16 v[212:215], a[232:235], a[120:123], 0
    ds_read_b128 a[232:235], v240 offset:1664
    v_cvt_pk_bf16_f32 v156, v192, v193
    v_mfma_f32_16x16x32_bf16 v[204:207], a[236:239], a[76:79], v[204:207]
    s_waitcnt lgkmcnt(4)
    v_cvt_pk_bf16_f32 v157, v194, v195
    v_cvt_pk_bf16_f32 v158, v196, v197
    v_mfma_f32_16x16x32_bf16 v[208:211], a[236:239], a[100:103], v[208:211]
    s_waitcnt lgkmcnt(3)
    v_cvt_pk_bf16_f32 v159, v198, v199
    v_cvt_pk_bf16_f32 v160, v200, v201
    v_mfma_f32_16x16x32_bf16 v[212:215], a[236:239], a[124:127], v[212:215]
    ds_read_b128 a[236:239], v241 offset:1664
    v_cvt_pk_bf16_f32 v161, v202, v203
    v_mfma_f32_16x16x32_bf16 v[204:207], a[240:243], a[80:83], v[204:207]
    buffer_load_dwordx4 v28, s[12:15], s61 offen lds
    v_mov_b32 v195, 0
    v_mfma_f32_16x16x32_bf16 v[208:211], a[240:243], a[104:107], v[208:211]
    ds_read_b128 v[196:199], v244 offset:192
    s_add_u32 m0, s29, 0x2800
    v_mfma_f32_16x16x32_bf16 v[212:215], a[240:243], a[128:131], v[212:215]
    ds_read_b128 a[240:243], v240 offset:1792
    s_waitcnt vmcnt(7) lgkmcnt(4)
    v_mfma_f32_16x16x32_bf16 v[204:207], a[244:247], a[84:87], v[204:207]
    ds_read_b128 v[200:203], v245 offset:192
    v_mfma_f32_16x16x32_bf16 v[208:211], a[244:247], a[108:111], v[208:211]
    ds_read_b64_tr_b16 v[24:25], v249 offset:0
    v_mfma_f32_16x16x32_bf16 v[212:215], a[244:247], a[132:135], v[212:215]
    ds_read_b128 a[244:247], v241 offset:1792
    v_mfma_f32_16x16x32_bf16 v[204:207], a[216:219], a[88:91], v[204:207]
    buffer_load_dwordx4 v29, s[12:15], s61 offen lds
    s_add_u32 m0, s29, 0x2c00
    v_mfma_f32_16x16x32_bf16 v[208:211], a[216:219], a[112:115], v[208:211]
    ds_read_b64_tr_b16 v[26:27], v250 offset:0
    v_mfma_f32_16x16x32_bf16 v[212:215], a[216:219], a[136:139], v[212:215]
    ds_read_b128 a[216:219], v240 offset:3072
    v_mfma_f32_16x16x32_bf16 v[204:207], a[220:223], a[92:95], v[204:207]
    ds_read_b64_tr_b16 v[54:55], v249 offset:32
    v_mfma_f32_16x16x32_bf16 v[208:211], a[220:223], a[116:119], v[208:211]
    ds_read_b64_tr_b16 v[56:57], v250 offset:32
    v_mfma_f32_16x16x32_bf16 v[212:215], a[220:223], a[140:143], v[212:215]
    ds_read_b128 a[220:223], v241 offset:3072
    v_mfma_f32_16x16x32_bf16 v[216:219], a[224:227], a[72:75], 0
    buffer_load_dwordx4 v58, s[12:15], s61 offen lds
    s_add_u32 m0, s29, 0
    v_mfma_f32_16x16x32_bf16 v[220:223], a[224:227], a[96:99], 0
    ds_read_b64_tr_b16 v[84:85], v249 offset:64
    v_cvt_pk_bf16_f32 v2, v204, v205
    v_mfma_f32_16x16x32_bf16 v[224:227], a[224:227], a[120:123], 0
    ds_read_b128 a[224:227], v240 offset:3200
    v_cvt_pk_bf16_f32 v5, v206, v207
    v_mfma_f32_16x16x32_bf16 v[216:219], a[228:231], a[76:79], v[216:219]
    ds_read_b128 v[204:207], v246 offset:192
    v_cvt_pk_bf16_f32 v32, v208, v209
    v_mfma_f32_16x16x32_bf16 v[220:223], a[228:231], a[100:103], v[220:223]
    ds_read_b64_tr_b16 v[86:87], v250 offset:64
    v_cvt_pk_bf16_f32 v35, v210, v211
    v_mfma_f32_16x16x32_bf16 v[224:227], a[228:231], a[124:127], v[224:227]
    s_waitcnt lgkmcnt(7)
    v_cvt_pk_bf16_f32 v62, v212, v213
    v_cvt_pk_bf16_f32 v65, v214, v215
    v_mfma_f32_16x16x32_bf16 v[216:219], a[232:235], a[80:83], v[216:219]
    ds_read_b128 a[228:231], v241 offset:3200
    s_waitcnt lgkmcnt(6)
    v_mfma_f32_16x16x32_bf16 v[220:223], a[232:235], a[104:107], v[220:223]
    ds_read_b128 v[208:211], v244 offset:256
    v_mfma_f32_16x16x32_bf16 v[224:227], a[232:235], a[128:131], v[224:227]
    ds_read_b128 a[232:235], v240 offset:3328
    v_add_u32 v240, 0xffff1000, v240
    v_mfma_f32_16x16x32_bf16 v[216:219], a[236:239], a[84:87], v[216:219]
    buffer_store_dwordx4 v[24:27], v89, s[24:27], s56 offen
    v_mfma_f32_16x16x32_bf16 v[220:223], a[236:239], a[108:111], v[220:223]
    s_mov_b32 s56, 0x2400
    v_mfma_f32_16x16x32_bf16 v[224:227], a[236:239], a[132:135], v[224:227]
    ds_read_b128 a[236:239], v241 offset:3328
    v_add_u32 v241, 0xffff1000, v241
    v_mfma_f32_16x16x32_bf16 v[216:219], a[240:243], a[88:91], v[216:219]
    s_waitcnt lgkmcnt(4)
    v_mfma_f32_16x16x32_bf16 v[220:223], a[240:243], a[112:115], v[220:223]
    buffer_load_dwordx4 v28, s[12:15], s62 offen lds
    s_add_u32 m0, s29, 0x400
    v_mfma_f32_16x16x32_bf16 v[224:227], a[240:243], a[136:139], v[224:227]
    ds_read_b128 a[240:243], v242 offset:0
    s_waitcnt vmcnt(8)
    v_mfma_f32_16x16x32_bf16 v[216:219], a[244:247], a[92:95], v[216:219]
    ds_read_b64_tr_b16 v[24:25], v249 offset:3072
    v_mfma_f32_16x16x32_bf16 v[220:223], a[244:247], a[116:119], v[220:223]
    ds_read_b64_tr_b16 v[26:27], v250 offset:3072
    v_mfma_f32_16x16x32_bf16 v[224:227], a[244:247], a[140:143], v[224:227]
    ds_read_b128 a[244:247], v243 offset:0
    v_mfma_f32_16x16x32_bf16 v[180:183], a[216:219], a[72:75], 0
    buffer_load_dwordx4 v29, s[12:15], s62 offen lds
    s_add_u32 m0, s29, 0x800
    v_mfma_f32_16x16x32_bf16 v[184:187], a[216:219], a[96:99], 0
    v_cvt_pk_bf16_f32 v8, v216, v217
    v_cvt_pk_bf16_f32 v11, v218, v219
    v_mfma_f32_16x16x32_bf16 v[188:191], a[216:219], a[120:123], 0
    ds_read_b128 a[216:219], v242 offset:128
    v_cvt_pk_bf16_f32 v38, v220, v221
    v_mfma_f32_16x16x32_bf16 v[180:183], a[220:223], a[76:79], v[180:183]
    v_cvt_pk_bf16_f32 v41, v222, v223
    v_cvt_pk_bf16_f32 v68, v224, v225
    v_mfma_f32_16x16x32_bf16 v[184:187], a[220:223], a[100:103], v[184:187]
    v_cvt_pk_bf16_f32 v71, v226, v227
    s_waitcnt lgkmcnt(4)
    v_mfma_f32_16x16x32_bf16 v[188:191], a[220:223], a[124:127], v[188:191]
    ds_read_b128 a[220:223], v243 offset:128
    v_mfma_f32_16x16x32_bf16 v[180:183], a[224:227], a[80:83], v[180:183]
    buffer_load_dwordx4 v58, s[12:15], s62 offen lds
    s_add_u32 m0, s29, 0xc00
    v_mfma_f32_16x16x32_bf16 v[184:187], a[224:227], a[104:107], v[184:187]
    s_waitcnt lgkmcnt(3)
    v_mfma_f32_16x16x32_bf16 v[188:191], a[224:227], a[128:131], v[188:191]
    ds_read_b128 a[224:227], v242 offset:256
    v_mfma_f32_16x16x32_bf16 v[180:183], a[228:231], a[84:87], v[180:183]
    v_mfma_f32_16x16x32_bf16 v[184:187], a[228:231], a[108:111], v[184:187]
    v_mfma_f32_16x16x32_bf16 v[188:191], a[228:231], a[132:135], v[188:191]
    ds_read_b128 a[228:231], v243 offset:256
    v_mfma_f32_16x16x32_bf16 v[180:183], a[232:235], a[88:91], v[180:183]
    buffer_store_dwordx4 v[54:57], v89, s[24:27], s57 offen
    v_mfma_f32_16x16x32_bf16 v[184:187], a[232:235], a[112:115], v[184:187]
    s_mov_b32 s57, 0x3c00
    ds_read_b64_tr_b16 v[54:55], v249 offset:3104
    v_mfma_f32_16x16x32_bf16 v[188:191], a[232:235], a[136:139], v[188:191]
    ds_read_b128 a[232:235], v240 offset:4608
    v_mfma_f32_16x16x32_bf16 v[180:183], a[236:239], a[92:95], v[180:183]
    ds_read_b64_tr_b16 v[56:57], v250 offset:3104
    v_mfma_f32_16x16x32_bf16 v[184:187], a[236:239], a[116:119], v[184:187]
    buffer_store_dwordx4 v[84:87], v89, s[24:27], s58 offen
    v_mfma_f32_16x16x32_bf16 v[188:191], a[236:239], a[140:143], v[188:191]
    ds_read_b128 a[236:239], v241 offset:4608
    s_mov_b32 s58, 0x1000
    v_mfma_f32_16x16x32_bf16 v[228:231], a[144:147], a[240:243], 0
    ds_read_b64_tr_b16 v[84:85], v249 offset:3136
    v_cvt_pk_bf16_f32 v14, v180, v181
    v_mfma_f32_16x16x32_bf16 v[232:235], a[168:171], a[240:243], 0
    ds_read_b64_tr_b16 v[86:87], v250 offset:3136
    v_cvt_pk_bf16_f32 v17, v182, v183
    v_mfma_f32_16x16x32_bf16 v[236:239], a[192:195], a[240:243], 0
    s_waitcnt lgkmcnt(6)
    v_cvt_pk_bf16_f32 v44, v184, v185
    v_cvt_pk_bf16_f32 v47, v186, v187
    v_mfma_f32_16x16x32_bf16 v[228:231], a[148:151], a[244:247], v[228:231]
    ds_read_b128 a[240:243], v240 offset:4736
    v_cvt_pk_bf16_f32 v74, v188, v189
    v_mfma_f32_16x16x32_bf16 v[228:231], a[152:155], a[216:219], v[228:231]
    buffer_store_dwordx4 v[24:27], v89, s[24:27], s59 offen
    v_mfma_f32_16x16x32_bf16 v[228:231], a[156:159], a[220:223], v[228:231]
    s_mov_b32 s59, 0x2800
    v_cvt_pk_bf16_f32 v77, v190, v191
    s_waitcnt vmcnt(10) lgkmcnt(4)
    v_mfma_f32_16x16x32_bf16 v[228:231], a[160:163], a[224:227], v[228:231]
    ds_read_b64_tr_b16 v[24:25], v249 offset:6144
    v_mfma_f32_16x16x32_bf16 v[228:231], a[164:167], a[228:231], v[228:231]
    ds_read_b64_tr_b16 v[26:27], v250 offset:6144
    v_mfma_f32_16x16x32_bf16 v[232:235], a[172:175], a[244:247], v[232:235]
    buffer_store_dwordx4 v[54:57], v89, s[24:27], s50 offen
    v_mfma_f32_16x16x32_bf16 v[232:235], a[176:179], a[216:219], v[232:235]
    s_mov_b32 s50, 0x4000
    ds_read_b64_tr_b16 v[54:55], v249 offset:6176
    v_mfma_f32_16x16x32_bf16 v[232:235], a[180:183], a[220:223], v[232:235]
    ds_read_b64_tr_b16 v[56:57], v250 offset:6176
    v_mul_f32 v228, s38, v228
    v_mfma_f32_16x16x32_bf16 v[232:235], a[184:187], a[224:227], v[232:235]
    s_waitcnt lgkmcnt(4)
    v_mul_f32 v229, s38, v229
    v_mul_f32 v230, s38, v230
    v_mfma_f32_16x16x32_bf16 v[232:235], a[188:191], a[228:231], v[232:235]
    buffer_load_dwordx4 v28, s[12:15], s63 offen lds
    v_mul_f32 v231, s38, v231
    v_mfma_f32_16x16x32_bf16 v[236:239], a[196:199], a[244:247], v[236:239]
    ds_read_b128 a[244:247], v241 offset:4736
    v_cvt_pk_bf16_f32 v168, v228, v229
    v_mfma_f32_16x16x32_bf16 v[236:239], a[200:203], a[216:219], v[236:239]
    ds_read_b128 a[216:219], v240 offset:4864
    v_cvt_pk_bf16_f32 v169, v230, v231
    v_mfma_f32_16x16x32_bf16 v[236:239], a[204:207], a[220:223], v[236:239]
    ds_read_b128 a[220:223], v241 offset:4864
    v_mul_f32 v232, s3, v232
    v_mfma_f32_16x16x32_bf16 v[236:239], a[208:211], a[224:227], v[236:239]
    ds_read_b128 a[224:227], v240 offset:35328
    v_mul_f32 v233, s3, v233
    v_mfma_f32_16x16x32_bf16 v[236:239], a[212:215], a[228:231], v[236:239]
    ds_read_b128 a[228:231], v241 offset:35328
    v_mul_f32 v234, s3, v234
    v_mfma_f32_16x16x32_bf16 v[228:231], a[232:235], a[72:75], 0
    buffer_store_dwordx4 v[84:87], v89, s[24:27], s51 offen
    v_mfma_f32_16x16x32_bf16 v[228:231], a[236:239], a[76:79], v[228:231]
    s_add_u32 m0, s29, 0x1000
    v_mul_f32 v235, s3, v235
    v_cvt_pk_bf16_f32 v170, v232, v233
    v_mfma_f32_16x16x32_bf16 v[228:231], a[240:243], a[80:83], v[228:231]
    s_waitcnt lgkmcnt(5)
    v_cvt_pk_bf16_f32 v171, v234, v235
    v_mul_f32 v236, s38, v236
    v_mfma_f32_16x16x32_bf16 v[232:235], a[232:235], a[96:99], 0
    ds_read_b64_tr_b16 v[84:85], v249 offset:6208
    v_mul_f32 v237, s38, v237
    v_mfma_f32_16x16x32_bf16 v[196:199], v[90:93], v[168:171], v[196:199]
    buffer_load_dwordx4 v29, s[12:15], s63 offen lds
    v_mul_f32 v238, s38, v238
    v_mfma_f32_16x16x32_bf16 v[200:203], v[114:117], v[168:171], v[200:203]
    ds_read_b64_tr_b16 v[86:87], v250 offset:6208
    v_mul_f32 v239, s38, v239
    v_mfma_f32_16x16x32_bf16 v[204:207], v[138:141], v[168:171], v[204:207]
    s_add_u32 m0, s29, 0x1400
    v_cvt_pk_bf16_f32 v172, v236, v237
    v_cvt_pk_bf16_f32 v173, v238, v239
    v_mfma_f32_16x16x32_bf16 v[208:211], v[96:99], v[168:171], v[208:211]
    s_mov_b32 s51, 0x1400
    s_waitcnt lgkmcnt(2)
    v_mfma_f32_16x16x32_bf16 v[196:199], v[92:95], v[170:173], v[196:199]
    v_mfma_f32_16x16x32_bf16 v[200:203], v[116:119], v[170:173], v[200:203]
    buffer_load_dwordx4 v58, s[12:15], s63 offen lds
    s_add_u32 m0, s46, 0x16800
    v_mfma_f32_16x16x32_bf16 v[204:207], v[140:143], v[170:173], v[204:207]
    v_mfma_f32_16x16x32_bf16 v[208:211], v[98:101], v[170:173], v[208:211]
    v_mfma_f32_16x16x32_bf16 v[228:231], a[244:247], a[84:87], v[228:231]
    v_mfma_f32_16x16x32_bf16 v[228:231], a[216:219], a[88:91], v[228:231]
    v_mfma_f32_16x16x32_bf16 v[228:231], a[220:223], a[92:95], v[228:231]
    buffer_store_dwordx4 v[24:27], v89, s[24:27], s52 offen
    v_mfma_f32_16x16x32_bf16 v[232:235], a[236:239], a[100:103], v[232:235]
    s_mov_b32 s52, 0x2c00
    v_exp_f32 v196, v196
    v_mfma_f32_16x16x32_bf16 v[232:235], a[240:243], a[104:107], v[232:235]
    s_waitcnt vmcnt(13) lgkmcnt(0)
    v_exp_f32 v197, v197
    v_mfma_f32_16x16x32_bf16 v[232:235], a[244:247], a[108:111], v[232:235]
    ds_read_b64_tr_b16 v[24:25], v249 offset:9216
    v_cvt_pk_bf16_f32 v18, v228, v229
    v_mfma_f32_16x16x32_bf16 v[232:235], a[216:219], a[112:115], v[232:235]
    buffer_store_dwordx4 v[54:57], v89, s[24:27], s53 offen
    v_mfma_f32_16x16x32_bf16 v[232:235], a[220:223], a[116:119], v[232:235]
    ds_read_b64_tr_b16 v[26:27], v250 offset:9216
    v_cvt_pk_bf16_f32 v21, v230, v231
    v_mfma_f32_16x16x32_bf16 v[236:239], a[232:235], a[120:123], 0
    ds_read_b128 a[232:235], v240 offset:35456
    v_cvt_pk_bf16_f32 v180, v196, v197
    v_mfma_f32_16x16x32_bf16 v[236:239], a[236:239], a[124:127], v[236:239]
    ds_read_b128 a[236:239], v241 offset:35456
    s_mov_b32 s53, 0x4400
    v_mfma_f32_16x16x32_bf16 v[236:239], a[240:243], a[128:131], v[236:239]
    ds_read_b128 a[240:243], v240 offset:35584
    v_cvt_pk_bf16_f32 v48, v232, v233
    v_mfma_f32_16x16x32_bf16 v[236:239], a[244:247], a[132:135], v[236:239]
    ds_read_b128 a[244:247], v241 offset:35584
    v_cvt_pk_bf16_f32 v51, v234, v235
    v_mfma_f32_16x16x32_bf16 v[236:239], a[216:219], a[136:139], v[236:239]
    buffer_store_dwordx4 v[84:87], v89, s[24:27], s54 offen
    v_mfma_f32_16x16x32_bf16 v[236:239], a[220:223], a[140:143], v[236:239]
    ds_read_b64_tr_b16 v[54:55], v249 offset:9248
    v_add_u32 v240, 0xf000, v240
    v_mfma_f32_16x16x32_bf16 v[228:231], a[224:227], a[72:75], 0
    ds_read_b128 a[216:219], v240 offset:4608
    v_add_u32 v241, 0xf000, v241
    v_mfma_f32_16x16x32_bf16 v[228:231], a[228:231], a[76:79], v[228:231]
    ds_read_b128 a[220:223], v241 offset:4608
    s_add_u32 s54, s43, s45
    v_mfma_f32_16x16x32_bf16 v[232:235], a[224:227], a[96:99], 0
    ds_read_b64_tr_b16 v[56:57], v250 offset:9248
    v_cvt_pk_bf16_f32 v78, v236, v237
    v_mfma_f32_16x16x32_bf16 v[232:235], a[228:231], a[100:103], v[232:235]
    s_waitcnt lgkmcnt(6)
    v_cvt_pk_bf16_f32 v81, v238, v239
    v_mfma_f32_16x16x32_bf16 v[228:231], a[232:235], a[80:83], v[228:231]
    buffer_store_dwordx4 v[24:27], v89, s[24:27], s55 offen
    v_mfma_f32_16x16x32_bf16 v[228:231], a[236:239], a[84:87], v[228:231]
    ds_read_b64_tr_b16 v[84:85], v249 offset:9280
    s_add_u32 s55, s43, s45
    v_mfma_f32_16x16x32_bf16 v[232:235], a[232:235], a[104:107], v[232:235]
    ds_read_b64_tr_b16 v[86:87], v250 offset:9280
    s_waitcnt vmcnt(12) lgkmcnt(5)
    v_mfma_f32_16x16x32_bf16 v[228:231], a[240:243], a[88:91], v[228:231]
    ds_read_b64_tr_b16 v[24:25], v249 offset:0
    v_mfma_f32_16x16x32_bf16 v[228:231], a[244:247], a[92:95], v[228:231]
    ds_read_b64_tr_b16 v[26:27], v250 offset:0
    v_mfma_f32_16x16x32_bf16 v[232:235], a[236:239], a[108:111], v[232:235]
    v_exp_f32 v198, v198
    v_mfma_f32_16x16x32_bf16 v[232:235], a[240:243], a[112:115], v[232:235]
    s_waitcnt lgkmcnt(4)
    v_exp_f32 v199, v199
    v_mfma_f32_16x16x32_bf16 v[232:235], a[244:247], a[116:119], v[232:235]
    buffer_store_dwordx4 v[54:57], v89, s[24:27], s56 offen
    v_mfma_f32_16x16x32_bf16 v[236:239], a[224:227], a[120:123], 0
    ds_read_b128 a[224:227], v240 offset:4736
    v_cvt_pk_bf16_f32 v19, v228, v229
    v_mfma_f32_16x16x32_bf16 v[236:239], a[228:231], a[124:127], v[236:239]
    ds_read_b128 a[228:231], v241 offset:4736
    v_cvt_pk_bf16_f32 v22, v230, v231
    v_mfma_f32_16x16x32_bf16 v[236:239], a[232:235], a[128:131], v[236:239]
    ds_read_b128 a[232:235], v240 offset:4864
    v_cvt_pk_bf16_f32 v49, v232, v233
    v_mfma_f32_16x16x32_bf16 v[236:239], a[236:239], a[132:135], v[236:239]
    ds_read_b128 a[236:239], v241 offset:4864
    v_cvt_pk_bf16_f32 v52, v234, v235
    v_mfma_f32_16x16x32_bf16 v[236:239], a[240:243], a[136:139], v[236:239]
    ds_read_b64_tr_b16 v[54:55], v249 offset:32
    v_add_u32 v240, 0xffff1000, v240
    v_mfma_f32_16x16x32_bf16 v[236:239], a[244:247], a[140:143], v[236:239]
    ds_read_b128 a[240:243], v240 offset:6144
    v_add_u32 v241, 0xffff1000, v241
    v_mfma_f32_16x16x32_bf16 v[228:231], a[216:219], a[72:75], 0
    ds_read_b128 a[244:247], v241 offset:6144
    v_cvt_pk_bf16_f32 v183, v198, v199
    v_mfma_f32_16x16x32_bf16 v[228:231], a[220:223], a[76:79], v[228:231]
    ds_read_b128 v[196:199], v245 offset:256
    s_add_u32 s56, s43, s45
    v_mfma_f32_16x16x32_bf16 v[232:235], a[216:219], a[96:99], 0
    ds_read_b64_tr_b16 v[56:57], v250 offset:32
    v_cvt_pk_bf16_f32 v79, v236, v237
    v_mfma_f32_16x16x32_bf16 v[232:235], a[220:223], a[100:103], v[232:235]
    s_waitcnt lgkmcnt(8)
    v_cvt_pk_bf16_f32 v82, v238, v239
    v_mfma_f32_16x16x32_bf16 v[228:231], a[224:227], a[80:83], v[228:231]
    buffer_store_dwordx4 v[84:87], v89, s[24:27], s57 offen
    v_mfma_f32_16x16x32_bf16 v[232:235], a[224:227], a[104:107], v[232:235]
    s_lshl1_add_u32 s57, s45, s43
    v_exp_f32 v200, v200
    v_mfma_f32_16x16x32_bf16 v[236:239], a[216:219], a[120:123], 0
    ds_read_b128 a[216:219], v240 offset:6272
    s_waitcnt lgkmcnt(4)
    v_mfma_f32_16x16x32_bf16 v[228:231], a[228:231], a[84:87], v[228:231]
    ds_read_b64_tr_b16 v[84:85], v249 offset:64
    v_mfma_f32_16x16x32_bf16 v[228:231], a[232:235], a[88:91], v[228:231]
    buffer_store_dwordx4 v[24:27], v89, s[24:27], s58 offen
    v_mfma_f32_16x16x32_bf16 v[228:231], a[236:239], a[92:95], v[228:231]
    ds_read_b64_tr_b16 v[86:87], v250 offset:64
    s_lshl1_add_u32 s58, s45, s43
    v_mfma_f32_16x16x32_bf16 v[232:235], a[228:231], a[108:111], v[232:235]
    s_waitcnt vmcnt(7) lgkmcnt(3)
    v_exp_f32 v201, v201
    v_mfma_f32_16x16x32_bf16 v[196:199], v[120:123], v[168:171], v[196:199]
    ds_read_b64_tr_b16 v[24:25], v249 offset:3072
    v_cvt_pk_bf16_f32 v181, v200, v201
    v_mfma_f32_16x16x32_bf16 v[196:199], v[122:125], v[170:173], v[196:199]
    buffer_store_dwordx4 v[54:57], v89, s[24:27], s59 offen
    v_mfma_f32_16x16x32_bf16 v[232:235], a[232:235], a[112:115], v[232:235]
    ds_read_b64_tr_b16 v[26:27], v250 offset:3072
    v_cvt_pk_bf16_f32 v20, v228, v229
    v_mfma_f32_16x16x32_bf16 v[232:235], a[236:239], a[116:119], v[232:235]
    ds_read_b64_tr_b16 v[54:55], v249 offset:3104
    v_cvt_pk_bf16_f32 v23, v230, v231
    v_mfma_f32_16x16x32_bf16 v[236:239], a[220:223], a[124:127], v[236:239]
    ds_read_b128 a[220:223], v241 offset:6272
    s_add_u32 s59, s44, s45
    v_mfma_f32_16x16x32_bf16 v[236:239], a[224:227], a[128:131], v[236:239]
    ds_read_b128 a[224:227], v240 offset:6400
    s_waitcnt lgkmcnt(5)
    v_mfma_f32_16x16x32_bf16 v[236:239], a[228:231], a[132:135], v[236:239]
    ds_read_b128 a[228:231], v241 offset:6400
    v_cvt_pk_bf16_f32 v50, v232, v233
    v_mfma_f32_16x16x32_bf16 v[236:239], a[232:235], a[136:139], v[236:239]
    ds_read_b128 a[232:235], v242 offset:1536
    v_cvt_pk_bf16_f32 v53, v234, v235
    v_mfma_f32_16x16x32_bf16 v[236:239], a[236:239], a[140:143], v[236:239]
    ds_read_b128 a[236:239], v243 offset:1536
    v_mfma_f32_16x16x32_bf16 v[228:231], a[0:3], a[240:243], 0
    buffer_store_dwordx4 v[84:87], v89, s[24:27], s50 offen
    v_mfma_f32_16x16x32_bf16 v[228:231], a[4:7], a[244:247], v[228:231]
    ds_read_b64_tr_b16 v[56:57], v250 offset:3104
    s_add_u32 s50, s44, s45
    v_mfma_f32_16x16x32_bf16 v[228:231], a[8:11], a[216:219], v[228:231]
    ds_read_b64_tr_b16 v[84:85], v249 offset:3136
    v_cvt_pk_bf16_f32 v80, v236, v237
    v_mfma_f32_16x16x32_bf16 v[232:235], a[24:27], a[240:243], 0
    ds_read_b64_tr_b16 v[86:87], v250 offset:3136
    v_cvt_pk_bf16_f32 v83, v238, v239
    v_mfma_f32_16x16x32_bf16 v[232:235], a[28:31], a[244:247], v[232:235]
    s_waitcnt lgkmcnt(6)
    v_exp_f32 v202, v202
    v_mfma_f32_16x16x32_bf16 v[228:231], a[12:15], a[220:223], v[228:231]
    buffer_store_dwordx4 v[24:27], v89, s[24:27], s51 offen
    v_mfma_f32_16x16x32_bf16 v[228:231], a[16:19], a[224:227], v[228:231]
    s_add_u32 s51, s44, s45
    v_exp_f32 v203, v203
    v_mfma_f32_16x16x32_bf16 v[232:235], a[32:35], a[216:219], v[232:235]
    s_waitcnt lgkmcnt(3)
    v_exp_f32 v204, v204
    v_mfma_f32_16x16x32_bf16 v[228:231], a[20:23], a[228:231], v[228:231]
    v_exp_f32 v205, v205
    v_mfma_f32_16x16x32_bf16 v[232:235], a[36:39], a[220:223], v[232:235]
    s_waitcnt lgkmcnt(2)
    v_cvt_pk_bf16_f32 v184, v202, v203
    v_cvt_pk_bf16_f32 v182, v204, v205
    v_mfma_f32_16x16x32_bf16 v[232:235], a[40:43], a[224:227], v[232:235]
    ds_read_b128 v[200:203], v246 offset:256
    s_waitcnt lgkmcnt(1)
    v_mfma_f32_16x16x32_bf16 v[212:215], v[0:3], v[180:183], 0
    buffer_store_dwordx4 v[54:57], v89, s[24:27], s52 offen
    v_mfma_f32_16x16x32_bf16 v[216:219], v[30:33], v[180:183], 0
    s_barrier
    v_cvt_pk_bf16_f32 v162, v228, v229
    v_cvt_pk_bf16_f32 v163, v230, v231
    v_mfma_f32_16x16x32_bf16 v[220:223], v[60:63], v[180:183], 0
    s_lshl1_add_u32 s52, s45, s44
    v_exp_f32 v206, v206
    v_mfma_f32_16x16x32_bf16 v[224:227], a[248:251], v[180:183], 0
    v_exp_f32 v207, v207
    v_mfma_f32_16x16x32_bf16 v[232:235], a[44:47], a[228:231], v[232:235]
    buffer_load_dwordx4 v254, s[4:7], s43 offen lds
    v_cvt_pk_bf16_f32 v185, v206, v207
    v_mfma_f32_16x16x32_bf16 v[236:239], a[48:51], a[240:243], 0
    ds_read_b128 a[240:243], v242 offset:1664
    v_accvgpr_read_b32 v254, a254
    v_mfma_f32_16x16x32_bf16 v[236:239], a[52:55], a[244:247], v[236:239]
    ds_read_b128 a[244:247], v243 offset:1664
    s_add_u32 m0, s46, 0x16c00
    v_mfma_f32_16x16x32_bf16 v[236:239], a[56:59], a[216:219], v[236:239]
    ds_read_b128 a[216:219], v242 offset:1792
    v_cvt_pk_bf16_f32 v164, v232, v233
    v_mfma_f32_16x16x32_bf16 v[236:239], a[60:63], a[220:223], v[236:239]
    ds_read_b128 a[220:223], v243 offset:1792
    v_cvt_pk_bf16_f32 v165, v234, v235
    v_mfma_f32_16x16x32_bf16 v[236:239], a[64:67], a[224:227], v[236:239]
    ds_read_b128 a[224:227], v240 offset:6144
    s_waitcnt lgkmcnt(5)
    v_mfma_f32_16x16x32_bf16 v[200:203], v[144:147], v[168:171], v[200:203]
    ds_read_b128 v[204:207], v244 offset:320
    v_mfma_f32_16x16x32_bf16 v[200:203], v[146:149], v[170:173], v[200:203]
    buffer_load_dwordx4 v255, s[4:7], s43 offen lds
    v_accvgpr_read_b32 v255, a252
    v_mfma_f32_16x16x32_bf16 v[236:239], a[68:71], a[228:231], v[236:239]
    ds_read_b128 a[228:231], v241 offset:6144
    s_add_u32 m0, s46, 0x17000
    v_mfma_f32_16x16x32_bf16 v[228:231], a[144:147], a[232:235], 0
    v_exp_f32 v208, v208
    v_mfma_f32_16x16x32_bf16 v[228:231], a[148:151], a[236:239], v[228:231]
    s_waitcnt lgkmcnt(6)
    v_exp_f32 v209, v209
    v_mfma_f32_16x16x32_bf16 v[228:231], a[152:155], a[240:243], v[228:231]
    s_waitcnt lgkmcnt(5)
    v_cvt_pk_bf16_f32 v166, v236, v237
    v_cvt_pk_bf16_f32 v167, v238, v239
    v_mfma_f32_16x16x32_bf16 v[228:231], a[156:159], a[244:247], v[228:231]
    buffer_load_dwordx4 v254, s[4:7], s43 offen lds
    v_cvt_pk_bf16_f32 v186, v208, v209
    v_mfma_f32_16x16x32_bf16 v[232:235], a[168:171], a[232:235], 0
    s_add_u32 m0, s46, 0x17400
    v_exp_f32 v210, v210
    v_mfma_f32_16x16x32_bf16 v[232:235], a[172:175], a[236:239], v[232:235]
    s_waitcnt lgkmcnt(2)
    v_exp_f32 v211, v211
    v_mfma_f32_16x16x32_bf16 v[228:231], a[160:163], a[216:219], v[228:231]
    s_waitcnt lgkmcnt(1)
    v_cvt_pk_bf16_f32 v189, v210, v211
    v_accvgpr_read_b32 v254, a253
    v_mfma_f32_16x16x32_bf16 v[204:207], v[102:105], v[168:171], v[204:207]
    ds_read_b128 v[208:211], v245 offset:320
    v_mfma_f32_16x16x32_bf16 v[204:207], v[104:107], v[170:173], v[204:207]
    buffer_load_dwordx4 v255, s[4:7], s54 offen lds
    v_accvgpr_read_b32 v255, a254
    v_mfma_f32_16x16x32_bf16 v[228:231], a[164:167], a[220:223], v[228:231]
    s_add_u32 m0, s46, 0x17800
    v_exp_f32 v196, v196
    v_mfma_f32_16x16x32_bf16 v[232:235], a[176:179], a[240:243], v[232:235]
    s_mov_b32 s54, 0
    v_exp_f32 v197, v197
    v_mfma_f32_16x16x32_bf16 v[232:235], a[180:183], a[244:247], v[232:235]
    v_exp_f32 v198, v198
    v_mfma_f32_16x16x32_bf16 v[232:235], a[184:187], a[216:219], v[232:235]
    v_mul_f32 v228, s38, v228
    v_mul_f32 v229, s38, v229
    v_mfma_f32_16x16x32_bf16 v[232:235], a[188:191], a[220:223], v[232:235]
    buffer_load_dwordx4 v254, s[4:7], s55 offen lds
    v_mul_f32 v230, s38, v230
    v_mfma_f32_16x16x32_bf16 v[236:239], a[192:195], a[232:235], 0
    ds_read_b128 a[232:235], v240 offset:6272
    v_mul_f32 v231, s38, v231
    v_mfma_f32_16x16x32_bf16 v[236:239], a[196:199], a[236:239], v[236:239]
    ds_read_b128 a[236:239], v241 offset:6272
    v_cvt_pk_bf16_f32 v174, v228, v229
    v_mfma_f32_16x16x32_bf16 v[236:239], a[200:203], a[240:243], v[236:239]
    ds_read_b128 a[240:243], v240 offset:6400
    v_cvt_pk_bf16_f32 v175, v230, v231
    v_mfma_f32_16x16x32_bf16 v[236:239], a[204:207], a[244:247], v[236:239]
    ds_read_b128 a[244:247], v241 offset:6400
    v_mul_f32 v232, s3, v232
    v_mfma_f32_16x16x32_bf16 v[236:239], a[208:211], a[216:219], v[236:239]
    ds_read_b128 a[216:219], v240 offset:36864
    v_mul_f32 v233, s3, v233
    v_mfma_f32_16x16x32_bf16 v[236:239], a[212:215], a[220:223], v[236:239]
    ds_read_b128 a[220:223], v241 offset:36864
    v_mul_f32 v234, s3, v234
    v_mfma_f32_16x16x32_bf16 v[228:231], a[224:227], a[72:75], 0
    s_waitcnt lgkmcnt(6)
    v_mul_f32 v235, s3, v235
    v_cvt_pk_bf16_f32 v176, v232, v233
    v_mfma_f32_16x16x32_bf16 v[208:211], v[126:129], v[168:171], v[208:211]
    buffer_store_dwordx4 v[84:87], v89, s[24:27], s53 offen
    v_mfma_f32_16x16x32_bf16 v[208:211], v[128:131], v[170:173], v[208:211]
    s_add_u32 m0, s46, 0x17c00
    v_cvt_pk_bf16_f32 v177, v234, v235
    v_mul_f32 v236, s38, v236
    v_mfma_f32_16x16x32_bf16 v[228:231], a[228:231], a[76:79], v[228:231]
    s_lshl1_add_u32 s53, s45, s44
    v_mul_f32 v237, s38, v237
    v_mul_f32 v238, s38, v238
    v_mfma_f32_16x16x32_bf16 v[232:235], a[224:227], a[96:99], 0
    s_mov_b32 s55, 0
    v_mul_f32 v239, s38, v239
    v_cvt_pk_bf16_f32 v178, v236, v237
    v_mfma_f32_16x16x32_bf16 v[232:235], a[228:231], a[100:103], v[232:235]
    s_waitcnt lgkmcnt(2)
    v_cvt_pk_bf16_f32 v179, v238, v239
    v_cvt_pk_bf16_f32 v187, v196, v197
    v_mfma_f32_16x16x32_bf16 v[228:231], a[232:235], a[80:83], v[228:231]
    buffer_load_dwordx4 v255, s[4:7], s56 offen lds
    v_accvgpr_read_b32 v254, a252
    v_mfma_f32_16x16x32_bf16 v[212:215], v[4:7], v[184:187], v[212:215]
    s_add_u32 m0, s46, 0x18000
    v_exp_f32 v199, v199
    v_mfma_f32_16x16x32_bf16 v[216:219], v[34:37], v[184:187], v[216:219]
    s_mov_b32 s56, 0
    v_cvt_pk_bf16_f32 v190, v198, v199
    v_accvgpr_read_b32 v255, a255
    v_mfma_f32_16x16x32_bf16 v[220:223], v[64:67], v[184:187], v[220:223]
    ds_read_b128 v[196:199], v246 offset:320
    v_mfma_f32_16x16x32_bf16 v[224:227], a[248:251], v[184:187], v[224:227]
    v_exp_f32 v200, v200
    v_mfma_f32_16x16x32_bf16 v[228:231], a[236:239], a[84:87], v[228:231]
    buffer_load_dwordx4 v254, s[4:7], s57 offen lds
    v_mbcnt_lo_u32_b32 v254, -1, 0
    v_mfma_f32_16x16x32_bf16 v[228:231], a[240:243], a[88:91], v[228:231]
    s_add_u32 m0, s46, 0x18200
    v_exp_f32 v201, v201
    v_mfma_f32_16x16x32_bf16 v[228:231], a[244:247], a[92:95], v[228:231]
    s_mov_b32 s57, 0
    v_exp_f32 v202, v202
    v_mfma_f32_16x16x32_bf16 v[232:235], a[232:235], a[104:107], v[232:235]
    v_exp_f32 v203, v203
    v_mfma_f32_16x16x32_bf16 v[232:235], a[236:239], a[108:111], v[232:235]
    v_cvt_pk_bf16_f32 v188, v200, v201
    v_cvt_pk_bf16_f32 v191, v202, v203
    v_mfma_f32_16x16x32_bf16 v[232:235], a[240:243], a[112:115], v[232:235]
    ds_read_b128 v[200:203], v244 offset:0
    v_cvt_pk_bf16_f32 v24, v228, v229
    v_mfma_f32_16x16x32_bf16 v[212:215], v[8:11], v[188:191], v[212:215]
    buffer_load_dwordx4 v255, s[4:7], s58 offen lds
    v_cvt_pk_bf16_f32 v27, v230, v231
    v_mfma_f32_16x16x32_bf16 v[216:219], v[38:41], v[188:191], v[216:219]
    s_add_u32 m0, s46, 0
    v_exp_f32 v204, v204
    v_mfma_f32_16x16x32_bf16 v[220:223], v[68:71], v[188:191], v[220:223]
    s_mov_b32 s58, 0x1000
    v_exp_f32 v205, v205
    v_mfma_f32_16x16x32_bf16 v[224:227], a[248:251], v[188:191], v[224:227]
    s_waitcnt lgkmcnt(1)
    v_cvt_pk_bf16_f32 v192, v204, v205
    v_mbcnt_hi_u32_b32 v254, -1, v254
    v_mfma_f32_16x16x32_bf16 v[196:199], v[150:153], v[168:171], v[196:199]
    ds_read_b128 v[204:207], v245 offset:0
    v_bfe_u32 v254, v254, 1, 1
    v_mfma_f32_16x16x32_bf16 v[196:199], v[152:155], v[170:173], v[196:199]
    v_exp_f32 v208, v208
    v_mfma_f32_16x16x32_bf16 v[232:235], a[244:247], a[116:119], v[232:235]
    v_exp_f32 v209, v209
    v_mfma_f32_16x16x32_bf16 v[236:239], a[224:227], a[120:123], 0
    ds_read_b128 a[224:227], v240 offset:36992
    v_cvt_pk_bf16_f32 v193, v208, v209
    v_mfma_f32_16x16x32_bf16 v[236:239], a[228:231], a[124:127], v[236:239]
    ds_read_b128 a[228:231], v241 offset:36992
    v_lshlrev_b32 v255, 4, v254
    v_mfma_f32_16x16x32_bf16 v[236:239], a[232:235], a[128:131], v[236:239]
    ds_read_b128 a[232:235], v240 offset:37120
    v_cvt_pk_bf16_f32 v54, v232, v233
    v_mfma_f32_16x16x32_bf16 v[236:239], a[236:239], a[132:135], v[236:239]
    ds_read_b128 a[236:239], v241 offset:37120
    v_cvt_pk_bf16_f32 v57, v234, v235
    v_mfma_f32_16x16x32_bf16 v[236:239], a[240:243], a[136:139], v[236:239]
    ds_read_b128 a[240:243], v242 offset:3072
    v_add_u32 v240, 0xf000, v240
    v_mfma_f32_16x16x32_bf16 v[236:239], a[244:247], a[140:143], v[236:239]
    ds_read_b128 a[244:247], v243 offset:3072
    v_add_u32 v241, 0xf000, v241
    v_mfma_f32_16x16x32_bf16 v[228:231], a[0:3], a[216:219], 0
    ds_read_b128 v[208:211], v246 offset:0
    v_xor_b32 v255, v255, v242
    v_mfma_f32_16x16x32_bf16 v[228:231], a[4:7], a[220:223], v[228:231]
    s_waitcnt lgkmcnt(7)
    v_exp_f32 v196, v196
    v_mfma_f32_16x16x32_bf16 v[200:203], v[96:99], v[174:177], v[200:203]
    v_cvt_pk_bf16_f32 v84, v236, v237
    v_cvt_pk_bf16_f32 v87, v238, v239
    v_mfma_f32_16x16x32_bf16 v[200:203], v[98:101], v[176:179], v[200:203]
    s_waitcnt lgkmcnt(6)
    v_exp_f32 v197, v197
    v_mfma_f32_16x16x32_bf16 v[204:207], v[120:123], v[174:177], v[204:207]
    v_cvt_pk_bf16_f32 v194, v196, v197
    v_mul_u32_u24 v254, 0x7500, v254
    v_mfma_f32_16x16x32_bf16 v[204:207], v[122:125], v[176:179], v[204:207]
    ds_read_b128 v[196:199], v244 offset:64
    v_add_u32 v254, v254, v255
    v_mfma_f32_16x16x32_bf16 v[212:215], v[12:15], v[192:195], v[212:215]
    v_exp_f32 v200, v200
    v_mfma_f32_16x16x32_bf16 v[216:219], v[42:45], v[192:195], v[216:219]
    v_exp_f32 v201, v201
    v_mfma_f32_16x16x32_bf16 v[220:223], v[72:75], v[192:195], v[220:223]
    v_exp_f32 v202, v202
    v_mfma_f32_16x16x32_bf16 v[224:227], a[248:251], v[192:195], v[224:227]
    s_waitcnt lgkmcnt(1)
    v_exp_f32 v203, v203
    v_mfma_f32_16x16x32_bf16 v[208:211], v[144:147], v[174:177], v[208:211]
    v_cvt_pk_bf16_f32 v180, v200, v201
    v_cvt_pk_bf16_f32 v183, v202, v203
    v_mfma_f32_16x16x32_bf16 v[208:211], v[146:149], v[176:179], v[208:211]
    ds_read_b128 v[200:203], v245 offset:64
    v_xor_b32 v255, 64, v254
    v_mfma_f32_16x16x32_bf16 v[228:231], a[8:11], a[224:227], v[228:231]
    v_rcp_f32 v225, v224
    v_mfma_f32_16x16x32_bf16 v[228:231], a[12:15], a[228:231], v[228:231]
    v_max3_f32 v248, v248, v224, v225
    v_mul_f32 v212, v212, v225
    v_mfma_f32_16x16x32_bf16 v[228:231], a[16:19], a[232:235], v[228:231]
    s_waitcnt lgkmcnt(1)
    v_mul_f32 v213, v213, v225
    v_mul_f32 v214, v214, v225
    v_mfma_f32_16x16x32_bf16 v[196:199], v[102:105], v[174:177], v[196:199]
    v_mul_f32 v215, v215, v225
    v_cvt_pk_bf16_f32 v212, v212, v213
    v_mfma_f32_16x16x32_bf16 v[196:199], v[104:107], v[176:179], v[196:199]
    v_cvt_pk_bf16_f32 v213, v214, v215
    v_mul_f32 v216, v216, v225
    v_mfma_f32_16x16x32_bf16 v[228:231], a[20:23], a[236:239], v[228:231]
    ds_write_b64 v251, v[212:213] offset:0
    v_mfma_f32_16x16x32_bf16 v[232:235], a[24:27], a[216:219], 0
    v_mul_f32 v217, v217, v225
    v_mul_f32 v218, v218, v225
    v_mfma_f32_16x16x32_bf16 v[232:235], a[28:31], a[220:223], v[232:235]
    s_waitcnt lgkmcnt(1)
    v_mul_f32 v219, v219, v225
    v_cvt_pk_bf16_f32 v216, v216, v217
    v_mfma_f32_16x16x32_bf16 v[200:203], v[126:129], v[174:177], v[200:203]
    v_cvt_pk_bf16_f32 v90, v228, v229
    v_cvt_pk_bf16_f32 v91, v230, v231
    v_mfma_f32_16x16x32_bf16 v[200:203], v[128:131], v[176:179], v[200:203]
    v_cvt_pk_bf16_f32 v217, v218, v219
    v_mul_f32 v220, v220, v225
    v_mfma_f32_16x16x32_bf16 v[232:235], a[32:35], a[224:227], v[232:235]
    ds_write_b64 v251, v[216:217] offset:128
    v_mfma_f32_16x16x32_bf16 v[232:235], a[36:39], a[228:231], v[232:235]
    v_mul_f32 v221, v221, v225
    v_mul_f32 v222, v222, v225
    v_mfma_f32_16x16x32_bf16 v[232:235], a[40:43], a[232:235], v[232:235]
    v_mul_f32 v223, v223, v225
    v_cvt_pk_bf16_f32 v220, v220, v221
    v_mfma_f32_16x16x32_bf16 v[232:235], a[44:47], a[236:239], v[232:235]
    v_exp_f32 v204, v204
    v_mfma_f32_16x16x32_bf16 v[236:239], a[48:51], a[216:219], 0
    v_exp_f32 v205, v205
    v_mfma_f32_16x16x32_bf16 v[236:239], a[52:55], a[220:223], v[236:239]
    v_cvt_pk_bf16_f32 v221, v222, v223
    v_cvt_pk_bf16_f32 v181, v204, v205
    v_mfma_f32_16x16x32_bf16 v[236:239], a[56:59], a[224:227], v[236:239]
    ds_write_b64 v251, v[220:221] offset:256
    v_mfma_f32_16x16x32_bf16 v[236:239], a[60:63], a[228:231], v[236:239]
    v_cvt_pk_bf16_f32 v92, v232, v233
    v_cvt_pk_bf16_f32 v93, v234, v235
    v_mfma_f32_16x16x32_bf16 v[236:239], a[64:67], a[232:235], v[236:239]
    v_exp_f32 v206, v206
    v_mfma_f32_16x16x32_bf16 v[236:239], a[68:71], a[236:239], v[236:239]
    v_exp_f32 v207, v207
    v_mfma_f32_16x16x32_bf16 v[228:231], a[216:219], a[72:75], 0
    v_exp_f32 v208, v208
    v_mfma_f32_16x16x32_bf16 v[228:231], a[220:223], a[76:79], v[228:231]
    v_exp_f32 v209, v209
    v_mfma_f32_16x16x32_bf16 v[228:231], a[224:227], a[80:83], v[228:231]
    v_cvt_pk_bf16_f32 v184, v206, v207
    v_cvt_pk_bf16_f32 v182, v208, v209
    v_mfma_f32_16x16x32_bf16 v[228:231], a[228:231], a[84:87], v[228:231]
    ds_read_b128 v[204:207], v246 offset:64
    v_cvt_pk_bf16_f32 v94, v236, v237
    v_mfma_f32_16x16x32_bf16 v[212:215], v[6:9], v[180:183], 0
    v_cvt_pk_bf16_f32 v95, v238, v239
    v_mfma_f32_16x16x32_bf16 v[216:219], v[36:39], v[180:183], 0
    v_exp_f32 v210, v210
    v_mfma_f32_16x16x32_bf16 v[220:223], v[66:69], v[180:183], 0
    v_exp_f32 v211, v211
    v_mfma_f32_16x16x32_bf16 v[224:227], a[248:251], v[180:183], 0
    v_exp_f32 v196, v196
    v_mfma_f32_16x16x32_bf16 v[228:231], a[232:235], a[88:91], v[228:231]
    v_exp_f32 v197, v197
    v_mfma_f32_16x16x32_bf16 v[228:231], a[236:239], a[92:95], v[228:231]
    v_cvt_pk_bf16_f32 v185, v210, v211
    v_cvt_pk_bf16_f32 v186, v196, v197
    v_mfma_f32_16x16x32_bf16 v[232:235], a[216:219], a[96:99], 0
    ds_read_b128 v[208:211], v244 offset:128
    v_mfma_f32_16x16x32_bf16 v[232:235], a[220:223], a[100:103], v[232:235]
    v_exp_f32 v198, v198
    v_mfma_f32_16x16x32_bf16 v[232:235], a[224:227], a[104:107], v[232:235]
    s_waitcnt lgkmcnt(1)
    v_cvt_pk_bf16_f32 v25, v228, v229
    v_cvt_pk_bf16_f32 v28, v230, v231
    v_mfma_f32_16x16x32_bf16 v[204:207], v[150:153], v[174:177], v[204:207]
    v_exp_f32 v199, v199
    v_mfma_f32_16x16x32_bf16 v[204:207], v[152:155], v[176:179], v[204:207]
    v_exp_f32 v200, v200
    v_mfma_f32_16x16x32_bf16 v[232:235], a[228:231], a[108:111], v[232:235]
    v_exp_f32 v201, v201
    v_mfma_f32_16x16x32_bf16 v[232:235], a[232:235], a[112:115], v[232:235]
    v_cvt_pk_bf16_f32 v189, v198, v199
    v_cvt_pk_bf16_f32 v187, v200, v201
    v_mfma_f32_16x16x32_bf16 v[232:235], a[236:239], a[116:119], v[232:235]
    ds_read_b128 v[196:199], v245 offset:128
    v_mfma_f32_16x16x32_bf16 v[212:215], v[10:13], v[184:187], v[212:215]
    v_exp_f32 v202, v202
    v_mfma_f32_16x16x32_bf16 v[216:219], v[40:43], v[184:187], v[216:219]
    s_waitcnt lgkmcnt(1)
    v_exp_f32 v203, v203
    v_mfma_f32_16x16x32_bf16 v[220:223], v[70:73], v[184:187], v[220:223]
    v_exp_f32 v204, v204
    v_mfma_f32_16x16x32_bf16 v[224:227], a[248:251], v[184:187], v[224:227]
    v_cvt_pk_bf16_f32 v55, v232, v233
    v_cvt_pk_bf16_f32 v58, v234, v235
    v_mfma_f32_16x16x32_bf16 v[208:211], v[108:111], v[174:177], v[208:211]
    v_exp_f32 v205, v205
    v_mfma_f32_16x16x32_bf16 v[208:211], v[110:113], v[176:179], v[208:211]
    v_cvt_pk_bf16_f32 v190, v202, v203
    v_cvt_pk_bf16_f32 v188, v204, v205
    v_mfma_f32_16x16x32_bf16 v[236:239], a[216:219], a[120:123], 0
    ds_read_b128 a[216:219], v242 offset:3200
    v_mfma_f32_16x16x32_bf16 v[236:239], a[220:223], a[124:127], v[236:239]
    ds_read_b128 a[220:223], v243 offset:3200
    s_waitcnt lgkmcnt(2)
    v_mfma_f32_16x16x32_bf16 v[196:199], v[132:135], v[174:177], v[196:199]
    ds_read_b128 v[200:203], v246 offset:128
    v_mfma_f32_16x16x32_bf16 v[196:199], v[134:137], v[176:179], v[196:199]
    v_exp_f32 v206, v206
    v_mfma_f32_16x16x32_bf16 v[236:239], a[224:227], a[128:131], v[236:239]
    ds_read_b128 a[224:227], v242 offset:3328
    v_mfma_f32_16x16x32_bf16 v[236:239], a[228:231], a[132:135], v[236:239]
    ds_read_b128 a[228:231], v243 offset:3328
    v_mfma_f32_16x16x32_bf16 v[236:239], a[232:235], a[136:139], v[236:239]
    ds_read_b128 a[232:235], v240 offset:6144
    v_mfma_f32_16x16x32_bf16 v[236:239], a[236:239], a[140:143], v[236:239]
    ds_read_b128 a[236:239], v241 offset:6144
    v_mfma_f32_16x16x32_bf16 v[228:231], a[144:147], a[240:243], 0
    v_exp_f32 v207, v207
    v_mfma_f32_16x16x32_bf16 v[228:231], a[148:151], a[244:247], v[228:231]
    s_waitcnt lgkmcnt(6)
    v_exp_f32 v208, v208
    v_mfma_f32_16x16x32_bf16 v[228:231], a[152:155], a[216:219], v[228:231]
    s_waitcnt lgkmcnt(5)
    v_cvt_pk_bf16_f32 v85, v236, v237
    v_cvt_pk_bf16_f32 v88, v238, v239
    v_mfma_f32_16x16x32_bf16 v[228:231], a[156:159], a[220:223], v[228:231]
    s_waitcnt lgkmcnt(4)
    v_exp_f32 v209, v209
    v_mfma_f32_16x16x32_bf16 v[200:203], v[156:159], v[174:177], v[200:203]
    v_cvt_pk_bf16_f32 v191, v206, v207
    v_cvt_pk_bf16_f32 v192, v208, v209
    v_mfma_f32_16x16x32_bf16 v[200:203], v[158:161], v[176:179], v[200:203]
    ds_read_b128 v[204:207], v244 offset:0
    s_waitcnt lgkmcnt(3)
    v_mfma_f32_16x16x32_bf16 v[212:215], v[14:17], v[188:191], v[212:215]
    ds_read_b128 v[208:211], v245 offset:0
    v_mfma_f32_16x16x32_bf16 v[216:219], v[44:47], v[188:191], v[216:219]
    v_exp_f32 v196, v196
    v_mfma_f32_16x16x32_bf16 v[220:223], v[74:77], v[188:191], v[220:223]
    v_exp_f32 v197, v197
    v_mfma_f32_16x16x32_bf16 v[224:227], a[248:251], v[188:191], v[224:227]
    v_exp_f32 v200, v200
    v_mfma_f32_16x16x32_bf16 v[228:231], a[160:163], a[224:227], v[228:231]
    v_exp_f32 v201, v201
    v_mfma_f32_16x16x32_bf16 v[228:231], a[164:167], a[228:231], v[228:231]
    v_cvt_pk_bf16_f32 v193, v196, v197
    v_cvt_pk_bf16_f32 v194, v200, v201
    v_mfma_f32_16x16x32_bf16 v[232:235], a[168:171], a[240:243], 0
    ds_read_b128 v[196:199], v246 offset:0
    v_mfma_f32_16x16x32_bf16 v[212:215], v[18:21], v[192:195], v[212:215]
    ds_read_b128 v[200:203], v244 offset:64
    v_mfma_f32_16x16x32_bf16 v[216:219], v[48:51], v[192:195], v[216:219]
    v_mfma_f32_16x16x32_bf16 v[220:223], v[78:81], v[192:195], v[220:223]
    v_mul_f32 v228, s38, v228
    v_mul_f32 v229, s38, v229
    v_mfma_f32_16x16x32_bf16 v[224:227], a[248:251], v[192:195], v[224:227]
    v_mul_f32 v230, s38, v230
    v_mul_f32 v231, s38, v231
    v_mfma_f32_16x16x32_bf16 v[232:235], a[172:175], a[244:247], v[232:235]
    v_cvt_pk_bf16_f32 v168, v228, v229
    v_cvt_pk_bf16_f32 v169, v230, v231
    v_mfma_f32_16x16x32_bf16 v[232:235], a[176:179], a[216:219], v[232:235]
    s_waitcnt lgkmcnt(2)
    v_mfma_f32_16x16x32_bf16 v[232:235], a[180:183], a[220:223], v[232:235]
    v_rcp_f32 v225, v224
    v_mfma_f32_16x16x32_bf16 v[232:235], a[184:187], a[224:227], v[232:235]
    v_max3_f32 v248, v248, v224, v225
    v_mul_f32 v212, v212, v225
    v_mfma_f32_16x16x32_bf16 v[232:235], a[188:191], a[228:231], v[232:235]
    v_mul_f32 v213, v213, v225
    v_mul_f32 v214, v214, v225
    v_mfma_f32_16x16x32_bf16 v[236:239], a[192:195], a[240:243], 0
    ds_read_b128 a[240:243], v240 offset:6272
    v_mul_f32 v215, v215, v225
    v_mfma_f32_16x16x32_bf16 v[236:239], a[196:199], a[244:247], v[236:239]
    ds_read_b128 a[244:247], v241 offset:6272
    v_cvt_pk_bf16_f32 v212, v212, v213
    v_mfma_f32_16x16x32_bf16 v[236:239], a[200:203], a[216:219], v[236:239]
    ds_read_b128 a[216:219], v240 offset:6400
    v_mul_f32 v232, s3, v232
    v_mfma_f32_16x16x32_bf16 v[236:239], a[204:207], a[220:223], v[236:239]
    ds_read_b128 a[220:223], v241 offset:6400
    v_mul_f32 v233, s3, v233
    v_mfma_f32_16x16x32_bf16 v[236:239], a[208:211], a[224:227], v[236:239]
    ds_read_b128 a[224:227], v254 offset:4608
    v_mul_f32 v234, s3, v234
    v_mfma_f32_16x16x32_bf16 v[236:239], a[212:215], a[228:231], v[236:239]
    ds_read_b128 a[228:231], v255 offset:4608
    v_mul_f32 v235, s3, v235
    v_mfma_f32_16x16x32_bf16 v[228:231], a[0:3], a[232:235], 0
    v_cvt_pk_bf16_f32 v170, v232, v233
    v_cvt_pk_bf16_f32 v171, v234, v235
    v_mfma_f32_16x16x32_bf16 v[228:231], a[4:7], a[236:239], v[228:231]
    s_waitcnt lgkmcnt(6)
    v_cvt_pk_bf16_f32 v213, v214, v215
    v_mul_f32 v236, s38, v236
    v_mfma_f32_16x16x32_bf16 v[204:207], v[102:105], v[168:171], v[204:207]
    ds_write_b64 v251, v[212:213] offset:6144
    v_mfma_f32_16x16x32_bf16 v[208:211], v[126:129], v[168:171], v[208:211]
    s_waitcnt lgkmcnt(5)
    v_mul_f32 v237, s38, v237
    v_mul_f32 v238, s38, v238
    v_mfma_f32_16x16x32_bf16 v[196:199], v[150:153], v[168:171], v[196:199]
    v_mul_f32 v239, s38, v239
    v_cvt_pk_bf16_f32 v172, v236, v237
    v_mfma_f32_16x16x32_bf16 v[200:203], v[108:111], v[168:171], v[200:203]
    v_cvt_pk_bf16_f32 v173, v238, v239
    v_mul_f32 v216, v216, v225
    v_mfma_f32_16x16x32_bf16 v[228:231], a[8:11], a[240:243], v[228:231]
    v_mul_f32 v217, v217, v225
    v_mul_f32 v218, v218, v225
    v_mfma_f32_16x16x32_bf16 v[204:207], v[104:107], v[170:173], v[204:207]
    v_mul_f32 v219, v219, v225
    v_cvt_pk_bf16_f32 v216, v216, v217
    v_mfma_f32_16x16x32_bf16 v[208:211], v[128:131], v[170:173], v[208:211]
    v_cvt_pk_bf16_f32 v217, v218, v219
    v_mul_f32 v220, v220, v225
    v_mfma_f32_16x16x32_bf16 v[196:199], v[152:155], v[170:173], v[196:199]
    ds_write_b64 v251, v[216:217] offset:6272
    v_mfma_f32_16x16x32_bf16 v[200:203], v[110:113], v[170:173], v[200:203]
    v_mul_f32 v221, v221, v225
    v_mul_f32 v222, v222, v225
    v_mfma_f32_16x16x32_bf16 v[228:231], a[12:15], a[244:247], v[228:231]
    s_waitcnt lgkmcnt(1)
    v_mul_f32 v223, v223, v225
    v_cvt_pk_bf16_f32 v220, v220, v221
    v_mfma_f32_16x16x32_bf16 v[228:231], a[16:19], a[216:219], v[228:231]
    v_exp_f32 v204, v204
    v_mfma_f32_16x16x32_bf16 v[228:231], a[20:23], a[220:223], v[228:231]
    v_exp_f32 v205, v205
    v_mfma_f32_16x16x32_bf16 v[232:235], a[24:27], a[232:235], 0
    v_cvt_pk_bf16_f32 v221, v222, v223
    v_cvt_pk_bf16_f32 v180, v204, v205
    v_mfma_f32_16x16x32_bf16 v[232:235], a[28:31], a[236:239], v[232:235]
    ds_write_b64 v251, v[220:221] offset:6400
    v_mfma_f32_16x16x32_bf16 v[232:235], a[32:35], a[240:243], v[232:235]
    v_exp_f32 v206, v206
    v_mfma_f32_16x16x32_bf16 v[232:235], a[36:39], a[244:247], v[232:235]
    v_cvt_pk_bf16_f32 v96, v228, v229
    v_cvt_pk_bf16_f32 v97, v230, v231
    v_mfma_f32_16x16x32_bf16 v[232:235], a[40:43], a[216:219], v[232:235]
    v_exp_f32 v207, v207
    v_mfma_f32_16x16x32_bf16 v[232:235], a[44:47], a[220:223], v[232:235]
    v_exp_f32 v208, v208
    v_mfma_f32_16x16x32_bf16 v[236:239], a[48:51], a[232:235], 0
    v_exp_f32 v209, v209
    v_mfma_f32_16x16x32_bf16 v[236:239], a[52:55], a[236:239], v[236:239]
    v_cvt_pk_bf16_f32 v183, v206, v207
    v_cvt_pk_bf16_f32 v181, v208, v209
    v_mfma_f32_16x16x32_bf16 v[236:239], a[56:59], a[240:243], v[236:239]
    ds_read_b128 v[204:207], v245 offset:64
    v_cvt_pk_bf16_f32 v98, v232, v233
    v_mfma_f32_16x16x32_bf16 v[236:239], a[60:63], a[244:247], v[236:239]
    v_cvt_pk_bf16_f32 v99, v234, v235
    v_mfma_f32_16x16x32_bf16 v[236:239], a[64:67], a[216:219], v[236:239]
    v_exp_f32 v210, v210
    v_mfma_f32_16x16x32_bf16 v[236:239], a[68:71], a[220:223], v[236:239]
    v_exp_f32 v211, v211
    v_mfma_f32_16x16x32_bf16 v[228:231], a[232:235], a[72:75], 0
    v_exp_f32 v196, v196
    v_mfma_f32_16x16x32_bf16 v[228:231], a[236:239], a[76:79], v[228:231]
    v_exp_f32 v197, v197
    v_mfma_f32_16x16x32_bf16 v[228:231], a[240:243], a[80:83], v[228:231]
    v_cvt_pk_bf16_f32 v184, v210, v211
    v_cvt_pk_bf16_f32 v182, v196, v197
    v_mfma_f32_16x16x32_bf16 v[228:231], a[244:247], a[84:87], v[228:231]
    ds_read_b128 v[208:211], v246 offset:64
    v_cvt_pk_bf16_f32 v100, v236, v237
    v_mfma_f32_16x16x32_bf16 v[212:215], v[12:15], v[180:183], 0
    v_cvt_pk_bf16_f32 v101, v238, v239
    s_waitcnt lgkmcnt(1)
    v_mfma_f32_16x16x32_bf16 v[216:219], v[42:45], v[180:183], 0
    v_exp_f32 v198, v198
    v_mfma_f32_16x16x32_bf16 v[220:223], v[72:75], v[180:183], 0
    v_exp_f32 v199, v199
    v_mfma_f32_16x16x32_bf16 v[224:227], a[248:251], v[180:183], 0
    v_exp_f32 v200, v200
    v_mfma_f32_16x16x32_bf16 v[204:207], v[132:135], v[168:171], v[204:207]
    v_exp_f32 v201, v201
    v_mfma_f32_16x16x32_bf16 v[204:207], v[134:137], v[170:173], v[204:207]
    v_cvt_pk_bf16_f32 v185, v198, v199
    v_cvt_pk_bf16_f32 v186, v200, v201
    v_mfma_f32_16x16x32_bf16 v[228:231], a[216:219], a[88:91], v[228:231]
    ds_read_b128 v[196:199], v244 offset:128
    v_mfma_f32_16x16x32_bf16 v[228:231], a[220:223], a[92:95], v[228:231]
    v_exp_f32 v202, v202
    v_mfma_f32_16x16x32_bf16 v[232:235], a[232:235], a[96:99], 0
    s_waitcnt lgkmcnt(1)
    v_exp_f32 v203, v203
    v_mfma_f32_16x16x32_bf16 v[208:211], v[156:159], v[168:171], v[208:211]
    v_exp_f32 v204, v204
    v_mfma_f32_16x16x32_bf16 v[208:211], v[158:161], v[170:173], v[208:211]
    v_exp_f32 v205, v205
    v_mfma_f32_16x16x32_bf16 v[232:235], a[236:239], a[100:103], v[232:235]
    v_cvt_pk_bf16_f32 v26, v228, v229
    v_cvt_pk_bf16_f32 v29, v230, v231
    v_mfma_f32_16x16x32_bf16 v[232:235], a[240:243], a[104:107], v[232:235]
    v_cvt_pk_bf16_f32 v189, v202, v203
    v_cvt_pk_bf16_f32 v187, v204, v205
    v_mfma_f32_16x16x32_bf16 v[232:235], a[244:247], a[108:111], v[232:235]
    ds_read_b128 v[200:203], v245 offset:128
    v_mfma_f32_16x16x32_bf16 v[212:215], v[16:19], v[184:187], v[212:215]
    v_exp_f32 v206, v206
    v_mfma_f32_16x16x32_bf16 v[216:219], v[46:49], v[184:187], v[216:219]
    s_waitcnt lgkmcnt(1)
    v_exp_f32 v207, v207
    v_mfma_f32_16x16x32_bf16 v[220:223], v[76:79], v[184:187], v[220:223]
    v_exp_f32 v208, v208
    v_mfma_f32_16x16x32_bf16 v[224:227], a[248:251], v[184:187], v[224:227]
    v_exp_f32 v209, v209
    v_mfma_f32_16x16x32_bf16 v[196:199], v[162:165], v[168:171], v[196:199]
    v_cvt_pk_bf16_f32 v190, v206, v207
    v_cvt_pk_bf16_f32 v188, v208, v209
    v_mfma_f32_16x16x32_bf16 v[196:199], v[164:167], v[170:173], v[196:199]
    ds_read_b128 v[204:207], v246 offset:128
    v_mfma_f32_16x16x32_bf16 v[232:235], a[216:219], a[112:115], v[232:235]
    v_exp_f32 v210, v210
    v_mfma_f32_16x16x32_bf16 v[232:235], a[220:223], a[116:119], v[232:235]
    v_exp_f32 v211, v211
    v_mfma_f32_16x16x32_bf16 v[236:239], a[232:235], a[120:123], 0
    ds_read_b128 a[232:235], v254 offset:4736
    v_cvt_pk_bf16_f32 v191, v210, v211
    v_mfma_f32_16x16x32_bf16 v[236:239], a[236:239], a[124:127], v[236:239]
    ds_read_b128 a[236:239], v255 offset:4736
    s_waitcnt lgkmcnt(3)
    v_mfma_f32_16x16x32_bf16 v[212:215], v[20:23], v[188:191], v[212:215]
    ds_read_b128 v[208:211], v244 offset:0
    v_cvt_pk_bf16_f32 v56, v232, v233
    v_mfma_f32_16x16x32_bf16 v[216:219], v[50:53], v[188:191], v[216:219]
    v_cvt_pk_bf16_f32 v59, v234, v235
    v_mfma_f32_16x16x32_bf16 v[220:223], v[80:83], v[188:191], v[220:223]
    v_exp_f32 v196, v196
    v_mfma_f32_16x16x32_bf16 v[224:227], a[248:251], v[188:191], v[224:227]
    v_exp_f32 v197, v197
    v_mfma_f32_16x16x32_bf16 v[200:203], v[90:93], v[168:171], v[200:203]
    s_waitcnt lgkmcnt(3)
    v_cvt_pk_bf16_f32 v192, v196, v197
    v_mfma_f32_16x16x32_bf16 v[200:203], v[92:95], v[170:173], v[200:203]
    ds_read_b128 v[196:199], v245 offset:0
    v_mfma_f32_16x16x32_bf16 v[204:207], v[96:99], v[168:171], v[204:207]
    v_mfma_f32_16x16x32_bf16 v[204:207], v[98:101], v[170:173], v[204:207]
    v_mfma_f32_16x16x32_bf16 v[236:239], a[240:243], a[128:131], v[236:239]
    ds_read_b128 a[240:243], v254 offset:4864
    v_accvgpr_read_b32 v254, a252
    v_mfma_f32_16x16x32_bf16 v[236:239], a[244:247], a[132:135], v[236:239]
    ds_read_b128 a[244:247], v255 offset:4864
    v_accvgpr_read_b32 v255, a253
    v_mfma_f32_16x16x32_bf16 v[236:239], a[216:219], a[136:139], v[236:239]
    v_exp_f32 v200, v200
    v_mfma_f32_16x16x32_bf16 v[236:239], a[220:223], a[140:143], v[236:239]
    v_exp_f32 v201, v201
    v_mfma_f32_16x16x32_bf16 v[228:231], a[144:147], a[224:227], 0
    v_exp_f32 v204, v204
    v_mfma_f32_16x16x32_bf16 v[228:231], a[148:151], a[228:231], v[228:231]
    s_waitcnt lgkmcnt(3)
    v_exp_f32 v205, v205
    v_mfma_f32_16x16x32_bf16 v[228:231], a[152:155], a[232:235], v[228:231]
    v_cvt_pk_bf16_f32 v193, v200, v201
    v_cvt_pk_bf16_f32 v86, v236, v237
    v_mfma_f32_16x16x32_bf16 v[228:231], a[156:159], a[236:239], v[228:231]
    ds_read_b128 v[200:203], v246 offset:0
    v_cvt_pk_bf16_f32 v89, v238, v239
    v_mfma_f32_16x16x32_bf16 v[232:235], a[168:171], a[224:227], 0
    v_cvt_pk_bf16_f32 v194, v204, v205
    s_waitcnt lgkmcnt(2)
    v_mfma_f32_16x16x32_bf16 v[228:231], a[160:163], a[240:243], v[228:231]
    ds_read_b128 v[204:207], v244 offset:64
    s_waitcnt vmcnt(0) lgkmcnt(2)
    v_mfma_f32_16x16x32_bf16 v[212:215], v[24:27], v[192:195], v[212:215]
    s_barrier
    ds_read_b128 a[216:219], v240 offset:30720
    v_mfma_f32_16x16x32_bf16 v[216:219], v[54:57], v[192:195], v[216:219]
    ds_read_b128 a[220:223], v241 offset:30720
    v_mfma_f32_16x16x32_bf16 v[220:223], v[84:87], v[192:195], v[220:223]
    buffer_load_dwordx4 v254, s[4:7], s44 offen lds
    v_accvgpr_read_b32 v254, a254
    v_mfma_f32_16x16x32_bf16 v[224:227], a[248:251], v[192:195], v[224:227]
    s_add_u32 m0, s46, 0x400
    v_mfma_f32_16x16x32_bf16 v[228:231], a[164:167], a[244:247], v[228:231]
    v_mfma_f32_16x16x32_bf16 v[232:235], a[172:175], a[228:231], v[232:235]
    v_mfma_f32_16x16x32_bf16 v[232:235], a[176:179], a[232:235], v[232:235]
    v_mfma_f32_16x16x32_bf16 v[232:235], a[180:183], a[236:239], v[232:235]
    buffer_load_dwordx4 v255, s[4:7], s44 offen lds
    v_accvgpr_read_b32 v255, a252
    v_mfma_f32_16x16x32_bf16 v[232:235], a[184:187], a[240:243], v[232:235]
    s_add_u32 m0, s46, 0x800
    v_rcp_f32 v225, v224
    v_mfma_f32_16x16x32_bf16 v[232:235], a[188:191], a[244:247], v[232:235]
    v_mul_f32 v228, s38, v228
    v_mul_f32 v229, s38, v229
    v_mfma_f32_16x16x32_bf16 v[236:239], a[192:195], a[224:227], 0
    ds_read_b128 a[224:227], v240 offset:30848
    v_mul_f32 v230, s38, v230
    v_mfma_f32_16x16x32_bf16 v[236:239], a[196:199], a[228:231], v[236:239]
    ds_read_b128 a[228:231], v241 offset:30848
    v_mul_f32 v231, s38, v231
    v_mfma_f32_16x16x32_bf16 v[236:239], a[200:203], a[232:235], v[236:239]
    ds_read_b128 a[232:235], v240 offset:30976
    v_cvt_pk_bf16_f32 v174, v228, v229
    v_mfma_f32_16x16x32_bf16 v[236:239], a[204:207], a[236:239], v[236:239]
    ds_read_b128 a[236:239], v241 offset:30976
    v_cvt_pk_bf16_f32 v175, v230, v231
    v_mfma_f32_16x16x32_bf16 v[236:239], a[208:211], a[240:243], v[236:239]
    ds_write_b64 v247, v[174:175] offset:0
    v_mfma_f32_16x16x32_bf16 v[236:239], a[212:215], a[244:247], v[236:239]
    s_waitcnt lgkmcnt(5)
    v_mul_f32 v232, s3, v232
    v_mul_f32 v233, s3, v233
    v_mfma_f32_16x16x32_bf16 v[228:231], a[0:3], a[216:219], 0
    ds_read_b128 a[240:243], v242 offset:30720
    v_mul_f32 v234, s3, v234
    v_mfma_f32_16x16x32_bf16 v[228:231], a[4:7], a[220:223], v[228:231]
    ds_read_b128 a[244:247], v243 offset:30720
    v_mul_f32 v235, s3, v235
    v_cvt_pk_bf16_f32 v176, v232, v233
    v_cvt_pk_bf16_f32 v177, v234, v235
    v_mfma_f32_16x16x32_bf16 v[232:235], a[24:27], a[216:219], 0
    ds_write_b64 v247, v[176:177] offset:128
    v_mfma_f32_16x16x32_bf16 v[208:211], v[108:111], v[174:177], v[208:211]
    buffer_load_dwordx4 v254, s[4:7], s44 offen lds
    v_mul_f32 v236, s38, v236
    v_mfma_f32_16x16x32_bf16 v[196:199], v[132:135], v[174:177], v[196:199]
    s_add_u32 m0, s46, 0xc00
    v_mul_f32 v237, s38, v237
    v_mul_f32 v238, s38, v238
    v_mfma_f32_16x16x32_bf16 v[200:203], v[156:159], v[174:177], v[200:203]
    s_waitcnt lgkmcnt(4)
    v_mul_f32 v239, s38, v239
    v_cvt_pk_bf16_f32 v178, v236, v237
    v_mfma_f32_16x16x32_bf16 v[204:207], v[162:165], v[174:177], v[204:207]
    v_cvt_pk_bf16_f32 v179, v238, v239
    v_accvgpr_read_b32 v254, a253
    v_mfma_f32_16x16x32_bf16 v[228:231], a[8:11], a[224:227], v[228:231]
    ds_write_b64 v247, v[178:179] offset:256
    v_mfma_f32_16x16x32_bf16 v[208:211], v[110:113], v[176:179], v[208:211]
    buffer_load_dwordx4 v255, s[4:7], s59 offen lds
    v_accvgpr_read_b32 v255, a254
    v_mfma_f32_16x16x32_bf16 v[196:199], v[134:137], v[176:179], v[196:199]
    s_add_u32 m0, s46, 0x1000
    v_max3_f32 v248, v248, v224, v225
    v_mul_f32 v212, v212, v225
    v_mfma_f32_16x16x32_bf16 v[200:203], v[158:161], v[176:179], v[200:203]
    s_mov_b32 s59, 0x1000
    v_mul_f32 v213, v213, v225
    v_mul_f32 v214, v214, v225
    v_mfma_f32_16x16x32_bf16 v[204:207], v[164:167], v[176:179], v[204:207]
    v_mul_f32 v215, v215, v225
    v_cvt_pk_bf16_f32 v212, v212, v213
    v_mfma_f32_16x16x32_bf16 v[228:231], a[12:15], a[228:231], v[228:231]
    v_cvt_pk_bf16_f32 v213, v214, v215
    v_mul_f32 v216, v216, v225
    v_mfma_f32_16x16x32_bf16 v[228:231], a[16:19], a[232:235], v[228:231]
    buffer_load_dwordx4 v254, s[4:7], s50 offen lds
    v_accvgpr_read_b32 v254, a252
    v_mfma_f32_16x16x32_bf16 v[228:231], a[20:23], a[236:239], v[228:231]
    ds_write_b64 v251, v[212:213] offset:12288
    v_mfma_f32_16x16x32_bf16 v[232:235], a[28:31], a[220:223], v[232:235]
    s_add_u32 m0, s46, 0x1400
    v_mul_f32 v217, v217, v225
    v_mul_f32 v218, v218, v225
    v_mfma_f32_16x16x32_bf16 v[232:235], a[32:35], a[224:227], v[232:235]
    s_mov_b32 s50, 0x1000
    v_mul_f32 v219, v219, v225
    v_cvt_pk_bf16_f32 v102, v228, v229
    v_mfma_f32_16x16x32_bf16 v[232:235], a[36:39], a[228:231], v[232:235]
    buffer_load_dwordx4 v255, s[4:7], s51 offen lds
    v_cvt_pk_bf16_f32 v103, v230, v231
    v_mfma_f32_16x16x32_bf16 v[232:235], a[40:43], a[232:235], v[232:235]
    s_add_u32 m0, s46, 0x1800
    v_accvgpr_read_b32 v255, a255
    v_cvt_pk_bf16_f32 v216, v216, v217
    v_mfma_f32_16x16x32_bf16 v[232:235], a[44:47], a[236:239], v[232:235]
    s_mov_b32 s51, 0x1000
    v_cvt_pk_bf16_f32 v217, v218, v219
    v_mul_f32 v220, v220, v225
    v_mfma_f32_16x16x32_bf16 v[236:239], a[48:51], a[216:219], 0
    ds_write_b64 v251, v[216:217] offset:12416
    v_mfma_f32_16x16x32_bf16 v[236:239], a[52:55], a[220:223], v[236:239]
    v_mul_f32 v221, v221, v225
    v_mul_f32 v222, v222, v225
    v_mfma_f32_16x16x32_bf16 v[236:239], a[56:59], a[224:227], v[236:239]
    buffer_load_dwordx4 v254, s[4:7], s52 offen lds
    v_cvt_pk_bf16_f32 v104, v232, v233
    v_mfma_f32_16x16x32_bf16 v[236:239], a[60:63], a[228:231], v[236:239]
    s_add_u32 m0, s46, 0x1a00
    v_cvt_pk_bf16_f32 v105, v234, v235
    v_mul_f32 v223, v223, v225
    v_mfma_f32_16x16x32_bf16 v[236:239], a[64:67], a[232:235], v[236:239]
    s_mov_b32 s52, 0x2000
    v_cvt_pk_bf16_f32 v220, v220, v221
    v_cvt_pk_bf16_f32 v221, v222, v223
    v_mfma_f32_16x16x32_bf16 v[236:239], a[68:71], a[236:239], v[236:239]
    ds_write_b64 v251, v[220:221] offset:12544
    v_mfma_f32_16x16x32_bf16 v[228:231], a[216:219], a[72:75], 0
    buffer_load_dwordx4 v255, s[4:7], s53 offen lds
    v_mbcnt_lo_u32_b32 v254, -1, 0
    v_mfma_f32_16x16x32_bf16 v[228:231], a[220:223], a[76:79], v[228:231]
    s_mov_b32 s53, 0x2000
    v_exp_f32 v208, v208
    v_mfma_f32_16x16x32_bf16 v[228:231], a[224:227], a[80:83], v[228:231]
    v_cvt_pk_bf16_f32 v106, v236, v237
    v_cvt_pk_bf16_f32 v107, v238, v239
    v_mfma_f32_16x16x32_bf16 v[228:231], a[228:231], a[84:87], v[228:231]
    v_exp_f32 v209, v209
    v_mfma_f32_16x16x32_bf16 v[228:231], a[232:235], a[88:91], v[228:231]
    v_exp_f32 v210, v210
    v_mfma_f32_16x16x32_bf16 v[228:231], a[236:239], a[92:95], v[228:231]
    v_exp_f32 v211, v211
    v_mfma_f32_16x16x32_bf16 v[232:235], a[216:219], a[96:99], 0
    v_cvt_pk_bf16_f32 v180, v208, v209
    v_cvt_pk_bf16_f32 v183, v210, v211
    v_mfma_f32_16x16x32_bf16 v[232:235], a[220:223], a[100:103], v[232:235]
    ds_read_b128 v[208:211], v245 offset:64
    v_mbcnt_hi_u32_b32 v254, -1, v254
    v_mfma_f32_16x16x32_bf16 v[232:235], a[224:227], a[104:107], v[232:235]
    v_cvt_pk_bf16_f32 v0, v228, v229
    v_cvt_pk_bf16_f32 v3, v230, v231
    v_mfma_f32_16x16x32_bf16 v[232:235], a[228:231], a[108:111], v[232:235]
    s_waitcnt lgkmcnt(1)
    v_exp_f32 v196, v196
    v_mfma_f32_16x16x32_bf16 v[232:235], a[232:235], a[112:115], v[232:235]
    v_exp_f32 v197, v197
    v_mfma_f32_16x16x32_bf16 v[232:235], a[236:239], a[116:119], v[232:235]
    v_exp_f32 v198, v198
    v_mfma_f32_16x16x32_bf16 v[236:239], a[216:219], a[120:123], 0
    ds_read_b128 a[216:219], v242 offset:30848
    v_cvt_pk_bf16_f32 v181, v196, v197
    v_mfma_f32_16x16x32_bf16 v[236:239], a[220:223], a[124:127], v[236:239]
    ds_read_b128 a[220:223], v243 offset:30848
    v_lshl_add_u32 v254, v254, 4, s66
    v_mfma_f32_16x16x32_bf16 v[236:239], a[224:227], a[128:131], v[236:239]
    ds_read_b128 a[224:227], v242 offset:30976
    v_cvt_pk_bf16_f32 v30, v232, v233
    v_mfma_f32_16x16x32_bf16 v[236:239], a[228:231], a[132:135], v[236:239]
    ds_read_b128 a[228:231], v243 offset:30976
    v_cvt_pk_bf16_f32 v33, v234, v235
    v_mfma_f32_16x16x32_bf16 v[236:239], a[232:235], a[136:139], v[236:239]
    ds_read_b128 a[232:235], v242 offset:32256
    s_lshl_b32 s66, s28, 1
    v_mfma_f32_16x16x32_bf16 v[236:239], a[236:239], a[140:143], v[236:239]
    ds_read_b128 a[236:239], v243 offset:32256
    s_waitcnt lgkmcnt(6)
    v_mfma_f32_16x16x32_bf16 v[208:211], v[90:93], v[174:177], v[208:211]
    v_exp_f32 v199, v199
    v_mfma_f32_16x16x32_bf16 v[208:211], v[92:95], v[176:179], v[208:211]
    v_exp_f32 v200, v200
    v_mfma_f32_16x16x32_bf16 v[228:231], a[144:147], a[240:243], 0
    v_exp_f32 v201, v201
    v_mfma_f32_16x16x32_bf16 v[228:231], a[148:151], a[244:247], v[228:231]
    s_waitcnt lgkmcnt(5)
    v_cvt_pk_bf16_f32 v60, v236, v237
    v_cvt_pk_bf16_f32 v63, v238, v239
    v_mfma_f32_16x16x32_bf16 v[228:231], a[152:155], a[216:219], v[228:231]
    s_waitcnt lgkmcnt(4)
    v_cvt_pk_bf16_f32 v184, v198, v199
    v_cvt_pk_bf16_f32 v182, v200, v201
    v_mfma_f32_16x16x32_bf16 v[228:231], a[156:159], a[220:223], v[228:231]
    ds_read_b128 v[196:199], v246 offset:64
    s_waitcnt lgkmcnt(3)
    v_mfma_f32_16x16x32_bf16 v[212:215], v[18:21], v[180:183], 0
    v_exp_f32 v202, v202
    v_mfma_f32_16x16x32_bf16 v[216:219], v[48:51], v[180:183], 0
    v_exp_f32 v203, v203
    v_mfma_f32_16x16x32_bf16 v[220:223], v[78:81], v[180:183], 0
    v_exp_f32 v204, v204
    v_mfma_f32_16x16x32_bf16 v[224:227], a[248:251], v[180:183], 0
    v_exp_f32 v205, v205
    v_mfma_f32_16x16x32_bf16 v[228:231], a[160:163], a[224:227], v[228:231]
    v_cvt_pk_bf16_f32 v185, v202, v203
    v_cvt_pk_bf16_f32 v186, v204, v205
    v_mfma_f32_16x16x32_bf16 v[228:231], a[164:167], a[228:231], v[228:231]
    v_exp_f32 v206, v206
    v_mfma_f32_16x16x32_bf16 v[232:235], a[168:171], a[240:243], 0
    v_exp_f32 v207, v207
    v_mfma_f32_16x16x32_bf16 v[232:235], a[172:175], a[244:247], v[232:235]
    v_cvt_pk_bf16_f32 v189, v206, v207
    v_mbcnt_lo_u32_b32 v204, -1, 0
    v_mfma_f32_16x16x32_bf16 v[232:235], a[176:179], a[216:219], v[232:235]
    s_waitcnt lgkmcnt(0)
    v_mul_f32 v228, s38, v228
    v_mul_f32 v229, s38, v229
    v_mfma_f32_16x16x32_bf16 v[196:199], v[96:99], v[174:177], v[196:199]
    v_mul_f32 v230, s38, v230
    v_mul_f32 v231, s38, v231
    v_mfma_f32_16x16x32_bf16 v[196:199], v[98:101], v[176:179], v[196:199]
    v_cvt_pk_bf16_f32 v168, v228, v229
    v_cvt_pk_bf16_f32 v169, v230, v231
    v_mfma_f32_16x16x32_bf16 v[232:235], a[180:183], a[220:223], v[232:235]
    v_exp_f32 v208, v208
    v_mfma_f32_16x16x32_bf16 v[232:235], a[184:187], a[224:227], v[232:235]
    v_exp_f32 v209, v209
    v_mfma_f32_16x16x32_bf16 v[232:235], a[188:191], a[228:231], v[232:235]
    v_exp_f32 v210, v210
    v_mfma_f32_16x16x32_bf16 v[236:239], a[192:195], a[240:243], 0
    ds_read_b128 a[240:243], v242 offset:32384
    v_cvt_pk_bf16_f32 v187, v208, v209
    v_mfma_f32_16x16x32_bf16 v[236:239], a[196:199], a[244:247], v[236:239]
    ds_read_b128 a[244:247], v243 offset:32384
    v_mbcnt_hi_u32_b32 v204, -1, v204
    v_mfma_f32_16x16x32_bf16 v[212:215], v[22:25], v[184:187], v[212:215]
    v_mul_f32 v232, s3, v232
    v_mul_f32 v233, s3, v233
    v_mfma_f32_16x16x32_bf16 v[216:219], v[52:55], v[184:187], v[216:219]
    v_mul_f32 v234, s3, v234
    v_mul_f32 v235, s3, v235
    v_mfma_f32_16x16x32_bf16 v[220:223], v[82:85], v[184:187], v[220:223]
    v_cvt_pk_bf16_f32 v170, v232, v233
    v_cvt_pk_bf16_f32 v171, v234, v235
    v_mfma_f32_16x16x32_bf16 v[224:227], a[248:251], v[184:187], v[224:227]
    v_exp_f32 v211, v211
    v_mfma_f32_16x16x32_bf16 v[236:239], a[200:203], a[216:219], v[236:239]
    ds_read_b128 a[216:219], v242 offset:32512
    v_cvt_pk_bf16_f32 v190, v210, v211
    v_mfma_f32_16x16x32_bf16 v[236:239], a[204:207], a[220:223], v[236:239]
    ds_read_b128 a[220:223], v243 offset:32512
    v_bfe_u32 v200, v204, 2, 2
    v_mfma_f32_16x16x32_bf16 v[236:239], a[208:211], a[224:227], v[236:239]
    ds_read_b128 a[224:227], v242 offset:33792
    v_and_b32 v201, 3, v204
    v_mfma_f32_16x16x32_bf16 v[236:239], a[212:215], a[228:231], v[236:239]
    ds_read_b128 a[228:231], v243 offset:33792
    v_lshrrev_b32 v204, 4, v204
    v_mfma_f32_16x16x32_bf16 v[228:231], a[144:147], a[232:235], 0
    v_exp_f32 v196, v196
    v_mfma_f32_16x16x32_bf16 v[228:231], a[148:151], a[236:239], v[228:231]
    s_waitcnt lgkmcnt(4)
    v_exp_f32 v197, v197
    v_mfma_f32_16x16x32_bf16 v[228:231], a[152:155], a[240:243], v[228:231]
    v_mul_f32 v236, s38, v236
    v_mul_f32 v237, s38, v237
    v_mfma_f32_16x16x32_bf16 v[228:231], a[156:159], a[244:247], v[228:231]
    v_mul_f32 v238, s38, v238
    v_mul_f32 v239, s38, v239
    v_mfma_f32_16x16x32_bf16 v[232:235], a[168:171], a[232:235], 0
    v_cvt_pk_bf16_f32 v172, v236, v237
    v_cvt_pk_bf16_f32 v173, v238, v239
    v_mfma_f32_16x16x32_bf16 v[232:235], a[172:175], a[236:239], v[232:235]
    s_waitcnt lgkmcnt(3)
    v_exp_f32 v198, v198
    v_mfma_f32_16x16x32_bf16 v[228:231], a[160:163], a[216:219], v[228:231]
    s_waitcnt lgkmcnt(2)
    v_exp_f32 v199, v199
    v_mfma_f32_16x16x32_bf16 v[228:231], a[164:167], a[220:223], v[228:231]
    v_cvt_pk_bf16_f32 v188, v196, v197
    v_cvt_pk_bf16_f32 v191, v198, v199
    v_mfma_f32_16x16x32_bf16 v[232:235], a[176:179], a[240:243], v[232:235]
    v_sub_u32 v202, v204, v200
    v_mul_i32_i24 v202, 0x1c0, v202
    v_mfma_f32_16x16x32_bf16 v[212:215], v[26:29], v[188:191], v[212:215]
    v_lshlrev_b32 v203, 4, v201
    v_sub_u32 v202, v202, v203
    v_mfma_f32_16x16x32_bf16 v[216:219], v[56:59], v[188:191], v[216:219]
    v_mul_f32 v228, s38, v228
    v_mul_f32 v229, s38, v229
    v_mfma_f32_16x16x32_bf16 v[220:223], v[86:89], v[188:191], v[220:223]
    v_mul_f32 v230, s38, v230
    v_mul_f32 v231, s38, v231
    v_mfma_f32_16x16x32_bf16 v[224:227], a[248:251], v[188:191], v[224:227]
    v_cvt_pk_bf16_f32 v228, v228, v229
    v_cvt_pk_bf16_f32 v229, v230, v231
    v_mfma_f32_16x16x32_bf16 v[232:235], a[180:183], a[244:247], v[232:235]
    ds_write_b64 v247, v[228:229] offset:12288
    v_mfma_f32_16x16x32_bf16 v[232:235], a[184:187], a[216:219], v[232:235]
    s_waitcnt lgkmcnt(1)
    v_add_u32 v202, s37, v202
    v_sub_u32 v203, v204, v200
    v_mfma_f32_16x16x32_bf16 v[232:235], a[188:191], a[220:223], v[232:235]
    v_rcp_f32 v225, v224
    v_mfma_f32_16x16x32_bf16 v[236:239], a[192:195], a[232:235], 0
    ds_read_b128 a[232:235], v242 offset:33920
    v_max3_f32 v248, v248, v224, v225
    v_mfma_f32_16x16x32_bf16 v[236:239], a[196:199], a[236:239], v[236:239]
    ds_read_b128 a[236:239], v243 offset:33920
    v_mbcnt_lo_u32_b32 v226, -1, 0
    v_mfma_f32_16x16x32_bf16 v[236:239], a[200:203], a[240:243], v[236:239]
    ds_read_b128 a[240:243], v242 offset:34048
    v_mul_f32 v232, s3, v232
    v_mfma_f32_16x16x32_bf16 v[236:239], a[204:207], a[244:247], v[236:239]
    ds_read_b128 a[244:247], v243 offset:34048
    v_mul_f32 v233, s3, v233
    v_mfma_f32_16x16x32_bf16 v[236:239], a[208:211], a[216:219], v[236:239]
    ds_read_b128 a[216:219], v240 offset:32256
    v_mul_f32 v234, s3, v234
    v_mfma_f32_16x16x32_bf16 v[236:239], a[212:215], a[220:223], v[236:239]
    ds_read_b128 a[220:223], v241 offset:32256
    v_mul_f32 v235, s3, v235
    v_mfma_f32_16x16x32_bf16 v[228:231], a[144:147], a[224:227], 0
    v_cvt_pk_bf16_f32 v232, v232, v233
    v_cvt_pk_bf16_f32 v233, v234, v235
    v_mfma_f32_16x16x32_bf16 v[228:231], a[148:151], a[228:231], v[228:231]
    ds_write_b64 v247, v[232:233] offset:12416
    v_mfma_f32_16x16x32_bf16 v[232:235], a[168:171], a[224:227], 0
    s_waitcnt lgkmcnt(6)
    v_mul_f32 v236, s38, v236
    v_mul_f32 v237, s38, v237
    v_mfma_f32_16x16x32_bf16 v[228:231], a[152:155], a[232:235], v[228:231]
    s_waitcnt lgkmcnt(5)
    v_mul_f32 v238, s38, v238
    v_mul_f32 v239, s38, v239
    v_mfma_f32_16x16x32_bf16 v[228:231], a[156:159], a[236:239], v[228:231]
    s_waitcnt lgkmcnt(4)
    v_cvt_pk_bf16_f32 v236, v236, v237
    v_cvt_pk_bf16_f32 v237, v238, v239
    v_mfma_f32_16x16x32_bf16 v[228:231], a[160:163], a[240:243], v[228:231]
    ds_write_b64 v247, v[236:237] offset:12544
    v_mfma_f32_16x16x32_bf16 v[232:235], a[172:175], a[228:231], v[232:235]
    ds_read_b64 v[174:175], v247 offset:12288
    v_mbcnt_hi_u32_b32 v226, -1, v226
    v_mfma_f32_16x16x32_bf16 v[232:235], a[176:179], a[232:235], v[232:235]
    ds_read_b64 v[176:177], v247 offset:12416
    v_and_b32 v226, 2, v226
    v_mfma_f32_16x16x32_bf16 v[232:235], a[180:183], a[236:239], v[232:235]
    ds_read_b64 v[178:179], v247 offset:12544
    v_cmp_eq_u32 vcc, 0, v226
    v_mfma_f32_16x16x32_bf16 v[232:235], a[184:187], a[240:243], v[232:235]
    s_waitcnt lgkmcnt(4)
    v_add_u32 v226, 0xfffdd200, v247
    v_cndmask_b32 v226, 0, v226, vcc
    v_mfma_f32_16x16x32_bf16 v[228:231], a[164:167], a[244:247], v[228:231]
    s_barrier
    v_add_u32 v226, 0x22e00, v226
    v_mul_f32 v212, v212, v225
    v_mfma_f32_16x16x32_bf16 v[232:235], a[188:191], a[244:247], v[232:235]
    v_mul_f32 v213, v213, v225
    v_mul_f32 v214, v214, v225
    v_mfma_f32_16x16x32_bf16 v[236:239], a[192:195], a[224:227], 0
    ds_read_b128 a[224:227], v240 offset:32384
    v_mul_f32 v228, s38, v228
    v_mfma_f32_16x16x32_bf16 v[236:239], a[196:199], a[228:231], v[236:239]
    ds_read_b128 a[228:231], v241 offset:32384
    v_mul_f32 v229, s38, v229
    v_mfma_f32_16x16x32_bf16 v[236:239], a[200:203], a[232:235], v[236:239]
    ds_read_b128 a[232:235], v240 offset:32512
    v_mul_f32 v230, s38, v230
    v_mfma_f32_16x16x32_bf16 v[236:239], a[204:207], a[236:239], v[236:239]
    ds_read_b128 a[236:239], v241 offset:32512
    v_mul_f32 v231, s38, v231
    v_mfma_f32_16x16x32_bf16 v[236:239], a[208:211], a[240:243], v[236:239]
    ds_read_b128 a[240:243], v240 offset:33792
    v_cvt_pk_bf16_f32 v228, v228, v229
    v_mfma_f32_16x16x32_bf16 v[236:239], a[212:215], a[244:247], v[236:239]
    ds_read_b128 a[244:247], v241 offset:33792
    v_cvt_pk_bf16_f32 v229, v230, v231
    ds_write_b64 v247, v[228:229] offset:18432
    v_mfma_f32_16x16x32_bf16 v[228:231], a[0:3], a[216:219], 0
    v_mul_f32 v232, s3, v232
    v_mul_f32 v233, s3, v233
    v_mfma_f32_16x16x32_bf16 v[228:231], a[4:7], a[220:223], v[228:231]
    s_waitcnt lgkmcnt(6)
    v_mul_f32 v234, s3, v234
    v_mul_f32 v235, s3, v235
    v_mfma_f32_16x16x32_bf16 v[228:231], a[8:11], a[224:227], v[228:231]
    s_waitcnt lgkmcnt(5)
    v_cvt_pk_bf16_f32 v232, v232, v233
    v_cvt_pk_bf16_f32 v233, v234, v235
    v_mfma_f32_16x16x32_bf16 v[228:231], a[12:15], a[228:231], v[228:231]
    s_waitcnt lgkmcnt(4)
    v_mul_f32 v236, s38, v236
    v_mul_f32 v237, s38, v237
    v_mfma_f32_16x16x32_bf16 v[228:231], a[16:19], a[232:235], v[228:231]
    s_waitcnt lgkmcnt(3)
    v_mul_f32 v238, s38, v238
    v_mul_f32 v239, s38, v239
    v_mfma_f32_16x16x32_bf16 v[228:231], a[20:23], a[236:239], v[228:231]
    ds_write_b64 v247, v[232:233] offset:18560
    v_mfma_f32_16x16x32_bf16 v[232:235], a[24:27], a[216:219], 0
    v_cvt_pk_bf16_f32 v236, v236, v237
    v_cvt_pk_bf16_f32 v237, v238, v239
    v_mfma_f32_16x16x32_bf16 v[232:235], a[28:31], a[220:223], v[232:235]
    ds_write_b64 v247, v[236:237] offset:18688
    v_mfma_f32_16x16x32_bf16 v[232:235], a[32:35], a[224:227], v[232:235]
    v_mul_f32 v215, v215, v225
    v_cvt_pk_bf16_f32 v108, v228, v229
    v_mfma_f32_16x16x32_bf16 v[232:235], a[36:39], a[228:231], v[232:235]
    v_cvt_pk_bf16_f32 v109, v230, v231
    v_cvt_pk_bf16_f32 v212, v212, v213
    v_mfma_f32_16x16x32_bf16 v[232:235], a[40:43], a[232:235], v[232:235]
    v_cvt_pk_bf16_f32 v213, v214, v215
    v_mul_f32 v216, v216, v225
    v_mfma_f32_16x16x32_bf16 v[232:235], a[44:47], a[236:239], v[232:235]
    ds_write_b64 v226, v[212:213] offset:0
    v_mfma_f32_16x16x32_bf16 v[236:239], a[48:51], a[216:219], 0
    v_mul_f32 v217, v217, v225
    v_mul_f32 v218, v218, v225
    v_mfma_f32_16x16x32_bf16 v[236:239], a[52:55], a[220:223], v[236:239]
    v_mul_f32 v219, v219, v225
    v_cvt_pk_bf16_f32 v216, v216, v217
    v_mfma_f32_16x16x32_bf16 v[236:239], a[56:59], a[224:227], v[236:239]
    v_cvt_pk_bf16_f32 v110, v232, v233
    v_cvt_pk_bf16_f32 v111, v234, v235
    v_mfma_f32_16x16x32_bf16 v[236:239], a[60:63], a[228:231], v[236:239]
    v_cvt_pk_bf16_f32 v217, v218, v219
    v_mul_f32 v220, v220, v225
    v_mfma_f32_16x16x32_bf16 v[236:239], a[64:67], a[232:235], v[236:239]
    ds_write_b64 v226, v[216:217] offset:128
    v_mfma_f32_16x16x32_bf16 v[236:239], a[68:71], a[236:239], v[236:239]
    v_mul_f32 v221, v221, v225
    v_mul_f32 v222, v222, v225
    v_mfma_f32_16x16x32_bf16 v[228:231], a[216:219], a[72:75], 0
    v_mul_f32 v223, v223, v225
    v_cvt_pk_bf16_f32 v220, v220, v221
    v_mfma_f32_16x16x32_bf16 v[228:231], a[220:223], a[76:79], v[228:231]
    v_cvt_pk_bf16_f32 v221, v222, v223
    v_add_u32 v244, 0, v203
    v_mfma_f32_16x16x32_bf16 v[228:231], a[224:227], a[80:83], v[228:231]
    ds_write_b64 v226, v[220:221] offset:256
    v_mfma_f32_16x16x32_bf16 v[228:231], a[228:231], a[84:87], v[228:231]
    v_cvt_pk_bf16_f32 v112, v236, v237
    v_cvt_pk_bf16_f32 v113, v238, v239
    v_mfma_f32_16x16x32_bf16 v[228:231], a[232:235], a[88:91], v[228:231]
    v_cmp_gt_u32 vcc, 7, v244
    v_add_u32 v244, 0xfffdc870, v202
    v_mfma_f32_16x16x32_bf16 v[228:231], a[236:239], a[92:95], v[228:231]
    v_cndmask_b32 v244, 0, v244, vcc
    v_add_u32 v244, 0x237c0, v244
    v_mfma_f32_16x16x32_bf16 v[232:235], a[216:219], a[96:99], 0
    ds_read_b128 v[196:199], v244 offset:256
    v_add_u32 v245, 4, v203
    v_mfma_f32_16x16x32_bf16 v[232:235], a[220:223], a[100:103], v[232:235]
    v_cmp_gt_u32 vcc, 7, v245
    v_add_u32 v245, 0xfffdcf70, v202
    v_mfma_f32_16x16x32_bf16 v[232:235], a[224:227], a[104:107], v[232:235]
    v_cvt_pk_bf16_f32 v6, v228, v229
    v_cvt_pk_bf16_f32 v9, v230, v231
    v_mfma_f32_16x16x32_bf16 v[232:235], a[228:231], a[108:111], v[232:235]
    s_waitcnt lgkmcnt(2)
    v_cndmask_b32 v245, 0, v245, vcc
    v_add_u32 v245, 0x237c0, v245
    v_mfma_f32_16x16x32_bf16 v[232:235], a[232:235], a[112:115], v[232:235]
    ds_read_b128 v[204:207], v245 offset:192
    v_add_u32 v246, 8, v203
    v_mfma_f32_16x16x32_bf16 v[232:235], a[236:239], a[116:119], v[232:235]
    v_cmp_gt_u32 vcc, 7, v246
    v_add_u32 v246, 0xfffdd670, v202
    v_mfma_f32_16x16x32_bf16 v[236:239], a[216:219], a[120:123], 0
    ds_read_b128 a[216:219], v240 offset:33920
    v_cndmask_b32 v246, 0, v246, vcc
    v_mfma_f32_16x16x32_bf16 v[236:239], a[220:223], a[124:127], v[236:239]
    ds_read_b128 a[220:223], v241 offset:33920
    v_add_u32 v246, 0x237c0, v246
    v_mfma_f32_16x16x32_bf16 v[236:239], a[224:227], a[128:131], v[236:239]
    ds_read_b128 a[224:227], v240 offset:34048
    v_cvt_pk_bf16_f32 v36, v232, v233
    v_mfma_f32_16x16x32_bf16 v[236:239], a[228:231], a[132:135], v[236:239]
    ds_read_b128 a[228:231], v241 offset:34048
    v_cvt_pk_bf16_f32 v39, v234, v235
    v_mfma_f32_16x16x32_bf16 v[236:239], a[232:235], a[136:139], v[236:239]
    ds_read_b128 a[232:235], v242 offset:61440
    v_mov_b32 v191, 0
    v_mfma_f32_16x16x32_bf16 v[236:239], a[236:239], a[140:143], v[236:239]
    ds_read_b128 a[236:239], v243 offset:61440
    s_waitcnt lgkmcnt(7)
    v_mfma_f32_16x16x32_bf16 v[196:199], v[120:123], v[168:171], v[196:199]
    ds_read_b128 v[200:203], v244 offset:192
    s_waitcnt lgkmcnt(7)
    v_mfma_f32_16x16x32_bf16 v[204:207], v[138:141], v[168:171], v[204:207]
    ds_read_b128 v[208:211], v246 offset:192
    v_mfma_f32_16x16x32_bf16 v[204:207], v[140:143], v[170:173], v[204:207]
    v_cvt_pk_bf16_f32 v66, v236, v237
    v_cvt_pk_bf16_f32 v69, v238, v239
    v_mfma_f32_16x16x32_bf16 v[196:199], v[122:125], v[170:173], v[196:199]
    v_mfma_f32_16x16x32_bf16 v[228:231], a[0:3], a[240:243], 0
    v_mfma_f32_16x16x32_bf16 v[228:231], a[4:7], a[244:247], v[228:231]
    s_waitcnt lgkmcnt(5)
    v_mfma_f32_16x16x32_bf16 v[228:231], a[8:11], a[216:219], v[228:231]
    v_mfma_f32_16x16x32_bf16 v[228:231], a[12:15], a[220:223], v[228:231]
    v_exp_f32 v204, v204
    v_mfma_f32_16x16x32_bf16 v[228:231], a[16:19], a[224:227], v[228:231]
    s_waitcnt lgkmcnt(2)
    v_exp_f32 v205, v205
    v_mfma_f32_16x16x32_bf16 v[228:231], a[20:23], a[228:231], v[228:231]
    s_waitcnt lgkmcnt(1)
    v_exp_f32 v206, v206
    v_mfma_f32_16x16x32_bf16 v[200:203], v[114:117], v[168:171], v[200:203]
    s_waitcnt lgkmcnt(0)
    v_exp_f32 v207, v207
    v_mfma_f32_16x16x32_bf16 v[200:203], v[116:119], v[170:173], v[200:203]
    v_cvt_pk_bf16_f32 v194, v204, v205
    v_cvt_pk_bf16_f32 v181, v206, v207
    v_mfma_f32_16x16x32_bf16 v[208:211], v[102:105], v[168:171], v[208:211]
    ds_read_b128 v[204:207], v246 offset:256
    v_cvt_pk_bf16_f32 v162, v228, v229
    v_mfma_f32_16x16x32_bf16 v[208:211], v[104:107], v[170:173], v[208:211]
    v_cvt_pk_bf16_f32 v163, v230, v231
    v_mfma_f32_16x16x32_bf16 v[232:235], a[24:27], a[240:243], 0
    v_exp_f32 v200, v200
    v_mfma_f32_16x16x32_bf16 v[232:235], a[28:31], a[244:247], v[232:235]
    v_exp_f32 v201, v201
    v_mfma_f32_16x16x32_bf16 v[232:235], a[32:35], a[216:219], v[232:235]
    v_exp_f32 v202, v202
    v_mfma_f32_16x16x32_bf16 v[232:235], a[36:39], a[220:223], v[232:235]
    v_exp_f32 v203, v203
    v_mfma_f32_16x16x32_bf16 v[232:235], a[40:43], a[224:227], v[232:235]
    v_cvt_pk_bf16_f32 v193, v200, v201
    v_cvt_pk_bf16_f32 v180, v202, v203
    v_mfma_f32_16x16x32_bf16 v[232:235], a[44:47], a[228:231], v[232:235]
    ds_read_b128 v[200:203], v245 offset:256
    v_mfma_f32_16x16x32_bf16 v[236:239], a[48:51], a[240:243], 0
    v_exp_f32 v208, v208
    v_mfma_f32_16x16x32_bf16 v[236:239], a[52:55], a[244:247], v[236:239]
    s_waitcnt lgkmcnt(1)
    v_exp_f32 v209, v209
    v_mfma_f32_16x16x32_bf16 v[204:207], v[108:111], v[168:171], v[204:207]
    v_exp_f32 v210, v210
    v_mfma_f32_16x16x32_bf16 v[204:207], v[110:113], v[170:173], v[204:207]
    v_cvt_pk_bf16_f32 v164, v232, v233
    v_cvt_pk_bf16_f32 v165, v234, v235
    v_mfma_f32_16x16x32_bf16 v[236:239], a[56:59], a[216:219], v[236:239]
    v_exp_f32 v211, v211
    v_mfma_f32_16x16x32_bf16 v[236:239], a[60:63], a[220:223], v[236:239]
    v_cvt_pk_bf16_f32 v192, v208, v209
    v_cvt_pk_bf16_f32 v195, v210, v211
    v_mfma_f32_16x16x32_bf16 v[236:239], a[64:67], a[224:227], v[236:239]
    ds_read_b128 v[208:211], v244 offset:320
    v_mfma_f32_16x16x32_bf16 v[212:215], v[0:3], v[192:195], 0
    v_exp_f32 v196, v196
    v_mfma_f32_16x16x32_bf16 v[216:219], v[30:33], v[192:195], 0
    s_waitcnt lgkmcnt(1)
    v_exp_f32 v197, v197
    v_mfma_f32_16x16x32_bf16 v[220:223], v[60:63], v[192:195], 0
    v_exp_f32 v198, v198
    v_mfma_f32_16x16x32_bf16 v[224:227], a[248:251], v[192:195], 0
    v_exp_f32 v199, v199
    v_mfma_f32_16x16x32_bf16 v[200:203], v[144:147], v[168:171], v[200:203]
    v_cvt_pk_bf16_f32 v183, v196, v197
    v_cvt_pk_bf16_f32 v186, v198, v199
    v_mfma_f32_16x16x32_bf16 v[200:203], v[146:149], v[170:173], v[200:203]
    ds_read_b128 v[196:199], v245 offset:320
    v_mfma_f32_16x16x32_bf16 v[236:239], a[68:71], a[228:231], v[236:239]
    v_exp_f32 v204, v204
    v_mfma_f32_16x16x32_bf16 v[228:231], a[240:243], a[72:75], 0
    v_exp_f32 v205, v205
    v_mfma_f32_16x16x32_bf16 v[228:231], a[244:247], a[76:79], v[228:231]
    s_waitcnt lgkmcnt(1)
    v_exp_f32 v206, v206
    v_mfma_f32_16x16x32_bf16 v[208:211], v[126:129], v[168:171], v[208:211]
    v_exp_f32 v200, v200
    v_mfma_f32_16x16x32_bf16 v[208:211], v[128:131], v[170:173], v[208:211]
    v_cvt_pk_bf16_f32 v166, v236, v237
    v_cvt_pk_bf16_f32 v167, v238, v239
    v_mfma_f32_16x16x32_bf16 v[228:231], a[216:219], a[80:83], v[228:231]
    v_exp_f32 v201, v201
    v_mfma_f32_16x16x32_bf16 v[228:231], a[220:223], a[84:87], v[228:231]
    v_exp_f32 v202, v202
    v_mfma_f32_16x16x32_bf16 v[228:231], a[224:227], a[88:91], v[228:231]
    v_exp_f32 v203, v203
    v_mfma_f32_16x16x32_bf16 v[228:231], a[228:231], a[92:95], v[228:231]
    s_waitcnt lgkmcnt(0)
    v_cvt_pk_bf16_f32 v184, v200, v201
    v_cvt_pk_bf16_f32 v187, v202, v203
    v_mfma_f32_16x16x32_bf16 v[196:199], v[150:153], v[168:171], v[196:199]
    ds_read_b128 v[200:203], v246 offset:320
    v_cvt_pk_bf16_f32 v182, v204, v205
    v_mfma_f32_16x16x32_bf16 v[196:199], v[152:155], v[170:173], v[196:199]
    v_exp_f32 v207, v207
    v_mfma_f32_16x16x32_bf16 v[212:215], v[4:7], v[180:183], v[212:215]
    v_cvt_pk_bf16_f32 v12, v228, v229
    v_cvt_pk_bf16_f32 v15, v230, v231
    v_mfma_f32_16x16x32_bf16 v[216:219], v[34:37], v[180:183], v[216:219]
    v_exp_f32 v208, v208
    v_mfma_f32_16x16x32_bf16 v[220:223], v[64:67], v[180:183], v[220:223]
    v_exp_f32 v209, v209
    v_mfma_f32_16x16x32_bf16 v[224:227], a[248:251], v[180:183], v[224:227]
    v_cvt_pk_bf16_f32 v185, v206, v207
    v_cvt_pk_bf16_f32 v189, v208, v209
    v_mfma_f32_16x16x32_bf16 v[232:235], a[240:243], a[96:99], 0
    ds_read_b128 v[204:207], v244 offset:0
    v_mfma_f32_16x16x32_bf16 v[212:215], v[8:11], v[184:187], v[212:215]
    ds_read_b128 v[208:211], v245 offset:0
    v_mfma_f32_16x16x32_bf16 v[216:219], v[38:41], v[184:187], v[216:219]
    v_exp_f32 v196, v196
    v_mfma_f32_16x16x32_bf16 v[220:223], v[68:71], v[184:187], v[220:223]
    s_waitcnt lgkmcnt(2)
    v_exp_f32 v197, v197
    v_mfma_f32_16x16x32_bf16 v[224:227], a[248:251], v[184:187], v[224:227]
    v_cvt_pk_bf16_f32 v190, v196, v197
    v_mfma_f32_16x16x32_bf16 v[200:203], v[162:165], v[168:171], v[200:203]
    ds_read_b128 v[196:199], v246 offset:0
    v_mfma_f32_16x16x32_bf16 v[200:203], v[164:167], v[170:173], v[200:203]
    ds_read_b64 v[168:169], v247 offset:18432
    v_mfma_f32_16x16x32_bf16 v[232:235], a[244:247], a[100:103], v[232:235]
    ds_read_b64 v[170:171], v247 offset:18560
    v_mfma_f32_16x16x32_bf16 v[232:235], a[216:219], a[104:107], v[232:235]
    ds_read_b64 v[172:173], v247 offset:18688
    s_waitcnt lgkmcnt(5)
    v_mfma_f32_16x16x32_bf16 v[204:207], v[120:123], v[174:177], v[204:207]
    v_mfma_f32_16x16x32_bf16 v[204:207], v[122:125], v[176:179], v[204:207]
    s_waitcnt lgkmcnt(4)
    v_exp_f32 v200, v200
    v_mfma_f32_16x16x32_bf16 v[208:211], v[144:147], v[174:177], v[208:211]
    v_exp_f32 v201, v201
    v_mfma_f32_16x16x32_bf16 v[208:211], v[146:149], v[176:179], v[208:211]
    v_cvt_pk_bf16_f32 v188, v200, v201
    v_mfma_f32_16x16x32_bf16 v[232:235], a[220:223], a[108:111], v[232:235]
    ds_read_b128 v[200:203], v244 offset:64
    s_waitcnt lgkmcnt(4)
    v_mfma_f32_16x16x32_bf16 v[212:215], v[12:15], v[188:191], v[212:215]
    v_exp_f32 v204, v204
    v_mfma_f32_16x16x32_bf16 v[224:227], a[248:251], v[188:191], v[224:227]
    v_exp_f32 v205, v205
    v_mfma_f32_16x16x32_bf16 v[196:199], v[108:111], v[174:177], v[196:199]
    v_exp_f32 v206, v206
    v_mfma_f32_16x16x32_bf16 v[196:199], v[110:113], v[176:179], v[196:199]
    v_exp_f32 v207, v207
    v_mfma_f32_16x16x32_bf16 v[232:235], a[224:227], a[112:115], v[232:235]
    v_cvt_pk_bf16_f32 v193, v204, v205
    v_cvt_pk_bf16_f32 v180, v206, v207
    v_mfma_f32_16x16x32_bf16 v[232:235], a[228:231], a[116:119], v[232:235]
    ds_read_b128 v[204:207], v245 offset:64
    v_mfma_f32_16x16x32_bf16 v[236:239], a[240:243], a[120:123], 0
    ds_read_b128 a[240:243], v242 offset:61568
    v_mfma_f32_16x16x32_bf16 v[236:239], a[244:247], a[124:127], v[236:239]
    ds_read_b128 a[244:247], v243 offset:61568
    s_waitcnt lgkmcnt(3)
    v_mfma_f32_16x16x32_bf16 v[200:203], v[126:129], v[174:177], v[200:203]
    v_rcp_f32 v225, v224
    v_mfma_f32_16x16x32_bf16 v[200:203], v[128:131], v[176:179], v[200:203]
    v_cvt_pk_bf16_f32 v42, v232, v233
    v_cvt_pk_bf16_f32 v45, v234, v235
    v_mfma_f32_16x16x32_bf16 v[236:239], a[216:219], a[128:131], v[236:239]
    ds_read_b128 a[216:219], v242 offset:61696
    v_max3_f32 v248, v248, v224, v225
    v_mfma_f32_16x16x32_bf16 v[216:219], v[42:45], v[188:191], v[216:219]
    v_mul_f32 v212, v212, v225
    v_mul_f32 v213, v213, v225
    v_mfma_f32_16x16x32_bf16 v[236:239], a[220:223], a[132:135], v[236:239]
    ds_read_b128 a[220:223], v243 offset:61696
    v_mul_f32 v214, v214, v225
    v_mfma_f32_16x16x32_bf16 v[236:239], a[224:227], a[136:139], v[236:239]
    ds_read_b128 a[224:227], v242 offset:62976
    v_mul_f32 v215, v215, v225
    v_mfma_f32_16x16x32_bf16 v[236:239], a[228:231], a[140:143], v[236:239]
    ds_read_b128 a[228:231], v243 offset:62976
    v_cvt_pk_bf16_f32 v212, v212, v213
    v_mfma_f32_16x16x32_bf16 v[228:231], a[144:147], a[232:235], 0
    s_waitcnt lgkmcnt(5)
    v_cvt_pk_bf16_f32 v213, v214, v215
    v_mul_f32 v216, v216, v225
    v_mfma_f32_16x16x32_bf16 v[204:207], v[150:153], v[174:177], v[204:207]
    ds_write_b64 v247, v[212:213] offset:6144
    v_mfma_f32_16x16x32_bf16 v[204:207], v[152:155], v[176:179], v[204:207]
    v_cvt_pk_bf16_f32 v72, v236, v237
    v_cvt_pk_bf16_f32 v75, v238, v239
    v_mfma_f32_16x16x32_bf16 v[228:231], a[148:151], a[236:239], v[228:231]
    v_mul_f32 v217, v217, v225
    v_mul_f32 v218, v218, v225
    v_mfma_f32_16x16x32_bf16 v[220:223], v[72:75], v[188:191], v[220:223]
    v_mul_f32 v219, v219, v225
    v_cvt_pk_bf16_f32 v216, v216, v217
    v_mfma_f32_16x16x32_bf16 v[228:231], a[152:155], a[240:243], v[228:231]
    s_waitcnt lgkmcnt(3)
    v_exp_f32 v208, v208
    v_mfma_f32_16x16x32_bf16 v[228:231], a[156:159], a[244:247], v[228:231]
    v_exp_f32 v209, v209
    v_mfma_f32_16x16x32_bf16 v[228:231], a[160:163], a[216:219], v[228:231]
    v_cvt_pk_bf16_f32 v217, v218, v219
    v_mul_f32 v220, v220, v225
    v_mfma_f32_16x16x32_bf16 v[228:231], a[164:167], a[220:223], v[228:231]
    ds_write_b64 v247, v[216:217] offset:6272
    v_mfma_f32_16x16x32_bf16 v[232:235], a[168:171], a[232:235], 0
    v_mul_f32 v221, v221, v225
    v_mul_f32 v222, v222, v225
    v_mfma_f32_16x16x32_bf16 v[232:235], a[172:175], a[236:239], v[232:235]
    v_mul_f32 v223, v223, v225
    v_cvt_pk_bf16_f32 v220, v220, v221
    v_mfma_f32_16x16x32_bf16 v[232:235], a[176:179], a[240:243], v[232:235]
    v_mul_f32 v228, s38, v228
    v_mul_f32 v229, s38, v229
    v_mfma_f32_16x16x32_bf16 v[232:235], a[180:183], a[244:247], v[232:235]
    v_mul_f32 v230, s38, v230
    v_mul_f32 v231, s38, v231
    v_mfma_f32_16x16x32_bf16 v[232:235], a[184:187], a[216:219], v[232:235]
    v_cvt_pk_bf16_f32 v228, v228, v229
    v_cvt_pk_bf16_f32 v229, v230, v231
    v_mfma_f32_16x16x32_bf16 v[232:235], a[188:191], a[220:223], v[232:235]
    ds_write_b64 v247, v[228:229] offset:24576
    v_mfma_f32_16x16x32_bf16 v[236:239], a[192:195], a[232:235], 0
    ds_read_b128 a[232:235], v242 offset:63104
    v_cvt_pk_bf16_f32 v221, v222, v223
    v_mfma_f32_16x16x32_bf16 v[236:239], a[196:199], a[236:239], v[236:239]
    ds_read_b128 a[236:239], v243 offset:63104
    v_cvt_pk_bf16_f32 v194, v208, v209
    v_mfma_f32_16x16x32_bf16 v[236:239], a[200:203], a[240:243], v[236:239]
    ds_read_b128 a[240:243], v242 offset:63232
    v_mul_f32 v232, s3, v232
    v_mfma_f32_16x16x32_bf16 v[236:239], a[204:207], a[244:247], v[236:239]
    ds_read_b128 a[244:247], v243 offset:63232
    v_mul_f32 v233, s3, v233
    v_mfma_f32_16x16x32_bf16 v[236:239], a[208:211], a[216:219], v[236:239]
    ds_read_b128 a[216:219], v242 offset:64512
    v_mul_f32 v234, s3, v234
    v_mfma_f32_16x16x32_bf16 v[236:239], a[212:215], a[220:223], v[236:239]
    s_waitcnt lgkmcnt(6)
    v_mul_f32 v235, s3, v235
    v_cvt_pk_bf16_f32 v232, v232, v233
    v_mfma_f32_16x16x32_bf16 v[228:231], a[144:147], a[224:227], 0
    ds_read_b128 a[220:223], v243 offset:64512
    v_cvt_pk_bf16_f32 v233, v234, v235
    v_mfma_f32_16x16x32_bf16 v[228:231], a[148:151], a[228:231], v[228:231]
    ds_write_b64 v247, v[232:233] offset:24704
    v_mfma_f32_16x16x32_bf16 v[232:235], a[168:171], a[224:227], 0
    ds_write_b64 v247, v[220:221] offset:6400
    v_mfma_f32_16x16x32_bf16 v[232:235], a[172:175], a[228:231], v[232:235]
    s_waitcnt lgkmcnt(6)
    v_mul_f32 v236, s38, v236
    v_mul_f32 v237, s38, v237
    v_mfma_f32_16x16x32_bf16 v[228:231], a[152:155], a[232:235], v[228:231]
    v_mul_f32 v238, s38, v238
    v_mul_f32 v239, s38, v239
    v_mfma_f32_16x16x32_bf16 v[228:231], a[156:159], a[236:239], v[228:231]
    s_waitcnt lgkmcnt(4)
    v_cvt_pk_bf16_f32 v236, v236, v237
    v_cvt_pk_bf16_f32 v237, v238, v239
    v_mfma_f32_16x16x32_bf16 v[228:231], a[160:163], a[240:243], v[228:231]
    ds_write_b64 v247, v[236:237] offset:24832
    v_mfma_f32_16x16x32_bf16 v[228:231], a[164:167], a[244:247], v[228:231]
    v_exp_f32 v210, v210
    v_mfma_f32_16x16x32_bf16 v[232:235], a[176:179], a[232:235], v[232:235]
    v_exp_f32 v211, v211
    v_mfma_f32_16x16x32_bf16 v[232:235], a[180:183], a[236:239], v[232:235]
    v_exp_f32 v196, v196
    v_mfma_f32_16x16x32_bf16 v[232:235], a[184:187], a[240:243], v[232:235]
    v_exp_f32 v197, v197
    v_mfma_f32_16x16x32_bf16 v[232:235], a[188:191], a[244:247], v[232:235]
    v_mul_f32 v228, s38, v228
    v_mul_f32 v229, s38, v229
    v_mfma_f32_16x16x32_bf16 v[236:239], a[192:195], a[224:227], 0
    ds_read_b128 a[224:227], v242 offset:64640
    v_mul_f32 v230, s38, v230
    v_mfma_f32_16x16x32_bf16 v[236:239], a[196:199], a[228:231], v[236:239]
    ds_read_b128 a[228:231], v243 offset:64640
    v_mul_f32 v231, s38, v231
    v_mfma_f32_16x16x32_bf16 v[236:239], a[200:203], a[232:235], v[236:239]
    ds_read_b128 a[232:235], v242 offset:64768
    v_cvt_pk_bf16_f32 v228, v228, v229
    v_mfma_f32_16x16x32_bf16 v[236:239], a[204:207], a[236:239], v[236:239]
    ds_read_b128 a[236:239], v243 offset:64768
    v_cvt_pk_bf16_f32 v229, v230, v231
    v_mfma_f32_16x16x32_bf16 v[236:239], a[208:211], a[240:243], v[236:239]
    ds_write_b64 v247, v[228:229] offset:30720
    v_mfma_f32_16x16x32_bf16 v[236:239], a[212:215], a[244:247], v[236:239]
    s_waitcnt lgkmcnt(5)
    v_mul_f32 v232, s3, v232
    v_mul_f32 v233, s3, v233
    v_mfma_f32_16x16x32_bf16 v[228:231], a[144:147], a[216:219], 0
    v_mul_f32 v234, s3, v234
    v_mul_f32 v235, s3, v235
    v_mfma_f32_16x16x32_bf16 v[228:231], a[148:151], a[220:223], v[228:231]
    v_cvt_pk_bf16_f32 v232, v232, v233
    v_cvt_pk_bf16_f32 v233, v234, v235
    ds_write_b64 v247, v[232:233] offset:30848
    v_mfma_f32_16x16x32_bf16 v[232:235], a[168:171], a[216:219], 0
    s_waitcnt lgkmcnt(4)
    v_mul_f32 v236, s38, v236
    v_mul_f32 v237, s38, v237
    v_mfma_f32_16x16x32_bf16 v[228:231], a[152:155], a[224:227], v[228:231]
    v_mul_f32 v238, s38, v238
    v_mul_f32 v239, s38, v239
    v_mfma_f32_16x16x32_bf16 v[228:231], a[156:159], a[228:231], v[228:231]
    s_waitcnt lgkmcnt(2)
    v_cvt_pk_bf16_f32 v236, v236, v237
    v_cvt_pk_bf16_f32 v237, v238, v239
    v_mfma_f32_16x16x32_bf16 v[228:231], a[160:163], a[232:235], v[228:231]
    ds_write_b64 v247, v[236:237] offset:30976
    v_mfma_f32_16x16x32_bf16 v[228:231], a[164:167], a[236:239], v[228:231]
    v_add_u32 v242, 0xf000, v242
    v_add_u32 v243, 0xf000, v243
    v_mfma_f32_16x16x32_bf16 v[232:235], a[172:175], a[220:223], v[232:235]
    ds_read_b128 a[240:243], v242 offset:4608
    v_cvt_pk_bf16_f32 v181, v210, v211
    v_mfma_f32_16x16x32_bf16 v[232:235], a[176:179], a[224:227], v[232:235]
    ds_read_b128 a[244:247], v243 offset:4608
    v_cvt_pk_bf16_f32 v192, v196, v197
    v_mfma_f32_16x16x32_bf16 v[232:235], a[180:183], a[228:231], v[232:235]
    ds_read_b128 v[208:211], v246 offset:64
    v_mul_f32 v228, s38, v228
    v_mfma_f32_16x16x32_bf16 v[232:235], a[184:187], a[232:235], v[232:235]
    v_mul_f32 v229, s38, v229
    v_mul_f32 v230, s38, v230
    v_mfma_f32_16x16x32_bf16 v[232:235], a[188:191], a[236:239], v[232:235]
    v_mul_f32 v231, s38, v231
    v_cvt_pk_bf16_f32 v228, v228, v229
    v_mfma_f32_16x16x32_bf16 v[236:239], a[192:195], a[216:219], 0
    ds_read_b128 a[216:219], v242 offset:4736
    v_cvt_pk_bf16_f32 v229, v230, v231
    v_mfma_f32_16x16x32_bf16 v[236:239], a[196:199], a[220:223], v[236:239]
    ds_write_b64 v247, v[228:229] offset:36864
    v_mfma_f32_16x16x32_bf16 v[236:239], a[200:203], a[224:227], v[236:239]
    ds_read_b128 a[220:223], v243 offset:4736
    v_mul_f32 v232, s3, v232
    v_mfma_f32_16x16x32_bf16 v[236:239], a[204:207], a[228:231], v[236:239]
    ds_read_b128 a[224:227], v242 offset:4864
    v_mul_f32 v233, s3, v233
    v_mfma_f32_16x16x32_bf16 v[236:239], a[208:211], a[232:235], v[236:239]
    ds_read_b128 a[228:231], v243 offset:4864
    v_mul_f32 v234, s3, v234
    v_mfma_f32_16x16x32_bf16 v[236:239], a[212:215], a[236:239], v[236:239]
    s_waitcnt lgkmcnt(5)
    v_mul_f32 v235, s3, v235
    v_cvt_pk_bf16_f32 v232, v232, v233
    v_mfma_f32_16x16x32_bf16 v[208:211], v[162:165], v[174:177], v[208:211]
    ds_read_b128 a[232:235], v240 offset:35328
    v_cvt_pk_bf16_f32 v233, v234, v235
    v_mfma_f32_16x16x32_bf16 v[208:211], v[164:167], v[176:179], v[208:211]
    ds_write_b64 v247, v[232:233] offset:36992
    v_mfma_f32_16x16x32_bf16 v[228:231], a[144:147], a[240:243], 0
    ds_read_b128 a[236:239], v241 offset:35328
    v_mul_f32 v236, s38, v236
    v_mfma_f32_16x16x32_bf16 v[228:231], a[148:151], a[244:247], v[228:231]
    s_waitcnt lgkmcnt(7)
    v_mul_f32 v237, s38, v237
    v_mul_f32 v238, s38, v238
    v_mfma_f32_16x16x32_bf16 v[228:231], a[152:155], a[216:219], v[228:231]
    v_mul_f32 v239, s38, v239
    v_cvt_pk_bf16_f32 v236, v236, v237
    v_mfma_f32_16x16x32_bf16 v[232:235], a[168:171], a[240:243], 0
    s_waitcnt lgkmcnt(5)
    v_cvt_pk_bf16_f32 v237, v238, v239
    v_mfma_f32_16x16x32_bf16 v[228:231], a[156:159], a[220:223], v[228:231]
    ds_write_b64 v247, v[236:237] offset:37120
    v_mfma_f32_16x16x32_bf16 v[232:235], a[172:175], a[244:247], v[232:235]
    s_waitcnt vmcnt(0) lgkmcnt(4)
    v_exp_f32 v198, v198
    v_mfma_f32_16x16x32_bf16 v[228:231], a[160:163], a[224:227], v[228:231]
    s_barrier
    v_exp_f32 v199, v199
    v_mfma_f32_16x16x32_bf16 v[228:231], a[164:167], a[228:231], v[228:231]
    v_exp_f32 v200, v200
    v_mfma_f32_16x16x32_bf16 v[232:235], a[176:179], a[216:219], v[232:235]
    v_exp_f32 v201, v201
    v_mfma_f32_16x16x32_bf16 v[232:235], a[180:183], a[220:223], v[232:235]
    v_cvt_pk_bf16_f32 v195, v198, v199
    v_cvt_pk_bf16_f32 v183, v200, v201
    v_mfma_f32_16x16x32_bf16 v[232:235], a[184:187], a[224:227], v[232:235]
    ds_read_b128 v[196:199], v244 offset:128
    v_mul_f32 v228, s38, v228
    v_mfma_f32_16x16x32_bf16 v[212:215], v[6:9], v[192:195], 0
    v_mul_f32 v229, s38, v229
    v_mul_f32 v230, s38, v230
    v_mfma_f32_16x16x32_bf16 v[216:219], v[36:39], v[192:195], 0
    v_mul_f32 v231, s38, v231
    v_cvt_pk_bf16_f32 v228, v228, v229
    v_mfma_f32_16x16x32_bf16 v[220:223], v[66:69], v[192:195], 0
    v_cvt_pk_bf16_f32 v229, v230, v231
    v_mfma_f32_16x16x32_bf16 v[224:227], a[248:251], v[192:195], 0
    ds_write_b64 v247, v[228:229] offset:43008
    v_mfma_f32_16x16x32_bf16 v[232:235], a[188:191], a[228:231], v[232:235]
    s_waitcnt lgkmcnt(2)
    v_exp_f32 v202, v202
    v_mfma_f32_16x16x32_bf16 v[236:239], a[192:195], a[240:243], 0
    ds_read_b128 a[240:243], v240 offset:35456
    v_mfma_f32_16x16x32_bf16 v[236:239], a[196:199], a[244:247], v[236:239]
    ds_read_b128 a[244:247], v241 offset:35456
    v_mfma_f32_16x16x32_bf16 v[236:239], a[200:203], a[216:219], v[236:239]
    ds_read_b128 a[216:219], v240 offset:35584
    v_mul_f32 v232, s3, v232
    v_mfma_f32_16x16x32_bf16 v[236:239], a[204:207], a[220:223], v[236:239]
    ds_read_b128 a[220:223], v241 offset:35584
    v_mul_f32 v233, s3, v233
    v_mfma_f32_16x16x32_bf16 v[236:239], a[208:211], a[224:227], v[236:239]
    s_waitcnt lgkmcnt(5)
    v_mul_f32 v234, s3, v234
    v_mul_f32 v235, s3, v235
    v_mfma_f32_16x16x32_bf16 v[196:199], v[132:135], v[174:177], v[196:199]
    v_cvt_pk_bf16_f32 v232, v232, v233
    v_cvt_pk_bf16_f32 v233, v234, v235
    v_mfma_f32_16x16x32_bf16 v[196:199], v[134:137], v[176:179], v[196:199]
    ds_write_b64 v247, v[232:233] offset:43136
    v_mfma_f32_16x16x32_bf16 v[236:239], a[212:215], a[228:231], v[236:239]
    v_exp_f32 v203, v203
    v_mfma_f32_16x16x32_bf16 v[228:231], a[0:3], a[232:235], 0
    v_exp_f32 v204, v204
    v_mfma_f32_16x16x32_bf16 v[228:231], a[4:7], a[236:239], v[228:231]
    s_waitcnt lgkmcnt(3)
    v_exp_f32 v205, v205
    v_mfma_f32_16x16x32_bf16 v[228:231], a[8:11], a[240:243], v[228:231]
    v_cvt_pk_bf16_f32 v186, v202, v203
    v_mul_f32 v236, s38, v236
    v_mfma_f32_16x16x32_bf16 v[228:231], a[12:15], a[244:247], v[228:231]
    ds_read_b128 v[200:203], v245 offset:128
    v_mul_f32 v237, s38, v237
    v_mfma_f32_16x16x32_bf16 v[232:235], a[24:27], a[232:235], 0
    s_waitcnt lgkmcnt(2)
    v_mul_f32 v238, s38, v238
    v_mul_f32 v239, s38, v239
    v_mfma_f32_16x16x32_bf16 v[228:231], a[16:19], a[216:219], v[228:231]
    v_cvt_pk_bf16_f32 v236, v236, v237
    v_cvt_pk_bf16_f32 v237, v238, v239
    v_mfma_f32_16x16x32_bf16 v[228:231], a[20:23], a[220:223], v[228:231]
    ds_write_b64 v247, v[236:237] offset:43264
    v_mfma_f32_16x16x32_bf16 v[232:235], a[28:31], a[236:239], v[232:235]
    v_exp_f32 v206, v206
    v_mfma_f32_16x16x32_bf16 v[232:235], a[32:35], a[240:243], v[232:235]
    v_exp_f32 v207, v207
    v_mfma_f32_16x16x32_bf16 v[232:235], a[36:39], a[244:247], v[232:235]
    v_cvt_pk_bf16_f32 v184, v204, v205
    v_cvt_pk_bf16_f32 v187, v206, v207
    v_mfma_f32_16x16x32_bf16 v[232:235], a[40:43], a[216:219], v[232:235]
    ds_read_b128 v[204:207], v246 offset:128
    v_cvt_pk_bf16_f32 v114, v228, v229
    v_mfma_f32_16x16x32_bf16 v[232:235], a[44:47], a[220:223], v[232:235]
    s_waitcnt lgkmcnt(2)
    v_cvt_pk_bf16_f32 v115, v230, v231
    v_mfma_f32_16x16x32_bf16 v[200:203], v[156:159], v[174:177], v[200:203]
    v_exp_f32 v208, v208
    v_mfma_f32_16x16x32_bf16 v[200:203], v[158:161], v[176:179], v[200:203]
    v_exp_f32 v209, v209
    v_mfma_f32_16x16x32_bf16 v[236:239], a[48:51], a[232:235], 0
    v_exp_f32 v210, v210
    v_mfma_f32_16x16x32_bf16 v[236:239], a[52:55], a[236:239], v[236:239]
    v_cvt_pk_bf16_f32 v116, v232, v233
    v_cvt_pk_bf16_f32 v117, v234, v235
    v_mfma_f32_16x16x32_bf16 v[236:239], a[56:59], a[240:243], v[236:239]
    v_exp_f32 v211, v211
    v_mfma_f32_16x16x32_bf16 v[236:239], a[60:63], a[244:247], v[236:239]
    v_cvt_pk_bf16_f32 v182, v208, v209
    v_cvt_pk_bf16_f32 v185, v210, v211
    v_mfma_f32_16x16x32_bf16 v[236:239], a[64:67], a[216:219], v[236:239]
    ds_read_b128 v[208:211], v244 offset:0
    s_waitcnt lgkmcnt(1)
    v_mfma_f32_16x16x32_bf16 v[212:215], v[10:13], v[180:183], v[212:215]
    v_exp_f32 v196, v196
    v_mfma_f32_16x16x32_bf16 v[216:219], v[40:43], v[180:183], v[216:219]
    v_exp_f32 v197, v197
    v_mfma_f32_16x16x32_bf16 v[220:223], v[70:73], v[180:183], v[220:223]
    v_exp_f32 v200, v200
    v_mfma_f32_16x16x32_bf16 v[224:227], a[248:251], v[180:183], v[224:227]
    v_exp_f32 v201, v201
    v_mfma_f32_16x16x32_bf16 v[212:215], v[14:17], v[184:187], v[212:215]
    v_cvt_pk_bf16_f32 v189, v196, v197
    v_cvt_pk_bf16_f32 v190, v200, v201
    v_mfma_f32_16x16x32_bf16 v[216:219], v[44:47], v[184:187], v[216:219]
    ds_read_b128 v[196:199], v245 offset:0
    v_mfma_f32_16x16x32_bf16 v[220:223], v[74:77], v[184:187], v[220:223]
    ds_read_b128 v[200:203], v246 offset:0
    v_mfma_f32_16x16x32_bf16 v[224:227], a[248:251], v[184:187], v[224:227]
    v_mfma_f32_16x16x32_bf16 v[204:207], v[114:117], v[174:177], v[204:207]
    ds_read_b64 v[174:175], v247 offset:0
    s_waitcnt lgkmcnt(3)
    v_mfma_f32_16x16x32_bf16 v[208:211], v[126:129], v[168:171], v[208:211]
    v_mfma_f32_16x16x32_bf16 v[208:211], v[128:131], v[170:173], v[208:211]
    v_mfma_f32_16x16x32_bf16 v[236:239], a[68:71], a[220:223], v[236:239]
    v_mfma_f32_16x16x32_bf16 v[228:231], a[232:235], a[72:75], 0
    v_mfma_f32_16x16x32_bf16 v[228:231], a[236:239], a[76:79], v[228:231]
    v_mfma_f32_16x16x32_bf16 v[228:231], a[240:243], a[80:83], v[228:231]
    s_waitcnt lgkmcnt(2)
    s_waitcnt lgkmcnt(1)
    v_mfma_f32_16x16x32_bf16 v[196:199], v[150:153], v[168:171], v[196:199]
    v_mfma_f32_16x16x32_bf16 v[196:199], v[152:155], v[170:173], v[196:199]
    v_exp_f32 v208, v208
    v_mfma_f32_16x16x32_bf16 v[200:203], v[162:165], v[168:171], v[200:203]
    v_cvt_pk_bf16_f32 v118, v236, v237
    v_cvt_pk_bf16_f32 v119, v238, v239
    v_mfma_f32_16x16x32_bf16 v[200:203], v[164:167], v[170:173], v[200:203]
    v_exp_f32 v209, v209
    v_mfma_f32_16x16x32_bf16 v[204:207], v[116:119], v[176:179], v[204:207]
    ds_read_b64 v[176:177], v247 offset:128
    v_cvt_pk_bf16_f32 v193, v208, v209
    v_mfma_f32_16x16x32_bf16 v[228:231], a[244:247], a[84:87], v[228:231]
    ds_read_b64 v[178:179], v247 offset:256
    v_mfma_f32_16x16x32_bf16 v[228:231], a[216:219], a[88:91], v[228:231]
    v_exp_f32 v210, v210
    v_mfma_f32_16x16x32_bf16 v[228:231], a[220:223], a[92:95], v[228:231]
    v_exp_f32 v211, v211
    v_mfma_f32_16x16x32_bf16 v[232:235], a[232:235], a[96:99], 0
    v_exp_f32 v204, v204
    v_mfma_f32_16x16x32_bf16 v[232:235], a[236:239], a[100:103], v[232:235]
    v_exp_f32 v205, v205
    v_mfma_f32_16x16x32_bf16 v[232:235], a[240:243], a[104:107], v[232:235]
    v_cvt_pk_bf16_f32 v188, v204, v205
    v_cvt_pk_bf16_f32 v180, v210, v211
    v_mfma_f32_16x16x32_bf16 v[232:235], a[244:247], a[108:111], v[232:235]
    ds_read_b128 v[204:207], v244 offset:64
    v_cvt_pk_bf16_f32 v18, v228, v229
    v_mfma_f32_16x16x32_bf16 v[224:227], a[248:251], v[188:191], v[224:227]
    ds_read_b128 v[208:211], v245 offset:64
    v_cvt_pk_bf16_f32 v21, v230, v231
    v_mfma_f32_16x16x32_bf16 v[232:235], a[216:219], a[112:115], v[232:235]
    v_mbcnt_lo_u32_b32 v228, -1, 0
    v_mbcnt_hi_u32_b32 v228, -1, v228
    v_mfma_f32_16x16x32_bf16 v[212:215], v[18:21], v[188:191], v[212:215]
    v_lshrrev_b32 v229, 4, v228
    v_bfe_u32 v230, v228, 2, 1
    v_mfma_f32_16x16x32_bf16 v[232:235], a[220:223], a[116:119], v[232:235]
    v_add_u32 v230, 15, v230
    v_and_b32 v230, 15, v230
    v_mfma_f32_16x16x32_bf16 v[236:239], a[232:235], a[120:123], 0
    v_bfe_u32 v231, v228, 3, 1
    v_and_b32 v228, 3, v228
    v_mfma_f32_16x16x32_bf16 v[236:239], a[236:239], a[124:127], v[236:239]
    v_lshl_add_u32 v228, v231, 2, v228
    v_add_u32 v228, 3, v228
    v_mfma_f32_16x16x32_bf16 v[236:239], a[240:243], a[128:131], v[236:239]
    v_cvt_pk_bf16_f32 v48, v232, v233
    v_cvt_pk_bf16_f32 v51, v234, v235
    v_mfma_f32_16x16x32_bf16 v[236:239], a[244:247], a[132:135], v[236:239]
    v_and_b32 v231, 3, v230
    v_mul_u32_u24 v230, 0x1e00, v230
    v_mfma_f32_16x16x32_bf16 v[216:219], v[48:51], v[188:191], v[216:219]
    s_waitcnt lgkmcnt(1)
    v_lshlrev_b32 v231, 1, v231
    v_bfe_u32 v243, v228, 1, 1
    v_mfma_f32_16x16x32_bf16 v[204:207], v[132:135], v[168:171], v[204:207]
    s_waitcnt lgkmcnt(0)
    v_or_b32 v231, v231, v243
    v_xor_b32 v231, v231, v229
    v_mfma_f32_16x16x32_bf16 v[204:207], v[134:137], v[170:173], v[204:207]
    v_lshl_add_u32 v230, v231, 4, v230
    v_mul_u32_u24 v231, 0x180, v228
    v_mfma_f32_16x16x32_bf16 v[208:211], v[156:159], v[168:171], v[208:211]
    v_add_u32 v242, v230, v231
    v_xor_b32 v243, 64, v242
    v_mfma_f32_16x16x32_bf16 v[208:211], v[158:161], v[170:173], v[208:211]
    ds_read_b128 a[224:227], v242 offset:0
    v_mfma_f32_16x16x32_bf16 v[236:239], a[216:219], a[136:139], v[236:239]
    ds_read_b128 a[228:231], v243 offset:0
    v_mfma_f32_16x16x32_bf16 v[236:239], a[220:223], a[140:143], v[236:239]
    ds_read_b128 a[232:235], v242 offset:128
    ds_read_b128 a[236:239], v243 offset:128
    ds_read_b128 a[240:243], v242 offset:256
    ds_read_b128 a[244:247], v243 offset:256
    ds_read_b128 a[216:219], v242 offset:3072
    ds_read_b128 a[220:223], v243 offset:3072
    v_rcp_f32 v225, v224
    v_exp_f32 v196, v196
    v_cvt_pk_bf16_f32 v78, v236, v237
    v_cvt_pk_bf16_f32 v81, v238, v239
    v_max3_f32 v248, v248, v224, v225
    v_mul_f32 v212, v212, v225
    v_mfma_f32_16x16x32_bf16 v[220:223], v[78:81], v[188:191], v[220:223]
    v_mul_f32 v213, v213, v225
    v_mul_f32 v214, v214, v225
    v_mul_f32 v215, v215, v225
    v_cvt_pk_bf16_f32 v212, v212, v213
    v_cvt_pk_bf16_f32 v213, v214, v215
    ds_write_b64 v247, v[212:213] offset:12288
    v_mul_f32 v216, v216, v225
    v_mul_f32 v217, v217, v225
    v_mul_f32 v218, v218, v225
    v_mul_f32 v219, v219, v225
    v_cvt_pk_bf16_f32 v216, v216, v217
    v_cvt_pk_bf16_f32 v217, v218, v219
    ds_write_b64 v247, v[216:217] offset:12416
    v_mul_f32 v220, v220, v225
    v_mul_f32 v221, v221, v225
    v_mul_f32 v222, v222, v225
    v_mul_f32 v223, v223, v225
    v_cvt_pk_bf16_f32 v220, v220, v221
    v_cvt_pk_bf16_f32 v221, v222, v223
    ds_write_b64 v247, v[220:221] offset:12544
    v_exp_f32 v197, v197
    v_exp_f32 v198, v198
    v_exp_f32 v199, v199
    v_cvt_pk_bf16_f32 v194, v196, v197
    v_cvt_pk_bf16_f32 v181, v198, v199
    ds_read_b128 v[196:199], v246 offset:64
    v_exp_f32 v200, v200
    v_exp_f32 v201, v201
    v_exp_f32 v202, v202
    v_exp_f32 v203, v203
    v_cvt_pk_bf16_f32 v192, v200, v201
    v_cvt_pk_bf16_f32 v195, v202, v203
    s_waitcnt lgkmcnt(2)
    v_mfma_f32_16x16x32_bf16 v[232:235], a[144:147], a[224:227], 0
    ds_read_b128 v[200:203], v244 offset:128
    v_mfma_f32_16x16x32_bf16 v[212:215], v[12:15], v[192:195], 0
    v_exp_f32 v204, v204
    v_mfma_f32_16x16x32_bf16 v[216:219], v[42:45], v[192:195], 0
    v_exp_f32 v205, v205
    v_mfma_f32_16x16x32_bf16 v[220:223], v[72:75], v[192:195], 0
    v_exp_f32 v206, v206
    v_mfma_f32_16x16x32_bf16 v[224:227], a[248:251], v[192:195], 0
    v_exp_f32 v207, v207
    v_mfma_f32_16x16x32_bf16 v[232:235], a[148:151], a[228:231], v[232:235]
    s_waitcnt lgkmcnt(1)
    v_cvt_pk_bf16_f32 v183, v204, v205
    v_cvt_pk_bf16_f32 v186, v206, v207
    v_mfma_f32_16x16x32_bf16 v[196:199], v[114:117], v[168:171], v[196:199]
    ds_read_b128 v[204:207], v245 offset:128
    v_mfma_f32_16x16x32_bf16 v[196:199], v[116:119], v[170:173], v[196:199]
    v_exp_f32 v208, v208
    v_mfma_f32_16x16x32_bf16 v[232:235], a[152:155], a[232:235], v[232:235]
    v_exp_f32 v209, v209
    v_mfma_f32_16x16x32_bf16 v[232:235], a[156:159], a[236:239], v[232:235]
    s_waitcnt lgkmcnt(1)
    v_exp_f32 v210, v210
    v_mfma_f32_16x16x32_bf16 v[200:203], v[90:93], v[168:171], v[200:203]
    v_exp_f32 v211, v211
    v_mfma_f32_16x16x32_bf16 v[200:203], v[92:95], v[170:173], v[200:203]
    v_cvt_pk_bf16_f32 v184, v208, v209
    v_cvt_pk_bf16_f32 v187, v210, v211
    v_mfma_f32_16x16x32_bf16 v[232:235], a[160:163], a[240:243], v[232:235]
    ds_read_b128 v[208:211], v246 offset:128
    v_mfma_f32_16x16x32_bf16 v[232:235], a[164:167], a[244:247], v[232:235]
    v_exp_f32 v196, v196
    v_mfma_f32_16x16x32_bf16 v[236:239], a[168:171], a[224:227], 0
    v_exp_f32 v197, v197
    v_mfma_f32_16x16x32_bf16 v[236:239], a[172:175], a[228:231], v[236:239]
    s_waitcnt lgkmcnt(1)
    v_exp_f32 v198, v198
    v_mfma_f32_16x16x32_bf16 v[204:207], v[96:99], v[168:171], v[204:207]
    v_exp_f32 v199, v199
    v_mfma_f32_16x16x32_bf16 v[204:207], v[98:101], v[170:173], v[204:207]
    v_mul_f32 v232, s38, v232
    v_mul_f32 v233, s38, v233
    v_mfma_f32_16x16x32_bf16 v[236:239], a[176:179], a[232:235], v[236:239]
    v_mul_f32 v234, s38, v234
    v_mul_f32 v235, s38, v235
    v_mfma_f32_16x16x32_bf16 v[236:239], a[180:183], a[236:239], v[236:239]
    v_cvt_pk_bf16_f32 v232, v232, v233
    v_cvt_pk_bf16_f32 v233, v234, v235
    v_mfma_f32_16x16x32_bf16 v[236:239], a[184:187], a[240:243], v[236:239]
    ds_write_b64 v247, v[232:233] offset:49152
    v_mfma_f32_16x16x32_bf16 v[236:239], a[188:191], a[244:247], v[236:239]
    v_cvt_pk_bf16_f32 v182, v196, v197
    v_cvt_pk_bf16_f32 v185, v198, v199
    v_mfma_f32_16x16x32_bf16 v[228:231], a[192:195], a[224:227], 0
    ds_read_b128 a[224:227], v242 offset:3200
    v_mfma_f32_16x16x32_bf16 v[212:215], v[16:19], v[180:183], v[212:215]
    ds_read_b128 v[196:199], v244 offset:32
    v_mfma_f32_16x16x32_bf16 v[216:219], v[46:49], v[180:183], v[216:219]
    v_exp_f32 v200, v200
    v_mfma_f32_16x16x32_bf16 v[220:223], v[76:79], v[180:183], v[220:223]
    v_mul_f32 v236, s3, v236
    v_mul_f32 v237, s3, v237
    v_mfma_f32_16x16x32_bf16 v[224:227], a[248:251], v[180:183], v[224:227]
    v_mul_f32 v238, s3, v238
    v_mul_f32 v239, s3, v239
    v_mfma_f32_16x16x32_bf16 v[212:215], v[20:23], v[184:187], v[212:215]
    v_cvt_pk_bf16_f32 v236, v236, v237
    v_cvt_pk_bf16_f32 v237, v238, v239
    v_mfma_f32_16x16x32_bf16 v[216:219], v[50:53], v[184:187], v[216:219]
    ds_write_b64 v247, v[236:237] offset:49280
    v_mfma_f32_16x16x32_bf16 v[220:223], v[80:83], v[184:187], v[220:223]
    v_exp_f32 v201, v201
    v_mfma_f32_16x16x32_bf16 v[224:227], a[248:251], v[184:187], v[224:227]
    v_exp_f32 v204, v204
    v_mfma_f32_16x16x32_bf16 v[228:231], a[196:199], a[228:231], v[228:231]
    ds_read_b128 a[228:231], v243 offset:3200
    v_cvt_pk_bf16_f32 v189, v200, v201
    v_mfma_f32_16x16x32_bf16 v[228:231], a[200:203], a[232:235], v[228:231]
    ds_read_b128 a[232:235], v242 offset:3328
    s_waitcnt lgkmcnt(3)
    v_mfma_f32_16x16x32_bf16 v[196:199], v[132:135], v[174:177], v[196:199]
    ds_read_b128 v[200:203], v245 offset:32
    v_mfma_f32_16x16x32_bf16 v[196:199], v[134:137], v[176:179], v[196:199]
    v_exp_f32 v205, v205
    v_mfma_f32_16x16x32_bf16 v[228:231], a[204:207], a[236:239], v[228:231]
    ds_read_b128 a[236:239], v243 offset:3328
    v_cvt_pk_bf16_f32 v190, v204, v205
    v_mfma_f32_16x16x32_bf16 v[228:231], a[208:211], a[240:243], v[228:231]
    ds_read_b128 a[240:243], v240 offset:36864
    v_mfma_f32_16x16x32_bf16 v[228:231], a[212:215], a[244:247], v[228:231]
    ds_read_b128 a[244:247], v241 offset:36864
    v_mfma_f32_16x16x32_bf16 v[232:235], a[144:147], a[216:219], 0
    ds_read_b128 v[204:207], v246 offset:32
    v_mfma_f32_16x16x32_bf16 v[232:235], a[148:151], a[220:223], v[232:235]
    buffer_load_dwordx4 a[144:147], v254, s[24:27], s54 offen
    s_mov_b32 s54, 0x2000
    v_mfma_f32_16x16x32_bf16 v[232:235], a[152:155], a[224:227], v[232:235]
    s_waitcnt lgkmcnt(6)
    v_mul_f32 v228, s38, v228
    v_mul_f32 v229, s38, v229
    v_mfma_f32_16x16x32_bf16 v[232:235], a[156:159], a[228:231], v[232:235]
    s_waitcnt lgkmcnt(5)
    v_mul_f32 v230, s38, v230
    v_mul_f32 v231, s38, v231
    v_mfma_f32_16x16x32_bf16 v[232:235], a[160:163], a[232:235], v[232:235]
    s_waitcnt lgkmcnt(4)
    v_cvt_pk_bf16_f32 v228, v228, v229
    v_cvt_pk_bf16_f32 v229, v230, v231
    v_mfma_f32_16x16x32_bf16 v[200:203], v[156:159], v[174:177], v[200:203]
    ds_write_b64 v247, v[228:229] offset:49408
    v_mfma_f32_16x16x32_bf16 v[200:203], v[158:161], v[176:179], v[200:203]
    buffer_load_dwordx4 a[148:151], v254, s[24:27], s55 offen offset:1024
    s_mov_b32 s55, 0x2000
    v_mfma_f32_16x16x32_bf16 v[236:239], a[168:171], a[216:219], 0
    s_waitcnt lgkmcnt(2)
    v_exp_f32 v196, v196
    v_mfma_f32_16x16x32_bf16 v[232:235], a[164:167], a[236:239], v[232:235]
    s_waitcnt lgkmcnt(1)
    v_exp_f32 v197, v197
    v_mfma_f32_16x16x32_bf16 v[204:207], v[114:117], v[174:177], v[204:207]
    v_exp_f32 v198, v198
    v_mfma_f32_16x16x32_bf16 v[204:207], v[116:119], v[176:179], v[204:207]
    v_exp_f32 v199, v199
    v_mfma_f32_16x16x32_bf16 v[236:239], a[172:175], a[220:223], v[236:239]
    buffer_load_dwordx4 a[152:155], v254, s[24:27], s56 offen offset:2048
    v_mul_f32 v232, s38, v232
    v_mfma_f32_16x16x32_bf16 v[236:239], a[176:179], a[224:227], v[236:239]
    s_mov_b32 s56, 0x3000
    v_mul_f32 v233, s38, v233
    v_mul_f32 v234, s38, v234
    v_mfma_f32_16x16x32_bf16 v[236:239], a[180:183], a[228:231], v[236:239]
    v_mul_f32 v235, s38, v235
    v_cvt_pk_bf16_f32 v232, v232, v233
    v_mfma_f32_16x16x32_bf16 v[236:239], a[184:187], a[232:235], v[236:239]
    v_cvt_pk_bf16_f32 v233, v234, v235
    v_cvt_pk_bf16_f32 v193, v196, v197
    v_mfma_f32_16x16x32_bf16 v[236:239], a[188:191], a[236:239], v[236:239]
    ds_write_b64 v247, v[232:233] offset:55296
    v_mfma_f32_16x16x32_bf16 v[228:231], a[192:195], a[216:219], 0
    ds_read_b128 a[216:219], v240 offset:36992
    v_mbcnt_lo_u32_b32 v232, -1, 0
    v_mfma_f32_16x16x32_bf16 v[228:231], a[196:199], a[220:223], v[228:231]
    ds_read_b128 a[220:223], v241 offset:36992
    v_mbcnt_hi_u32_b32 v232, -1, v232
    v_mfma_f32_16x16x32_bf16 v[228:231], a[200:203], a[224:227], v[228:231]
    ds_read_b128 a[224:227], v240 offset:37120
    v_mul_f32 v236, s3, v236
    v_mfma_f32_16x16x32_bf16 v[228:231], a[204:207], a[228:231], v[228:231]
    ds_read_b128 a[228:231], v241 offset:37120
    v_mul_f32 v237, s3, v237
    v_mfma_f32_16x16x32_bf16 v[228:231], a[208:211], a[232:235], v[228:231]
    buffer_load_dwordx4 a[156:159], v254, s[24:27], s57 offen offset:3072
    v_mul_f32 v238, s3, v238
    v_mfma_f32_16x16x32_bf16 v[228:231], a[212:215], a[236:239], v[228:231]
    s_mov_b32 s57, 0x3000
    v_mul_f32 v239, s3, v239
    v_cvt_pk_bf16_f32 v236, v236, v237
    v_cvt_pk_bf16_f32 v237, v238, v239
    ds_write_b64 v247, v[236:237] offset:55424
    v_mfma_f32_16x16x32_bf16 v[236:239], a[0:3], a[240:243], 0
    v_add_u32 v240, 0xffff1000, v240
    v_add_u32 v241, 0xffff1000, v241
    v_mfma_f32_16x16x32_bf16 v[236:239], a[4:7], a[244:247], v[236:239]
    s_waitcnt lgkmcnt(4)
    v_mul_f32 v228, s38, v228
    v_mul_f32 v229, s38, v229
    v_mfma_f32_16x16x32_bf16 v[236:239], a[8:11], a[216:219], v[236:239]
    s_waitcnt lgkmcnt(3)
    v_mul_f32 v230, s38, v230
    v_mul_f32 v231, s38, v231
    v_mfma_f32_16x16x32_bf16 v[236:239], a[12:15], a[220:223], v[236:239]
    s_waitcnt lgkmcnt(2)
    v_cvt_pk_bf16_f32 v228, v228, v229
    v_cvt_pk_bf16_f32 v229, v230, v231
    v_mfma_f32_16x16x32_bf16 v[236:239], a[16:19], a[224:227], v[236:239]
    s_waitcnt lgkmcnt(1)
    v_and_b32 v233, 15, v232
    v_lshrrev_b32 v232, 4, v232
    v_mfma_f32_16x16x32_bf16 v[236:239], a[20:23], a[228:231], v[236:239]
    ds_write_b64 v247, v[228:229] offset:55552
    v_mfma_f32_16x16x32_bf16 v[228:231], a[24:27], a[240:243], 0
    buffer_load_dwordx4 a[160:163], v254, s[24:27], s58 offen
    v_lshrrev_b32 v234, 1, v233
    v_mfma_f32_16x16x32_bf16 v[228:231], a[28:31], a[244:247], v[228:231]
    s_mov_b32 s58, 0x3000
    v_mul_u32_u24 v235, 0x180, v233
    v_xor_b32 v243, v232, v234
    v_mfma_f32_16x16x32_bf16 v[228:231], a[32:35], a[216:219], v[228:231]
    v_cvt_pk_bf16_f32 v120, v236, v237
    v_cvt_pk_bf16_f32 v121, v238, v239
    v_mfma_f32_16x16x32_bf16 v[228:231], a[36:39], a[220:223], v[228:231]
    v_lshl_add_u32 v242, v243, 4, v235
    v_xor_b32 v243, 64, v242
    v_mfma_f32_16x16x32_bf16 v[228:231], a[40:43], a[224:227], v[228:231]
    v_add_u32 v242, 0x1e000, v242
    v_add_u32 v243, 0x1e000, v243
    v_mfma_f32_16x16x32_bf16 v[228:231], a[44:47], a[228:231], v[228:231]
    ds_read_b128 a[232:235], v242 offset:0
    v_lshrrev_b32 v249, 1, v232
    v_mfma_f32_16x16x32_bf16 v[236:239], a[240:243], a[72:75], 0
    ds_read_b128 a[236:239], v243 offset:0
    v_or_b32 v249, s66, v249
    v_mfma_f32_16x16x32_bf16 v[236:239], a[244:247], a[76:79], v[236:239]
    buffer_load_dwordx4 a[164:167], v254, s[24:27], s59 offen offset:1024
    v_mov_b32 v253, v249
    v_mfma_f32_16x16x32_bf16 v[236:239], a[216:219], a[80:83], v[236:239]
    s_mov_b32 s59, 0x3000
    v_cvt_pk_bf16_f32 v122, v228, v229
    v_cvt_pk_bf16_f32 v123, v230, v231
    v_mfma_f32_16x16x32_bf16 v[236:239], a[220:223], a[84:87], v[236:239]
    v_xor_b32 v249, v249, v234
    v_lshl_add_u32 v249, v249, 4, v235
    v_mfma_f32_16x16x32_bf16 v[208:211], v[120:123], v[168:171], v[208:211]
    ds_read_b64 v[168:169], v247 offset:24576
    v_and_b32 v235, 1, v232
    v_mfma_f32_16x16x32_bf16 v[236:239], a[224:227], a[88:91], v[236:239]
    v_lshl_add_u32 v249, v235, 3, v249
    v_add_u32 v249, 0x1e000, v249
    v_mfma_f32_16x16x32_bf16 v[236:239], a[228:231], a[92:95], v[236:239]
    buffer_load_dwordx4 a[168:171], v254, s[24:27], s50 offen offset:2048
    v_mul_u32_u24 v232, 0x180, v232
    v_mfma_f32_16x16x32_bf16 v[228:231], a[240:243], a[96:99], 0
    s_mov_b32 s50, 0x4000
    v_add_u32 v232, s67, v232
    v_lshlrev_b32 v235, 3, v235
    v_mfma_f32_16x16x32_bf16 v[228:231], a[244:247], a[100:103], v[228:231]
    s_lshl2_add_u32 s67, s28, 0x23000
    v_cvt_pk_bf16_f32 v24, v236, v237
    v_cvt_pk_bf16_f32 v27, v238, v239
    v_mfma_f32_16x16x32_bf16 v[228:231], a[216:219], a[104:107], v[228:231]
    v_xor_b32 v252, v233, v235
    v_xor_b32 v252, v252, v253
    v_mfma_f32_16x16x32_bf16 v[228:231], a[220:223], a[108:111], v[228:231]
    v_lshl_add_u32 v252, v252, 4, v232
    v_add_u32 v252, 0x1e000, v252
    v_mfma_f32_16x16x32_bf16 v[228:231], a[224:227], a[112:115], v[228:231]
    buffer_load_dwordx4 a[172:175], v254, s[24:27], s51 offen offset:3072
    v_xor_b32 v253, v253, v234
    v_mfma_f32_16x16x32_bf16 v[228:231], a[228:231], a[116:119], v[228:231]
    s_mov_b32 s51, 0x4000
    v_lshl_add_u32 v253, v253, 4, v232
    v_and_b32 v233, 1, v233
    v_lshl_add_u32 v253, v233, 3, v253
    v_mfma_f32_16x16x32_bf16 v[232:235], a[48:51], a[240:243], 0
    v_add_u32 v253, 0x1e000, v253
    v_cvt_pk_bf16_f32 v180, v198, v199
    v_mfma_f32_16x16x32_bf16 v[232:235], a[52:55], a[244:247], v[232:235]
    ds_read_b128 v[196:199], v245 offset:96
    v_cvt_pk_bf16_f32 v54, v228, v229
    v_mfma_f32_16x16x32_bf16 v[232:235], a[56:59], a[216:219], v[232:235]
    buffer_load_dwordx4 a[176:179], v254, s[24:27], s52 offen
    v_cvt_pk_bf16_f32 v57, v230, v231
    v_mfma_f32_16x16x32_bf16 v[232:235], a[60:63], a[220:223], v[232:235]
    s_add_u32 s52, s28, 3
    v_exp_f32 v200, v200
    v_mfma_f32_16x16x32_bf16 v[232:235], a[64:67], a[224:227], v[232:235]
    s_mul_i32 s52, s52, s30
    v_exp_f32 v201, v201
    v_mfma_f32_16x16x32_bf16 v[232:235], a[68:71], a[228:231], v[232:235]
    s_waitcnt vmcnt(8) lgkmcnt(1)
    v_exp_f32 v202, v202
    v_mfma_f32_16x16x32_bf16 v[236:239], a[144:147], a[232:235], 0
    v_exp_f32 v203, v203
    s_waitcnt vmcnt(7)
    v_mfma_f32_16x16x32_bf16 v[236:239], a[148:151], a[236:239], v[236:239]
    buffer_load_dwordx4 a[180:183], v254, s[24:27], s53 offen offset:1024
    s_mov_b32 s53, 3
    v_cvt_pk_bf16_f32 v124, v232, v233
    v_cvt_pk_bf16_f32 v125, v234, v235
    v_mfma_f32_16x16x32_bf16 v[232:235], a[240:243], a[120:123], 0
    ds_read_b128 a[240:243], v242 offset:128
    v_cvt_pk_bf16_f32 v194, v200, v201
    v_mfma_f32_16x16x32_bf16 v[208:211], v[122:125], v[170:173], v[208:211]
    ds_read_b64 v[170:171], v247 offset:24704
    v_cvt_pk_bf16_f32 v181, v202, v203
    v_mfma_f32_16x16x32_bf16 v[232:235], a[244:247], a[124:127], v[232:235]
    ds_read_b128 a[244:247], v243 offset:128
    s_mul_i32 s53, s53, s31
    v_mfma_f32_16x16x32_bf16 v[232:235], a[216:219], a[128:131], v[232:235]
    ds_read_b128 a[216:219], v242 offset:256
    s_add_u32 s52, s52, s53
    v_mfma_f32_16x16x32_bf16 v[232:235], a[220:223], a[132:135], v[232:235]
    ds_read_b128 a[220:223], v243 offset:256
    s_add_u32 s52, s52, s32
    v_mfma_f32_16x16x32_bf16 v[232:235], a[224:227], a[136:139], v[232:235]
    ds_read_b128 v[200:203], v246 offset:96
    s_mul_i32 s53, s31, 4
    v_mfma_f32_16x16x32_bf16 v[232:235], a[228:231], a[140:143], v[232:235]
    s_waitcnt lgkmcnt(6)
    v_exp_f32 v208, v208
    v_mfma_f32_16x16x32_bf16 v[196:199], v[96:99], v[174:177], v[196:199]
    ds_read_b64 v[172:173], v247 offset:24832
    v_mfma_f32_16x16x32_bf16 v[196:199], v[98:101], v[176:179], v[196:199]
    buffer_load_dwordx4 a[184:187], v254, s[24:27], s54 offen offset:2048
    s_waitcnt vmcnt(8) lgkmcnt(6)
    v_mfma_f32_16x16x32_bf16 v[236:239], a[152:155], a[240:243], v[236:239]
    s_mul_i32 s54, s30, 0
    v_cvt_pk_bf16_f32 v84, v232, v233
    v_cvt_pk_bf16_f32 v87, v234, v235
    v_exp_f32 v209, v209
    v_exp_f32 v204, v204
    v_cvt_pk_bf16_f32 v188, v208, v209
    ds_read_b128 v[208:211], v244 offset:96
    v_exp_f32 v205, v205
    v_mfma_f32_16x16x32_bf16 v[212:215], v[24:27], v[188:191], v[212:215]
    buffer_load_dwordx4 a[188:191], v254, s[24:27], s55 offen offset:3072
    v_cvt_pk_bf16_f32 v192, v204, v205
    v_mfma_f32_16x16x32_bf16 v[216:219], v[54:57], v[188:191], v[216:219]
    s_mul_i32 s55, s31, 4
    v_exp_f32 v206, v206
    v_mfma_f32_16x16x32_bf16 v[220:223], v[84:87], v[188:191], v[220:223]
    s_add_u32 s54, s54, s55
    v_exp_f32 v207, v207
    v_mfma_f32_16x16x32_bf16 v[224:227], a[248:251], v[188:191], v[224:227]
    s_waitcnt vmcnt(8) lgkmcnt(1)
    v_exp_f32 v196, v196
    v_mfma_f32_16x16x32_bf16 v[200:203], v[120:123], v[174:177], v[200:203]
    s_barrier
    v_exp_f32 v197, v197
    v_mfma_f32_16x16x32_bf16 v[200:203], v[122:125], v[176:179], v[200:203]
    ds_read_b128 a[224:227], v242 offset:6144
    v_cvt_pk_bf16_f32 v195, v206, v207
    v_mfma_f32_16x16x32_bf16 v[236:239], a[156:159], a[244:247], v[236:239]
    ds_read_b128 a[228:231], v243 offset:6144
    ds_read_b128 v[204:207], v244 offset:192
    buffer_load_dwordx4 a[192:195], v254, s[24:27], s56 offen
    v_rcp_f32 v225, v224
    s_mul_i32 s56, s30, 0
    v_max3_f32 v248, v248, v224, v225
    v_mul_f32 v212, v212, v225
    v_mul_f32 v213, v213, v225
    v_mul_f32 v214, v214, v225
    v_mul_f32 v215, v215, v225
    v_cvt_pk_bf16_f32 v212, v212, v213
    v_cvt_pk_bf16_f32 v213, v214, v215
    ds_write_b64 v247, v[212:213] offset:18432
    v_mfma_f32_16x16x32_bf16 v[212:215], v[18:21], v[192:195], 0
    s_waitcnt vmcnt(8) lgkmcnt(4)
    v_mul_f32 v216, v216, v225
    v_mul_f32 v217, v217, v225
    v_mfma_f32_16x16x32_bf16 v[208:211], v[90:93], v[174:177], v[208:211]
    ds_read_b64 v[174:175], v247 offset:30720
    v_mul_f32 v218, v218, v225
    v_mfma_f32_16x16x32_bf16 v[208:211], v[92:95], v[176:179], v[208:211]
    ds_read_b64 v[176:177], v247 offset:30848
    v_mul_f32 v219, v219, v225
    v_mfma_f32_16x16x32_bf16 v[236:239], a[160:163], a[216:219], v[236:239]
    ds_read_b64 v[178:179], v247 offset:30976
    buffer_load_dwordx4 a[196:199], v254, s[24:27], s57 offen offset:1024
    v_cvt_pk_bf16_f32 v216, v216, v217
    v_cvt_pk_bf16_f32 v217, v218, v219
    ds_write_b64 v247, v[216:217] offset:18560
    v_mfma_f32_16x16x32_bf16 v[216:219], v[48:51], v[192:195], 0
    s_waitcnt vmcnt(8) lgkmcnt(5)
    v_mul_f32 v220, v220, v225
    v_mul_f32 v221, v221, v225
    v_mfma_f32_16x16x32_bf16 v[204:207], v[138:141], v[168:171], v[204:207]
    s_mul_i32 s57, s31, 4
    v_mul_f32 v222, v222, v225
    v_mul_f32 v223, v223, v225
    v_mfma_f32_16x16x32_bf16 v[224:227], a[248:251], v[192:195], 0
    buffer_load_dwordx4 a[200:203], v254, s[24:27], s58 offen offset:2048
    v_cvt_pk_bf16_f32 v220, v220, v221
    v_mfma_f32_16x16x32_bf16 v[204:207], v[140:143], v[170:173], v[204:207]
    s_add_u32 s56, s56, s57
    v_cvt_pk_bf16_f32 v221, v222, v223
    v_cvt_pk_bf16_f32 v184, v196, v197
    v_mfma_f32_16x16x32_bf16 v[236:239], a[164:167], a[220:223], v[236:239]
    ds_write_b64 v247, v[220:221] offset:18688
    v_mfma_f32_16x16x32_bf16 v[220:223], v[78:81], v[192:195], 0
    s_waitcnt vmcnt(8)
    v_exp_f32 v208, v208
    v_mfma_f32_16x16x32_bf16 v[228:231], a[168:171], a[232:235], 0
    buffer_load_dwordx4 a[204:207], v254, s[24:27], s59 offen offset:3072
    v_exp_f32 v209, v209
    v_exp_f32 v210, v210
    v_cvt_pk_bf16_f32 v236, v236, v237
    v_cvt_pk_bf16_f32 v237, v238, v239
    ds_write_b64 v249, v[236:237] offset:0
    v_mfma_f32_16x16x32_bf16 v[236:239], a[144:147], a[224:227], 0
    s_mul_i32 s58, s30, 4
    v_exp_f32 v211, v211
    v_mfma_f32_16x16x32_bf16 v[236:239], a[148:151], a[228:231], v[236:239]
    s_waitcnt vmcnt(8)
    v_cvt_pk_bf16_f32 v183, v208, v209
    v_cvt_pk_bf16_f32 v186, v210, v211
    v_mfma_f32_16x16x32_bf16 v[228:231], a[172:175], a[236:239], v[228:231]
    ds_read_b128 v[208:211], v245 offset:192
    buffer_load_dwordx4 a[208:211], v254, s[24:27], s50 offen
    v_exp_f32 v198, v198
    v_exp_f32 v199, v199
    v_exp_f32 v200, v200
    v_cvt_pk_bf16_f32 v187, v198, v199
    ds_read_b128 v[196:199], v246 offset:192
    v_exp_f32 v201, v201
    v_exp_f32 v202, v202
    v_exp_f32 v203, v203
    buffer_load_dwordx4 a[212:215], v254, s[24:27], s51 offen offset:1024
    v_mbcnt_lo_u32_b32 v254, -1, 0
    v_mbcnt_hi_u32_b32 v254, -1, v254
    v_lshrrev_b32 v255, 4, v254
    v_mul_i32_i24 v250, s31, v255
    v_add_u32 v250, s52, v250
    v_and_b32 v254, 15, v254
    v_lshl_add_u32 v251, v254, 3, v250
    v_lshlrev_b32 v255, 3, v255
    v_and_b32 v255, 8, v255
    v_xor_b32 v254, v254, v255
    v_lshl_add_u32 v250, v254, 4, v250
    v_cvt_pk_bf16_f32 v182, v200, v201
    s_waitcnt vmcnt(9) lgkmcnt(1)
    v_mfma_f32_16x16x32_bf16 v[208:211], v[102:105], v[168:171], v[208:211]
    s_mul_i32 s59, s31, -8
    v_exp_f32 v204, v204
    v_mfma_f32_16x16x32_bf16 v[212:215], v[22:25], v[180:183], v[212:215]
    s_add_u32 s58, s58, s59
    v_exp_f32 v205, v205
    v_mfma_f32_16x16x32_bf16 v[216:219], v[52:55], v[180:183], v[216:219]
    s_mul_i32 s50, s30, 0
    v_cvt_pk_bf16_f32 v185, v202, v203
    v_cvt_pk_bf16_f32 v190, v204, v205
    v_mfma_f32_16x16x32_bf16 v[220:223], v[82:85], v[180:183], v[220:223]
    ds_read_b128 v[200:203], v244 offset:256
    s_mul_i32 s51, s31, 4
    v_mfma_f32_16x16x32_bf16 v[224:227], a[248:251], v[180:183], v[224:227]
    s_add_u32 s50, s50, s51
    v_exp_f32 v206, v206
    v_mfma_f32_16x16x32_bf16 v[212:215], v[26:29], v[184:187], v[212:215]
    s_mul_i32 s52, s30, 0
    v_exp_f32 v207, v207
    v_mfma_f32_16x16x32_bf16 v[216:219], v[56:59], v[184:187], v[216:219]
    s_add_u32 s52, s52, s53
    v_cvt_pk_bf16_f32 v193, v206, v207
    s_mov_b32 s55, 15
    v_mfma_f32_16x16x32_bf16 v[220:223], v[86:89], v[184:187], v[220:223]
    ds_read_b128 v[204:207], v245 offset:256
    s_mul_i32 s55, s55, s31
    v_mfma_f32_16x16x32_bf16 v[224:227], a[248:251], v[184:187], v[224:227]
    s_mov_b32 s57, 3
    v_mov_b32 v187, 0
    s_mul_i32 s57, s57, s31
    v_mfma_f32_16x16x32_bf16 v[208:211], v[104:107], v[170:173], v[208:211]
    s_mul_i32 s59, s31, 4
    s_mul_i32 s51, s31, 4
    s_mov_b32 s53, 15
    v_mfma_f32_16x16x32_bf16 v[228:231], a[176:179], a[240:243], v[228:231]
    s_waitcnt vmcnt(8)
    v_rcp_f32 v225, v224
    v_mfma_f32_16x16x32_bf16 v[228:231], a[180:183], a[244:247], v[228:231]
    s_waitcnt vmcnt(7)
    v_max3_f32 v248, v248, v224, v225
    v_mbcnt_lo_u32_b32 v226, -1, 0
    v_mfma_f32_16x16x32_bf16 v[228:231], a[184:187], a[216:219], v[228:231]
    s_waitcnt lgkmcnt(1)
    v_mbcnt_hi_u32_b32 v226, -1, v226
    v_and_b32 v226, 2, v226
    v_mfma_f32_16x16x32_bf16 v[200:203], v[144:147], v[168:171], v[200:203]
    s_waitcnt vmcnt(6)
    v_cmp_eq_u32 vcc, 2, v226
    v_add_u32 v226, 0xfffdd200, v247
    v_mfma_f32_16x16x32_bf16 v[200:203], v[146:149], v[170:173], v[200:203]
    v_cndmask_b32 v226, 0, v226, vcc
    v_add_u32 v226, 0x22e00, v226
    v_mfma_f32_16x16x32_bf16 v[228:231], a[188:191], a[220:223], v[228:231]
    v_mul_f32 v212, v212, v225
    s_waitcnt lgkmcnt(0)
    v_mfma_f32_16x16x32_bf16 v[204:207], v[108:111], v[168:171], v[204:207]
    v_mul_f32 v213, v213, v225
    v_mul_f32 v214, v214, v225
    v_mfma_f32_16x16x32_bf16 v[204:207], v[110:113], v[170:173], v[204:207]
    v_mul_f32 v215, v215, v225
    v_cvt_pk_bf16_f32 v212, v212, v213
    v_cvt_pk_bf16_f32 v228, v228, v229
    v_cvt_pk_bf16_f32 v229, v230, v231
    ds_write_b64 v249, v[228:229] offset:128
    v_mfma_f32_16x16x32_bf16 v[228:231], a[168:171], a[224:227], 0
    s_waitcnt vmcnt(5)
    v_cvt_pk_bf16_f32 v213, v214, v215
    v_mul_f32 v216, v216, v225
    v_mfma_f32_16x16x32_bf16 v[232:235], a[192:195], a[232:235], 0
    ds_read_b128 a[232:235], v242 offset:6272
    v_mul_f32 v217, v217, v225
    v_mfma_f32_16x16x32_bf16 v[228:231], a[172:175], a[228:231], v[228:231]
    ds_write_b64 v226, v[212:213] offset:0
    v_mul_f32 v218, v218, v225
    v_mul_f32 v219, v219, v225
    v_cvt_pk_bf16_f32 v216, v216, v217
    v_cvt_pk_bf16_f32 v217, v218, v219
    ds_write_b64 v226, v[216:217] offset:128
    v_mul_f32 v220, v220, v225
    v_mul_f32 v221, v221, v225
    v_mul_f32 v222, v222, v225
    v_mul_f32 v223, v223, v225
    v_cvt_pk_bf16_f32 v220, v220, v221
    v_cvt_pk_bf16_f32 v221, v222, v223
    ds_write_b64 v226, v[220:221] offset:256
    v_exp_f32 v208, v208
    v_exp_f32 v209, v209
    v_exp_f32 v210, v210
    v_exp_f32 v211, v211
    v_cvt_pk_bf16_f32 v188, v208, v209
    v_cvt_pk_bf16_f32 v191, v210, v211
    ds_read_b128 v[208:211], v246 offset:256
    v_exp_f32 v200, v200
    v_exp_f32 v201, v201
    v_exp_f32 v202, v202
    v_exp_f32 v203, v203
    v_cvt_pk_bf16_f32 v180, v200, v201
    v_cvt_pk_bf16_f32 v183, v202, v203
    ds_read_b128 v[200:203], v245 offset:320
    v_exp_f32 v204, v204
    v_exp_f32 v205, v205
    v_exp_f32 v206, v206
    v_exp_f32 v207, v207
    v_cvt_pk_bf16_f32 v194, v204, v205
    v_cvt_pk_bf16_f32 v181, v206, v207
    ds_read_b128 v[204:207], v246 offset:320
    s_waitcnt vmcnt(4) lgkmcnt(3)
    v_mfma_f32_16x16x32_bf16 v[232:235], a[196:199], a[236:239], v[232:235]
    ds_read_b128 a[236:239], v243 offset:6272
    s_waitcnt vmcnt(3)
    v_mfma_f32_16x16x32_bf16 v[232:235], a[200:203], a[240:243], v[232:235]
    ds_read_b128 a[240:243], v242 offset:6400
    s_waitcnt vmcnt(2)
    v_mfma_f32_16x16x32_bf16 v[232:235], a[204:207], a[244:247], v[232:235]
    ds_read_b128 a[244:247], v243 offset:6400
    v_mfma_f32_16x16x32_bf16 v[236:239], a[152:155], a[232:235], v[236:239]
    v_mfma_f32_16x16x32_bf16 v[228:231], a[176:179], a[232:235], v[228:231]
    s_waitcnt vmcnt(1) lgkmcnt(4)
    v_mfma_f32_16x16x32_bf16 v[200:203], v[162:165], v[168:171], v[200:203]
    v_mfma_f32_16x16x32_bf16 v[200:203], v[164:167], v[170:173], v[200:203]
    v_mfma_f32_16x16x32_bf16 v[232:235], a[208:211], a[216:219], v[232:235]
    ds_read_b128 a[216:219], v240 offset:0
    s_nop 5
    v_exp_f32 v200, v200
    v_exp_f32 v201, v201
    s_waitcnt vmcnt(0) lgkmcnt(2)
    v_mfma_f32_16x16x32_bf16 v[232:235], a[212:215], a[220:223], v[232:235]
    ds_read_b128 a[220:223], v241 offset:0
    v_cvt_pk_bf16_f32 v184, v200, v201
    v_mfma_f32_16x16x32_bf16 v[236:239], a[156:159], a[236:239], v[236:239]
    ds_read_b128 v[200:203], v246 offset:0
    v_mfma_f32_16x16x32_bf16 v[236:239], a[160:163], a[240:243], v[236:239]
    s_waitcnt lgkmcnt(3)
    v_mfma_f32_16x16x32_bf16 v[236:239], a[164:167], a[244:247], v[236:239]
    v_mfma_f32_16x16x32_bf16 v[228:231], a[180:183], a[236:239], v[228:231]
    v_cvt_pk_bf16_f32 v232, v232, v233
    v_cvt_pk_bf16_f32 v233, v234, v235
    v_mfma_f32_16x16x32_bf16 v[228:231], a[184:187], a[240:243], v[228:231]
    ds_write_b64 v249, v[232:233] offset:256
    v_mfma_f32_16x16x32_bf16 v[228:231], a[188:191], a[244:247], v[228:231]
    v_mfma_f32_16x16x32_bf16 v[232:235], a[192:195], a[224:227], 0
    ds_read_b128 a[224:227], v240 offset:128
    v_cvt_pk_bf16_f32 v236, v236, v237
    v_mfma_f32_16x16x32_bf16 v[232:235], a[196:199], a[228:231], v[232:235]
    ds_read_b128 a[228:231], v241 offset:128
    v_cvt_pk_bf16_f32 v237, v238, v239
    v_mfma_f32_16x16x32_bf16 v[232:235], a[200:203], a[232:235], v[232:235]
    ds_read_b128 a[232:235], v240 offset:256
    v_cvt_pk_bf16_f32 v228, v228, v229
    v_mfma_f32_16x16x32_bf16 v[232:235], a[204:207], a[236:239], v[232:235]
    ds_read_b128 a[236:239], v241 offset:256
    v_cvt_pk_bf16_f32 v229, v230, v231
    v_mfma_f32_16x16x32_bf16 v[232:235], a[208:211], a[240:243], v[232:235]
    v_mfma_f32_16x16x32_bf16 v[232:235], a[212:215], a[244:247], v[232:235]
    s_nop 7
    v_cvt_pk_bf16_f32 v232, v232, v233
    v_cvt_pk_bf16_f32 v233, v234, v235
    s_waitcnt lgkmcnt(4)
    s_barrier
    ds_write_b64 v249, v[236:237] offset:6144
    v_mfma_f32_16x16x32_bf16 v[236:239], a[0:3], a[216:219], 0
    ds_write_b64 v249, v[228:229] offset:6272
    v_mfma_f32_16x16x32_bf16 v[236:239], a[4:7], a[220:223], v[236:239]
    ds_write_b64 v249, v[232:233] offset:6400
    v_mfma_f32_16x16x32_bf16 v[228:231], a[24:27], a[216:219], 0
    ds_read_b128 a[240:243], v242 offset:12288
    s_waitcnt lgkmcnt(4)
    v_mfma_f32_16x16x32_bf16 v[236:239], a[8:11], a[224:227], v[236:239]
    ds_read_b128 a[244:247], v243 offset:12288
    v_mfma_f32_16x16x32_bf16 v[236:239], a[12:15], a[228:231], v[236:239]
    ds_read_b128 a[252:255], v252 offset:0
    v_mfma_f32_16x16x32_bf16 v[236:239], a[16:19], a[232:235], v[236:239]
    ds_read_b64 v[254:255], v253 offset:256
    v_mfma_f32_16x16x32_bf16 v[236:239], a[20:23], a[236:239], v[236:239]
    v_mfma_f32_16x16x32_bf16 v[228:231], a[28:31], a[220:223], v[228:231]
    v_mfma_f32_16x16x32_bf16 v[228:231], a[32:35], a[224:227], v[228:231]
    v_mfma_f32_16x16x32_bf16 v[228:231], a[36:39], a[228:231], v[228:231]
    v_mfma_f32_16x16x32_bf16 v[228:231], a[40:43], a[232:235], v[228:231]
    v_mfma_f32_16x16x32_bf16 v[228:231], a[44:47], a[236:239], v[228:231]
    v_mfma_f32_16x16x32_bf16 v[232:235], a[48:51], a[216:219], 0
    v_mfma_f32_16x16x32_bf16 v[232:235], a[52:55], a[220:223], v[232:235]
    s_waitcnt lgkmcnt(1)
    v_cvt_pk_bf16_f32 v126, v236, v237
    v_cvt_pk_bf16_f32 v127, v238, v239
    v_mfma_f32_16x16x32_bf16 v[232:235], a[56:59], a[224:227], v[232:235]
    buffer_store_dwordx4 a[252:255], v250, s[20:23], 0 offen nt
    v_mfma_f32_16x16x32_bf16 v[232:235], a[60:63], a[228:231], v[232:235]
    s_waitcnt lgkmcnt(0)
    v_cvt_pk_bf16_f32 v128, v228, v229
    v_cvt_pk_bf16_f32 v129, v230, v231
    v_mfma_f32_16x16x32_bf16 v[232:235], a[64:67], a[232:235], v[232:235]
    v_add_u32 v250, s54, v250
    v_mfma_f32_16x16x32_bf16 v[196:199], v[126:129], v[168:171], v[196:199]
    v_mfma_f32_16x16x32_bf16 v[232:235], a[68:71], a[236:239], v[232:235]
    buffer_store_dwordx2 v[254:255], v251, s[20:23], 0 offen offset:256 nt
    v_mfma_f32_16x16x32_bf16 v[236:239], a[216:219], a[72:75], 0
    v_add_u32 v251, s54, v251
    s_add_u32 s54, s28, 3
    v_mfma_f32_16x16x32_bf16 v[236:239], a[220:223], a[76:79], v[236:239]
    s_mul_i32 s54, s54, s30
    s_add_u32 s54, s54, s55
    s_add_u32 s54, s54, s32
    v_mfma_f32_16x16x32_bf16 v[236:239], a[224:227], a[80:83], v[236:239]
    s_lshr_b32 s55, s28, 1
    v_cvt_pk_bf16_f32 v130, v232, v233
    v_cvt_pk_bf16_f32 v131, v234, v235
    v_mfma_f32_16x16x32_bf16 v[236:239], a[228:231], a[84:87], v[236:239]
    s_lshl2_add_u32 s55, s55, 3
    s_mul_i32 s55, s55, s31
    v_mfma_f32_16x16x32_bf16 v[196:199], v[128:131], v[170:173], v[196:199]
    v_mfma_f32_16x16x32_bf16 v[236:239], a[232:235], a[88:91], v[236:239]
    v_mfma_f32_16x16x32_bf16 v[236:239], a[236:239], a[92:95], v[236:239]
    v_mfma_f32_16x16x32_bf16 v[228:231], a[216:219], a[96:99], 0
    v_mfma_f32_16x16x32_bf16 v[228:231], a[220:223], a[100:103], v[228:231]
    v_mfma_f32_16x16x32_bf16 v[228:231], a[224:227], a[104:107], v[228:231]
    v_mfma_f32_16x16x32_bf16 v[228:231], a[228:231], a[108:111], v[228:231]
    v_mfma_f32_16x16x32_bf16 v[228:231], a[232:235], a[112:115], v[228:231]
    v_mfma_f32_16x16x32_bf16 v[228:231], a[236:239], a[116:119], v[228:231]
    v_exp_f32 v196, v196
    v_mfma_f32_16x16x32_bf16 v[232:235], a[216:219], a[120:123], 0
    ds_read_b128 a[216:219], v242 offset:12416
    v_cvt_pk_bf16_f32 v1, v236, v237
    v_mfma_f32_16x16x32_bf16 v[232:235], a[220:223], a[124:127], v[232:235]
    ds_read_b128 a[220:223], v243 offset:12416
    v_cvt_pk_bf16_f32 v4, v238, v239
    v_mfma_f32_16x16x32_bf16 v[232:235], a[224:227], a[128:131], v[232:235]
    ds_read_b128 a[224:227], v242 offset:12544
    v_cvt_pk_bf16_f32 v31, v228, v229
    v_mfma_f32_16x16x32_bf16 v[232:235], a[228:231], a[132:135], v[232:235]
    ds_read_b128 a[228:231], v243 offset:12544
    v_cvt_pk_bf16_f32 v34, v230, v231
    v_mfma_f32_16x16x32_bf16 v[232:235], a[232:235], a[136:139], v[232:235]
    v_add_u32 v242, 0xfffe9800, v242
    v_add_u32 v243, 0xfffe9800, v243
    v_mfma_f32_16x16x32_bf16 v[232:235], a[236:239], a[140:143], v[232:235]
    v_exp_f32 v197, v197
    v_mfma_f32_16x16x32_bf16 v[236:239], a[144:147], a[240:243], 0
    v_exp_f32 v198, v198
    v_mfma_f32_16x16x32_bf16 v[236:239], a[148:151], a[244:247], v[236:239]
    v_exp_f32 v199, v199
    v_mfma_f32_16x16x32_bf16 v[228:231], a[168:171], a[240:243], 0
    v_cvt_pk_bf16_f32 v189, v196, v197
    v_cvt_pk_bf16_f32 v192, v198, v199
    v_mfma_f32_16x16x32_bf16 v[228:231], a[172:175], a[244:247], v[228:231]
    ds_read_b128 v[196:199], v244 offset:320
    v_cvt_pk_bf16_f32 v61, v232, v233
    v_mfma_f32_16x16x32_bf16 v[212:215], v[0:3], v[188:191], 0
    s_waitcnt lgkmcnt(3)
    v_cvt_pk_bf16_f32 v64, v234, v235
    v_mfma_f32_16x16x32_bf16 v[216:219], v[30:33], v[188:191], 0
    v_mfma_f32_16x16x32_bf16 v[220:223], v[60:63], v[188:191], 0
    s_waitcnt lgkmcnt(1)
    s_barrier
    v_mfma_f32_16x16x32_bf16 v[224:227], a[248:251], v[188:191], 0
    ds_read_b128 a[232:235], v242 offset:6144
    v_mfma_f32_16x16x32_bf16 v[236:239], a[152:155], a[216:219], v[236:239]
    ds_read_b128 a[236:239], v243 offset:6144
    v_mfma_f32_16x16x32_bf16 v[236:239], a[156:159], a[220:223], v[236:239]
    ds_read_b128 a[252:255], v252 offset:6144
    v_mfma_f32_16x16x32_bf16 v[236:239], a[160:163], a[224:227], v[236:239]
    ds_read_b64 v[254:255], v253 offset:6400
    v_mfma_f32_16x16x32_bf16 v[236:239], a[164:167], a[228:231], v[236:239]
    v_mfma_f32_16x16x32_bf16 v[228:231], a[176:179], a[216:219], v[228:231]
    s_waitcnt lgkmcnt(4)
    v_mfma_f32_16x16x32_bf16 v[196:199], v[150:153], v[168:171], v[196:199]
    v_mfma_f32_16x16x32_bf16 v[196:199], v[152:155], v[170:173], v[196:199]
    v_mfma_f32_16x16x32_bf16 v[228:231], a[180:183], a[220:223], v[228:231]
    v_mfma_f32_16x16x32_bf16 v[228:231], a[184:187], a[224:227], v[228:231]
    v_mfma_f32_16x16x32_bf16 v[228:231], a[188:191], a[228:231], v[228:231]
    v_mfma_f32_16x16x32_bf16 v[232:235], a[192:195], a[240:243], 0
    ds_read_b128 a[240:243], v242 offset:6272
    v_cvt_pk_bf16_f32 v236, v236, v237
    v_mfma_f32_16x16x32_bf16 v[232:235], a[196:199], a[244:247], v[232:235]
    ds_read_b128 a[244:247], v243 offset:6272
    v_cvt_pk_bf16_f32 v237, v238, v239
    v_mfma_f32_16x16x32_bf16 v[232:235], a[200:203], a[216:219], v[232:235]
    ds_write_b64 v249, v[236:237] offset:12288
    v_mfma_f32_16x16x32_bf16 v[232:235], a[204:207], a[220:223], v[232:235]
    ds_read_b128 a[216:219], v242 offset:6400
    v_cvt_pk_bf16_f32 v228, v228, v229
    v_mfma_f32_16x16x32_bf16 v[232:235], a[208:211], a[224:227], v[232:235]
    ds_read_b128 a[220:223], v243 offset:6400
    v_cvt_pk_bf16_f32 v229, v230, v231
    v_mfma_f32_16x16x32_bf16 v[232:235], a[212:215], a[228:231], v[232:235]
    s_waitcnt lgkmcnt(5)
    v_exp_f32 v196, v196
    v_mfma_f32_16x16x32_bf16 v[236:239], a[144:147], a[232:235], 0
    ds_write_b64 v249, v[228:229] offset:12416
    v_mfma_f32_16x16x32_bf16 v[236:239], a[148:151], a[236:239], v[236:239]
    ds_read_b128 a[224:227], v240 offset:1536
    v_mfma_f32_16x16x32_bf16 v[228:231], a[168:171], a[232:235], 0
    ds_read_b128 a[228:231], v241 offset:1536
    v_cvt_pk_bf16_f32 v232, v232, v233
    v_mfma_f32_16x16x32_bf16 v[228:231], a[172:175], a[236:239], v[228:231]
    s_waitcnt lgkmcnt(6)
    v_cvt_pk_bf16_f32 v233, v234, v235
    v_mfma_f32_16x16x32_bf16 v[236:239], a[152:155], a[240:243], v[236:239]
    ds_write_b64 v249, v[232:233] offset:12544
    v_mfma_f32_16x16x32_bf16 v[236:239], a[156:159], a[244:247], v[236:239]
    buffer_store_dwordx4 a[252:255], v250, s[20:23], 0 offen nt
    v_mfma_f32_16x16x32_bf16 v[228:231], a[176:179], a[240:243], v[228:231]
    s_waitcnt lgkmcnt(4)
    v_add_u32 v249, 0xfffe9800, v249
    v_add_u32 v250, s56, v250
    v_mfma_f32_16x16x32_bf16 v[236:239], a[160:163], a[216:219], v[236:239]
    v_exp_f32 v197, v197
    v_mfma_f32_16x16x32_bf16 v[236:239], a[164:167], a[220:223], v[236:239]
    v_cvt_pk_bf16_f32 v186, v196, v197
    v_mfma_f32_16x16x32_bf16 v[228:231], a[180:183], a[244:247], v[228:231]
    ds_read_b128 v[196:199], v245 offset:0
    v_mfma_f32_16x16x32_bf16 v[228:231], a[184:187], a[216:219], v[228:231]
    buffer_store_dwordx2 v[254:255], v251, s[20:23], 0 offen offset:256 nt
    v_mfma_f32_16x16x32_bf16 v[228:231], a[188:191], a[220:223], v[228:231]
    s_waitcnt lgkmcnt(1)
    v_add_u32 v251, s56, v251
    v_cvt_pk_bf16_f32 v236, v236, v237
    v_mfma_f32_16x16x32_bf16 v[232:235], a[192:195], a[232:235], 0
    ds_read_b128 a[232:235], v240 offset:1664
    v_cvt_pk_bf16_f32 v237, v238, v239
    v_mfma_f32_16x16x32_bf16 v[232:235], a[196:199], a[236:239], v[232:235]
    ds_read_b128 a[236:239], v241 offset:1664
    v_cvt_pk_bf16_f32 v228, v228, v229
    v_mfma_f32_16x16x32_bf16 v[232:235], a[200:203], a[240:243], v[232:235]
    ds_read_b128 a[240:243], v240 offset:1792
    v_cvt_pk_bf16_f32 v229, v230, v231
    v_mfma_f32_16x16x32_bf16 v[232:235], a[204:207], a[244:247], v[232:235]
    ds_read_b128 a[244:247], v241 offset:1792
    s_barrier
    v_mfma_f32_16x16x32_bf16 v[232:235], a[208:211], a[216:219], v[232:235]
    ds_write_b64 v249, v[236:237] offset:6144
    v_mfma_f32_16x16x32_bf16 v[232:235], a[212:215], a[220:223], v[232:235]
    ds_write_b64 v249, v[228:229] offset:6272
    v_mfma_f32_16x16x32_bf16 v[236:239], a[0:3], a[224:227], 0
    ds_read_b128 a[216:219], v240 offset:3072
    s_add_u32 s56, s28, 11
    v_mfma_f32_16x16x32_bf16 v[236:239], a[4:7], a[228:231], v[236:239]
    ds_read_b128 a[220:223], v241 offset:3072
    s_mul_i32 s56, s56, s30
    v_mfma_f32_16x16x32_bf16 v[228:231], a[24:27], a[224:227], 0
    ds_read_b128 a[252:255], v252 offset:12288
    v_cvt_pk_bf16_f32 v232, v232, v233
    v_mfma_f32_16x16x32_bf16 v[228:231], a[28:31], a[228:231], v[228:231]
    s_waitcnt lgkmcnt(7)
    v_cvt_pk_bf16_f32 v233, v234, v235
    v_add_u32 v252, 0xfffe9800, v252
    v_mfma_f32_16x16x32_bf16 v[196:199], v[108:111], v[174:177], v[196:199]
    ds_write_b64 v249, v[232:233] offset:6400
    v_mfma_f32_16x16x32_bf16 v[196:199], v[110:113], v[176:179], v[196:199]
    ds_read_b64 v[254:255], v253 offset:12544
    v_add_u32 v253, 0xfffe9800, v253
    v_mfma_f32_16x16x32_bf16 v[236:239], a[8:11], a[232:235], v[236:239]
    s_add_u32 s56, s56, s57
    s_add_u32 s56, s56, s32
    s_lshr_b32 s57, s28, 1
    v_mfma_f32_16x16x32_bf16 v[236:239], a[12:15], a[236:239], v[236:239]
    s_lshl2_add_u32 s57, s57, 11
    v_exp_f32 v196, v196
    v_mfma_f32_16x16x32_bf16 v[228:231], a[32:35], a[232:235], v[228:231]
    s_waitcnt lgkmcnt(5)
    v_exp_f32 v197, v197
    v_mfma_f32_16x16x32_bf16 v[236:239], a[16:19], a[240:243], v[236:239]
    v_exp_f32 v198, v198
    v_mfma_f32_16x16x32_bf16 v[236:239], a[20:23], a[244:247], v[236:239]
    v_exp_f32 v199, v199
    v_mfma_f32_16x16x32_bf16 v[228:231], a[36:39], a[236:239], v[228:231]
    s_waitcnt lgkmcnt(2)
    v_cvt_pk_bf16_f32 v188, v196, v197
    v_cvt_pk_bf16_f32 v191, v198, v199
    v_mfma_f32_16x16x32_bf16 v[228:231], a[40:43], a[240:243], v[228:231]
    ds_read_b128 v[196:199], v246 offset:64
    v_mfma_f32_16x16x32_bf16 v[228:231], a[44:47], a[244:247], v[228:231]
    buffer_store_dwordx4 a[252:255], v250, s[20:23], 0 offen nt
    v_mfma_f32_16x16x32_bf16 v[232:235], a[48:51], a[224:227], 0
    s_waitcnt lgkmcnt(1)
    v_cvt_pk_bf16_f32 v132, v236, v237
    v_cvt_pk_bf16_f32 v133, v238, v239
    v_mfma_f32_16x16x32_bf16 v[232:235], a[52:55], a[228:231], v[232:235]
    v_add_u32 v250, s58, v250
    v_mfma_f32_16x16x32_bf16 v[232:235], a[56:59], a[232:235], v[232:235]
    v_cvt_pk_bf16_f32 v134, v228, v229
    v_cvt_pk_bf16_f32 v135, v230, v231
    v_mfma_f32_16x16x32_bf16 v[232:235], a[60:63], a[236:239], v[232:235]
    buffer_store_dwordx2 v[254:255], v251, s[20:23], 0 offen offset:256 nt
    v_mfma_f32_16x16x32_bf16 v[208:211], v[132:135], v[168:171], v[208:211]
    v_add_u32 v251, s58, v251
    s_mul_i32 s58, s30, 0
    v_mfma_f32_16x16x32_bf16 v[200:203], v[132:135], v[174:177], v[200:203]
    s_add_u32 s58, s58, s59
    v_mfma_f32_16x16x32_bf16 v[232:235], a[64:67], a[240:243], v[232:235]
    v_mfma_f32_16x16x32_bf16 v[232:235], a[68:71], a[244:247], v[232:235]
    v_mfma_f32_16x16x32_bf16 v[236:239], a[224:227], a[72:75], 0
    v_mfma_f32_16x16x32_bf16 v[236:239], a[228:231], a[76:79], v[236:239]
    v_mfma_f32_16x16x32_bf16 v[236:239], a[232:235], a[80:83], v[236:239]
    v_mfma_f32_16x16x32_bf16 v[236:239], a[236:239], a[84:87], v[236:239]
    v_mfma_f32_16x16x32_bf16 v[236:239], a[240:243], a[88:91], v[236:239]
    v_mfma_f32_16x16x32_bf16 v[236:239], a[244:247], a[92:95], v[236:239]
    v_mfma_f32_16x16x32_bf16 v[228:231], a[224:227], a[96:99], 0
    v_mfma_f32_16x16x32_bf16 v[228:231], a[228:231], a[100:103], v[228:231]
    v_cvt_pk_bf16_f32 v136, v232, v233
    v_cvt_pk_bf16_f32 v137, v234, v235
    v_mfma_f32_16x16x32_bf16 v[228:231], a[232:235], a[104:107], v[228:231]
    v_mfma_f32_16x16x32_bf16 v[228:231], a[236:239], a[108:111], v[228:231]
    v_mfma_f32_16x16x32_bf16 v[208:211], v[134:137], v[170:173], v[208:211]
    v_mfma_f32_16x16x32_bf16 v[200:203], v[134:137], v[176:179], v[200:203]
    v_cvt_pk_bf16_f32 v7, v236, v237
    v_cvt_pk_bf16_f32 v10, v238, v239
    v_mfma_f32_16x16x32_bf16 v[228:231], a[240:243], a[112:115], v[228:231]
    v_mfma_f32_16x16x32_bf16 v[228:231], a[244:247], a[116:119], v[228:231]
    v_mfma_f32_16x16x32_bf16 v[232:235], a[224:227], a[120:123], 0
    ds_read_b128 a[224:227], v240 offset:3200
    v_mfma_f32_16x16x32_bf16 v[232:235], a[228:231], a[124:127], v[232:235]
    ds_read_b128 a[228:231], v241 offset:3200
    v_mfma_f32_16x16x32_bf16 v[232:235], a[232:235], a[128:131], v[232:235]
    ds_read_b128 a[232:235], v240 offset:3328
    v_mfma_f32_16x16x32_bf16 v[232:235], a[236:239], a[132:135], v[232:235]
    ds_read_b128 a[236:239], v241 offset:3328
    v_cvt_pk_bf16_f32 v37, v228, v229
    v_mfma_f32_16x16x32_bf16 v[232:235], a[240:243], a[136:139], v[232:235]
    ds_read_b128 a[240:243], v242 offset:12288
    v_cvt_pk_bf16_f32 v40, v230, v231
    v_mfma_f32_16x16x32_bf16 v[232:235], a[244:247], a[140:143], v[232:235]
    ds_read_b128 a[244:247], v243 offset:12288
    v_mfma_f32_16x16x32_bf16 v[236:239], a[0:3], a[216:219], 0
    v_exp_f32 v208, v208
    v_mfma_f32_16x16x32_bf16 v[236:239], a[4:7], a[220:223], v[236:239]
    v_exp_f32 v209, v209
    v_mfma_f32_16x16x32_bf16 v[228:231], a[24:27], a[216:219], 0
    v_exp_f32 v210, v210
    v_mfma_f32_16x16x32_bf16 v[228:231], a[28:31], a[220:223], v[228:231]
    s_waitcnt lgkmcnt(5)
    v_cvt_pk_bf16_f32 v67, v232, v233
    v_cvt_pk_bf16_f32 v70, v234, v235
    v_mfma_f32_16x16x32_bf16 v[236:239], a[8:11], a[224:227], v[236:239]
    s_waitcnt lgkmcnt(4)
    v_exp_f32 v211, v211
    v_mfma_f32_16x16x32_bf16 v[236:239], a[12:15], a[228:231], v[236:239]
    s_waitcnt lgkmcnt(3)
    v_cvt_pk_bf16_f32 v195, v208, v209
    v_cvt_pk_bf16_f32 v182, v210, v211
    v_mfma_f32_16x16x32_bf16 v[236:239], a[16:19], a[232:235], v[236:239]
    ds_read_b128 v[208:211], v244 offset:0
    s_waitcnt lgkmcnt(2)
    v_mfma_f32_16x16x32_bf16 v[212:215], v[4:7], v[192:195], v[212:215]
    v_exp_f32 v200, v200
    v_mfma_f32_16x16x32_bf16 v[216:219], v[34:37], v[192:195], v[216:219]
    v_exp_f32 v201, v201
    v_mfma_f32_16x16x32_bf16 v[220:223], v[64:67], v[192:195], v[220:223]
    v_exp_f32 v202, v202
    v_mfma_f32_16x16x32_bf16 v[224:227], a[248:251], v[192:195], v[224:227]
    v_exp_f32 v203, v203
    v_mfma_f32_16x16x32_bf16 v[212:215], v[8:11], v[180:183], v[212:215]
    v_cvt_pk_bf16_f32 v189, v200, v201
    v_cvt_pk_bf16_f32 v192, v202, v203
    v_mfma_f32_16x16x32_bf16 v[216:219], v[38:41], v[180:183], v[216:219]
    ds_read_b128 v[200:203], v244 offset:128
    v_mfma_f32_16x16x32_bf16 v[220:223], v[68:71], v[180:183], v[220:223]
    v_mfma_f32_16x16x32_bf16 v[224:227], a[248:251], v[180:183], v[224:227]
    v_mfma_f32_16x16x32_bf16 v[236:239], a[20:23], a[236:239], v[236:239]
    s_waitcnt lgkmcnt(1)
    v_mfma_f32_16x16x32_bf16 v[208:211], v[144:147], v[174:177], v[208:211]
    v_mfma_f32_16x16x32_bf16 v[208:211], v[146:149], v[176:179], v[208:211]
    v_mfma_f32_16x16x32_bf16 v[228:231], a[32:35], a[224:227], v[228:231]
    v_mfma_f32_16x16x32_bf16 v[228:231], a[36:39], a[228:231], v[228:231]
    v_mfma_f32_16x16x32_bf16 v[228:231], a[40:43], a[232:235], v[228:231]
    v_mfma_f32_16x16x32_bf16 v[228:231], a[44:47], a[236:239], v[228:231]
    s_waitcnt lgkmcnt(0)
    v_cvt_pk_bf16_f32 v90, v236, v237
    v_cvt_pk_bf16_f32 v91, v238, v239
    v_mfma_f32_16x16x32_bf16 v[200:203], v[156:159], v[174:177], v[200:203]
    v_exp_f32 v208, v208
    v_mfma_f32_16x16x32_bf16 v[200:203], v[158:161], v[176:179], v[200:203]
    v_exp_f32 v209, v209
    v_mfma_f32_16x16x32_bf16 v[232:235], a[48:51], a[216:219], 0
    v_cvt_pk_bf16_f32 v92, v228, v229
    v_cvt_pk_bf16_f32 v93, v230, v231
    v_mfma_f32_16x16x32_bf16 v[232:235], a[52:55], a[220:223], v[232:235]
    v_exp_f32 v210, v210
    v_mfma_f32_16x16x32_bf16 v[204:207], v[90:93], v[168:171], v[204:207]
    ds_read_b64 v[168:169], v247 offset:36864
    v_cvt_pk_bf16_f32 v190, v208, v209
    v_mfma_f32_16x16x32_bf16 v[196:199], v[90:93], v[174:177], v[196:199]
    v_exp_f32 v211, v211
    v_mfma_f32_16x16x32_bf16 v[232:235], a[56:59], a[224:227], v[232:235]
    v_exp_f32 v200, v200
    v_mfma_f32_16x16x32_bf16 v[232:235], a[60:63], a[228:231], v[232:235]
    v_exp_f32 v201, v201
    v_mfma_f32_16x16x32_bf16 v[232:235], a[64:67], a[232:235], v[232:235]
    v_cvt_pk_bf16_f32 v193, v210, v211
    v_mfma_f32_16x16x32_bf16 v[232:235], a[68:71], a[236:239], v[232:235]
    ds_read_b128 v[208:211], v245 offset:64
    v_mfma_f32_16x16x32_bf16 v[236:239], a[216:219], a[72:75], 0
    v_mfma_f32_16x16x32_bf16 v[236:239], a[220:223], a[76:79], v[236:239]
    v_mfma_f32_16x16x32_bf16 v[236:239], a[224:227], a[80:83], v[236:239]
    v_mfma_f32_16x16x32_bf16 v[236:239], a[228:231], a[84:87], v[236:239]
    v_mfma_f32_16x16x32_bf16 v[236:239], a[232:235], a[88:91], v[236:239]
    v_mfma_f32_16x16x32_bf16 v[236:239], a[236:239], a[92:95], v[236:239]
    v_mfma_f32_16x16x32_bf16 v[228:231], a[216:219], a[96:99], 0
    v_cvt_pk_bf16_f32 v94, v232, v233
    v_cvt_pk_bf16_f32 v95, v234, v235
    v_mfma_f32_16x16x32_bf16 v[228:231], a[220:223], a[100:103], v[228:231]
    v_mfma_f32_16x16x32_bf16 v[228:231], a[224:227], a[104:107], v[228:231]
    s_waitcnt lgkmcnt(0)
    v_mfma_f32_16x16x32_bf16 v[204:207], v[92:95], v[170:173], v[204:207]
    ds_read_b64 v[170:171], v247 offset:36992
    v_cvt_pk_bf16_f32 v13, v236, v237
    v_mfma_f32_16x16x32_bf16 v[208:211], v[162:165], v[174:177], v[208:211]
    ds_read_b64 v[172:173], v247 offset:37120
    v_cvt_pk_bf16_f32 v16, v238, v239
    v_mfma_f32_16x16x32_bf16 v[208:211], v[164:167], v[176:179], v[208:211]
    v_mfma_f32_16x16x32_bf16 v[196:199], v[92:95], v[176:179], v[196:199]
    v_mfma_f32_16x16x32_bf16 v[228:231], a[228:231], a[108:111], v[228:231]
    v_exp_f32 v204, v204
    v_mfma_f32_16x16x32_bf16 v[228:231], a[232:235], a[112:115], v[228:231]
    v_exp_f32 v205, v205
    v_mfma_f32_16x16x32_bf16 v[228:231], a[236:239], a[116:119], v[228:231]
    v_cvt_pk_bf16_f32 v185, v204, v205
    v_mfma_f32_16x16x32_bf16 v[232:235], a[216:219], a[120:123], 0
    ds_read_b128 a[216:219], v242 offset:12416
    v_mfma_f32_16x16x32_bf16 v[212:215], v[12:15], v[184:187], v[212:215]
    ds_read_b128 v[204:207], v244 offset:64
    v_mfma_f32_16x16x32_bf16 v[224:227], a[248:251], v[184:187], v[224:227]
    v_exp_f32 v208, v208
    v_mfma_f32_16x16x32_bf16 v[232:235], a[220:223], a[124:127], v[232:235]
    ds_read_b128 a[220:223], v243 offset:12416
    v_cvt_pk_bf16_f32 v43, v228, v229
    v_mfma_f32_16x16x32_bf16 v[232:235], a[224:227], a[128:131], v[232:235]
    ds_read_b128 a[224:227], v242 offset:12544
    v_cvt_pk_bf16_f32 v46, v230, v231
    v_mfma_f32_16x16x32_bf16 v[216:219], v[42:45], v[184:187], v[216:219]
    v_rcp_f32 v225, v224
    v_mfma_f32_16x16x32_bf16 v[232:235], a[228:231], a[132:135], v[232:235]
    ds_read_b128 a[228:231], v243 offset:12544
    v_max3_f32 v248, v248, v224, v225
    v_mfma_f32_16x16x32_bf16 v[232:235], a[232:235], a[136:139], v[232:235]
    ds_read_b128 a[232:235], v240 offset:4608
    v_mul_f32 v212, v212, v225
    v_mfma_f32_16x16x32_bf16 v[232:235], a[236:239], a[140:143], v[232:235]
    ds_read_b128 a[236:239], v241 offset:4608
    v_mul_f32 v213, v213, v225
    v_mfma_f32_16x16x32_bf16 v[236:239], a[144:147], a[240:243], 0
    v_mul_f32 v214, v214, v225
    v_mul_f32 v215, v215, v225
    v_mfma_f32_16x16x32_bf16 v[236:239], a[148:151], a[244:247], v[236:239]
    s_waitcnt lgkmcnt(5)
    v_cvt_pk_bf16_f32 v212, v212, v213
    v_cvt_pk_bf16_f32 v73, v232, v233
    v_mfma_f32_16x16x32_bf16 v[204:207], v[150:153], v[174:177], v[204:207]
    v_cvt_pk_bf16_f32 v76, v234, v235
    v_cvt_pk_bf16_f32 v213, v214, v215
    v_mfma_f32_16x16x32_bf16 v[220:223], v[72:75], v[184:187], v[220:223]
    ds_write_b64 v247, v[212:213] offset:24576
    v_mfma_f32_16x16x32_bf16 v[212:215], v[6:9], v[188:191], 0
    v_mul_f32 v216, v216, v225
    v_mul_f32 v217, v217, v225
    v_mfma_f32_16x16x32_bf16 v[204:207], v[152:155], v[176:179], v[204:207]
    s_waitcnt lgkmcnt(3)
    v_mul_f32 v218, v218, v225
    v_mul_f32 v219, v219, v225
    v_mfma_f32_16x16x32_bf16 v[236:239], a[152:155], a[216:219], v[236:239]
    s_barrier
    v_cvt_pk_bf16_f32 v216, v216, v217
    v_cvt_pk_bf16_f32 v217, v218, v219
    v_mfma_f32_16x16x32_bf16 v[236:239], a[156:159], a[220:223], v[236:239]
    ds_read_b128 a[252:255], v252 offset:6144
    v_mul_f32 v220, v220, v225
    v_mfma_f32_16x16x32_bf16 v[236:239], a[160:163], a[224:227], v[236:239]
    ds_read_b64 v[254:255], v253 offset:6400
    v_mul_f32 v221, v221, v225
    v_mfma_f32_16x16x32_bf16 v[236:239], a[164:167], a[228:231], v[236:239]
    ds_write_b64 v247, v[216:217] offset:24704
    v_mfma_f32_16x16x32_bf16 v[216:219], v[36:39], v[188:191], 0
    v_mul_f32 v222, v222, v225
    v_mul_f32 v223, v223, v225
    v_mfma_f32_16x16x32_bf16 v[224:227], a[248:251], v[188:191], 0
    v_cvt_pk_bf16_f32 v220, v220, v221
    v_cvt_pk_bf16_f32 v221, v222, v223
    v_mfma_f32_16x16x32_bf16 v[228:231], a[168:171], a[240:243], 0
    ds_write_b64 v247, v[220:221] offset:24832
    v_mfma_f32_16x16x32_bf16 v[220:223], v[66:69], v[188:191], 0
    v_cvt_pk_bf16_f32 v236, v236, v237
    v_cvt_pk_bf16_f32 v237, v238, v239
    v_mfma_f32_16x16x32_bf16 v[228:231], a[172:175], a[244:247], v[228:231]
    ds_write_b64 v249, v[236:237] offset:12288
    v_mfma_f32_16x16x32_bf16 v[228:231], a[176:179], a[216:219], v[228:231]
    s_waitcnt lgkmcnt(4)
    v_exp_f32 v204, v204
    v_mfma_f32_16x16x32_bf16 v[228:231], a[180:183], a[220:223], v[228:231]
    buffer_store_dwordx4 a[252:255], v250, s[20:23], 0 offen nt
    v_mfma_f32_16x16x32_bf16 v[228:231], a[184:187], a[224:227], v[228:231]
    s_waitcnt lgkmcnt(2)
    v_add_u32 v250, s50, v250
    v_cvt_pk_bf16_f32 v186, v200, v201
    v_mfma_f32_16x16x32_bf16 v[228:231], a[188:191], a[228:231], v[228:231]
    ds_read_b128 v[200:203], v245 offset:0
    v_mfma_f32_16x16x32_bf16 v[232:235], a[192:195], a[240:243], 0
    ds_read_b128 a[240:243], v240 offset:4736
    v_mfma_f32_16x16x32_bf16 v[232:235], a[196:199], a[244:247], v[232:235]
    ds_read_b128 a[244:247], v241 offset:4736
    v_mfma_f32_16x16x32_bf16 v[232:235], a[200:203], a[216:219], v[232:235]
    ds_read_b128 a[216:219], v240 offset:4864
    v_mfma_f32_16x16x32_bf16 v[232:235], a[204:207], a[220:223], v[232:235]
    ds_read_b128 a[220:223], v241 offset:4864
    v_cvt_pk_bf16_f32 v228, v228, v229
    v_mfma_f32_16x16x32_bf16 v[232:235], a[208:211], a[224:227], v[232:235]
    ds_read_b128 a[224:227], v242 offset:18432
    v_cvt_pk_bf16_f32 v229, v230, v231
    v_mfma_f32_16x16x32_bf16 v[232:235], a[212:215], a[228:231], v[232:235]
    ds_write_b64 v249, v[228:229] offset:12416
    v_mfma_f32_16x16x32_bf16 v[236:239], a[0:3], a[232:235], 0
    ds_read_b128 a[228:231], v243 offset:18432
    v_mfma_f32_16x16x32_bf16 v[236:239], a[4:7], a[236:239], v[236:239]
    buffer_store_dwordx2 v[254:255], v251, s[20:23], 0 offen offset:256 nt
    v_mfma_f32_16x16x32_bf16 v[228:231], a[24:27], a[232:235], 0
    s_waitcnt lgkmcnt(6)
    v_exp_f32 v205, v205
    v_mfma_f32_16x16x32_bf16 v[200:203], v[162:165], v[168:171], v[200:203]
    v_cvt_pk_bf16_f32 v232, v232, v233
    v_cvt_pk_bf16_f32 v233, v234, v235
    v_mfma_f32_16x16x32_bf16 v[200:203], v[164:167], v[170:173], v[200:203]
    ds_write_b64 v249, v[232:233] offset:12544
    v_mfma_f32_16x16x32_bf16 v[236:239], a[8:11], a[240:243], v[236:239]
    s_waitcnt lgkmcnt(4)
    v_add_u32 v251, s50, v251
    v_cvt_pk_bf16_f32 v180, v204, v205
    v_mfma_f32_16x16x32_bf16 v[236:239], a[12:15], a[244:247], v[236:239]
    s_mul_i32 s50, s30, 0
    v_exp_f32 v206, v206
    v_mfma_f32_16x16x32_bf16 v[236:239], a[16:19], a[216:219], v[236:239]
    s_add_u32 s50, s50, s51
    v_exp_f32 v207, v207
    v_mfma_f32_16x16x32_bf16 v[236:239], a[20:23], a[220:223], v[236:239]
    v_exp_f32 v209, v209
    v_mfma_f32_16x16x32_bf16 v[228:231], a[28:31], a[236:239], v[228:231]
    v_cvt_pk_bf16_f32 v183, v206, v207
    v_cvt_pk_bf16_f32 v194, v208, v209
    v_mfma_f32_16x16x32_bf16 v[228:231], a[32:35], a[240:243], v[228:231]
    ds_read_b128 v[204:207], v245 offset:128
    v_mfma_f32_16x16x32_bf16 v[228:231], a[36:39], a[244:247], v[228:231]
    v_exp_f32 v210, v210
    v_mfma_f32_16x16x32_bf16 v[228:231], a[40:43], a[216:219], v[228:231]
    v_cvt_pk_bf16_f32 v138, v236, v237
    v_cvt_pk_bf16_f32 v139, v238, v239
    v_mfma_f32_16x16x32_bf16 v[228:231], a[44:47], a[220:223], v[228:231]
    v_exp_f32 v211, v211
    v_mfma_f32_16x16x32_bf16 v[232:235], a[48:51], a[232:235], 0
    v_exp_f32 v196, v196
    v_mfma_f32_16x16x32_bf16 v[232:235], a[52:55], a[236:239], v[232:235]
    v_exp_f32 v197, v197
    v_mfma_f32_16x16x32_bf16 v[232:235], a[56:59], a[240:243], v[232:235]
    v_cvt_pk_bf16_f32 v181, v210, v211
    v_cvt_pk_bf16_f32 v195, v196, v197
    v_mfma_f32_16x16x32_bf16 v[232:235], a[60:63], a[244:247], v[232:235]
    ds_read_b128 v[208:211], v246 offset:128
    v_cvt_pk_bf16_f32 v140, v228, v229
    v_mfma_f32_16x16x32_bf16 v[212:215], v[10:13], v[192:195], v[212:215]
    v_cvt_pk_bf16_f32 v141, v230, v231
    s_waitcnt lgkmcnt(1)
    v_mfma_f32_16x16x32_bf16 v[216:219], v[40:43], v[192:195], v[216:219]
    v_exp_f32 v198, v198
    v_mfma_f32_16x16x32_bf16 v[220:223], v[70:73], v[192:195], v[220:223]
    v_exp_f32 v199, v199
    v_mfma_f32_16x16x32_bf16 v[224:227], a[248:251], v[192:195], v[224:227]
    v_exp_f32 v200, v200
    v_mfma_f32_16x16x32_bf16 v[204:207], v[114:117], v[174:177], v[204:207]
    v_exp_f32 v201, v201
    v_mfma_f32_16x16x32_bf16 v[204:207], v[116:119], v[176:179], v[204:207]
    v_cvt_pk_bf16_f32 v182, v198, v199
    v_cvt_pk_bf16_f32 v188, v200, v201
    v_mfma_f32_16x16x32_bf16 v[232:235], a[64:67], a[216:219], v[232:235]
    ds_read_b128 v[196:199], v244 offset:0
    v_mfma_f32_16x16x32_bf16 v[212:215], v[14:17], v[180:183], v[212:215]
    v_exp_f32 v202, v202
    v_mfma_f32_16x16x32_bf16 v[216:219], v[44:47], v[180:183], v[216:219]
    s_waitcnt lgkmcnt(1)
    v_exp_f32 v204, v204
    v_mfma_f32_16x16x32_bf16 v[220:223], v[74:77], v[180:183], v[220:223]
    v_exp_f32 v205, v205
    v_mfma_f32_16x16x32_bf16 v[224:227], a[248:251], v[180:183], v[224:227]
    v_exp_f32 v203, v203
    v_mfma_f32_16x16x32_bf16 v[208:211], v[138:141], v[174:177], v[208:211]
    ds_read_b64 v[174:175], v247 offset:43008
    v_cvt_pk_bf16_f32 v184, v204, v205
    v_mfma_f32_16x16x32_bf16 v[232:235], a[68:71], a[220:223], v[232:235]
    ds_read_b128 v[204:207], v246 offset:0
    v_cvt_pk_bf16_f32 v191, v202, v203
    v_mfma_f32_16x16x32_bf16 v[236:239], a[232:235], a[72:75], 0
    ds_read_b128 v[200:203], v246 offset:64
    v_mfma_f32_16x16x32_bf16 v[236:239], a[236:239], a[76:79], v[236:239]
    v_mfma_f32_16x16x32_bf16 v[236:239], a[240:243], a[80:83], v[236:239]
    s_waitcnt lgkmcnt(3)
    v_mfma_f32_16x16x32_bf16 v[196:199], v[150:153], v[168:171], v[196:199]
    v_cvt_pk_bf16_f32 v142, v232, v233
    v_cvt_pk_bf16_f32 v143, v234, v235
    v_mfma_f32_16x16x32_bf16 v[196:199], v[152:155], v[170:173], v[196:199]
    v_mfma_f32_16x16x32_bf16 v[236:239], a[244:247], a[84:87], v[236:239]
    v_mfma_f32_16x16x32_bf16 v[208:211], v[140:143], v[176:179], v[208:211]
    ds_read_b64 v[176:177], v247 offset:43136
    v_mfma_f32_16x16x32_bf16 v[236:239], a[216:219], a[88:91], v[236:239]
    ds_read_b64 v[178:179], v247 offset:43264
    s_waitcnt lgkmcnt(3)
    v_mfma_f32_16x16x32_bf16 v[204:207], v[90:93], v[168:171], v[204:207]
    v_mfma_f32_16x16x32_bf16 v[204:207], v[92:95], v[170:173], v[204:207]
    s_waitcnt lgkmcnt(2)
    v_exp_f32 v196, v196
    v_mfma_f32_16x16x32_bf16 v[200:203], v[138:141], v[168:171], v[200:203]
    v_exp_f32 v208, v208
    v_mfma_f32_16x16x32_bf16 v[200:203], v[140:143], v[170:173], v[200:203]
    v_exp_f32 v209, v209
    v_mfma_f32_16x16x32_bf16 v[236:239], a[220:223], a[92:95], v[236:239]
    v_exp_f32 v197, v197
    v_mfma_f32_16x16x32_bf16 v[228:231], a[232:235], a[96:99], 0
    v_cvt_pk_bf16_f32 v185, v208, v209
    v_cvt_pk_bf16_f32 v190, v196, v197
    v_mfma_f32_16x16x32_bf16 v[228:231], a[236:239], a[100:103], v[228:231]
    ds_read_b128 v[208:211], v244 offset:64
    v_mfma_f32_16x16x32_bf16 v[224:227], a[248:251], v[184:187], v[224:227]
    v_exp_f32 v198, v198
    v_mfma_f32_16x16x32_bf16 v[228:231], a[240:243], a[104:107], v[228:231]
    v_cvt_pk_bf16_f32 v19, v236, v237
    v_cvt_pk_bf16_f32 v22, v238, v239
    v_mfma_f32_16x16x32_bf16 v[228:231], a[244:247], a[108:111], v[228:231]
    v_exp_f32 v199, v199
    v_mfma_f32_16x16x32_bf16 v[212:215], v[18:21], v[184:187], v[212:215]
    v_exp_f32 v204, v204
    v_mfma_f32_16x16x32_bf16 v[228:231], a[216:219], a[112:115], v[228:231]
    v_rcp_f32 v225, v224
    v_mfma_f32_16x16x32_bf16 v[228:231], a[220:223], a[116:119], v[228:231]
    v_max3_f32 v248, v248, v224, v225
    v_cvt_pk_bf16_f32 v193, v198, v199
    v_mfma_f32_16x16x32_bf16 v[232:235], a[232:235], a[120:123], 0
    ds_read_b128 a[232:235], v242 offset:18560
    v_mul_f32 v212, v212, v225
    v_mfma_f32_16x16x32_bf16 v[232:235], a[236:239], a[124:127], v[232:235]
    ds_read_b128 a[236:239], v243 offset:18560
    v_mul_f32 v213, v213, v225
    v_mfma_f32_16x16x32_bf16 v[232:235], a[240:243], a[128:131], v[232:235]
    ds_read_b128 a[240:243], v242 offset:18688
    v_cvt_pk_bf16_f32 v49, v228, v229
    v_mfma_f32_16x16x32_bf16 v[232:235], a[244:247], a[132:135], v[232:235]
    ds_read_b128 a[244:247], v243 offset:18688
    v_cvt_pk_bf16_f32 v52, v230, v231
    v_mfma_f32_16x16x32_bf16 v[216:219], v[48:51], v[184:187], v[216:219]
    ds_read_b128 v[196:199], v245 offset:64
    v_mul_f32 v214, v214, v225
    v_mfma_f32_16x16x32_bf16 v[232:235], a[216:219], a[136:139], v[232:235]
    s_waitcnt lgkmcnt(5)
    v_mul_f32 v215, v215, v225
    v_cvt_pk_bf16_f32 v212, v212, v213
    v_mfma_f32_16x16x32_bf16 v[208:211], v[156:159], v[168:171], v[208:211]
    v_exp_f32 v205, v205
    v_mfma_f32_16x16x32_bf16 v[208:211], v[158:161], v[170:173], v[208:211]
    v_cvt_pk_bf16_f32 v213, v214, v215
    v_mul_f32 v216, v216, v225
    v_mfma_f32_16x16x32_bf16 v[232:235], a[220:223], a[140:143], v[232:235]
    ds_write_b64 v247, v[212:213] offset:30720
    v_mfma_f32_16x16x32_bf16 v[236:239], a[144:147], a[224:227], 0
    v_mul_f32 v217, v217, v225
    v_mul_f32 v218, v218, v225
    v_mfma_f32_16x16x32_bf16 v[236:239], a[148:151], a[228:231], v[236:239]
    s_waitcnt lgkmcnt(3)
    v_mul_f32 v219, v219, v225
    v_cvt_pk_bf16_f32 v216, v216, v217
    v_mfma_f32_16x16x32_bf16 v[236:239], a[152:155], a[232:235], v[236:239]
    s_waitcnt lgkmcnt(2)
    v_cvt_pk_bf16_f32 v79, v232, v233
    v_cvt_pk_bf16_f32 v82, v234, v235
    v_mfma_f32_16x16x32_bf16 v[236:239], a[156:159], a[236:239], v[236:239]
    s_barrier
    v_cvt_pk_bf16_f32 v217, v218, v219
    v_cvt_pk_bf16_f32 v189, v204, v205
    v_mfma_f32_16x16x32_bf16 v[220:223], v[78:81], v[184:187], v[220:223]
    ds_read_b128 a[216:219], v242 offset:0
    s_waitcnt lgkmcnt(2)
    v_mfma_f32_16x16x32_bf16 v[212:215], v[12:15], v[188:191], 0
    ds_read_b128 a[220:223], v243 offset:0
    v_mfma_f32_16x16x32_bf16 v[196:199], v[114:117], v[168:171], v[196:199]
    ds_read_b128 a[252:255], v252 offset:12288
    v_mfma_f32_16x16x32_bf16 v[196:199], v[116:119], v[170:173], v[196:199]
    ds_read_b64 v[254:255], v253 offset:12544
    v_mul_f32 v220, v220, v225
    v_mfma_f32_16x16x32_bf16 v[236:239], a[160:163], a[240:243], v[236:239]
    ds_write_b64 v247, v[216:217] offset:30848
    v_mfma_f32_16x16x32_bf16 v[216:219], v[42:45], v[188:191], 0
    v_mul_f32 v221, v221, v225
    v_mul_f32 v222, v222, v225
    v_mfma_f32_16x16x32_bf16 v[236:239], a[164:167], a[244:247], v[236:239]
    v_mul_f32 v223, v223, v225
    v_cvt_pk_bf16_f32 v220, v220, v221
    v_mfma_f32_16x16x32_bf16 v[224:227], a[248:251], v[188:191], 0
    v_exp_f32 v206, v206
    v_mfma_f32_16x16x32_bf16 v[228:231], a[168:171], a[224:227], 0
    v_exp_f32 v207, v207
    v_mfma_f32_16x16x32_bf16 v[228:231], a[172:175], a[228:231], v[228:231]
    v_cvt_pk_bf16_f32 v221, v222, v223
    v_cvt_pk_bf16_f32 v236, v236, v237
    v_mfma_f32_16x16x32_bf16 v[228:231], a[176:179], a[232:235], v[228:231]
    ds_write_b64 v247, v[220:221] offset:30976
    v_mfma_f32_16x16x32_bf16 v[220:223], v[72:75], v[188:191], 0
    s_waitcnt lgkmcnt(2)
    v_cvt_pk_bf16_f32 v237, v238, v239
    v_cvt_pk_bf16_f32 v192, v206, v207
    v_mfma_f32_16x16x32_bf16 v[228:231], a[180:183], a[236:239], v[228:231]
    ds_write_b64 v249, v[236:237] offset:18432
    v_mfma_f32_16x16x32_bf16 v[228:231], a[184:187], a[240:243], v[228:231]
    ds_read_b128 v[204:207], v244 offset:128
    v_mfma_f32_16x16x32_bf16 v[228:231], a[188:191], a[244:247], v[228:231]
    buffer_store_dwordx4 a[252:255], v250, s[20:23], 0 offen nt
    v_mfma_f32_16x16x32_bf16 v[232:235], a[192:195], a[224:227], 0
    ds_read_b128 a[224:227], v242 offset:128
    v_add_u32 v250, s52, v250
    v_mfma_f32_16x16x32_bf16 v[232:235], a[196:199], a[228:231], v[232:235]
    ds_read_b128 a[228:231], v243 offset:128
    v_mfma_f32_16x16x32_bf16 v[232:235], a[200:203], a[232:235], v[232:235]
    ds_read_b128 a[232:235], v242 offset:256
    v_cvt_pk_bf16_f32 v228, v228, v229
    v_mfma_f32_16x16x32_bf16 v[232:235], a[204:207], a[236:239], v[232:235]
    ds_read_b128 a[236:239], v243 offset:256
    v_cvt_pk_bf16_f32 v229, v230, v231
    v_mfma_f32_16x16x32_bf16 v[232:235], a[208:211], a[240:243], v[232:235]
    ds_write_b64 v249, v[228:229] offset:18560
    v_mfma_f32_16x16x32_bf16 v[232:235], a[212:215], a[244:247], v[232:235]
    ds_read_b128 a[240:243], v240 offset:6144
    s_waitcnt lgkmcnt(6)
    v_mfma_f32_16x16x32_bf16 v[204:207], v[96:99], v[168:171], v[204:207]
    ds_read_b128 a[244:247], v241 offset:6144
    v_mfma_f32_16x16x32_bf16 v[204:207], v[98:101], v[170:173], v[204:207]
    buffer_store_dwordx2 v[254:255], v251, s[20:23], 0 offen offset:256 nt
    v_mfma_f32_16x16x32_bf16 v[236:239], a[144:147], a[216:219], 0
    v_exp_f32 v208, v208
    v_mfma_f32_16x16x32_bf16 v[236:239], a[148:151], a[220:223], v[236:239]
    s_waitcnt lgkmcnt(5)
    v_cvt_pk_bf16_f32 v232, v232, v233
    v_cvt_pk_bf16_f32 v233, v234, v235
    v_mfma_f32_16x16x32_bf16 v[236:239], a[152:155], a[224:227], v[236:239]
    ds_write_b64 v249, v[232:233] offset:18688
    v_mfma_f32_16x16x32_bf16 v[236:239], a[156:159], a[228:231], v[236:239]
    s_waitcnt lgkmcnt(4)
    v_exp_f32 v209, v209
    v_mfma_f32_16x16x32_bf16 v[236:239], a[160:163], a[232:235], v[236:239]
    v_add_u32 v251, s52, v251
    v_cvt_pk_bf16_f32 v180, v208, v209
    v_mfma_f32_16x16x32_bf16 v[236:239], a[164:167], a[236:239], v[236:239]
    s_add_u32 s52, s28, 11
    v_exp_f32 v210, v210
    v_mfma_f32_16x16x32_bf16 v[228:231], a[168:171], a[216:219], 0
    s_mul_i32 s52, s52, s30
    v_exp_f32 v211, v211
    v_mfma_f32_16x16x32_bf16 v[228:231], a[172:175], a[220:223], v[228:231]
    v_exp_f32 v196, v196
    v_mfma_f32_16x16x32_bf16 v[228:231], a[176:179], a[224:227], v[228:231]
    v_cvt_pk_bf16_f32 v236, v236, v237
    v_cvt_pk_bf16_f32 v237, v238, v239
    v_mfma_f32_16x16x32_bf16 v[228:231], a[180:183], a[228:231], v[228:231]
    v_exp_f32 v197, v197
    v_mfma_f32_16x16x32_bf16 v[228:231], a[184:187], a[232:235], v[228:231]
    s_waitcnt lgkmcnt(0)
    v_cvt_pk_bf16_f32 v183, v210, v211
    v_cvt_pk_bf16_f32 v194, v196, v197
    v_mfma_f32_16x16x32_bf16 v[228:231], a[188:191], a[236:239], v[228:231]
    ds_read_b128 v[208:211], v245 offset:128
    s_barrier
    v_mfma_f32_16x16x32_bf16 v[232:235], a[192:195], a[216:219], 0
    ds_write_b64 v249, v[236:237] offset:0
    v_mfma_f32_16x16x32_bf16 v[232:235], a[196:199], a[220:223], v[232:235]
    ds_read_b128 a[216:219], v240 offset:6272
    v_mfma_f32_16x16x32_bf16 v[232:235], a[200:203], a[224:227], v[232:235]
    ds_read_b128 a[220:223], v241 offset:6272
    v_cvt_pk_bf16_f32 v228, v228, v229
    v_mfma_f32_16x16x32_bf16 v[232:235], a[204:207], a[228:231], v[232:235]
    ds_read_b128 a[224:227], v240 offset:6400
    v_cvt_pk_bf16_f32 v229, v230, v231
    v_mfma_f32_16x16x32_bf16 v[232:235], a[208:211], a[232:235], v[232:235]
    ds_write_b64 v249, v[228:229] offset:128
    v_mfma_f32_16x16x32_bf16 v[232:235], a[212:215], a[236:239], v[232:235]
    ds_read_b128 a[228:231], v241 offset:6400
    v_mfma_f32_16x16x32_bf16 v[236:239], a[0:3], a[240:243], 0
    ds_read_b128 a[232:235], v242 offset:24576
    v_mfma_f32_16x16x32_bf16 v[236:239], a[4:7], a[244:247], v[236:239]
    ds_read_b128 a[236:239], v243 offset:24576
    s_waitcnt lgkmcnt(8)
    v_mfma_f32_16x16x32_bf16 v[208:211], v[120:123], v[168:171], v[208:211]
    ds_read_b128 a[252:255], v252 offset:18432
    v_cvt_pk_bf16_f32 v232, v232, v233
    v_mfma_f32_16x16x32_bf16 v[208:211], v[122:125], v[170:173], v[208:211]
    ds_read_b64 v[254:255], v253 offset:18688
    v_cvt_pk_bf16_f32 v233, v234, v235
    v_mfma_f32_16x16x32_bf16 v[228:231], a[24:27], a[240:243], 0
    ds_write_b64 v249, v[232:233] offset:256
    v_mfma_f32_16x16x32_bf16 v[228:231], a[28:31], a[244:247], v[228:231]
    s_waitcnt lgkmcnt(7)
    v_exp_f32 v198, v198
    v_mfma_f32_16x16x32_bf16 v[236:239], a[8:11], a[216:219], v[236:239]
    v_exp_f32 v199, v199
    v_mfma_f32_16x16x32_bf16 v[236:239], a[12:15], a[220:223], v[236:239]
    v_exp_f32 v200, v200
    v_mfma_f32_16x16x32_bf16 v[236:239], a[16:19], a[224:227], v[236:239]
    s_waitcnt lgkmcnt(5)
    v_exp_f32 v201, v201
    v_mfma_f32_16x16x32_bf16 v[236:239], a[20:23], a[228:231], v[236:239]
    v_cvt_pk_bf16_f32 v181, v198, v199
    v_cvt_pk_bf16_f32 v195, v200, v201
    v_mfma_f32_16x16x32_bf16 v[228:231], a[32:35], a[216:219], v[228:231]
    ds_read_b128 v[196:199], v246 offset:128
    s_waitcnt lgkmcnt(3)
    v_mfma_f32_16x16x32_bf16 v[212:215], v[16:19], v[192:195], v[212:215]
    buffer_store_dwordx4 a[252:255], v250, s[20:23], 0 offen nt
    v_mfma_f32_16x16x32_bf16 v[216:219], v[46:49], v[192:195], v[216:219]
    s_waitcnt lgkmcnt(1)
    v_cvt_pk_bf16_f32 v144, v236, v237
    v_cvt_pk_bf16_f32 v145, v238, v239
    v_mfma_f32_16x16x32_bf16 v[220:223], v[76:79], v[192:195], v[220:223]
    v_exp_f32 v202, v202
    v_mfma_f32_16x16x32_bf16 v[224:227], a[248:251], v[192:195], v[224:227]
    v_exp_f32 v203, v203
    v_mfma_f32_16x16x32_bf16 v[228:231], a[36:39], a[220:223], v[228:231]
    buffer_store_dwordx2 v[254:255], v251, s[20:23], 0 offen offset:256 nt
    v_mfma_f32_16x16x32_bf16 v[228:231], a[40:43], a[224:227], v[228:231]
    v_mbcnt_lo_u32_b32 v254, -1, 0
    v_mbcnt_hi_u32_b32 v254, -1, v254
    v_mfma_f32_16x16x32_bf16 v[228:231], a[44:47], a[228:231], v[228:231]
    v_lshrrev_b32 v255, 4, v254
    v_and_b32 v251, 2, v255
    v_mfma_f32_16x16x32_bf16 v[232:235], a[48:51], a[240:243], 0
    v_lshlrev_b32 v251, 1, v251
    v_mul_i32_i24 v251, s30, v251
    v_mfma_f32_16x16x32_bf16 v[232:235], a[52:55], a[244:247], v[232:235]
    v_and_b32 v250, 1, v255
    v_mad_i32_i24 v250, v250, s31, v251
    v_mfma_f32_16x16x32_bf16 v[232:235], a[56:59], a[216:219], v[232:235]
    v_cvt_pk_bf16_f32 v146, v228, v229
    v_cvt_pk_bf16_f32 v147, v230, v231
    v_mfma_f32_16x16x32_bf16 v[232:235], a[60:63], a[220:223], v[232:235]
    s_waitcnt lgkmcnt(0)
    v_add_u32 v250, s54, v250
    v_and_b32 v254, 15, v254
    v_mfma_f32_16x16x32_bf16 v[196:199], v[144:147], v[168:171], v[196:199]
    ds_read_b64 v[168:169], v247 offset:49152
    v_lshl_add_u32 v251, v254, 3, v250
    v_mfma_f32_16x16x32_bf16 v[232:235], a[64:67], a[224:227], v[232:235]
    s_and_b32 s54, s28, 1
    v_lshlrev_b32 v255, 3, v255
    v_and_b32 v255, 8, v255
    v_mfma_f32_16x16x32_bf16 v[232:235], a[68:71], a[228:231], v[232:235]
    s_add_u32 s54, s54, 15
    v_xor_b32 v254, v254, v255
    v_lshl_add_u32 v250, v254, 4, v250
    v_mfma_f32_16x16x32_bf16 v[236:239], a[240:243], a[72:75], 0
    s_mul_i32 s54, s54, s30
    v_exp_f32 v204, v204
    v_mfma_f32_16x16x32_bf16 v[236:239], a[244:247], a[76:79], v[236:239]
    s_add_u32 s54, s54, s55
    v_cvt_pk_bf16_f32 v148, v232, v233
    v_cvt_pk_bf16_f32 v149, v234, v235
    v_mfma_f32_16x16x32_bf16 v[236:239], a[216:219], a[80:83], v[236:239]
    s_add_u32 s54, s54, s32
    v_exp_f32 v205, v205
    v_mfma_f32_16x16x32_bf16 v[196:199], v[146:149], v[170:173], v[196:199]
    ds_read_b64 v[170:171], v247 offset:49280
    v_cvt_pk_bf16_f32 v182, v202, v203
    v_mfma_f32_16x16x32_bf16 v[236:239], a[220:223], a[84:87], v[236:239]
    ds_read_b128 v[200:203], v244 offset:0
    v_cvt_pk_bf16_f32 v186, v204, v205
    v_mfma_f32_16x16x32_bf16 v[212:215], v[20:23], v[180:183], v[212:215]
    ds_read_b128 v[204:207], v245 offset:0
    v_mfma_f32_16x16x32_bf16 v[216:219], v[50:53], v[180:183], v[216:219]
    ds_read_b64 v[172:173], v247 offset:49408
    v_mfma_f32_16x16x32_bf16 v[220:223], v[80:83], v[180:183], v[220:223]
    v_exp_f32 v208, v208
    v_mfma_f32_16x16x32_bf16 v[224:227], a[248:251], v[180:183], v[224:227]
    v_exp_f32 v209, v209
    v_mfma_f32_16x16x32_bf16 v[236:239], a[224:227], a[88:91], v[236:239]
    v_exp_f32 v196, v196
    v_mfma_f32_16x16x32_bf16 v[236:239], a[228:231], a[92:95], v[236:239]
    v_exp_f32 v197, v197
    v_mfma_f32_16x16x32_bf16 v[228:231], a[240:243], a[96:99], 0
    v_cvt_pk_bf16_f32 v184, v208, v209
    v_cvt_pk_bf16_f32 v185, v196, v197
    v_mfma_f32_16x16x32_bf16 v[228:231], a[244:247], a[100:103], v[228:231]
    ds_read_b128 v[208:211], v246 offset:0
    s_waitcnt lgkmcnt(3)
    v_mfma_f32_16x16x32_bf16 v[224:227], a[248:251], v[184:187], v[224:227]
    ds_read_b128 v[196:199], v244 offset:64
    v_cvt_pk_bf16_f32 v25, v236, v237
    v_mfma_f32_16x16x32_bf16 v[200:203], v[156:159], v[174:177], v[200:203]
    s_waitcnt lgkmcnt(3)
    v_cvt_pk_bf16_f32 v28, v238, v239
    v_mfma_f32_16x16x32_bf16 v[212:215], v[24:27], v[184:187], v[212:215]
    v_mfma_f32_16x16x32_bf16 v[200:203], v[158:161], v[176:179], v[200:203]
    v_mfma_f32_16x16x32_bf16 v[204:207], v[114:117], v[174:177], v[204:207]
    v_rcp_f32 v225, v224
    v_mfma_f32_16x16x32_bf16 v[204:207], v[116:119], v[176:179], v[204:207]
    v_max3_f32 v248, v248, v224, v225
    v_mfma_f32_16x16x32_bf16 v[228:231], a[216:219], a[104:107], v[228:231]
    v_mfma_f32_16x16x32_bf16 v[228:231], a[220:223], a[108:111], v[228:231]
    v_mfma_f32_16x16x32_bf16 v[228:231], a[224:227], a[112:115], v[228:231]
    s_waitcnt lgkmcnt(1)
    v_mul_f32 v212, v212, v225
    v_mul_f32 v213, v213, v225
    v_mfma_f32_16x16x32_bf16 v[208:211], v[138:141], v[174:177], v[208:211]
    s_waitcnt lgkmcnt(0)
    v_mul_f32 v214, v214, v225
    v_mul_f32 v215, v215, v225
    v_mfma_f32_16x16x32_bf16 v[208:211], v[140:143], v[176:179], v[208:211]
    v_cvt_pk_bf16_f32 v212, v212, v213
    v_cvt_pk_bf16_f32 v213, v214, v215
    v_mfma_f32_16x16x32_bf16 v[196:199], v[96:99], v[174:177], v[196:199]
    ds_write_b64 v247, v[212:213] offset:36864
    v_mfma_f32_16x16x32_bf16 v[196:199], v[98:101], v[176:179], v[196:199]
    v_exp_f32 v200, v200
    v_mfma_f32_16x16x32_bf16 v[228:231], a[228:231], a[116:119], v[228:231]
    v_exp_f32 v201, v201
    v_mfma_f32_16x16x32_bf16 v[232:235], a[240:243], a[120:123], 0
    ds_read_b128 a[240:243], v242 offset:24704
    v_cvt_pk_bf16_f32 v190, v200, v201
    v_mfma_f32_16x16x32_bf16 v[232:235], a[244:247], a[124:127], v[232:235]
    ds_read_b128 a[244:247], v243 offset:24704
    v_mfma_f32_16x16x32_bf16 v[232:235], a[216:219], a[128:131], v[232:235]
    ds_read_b128 a[216:219], v242 offset:24832
    v_cvt_pk_bf16_f32 v55, v228, v229
    v_mfma_f32_16x16x32_bf16 v[232:235], a[220:223], a[132:135], v[232:235]
    ds_read_b128 a[220:223], v243 offset:24832
    v_cvt_pk_bf16_f32 v58, v230, v231
    v_mfma_f32_16x16x32_bf16 v[216:219], v[54:57], v[184:187], v[216:219]
    v_exp_f32 v202, v202
    v_mfma_f32_16x16x32_bf16 v[232:235], a[224:227], a[136:139], v[232:235]
    v_exp_f32 v203, v203
    v_mfma_f32_16x16x32_bf16 v[232:235], a[228:231], a[140:143], v[232:235]
    v_exp_f32 v204, v204
    v_mfma_f32_16x16x32_bf16 v[236:239], a[144:147], a[232:235], 0
    v_exp_f32 v205, v205
    v_mfma_f32_16x16x32_bf16 v[236:239], a[148:151], a[236:239], v[236:239]
    v_mul_f32 v216, v216, v225
    v_mul_f32 v217, v217, v225
    v_mfma_f32_16x16x32_bf16 v[228:231], a[168:171], a[232:235], 0
    s_waitcnt lgkmcnt(3)
    v_cvt_pk_bf16_f32 v85, v232, v233
    v_cvt_pk_bf16_f32 v88, v234, v235
    v_mfma_f32_16x16x32_bf16 v[236:239], a[152:155], a[240:243], v[236:239]
    s_waitcnt lgkmcnt(2)
    v_mul_f32 v218, v218, v225
    v_mul_f32 v219, v219, v225
    v_mfma_f32_16x16x32_bf16 v[220:223], v[84:87], v[184:187], v[220:223]
    v_cvt_pk_bf16_f32 v216, v216, v217
    v_cvt_pk_bf16_f32 v217, v218, v219
    v_mfma_f32_16x16x32_bf16 v[236:239], a[156:159], a[244:247], v[236:239]
    ds_write_b64 v247, v[216:217] offset:36992
    v_mfma_f32_16x16x32_bf16 v[228:231], a[172:175], a[236:239], v[228:231]
    s_waitcnt lgkmcnt(1)
    v_cvt_pk_bf16_f32 v193, v202, v203
    v_cvt_pk_bf16_f32 v188, v204, v205
    v_mfma_f32_16x16x32_bf16 v[236:239], a[160:163], a[216:219], v[236:239]
    ds_read_b128 v[200:203], v245 offset:64
    v_mul_f32 v220, v220, v225
    v_mfma_f32_16x16x32_bf16 v[236:239], a[164:167], a[220:223], v[236:239]
    s_barrier
    v_mul_f32 v221, v221, v225
    v_mul_f32 v222, v222, v225
    v_mfma_f32_16x16x32_bf16 v[228:231], a[176:179], a[240:243], v[228:231]
    ds_read_b128 a[224:227], v242 offset:30720
    v_mul_f32 v223, v223, v225
    v_mfma_f32_16x16x32_bf16 v[228:231], a[180:183], a[244:247], v[228:231]
    ds_read_b128 a[228:231], v243 offset:30720
    v_cvt_pk_bf16_f32 v236, v236, v237
    v_mfma_f32_16x16x32_bf16 v[228:231], a[184:187], a[216:219], v[228:231]
    ds_read_b128 a[252:255], v252 offset:0
    v_cvt_pk_bf16_f32 v237, v238, v239
    v_mfma_f32_16x16x32_bf16 v[228:231], a[188:191], a[220:223], v[228:231]
    ds_write_b64 v249, v[236:237] offset:24576
    v_mfma_f32_16x16x32_bf16 v[232:235], a[192:195], a[232:235], 0
    ds_read_b128 a[232:235], v242 offset:30848
    v_cvt_pk_bf16_f32 v220, v220, v221
    v_mfma_f32_16x16x32_bf16 v[232:235], a[196:199], a[236:239], v[232:235]
    ds_read_b128 a[236:239], v243 offset:30848
    v_cvt_pk_bf16_f32 v221, v222, v223
    v_mfma_f32_16x16x32_bf16 v[232:235], a[200:203], a[240:243], v[232:235]
    ds_read_b128 a[240:243], v242 offset:30976
    v_cvt_pk_bf16_f32 v228, v228, v229
    v_mfma_f32_16x16x32_bf16 v[232:235], a[204:207], a[244:247], v[232:235]
    ds_read_b128 a[244:247], v243 offset:30976
    v_cvt_pk_bf16_f32 v229, v230, v231
    v_mfma_f32_16x16x32_bf16 v[232:235], a[208:211], a[216:219], v[232:235]
    ds_write_b64 v249, v[228:229] offset:24704
    v_mfma_f32_16x16x32_bf16 v[232:235], a[212:215], a[220:223], v[232:235]
    s_waitcnt lgkmcnt(7)
    v_exp_f32 v206, v206
    v_mfma_f32_16x16x32_bf16 v[200:203], v[120:123], v[174:177], v[200:203]
    ds_read_b64 v[254:255], v253 offset:256
    v_mov_b32 v186, 0
    v_mfma_f32_16x16x32_bf16 v[200:203], v[122:125], v[176:179], v[200:203]
    ds_write_b64 v247, v[220:221] offset:37120
    v_mfma_f32_16x16x32_bf16 v[236:239], a[144:147], a[224:227], 0
    s_waitcnt lgkmcnt(6)
    v_cvt_pk_bf16_f32 v232, v232, v233
    v_cvt_pk_bf16_f32 v233, v234, v235
    v_mfma_f32_16x16x32_bf16 v[236:239], a[148:151], a[228:231], v[236:239]
    ds_write_b64 v249, v[232:233] offset:24832
    v_mfma_f32_16x16x32_bf16 v[236:239], a[152:155], a[232:235], v[236:239]
    buffer_store_dwordx4 a[252:255], v250, s[20:23], 0 offen nt
    v_mfma_f32_16x16x32_bf16 v[228:231], a[168:171], a[224:227], 0
    s_waitcnt lgkmcnt(4)
    v_exp_f32 v207, v207
    v_mfma_f32_16x16x32_bf16 v[236:239], a[156:159], a[236:239], v[236:239]
    v_exp_f32 v208, v208
    v_mfma_f32_16x16x32_bf16 v[236:239], a[160:163], a[240:243], v[236:239]
    s_waitcnt lgkmcnt(2)
    v_exp_f32 v209, v209
    v_mfma_f32_16x16x32_bf16 v[236:239], a[164:167], a[244:247], v[236:239]
    buffer_store_dwordx2 v[254:255], v251, s[20:23], 0 offen offset:256 nt
    v_mfma_f32_16x16x32_bf16 v[228:231], a[172:175], a[228:231], v[228:231]
    v_mbcnt_lo_u32_b32 v254, -1, 0
    v_mbcnt_hi_u32_b32 v254, -1, v254
    v_mfma_f32_16x16x32_bf16 v[228:231], a[176:179], a[232:235], v[228:231]
    s_waitcnt lgkmcnt(0)
    v_lshrrev_b32 v255, 4, v254
    v_mul_i32_i24 v250, s31, v255
    v_mfma_f32_16x16x32_bf16 v[228:231], a[180:183], a[236:239], v[228:231]
    s_barrier
    v_cvt_pk_bf16_f32 v236, v236, v237
    v_cvt_pk_bf16_f32 v237, v238, v239
    v_mfma_f32_16x16x32_bf16 v[228:231], a[184:187], a[240:243], v[228:231]
    ds_write_b64 v249, v[236:237] offset:30720
    v_mfma_f32_16x16x32_bf16 v[228:231], a[188:191], a[244:247], v[228:231]
    ds_read_b128 a[216:219], v242 offset:36864
    v_add_u32 v250, s56, v250
    v_mfma_f32_16x16x32_bf16 v[232:235], a[192:195], a[224:227], 0
    ds_read_b128 a[220:223], v243 offset:36864
    v_and_b32 v254, 15, v254
    v_mfma_f32_16x16x32_bf16 v[232:235], a[196:199], a[228:231], v[232:235]
    ds_read_b128 a[224:227], v242 offset:36992
    v_lshl_add_u32 v251, v254, 3, v250
    v_mfma_f32_16x16x32_bf16 v[232:235], a[200:203], a[232:235], v[232:235]
    ds_read_b128 a[228:231], v243 offset:36992
    v_cvt_pk_bf16_f32 v228, v228, v229
    v_mfma_f32_16x16x32_bf16 v[232:235], a[204:207], a[236:239], v[232:235]
    ds_read_b128 a[232:235], v242 offset:37120
    v_cvt_pk_bf16_f32 v229, v230, v231
    v_mfma_f32_16x16x32_bf16 v[232:235], a[208:211], a[240:243], v[232:235]
    ds_write_b64 v249, v[228:229] offset:30848
    v_mfma_f32_16x16x32_bf16 v[232:235], a[212:215], a[244:247], v[232:235]
    ds_read_b128 a[236:239], v243 offset:37120
    v_lshlrev_b32 v255, 3, v255
    v_and_b32 v255, 8, v255
    v_xor_b32 v254, v254, v255
    v_lshl_add_u32 v250, v254, 4, v250
    ds_read_b128 a[252:255], v252 offset:24576
    ds_read_b64 v[254:255], v253 offset:24832
    v_cvt_pk_bf16_f32 v191, v206, v207
    v_cvt_pk_bf16_f32 v232, v232, v233
    v_cvt_pk_bf16_f32 v233, v234, v235
    ds_write_b64 v249, v[232:233] offset:30976
    ds_read_b128 v[204:207], v246 offset:64
    v_exp_f32 v210, v210
    v_exp_f32 v211, v211
    v_cvt_pk_bf16_f32 v189, v208, v209
    s_waitcnt lgkmcnt(6)
    v_mfma_f32_16x16x32_bf16 v[236:239], a[144:147], a[216:219], 0
    s_and_b32 s56, s28, 1
    v_exp_f32 v196, v196
    v_mfma_f32_16x16x32_bf16 v[212:215], v[18:21], v[188:191], 0
    s_add_u32 s56, s56, 15
    v_exp_f32 v197, v197
    v_mfma_f32_16x16x32_bf16 v[216:219], v[48:51], v[188:191], 0
    s_mul_i32 s56, s56, s30
    v_cvt_pk_bf16_f32 v192, v210, v211
    v_cvt_pk_bf16_f32 v180, v196, v197
    v_mfma_f32_16x16x32_bf16 v[220:223], v[78:81], v[188:191], 0
    v_exp_f32 v198, v198
    v_mfma_f32_16x16x32_bf16 v[224:227], a[248:251], v[188:191], 0
    s_waitcnt lgkmcnt(2)
    v_exp_f32 v199, v199
    v_mfma_f32_16x16x32_bf16 v[236:239], a[148:151], a[220:223], v[236:239]
    buffer_store_dwordx4 a[252:255], v250, s[20:23], 0 offen nt
    v_mfma_f32_16x16x32_bf16 v[236:239], a[152:155], a[224:227], v[236:239]
    s_waitcnt lgkmcnt(0)
    v_cvt_pk_bf16_f32 v183, v198, v199
    v_add_u32 v250, s58, v250
    v_mfma_f32_16x16x32_bf16 v[204:207], v[144:147], v[174:177], v[204:207]
    ds_read_b64 v[174:175], v247 offset:55296
    v_mbcnt_lo_u32_b32 v196, -1, 0
    v_mfma_f32_16x16x32_bf16 v[204:207], v[146:149], v[176:179], v[204:207]
    ds_read_b64 v[176:177], v247 offset:55424
    v_mbcnt_hi_u32_b32 v196, -1, v196
    v_mfma_f32_16x16x32_bf16 v[236:239], a[156:159], a[228:231], v[236:239]
    ds_read_b64 v[178:179], v247 offset:55552
    v_bfe_u32 v208, v196, 2, 1
    v_mfma_f32_16x16x32_bf16 v[236:239], a[160:163], a[232:235], v[236:239]
    buffer_store_dwordx2 v[254:255], v251, s[20:23], 0 offen offset:256 nt
    v_mfma_f32_16x16x32_bf16 v[236:239], a[164:167], a[236:239], v[236:239]
    v_exp_f32 v200, v200
    v_mfma_f32_16x16x32_bf16 v[228:231], a[168:171], a[216:219], 0
    v_exp_f32 v201, v201
    v_mfma_f32_16x16x32_bf16 v[228:231], a[172:175], a[220:223], v[228:231]
    v_exp_f32 v202, v202
    v_mfma_f32_16x16x32_bf16 v[228:231], a[176:179], a[224:227], v[228:231]
    v_exp_f32 v203, v203
    v_mfma_f32_16x16x32_bf16 v[228:231], a[180:183], a[228:231], v[228:231]
    v_cvt_pk_bf16_f32 v236, v236, v237
    v_cvt_pk_bf16_f32 v237, v238, v239
    v_mfma_f32_16x16x32_bf16 v[228:231], a[184:187], a[232:235], v[228:231]
    v_cvt_pk_bf16_f32 v194, v200, v201
    v_cvt_pk_bf16_f32 v181, v202, v203
    v_mfma_f32_16x16x32_bf16 v[228:231], a[188:191], a[236:239], v[228:231]
    v_exp_f32 v204, v204
    v_mfma_f32_16x16x32_bf16 v[232:235], a[192:195], a[216:219], 0
    v_exp_f32 v205, v205
    v_mfma_f32_16x16x32_bf16 v[232:235], a[196:199], a[220:223], v[232:235]
    v_exp_f32 v206, v206
    v_mfma_f32_16x16x32_bf16 v[232:235], a[200:203], a[224:227], v[232:235]
    v_exp_f32 v207, v207
    v_mfma_f32_16x16x32_bf16 v[232:235], a[204:207], a[228:231], v[232:235]
    v_cvt_pk_bf16_f32 v228, v228, v229
    v_cvt_pk_bf16_f32 v229, v230, v231
    v_mfma_f32_16x16x32_bf16 v[232:235], a[208:211], a[232:235], v[232:235]
    v_cvt_pk_bf16_f32 v195, v204, v205
    v_cvt_pk_bf16_f32 v182, v206, v207
    v_mfma_f32_16x16x32_bf16 v[232:235], a[212:215], a[236:239], v[232:235]
    v_add_u32 v251, s58, v251
    v_lshrrev_b32 v209, 1, v196
    v_mfma_f32_16x16x32_bf16 v[212:215], v[22:25], v[192:195], v[212:215]
    v_and_b32 v209, 4, v209
    v_and_or_b32 v209, v196, 3, v209
    v_mfma_f32_16x16x32_bf16 v[216:219], v[52:55], v[192:195], v[216:219]
    v_bfe_u32 v197, v196, 3, 1
    v_lshrrev_b32 v196, 4, v196
    v_mfma_f32_16x16x32_bf16 v[220:223], v[82:85], v[192:195], v[220:223]
    v_cvt_pk_bf16_f32 v232, v232, v233
    v_cvt_pk_bf16_f32 v233, v234, v235
    v_mfma_f32_16x16x32_bf16 v[224:227], a[248:251], v[192:195], v[224:227]
    v_sub_u32 v210, v196, v208
    v_mul_i32_i24 v210, 0x1c0, v210
    v_mfma_f32_16x16x32_bf16 v[212:215], v[26:29], v[180:183], v[212:215]
    v_lshlrev_b32 v211, 4, v209
    v_sub_u32 v210, v210, v211
    v_mfma_f32_16x16x32_bf16 v[216:219], v[56:59], v[180:183], v[216:219]
    v_add_u32 v210, s37, v210
    v_sub_u32 v211, v196, v208
    v_mfma_f32_16x16x32_bf16 v[220:223], v[86:89], v[180:183], v[220:223]
    v_add_u32 v244, 0, v211
    v_cmp_gt_u32 vcc, 7, v244
    v_mfma_f32_16x16x32_bf16 v[224:227], a[248:251], v[180:183], v[224:227]
    v_add_u32 v244, 0xfffdc870, v210
    v_cndmask_b32 v244, 0, v244, vcc
    v_add_u32 v244, 0x237c0, v244
    v_add_u32 v245, 4, v211
    v_cmp_gt_u32 vcc, 7, v245
    v_add_u32 v245, 0xfffdcf70, v210
    v_add_u32 v246, 8, v211
    v_cndmask_b32 v245, 0, v245, vcc
    v_rcp_f32 v225, v224
    v_add_u32 v245, 0x237c0, v245
    v_max3_f32 v248, v248, v224, v225
    v_mul_f32 v212, v212, v225
    v_mul_f32 v213, v213, v225
    v_mul_f32 v214, v214, v225
    v_mul_f32 v215, v215, v225
    v_cvt_pk_bf16_f32 v212, v212, v213
    v_cvt_pk_bf16_f32 v213, v214, v215
    ds_write_b64 v247, v[212:213] offset:43008
    v_mul_f32 v216, v216, v225
    v_mul_f32 v217, v217, v225
    v_mul_f32 v218, v218, v225
    v_mul_f32 v219, v219, v225
    v_cvt_pk_bf16_f32 v216, v216, v217
    v_cvt_pk_bf16_f32 v217, v218, v219
    ds_write_b64 v247, v[216:217] offset:43136
    v_mul_f32 v220, v220, v225
    v_mul_f32 v221, v221, v225
    v_mul_f32 v222, v222, v225
    v_mul_f32 v223, v223, v225
    v_cvt_pk_bf16_f32 v220, v220, v221
    v_cvt_pk_bf16_f32 v221, v222, v223
    ds_write_b64 v247, v[220:221] offset:43264
    v_cmp_gt_u32 vcc, 7, v246
    v_add_u32 v246, 0xfffdd670, v210
    v_xor_b32 v197, 1, v197
    v_cndmask_b32 v246, 0, v246, vcc
    v_add_u32 v246, 0x237c0, v246
    v_mul_u32_u24 v246, 0xc0, v197
    v_add_u32 v244, v244, v246
    v_add_u32 v245, v245, v246
    v_mov_b32 v189, 0
    v_mov_b32 v192, 0
    v_mov_b32 v195, 0
    v_mov_b32 v182, 0
    s_waitcnt lgkmcnt(0)
    s_barrier
    ds_write_b64 v249, v[236:237] offset:36864
    ds_write_b64 v249, v[228:229] offset:36992
    ds_write_b64 v249, v[232:233] offset:37120
    ds_read_b128 a[240:243], v242 offset:43008
    ds_read_b128 a[244:247], v243 offset:43008
    ds_read_b128 a[216:219], v242 offset:43136
    ds_read_b128 a[220:223], v243 offset:43136
    ds_read_b128 a[224:227], v242 offset:43264
    ds_read_b128 a[228:231], v243 offset:43264
    ds_read_b128 v[208:211], v244 offset:0
    ds_read_b128 v[196:199], v245 offset:0
    ds_read_b128 v[200:203], v244 offset:64
    ds_read_b128 v[204:207], v245 offset:64
    ds_read_b128 a[252:255], v252 offset:30720
    ds_read_b64 v[254:255], v253 offset:30976
    s_waitcnt lgkmcnt(11)
    v_mfma_f32_16x16x32_bf16 v[236:239], a[144:147], a[240:243], 0
    v_mfma_f32_16x16x32_bf16 v[228:231], a[168:171], a[240:243], 0
    s_waitcnt lgkmcnt(10)
    v_mfma_f32_16x16x32_bf16 v[236:239], a[148:151], a[244:247], v[236:239]
    s_waitcnt lgkmcnt(9)
    v_mfma_f32_16x16x32_bf16 v[236:239], a[152:155], a[216:219], v[236:239]
    s_waitcnt lgkmcnt(8)
    v_mfma_f32_16x16x32_bf16 v[236:239], a[156:159], a[220:223], v[236:239]
    s_waitcnt lgkmcnt(7)
    v_mfma_f32_16x16x32_bf16 v[236:239], a[160:163], a[224:227], v[236:239]
    s_waitcnt lgkmcnt(6)
    v_mfma_f32_16x16x32_bf16 v[236:239], a[164:167], a[228:231], v[236:239]
    s_waitcnt lgkmcnt(5)
    v_mfma_f32_16x16x32_bf16 v[208:211], v[102:105], v[168:171], v[208:211]
    s_waitcnt lgkmcnt(4)
    v_mfma_f32_16x16x32_bf16 v[208:211], v[104:107], v[170:173], v[208:211]
    s_waitcnt lgkmcnt(3)
    v_mfma_f32_16x16x32_bf16 v[196:199], v[126:129], v[168:171], v[196:199]
    s_waitcnt lgkmcnt(2)
    v_mfma_f32_16x16x32_bf16 v[196:199], v[128:131], v[170:173], v[196:199]
    s_waitcnt lgkmcnt(0)
    v_cvt_pk_bf16_f32 v236, v236, v237
    v_cvt_pk_bf16_f32 v237, v238, v239
    v_mfma_f32_16x16x32_bf16 v[200:203], v[108:111], v[168:171], v[200:203]
    buffer_store_dwordx4 a[252:255], v250, s[20:23], 0 offen nt
    v_mfma_f32_16x16x32_bf16 v[200:203], v[110:113], v[170:173], v[200:203]
    v_exp_f32 v208, v208
    v_mfma_f32_16x16x32_bf16 v[204:207], v[132:135], v[168:171], v[204:207]
    v_exp_f32 v209, v209
    v_mfma_f32_16x16x32_bf16 v[204:207], v[134:137], v[170:173], v[204:207]
    v_exp_f32 v210, v210
    v_mfma_f32_16x16x32_bf16 v[228:231], a[172:175], a[244:247], v[228:231]
    buffer_store_dwordx2 v[254:255], v251, s[20:23], 0 offen offset:256 nt
    v_mfma_f32_16x16x32_bf16 v[228:231], a[176:179], a[216:219], v[228:231]
    v_exp_f32 v211, v211
    v_mfma_f32_16x16x32_bf16 v[228:231], a[180:183], a[220:223], v[228:231]
    v_cvt_pk_bf16_f32 v184, v208, v209
    v_cvt_pk_bf16_f32 v187, v210, v211
    v_mfma_f32_16x16x32_bf16 v[228:231], a[184:187], a[224:227], v[228:231]
    ds_read_b128 v[208:211], v244 offset:128
    v_add_u32 v250, s50, v250
    v_mfma_f32_16x16x32_bf16 v[228:231], a[188:191], a[228:231], v[228:231]
    v_exp_f32 v196, v196
    v_mfma_f32_16x16x32_bf16 v[232:235], a[192:195], a[240:243], 0
    v_exp_f32 v197, v197
    v_mfma_f32_16x16x32_bf16 v[232:235], a[196:199], a[244:247], v[232:235]
    v_exp_f32 v198, v198
    v_mfma_f32_16x16x32_bf16 v[232:235], a[200:203], a[216:219], v[232:235]
    v_exp_f32 v199, v199
    v_mfma_f32_16x16x32_bf16 v[232:235], a[204:207], a[220:223], v[232:235]
    v_cvt_pk_bf16_f32 v228, v228, v229
    v_cvt_pk_bf16_f32 v229, v230, v231
    v_mfma_f32_16x16x32_bf16 v[232:235], a[208:211], a[224:227], v[232:235]
    v_cvt_pk_bf16_f32 v185, v196, v197
    v_cvt_pk_bf16_f32 v188, v198, v199
    v_mfma_f32_16x16x32_bf16 v[232:235], a[212:215], a[228:231], v[232:235]
    ds_read_b128 v[196:199], v245 offset:128
    v_add_u32 v251, s50, v251
    v_mfma_f32_16x16x32_bf16 v[212:215], v[0:3], v[184:187], 0
    v_exp_f32 v200, v200
    v_mfma_f32_16x16x32_bf16 v[216:219], v[30:33], v[184:187], 0
    s_waitcnt lgkmcnt(1)
    v_exp_f32 v201, v201
    v_mfma_f32_16x16x32_bf16 v[220:223], v[60:63], v[184:187], 0
    v_cvt_pk_bf16_f32 v232, v232, v233
    v_cvt_pk_bf16_f32 v233, v234, v235
    v_mfma_f32_16x16x32_bf16 v[224:227], a[248:251], v[184:187], 0
    v_exp_f32 v202, v202
    v_mfma_f32_16x16x32_bf16 v[208:211], v[162:165], v[168:171], v[208:211]
    v_exp_f32 v203, v203
    v_mfma_f32_16x16x32_bf16 v[208:211], v[164:167], v[170:173], v[208:211]
    v_cvt_pk_bf16_f32 v190, v200, v201
    v_cvt_pk_bf16_f32 v193, v202, v203
    ds_read_b128 v[200:203], v244 offset:192
    v_exp_f32 v204, v204
    v_exp_f32 v205, v205
    v_exp_f32 v206, v206
    v_exp_f32 v207, v207
    v_cvt_pk_bf16_f32 v191, v204, v205
    s_waitcnt lgkmcnt(1)
    v_mfma_f32_16x16x32_bf16 v[196:199], v[90:93], v[168:171], v[196:199]
    v_cvt_pk_bf16_f32 v194, v206, v207
    v_mov_b32 v185, 0
    v_mfma_f32_16x16x32_bf16 v[212:215], v[4:7], v[188:191], v[212:215]
    ds_read_b128 v[204:207], v245 offset:192
    v_sub_u32 v244, v244, v246
    v_mfma_f32_16x16x32_bf16 v[216:219], v[34:37], v[188:191], v[216:219]
    v_exp_f32 v208, v208
    v_mfma_f32_16x16x32_bf16 v[220:223], v[64:67], v[188:191], v[220:223]
    v_exp_f32 v209, v209
    v_mfma_f32_16x16x32_bf16 v[224:227], a[248:251], v[188:191], v[224:227]
    v_exp_f32 v210, v210
    v_mfma_f32_16x16x32_bf16 v[212:215], v[8:11], v[192:195], v[212:215]
    s_waitcnt lgkmcnt(1)
    v_exp_f32 v211, v211
    v_mfma_f32_16x16x32_bf16 v[216:219], v[38:41], v[192:195], v[216:219]
    v_cvt_pk_bf16_f32 v180, v208, v209
    v_cvt_pk_bf16_f32 v183, v210, v211
    v_mfma_f32_16x16x32_bf16 v[220:223], v[68:71], v[192:195], v[220:223]
    ds_read_b128 v[208:211], v244 offset:0
    v_sub_u32 v245, v245, v246
    v_mfma_f32_16x16x32_bf16 v[224:227], a[248:251], v[192:195], v[224:227]
    v_mov_b32 v190, 0
    v_mov_b32 v193, 0
    v_mfma_f32_16x16x32_bf16 v[196:199], v[92:95], v[170:173], v[196:199]
    v_mfma_f32_16x16x32_bf16 v[200:203], v[114:117], v[168:171], v[200:203]
    s_waitcnt lgkmcnt(1)
    v_mfma_f32_16x16x32_bf16 v[200:203], v[116:119], v[170:173], v[200:203]
    v_mfma_f32_16x16x32_bf16 v[204:207], v[138:141], v[168:171], v[204:207]
    v_mfma_f32_16x16x32_bf16 v[204:207], v[140:143], v[170:173], v[204:207]
    s_nop 2
    v_exp_f32 v196, v196
    v_exp_f32 v197, v197
    v_exp_f32 v198, v198
    v_exp_f32 v199, v199
    v_cvt_pk_bf16_f32 v181, v196, v197
    s_waitcnt lgkmcnt(0)
    v_mfma_f32_16x16x32_bf16 v[208:211], v[162:165], v[174:177], v[208:211]
    v_exp_f32 v200, v200
    v_mfma_f32_16x16x32_bf16 v[212:215], v[12:15], v[180:183], v[212:215]
    v_exp_f32 v201, v201
    v_mfma_f32_16x16x32_bf16 v[216:219], v[42:45], v[180:183], v[216:219]
    v_cvt_pk_bf16_f32 v184, v198, v199
    v_cvt_pk_bf16_f32 v186, v200, v201
    v_mfma_f32_16x16x32_bf16 v[220:223], v[72:75], v[180:183], v[220:223]
    ds_read_b128 v[196:199], v245 offset:0
    v_mfma_f32_16x16x32_bf16 v[224:227], a[248:251], v[180:183], v[224:227]
    ds_read_b128 v[200:203], v244 offset:64
    v_mov_b32 v180, 0
    v_mfma_f32_16x16x32_bf16 v[208:211], v[164:167], v[176:179], v[208:211]
    v_exp_f32 v204, v204
    v_exp_f32 v205, v205
    v_mov_b32 v183, 0
    v_cvt_pk_bf16_f32 v187, v204, v205
    ds_read_b128 v[204:207], v245 offset:64
    s_nop 0
    v_mfma_f32_16x16x32_bf16 v[212:215], v[16:19], v[184:187], v[212:215]
    v_mfma_f32_16x16x32_bf16 v[216:219], v[46:49], v[184:187], v[216:219]
    v_exp_f32 v208, v208
    v_mfma_f32_16x16x32_bf16 v[220:223], v[76:79], v[184:187], v[220:223]
    v_exp_f32 v209, v209
    v_mfma_f32_16x16x32_bf16 v[224:227], a[248:251], v[184:187], v[224:227]
    v_exp_f32 v210, v210
    s_waitcnt lgkmcnt(2)
    v_mfma_f32_16x16x32_bf16 v[196:199], v[90:93], v[174:177], v[196:199]
    s_waitcnt lgkmcnt(1)
    v_exp_f32 v211, v211
    v_mfma_f32_16x16x32_bf16 v[196:199], v[92:95], v[176:179], v[196:199]
    v_cvt_pk_bf16_f32 v188, v208, v209
    v_cvt_pk_bf16_f32 v191, v210, v211
    v_mfma_f32_16x16x32_bf16 v[200:203], v[114:117], v[174:177], v[200:203]
    ds_read_b128 v[208:211], v244 offset:128
    v_mov_b32 v186, 0
    v_mfma_f32_16x16x32_bf16 v[200:203], v[116:119], v[176:179], v[200:203]
    s_waitcnt lgkmcnt(1)
    v_rcp_f32 v225, v224
    v_mfma_f32_16x16x32_bf16 v[204:207], v[138:141], v[174:177], v[204:207]
    v_max3_f32 v248, v248, v224, v225
    v_mul_f32 v212, v212, v225
    v_mfma_f32_16x16x32_bf16 v[204:207], v[140:143], v[176:179], v[204:207]
    v_mul_f32 v213, v213, v225
    v_mul_f32 v214, v214, v225
    v_mul_f32 v215, v215, v225
    v_cvt_pk_bf16_f32 v212, v212, v213
    v_cvt_pk_bf16_f32 v213, v214, v215
    ds_write_b64 v247, v[212:213] offset:49152
    v_mul_f32 v216, v216, v225
    v_mul_f32 v217, v217, v225
    v_mul_f32 v218, v218, v225
    v_mul_f32 v219, v219, v225
    v_cvt_pk_bf16_f32 v216, v216, v217
    v_cvt_pk_bf16_f32 v217, v218, v219
    ds_write_b64 v247, v[216:217] offset:49280
    v_mul_f32 v220, v220, v225
    v_mul_f32 v221, v221, v225
    v_mul_f32 v222, v222, v225
    v_mul_f32 v223, v223, v225
    v_cvt_pk_bf16_f32 v220, v220, v221
    v_cvt_pk_bf16_f32 v221, v222, v223
    ds_write_b64 v247, v[220:221] offset:49408
    v_exp_f32 v196, v196
    v_exp_f32 v197, v197
    v_exp_f32 v198, v198
    v_exp_f32 v199, v199
    v_cvt_pk_bf16_f32 v189, v196, v197
    s_waitcnt lgkmcnt(2)
    v_mfma_f32_16x16x32_bf16 v[208:211], v[120:123], v[174:177], v[208:211]
    v_exp_f32 v200, v200
    v_mfma_f32_16x16x32_bf16 v[212:215], v[12:15], v[188:191], 0
    v_exp_f32 v201, v201
    v_mfma_f32_16x16x32_bf16 v[216:219], v[42:45], v[188:191], 0
    v_cvt_pk_bf16_f32 v192, v198, v199
    v_cvt_pk_bf16_f32 v194, v200, v201
    v_mfma_f32_16x16x32_bf16 v[220:223], v[72:75], v[188:191], 0
    ds_read_b128 v[196:199], v245 offset:128
    v_mfma_f32_16x16x32_bf16 v[224:227], a[248:251], v[188:191], 0
    v_exp_f32 v202, v202
    v_mfma_f32_16x16x32_bf16 v[208:211], v[122:125], v[176:179], v[208:211]
    s_waitcnt lgkmcnt(1)
    s_barrier
    ds_write_b64 v249, v[236:237] offset:43008
    ds_write_b64 v249, v[228:229] offset:43136
    ds_write_b64 v249, v[232:233] offset:43264
    ds_read_b128 a[232:235], v242 offset:49152
    ds_read_b128 a[236:239], v243 offset:49152
    ds_read_b128 a[240:243], v242 offset:49280
    ds_read_b128 a[244:247], v243 offset:49280
    ds_read_b128 a[216:219], v242 offset:49408
    ds_read_b128 a[220:223], v243 offset:49408
    ds_read_b128 a[252:255], v252 offset:36864
    ds_read_b64 v[254:255], v253 offset:37120
    v_exp_f32 v203, v203
    v_exp_f32 v204, v204
    v_cvt_pk_bf16_f32 v181, v202, v203
    v_exp_f32 v205, v205
    v_exp_f32 v206, v206
    v_exp_f32 v207, v207
    v_cvt_pk_bf16_f32 v195, v204, v205
    s_waitcnt lgkmcnt(10)
    v_mfma_f32_16x16x32_bf16 v[196:199], v[144:147], v[174:177], v[196:199]
    v_cvt_pk_bf16_f32 v182, v206, v207
    v_mov_b32 v189, 0
    v_mfma_f32_16x16x32_bf16 v[212:215], v[16:19], v[192:195], v[212:215]
    v_exp_f32 v208, v208
    v_mfma_f32_16x16x32_bf16 v[216:219], v[46:49], v[192:195], v[216:219]
    v_exp_f32 v209, v209
    v_mfma_f32_16x16x32_bf16 v[220:223], v[76:79], v[192:195], v[220:223]
    s_waitcnt lgkmcnt(7)
    v_exp_f32 v210, v210
    v_mfma_f32_16x16x32_bf16 v[224:227], a[248:251], v[192:195], v[224:227]
    v_exp_f32 v211, v211
    v_mfma_f32_16x16x32_bf16 v[212:215], v[20:23], v[180:183], v[212:215]
    v_cvt_pk_bf16_f32 v184, v208, v209
    v_cvt_pk_bf16_f32 v187, v210, v211
    v_mfma_f32_16x16x32_bf16 v[216:219], v[50:53], v[180:183], v[216:219]
    v_mov_b32 v191, 0
    v_mfma_f32_16x16x32_bf16 v[220:223], v[80:83], v[180:183], v[220:223]
    v_mfma_f32_16x16x32_bf16 v[224:227], a[248:251], v[180:183], v[224:227]
    v_mfma_f32_16x16x32_bf16 v[196:199], v[146:149], v[176:179], v[196:199]
    s_waitcnt lgkmcnt(1)
    v_mfma_f32_16x16x32_bf16 v[236:239], a[144:147], a[232:235], 0
    buffer_store_dwordx4 a[252:255], v250, s[20:23], 0 offen nt
    v_mfma_f32_16x16x32_bf16 v[236:239], a[148:151], a[236:239], v[236:239]
    s_waitcnt lgkmcnt(0)
    v_mfma_f32_16x16x32_bf16 v[236:239], a[152:155], a[240:243], v[236:239]
    v_mfma_f32_16x16x32_bf16 v[236:239], a[156:159], a[244:247], v[236:239]
    v_mfma_f32_16x16x32_bf16 v[236:239], a[160:163], a[216:219], v[236:239]
    buffer_store_dwordx2 v[254:255], v251, s[20:23], 0 offen offset:256 nt
    v_mfma_f32_16x16x32_bf16 v[236:239], a[164:167], a[220:223], v[236:239]
    v_exp_f32 v196, v196
    v_mfma_f32_16x16x32_bf16 v[228:231], a[168:171], a[232:235], 0
    v_exp_f32 v197, v197
    v_mfma_f32_16x16x32_bf16 v[228:231], a[172:175], a[236:239], v[228:231]
    v_exp_f32 v198, v198
    v_mfma_f32_16x16x32_bf16 v[228:231], a[176:179], a[240:243], v[228:231]
    v_exp_f32 v199, v199
    v_mfma_f32_16x16x32_bf16 v[228:231], a[180:183], a[244:247], v[228:231]
    v_cvt_pk_bf16_f32 v236, v236, v237
    v_cvt_pk_bf16_f32 v237, v238, v239
    v_mfma_f32_16x16x32_bf16 v[228:231], a[184:187], a[216:219], v[228:231]
    v_cvt_pk_bf16_f32 v185, v196, v197
    v_cvt_pk_bf16_f32 v188, v198, v199
    v_mfma_f32_16x16x32_bf16 v[228:231], a[188:191], a[220:223], v[228:231]
    v_mbcnt_lo_u32_b32 v254, -1, 0
    v_mbcnt_hi_u32_b32 v254, -1, v254
    v_mfma_f32_16x16x32_bf16 v[212:215], v[24:27], v[184:187], v[212:215]
    v_lshrrev_b32 v255, 4, v254
    v_add_u32 v251, s53, v255
    v_mfma_f32_16x16x32_bf16 v[216:219], v[54:57], v[184:187], v[216:219]
    s_mul_i32 s53, s53, s31
    v_mul_i32_i24 v250, s31, v255
    v_cvt_pk_bf16_f32 v228, v228, v229
    v_mfma_f32_16x16x32_bf16 v[220:223], v[84:87], v[184:187], v[220:223]
    s_add_u32 s52, s52, s53
    v_cvt_pk_bf16_f32 v229, v230, v231
    v_and_b32 v254, 15, v254
    v_mfma_f32_16x16x32_bf16 v[224:227], a[248:251], v[184:187], v[224:227]
    s_add_u32 s52, s52, s32
    v_add_u32 v250, s52, v250
    v_add_u32 v250, 0x80000000, v250
    v_mfma_f32_16x16x32_bf16 v[212:215], v[28:31], v[188:191], v[212:215]
    v_lshlrev_b32 v255, 3, v255
    v_and_b32 v255, 8, v255
    v_mfma_f32_16x16x32_bf16 v[216:219], v[58:61], v[188:191], v[216:219]
    v_mfma_f32_16x16x32_bf16 v[220:223], v[88:91], v[188:191], v[220:223]
    v_mfma_f32_16x16x32_bf16 v[224:227], a[248:251], v[188:191], v[224:227]
    v_mfma_f32_16x16x32_bf16 v[232:235], a[192:195], a[232:235], 0
    v_mfma_f32_16x16x32_bf16 v[232:235], a[196:199], a[236:239], v[232:235]
    v_mfma_f32_16x16x32_bf16 v[232:235], a[200:203], a[240:243], v[232:235]
    v_mfma_f32_16x16x32_bf16 v[232:235], a[204:207], a[244:247], v[232:235]
    v_mfma_f32_16x16x32_bf16 v[232:235], a[208:211], a[216:219], v[232:235]
    v_mfma_f32_16x16x32_bf16 v[232:235], a[212:215], a[220:223], v[232:235]
    s_nop 1
    v_mov_b32 v226, 0x5d800000
    v_rcp_f32 v225, v224
    s_nop 0
    v_max3_f32 v248, v248, v224, v225
    v_cmp_gt_f32 vcc, v248, v226
    v_mov_b32 v226, s67
    v_cvt_pk_bf16_f32 v232, v232, v233
    v_cvt_pk_bf16_f32 v233, v234, v235
    s_cmp_lg_u64 vcc, 0
    s_cselect_b32 s66, 1, 0
    v_mul_f32 v212, v212, v225
    v_mul_f32 v213, v213, v225
    v_mul_f32 v214, v214, v225
    v_mul_f32 v215, v215, v225
    v_cvt_pk_bf16_f32 v212, v212, v213
    v_cvt_pk_bf16_f32 v213, v214, v215
    ds_write_b64 v247, v[212:213] offset:55296
    v_mul_f32 v216, v216, v225
    v_mul_f32 v217, v217, v225
    v_mul_f32 v218, v218, v225
    v_mul_f32 v219, v219, v225
    v_cvt_pk_bf16_f32 v216, v216, v217
    v_cvt_pk_bf16_f32 v217, v218, v219
    ds_write_b64 v247, v[216:217] offset:55424
    v_mul_f32 v220, v220, v225
    v_mul_f32 v221, v221, v225
    v_mul_f32 v222, v222, v225
    v_mul_f32 v223, v223, v225
    v_mov_b32 v225, s66
    ds_write_b32 v226, v225 offset:0
    v_cvt_pk_bf16_f32 v220, v220, v221
    v_cvt_pk_bf16_f32 v221, v222, v223
    ds_write_b64 v247, v[220:221] offset:55552
    v_cmp_gt_u32 vcc, 17, v251
    v_mov_b32 v226, 0x23000
    s_nop 0
    v_cndmask_b32 v250, 0, v250, vcc
    v_add_u32 v250, 0x80000000, v250
    v_lshl_add_u32 v251, v254, 3, v250
    v_xor_b32 v254, v254, v255
    v_lshl_add_u32 v250, v254, 4, v250
    s_waitcnt lgkmcnt(0)
    s_barrier
    ds_write_b64 v249, v[236:237] offset:49152
    ds_write_b64 v249, v[228:229] offset:49280
    ds_write_b64 v249, v[232:233] offset:49408
    ds_read_b128 a[224:227], v242 offset:55296
    ds_read_b128 a[228:231], v243 offset:55296
    ds_read_b128 a[232:235], v242 offset:55424
    ds_read_b128 a[236:239], v243 offset:55424
    ds_read_b128 a[240:243], v242 offset:55552
    ds_read_b128 a[244:247], v243 offset:55552
    ds_read_b128 a[252:255], v252 offset:43008
    ds_read_b64 v[254:255], v253 offset:43264
    ds_read_b128 v[196:199], v226 offset:0
    s_waitcnt lgkmcnt(8)
    v_mfma_f32_16x16x32_bf16 v[236:239], a[144:147], a[224:227], 0
    v_mfma_f32_16x16x32_bf16 v[228:231], a[168:171], a[224:227], 0
    s_waitcnt lgkmcnt(7)
    v_mfma_f32_16x16x32_bf16 v[236:239], a[148:151], a[228:231], v[236:239]
    s_waitcnt lgkmcnt(6)
    v_mfma_f32_16x16x32_bf16 v[236:239], a[152:155], a[232:235], v[236:239]
    s_waitcnt lgkmcnt(5)
    v_mfma_f32_16x16x32_bf16 v[236:239], a[156:159], a[236:239], v[236:239]
    s_waitcnt lgkmcnt(4)
    v_mfma_f32_16x16x32_bf16 v[236:239], a[160:163], a[240:243], v[236:239]
    s_waitcnt lgkmcnt(3)
    s_barrier
    s_waitcnt lgkmcnt(2)
    v_mfma_f32_16x16x32_bf16 v[236:239], a[164:167], a[244:247], v[236:239]
    buffer_store_dwordx4 a[252:255], v250, s[20:23], 0 offen nt
    v_mfma_f32_16x16x32_bf16 v[228:231], a[172:175], a[228:231], v[228:231]
    s_waitcnt lgkmcnt(0)
    v_or3_b32 v225, v196, v197, v198
    v_or_b32 v225, v225, v199
    v_mfma_f32_16x16x32_bf16 v[228:231], a[176:179], a[232:235], v[228:231]
    ds_read_b128 a[252:255], v252 offset:49152
    v_readfirstlane_b32 s47, v225
    v_mfma_f32_16x16x32_bf16 v[228:231], a[180:183], a[236:239], v[228:231]
    v_cvt_pk_bf16_f32 v236, v236, v237
    v_cvt_pk_bf16_f32 v237, v238, v239
    v_mfma_f32_16x16x32_bf16 v[228:231], a[184:187], a[240:243], v[228:231]
    ds_write_b64 v249, v[236:237] offset:55296
    v_mfma_f32_16x16x32_bf16 v[228:231], a[188:191], a[244:247], v[228:231]
    buffer_store_dwordx2 v[254:255], v251, s[20:23], 0 offen offset:256 nt
    v_mfma_f32_16x16x32_bf16 v[232:235], a[192:195], a[224:227], 0
    v_mbcnt_lo_u32_b32 v254, -1, 0
    v_mbcnt_hi_u32_b32 v254, -1, v254
    v_mfma_f32_16x16x32_bf16 v[232:235], a[196:199], a[228:231], v[232:235]
    v_lshrrev_b32 v255, 4, v254
    v_mul_i32_i24 v250, s31, v255
    v_mfma_f32_16x16x32_bf16 v[232:235], a[200:203], a[232:235], v[232:235]
    v_cvt_pk_bf16_f32 v228, v228, v229
    v_cvt_pk_bf16_f32 v229, v230, v231
    v_mfma_f32_16x16x32_bf16 v[232:235], a[204:207], a[236:239], v[232:235]
    ds_write_b64 v249, v[228:229] offset:55424
    v_mfma_f32_16x16x32_bf16 v[232:235], a[208:211], a[240:243], v[232:235]
    v_add_u32 v250, s54, v250
    v_and_b32 v254, 15, v254
    v_mfma_f32_16x16x32_bf16 v[232:235], a[212:215], a[244:247], v[232:235]
    v_lshl_add_u32 v251, v254, 3, v250
    v_lshlrev_b32 v255, 3, v255
    v_and_b32 v255, 8, v255
    v_xor_b32 v254, v254, v255
    v_lshl_add_u32 v250, v254, 4, v250
    ds_read_b64 v[254:255], v253 offset:49408
    s_waitcnt lgkmcnt(2)
    buffer_store_dwordx4 a[252:255], v250, s[20:23], 0 offen nt
    v_cvt_pk_bf16_f32 v232, v232, v233
    v_cvt_pk_bf16_f32 v233, v234, v235
    ds_write_b64 v249, v[232:233] offset:55552
    s_waitcnt lgkmcnt(1)
    buffer_store_dwordx2 v[254:255], v251, s[20:23], 0 offen offset:256 nt
    v_mbcnt_lo_u32_b32 v254, -1, 0
    v_mbcnt_hi_u32_b32 v254, -1, v254
    v_lshrrev_b32 v255, 4, v254
    v_add_u32 v251, s57, v255
    v_cmp_gt_u32 vcc, 17, v251
    s_mul_i32 s57, s57, s31
    s_add_u32 s56, s56, s57
    s_add_u32 s56, s56, s32
    v_mul_i32_i24 v250, s31, v255
    v_add_u32 v250, s56, v250
    v_add_u32 v250, 0x80000000, v250
    v_cndmask_b32 v250, 0, v250, vcc
    v_add_u32 v250, 0x80000000, v250
    v_and_b32 v254, 15, v254
    v_lshl_add_u32 v251, v254, 3, v250
    v_lshlrev_b32 v255, 3, v255
    v_and_b32 v255, 8, v255
    v_xor_b32 v254, v254, v255
    v_lshl_add_u32 v250, v254, 4, v250
    s_waitcnt lgkmcnt(0)
    s_barrier
    ds_read_b128 a[252:255], v252 offset:55296
    ds_read_b64 v[254:255], v253 offset:55552
    s_waitcnt lgkmcnt(1)
    buffer_store_dwordx4 a[252:255], v250, s[20:23], 0 offen nt
    s_waitcnt lgkmcnt(0)
    buffer_store_dwordx2 v[254:255], v251, s[20:23], 0 offen offset:256 nt
    s_nop 4
    s_cmp_lg_u32 s47, 0
    s_cbranch_scc1 L_safe
L_exit:
    s_endpgm
L_safe:
    s_waitcnt vmcnt(0) lgkmcnt(0)
    s_nop 7
    s_barrier
    v_mbcnt_lo_u32_b32 v1, -1, 0
    v_mbcnt_hi_u32_b32 v1, -1, v1
    s_lshl_b32 s50, s28, 1
    s_mul_i32 s51, s36, 7
    v_add_u32 v2, 0, v1
    v_mul_u32_u24 v3, 0xaab, v2
    v_lshrrev_b32 v3, 16, v3
    v_mul_u32_u24 v4, 24, v3
    v_sub_u32 v2, v2, v4
    v_bfe_u32 v4, v3, 1, 1
    v_or_b32 v4, s50, v4
    v_xor_b32 v2, v2, v4
    v_xor_b32 v3, s51, v3
    v_mul_u32_u24 v3, 0x300, v3
    v_lshl_add_u32 v168, v2, 4, v3
    v_add_u32 v5, s40, v168
    v_max_i32 v5, 0, v5
    v_add_u32 v2, 64, v1
    v_mul_u32_u24 v3, 0xaab, v2
    v_lshrrev_b32 v3, 16, v3
    v_mul_u32_u24 v4, 24, v3
    v_sub_u32 v2, v2, v4
    v_bfe_u32 v4, v3, 1, 1
    v_or_b32 v4, s50, v4
    v_xor_b32 v2, v2, v4
    v_xor_b32 v3, s51, v3
    v_mul_u32_u24 v3, 0x300, v3
    v_lshl_add_u32 v169, v2, 4, v3
    v_add_u32 v6, s40, v169
    v_max_i32 v6, 0, v6
    v_add_u32 v2, 0x80, v1
    v_mul_u32_u24 v3, 0xaab, v2
    v_lshrrev_b32 v3, 16, v3
    v_mul_u32_u24 v4, 24, v3
    v_sub_u32 v2, v2, v4
    v_bfe_u32 v4, v3, 1, 1
    v_or_b32 v4, s50, v4
    v_xor_b32 v2, v2, v4
    v_xor_b32 v3, s51, v3
    v_mul_u32_u24 v3, 0x300, v3
    v_lshl_add_u32 v170, v2, 4, v3
    v_add_u32 v7, s40, v170
    v_max_i32 v7, 0, v7
    v_add_u32 v2, 32, v1
    v_mul_u32_u24 v3, 0xaab, v2
    v_lshrrev_b32 v3, 16, v3
    v_mul_u32_u24 v4, 24, v3
    v_sub_u32 v2, v2, v4
    v_bfe_u32 v4, v3, 1, 1
    v_or_b32 v4, s50, v4
    v_xor_b32 v2, v2, v4
    v_xor_b32 v3, s51, v3
    v_mul_u32_u24 v3, 0x300, v3
    v_lshl_add_u32 v171, v2, 4, v3
    v_add_u32 v2, 0, v1
    v_mul_u32_u24 v3, 0x2aab, v2
    v_lshrrev_b32 v3, 16, v3
    v_mul_u32_u24 v4, 6, v3
    v_sub_u32 v2, v2, v4
    v_lshrrev_b32 v4, 1, v3
    v_and_b32 v4, 4, v4
    v_xor_b32 v3, v3, v4
    v_mul_u32_u24 v3, 0x480, v3
    v_lshl_add_u32 v172, v2, 4, v3
    v_add_u32 v2, 64, v1
    v_mul_u32_u24 v3, 0x2aab, v2
    v_lshrrev_b32 v3, 16, v3
    v_mul_u32_u24 v4, 6, v3
    v_sub_u32 v2, v2, v4
    v_lshrrev_b32 v4, 1, v3
    v_and_b32 v4, 4, v4
    v_xor_b32 v3, v3, v4
    v_mul_u32_u24 v3, 0x480, v3
    v_lshl_add_u32 v173, v2, 4, v3
    v_add_u32 v2, 0x80, v1
    v_mul_u32_u24 v3, 0x2aab, v2
    v_lshrrev_b32 v3, 16, v3
    v_mul_u32_u24 v4, 6, v3
    v_sub_u32 v2, v2, v4
    v_lshrrev_b32 v4, 1, v3
    v_and_b32 v4, 4, v4
    v_xor_b32 v3, v3, v4
    v_mul_u32_u24 v3, 0x480, v3
    v_lshl_add_u32 v174, v2, 4, v3
L_safe2:
    s_add_u32 m0, s46, 0
    s_add_u32 s51, s40, s45
    buffer_load_dwordx4 v5, s[4:7], 0 offen lds
    s_add_u32 m0, s46, 0x400
    s_add_u32 s52, s40, s45
    buffer_load_dwordx4 v6, s[4:7], 0 offen lds
    s_add_u32 m0, s46, 0x800
    s_add_u32 s53, s40, s45
    buffer_load_dwordx4 v7, s[4:7], 0 offen lds
    s_add_u32 m0, s46, 0xc00
    s_lshl1_add_u32 s54, s45, s40
    buffer_load_dwordx4 v168, s[4:7], s51 offen lds
    s_add_u32 m0, s46, 0x1000
    s_lshl1_add_u32 s55, s45, s40
    buffer_load_dwordx4 v169, s[4:7], s52 offen lds
    s_add_u32 m0, s46, 0x1400
    s_add_u32 s60, s39, 0x180
    buffer_load_dwordx4 v170, s[4:7], s53 offen lds
    s_add_u32 m0, s46, 0x1800
    v_and_b32 v13, 15, v1
    buffer_load_dwordx4 v168, s[4:7], s54 offen lds
    s_add_u32 m0, s46, 0x1a00
    v_lshrrev_b32 v14, 4, v1
    buffer_load_dwordx4 v171, s[4:7], s55 offen lds
    s_add_u32 m0, s29, 0
    v_lshrrev_b32 v15, 2, v13
    buffer_load_dwordx4 v172, s[8:11], s60 offen lds
    s_add_u32 m0, s29, 0x400
    v_and_b32 v16, 3, v13
    buffer_load_dwordx4 v173, s[8:11], s60 offen lds
    s_add_u32 m0, s29, 0x800
    v_and_b32 v17, 1, v14
    buffer_load_dwordx4 v174, s[8:11], s60 offen lds
    v_lshl_add_u32 v18, v14, 3, v15
    v_xor_b32 v19, 0, v17
    v_lshl_add_u32 v19, v19, 2, v18
    v_mul_u32_u24 v19, 0x60, v19
    v_lshl_add_u32 v19, v16, 3, v19
    v_add_u32 v249, s29, v19
    v_add_u32 v19, s46, v19
    v_add_u32 v175, 0xf000, v19
    v_xor_b32 v19, 1, v17
    v_lshl_add_u32 v19, v19, 2, v18
    v_mul_u32_u24 v19, 0x60, v19
    v_lshl_add_u32 v19, v16, 3, v19
    v_add_u32 v250, s29, v19
    v_add_u32 v19, s46, v19
    v_add_u32 v176, 0xf000, v19
    v_mov_b32 v17, v15
    v_and_b32 v18, 3, v17
    v_mul_u32_u24 v17, 0x1e00, v17
    v_lshlrev_b32 v18, 1, v18
    v_bfe_u32 v241, v16, 1, 1
    v_or_b32 v18, v18, v241
    v_xor_b32 v18, v18, v14
    v_lshl_add_u32 v17, v18, 4, v17
    v_mul_u32_u24 v18, 0x180, v16
    v_add_u32 v240, v17, v18
    v_xor_b32 v241, 64, v240
    s_add_u32 m0, s46, 0x7800
    s_add_u32 s61, s39, 0x9180
    buffer_load_dwordx4 v168, s[4:7], s41 offen lds
    s_add_u32 m0, s29, 0xc00
    s_add_u32 s62, s39, 0x12180
    s_add_u32 s56, s41, s45
    s_add_u32 s63, s39, 0x1b180
    s_add_u32 s57, s41, s45
    s_add_u32 s60, s39, 0x24180
    s_add_u32 s58, s41, s45
    s_lshl1_add_u32 s59, s45, s41
    s_lshl1_add_u32 s50, s45, s41
    v_lshlrev_b32 v12, 4, v1
    s_and_b32 s65, s48, 0xfff0
    s_add_u32 s51, s42, s45
    s_add_u32 s52, s42, s45
    s_add_u32 s53, s42, s45
    s_lshl1_add_u32 s54, s45, s42
    s_lshl1_add_u32 s55, s45, s42
    v_add_u32 v17, 3, v15
    v_add_u32 v19, 3, v16
    v_and_b32 v18, 3, v17
    v_mul_u32_u24 v17, 0x1e00, v17
    v_lshlrev_b32 v18, 1, v18
    v_bfe_u32 v243, v19, 1, 1
    v_or_b32 v18, v18, v243
    v_xor_b32 v18, v18, v14
    v_lshl_add_u32 v17, v18, 4, v17
    v_mul_u32_u24 v18, 0x180, v19
    v_add_u32 v242, v17, v18
    v_xor_b32 v243, 64, v242
    v_accvgpr_write_b32 a252, v168
    v_accvgpr_read_b32 v254, a252
    v_accvgpr_write_b32 a253, v169
    v_accvgpr_read_b32 v255, a253
    v_accvgpr_write_b32 a254, v170
    v_accvgpr_write_b32 a255, v171
    v_mov_b32 v17, 0x3f803f80
    v_accvgpr_write_b32 a248, v17
    v_accvgpr_write_b32 a249, v17
    v_accvgpr_write_b32 a250, v17
    v_accvgpr_write_b32 a251, v17
    v_mov_b32 v248, 0
    s_and_b32 s66, s28, 1
    s_lshl_b32 s66, s66, 2
    s_lshr_b32 s67, s28, 1
    s_lshl_b32 s67, s67, 3
    v_lshrrev_b32 v18, 1, v13
    v_xor_b32 v18, v14, v18
    v_xor_b32 v18, s66, v18
    v_mul_u32_u24 v17, 0x180, v13
    v_lshl_add_u32 v17, v18, 4, v17
    v_add_u32 v17, s67, v17
    s_mul_i32 s67, s28, 0x600
    v_add_u32 v247, 0x7800, v17
    v_add_u32 v251, 0x1e000, v17
    v_sub_u32 v17, v14, v15
    v_mul_i32_i24 v17, 0x1c0, v17
    v_lshlrev_b32 v18, 4, v16
    v_sub_u32 v17, v17, v18
    v_add_u32 v17, s37, v17
    v_max_u32 v18, s33, v15
    v_sub_u32 v18, v14, v18
    v_add_u32 v244, 0, v18
    v_cmp_gt_u32 vcc, 7, v244
    v_add_u32 v244, 0xfffdc870, v17
    v_add_u32 v245, 4, v18
    v_cndmask_b32 v244, 0, v244, vcc
    v_add_u32 v244, 0x237c0, v244
    v_cmp_gt_u32 vcc, 7, v245
    v_add_u32 v245, 0xfffdcf70, v17
    v_add_u32 v246, 8, v18
    v_cndmask_b32 v245, 0, v245, vcc
    v_add_u32 v245, 0x237c0, v245
    v_cmp_gt_u32 vcc, 7, v246
    v_add_u32 v246, 0xfffdd670, v17
    v_min_u32 v20, 55, v1
    v_cndmask_b32 v246, 0, v246, vcc
    v_add_u32 v246, 0x237c0, v246
    v_lshlrev_b32 v62, 3, v20
    s_mul_i32 s64, s35, 0xfc0
    s_add_u32 s64, s64, s37
    v_add_u32 v62, s64, v62
    v_lshrrev_b32 v21, 1, v20
    v_and_b32 v20, 1, v20
    v_lshlrev_b32 v20, 1, v20
    v_add_u32 v22, -12, v21
    v_cmp_lt_u32 vcc, 11, v21
    v_mov_b32 v23, s34
    s_lshl_b32 s66, s36, 1
    v_cndmask_b32 v22, v21, v22, vcc
    v_cndmask_b32 v23, 0, v23, vcc
    s_sub_u32 s66, 1, s66
    v_add_u32 v63, 0, v20
    v_add3_u32 v64, v22, v63, -6
    v_add_u32 v65, 3, v64
    v_and_b32 v66, 12, v22
    v_add3_u32 v66, v66, v63, -3
    v_cmp_ne_u32 vcc, 0, v23
    v_mul_i32_i24 v64, s66, v64
    v_add_lshl_u32 v64, v64, 6, 1
    v_cndmask_b32 v65, v65, v66, vcc
    v_cmp_gt_u32 vcc, 7, v65
    v_mov_b32 v65, 0xf149f2ca
    v_add_u32 v63, 1, v20
    v_cndmask_b32 v50, 0, v64, vcc
    v_mov_b32 v64, 0x3fb8aa3b
    v_cndmask_b32 v52, 0, v64, vcc
    v_mov_b32 v64, 0
    v_cndmask_b32 v60, v65, v64, vcc
    v_add3_u32 v64, v22, v63, -6
    v_add_u32 v65, 3, v64
    v_and_b32 v66, 12, v22
    v_add3_u32 v66, v66, v63, -3
    v_cmp_ne_u32 vcc, 0, v23
    v_mul_i32_i24 v64, s66, v64
    v_add_lshl_u32 v64, v64, 6, 1
    v_cndmask_b32 v65, v65, v66, vcc
    v_cmp_gt_u32 vcc, 7, v65
    v_mov_b32 v65, 0xf149f2ca
    v_mbcnt_lo_u32_b32 v24, -1, 0
    v_cndmask_b32 v51, 0, v64, vcc
    v_mov_b32 v64, 0x3fb8aa3b
    v_cndmask_b32 v53, 0, v64, vcc
    v_mov_b32 v64, 0
    v_cndmask_b32 v61, v65, v64, vcc
    buffer_load_dwordx4 v172, s[8:11], s61 offen lds
    s_add_u32 m0, s29, 0x1000
    v_mbcnt_hi_u32_b32 v24, -1, v24
    v_add_u32 v25, 0, v24
    v_mul_u32_u24 v26, 0x2aab, v25
    v_lshrrev_b32 v26, 16, v26
    v_mul_u32_u24 v27, 6, v26
    v_sub_u32 v25, v25, v27
    v_lshrrev_b32 v27, 1, v26
    v_and_b32 v27, 4, v27
    v_xor_b32 v26, v26, v27
    v_bfe_u32 v27, v26, 2, 1
    v_mul_u32_u24 v28, 0x60, v27
    v_lshrrev_b32 v27, 3, v26
    v_lshl_add_u32 v28, v27, 2, v28
    v_and_or_b32 v26, v26, 3, v28
    buffer_load_dwordx4 v173, s[8:11], s61 offen lds
    s_add_u32 m0, s46, 0x7c00
    v_lshrrev_b32 v27, 1, v25
    v_and_b32 v25, 1, v25
    v_lshl_add_u32 v25, v27, 3, v25
    v_mul_u32_u24 v26, 0x180, v26
    v_lshl_add_u32 v28, v25, 4, v26
    v_add_u32 v25, 64, v24
    v_mul_u32_u24 v26, 0x2aab, v25
    v_lshrrev_b32 v26, 16, v26
    v_mul_u32_u24 v27, 6, v26
    v_sub_u32 v25, v25, v27
    v_lshrrev_b32 v27, 1, v26
    v_and_b32 v27, 4, v27
    v_xor_b32 v26, v26, v27
    v_bfe_u32 v27, v26, 2, 1
    buffer_load_dwordx4 v169, s[4:7], s41 offen lds
    s_add_u32 m0, s29, 0x1400
    v_mul_u32_u24 v29, 0x60, v27
    v_lshrrev_b32 v27, 3, v26
    v_lshl_add_u32 v29, v27, 2, v29
    v_and_or_b32 v26, v26, 3, v29
    v_lshrrev_b32 v27, 1, v25
    v_and_b32 v25, 1, v25
    v_lshl_add_u32 v25, v27, 3, v25
    v_mul_u32_u24 v26, 0x180, v26
    v_lshl_add_u32 v29, v25, 4, v26
    v_add_u32 v25, 0x80, v24
    v_mul_u32_u24 v26, 0x2aab, v25
    v_lshrrev_b32 v26, 16, v26
    v_mul_u32_u24 v27, 6, v26
    v_sub_u32 v25, v25, v27
    buffer_load_dwordx4 v174, s[8:11], s61 offen lds
    s_add_u32 m0, s29, 0x1800
    s_add_u32 s61, s39, 0x2d180
    v_lshrrev_b32 v27, 1, v26
    v_and_b32 v27, 4, v27
    v_xor_b32 v26, v26, v27
    v_bfe_u32 v27, v26, 2, 1
    v_mul_u32_u24 v58, 0x60, v27
    v_lshrrev_b32 v27, 3, v26
    v_lshl_add_u32 v58, v27, 2, v58
    v_and_or_b32 v26, v26, 3, v58
    v_lshrrev_b32 v27, 1, v25
    v_and_b32 v25, 1, v25
    v_lshl_add_u32 v25, v27, 3, v25
    v_mul_u32_u24 v26, 0x180, v26
    v_lshl_add_u32 v58, v25, 4, v26
    buffer_load_dwordx4 v172, s[8:11], s62 offen lds
    s_add_u32 m0, s46, 0x8000
    s_mul_i32 s66, s28, 0x4800
    v_lshl_add_u32 v89, v24, 4, s66
    s_mul_i32 s66, s28, 0x4800
    s_and_b32 s64, s48, 15
    s_add_u32 s64, s64, s37
    v_add_u32 v50, s64, v50
    v_add_u32 v51, s64, v51
    v_mov_b32 v64, 0xf149f2ca
    v_mov_b32 v65, 0xf149f2ca
    v_lshlrev_b32 v63, 3, v1
    v_add_u32 v63, 0x237c0, v63
    ds_write_b64 v63, v[64:65] offset:0
    buffer_load_dwordx4 v170, s[4:7], s41 offen lds
    s_add_u32 m0, s29, 0x1c00
    s_nop 0
    buffer_load_dwordx4 v173, s[8:11], s62 offen lds
    s_add_u32 m0, s29, 0x2000
    s_nop 0
    s_waitcnt vmcnt(11)
    s_barrier
    ds_read_b128 a[216:219], v240 offset:0
    ds_read_b128 a[220:223], v240 offset:1536
    ds_read_b128 a[224:227], v240 offset:3072
    ds_read_b128 a[228:231], v240 offset:4608
    ds_read_b128 a[232:235], v241 offset:0
    ds_read_b128 a[236:239], v241 offset:1536
    ds_read_b128 a[240:243], v241 offset:3072
    ds_read_b128 a[244:247], v241 offset:4608
    buffer_load_dwordx4 v174, s[8:11], s62 offen lds
    s_add_u32 m0, s46, 0x8400
    s_add_u32 s62, s39, 0x300
    buffer_load_dwordx4 v168, s[4:7], s56 offen lds
    s_add_u32 m0, s29, 0x2400
    s_mov_b32 s56, 0
    buffer_load_dwordx4 v172, s[8:11], s63 offen lds
    s_add_u32 m0, s29, 0x2800
    s_nop 0
    s_waitcnt vmcnt(11)
    ds_read_b64_tr_b16 a[0:1], v249 offset:0
    ds_read_b64_tr_b16 a[2:3], v250 offset:0
    ds_read_b64_tr_b16 a[24:25], v249 offset:32
    ds_read_b64_tr_b16 a[26:27], v250 offset:32
    ds_read_b64_tr_b16 a[48:49], v249 offset:64
    ds_read_b64_tr_b16 a[50:51], v250 offset:64
    buffer_load_dwordx4 v173, s[8:11], s63 offen lds
    s_add_u32 m0, s46, 0x8800
    s_nop 0
    buffer_load_dwordx4 v169, s[4:7], s57 offen lds
    s_add_u32 m0, s29, 0x2c00
    s_mov_b32 s57, 0x1800
    s_waitcnt lgkmcnt(4)
    v_mfma_f32_16x16x32_bf16 v[180:183], a[0:3], a[216:219], 0
    v_mfma_f32_16x16x32_bf16 v[192:195], a[0:3], a[220:223], 0
    s_waitcnt lgkmcnt(1)
    v_mfma_f32_16x16x32_bf16 v[184:187], a[24:27], a[216:219], 0
    s_waitcnt lgkmcnt(0)
    v_mfma_f32_16x16x32_bf16 v[188:191], a[48:51], a[216:219], 0
    ds_read_b128 a[216:219], v240 offset:128
    v_mfma_f32_16x16x32_bf16 v[196:199], a[24:27], a[220:223], 0
    buffer_load_dwordx4 v174, s[8:11], s63 offen lds
    s_add_u32 m0, s46, 0xf000
    v_mfma_f32_16x16x32_bf16 v[200:203], a[48:51], a[220:223], 0
    ds_read_b128 a[220:223], v240 offset:1664
    s_add_u32 s63, s39, 0x9300
    v_mfma_f32_16x16x32_bf16 v[204:207], a[0:3], a[224:227], 0
    v_mfma_f32_16x16x32_bf16 v[208:211], a[24:27], a[224:227], 0
    v_mfma_f32_16x16x32_bf16 v[212:215], a[48:51], a[224:227], 0
    ds_read_b128 a[224:227], v240 offset:3200
    v_mfma_f32_16x16x32_bf16 v[216:219], a[0:3], a[228:231], 0
    buffer_load_dwordx4 v172, s[8:11], s60 offen lds
    s_add_u32 m0, s46, 0x8c00
    v_mfma_f32_16x16x32_bf16 v[220:223], a[24:27], a[228:231], 0
    v_mfma_f32_16x16x32_bf16 v[224:227], a[48:51], a[228:231], 0
    ds_read_b128 a[228:231], v240 offset:4736
    s_waitcnt vmcnt(10)
    ds_read_b64_tr_b16 a[4:5], v249 offset:3072
    buffer_load_dwordx4 v170, s[4:7], s58 offen lds
    s_add_u32 m0, s46, 0xf400
    ds_read_b64_tr_b16 a[6:7], v250 offset:3072
    ds_read_b64_tr_b16 a[28:29], v249 offset:3104
    ds_read_b64_tr_b16 a[30:31], v250 offset:3104
    ds_read_b64_tr_b16 a[52:53], v249 offset:3136
    ds_read_b64_tr_b16 a[54:55], v250 offset:3136
    s_mov_b32 s58, 0x3000
    buffer_load_dwordx4 v173, s[8:11], s60 offen lds
    s_add_u32 m0, s46, 0xf800
    s_nop 0
    s_waitcnt lgkmcnt(4)
    v_mfma_f32_16x16x32_bf16 v[180:183], a[4:7], a[232:235], v[180:183]
    buffer_load_dwordx4 v174, s[8:11], s60 offen lds
    s_add_u32 m0, s46, 0x9000
    v_mfma_f32_16x16x32_bf16 v[192:195], a[4:7], a[236:239], v[192:195]
    s_add_u32 s60, s39, 0x12300
    s_waitcnt lgkmcnt(1)
    s_waitcnt lgkmcnt(0)
    v_mfma_f32_16x16x32_bf16 v[184:187], a[28:31], a[232:235], v[184:187]
    v_mfma_f32_16x16x32_bf16 v[188:191], a[52:55], a[232:235], v[188:191]
    ds_read_b128 a[232:235], v241 offset:128
    v_mfma_f32_16x16x32_bf16 v[196:199], a[28:31], a[236:239], v[196:199]
    v_mfma_f32_16x16x32_bf16 v[200:203], a[52:55], a[236:239], v[200:203]
    ds_read_b128 a[236:239], v241 offset:1664
    v_mfma_f32_16x16x32_bf16 v[204:207], a[4:7], a[240:243], v[204:207]
    buffer_load_dwordx4 v168, s[4:7], s59 offen lds
    s_add_u32 m0, s46, 0xfc00
    v_mfma_f32_16x16x32_bf16 v[208:211], a[28:31], a[240:243], v[208:211]
    s_mov_b32 s59, 0x400
    v_mfma_f32_16x16x32_bf16 v[212:215], a[52:55], a[240:243], v[212:215]
    ds_read_b128 a[240:243], v241 offset:3200
    s_waitcnt vmcnt(10)
    v_mfma_f32_16x16x32_bf16 v[216:219], a[4:7], a[244:247], v[216:219]
    ds_read_b64_tr_b16 a[8:9], v249 offset:6144
    v_mfma_f32_16x16x32_bf16 v[220:223], a[28:31], a[244:247], v[220:223]
    ds_read_b64_tr_b16 a[10:11], v250 offset:6144
    v_mfma_f32_16x16x32_bf16 v[224:227], a[52:55], a[244:247], v[224:227]
    ds_read_b128 a[244:247], v241 offset:4736
    buffer_load_dwordx4 v172, s[8:11], s61 offen lds
    s_add_u32 m0, s46, 0x10000
    ds_read_b64_tr_b16 a[32:33], v249 offset:6176
    ds_read_b64_tr_b16 a[34:35], v250 offset:6176
    ds_read_b64_tr_b16 a[56:57], v249 offset:6208
    ds_read_b64_tr_b16 a[58:59], v250 offset:6208
    buffer_load_dwordx4 v173, s[8:11], s61 offen lds
    s_add_u32 m0, s46, 0x9200
    s_nop 0
    s_waitcnt lgkmcnt(5)
    v_mfma_f32_16x16x32_bf16 v[180:183], a[8:11], a[216:219], v[180:183]
    v_mfma_f32_16x16x32_bf16 v[192:195], a[8:11], a[220:223], v[192:195]
    v_mfma_f32_16x16x32_bf16 v[204:207], a[8:11], a[224:227], v[204:207]
    buffer_load_dwordx4 v171, s[4:7], s50 offen lds
    s_add_u32 m0, s46, 0x10400
    v_mfma_f32_16x16x32_bf16 v[216:219], a[8:11], a[228:231], v[216:219]
    s_waitcnt lgkmcnt(1)
    s_mov_b32 s50, 0x1c00
    s_waitcnt lgkmcnt(0)
    v_mfma_f32_16x16x32_bf16 v[184:187], a[32:35], a[216:219], v[184:187]
    v_mfma_f32_16x16x32_bf16 v[188:191], a[56:59], a[216:219], v[188:191]
    ds_read_b128 a[216:219], v240 offset:256
    v_mfma_f32_16x16x32_bf16 v[196:199], a[32:35], a[220:223], v[196:199]
    v_mfma_f32_16x16x32_bf16 v[200:203], a[56:59], a[220:223], v[200:203]
    ds_read_b128 a[220:223], v240 offset:1792
    v_mfma_f32_16x16x32_bf16 v[208:211], a[32:35], a[224:227], v[208:211]
    buffer_load_dwordx4 v174, s[8:11], s61 offen lds
    s_add_u32 m0, s37, 0xd80
    v_mfma_f32_16x16x32_bf16 v[212:215], a[56:59], a[224:227], v[212:215]
    ds_read_b128 a[224:227], v240 offset:3328
    s_add_u32 s61, s39, 0x1b300
    v_mfma_f32_16x16x32_bf16 v[220:223], a[32:35], a[228:231], v[220:223]
    v_mfma_f32_16x16x32_bf16 v[224:227], a[56:59], a[228:231], v[224:227]
    ds_read_b128 a[228:231], v240 offset:4864
    buffer_load_dwordx4 v12, s[16:19], s65 offen lds
    s_add_u32 m0, s46, 0xf000
    s_waitcnt vmcnt(10)
    ds_read_b64_tr_b16 a[12:13], v249 offset:9216
    ds_read_b64_tr_b16 a[14:15], v250 offset:9216
    ds_read_b64_tr_b16 a[36:37], v249 offset:9248
    ds_read_b64_tr_b16 a[38:39], v250 offset:9248
    ds_read_b64_tr_b16 a[60:61], v249 offset:9280
    ds_read_b64_tr_b16 a[62:63], v250 offset:9280
    s_waitcnt lgkmcnt(4)
    v_mfma_f32_16x16x32_bf16 v[180:183], a[12:15], a[232:235], v[180:183]
    v_mfma_f32_16x16x32_bf16 v[192:195], a[12:15], a[236:239], v[192:195]
    s_waitcnt lgkmcnt(1)
    v_mfma_f32_16x16x32_bf16 v[184:187], a[36:39], a[232:235], v[184:187]
    s_waitcnt lgkmcnt(0)
    v_mfma_f32_16x16x32_bf16 v[188:191], a[60:63], a[232:235], v[188:191]
    ds_read_b128 a[232:235], v241 offset:256
    v_mfma_f32_16x16x32_bf16 v[196:199], a[36:39], a[236:239], v[196:199]
    v_mfma_f32_16x16x32_bf16 v[200:203], a[60:63], a[236:239], v[200:203]
    ds_read_b128 a[236:239], v241 offset:1792
    v_mfma_f32_16x16x32_bf16 v[204:207], a[12:15], a[240:243], v[204:207]
    v_mfma_f32_16x16x32_bf16 v[208:211], a[36:39], a[240:243], v[208:211]
    v_mfma_f32_16x16x32_bf16 v[212:215], a[60:63], a[240:243], v[212:215]
    ds_read_b128 a[240:243], v241 offset:3328
    v_mfma_f32_16x16x32_bf16 v[216:219], a[12:15], a[244:247], v[216:219]
    s_waitcnt vmcnt(6)
    ds_read_b64_tr_b16 a[16:17], v175 offset:0
    v_mfma_f32_16x16x32_bf16 v[220:223], a[36:39], a[244:247], v[220:223]
    ds_read_b64_tr_b16 a[18:19], v176 offset:0
    v_mfma_f32_16x16x32_bf16 v[224:227], a[60:63], a[244:247], v[224:227]
    ds_read_b128 a[244:247], v241 offset:4864
    ds_read_b64_tr_b16 a[40:41], v175 offset:32
    ds_read_b64_tr_b16 a[42:43], v176 offset:32
    ds_read_b64_tr_b16 a[64:65], v175 offset:64
    ds_read_b64_tr_b16 a[66:67], v176 offset:64
    s_waitcnt lgkmcnt(5)
    v_mfma_f32_16x16x32_bf16 v[180:183], a[16:19], a[216:219], v[180:183]
    v_mfma_f32_16x16x32_bf16 v[192:195], a[16:19], a[220:223], v[192:195]
    v_mfma_f32_16x16x32_bf16 v[204:207], a[16:19], a[224:227], v[204:207]
    s_waitcnt lgkmcnt(1)
    v_mfma_f32_16x16x32_bf16 v[184:187], a[40:43], a[216:219], v[184:187]
    s_waitcnt lgkmcnt(0)
    buffer_load_dwordx4 v168, s[4:7], s42 offen lds
    v_mfma_f32_16x16x32_bf16 v[188:191], a[64:67], a[216:219], v[188:191]
    s_add_u32 m0, s29, 0
    v_mfma_f32_16x16x32_bf16 v[196:199], a[40:43], a[220:223], v[196:199]
    v_mfma_f32_16x16x32_bf16 v[200:203], a[64:67], a[220:223], v[200:203]
    v_mfma_f32_16x16x32_bf16 v[208:211], a[40:43], a[224:227], v[208:211]
    v_mfma_f32_16x16x32_bf16 v[212:215], a[64:67], a[224:227], v[212:215]
    buffer_load_dwordx4 v172, s[8:11], s62 offen lds
    s_add_u32 m0, s29, 0x400
    v_mfma_f32_16x16x32_bf16 v[216:219], a[16:19], a[228:231], v[216:219]
    v_mfma_f32_16x16x32_bf16 v[220:223], a[40:43], a[228:231], v[220:223]
    v_mfma_f32_16x16x32_bf16 v[224:227], a[64:67], a[228:231], v[224:227]
    s_waitcnt vmcnt(4)
    s_barrier
    ds_read_b128 a[216:219], v240 offset:30720
    ds_read_b128 a[220:223], v241 offset:30720
    ds_read_b128 a[224:227], v240 offset:30848
    ds_read_b128 a[228:231], v241 offset:30848
    buffer_load_dwordx4 v173, s[8:11], s62 offen lds
    s_add_u32 m0, s46, 0xf400
    s_nop 0
    buffer_load_dwordx4 v169, s[4:7], s42 offen lds
    s_add_u32 m0, s29, 0x800
    s_waitcnt vmcnt(5)
    ds_read_b64_tr_b16 a[20:21], v175 offset:3072
    ds_read_b64_tr_b16 a[22:23], v176 offset:3072
    ds_read_b64_tr_b16 a[44:45], v175 offset:3104
    ds_read_b64_tr_b16 a[46:47], v176 offset:3104
    ds_read_b64_tr_b16 a[68:69], v175 offset:3136
    ds_read_b64_tr_b16 a[70:71], v176 offset:3136
    buffer_load_dwordx4 v174, s[8:11], s62 offen lds
    s_add_u32 m0, s29, 0xc00
    s_add_u32 s62, s39, 0x24300
    buffer_load_dwordx4 v172, s[8:11], s63 offen lds
    s_add_u32 m0, s46, 0xf800
    s_waitcnt lgkmcnt(4)
    v_mfma_f32_16x16x32_bf16 v[180:183], a[20:23], a[232:235], v[180:183]
    v_mfma_f32_16x16x32_bf16 v[192:195], a[20:23], a[236:239], v[192:195]
    s_waitcnt lgkmcnt(1)
    v_mfma_f32_16x16x32_bf16 v[184:187], a[44:47], a[232:235], v[184:187]
    s_waitcnt lgkmcnt(0)
    v_mfma_f32_16x16x32_bf16 v[188:191], a[68:71], a[232:235], v[188:191]
    ds_read_b128 a[232:235], v240 offset:30976
    v_mfma_f32_16x16x32_bf16 v[196:199], a[44:47], a[236:239], v[196:199]
    buffer_load_dwordx4 v170, s[4:7], s42 offen lds
    v_cvt_pk_bf16_f32 v90, v180, v181
    v_mfma_f32_16x16x32_bf16 v[200:203], a[68:71], a[236:239], v[200:203]
    ds_read_b128 a[236:239], v241 offset:30976
    v_cvt_pk_bf16_f32 v91, v182, v183
    v_mfma_f32_16x16x32_bf16 v[204:207], a[20:23], a[240:243], v[204:207]
    s_add_u32 m0, s29, 0x1000
    v_cvt_pk_bf16_f32 v92, v184, v185
    v_cvt_pk_bf16_f32 v93, v186, v187
    v_mfma_f32_16x16x32_bf16 v[208:211], a[44:47], a[240:243], v[208:211]
    v_cvt_pk_bf16_f32 v94, v188, v189
    v_cvt_pk_bf16_f32 v95, v190, v191
    v_mfma_f32_16x16x32_bf16 v[212:215], a[68:71], a[240:243], v[212:215]
    ds_read_b128 a[240:243], v240 offset:32256
    v_cvt_pk_bf16_f32 v96, v192, v193
    v_mfma_f32_16x16x32_bf16 v[216:219], a[20:23], a[244:247], v[216:219]
    buffer_load_dwordx4 v173, s[8:11], s63 offen lds
    v_cvt_pk_bf16_f32 v97, v194, v195
    v_mfma_f32_16x16x32_bf16 v[220:223], a[44:47], a[244:247], v[220:223]
    s_add_u32 m0, s29, 0x1400
    v_cvt_pk_bf16_f32 v98, v196, v197
    v_cvt_pk_bf16_f32 v99, v198, v199
    v_mfma_f32_16x16x32_bf16 v[224:227], a[68:71], a[244:247], v[224:227]
    ds_read_b128 a[244:247], v241 offset:32256
    v_cvt_pk_bf16_f32 v100, v200, v201
    v_mfma_f32_16x16x32_bf16 v[180:183], a[0:3], a[216:219], 0
    v_cvt_pk_bf16_f32 v101, v202, v203
    v_cvt_pk_bf16_f32 v102, v204, v205
    v_mfma_f32_16x16x32_bf16 v[184:187], a[24:27], a[216:219], 0
    v_cvt_pk_bf16_f32 v103, v206, v207
    v_cvt_pk_bf16_f32 v104, v208, v209
    v_mfma_f32_16x16x32_bf16 v[188:191], a[48:51], a[216:219], 0
    ds_read_b128 a[216:219], v240 offset:32384
    v_cvt_pk_bf16_f32 v105, v210, v211
    v_mfma_f32_16x16x32_bf16 v[180:183], a[4:7], a[220:223], v[180:183]
    buffer_load_dwordx4 v174, s[8:11], s63 offen lds
    v_cvt_pk_bf16_f32 v106, v212, v213
    v_mfma_f32_16x16x32_bf16 v[184:187], a[28:31], a[220:223], v[184:187]
    s_add_u32 m0, s46, 0xfc00
    v_cvt_pk_bf16_f32 v107, v214, v215
    v_cvt_pk_bf16_f32 v108, v216, v217
    v_mfma_f32_16x16x32_bf16 v[188:191], a[52:55], a[220:223], v[188:191]
    ds_read_b128 a[220:223], v241 offset:32384
    v_cvt_pk_bf16_f32 v109, v218, v219
    v_mfma_f32_16x16x32_bf16 v[180:183], a[8:11], a[224:227], v[180:183]
    s_add_u32 s63, s39, 0x2d300
    v_cvt_pk_bf16_f32 v110, v220, v221
    v_cvt_pk_bf16_f32 v111, v222, v223
    v_mfma_f32_16x16x32_bf16 v[184:187], a[32:35], a[224:227], v[184:187]
    s_waitcnt vmcnt(9) lgkmcnt(3)
    v_cvt_pk_bf16_f32 v112, v224, v225
    v_cvt_pk_bf16_f32 v113, v226, v227
    v_mfma_f32_16x16x32_bf16 v[188:191], a[56:59], a[224:227], v[188:191]
    ds_read_b128 a[224:227], v240 offset:32512
    v_mfma_f32_16x16x32_bf16 v[180:183], a[12:15], a[228:231], v[180:183]
    buffer_load_dwordx4 v168, s[4:7], s51 offen lds
    s_add_u32 m0, s29, 0x1800
    v_mfma_f32_16x16x32_bf16 v[184:187], a[36:39], a[228:231], v[184:187]
    ds_read_u16 v30, v50 offset:3456
    s_mov_b32 s51, 0x3400
    v_mfma_f32_16x16x32_bf16 v[188:191], a[60:63], a[228:231], v[188:191]
    ds_read_b128 a[228:231], v241 offset:32512
    v_mfma_f32_16x16x32_bf16 v[180:183], a[16:19], a[232:235], v[180:183]
    ds_read_u16 v31, v51 offset:3456
    v_mfma_f32_16x16x32_bf16 v[184:187], a[40:43], a[232:235], v[184:187]
    ds_read_u16 v32, v50 offset:3482
    v_mfma_f32_16x16x32_bf16 v[188:191], a[64:67], a[232:235], v[188:191]
    ds_read_b128 a[232:235], v240 offset:33792
    v_mfma_f32_16x16x32_bf16 v[180:183], a[20:23], a[236:239], v[180:183]
    buffer_load_dwordx4 v172, s[8:11], s60 offen lds
    s_add_u32 m0, s29, 0x1c00
    v_mfma_f32_16x16x32_bf16 v[184:187], a[44:47], a[236:239], v[184:187]
    ds_read_u16 v33, v51 offset:3482
    v_mfma_f32_16x16x32_bf16 v[188:191], a[68:71], a[236:239], v[188:191]
    ds_read_b128 a[236:239], v241 offset:33792
    v_mfma_f32_16x16x32_bf16 v[192:195], a[0:3], a[240:243], 0
    ds_read_u16 v34, v50 offset:3508
    v_cvt_pk_bf16_f32 v114, v180, v181
    v_mfma_f32_16x16x32_bf16 v[196:199], a[24:27], a[240:243], 0
    ds_read_u16 v35, v51 offset:3508
    v_cvt_pk_bf16_f32 v115, v182, v183
    v_mfma_f32_16x16x32_bf16 v[200:203], a[48:51], a[240:243], 0
    s_waitcnt lgkmcnt(7)
    v_cvt_pk_bf16_f32 v116, v184, v185
    v_cvt_pk_bf16_f32 v117, v186, v187
    v_mfma_f32_16x16x32_bf16 v[192:195], a[4:7], a[244:247], v[192:195]
    ds_read_b128 a[240:243], v240 offset:33920
    v_cvt_pk_bf16_f32 v118, v188, v189
    v_mfma_f32_16x16x32_bf16 v[196:199], a[28:31], a[244:247], v[196:199]
    buffer_load_dwordx4 v173, s[8:11], s60 offen lds
    v_cvt_pk_bf16_f32 v119, v190, v191
    v_mfma_f32_16x16x32_bf16 v[200:203], a[52:55], a[244:247], v[200:203]
    ds_read_b128 a[244:247], v241 offset:33920
    v_lshlrev_b32 v30, 16, v30
    v_mfma_f32_16x16x32_bf16 v[192:195], a[8:11], a[216:219], v[192:195]
    ds_read_u16 v36, v50 offset:3534
    v_fma_f32 v30, v30, v52, v60
    v_mfma_f32_16x16x32_bf16 v[196:199], a[32:35], a[216:219], v[196:199]
    ds_read_u16 v37, v51 offset:3534
    s_add_u32 m0, s46, 0x10000
    v_mfma_f32_16x16x32_bf16 v[200:203], a[56:59], a[216:219], v[200:203]
    ds_read_b128 a[216:219], v240 offset:34048
    s_waitcnt lgkmcnt(6)
    v_mfma_f32_16x16x32_bf16 v[192:195], a[12:15], a[220:223], v[192:195]
    buffer_load_dwordx4 v169, s[4:7], s52 offen lds
    v_lshlrev_b32 v31, 16, v31
    v_mfma_f32_16x16x32_bf16 v[196:199], a[36:39], a[220:223], v[196:199]
    ds_read_u16 v38, v50 offset:3560
    v_fma_f32 v31, v31, v53, v61
    v_mfma_f32_16x16x32_bf16 v[200:203], a[60:63], a[220:223], v[200:203]
    ds_read_b128 a[220:223], v241 offset:34048
    v_lshlrev_b32 v32, 16, v32
    v_mfma_f32_16x16x32_bf16 v[192:195], a[16:19], a[224:227], v[192:195]
    ds_read_u16 v39, v51 offset:3560
    v_fma_f32 v32, v32, v52, v60
    v_mfma_f32_16x16x32_bf16 v[196:199], a[40:43], a[224:227], v[196:199]
    ds_read_u16 v40, v50 offset:3586
    v_lshlrev_b32 v33, 16, v33
    v_mfma_f32_16x16x32_bf16 v[200:203], a[64:67], a[224:227], v[200:203]
    ds_read_b128 a[224:227], v240 offset:35328
    v_fma_f32 v33, v33, v53, v61
    v_mfma_f32_16x16x32_bf16 v[192:195], a[20:23], a[228:231], v[192:195]
    ds_read_u16 v41, v51 offset:3586
    v_lshlrev_b32 v34, 16, v34
    v_mfma_f32_16x16x32_bf16 v[196:199], a[44:47], a[228:231], v[196:199]
    ds_read_u16 v42, v50 offset:3612
    v_fma_f32 v34, v34, v52, v60
    v_mfma_f32_16x16x32_bf16 v[200:203], a[68:71], a[228:231], v[200:203]
    ds_read_b128 a[228:231], v241 offset:35328
    s_add_u32 m0, s29, 0x2000
    v_mfma_f32_16x16x32_bf16 v[204:207], a[0:3], a[232:235], 0
    buffer_load_dwordx4 v174, s[8:11], s60 offen lds
    v_cvt_pk_bf16_f32 v120, v192, v193
    v_mfma_f32_16x16x32_bf16 v[208:211], a[24:27], a[232:235], 0
    ds_read_u16 v43, v51 offset:3612
    v_cvt_pk_bf16_f32 v121, v194, v195
    v_mfma_f32_16x16x32_bf16 v[212:215], a[48:51], a[232:235], 0
    ds_read_b128 a[232:235], v240 offset:35456
    v_cvt_pk_bf16_f32 v122, v196, v197
    v_mfma_f32_16x16x32_bf16 v[204:207], a[4:7], a[236:239], v[204:207]
    ds_read_u16 v44, v50 offset:3638
    v_cvt_pk_bf16_f32 v123, v198, v199
    v_mfma_f32_16x16x32_bf16 v[208:211], a[28:31], a[236:239], v[208:211]
    ds_read_u16 v45, v51 offset:3638
    v_cvt_pk_bf16_f32 v124, v200, v201
    v_mfma_f32_16x16x32_bf16 v[212:215], a[52:55], a[236:239], v[212:215]
    s_waitcnt vmcnt(9) lgkmcnt(7)
    v_cvt_pk_bf16_f32 v125, v202, v203
    v_lshlrev_b32 v35, 16, v35
    v_mfma_f32_16x16x32_bf16 v[204:207], a[8:11], a[240:243], v[204:207]
    ds_read_b128 a[236:239], v241 offset:35456
    v_fma_f32 v35, v35, v53, v61
    v_mfma_f32_16x16x32_bf16 v[208:211], a[32:35], a[240:243], v[208:211]
    ds_read_b64_tr_b16 a[72:73], v249 offset:0
    v_lshlrev_b32 v36, 16, v36
    v_mfma_f32_16x16x32_bf16 v[212:215], a[56:59], a[240:243], v[212:215]
    ds_read_b128 a[240:243], v240 offset:35584
    v_fma_f32 v36, v36, v52, v60
    v_mfma_f32_16x16x32_bf16 v[204:207], a[12:15], a[244:247], v[204:207]
    ds_read_b64_tr_b16 a[74:75], v250 offset:0
    v_lshlrev_b32 v37, 16, v37
    v_mfma_f32_16x16x32_bf16 v[208:211], a[36:39], a[244:247], v[208:211]
    ds_read_b64_tr_b16 a[96:97], v249 offset:32
    v_fma_f32 v37, v37, v53, v61
    v_mfma_f32_16x16x32_bf16 v[212:215], a[60:63], a[244:247], v[212:215]
    ds_read_b128 a[244:247], v241 offset:35584
    v_lshlrev_b32 v38, 16, v38
    v_mfma_f32_16x16x32_bf16 v[204:207], a[16:19], a[216:219], v[204:207]
    ds_read_b64_tr_b16 a[98:99], v250 offset:32
    v_fma_f32 v38, v38, v52, v60
    v_mfma_f32_16x16x32_bf16 v[208:211], a[40:43], a[216:219], v[208:211]
    ds_read_b64_tr_b16 a[120:121], v249 offset:64
    v_lshlrev_b32 v39, 16, v39
    v_mfma_f32_16x16x32_bf16 v[212:215], a[64:67], a[216:219], v[212:215]
    ds_read_b128 a[216:219], v240 offset:0
    v_fma_f32 v39, v39, v53, v61
    v_mfma_f32_16x16x32_bf16 v[204:207], a[20:23], a[220:223], v[204:207]
    ds_read_b64_tr_b16 a[122:123], v250 offset:64
    v_lshlrev_b32 v40, 16, v40
    v_mfma_f32_16x16x32_bf16 v[208:211], a[44:47], a[220:223], v[208:211]
    ds_read_u16 v46, v50 offset:3664
    v_fma_f32 v40, v40, v52, v60
    v_mfma_f32_16x16x32_bf16 v[212:215], a[68:71], a[220:223], v[212:215]
    ds_read_b128 a[220:223], v240 offset:1536
    s_add_u32 m0, s29, 0x2400
    v_mfma_f32_16x16x32_bf16 v[216:219], a[0:3], a[224:227], 0
    buffer_load_dwordx4 v172, s[8:11], s61 offen lds
    v_cvt_pk_bf16_f32 v126, v204, v205
    v_mfma_f32_16x16x32_bf16 v[220:223], a[24:27], a[224:227], 0
    ds_read_u16 v47, v51 offset:3664
    v_cvt_pk_bf16_f32 v127, v206, v207
    v_mfma_f32_16x16x32_bf16 v[224:227], a[48:51], a[224:227], 0
    s_waitcnt vmcnt(6) lgkmcnt(7)
    v_cvt_pk_bf16_f32 v128, v208, v209
    v_cvt_pk_bf16_f32 v129, v210, v211
    v_mfma_f32_16x16x32_bf16 v[216:219], a[4:7], a[228:231], v[216:219]
    ds_read_b128 a[224:227], v240 offset:3072
    v_cvt_pk_bf16_f32 v130, v212, v213
    v_mfma_f32_16x16x32_bf16 v[220:223], a[28:31], a[228:231], v[220:223]
    ds_read_b64_tr_b16 a[76:77], v249 offset:3072
    v_cvt_pk_bf16_f32 v131, v214, v215
    v_mfma_f32_16x16x32_bf16 v[224:227], a[52:55], a[228:231], v[224:227]
    ds_read_b128 a[228:231], v241 offset:0
    v_lshlrev_b32 v41, 16, v41
    v_mfma_f32_16x16x32_bf16 v[216:219], a[8:11], a[232:235], v[216:219]
    ds_read_b64_tr_b16 a[78:79], v250 offset:3072
    v_fma_f32 v41, v41, v53, v61
    v_mfma_f32_16x16x32_bf16 v[220:223], a[32:35], a[232:235], v[220:223]
    ds_read_b64_tr_b16 a[100:101], v249 offset:3104
    v_lshlrev_b32 v42, 16, v42
    v_mfma_f32_16x16x32_bf16 v[224:227], a[56:59], a[232:235], v[224:227]
    ds_read_b128 a[232:235], v241 offset:1536
    v_fma_f32 v42, v42, v52, v60
    v_mfma_f32_16x16x32_bf16 v[216:219], a[12:15], a[236:239], v[216:219]
    ds_read_b64_tr_b16 a[102:103], v250 offset:3104
    v_lshlrev_b32 v43, 16, v43
    v_mfma_f32_16x16x32_bf16 v[220:223], a[36:39], a[236:239], v[220:223]
    ds_read_b64_tr_b16 a[124:125], v249 offset:3136
    v_fma_f32 v43, v43, v53, v61
    v_mfma_f32_16x16x32_bf16 v[224:227], a[60:63], a[236:239], v[224:227]
    ds_read_b128 a[236:239], v241 offset:3072
    v_lshlrev_b32 v44, 16, v44
    v_mfma_f32_16x16x32_bf16 v[216:219], a[16:19], a[240:243], v[216:219]
    ds_read_b64_tr_b16 a[126:127], v250 offset:3136
    v_fma_f32 v44, v44, v52, v60
    v_mfma_f32_16x16x32_bf16 v[220:223], a[40:43], a[240:243], v[220:223]
    ds_read_u16 v48, v50 offset:3690
    v_lshlrev_b32 v45, 16, v45
    v_mfma_f32_16x16x32_bf16 v[224:227], a[64:67], a[240:243], v[224:227]
    ds_read_b128 a[240:243], v240 offset:128
    v_fma_f32 v45, v45, v53, v61
    v_mfma_f32_16x16x32_bf16 v[216:219], a[20:23], a[244:247], v[216:219]
    ds_read_u16 v49, v51 offset:3690
    s_add_u32 m0, s46, 0x10400
    v_mfma_f32_16x16x32_bf16 v[220:223], a[44:47], a[244:247], v[220:223]
    buffer_load_dwordx4 v170, s[4:7], s53 offen lds
    s_add_u32 m0, s29, 0x2800
    v_mfma_f32_16x16x32_bf16 v[224:227], a[68:71], a[244:247], v[224:227]
    s_waitcnt lgkmcnt(7)
    v_lshlrev_b32 v46, 16, v46
    v_cvt_pk_bf16_f32 v132, v216, v217
    v_mfma_f32_16x16x32_bf16 v[180:183], a[216:219], a[72:75], 0
    ds_read_b128 a[244:247], v240 offset:1664
    v_cvt_pk_bf16_f32 v133, v218, v219
    v_mfma_f32_16x16x32_bf16 v[184:187], a[216:219], a[96:99], 0
    ds_write_b64 v62, v[30:31] offset:0
    v_mfma_f32_16x16x32_bf16 v[188:191], a[216:219], a[120:123], 0
    ds_read_b128 a[216:219], v240 offset:3200
    v_cvt_pk_bf16_f32 v134, v220, v221
    v_mfma_f32_16x16x32_bf16 v[192:195], a[220:223], a[72:75], 0
    buffer_load_dwordx4 v173, s[8:11], s61 offen lds
    v_cvt_pk_bf16_f32 v135, v222, v223
    v_mfma_f32_16x16x32_bf16 v[196:199], a[220:223], a[96:99], 0
    s_add_u32 m0, s29, 0x2c00
    v_cvt_pk_bf16_f32 v136, v224, v225
    v_cvt_pk_bf16_f32 v137, v226, v227
    v_mfma_f32_16x16x32_bf16 v[200:203], a[220:223], a[120:123], 0
    ds_read_b128 a[220:223], v241 offset:128
    v_add_u32 v62, s49, v62
    v_mfma_f32_16x16x32_bf16 v[204:207], a[224:227], a[72:75], 0
    ds_write_b64 v62, v[32:33] offset:0
    v_mfma_f32_16x16x32_bf16 v[208:211], a[224:227], a[96:99], 0
    buffer_load_dwordx4 v174, s[8:11], s61 offen lds
    v_add_u32 v62, s49, v62
    v_mfma_f32_16x16x32_bf16 v[212:215], a[224:227], a[120:123], 0
    ds_read_b128 a[224:227], v241 offset:1664
    v_fma_f32 v46, v46, v52, v60
    v_mfma_f32_16x16x32_bf16 v[180:183], a[228:231], a[76:79], v[180:183]
    ds_write_b64 v62, v[34:35] offset:0
    v_mfma_f32_16x16x32_bf16 v[192:195], a[232:235], a[76:79], v[192:195]
    s_waitcnt lgkmcnt(4)
    v_add_u32 v62, s49, v62
    v_lshlrev_b32 v47, 16, v47
    v_mfma_f32_16x16x32_bf16 v[184:187], a[228:231], a[100:103], v[184:187]
    ds_write_b64 v62, v[36:37] offset:0
    v_mfma_f32_16x16x32_bf16 v[188:191], a[228:231], a[124:127], v[188:191]
    ds_read_b128 a[228:231], v241 offset:3200
    v_add_u32 v62, s49, v62
    v_mfma_f32_16x16x32_bf16 v[196:199], a[232:235], a[100:103], v[196:199]
    ds_write_b64 v62, v[38:39] offset:0
    v_mfma_f32_16x16x32_bf16 v[200:203], a[232:235], a[124:127], v[200:203]
    ds_read_b128 a[232:235], v240 offset:256
    v_add_u32 v62, s49, v62
    v_mfma_f32_16x16x32_bf16 v[204:207], a[236:239], a[76:79], v[204:207]
    ds_write_b64 v62, v[40:41] offset:0
    v_mfma_f32_16x16x32_bf16 v[208:211], a[236:239], a[100:103], v[208:211]
    s_add_u32 m0, s46, 0x10800
    v_add_u32 v62, s49, v62
    v_fma_f32 v47, v47, v53, v61
    v_mfma_f32_16x16x32_bf16 v[212:215], a[236:239], a[124:127], v[212:215]
    s_waitcnt vmcnt(4)
    ds_read_b128 a[236:239], v240 offset:1792
    buffer_load_dwordx4 v168, s[4:7], s54 offen lds
    s_add_u32 m0, s29, 0
    ds_read_b64_tr_b16 a[80:81], v249 offset:6144
    ds_read_b64_tr_b16 a[82:83], v250 offset:6144
    ds_read_b64_tr_b16 a[104:105], v249 offset:6176
    ds_read_b64_tr_b16 a[106:107], v250 offset:6176
    ds_read_b64_tr_b16 a[128:129], v249 offset:6208
    ds_read_b64_tr_b16 a[130:131], v250 offset:6208
    s_add_u32 s60, s39, 0
    s_add_u32 s61, s39, 0x9000
    s_mov_b32 s52, 0x800
    s_mov_b32 s53, 0x2000
    s_mov_b32 s54, 0x3800
    ds_write_b64 v62, v[42:43] offset:0
    buffer_load_dwordx4 v172, s[8:11], s62 offen lds
    s_add_u32 m0, s29, 0x400
    v_add_u32 v62, s49, v62
    ds_write_b64 v62, v[44:45] offset:0
    v_add_u32 v62, s49, v62
    ds_write_b64 v62, v[46:47] offset:0
    v_add_u32 v62, s49, v62
    v_lshlrev_b32 v48, 16, v48
    buffer_load_dwordx4 v173, s[8:11], s62 offen lds
    s_add_u32 m0, s46, 0x10a00
    v_fma_f32 v48, v48, v52, v60
    v_lshlrev_b32 v49, 16, v49
    v_fma_f32 v49, v49, v53, v61
    ds_write_b64 v62, v[48:49] offset:0
    v_add_u32 v62, s49, v62
    s_waitcnt lgkmcnt(4)
    v_mfma_f32_16x16x32_bf16 v[180:183], a[240:243], a[80:83], v[180:183]
    v_mfma_f32_16x16x32_bf16 v[184:187], a[240:243], a[104:107], v[184:187]
    buffer_load_dwordx4 v171, s[4:7], s55 offen lds
    s_add_u32 m0, s29, 0x800
    v_mfma_f32_16x16x32_bf16 v[188:191], a[240:243], a[128:131], v[188:191]
    ds_read_b128 a[240:243], v240 offset:3328
    s_mov_b32 s55, 0xc00
    v_mfma_f32_16x16x32_bf16 v[192:195], a[244:247], a[80:83], v[192:195]
    v_mfma_f32_16x16x32_bf16 v[196:199], a[244:247], a[104:107], v[196:199]
    v_mfma_f32_16x16x32_bf16 v[200:203], a[244:247], a[128:131], v[200:203]
    ds_read_b128 a[244:247], v241 offset:256
    v_mfma_f32_16x16x32_bf16 v[204:207], a[216:219], a[80:83], v[204:207]
    buffer_load_dwordx4 v174, s[8:11], s62 offen lds
    s_add_u32 m0, s29, 0xc00
    v_mfma_f32_16x16x32_bf16 v[208:211], a[216:219], a[104:107], v[208:211]
    s_add_u32 s62, s39, 0x12000
    v_mfma_f32_16x16x32_bf16 v[212:215], a[216:219], a[128:131], v[212:215]
    ds_read_b128 a[216:219], v241 offset:1792
    buffer_load_dwordx4 v172, s[8:11], s63 offen lds
    s_add_u32 m0, s29, 0x1000
    s_nop 0
    buffer_load_dwordx4 v173, s[8:11], s63 offen lds
    s_add_u32 m0, s29, 0x1400
    s_nop 0
    buffer_load_dwordx4 v174, s[8:11], s63 offen lds
    s_add_u32 m0, s29, 0x1800
    s_add_u32 s63, s39, 0x1b000
    buffer_load_dwordx4 v172, s[8:11], s60 offen lds
    s_add_u32 m0, s29, 0x1c00
    s_nop 0
    s_waitcnt vmcnt(9)
    ds_read_b64_tr_b16 a[84:85], v249 offset:9216
    ds_read_b64_tr_b16 a[86:87], v250 offset:9216
    ds_read_b64_tr_b16 a[108:109], v249 offset:9248
    ds_read_b64_tr_b16 a[110:111], v250 offset:9248
    ds_read_b64_tr_b16 a[132:133], v249 offset:9280
    ds_read_b64_tr_b16 a[134:135], v250 offset:9280
    buffer_load_dwordx4 v173, s[8:11], s60 offen lds
    s_add_u32 m0, s29, 0x2000
    s_nop 0
    buffer_load_dwordx4 v174, s[8:11], s60 offen lds
    s_add_u32 m0, s29, 0x2400
    s_add_u32 s60, s39, 0x24000
    s_waitcnt lgkmcnt(4)
    v_mfma_f32_16x16x32_bf16 v[180:183], a[220:223], a[84:87], v[180:183]
    v_mfma_f32_16x16x32_bf16 v[192:195], a[224:227], a[84:87], v[192:195]
    s_waitcnt lgkmcnt(1)
    v_mfma_f32_16x16x32_bf16 v[184:187], a[220:223], a[108:111], v[184:187]
    s_waitcnt lgkmcnt(0)
    v_mfma_f32_16x16x32_bf16 v[188:191], a[220:223], a[132:135], v[188:191]
    ds_read_b128 a[220:223], v241 offset:3328
    v_mfma_f32_16x16x32_bf16 v[196:199], a[224:227], a[108:111], v[196:199]
    buffer_load_dwordx4 v172, s[8:11], s61 offen lds
    s_add_u32 m0, s29, 0x2800
    v_mfma_f32_16x16x32_bf16 v[200:203], a[224:227], a[132:135], v[200:203]
    ds_read_b128 a[224:227], v240 offset:30720
    v_mfma_f32_16x16x32_bf16 v[204:207], a[228:231], a[84:87], v[204:207]
    v_mfma_f32_16x16x32_bf16 v[208:211], a[228:231], a[108:111], v[208:211]
    v_mfma_f32_16x16x32_bf16 v[212:215], a[228:231], a[132:135], v[212:215]
    ds_read_b128 a[228:231], v241 offset:30720
    buffer_load_dwordx4 v173, s[8:11], s61 offen lds
    s_add_u32 m0, s29, 0x2c00
    s_nop 0
    buffer_load_dwordx4 v174, s[8:11], s61 offen lds
    s_add_u32 m0, s29, 0
    s_add_u32 s61, s39, 0x2d000
    s_waitcnt lgkmcnt(1)
    v_mfma_f32_16x16x32_bf16 v[216:219], a[224:227], a[72:75], 0
    v_mfma_f32_16x16x32_bf16 v[220:223], a[224:227], a[96:99], 0
    v_mfma_f32_16x16x32_bf16 v[224:227], a[224:227], a[120:123], 0
    s_waitcnt vmcnt(10) lgkmcnt(0)
    ds_read_b128 a[224:227], v240 offset:32384
    v_mfma_f32_16x16x32_bf16 v[216:219], a[228:231], a[76:79], v[216:219]
    s_barrier
    v_mfma_f32_16x16x32_bf16 v[220:223], a[228:231], a[100:103], v[220:223]
    v_mfma_f32_16x16x32_bf16 v[224:227], a[228:231], a[124:127], v[224:227]
    ds_read_b128 a[228:231], v241 offset:32384
    s_waitcnt vmcnt(9)
    ds_read_b64_tr_b16 a[88:89], v249 offset:0
    ds_read_b64_tr_b16 a[90:91], v250 offset:0
    ds_read_b64_tr_b16 a[112:113], v249 offset:32
    ds_read_b64_tr_b16 a[114:115], v250 offset:32
    ds_read_b64_tr_b16 a[136:137], v249 offset:64
    ds_read_b64_tr_b16 a[138:139], v250 offset:64
    s_waitcnt lgkmcnt(4)
    v_mfma_f32_16x16x32_bf16 v[180:183], a[232:235], a[88:91], v[180:183]
    v_mfma_f32_16x16x32_bf16 v[192:195], a[236:239], a[88:91], v[192:195]
    s_waitcnt lgkmcnt(1)
    v_mfma_f32_16x16x32_bf16 v[184:187], a[232:235], a[112:115], v[184:187]
    s_waitcnt lgkmcnt(0)
    buffer_load_dwordx4 v172, s[8:11], s62 offen lds
    v_mfma_f32_16x16x32_bf16 v[188:191], a[232:235], a[136:139], v[188:191]
    ds_read_b128 a[232:235], v240 offset:30848
    s_add_u32 m0, s29, 0x400
    v_mfma_f32_16x16x32_bf16 v[196:199], a[236:239], a[112:115], v[196:199]
    s_waitcnt vmcnt(7)
    ds_read_b64_tr_b16 a[92:93], v249 offset:3072
    v_mfma_f32_16x16x32_bf16 v[200:203], a[236:239], a[136:139], v[200:203]
    ds_read_b128 a[236:239], v241 offset:30848
    v_mfma_f32_16x16x32_bf16 v[204:207], a[240:243], a[88:91], v[204:207]
    ds_read_b64_tr_b16 a[94:95], v250 offset:3072
    v_mfma_f32_16x16x32_bf16 v[208:211], a[240:243], a[112:115], v[208:211]
    buffer_load_dwordx4 v173, s[8:11], s62 offen lds
    s_add_u32 m0, s29, 0x800
    v_mfma_f32_16x16x32_bf16 v[212:215], a[240:243], a[136:139], v[212:215]
    ds_read_b128 a[240:243], v240 offset:30976
    ds_read_b64_tr_b16 a[116:117], v249 offset:3104
    ds_read_b64_tr_b16 a[118:119], v250 offset:3104
    ds_read_b64_tr_b16 a[140:141], v249 offset:3136
    ds_read_b64_tr_b16 a[142:143], v250 offset:3136
    s_waitcnt lgkmcnt(8)
    v_mfma_f32_16x16x32_bf16 v[216:219], a[232:235], a[80:83], v[216:219]
    buffer_load_dwordx4 v174, s[8:11], s62 offen lds
    s_add_u32 m0, s29, 0xc00
    v_mfma_f32_16x16x32_bf16 v[220:223], a[232:235], a[104:107], v[220:223]
    s_lshl_b32 s62, s28, 5
    s_add_u32 s62, s62, 0
    v_mfma_f32_16x16x32_bf16 v[224:227], a[232:235], a[128:131], v[224:227]
    s_waitcnt lgkmcnt(6)
    ds_read_b128 a[232:235], v240 offset:32512
    v_mfma_f32_16x16x32_bf16 v[216:219], a[236:239], a[84:87], v[216:219]
    s_waitcnt lgkmcnt(6)
    v_mfma_f32_16x16x32_bf16 v[180:183], a[244:247], a[92:95], v[180:183]
    v_mfma_f32_16x16x32_bf16 v[192:195], a[216:219], a[92:95], v[192:195]
    s_waitcnt lgkmcnt(4)
    v_mfma_f32_16x16x32_bf16 v[204:207], a[220:223], a[92:95], v[204:207]
    s_waitcnt vmcnt(6) lgkmcnt(2)
    ds_read_b64_tr_b16 a[144:145], v249 offset:6144
    v_mfma_f32_16x16x32_bf16 v[184:187], a[244:247], a[116:119], v[184:187]
    ds_read_b64_tr_b16 a[146:147], v250 offset:6144
    s_waitcnt lgkmcnt(3)
    v_mfma_f32_16x16x32_bf16 v[188:191], a[244:247], a[140:143], v[188:191]
    ds_read_b128 a[244:247], v241 offset:30976
    v_cvt_pk_bf16_f32 v0, v180, v181
    v_mfma_f32_16x16x32_bf16 v[196:199], a[216:219], a[116:119], v[196:199]
    buffer_load_dwordx4 v172, s[8:11], s63 offen lds
    v_cvt_pk_bf16_f32 v3, v182, v183
    v_mfma_f32_16x16x32_bf16 v[200:203], a[216:219], a[140:143], v[200:203]
    ds_read_b128 a[216:219], v240 offset:32256
    v_cvt_pk_bf16_f32 v30, v184, v185
    v_mfma_f32_16x16x32_bf16 v[208:211], a[220:223], a[116:119], v[208:211]
    ds_read_b64_tr_b16 a[168:169], v249 offset:6176
    v_cvt_pk_bf16_f32 v33, v186, v187
    v_mfma_f32_16x16x32_bf16 v[212:215], a[220:223], a[140:143], v[212:215]
    ds_read_b128 a[220:223], v241 offset:32256
    v_cvt_pk_bf16_f32 v60, v188, v189
    v_mfma_f32_16x16x32_bf16 v[220:223], a[236:239], a[108:111], v[220:223]
    ds_read_b64_tr_b16 a[170:171], v250 offset:6176
    v_cvt_pk_bf16_f32 v63, v190, v191
    v_mfma_f32_16x16x32_bf16 v[224:227], a[236:239], a[132:135], v[224:227]
    ds_read_b128 a[236:239], v241 offset:32512
    v_cvt_pk_bf16_f32 v6, v192, v193
    v_mfma_f32_16x16x32_bf16 v[216:219], a[240:243], a[88:91], v[216:219]
    ds_read_b64_tr_b16 a[192:193], v249 offset:6208
    v_cvt_pk_bf16_f32 v9, v194, v195
    v_mfma_f32_16x16x32_bf16 v[220:223], a[240:243], a[112:115], v[220:223]
    ds_read_b64_tr_b16 a[194:195], v250 offset:6208
    v_cvt_pk_bf16_f32 v36, v196, v197
    v_mfma_f32_16x16x32_bf16 v[224:227], a[240:243], a[136:139], v[224:227]
    s_waitcnt lgkmcnt(7)
    v_cvt_pk_bf16_f32 v39, v198, v199
    v_cvt_pk_bf16_f32 v66, v200, v201
    v_mfma_f32_16x16x32_bf16 v[216:219], a[244:247], a[92:95], v[216:219]
    ds_read_b128 a[240:243], v240 offset:33792
    v_cvt_pk_bf16_f32 v69, v202, v203
    v_mfma_f32_16x16x32_bf16 v[220:223], a[244:247], a[116:119], v[220:223]
    s_add_u32 m0, s29, 0x1000
    v_cvt_pk_bf16_f32 v12, v204, v205
    v_cvt_pk_bf16_f32 v15, v206, v207
    v_mfma_f32_16x16x32_bf16 v[224:227], a[244:247], a[140:143], v[224:227]
    s_waitcnt lgkmcnt(6)
    v_cvt_pk_bf16_f32 v42, v208, v209
    v_cvt_pk_bf16_f32 v45, v210, v211
    v_mfma_f32_16x16x32_bf16 v[180:183], a[216:219], a[72:75], 0
    ds_read_b128 a[244:247], v241 offset:33792
    v_cvt_pk_bf16_f32 v72, v212, v213
    v_mfma_f32_16x16x32_bf16 v[184:187], a[216:219], a[96:99], 0
    buffer_load_dwordx4 v173, s[8:11], s63 offen lds
    v_cvt_pk_bf16_f32 v75, v214, v215
    v_mfma_f32_16x16x32_bf16 v[188:191], a[216:219], a[120:123], 0
    s_waitcnt vmcnt(5) lgkmcnt(4)
    v_cvt_pk_bf16_f32 v1, v216, v217
    v_cvt_pk_bf16_f32 v4, v218, v219
    v_mfma_f32_16x16x32_bf16 v[180:183], a[220:223], a[76:79], v[180:183]
    ds_read_b128 a[216:219], v240 offset:33920
    v_cvt_pk_bf16_f32 v31, v220, v221
    v_mfma_f32_16x16x32_bf16 v[184:187], a[220:223], a[100:103], v[184:187]
    ds_read_b64_tr_b16 a[148:149], v249 offset:9216
    v_cvt_pk_bf16_f32 v34, v222, v223
    v_mfma_f32_16x16x32_bf16 v[188:191], a[220:223], a[124:127], v[188:191]
    ds_read_b128 a[220:223], v241 offset:33920
    v_cvt_pk_bf16_f32 v61, v224, v225
    v_mfma_f32_16x16x32_bf16 v[180:183], a[224:227], a[80:83], v[180:183]
    ds_read_b64_tr_b16 a[150:151], v250 offset:9216
    v_cvt_pk_bf16_f32 v64, v226, v227
    v_mfma_f32_16x16x32_bf16 v[184:187], a[224:227], a[104:107], v[184:187]
    ds_read_b64_tr_b16 a[172:173], v249 offset:9248
    s_add_u32 m0, s29, 0x1400
    v_mfma_f32_16x16x32_bf16 v[188:191], a[224:227], a[128:131], v[188:191]
    ds_read_b128 a[224:227], v240 offset:34048
    s_waitcnt lgkmcnt(6)
    v_mfma_f32_16x16x32_bf16 v[180:183], a[228:231], a[84:87], v[180:183]
    buffer_load_dwordx4 v174, s[8:11], s63 offen lds
    s_add_u32 m0, s29, 0x1800
    v_mfma_f32_16x16x32_bf16 v[184:187], a[228:231], a[108:111], v[184:187]
    ds_read_b64_tr_b16 a[174:175], v250 offset:9248
    s_lshl_b32 s63, s28, 5
    v_mfma_f32_16x16x32_bf16 v[188:191], a[228:231], a[132:135], v[188:191]
    ds_read_b128 a[228:231], v241 offset:34048
    s_add_u32 s63, s63, 0x4800
    v_mfma_f32_16x16x32_bf16 v[180:183], a[232:235], a[88:91], v[180:183]
    ds_read_b64_tr_b16 a[196:197], v249 offset:9280
    v_mfma_f32_16x16x32_bf16 v[184:187], a[232:235], a[112:115], v[184:187]
    ds_read_b64_tr_b16 a[198:199], v250 offset:9280
    v_mfma_f32_16x16x32_bf16 v[188:191], a[232:235], a[136:139], v[188:191]
    ds_read_b128 a[232:235], v240 offset:61440
    v_mfma_f32_16x16x32_bf16 v[180:183], a[236:239], a[92:95], v[180:183]
    buffer_load_dwordx4 v172, s[8:11], s60 offen lds
    s_add_u32 m0, s29, 0x1c00
    v_mfma_f32_16x16x32_bf16 v[184:187], a[236:239], a[116:119], v[184:187]
    v_mfma_f32_16x16x32_bf16 v[188:191], a[236:239], a[140:143], v[188:191]
    ds_read_b128 a[236:239], v241 offset:61440
    v_mfma_f32_16x16x32_bf16 v[192:195], a[240:243], a[72:75], 0
    v_mfma_f32_16x16x32_bf16 v[196:199], a[240:243], a[96:99], 0
    v_mfma_f32_16x16x32_bf16 v[200:203], a[240:243], a[120:123], 0
    ds_read_b128 a[240:243], v240 offset:61568
    v_cvt_pk_bf16_f32 v7, v180, v181
    v_mfma_f32_16x16x32_bf16 v[192:195], a[244:247], a[76:79], v[192:195]
    buffer_load_dwordx4 v173, s[8:11], s60 offen lds
    v_cvt_pk_bf16_f32 v10, v182, v183
    v_mfma_f32_16x16x32_bf16 v[196:199], a[244:247], a[100:103], v[196:199]
    s_add_u32 m0, s29, 0x2000
    v_cvt_pk_bf16_f32 v37, v184, v185
    v_cvt_pk_bf16_f32 v40, v186, v187
    v_mfma_f32_16x16x32_bf16 v[200:203], a[244:247], a[124:127], v[200:203]
    s_waitcnt lgkmcnt(2)
    v_cvt_pk_bf16_f32 v67, v188, v189
    v_cvt_pk_bf16_f32 v70, v190, v191
    v_mfma_f32_16x16x32_bf16 v[192:195], a[216:219], a[80:83], v[192:195]
    ds_read_b128 a[244:247], v241 offset:61568
    v_mfma_f32_16x16x32_bf16 v[196:199], a[216:219], a[104:107], v[196:199]
    v_mfma_f32_16x16x32_bf16 v[200:203], a[216:219], a[128:131], v[200:203]
    ds_read_b128 a[216:219], v240 offset:61696
    v_mfma_f32_16x16x32_bf16 v[192:195], a[220:223], a[84:87], v[192:195]
    buffer_load_dwordx4 v174, s[8:11], s60 offen lds
    s_add_u32 m0, s29, 0x2400
    v_mfma_f32_16x16x32_bf16 v[196:199], a[220:223], a[108:111], v[196:199]
    s_lshl_b32 s60, s28, 5
    s_add_u32 s60, s60, 0x1800
    v_mfma_f32_16x16x32_bf16 v[200:203], a[220:223], a[132:135], v[200:203]
    ds_read_b128 a[220:223], v241 offset:61696
    s_waitcnt vmcnt(6)
    v_mfma_f32_16x16x32_bf16 v[192:195], a[224:227], a[88:91], v[192:195]
    ds_read_b64_tr_b16 a[152:153], v249 offset:0
    v_mfma_f32_16x16x32_bf16 v[196:199], a[224:227], a[112:115], v[196:199]
    ds_read_b64_tr_b16 a[154:155], v250 offset:0
    v_mfma_f32_16x16x32_bf16 v[200:203], a[224:227], a[136:139], v[200:203]
    ds_read_b128 a[224:227], v240 offset:62976
    v_mfma_f32_16x16x32_bf16 v[192:195], a[228:231], a[92:95], v[192:195]
    buffer_load_dwordx4 v172, s[8:11], s61 offen lds
    s_add_u32 m0, s29, 0x2800
    v_mfma_f32_16x16x32_bf16 v[196:199], a[228:231], a[116:119], v[196:199]
    ds_read_b64_tr_b16 a[176:177], v249 offset:32
    v_mfma_f32_16x16x32_bf16 v[200:203], a[228:231], a[140:143], v[200:203]
    ds_read_b128 a[228:231], v241 offset:62976
    v_mfma_f32_16x16x32_bf16 v[204:207], a[0:3], a[232:235], 0
    ds_read_b64_tr_b16 a[178:179], v250 offset:32
    v_cvt_pk_bf16_f32 v13, v192, v193
    v_mfma_f32_16x16x32_bf16 v[208:211], a[24:27], a[232:235], 0
    ds_read_b64_tr_b16 a[200:201], v249 offset:64
    v_cvt_pk_bf16_f32 v16, v194, v195
    v_mfma_f32_16x16x32_bf16 v[212:215], a[48:51], a[232:235], 0
    s_waitcnt lgkmcnt(7)
    v_cvt_pk_bf16_f32 v43, v196, v197
    v_cvt_pk_bf16_f32 v46, v198, v199
    v_mfma_f32_16x16x32_bf16 v[204:207], a[4:7], a[236:239], v[204:207]
    ds_read_b128 a[232:235], v240 offset:63104
    v_cvt_pk_bf16_f32 v73, v200, v201
    v_mfma_f32_16x16x32_bf16 v[208:211], a[28:31], a[236:239], v[208:211]
    buffer_load_dwordx4 v173, s[8:11], s61 offen lds
    v_cvt_pk_bf16_f32 v76, v202, v203
    v_mfma_f32_16x16x32_bf16 v[212:215], a[52:55], a[236:239], v[212:215]
    ds_read_b128 a[236:239], v241 offset:63104
    s_add_u32 m0, s29, 0x2c00
    v_mfma_f32_16x16x32_bf16 v[204:207], a[8:11], a[240:243], v[204:207]
    ds_read_b64_tr_b16 a[202:203], v250 offset:64
    s_waitcnt lgkmcnt(6)
    v_mfma_f32_16x16x32_bf16 v[208:211], a[32:35], a[240:243], v[208:211]
    v_mfma_f32_16x16x32_bf16 v[212:215], a[56:59], a[240:243], v[212:215]
    ds_read_b128 a[240:243], v240 offset:63232
    v_mfma_f32_16x16x32_bf16 v[204:207], a[12:15], a[244:247], v[204:207]
    buffer_load_dwordx4 v174, s[8:11], s61 offen lds
    s_add_u32 m0, s29, 0
    v_mfma_f32_16x16x32_bf16 v[208:211], a[36:39], a[244:247], v[208:211]
    s_lshl_b32 s61, s28, 5
    s_add_u32 s61, s61, 0x6000
    v_mfma_f32_16x16x32_bf16 v[212:215], a[60:63], a[244:247], v[212:215]
    ds_read_b128 a[244:247], v241 offset:63232
    v_mfma_f32_16x16x32_bf16 v[204:207], a[16:19], a[216:219], v[204:207]
    v_mfma_f32_16x16x32_bf16 v[208:211], a[40:43], a[216:219], v[208:211]
    v_mfma_f32_16x16x32_bf16 v[212:215], a[64:67], a[216:219], v[212:215]
    ds_read_b128 a[216:219], v240 offset:64512
    s_waitcnt lgkmcnt(3)
    v_mfma_f32_16x16x32_bf16 v[204:207], a[20:23], a[220:223], v[204:207]
    buffer_load_dwordx4 v28, s[12:15], s62 offen lds
    s_add_u32 m0, s29, 0x400
    v_mfma_f32_16x16x32_bf16 v[208:211], a[44:47], a[220:223], v[208:211]
    v_mfma_f32_16x16x32_bf16 v[212:215], a[68:71], a[220:223], v[212:215]
    ds_read_b128 a[220:223], v241 offset:64512
    v_mfma_f32_16x16x32_bf16 v[216:219], a[0:3], a[224:227], 0
    v_mfma_f32_16x16x32_bf16 v[220:223], a[24:27], a[224:227], 0
    v_mfma_f32_16x16x32_bf16 v[224:227], a[48:51], a[224:227], 0
    ds_read_b128 a[224:227], v240 offset:64640
    v_cvt_pk_bf16_f32 v138, v204, v205
    v_mfma_f32_16x16x32_bf16 v[216:219], a[4:7], a[228:231], v[216:219]
    buffer_load_dwordx4 v29, s[12:15], s62 offen lds
    v_cvt_pk_bf16_f32 v139, v206, v207
    v_mfma_f32_16x16x32_bf16 v[220:223], a[28:31], a[228:231], v[220:223]
    s_add_u32 m0, s29, 0x800
    v_cvt_pk_bf16_f32 v140, v208, v209
    v_cvt_pk_bf16_f32 v141, v210, v211
    v_mfma_f32_16x16x32_bf16 v[224:227], a[52:55], a[228:231], v[224:227]
    ds_read_b128 a[228:231], v241 offset:64640
    v_cvt_pk_bf16_f32 v142, v212, v213
    v_mfma_f32_16x16x32_bf16 v[216:219], a[8:11], a[232:235], v[216:219]
    s_waitcnt vmcnt(8) lgkmcnt(3)
    v_cvt_pk_bf16_f32 v143, v214, v215
    v_mfma_f32_16x16x32_bf16 v[220:223], a[32:35], a[232:235], v[220:223]
    ds_read_b64_tr_b16 a[156:157], v249 offset:3072
    v_mfma_f32_16x16x32_bf16 v[224:227], a[56:59], a[232:235], v[224:227]
    ds_read_b128 a[232:235], v240 offset:64768
    v_add_u32 v240, 0xf000, v240
    v_mfma_f32_16x16x32_bf16 v[216:219], a[12:15], a[236:239], v[216:219]
    buffer_load_dwordx4 v58, s[12:15], s62 offen lds
    s_add_u32 m0, s29, 0xc00
    v_mfma_f32_16x16x32_bf16 v[220:223], a[36:39], a[236:239], v[220:223]
    ds_read_b64_tr_b16 a[158:159], v250 offset:3072
    s_lshl_b32 s62, s28, 5
    v_mfma_f32_16x16x32_bf16 v[224:227], a[60:63], a[236:239], v[224:227]
    ds_read_b128 a[236:239], v241 offset:64768
    v_add_u32 v241, 0xf000, v241
    v_mfma_f32_16x16x32_bf16 v[216:219], a[16:19], a[240:243], v[216:219]
    ds_read_b64_tr_b16 a[180:181], v249 offset:3104
    s_add_u32 s62, s62, 0x3000
    v_mfma_f32_16x16x32_bf16 v[220:223], a[40:43], a[240:243], v[220:223]
    ds_read_b64_tr_b16 a[182:183], v250 offset:3104
    v_mfma_f32_16x16x32_bf16 v[224:227], a[64:67], a[240:243], v[224:227]
    ds_read_b128 a[240:243], v240 offset:4608
    v_mfma_f32_16x16x32_bf16 v[216:219], a[20:23], a[244:247], v[216:219]
    ds_read_b64_tr_b16 a[204:205], v249 offset:3136
    v_mfma_f32_16x16x32_bf16 v[220:223], a[44:47], a[244:247], v[220:223]
    ds_read_b64_tr_b16 a[206:207], v250 offset:3136
    v_mfma_f32_16x16x32_bf16 v[224:227], a[68:71], a[244:247], v[224:227]
    ds_read_b128 a[244:247], v241 offset:4608
    v_mfma_f32_16x16x32_bf16 v[180:183], a[0:3], a[216:219], 0
    s_waitcnt lgkmcnt(8)
    v_mfma_f32_16x16x32_bf16 v[184:187], a[24:27], a[216:219], 0
    v_cvt_pk_bf16_f32 v144, v216, v217
    v_cvt_pk_bf16_f32 v145, v218, v219
    v_mfma_f32_16x16x32_bf16 v[188:191], a[48:51], a[216:219], 0
    ds_read_b128 a[216:219], v240 offset:4736
    v_cvt_pk_bf16_f32 v146, v220, v221
    v_mfma_f32_16x16x32_bf16 v[180:183], a[4:7], a[220:223], v[180:183]
    v_cvt_pk_bf16_f32 v147, v222, v223
    v_cvt_pk_bf16_f32 v148, v224, v225
    v_mfma_f32_16x16x32_bf16 v[184:187], a[28:31], a[220:223], v[184:187]
    v_cvt_pk_bf16_f32 v149, v226, v227
    s_waitcnt lgkmcnt(4)
    v_mfma_f32_16x16x32_bf16 v[188:191], a[52:55], a[220:223], v[188:191]
    ds_read_b128 a[220:223], v241 offset:4736
    s_waitcnt vmcnt(6)
    v_mfma_f32_16x16x32_bf16 v[180:183], a[8:11], a[224:227], v[180:183]
    ds_read_b64_tr_b16 a[160:161], v249 offset:6144
    s_waitcnt lgkmcnt(4)
    v_mfma_f32_16x16x32_bf16 v[184:187], a[32:35], a[224:227], v[184:187]
    buffer_load_dwordx4 v28, s[12:15], s63 offen lds
    s_add_u32 m0, s29, 0x1000
    v_mfma_f32_16x16x32_bf16 v[188:191], a[56:59], a[224:227], v[188:191]
    ds_read_b128 a[224:227], v240 offset:4864
    v_mfma_f32_16x16x32_bf16 v[180:183], a[12:15], a[228:231], v[180:183]
    ds_read_b64_tr_b16 a[162:163], v250 offset:6144
    v_mfma_f32_16x16x32_bf16 v[184:187], a[36:39], a[228:231], v[184:187]
    ds_read_b64_tr_b16 a[184:185], v249 offset:6176
    v_mfma_f32_16x16x32_bf16 v[188:191], a[60:63], a[228:231], v[188:191]
    ds_read_b128 a[228:231], v241 offset:4864
    v_mfma_f32_16x16x32_bf16 v[180:183], a[16:19], a[232:235], v[180:183]
    buffer_load_dwordx4 v29, s[12:15], s63 offen lds
    s_add_u32 m0, s29, 0x1400
    v_mfma_f32_16x16x32_bf16 v[184:187], a[40:43], a[232:235], v[184:187]
    ds_read_b64_tr_b16 a[186:187], v250 offset:6176
    v_mfma_f32_16x16x32_bf16 v[188:191], a[64:67], a[232:235], v[188:191]
    ds_read_b128 a[232:235], v240 offset:0
    v_mfma_f32_16x16x32_bf16 v[180:183], a[20:23], a[236:239], v[180:183]
    ds_read_b64_tr_b16 a[208:209], v249 offset:6208
    v_mfma_f32_16x16x32_bf16 v[184:187], a[44:47], a[236:239], v[184:187]
    ds_read_b64_tr_b16 a[210:211], v250 offset:6208
    v_mfma_f32_16x16x32_bf16 v[188:191], a[68:71], a[236:239], v[188:191]
    ds_read_b128 a[236:239], v241 offset:0
    v_mfma_f32_16x16x32_bf16 v[192:195], a[0:3], a[240:243], 0
    buffer_load_dwordx4 v58, s[12:15], s63 offen lds
    s_add_u32 m0, s29, 0x1800
    v_mfma_f32_16x16x32_bf16 v[196:199], a[24:27], a[240:243], 0
    s_lshl_b32 s63, s28, 5
    v_cvt_pk_bf16_f32 v150, v180, v181
    v_cvt_pk_bf16_f32 v151, v182, v183
    v_mfma_f32_16x16x32_bf16 v[200:203], a[48:51], a[240:243], 0
    s_waitcnt lgkmcnt(5)
    v_cvt_pk_bf16_f32 v152, v184, v185
    v_cvt_pk_bf16_f32 v153, v186, v187
    v_mfma_f32_16x16x32_bf16 v[192:195], a[4:7], a[244:247], v[192:195]
    ds_read_b128 a[240:243], v240 offset:128
    v_cvt_pk_bf16_f32 v154, v188, v189
    v_mfma_f32_16x16x32_bf16 v[196:199], a[28:31], a[244:247], v[196:199]
    s_add_u32 s63, s63, 0x7800
    v_cvt_pk_bf16_f32 v155, v190, v191
    s_waitcnt lgkmcnt(4)
    v_mfma_f32_16x16x32_bf16 v[200:203], a[52:55], a[244:247], v[200:203]
    ds_read_b128 a[244:247], v241 offset:128
    s_waitcnt vmcnt(6)
    v_mfma_f32_16x16x32_bf16 v[192:195], a[8:11], a[216:219], v[192:195]
    ds_read_b64_tr_b16 a[164:165], v249 offset:9216
    s_waitcnt lgkmcnt(4)
    v_mfma_f32_16x16x32_bf16 v[196:199], a[32:35], a[216:219], v[196:199]
    buffer_load_dwordx4 v28, s[12:15], s60 offen lds
    s_add_u32 m0, s29, 0x1c00
    v_mfma_f32_16x16x32_bf16 v[200:203], a[56:59], a[216:219], v[200:203]
    ds_read_b128 a[216:219], v240 offset:256
    v_mfma_f32_16x16x32_bf16 v[192:195], a[12:15], a[220:223], v[192:195]
    ds_read_b64_tr_b16 a[166:167], v250 offset:9216
    v_mfma_f32_16x16x32_bf16 v[196:199], a[36:39], a[220:223], v[196:199]
    ds_read_b64_tr_b16 a[188:189], v249 offset:9248
    v_mfma_f32_16x16x32_bf16 v[200:203], a[60:63], a[220:223], v[200:203]
    ds_read_b128 a[220:223], v241 offset:256
    v_mfma_f32_16x16x32_bf16 v[192:195], a[16:19], a[224:227], v[192:195]
    buffer_load_dwordx4 v29, s[12:15], s60 offen lds
    s_add_u32 m0, s29, 0x2000
    v_mfma_f32_16x16x32_bf16 v[196:199], a[40:43], a[224:227], v[196:199]
    ds_read_b64_tr_b16 a[190:191], v250 offset:9248
    v_mfma_f32_16x16x32_bf16 v[200:203], a[64:67], a[224:227], v[200:203]
    ds_read_b128 a[224:227], v240 offset:1536
    v_mfma_f32_16x16x32_bf16 v[192:195], a[20:23], a[228:231], v[192:195]
    ds_read_b64_tr_b16 a[212:213], v249 offset:9280
    v_mfma_f32_16x16x32_bf16 v[196:199], a[44:47], a[228:231], v[196:199]
    ds_read_b64_tr_b16 a[214:215], v250 offset:9280
    v_mfma_f32_16x16x32_bf16 v[200:203], a[68:71], a[228:231], v[200:203]
    ds_read_b128 a[228:231], v241 offset:1536
    v_mfma_f32_16x16x32_bf16 v[204:207], a[232:235], a[72:75], 0
    buffer_load_dwordx4 v58, s[12:15], s60 offen lds
    s_add_u32 m0, s29, 0x2400
    v_mfma_f32_16x16x32_bf16 v[208:211], a[232:235], a[96:99], 0
    s_waitcnt lgkmcnt(6)
    v_cvt_pk_bf16_f32 v156, v192, v193
    v_cvt_pk_bf16_f32 v157, v194, v195
    v_mfma_f32_16x16x32_bf16 v[212:215], a[232:235], a[120:123], 0
    ds_read_b128 a[232:235], v240 offset:1664
    v_cvt_pk_bf16_f32 v158, v196, v197
    v_mfma_f32_16x16x32_bf16 v[204:207], a[236:239], a[76:79], v[204:207]
    v_cvt_pk_bf16_f32 v159, v198, v199
    v_cvt_pk_bf16_f32 v160, v200, v201
    v_mfma_f32_16x16x32_bf16 v[208:211], a[236:239], a[100:103], v[208:211]
    ds_read_b128 v[196:199], v244 offset:192
    v_cvt_pk_bf16_f32 v161, v202, v203
    v_mfma_f32_16x16x32_bf16 v[212:215], a[236:239], a[124:127], v[212:215]
    ds_read_b128 a[236:239], v241 offset:1664
    v_mov_b32 v195, 0
    v_mfma_f32_16x16x32_bf16 v[204:207], a[240:243], a[80:83], v[204:207]
    ds_read_b128 v[200:203], v245 offset:192
    s_waitcnt vmcnt(6) lgkmcnt(5)
    v_mfma_f32_16x16x32_bf16 v[208:211], a[240:243], a[104:107], v[208:211]
    buffer_load_dwordx4 v28, s[12:15], s61 offen lds
    s_add_u32 m0, s29, 0x2800
    v_mfma_f32_16x16x32_bf16 v[212:215], a[240:243], a[128:131], v[212:215]
    ds_read_b128 a[240:243], v240 offset:1792
    v_mfma_f32_16x16x32_bf16 v[204:207], a[244:247], a[84:87], v[204:207]
    ds_read_b64_tr_b16 v[24:25], v249 offset:0
    v_mfma_f32_16x16x32_bf16 v[208:211], a[244:247], a[108:111], v[208:211]
    ds_read_b64_tr_b16 v[26:27], v250 offset:0
    v_mfma_f32_16x16x32_bf16 v[212:215], a[244:247], a[132:135], v[212:215]
    ds_read_b128 a[244:247], v241 offset:1792
    v_mfma_f32_16x16x32_bf16 v[204:207], a[216:219], a[88:91], v[204:207]
    buffer_load_dwordx4 v29, s[12:15], s61 offen lds
    s_add_u32 m0, s29, 0x2c00
    v_mfma_f32_16x16x32_bf16 v[208:211], a[216:219], a[112:115], v[208:211]
    ds_read_b64_tr_b16 v[54:55], v249 offset:32
    v_mfma_f32_16x16x32_bf16 v[212:215], a[216:219], a[136:139], v[212:215]
    ds_read_b128 a[216:219], v240 offset:3072
    v_mfma_f32_16x16x32_bf16 v[204:207], a[220:223], a[92:95], v[204:207]
    ds_read_b64_tr_b16 v[56:57], v250 offset:32
    v_mfma_f32_16x16x32_bf16 v[208:211], a[220:223], a[116:119], v[208:211]
    ds_read_b64_tr_b16 v[84:85], v249 offset:64
    v_mfma_f32_16x16x32_bf16 v[212:215], a[220:223], a[140:143], v[212:215]
    ds_read_b128 a[220:223], v241 offset:3072
    v_mfma_f32_16x16x32_bf16 v[216:219], a[224:227], a[72:75], 0
    buffer_load_dwordx4 v58, s[12:15], s61 offen lds
    s_add_u32 m0, s29, 0
    v_mfma_f32_16x16x32_bf16 v[220:223], a[224:227], a[96:99], 0
    ds_read_b64_tr_b16 v[86:87], v250 offset:64
    v_cvt_pk_bf16_f32 v2, v204, v205
    v_mfma_f32_16x16x32_bf16 v[224:227], a[224:227], a[120:123], 0
    s_waitcnt lgkmcnt(6)
    v_cvt_pk_bf16_f32 v5, v206, v207
    v_cvt_pk_bf16_f32 v32, v208, v209
    v_mfma_f32_16x16x32_bf16 v[216:219], a[228:231], a[76:79], v[216:219]
    ds_read_b128 a[224:227], v240 offset:3200
    v_cvt_pk_bf16_f32 v35, v210, v211
    v_mfma_f32_16x16x32_bf16 v[220:223], a[228:231], a[100:103], v[220:223]
    ds_read_b128 v[204:207], v246 offset:192
    v_cvt_pk_bf16_f32 v62, v212, v213
    v_mfma_f32_16x16x32_bf16 v[224:227], a[228:231], a[124:127], v[224:227]
    ds_read_b128 a[228:231], v241 offset:3200
    v_cvt_pk_bf16_f32 v65, v214, v215
    v_mfma_f32_16x16x32_bf16 v[216:219], a[232:235], a[80:83], v[216:219]
    ds_read_b128 v[208:211], v244 offset:256
    s_waitcnt lgkmcnt(6)
    v_mfma_f32_16x16x32_bf16 v[220:223], a[232:235], a[104:107], v[220:223]
    buffer_store_dwordx4 v[24:27], v89, s[24:27], s56 offen
    v_mfma_f32_16x16x32_bf16 v[224:227], a[232:235], a[128:131], v[224:227]
    ds_read_b128 a[232:235], v240 offset:3328
    v_add_u32 v240, 0xffff1000, v240
    v_mfma_f32_16x16x32_bf16 v[216:219], a[236:239], a[84:87], v[216:219]
    s_mov_b32 s56, 0x2400
    s_waitcnt lgkmcnt(5)
    v_mfma_f32_16x16x32_bf16 v[220:223], a[236:239], a[108:111], v[220:223]
    v_mfma_f32_16x16x32_bf16 v[224:227], a[236:239], a[132:135], v[224:227]
    ds_read_b128 a[236:239], v241 offset:3328
    v_add_u32 v241, 0xffff1000, v241
    v_mfma_f32_16x16x32_bf16 v[216:219], a[240:243], a[88:91], v[216:219]
    buffer_load_dwordx4 v28, s[12:15], s62 offen lds
    s_add_u32 m0, s29, 0x400
    v_mfma_f32_16x16x32_bf16 v[220:223], a[240:243], a[112:115], v[220:223]
    v_mfma_f32_16x16x32_bf16 v[224:227], a[240:243], a[136:139], v[224:227]
    ds_read_b128 a[240:243], v242 offset:0
    s_waitcnt vmcnt(8)
    v_mfma_f32_16x16x32_bf16 v[216:219], a[244:247], a[92:95], v[216:219]
    ds_read_b64_tr_b16 v[24:25], v249 offset:3072
    v_mfma_f32_16x16x32_bf16 v[220:223], a[244:247], a[116:119], v[220:223]
    ds_read_b64_tr_b16 v[26:27], v250 offset:3072
    v_mfma_f32_16x16x32_bf16 v[224:227], a[244:247], a[140:143], v[224:227]
    ds_read_b128 a[244:247], v243 offset:0
    v_mfma_f32_16x16x32_bf16 v[180:183], a[216:219], a[72:75], 0
    buffer_load_dwordx4 v29, s[12:15], s62 offen lds
    s_add_u32 m0, s29, 0x800
    v_mfma_f32_16x16x32_bf16 v[184:187], a[216:219], a[96:99], 0
    v_cvt_pk_bf16_f32 v8, v216, v217
    v_cvt_pk_bf16_f32 v11, v218, v219
    v_mfma_f32_16x16x32_bf16 v[188:191], a[216:219], a[120:123], 0
    ds_read_b128 a[216:219], v242 offset:128
    v_cvt_pk_bf16_f32 v38, v220, v221
    v_mfma_f32_16x16x32_bf16 v[180:183], a[220:223], a[76:79], v[180:183]
    s_waitcnt lgkmcnt(5)
    v_cvt_pk_bf16_f32 v41, v222, v223
    v_cvt_pk_bf16_f32 v68, v224, v225
    v_mfma_f32_16x16x32_bf16 v[184:187], a[220:223], a[100:103], v[184:187]
    v_cvt_pk_bf16_f32 v71, v226, v227
    s_waitcnt lgkmcnt(4)
    v_mfma_f32_16x16x32_bf16 v[188:191], a[220:223], a[124:127], v[188:191]
    ds_read_b128 a[220:223], v243 offset:128
    v_mfma_f32_16x16x32_bf16 v[180:183], a[224:227], a[80:83], v[180:183]
    buffer_load_dwordx4 v58, s[12:15], s62 offen lds
    s_add_u32 m0, s29, 0xc00
    v_mfma_f32_16x16x32_bf16 v[184:187], a[224:227], a[104:107], v[184:187]
    s_waitcnt lgkmcnt(3)
    v_mfma_f32_16x16x32_bf16 v[188:191], a[224:227], a[128:131], v[188:191]
    ds_read_b128 a[224:227], v242 offset:256
    v_mfma_f32_16x16x32_bf16 v[180:183], a[228:231], a[84:87], v[180:183]
    v_mfma_f32_16x16x32_bf16 v[184:187], a[228:231], a[108:111], v[184:187]
    v_mfma_f32_16x16x32_bf16 v[188:191], a[228:231], a[132:135], v[188:191]
    ds_read_b128 a[228:231], v243 offset:256
    v_mfma_f32_16x16x32_bf16 v[180:183], a[232:235], a[88:91], v[180:183]
    buffer_store_dwordx4 v[54:57], v89, s[24:27], s57 offen
    v_mfma_f32_16x16x32_bf16 v[184:187], a[232:235], a[112:115], v[184:187]
    s_mov_b32 s57, 0x3c00
    ds_read_b64_tr_b16 v[54:55], v249 offset:3104
    v_mfma_f32_16x16x32_bf16 v[188:191], a[232:235], a[136:139], v[188:191]
    ds_read_b128 a[232:235], v240 offset:4608
    v_mfma_f32_16x16x32_bf16 v[180:183], a[236:239], a[92:95], v[180:183]
    ds_read_b64_tr_b16 v[56:57], v250 offset:3104
    v_mfma_f32_16x16x32_bf16 v[184:187], a[236:239], a[116:119], v[184:187]
    buffer_store_dwordx4 v[84:87], v89, s[24:27], s58 offen
    v_mfma_f32_16x16x32_bf16 v[188:191], a[236:239], a[140:143], v[188:191]
    ds_read_b128 a[236:239], v241 offset:4608
    s_mov_b32 s58, 0x1000
    v_mfma_f32_16x16x32_bf16 v[228:231], a[144:147], a[240:243], 0
    ds_read_b64_tr_b16 v[84:85], v249 offset:3136
    v_cvt_pk_bf16_f32 v14, v180, v181
    v_mfma_f32_16x16x32_bf16 v[232:235], a[168:171], a[240:243], 0
    ds_read_b64_tr_b16 v[86:87], v250 offset:3136
    v_cvt_pk_bf16_f32 v17, v182, v183
    v_mfma_f32_16x16x32_bf16 v[236:239], a[192:195], a[240:243], 0
    s_waitcnt lgkmcnt(6)
    v_cvt_pk_bf16_f32 v44, v184, v185
    v_cvt_pk_bf16_f32 v47, v186, v187
    v_mfma_f32_16x16x32_bf16 v[228:231], a[148:151], a[244:247], v[228:231]
    ds_read_b128 a[240:243], v240 offset:4736
    v_cvt_pk_bf16_f32 v74, v188, v189
    v_mfma_f32_16x16x32_bf16 v[228:231], a[152:155], a[216:219], v[228:231]
    buffer_store_dwordx4 v[24:27], v89, s[24:27], s59 offen
    v_mfma_f32_16x16x32_bf16 v[228:231], a[156:159], a[220:223], v[228:231]
    s_mov_b32 s59, 0x2800
    v_cvt_pk_bf16_f32 v77, v190, v191
    s_waitcnt vmcnt(10) lgkmcnt(4)
    v_mfma_f32_16x16x32_bf16 v[228:231], a[160:163], a[224:227], v[228:231]
    ds_read_b64_tr_b16 v[24:25], v249 offset:6144
    v_mfma_f32_16x16x32_bf16 v[228:231], a[164:167], a[228:231], v[228:231]
    ds_read_b64_tr_b16 v[26:27], v250 offset:6144
    v_mfma_f32_16x16x32_bf16 v[232:235], a[172:175], a[244:247], v[232:235]
    buffer_store_dwordx4 v[54:57], v89, s[24:27], s50 offen
    v_mfma_f32_16x16x32_bf16 v[232:235], a[176:179], a[216:219], v[232:235]
    s_mov_b32 s50, 0x4000
    ds_read_b64_tr_b16 v[54:55], v249 offset:6176
    v_mfma_f32_16x16x32_bf16 v[232:235], a[180:183], a[220:223], v[232:235]
    ds_read_b64_tr_b16 v[56:57], v250 offset:6176
    v_mul_f32 v228, s38, v228
    v_mfma_f32_16x16x32_bf16 v[232:235], a[184:187], a[224:227], v[232:235]
    s_waitcnt lgkmcnt(4)
    v_mul_f32 v229, s38, v229
    v_mul_f32 v230, s38, v230
    v_mfma_f32_16x16x32_bf16 v[232:235], a[188:191], a[228:231], v[232:235]
    buffer_load_dwordx4 v28, s[12:15], s63 offen lds
    v_mul_f32 v231, s38, v231
    v_mfma_f32_16x16x32_bf16 v[236:239], a[196:199], a[244:247], v[236:239]
    ds_read_b128 a[244:247], v241 offset:4736
    v_cvt_pk_bf16_f32 v168, v228, v229
    v_mfma_f32_16x16x32_bf16 v[236:239], a[200:203], a[216:219], v[236:239]
    ds_read_b128 a[216:219], v240 offset:4864
    v_cvt_pk_bf16_f32 v169, v230, v231
    v_mfma_f32_16x16x32_bf16 v[236:239], a[204:207], a[220:223], v[236:239]
    ds_read_b128 a[220:223], v241 offset:4864
    v_mul_f32 v232, s3, v232
    v_mfma_f32_16x16x32_bf16 v[236:239], a[208:211], a[224:227], v[236:239]
    ds_read_b128 a[224:227], v240 offset:35328
    v_mul_f32 v233, s3, v233
    v_mfma_f32_16x16x32_bf16 v[236:239], a[212:215], a[228:231], v[236:239]
    ds_read_b128 a[228:231], v241 offset:35328
    v_mul_f32 v234, s3, v234
    v_mfma_f32_16x16x32_bf16 v[228:231], a[232:235], a[72:75], 0
    buffer_store_dwordx4 v[84:87], v89, s[24:27], s51 offen
    v_mfma_f32_16x16x32_bf16 v[228:231], a[236:239], a[76:79], v[228:231]
    s_add_u32 m0, s29, 0x1000
    v_mul_f32 v235, s3, v235
    v_cvt_pk_bf16_f32 v170, v232, v233
    v_mfma_f32_16x16x32_bf16 v[228:231], a[240:243], a[80:83], v[228:231]
    s_waitcnt lgkmcnt(5)
    v_cvt_pk_bf16_f32 v171, v234, v235
    v_mul_f32 v236, s38, v236
    v_mfma_f32_16x16x32_bf16 v[232:235], a[232:235], a[96:99], 0
    ds_read_b64_tr_b16 v[84:85], v249 offset:6208
    v_mul_f32 v237, s38, v237
    v_mfma_f32_16x16x32_bf16 v[196:199], v[90:93], v[168:171], v[196:199]
    buffer_load_dwordx4 v29, s[12:15], s63 offen lds
    v_mul_f32 v238, s38, v238
    v_mfma_f32_16x16x32_bf16 v[200:203], v[114:117], v[168:171], v[200:203]
    ds_read_b64_tr_b16 v[86:87], v250 offset:6208
    v_mul_f32 v239, s38, v239
    v_mfma_f32_16x16x32_bf16 v[204:207], v[138:141], v[168:171], v[204:207]
    s_add_u32 m0, s29, 0x1400
    v_cvt_pk_bf16_f32 v172, v236, v237
    v_cvt_pk_bf16_f32 v173, v238, v239
    v_mfma_f32_16x16x32_bf16 v[208:211], v[96:99], v[168:171], v[208:211]
    s_mov_b32 s51, 0x1400
    s_waitcnt lgkmcnt(2)
    v_mfma_f32_16x16x32_bf16 v[196:199], v[92:95], v[170:173], v[196:199]
    v_mfma_f32_16x16x32_bf16 v[200:203], v[116:119], v[170:173], v[200:203]
    buffer_load_dwordx4 v58, s[12:15], s63 offen lds
    s_add_u32 m0, s46, 0x16800
    v_mfma_f32_16x16x32_bf16 v[204:207], v[140:143], v[170:173], v[204:207]
    v_mfma_f32_16x16x32_bf16 v[208:211], v[98:101], v[170:173], v[208:211]
    v_mfma_f32_16x16x32_bf16 v[228:231], a[244:247], a[84:87], v[228:231]
    v_mfma_f32_16x16x32_bf16 v[228:231], a[216:219], a[88:91], v[228:231]
    v_mfma_f32_16x16x32_bf16 v[228:231], a[220:223], a[92:95], v[228:231]
    buffer_store_dwordx4 v[24:27], v89, s[24:27], s52 offen
    v_mfma_f32_16x16x32_bf16 v[232:235], a[236:239], a[100:103], v[232:235]
    s_mov_b32 s52, 0x2c00
    v_max_f32 v248, v196, v197
    v_max3_f32 v248, v248, v198, v199
    v_mfma_f32_16x16x32_bf16 v[232:235], a[240:243], a[104:107], v[232:235]
    ds_read_b128 v[196:199], v245 offset:256
    v_max3_f32 v248, v248, v200, v201
    v_mfma_f32_16x16x32_bf16 v[232:235], a[244:247], a[108:111], v[232:235]
    s_waitcnt vmcnt(13) lgkmcnt(1)
    v_cvt_pk_bf16_f32 v18, v228, v229
    v_cvt_pk_bf16_f32 v21, v230, v231
    v_mfma_f32_16x16x32_bf16 v[232:235], a[216:219], a[112:115], v[232:235]
    buffer_store_dwordx4 v[54:57], v89, s[24:27], s53 offen
    v_mfma_f32_16x16x32_bf16 v[232:235], a[220:223], a[116:119], v[232:235]
    ds_read_b64_tr_b16 v[24:25], v249 offset:9216
    v_max3_f32 v248, v248, v202, v203
    v_mfma_f32_16x16x32_bf16 v[236:239], a[232:235], a[120:123], 0
    ds_read_b128 a[232:235], v240 offset:35456
    v_max3_f32 v248, v248, v204, v205
    v_mfma_f32_16x16x32_bf16 v[236:239], a[236:239], a[124:127], v[236:239]
    ds_read_b128 a[236:239], v241 offset:35456
    v_max3_f32 v248, v248, v206, v207
    v_mfma_f32_16x16x32_bf16 v[236:239], a[240:243], a[128:131], v[236:239]
    ds_read_b128 a[240:243], v240 offset:35584
    v_cvt_pk_bf16_f32 v48, v232, v233
    v_mfma_f32_16x16x32_bf16 v[236:239], a[244:247], a[132:135], v[236:239]
    ds_read_b128 a[244:247], v241 offset:35584
    v_cvt_pk_bf16_f32 v51, v234, v235
    v_mfma_f32_16x16x32_bf16 v[236:239], a[216:219], a[136:139], v[236:239]
    ds_read_b128 v[200:203], v246 offset:256
    v_add_u32 v240, 0xf000, v240
    v_mfma_f32_16x16x32_bf16 v[236:239], a[220:223], a[140:143], v[236:239]
    ds_read_b128 a[216:219], v240 offset:4608
    v_add_u32 v241, 0xf000, v241
    v_mfma_f32_16x16x32_bf16 v[228:231], a[224:227], a[72:75], 0
    ds_read_b128 a[220:223], v241 offset:4608
    v_max3_f32 v248, v248, v208, v209
    v_mfma_f32_16x16x32_bf16 v[228:231], a[228:231], a[76:79], v[228:231]
    ds_read_b128 v[204:207], v244 offset:320
    v_max3_f32 v248, v248, v210, v211
    v_mfma_f32_16x16x32_bf16 v[232:235], a[224:227], a[96:99], 0
    ds_read_b128 v[208:211], v245 offset:320
    v_cvt_pk_bf16_f32 v78, v236, v237
    v_mfma_f32_16x16x32_bf16 v[232:235], a[228:231], a[100:103], v[232:235]
    s_waitcnt lgkmcnt(8)
    v_cvt_pk_bf16_f32 v81, v238, v239
    s_mov_b32 s53, 0x4400
    v_mfma_f32_16x16x32_bf16 v[196:199], v[120:123], v[168:171], v[196:199]
    buffer_store_dwordx4 v[84:87], v89, s[24:27], s54 offen
    v_mfma_f32_16x16x32_bf16 v[196:199], v[122:125], v[170:173], v[196:199]
    ds_read_b64_tr_b16 v[26:27], v250 offset:9216
    s_add_u32 s54, s43, s45
    v_mfma_f32_16x16x32_bf16 v[228:231], a[232:235], a[80:83], v[228:231]
    ds_read_b64_tr_b16 v[54:55], v249 offset:9248
    s_waitcnt lgkmcnt(5)
    v_mfma_f32_16x16x32_bf16 v[200:203], v[144:147], v[168:171], v[200:203]
    ds_read_b64_tr_b16 v[56:57], v250 offset:9248
    v_mfma_f32_16x16x32_bf16 v[200:203], v[146:149], v[170:173], v[200:203]
    ds_read_b64_tr_b16 v[84:85], v249 offset:9280
    v_max3_f32 v248, v248, v196, v197
    v_mfma_f32_16x16x32_bf16 v[228:231], a[236:239], a[84:87], v[228:231]
    ds_read_b64_tr_b16 v[86:87], v250 offset:9280
    v_max3_f32 v248, v248, v198, v199
    v_mfma_f32_16x16x32_bf16 v[228:231], a[240:243], a[88:91], v[228:231]
    ds_read_b128 v[196:199], v246 offset:320
    s_waitcnt lgkmcnt(6)
    v_mfma_f32_16x16x32_bf16 v[204:207], v[102:105], v[168:171], v[204:207]
    v_max3_f32 v248, v248, v200, v201
    v_max3_f32 v248, v248, v202, v203
    v_mfma_f32_16x16x32_bf16 v[204:207], v[104:107], v[170:173], v[204:207]
    ds_read_b128 v[200:203], v244 offset:192
    v_mfma_f32_16x16x32_bf16 v[208:211], v[126:129], v[168:171], v[208:211]
    v_mfma_f32_16x16x32_bf16 v[208:211], v[128:131], v[170:173], v[208:211]
    s_waitcnt lgkmcnt(6)
    v_mfma_f32_16x16x32_bf16 v[228:231], a[244:247], a[92:95], v[228:231]
    buffer_store_dwordx4 v[24:27], v89, s[24:27], s55 offen
    v_mfma_f32_16x16x32_bf16 v[232:235], a[232:235], a[104:107], v[232:235]
    s_add_u32 s55, s43, s45
    v_max3_f32 v248, v248, v204, v205
    s_waitcnt vmcnt(12) lgkmcnt(2)
    v_mfma_f32_16x16x32_bf16 v[232:235], a[236:239], a[108:111], v[232:235]
    ds_read_b128 v[204:207], v245 offset:192
    v_max3_f32 v248, v248, v208, v209
    v_mfma_f32_16x16x32_bf16 v[232:235], a[240:243], a[112:115], v[232:235]
    ds_read_b128 v[208:211], v246 offset:192
    v_cvt_pk_bf16_f32 v19, v228, v229
    v_mfma_f32_16x16x32_bf16 v[232:235], a[244:247], a[116:119], v[232:235]
    buffer_store_dwordx4 v[54:57], v89, s[24:27], s56 offen
    v_mfma_f32_16x16x32_bf16 v[236:239], a[224:227], a[120:123], 0
    ds_read_b128 a[224:227], v240 offset:4736
    v_cvt_pk_bf16_f32 v22, v230, v231
    v_mfma_f32_16x16x32_bf16 v[236:239], a[228:231], a[124:127], v[236:239]
    ds_read_b128 a[228:231], v241 offset:4736
    s_add_u32 s56, s43, s45
    v_mfma_f32_16x16x32_bf16 v[236:239], a[232:235], a[128:131], v[236:239]
    ds_read_b128 a[232:235], v240 offset:4864
    v_cvt_pk_bf16_f32 v49, v232, v233
    v_mfma_f32_16x16x32_bf16 v[236:239], a[236:239], a[132:135], v[236:239]
    ds_read_b128 a[236:239], v241 offset:4864
    v_cvt_pk_bf16_f32 v52, v234, v235
    v_mfma_f32_16x16x32_bf16 v[236:239], a[240:243], a[136:139], v[236:239]
    buffer_store_dwordx4 v[84:87], v89, s[24:27], s57 offen
    v_mfma_f32_16x16x32_bf16 v[236:239], a[244:247], a[140:143], v[236:239]
    ds_read_b64_tr_b16 v[24:25], v249 offset:0
    v_add_u32 v240, 0xffff1000, v240
    v_mfma_f32_16x16x32_bf16 v[228:231], a[216:219], a[72:75], 0
    ds_read_b128 a[240:243], v240 offset:6144
    v_add_u32 v241, 0xffff1000, v241
    v_mfma_f32_16x16x32_bf16 v[228:231], a[220:223], a[76:79], v[228:231]
    ds_read_b128 a[244:247], v241 offset:6144
    s_lshl1_add_u32 s57, s45, s43
    v_mfma_f32_16x16x32_bf16 v[232:235], a[216:219], a[96:99], 0
    ds_read_b64_tr_b16 v[26:27], v250 offset:0
    v_cvt_pk_bf16_f32 v79, v236, v237
    v_mfma_f32_16x16x32_bf16 v[232:235], a[220:223], a[100:103], v[232:235]
    s_waitcnt lgkmcnt(6)
    v_cvt_pk_bf16_f32 v82, v238, v239
    v_mfma_f32_16x16x32_bf16 v[196:199], v[150:153], v[168:171], v[196:199]
    ds_read_b64_tr_b16 v[54:55], v249 offset:32
    v_mfma_f32_16x16x32_bf16 v[196:199], v[152:155], v[170:173], v[196:199]
    ds_read_b64_tr_b16 v[56:57], v250 offset:32
    v_mfma_f32_16x16x32_bf16 v[200:203], v[90:93], v[168:171], v[200:203]
    ds_read_b64_tr_b16 v[84:85], v249 offset:64
    v_mfma_f32_16x16x32_bf16 v[200:203], v[92:95], v[170:173], v[200:203]
    ds_read_b64_tr_b16 v[86:87], v250 offset:64
    v_mfma_f32_16x16x32_bf16 v[204:207], v[114:117], v[168:171], v[204:207]
    v_mfma_f32_16x16x32_bf16 v[204:207], v[116:119], v[170:173], v[204:207]
    v_mfma_f32_16x16x32_bf16 v[208:211], v[138:141], v[168:171], v[208:211]
    v_max3_f32 v248, v248, v196, v197
    v_mov_b32 v225, v248
    v_mfma_f32_16x16x32_bf16 v[208:211], v[140:143], v[170:173], v[208:211]
    ds_read_b128 v[196:199], v244 offset:256
    v_permlane16_swap_b32 v248, v225
    v_mfma_f32_16x16x32_bf16 v[228:231], a[224:227], a[80:83], v[228:231]
    s_waitcnt lgkmcnt(5)
    v_max_f32 v248, v248, v225
    v_mov_b32 v225, v248
    v_mfma_f32_16x16x32_bf16 v[228:231], a[228:231], a[84:87], v[228:231]
    buffer_store_dwordx4 v[24:27], v89, s[24:27], s58 offen
    v_mfma_f32_16x16x32_bf16 v[228:231], a[232:235], a[88:91], v[228:231]
    s_lshl1_add_u32 s58, s45, s43
    v_permlane32_swap_b32 v248, v225
    v_max_f32 v248, v248, v225
    v_mfma_f32_16x16x32_bf16 v[228:231], a[236:239], a[92:95], v[228:231]
    s_waitcnt vmcnt(7) lgkmcnt(1)
    v_sub_f32 v200, v200, v248
    v_sub_f32 v201, v201, v248
    v_mfma_f32_16x16x32_bf16 v[232:235], a[224:227], a[104:107], v[232:235]
    ds_read_b64_tr_b16 v[24:25], v249 offset:3072
    v_sub_f32 v202, v202, v248
    v_mfma_f32_16x16x32_bf16 v[232:235], a[228:231], a[108:111], v[232:235]
    buffer_store_dwordx4 v[54:57], v89, s[24:27], s59 offen
    v_mfma_f32_16x16x32_bf16 v[232:235], a[232:235], a[112:115], v[232:235]
    ds_read_b64_tr_b16 v[26:27], v250 offset:3072
    v_cvt_pk_bf16_f32 v20, v228, v229
    v_mfma_f32_16x16x32_bf16 v[232:235], a[236:239], a[116:119], v[232:235]
    ds_read_b64_tr_b16 v[54:55], v249 offset:3104
    v_cvt_pk_bf16_f32 v23, v230, v231
    v_mfma_f32_16x16x32_bf16 v[236:239], a[216:219], a[120:123], 0
    ds_read_b128 a[216:219], v240 offset:6272
    v_sub_f32 v203, v203, v248
    v_mfma_f32_16x16x32_bf16 v[236:239], a[220:223], a[124:127], v[236:239]
    ds_read_b128 a[220:223], v241 offset:6272
    v_sub_f32 v204, v204, v248
    v_mfma_f32_16x16x32_bf16 v[236:239], a[224:227], a[128:131], v[236:239]
    ds_read_b128 a[224:227], v240 offset:6400
    v_cvt_pk_bf16_f32 v50, v232, v233
    v_mfma_f32_16x16x32_bf16 v[236:239], a[228:231], a[132:135], v[236:239]
    ds_read_b128 a[228:231], v241 offset:6400
    v_cvt_pk_bf16_f32 v53, v234, v235
    v_mfma_f32_16x16x32_bf16 v[236:239], a[232:235], a[136:139], v[236:239]
    ds_read_b128 a[232:235], v242 offset:1536
    v_sub_f32 v205, v205, v248
    v_mfma_f32_16x16x32_bf16 v[236:239], a[236:239], a[140:143], v[236:239]
    ds_read_b128 a[236:239], v243 offset:1536
    v_sub_f32 v206, v206, v248
    v_mfma_f32_16x16x32_bf16 v[228:231], a[0:3], a[240:243], 0
    buffer_store_dwordx4 v[84:87], v89, s[24:27], s50 offen
    v_mfma_f32_16x16x32_bf16 v[228:231], a[4:7], a[244:247], v[228:231]
    ds_read_b64_tr_b16 v[56:57], v250 offset:3104
    v_sub_f32 v207, v207, v248
    v_mfma_f32_16x16x32_bf16 v[232:235], a[24:27], a[240:243], 0
    ds_read_b64_tr_b16 v[84:85], v249 offset:3136
    v_cvt_pk_bf16_f32 v80, v236, v237
    v_mfma_f32_16x16x32_bf16 v[232:235], a[28:31], a[244:247], v[232:235]
    s_waitcnt lgkmcnt(6)
    v_cvt_pk_bf16_f32 v83, v238, v239
    v_sub_f32 v208, v208, v248
    v_mfma_f32_16x16x32_bf16 v[196:199], v[96:99], v[168:171], v[196:199]
    buffer_store_dwordx4 v[24:27], v89, s[24:27], s51 offen
    v_mfma_f32_16x16x32_bf16 v[196:199], v[98:101], v[170:173], v[196:199]
    ds_read_b64_tr_b16 v[86:87], v250 offset:3136
    v_sub_f32 v209, v209, v248
    v_mfma_f32_16x16x32_bf16 v[228:231], a[8:11], a[216:219], v[228:231]
    s_add_u32 s59, s44, s45
    v_exp_f32 v200, v200
    v_mfma_f32_16x16x32_bf16 v[228:231], a[12:15], a[220:223], v[228:231]
    s_add_u32 s50, s44, s45
    v_exp_f32 v201, v201
    v_mfma_f32_16x16x32_bf16 v[232:235], a[32:35], a[216:219], v[232:235]
    s_add_u32 s51, s44, s45
    v_exp_f32 v202, v202
    v_mfma_f32_16x16x32_bf16 v[232:235], a[36:39], a[220:223], v[232:235]
    s_waitcnt lgkmcnt(2)
    v_exp_f32 v203, v203
    v_mfma_f32_16x16x32_bf16 v[228:231], a[16:19], a[224:227], v[228:231]
    buffer_store_dwordx4 v[54:57], v89, s[24:27], s52 offen
    v_mfma_f32_16x16x32_bf16 v[228:231], a[20:23], a[228:231], v[228:231]
    s_lshl1_add_u32 s52, s45, s44
    v_cvt_pk_bf16_f32 v180, v200, v201
    v_cvt_pk_bf16_f32 v183, v202, v203
    v_mfma_f32_16x16x32_bf16 v[232:235], a[40:43], a[224:227], v[232:235]
    ds_read_b128 v[200:203], v245 offset:256
    v_sub_f32 v210, v210, v248
    v_mfma_f32_16x16x32_bf16 v[232:235], a[44:47], a[228:231], v[232:235]
    s_waitcnt lgkmcnt(1)
    v_cvt_pk_bf16_f32 v162, v228, v229
    v_cvt_pk_bf16_f32 v163, v230, v231
    v_mfma_f32_16x16x32_bf16 v[236:239], a[48:51], a[240:243], 0
    ds_read_b128 a[240:243], v242 offset:1664
    v_sub_f32 v211, v211, v248
    v_mfma_f32_16x16x32_bf16 v[236:239], a[52:55], a[244:247], v[236:239]
    ds_read_b128 a[244:247], v243 offset:1664
    v_cvt_pk_bf16_f32 v164, v232, v233
    v_mfma_f32_16x16x32_bf16 v[236:239], a[56:59], a[216:219], v[236:239]
    ds_read_b128 a[216:219], v242 offset:1792
    v_cvt_pk_bf16_f32 v165, v234, v235
    v_mfma_f32_16x16x32_bf16 v[236:239], a[60:63], a[220:223], v[236:239]
    ds_read_b128 a[220:223], v243 offset:1792
    v_sub_f32 v196, v196, v248
    v_mfma_f32_16x16x32_bf16 v[236:239], a[64:67], a[224:227], v[236:239]
    ds_read_b128 a[224:227], v240 offset:6144
    v_sub_f32 v197, v197, v248
    v_mfma_f32_16x16x32_bf16 v[236:239], a[68:71], a[228:231], v[236:239]
    ds_read_b128 a[228:231], v241 offset:6144
    v_sub_f32 v198, v198, v248
    v_mfma_f32_16x16x32_bf16 v[228:231], a[144:147], a[232:235], 0
    buffer_store_dwordx4 v[84:87], v89, s[24:27], s53 offen
    v_mfma_f32_16x16x32_bf16 v[228:231], a[148:151], a[236:239], v[228:231]
    s_barrier
    v_exp_f32 v204, v204
    v_mfma_f32_16x16x32_bf16 v[232:235], a[168:171], a[232:235], 0
    s_lshl1_add_u32 s53, s45, s44
    v_cvt_pk_bf16_f32 v166, v236, v237
    v_cvt_pk_bf16_f32 v167, v238, v239
    v_mfma_f32_16x16x32_bf16 v[232:235], a[172:175], a[236:239], v[232:235]
    s_waitcnt lgkmcnt(4)
    v_exp_f32 v205, v205
    v_mfma_f32_16x16x32_bf16 v[200:203], v[120:123], v[168:171], v[200:203]
    buffer_load_dwordx4 v254, s[4:7], s43 offen lds
    v_cvt_pk_bf16_f32 v181, v204, v205
    v_mfma_f32_16x16x32_bf16 v[200:203], v[122:125], v[170:173], v[200:203]
    s_add_u32 m0, s46, 0x16c00
    v_exp_f32 v206, v206
    v_mfma_f32_16x16x32_bf16 v[228:231], a[152:155], a[240:243], v[228:231]
    v_exp_f32 v207, v207
    v_mfma_f32_16x16x32_bf16 v[228:231], a[156:159], a[244:247], v[228:231]
    s_waitcnt lgkmcnt(0)
    v_cvt_pk_bf16_f32 v184, v206, v207
    v_sub_f32 v199, v199, v248
    v_mfma_f32_16x16x32_bf16 v[228:231], a[160:163], a[216:219], v[228:231]
    ds_read_b128 v[204:207], v246 offset:256
    v_sub_f32 v200, v200, v248
    v_mfma_f32_16x16x32_bf16 v[228:231], a[164:167], a[220:223], v[228:231]
    buffer_load_dwordx4 v255, s[4:7], s43 offen lds
    v_sub_f32 v201, v201, v248
    v_mfma_f32_16x16x32_bf16 v[232:235], a[176:179], a[240:243], v[232:235]
    s_add_u32 m0, s46, 0x17000
    v_exp_f32 v208, v208
    v_mfma_f32_16x16x32_bf16 v[232:235], a[180:183], a[244:247], v[232:235]
    v_exp_f32 v209, v209
    v_mfma_f32_16x16x32_bf16 v[232:235], a[184:187], a[216:219], v[232:235]
    v_mul_f32 v228, s38, v228
    v_mul_f32 v229, s38, v229
    v_mfma_f32_16x16x32_bf16 v[232:235], a[188:191], a[220:223], v[232:235]
    v_mul_f32 v230, s38, v230
    v_mul_f32 v231, s38, v231
    v_mfma_f32_16x16x32_bf16 v[236:239], a[192:195], a[232:235], 0
    ds_read_b128 a[232:235], v240 offset:6272
    v_cvt_pk_bf16_f32 v174, v228, v229
    v_mfma_f32_16x16x32_bf16 v[236:239], a[196:199], a[236:239], v[236:239]
    ds_read_b128 a[236:239], v241 offset:6272
    v_cvt_pk_bf16_f32 v175, v230, v231
    v_mfma_f32_16x16x32_bf16 v[236:239], a[200:203], a[240:243], v[236:239]
    ds_read_b128 a[240:243], v240 offset:6400
    v_mul_f32 v232, s3, v232
    v_mfma_f32_16x16x32_bf16 v[236:239], a[204:207], a[244:247], v[236:239]
    ds_read_b128 a[244:247], v241 offset:6400
    v_mul_f32 v233, s3, v233
    v_mfma_f32_16x16x32_bf16 v[236:239], a[208:211], a[216:219], v[236:239]
    ds_read_b128 a[216:219], v240 offset:36864
    v_mul_f32 v234, s3, v234
    v_mfma_f32_16x16x32_bf16 v[236:239], a[212:215], a[220:223], v[236:239]
    ds_read_b128 a[220:223], v241 offset:36864
    v_mul_f32 v235, s3, v235
    v_mfma_f32_16x16x32_bf16 v[228:231], a[224:227], a[72:75], 0
    s_waitcnt lgkmcnt(6)
    v_cvt_pk_bf16_f32 v176, v232, v233
    v_cvt_pk_bf16_f32 v177, v234, v235
    v_mfma_f32_16x16x32_bf16 v[204:207], v[144:147], v[168:171], v[204:207]
    v_exp_f32 v210, v210
    v_mfma_f32_16x16x32_bf16 v[204:207], v[146:149], v[170:173], v[204:207]
    v_mul_f32 v236, s38, v236
    v_mul_f32 v237, s38, v237
    v_mfma_f32_16x16x32_bf16 v[228:231], a[228:231], a[76:79], v[228:231]
    s_waitcnt lgkmcnt(5)
    v_mul_f32 v238, s38, v238
    v_mul_f32 v239, s38, v239
    v_mfma_f32_16x16x32_bf16 v[228:231], a[232:235], a[80:83], v[228:231]
    s_waitcnt lgkmcnt(4)
    v_cvt_pk_bf16_f32 v178, v236, v237
    v_cvt_pk_bf16_f32 v179, v238, v239
    v_mfma_f32_16x16x32_bf16 v[228:231], a[236:239], a[84:87], v[228:231]
    s_waitcnt lgkmcnt(3)
    v_exp_f32 v211, v211
    v_mfma_f32_16x16x32_bf16 v[228:231], a[240:243], a[88:91], v[228:231]
    s_waitcnt lgkmcnt(2)
    v_cvt_pk_bf16_f32 v182, v208, v209
    v_cvt_pk_bf16_f32 v185, v210, v211
    v_mfma_f32_16x16x32_bf16 v[228:231], a[244:247], a[92:95], v[228:231]
    ds_read_b128 v[208:211], v244 offset:320
    v_sub_f32 v202, v202, v248
    v_mfma_f32_16x16x32_bf16 v[212:215], v[0:3], v[180:183], 0
    v_exp_f32 v196, v196
    v_mfma_f32_16x16x32_bf16 v[216:219], v[30:33], v[180:183], 0
    v_exp_f32 v197, v197
    v_mfma_f32_16x16x32_bf16 v[220:223], v[60:63], v[180:183], 0
    v_exp_f32 v198, v198
    v_mfma_f32_16x16x32_bf16 v[224:227], a[248:251], v[180:183], 0
    v_cvt_pk_bf16_f32 v24, v228, v229
    v_cvt_pk_bf16_f32 v27, v230, v231
    v_mfma_f32_16x16x32_bf16 v[232:235], a[224:227], a[96:99], 0
    s_waitcnt lgkmcnt(1)
    v_exp_f32 v199, v199
    v_mfma_f32_16x16x32_bf16 v[232:235], a[228:231], a[100:103], v[232:235]
    v_cvt_pk_bf16_f32 v186, v196, v197
    v_cvt_pk_bf16_f32 v189, v198, v199
    v_mfma_f32_16x16x32_bf16 v[232:235], a[232:235], a[104:107], v[232:235]
    ds_read_b128 v[196:199], v245 offset:320
    v_sub_f32 v203, v203, v248
    v_mfma_f32_16x16x32_bf16 v[232:235], a[236:239], a[108:111], v[232:235]
    v_exp_f32 v200, v200
    v_mfma_f32_16x16x32_bf16 v[232:235], a[240:243], a[112:115], v[232:235]
    s_waitcnt lgkmcnt(1)
    v_exp_f32 v201, v201
    v_mfma_f32_16x16x32_bf16 v[208:211], v[102:105], v[168:171], v[208:211]
    v_exp_f32 v202, v202
    v_mfma_f32_16x16x32_bf16 v[208:211], v[104:107], v[170:173], v[208:211]
    v_exp_f32 v203, v203
    v_mfma_f32_16x16x32_bf16 v[232:235], a[244:247], a[116:119], v[232:235]
    v_cvt_pk_bf16_f32 v187, v200, v201
    v_cvt_pk_bf16_f32 v190, v202, v203
    v_mfma_f32_16x16x32_bf16 v[236:239], a[224:227], a[120:123], 0
    ds_read_b128 a[224:227], v240 offset:36992
    v_sub_f32 v204, v204, v248
    v_mfma_f32_16x16x32_bf16 v[212:215], v[4:7], v[184:187], v[212:215]
    ds_read_b128 v[200:203], v246 offset:320
    v_sub_f32 v205, v205, v248
    v_mfma_f32_16x16x32_bf16 v[216:219], v[34:37], v[184:187], v[216:219]
    v_cvt_pk_bf16_f32 v54, v232, v233
    v_cvt_pk_bf16_f32 v57, v234, v235
    v_mfma_f32_16x16x32_bf16 v[220:223], v[64:67], v[184:187], v[220:223]
    s_waitcnt lgkmcnt(2)
    v_exp_f32 v204, v204
    v_mfma_f32_16x16x32_bf16 v[224:227], a[248:251], v[184:187], v[224:227]
    v_exp_f32 v205, v205
    v_mfma_f32_16x16x32_bf16 v[196:199], v[126:129], v[168:171], v[196:199]
    v_sub_f32 v206, v206, v248
    v_sub_f32 v207, v207, v248
    v_mfma_f32_16x16x32_bf16 v[196:199], v[128:131], v[170:173], v[196:199]
    v_exp_f32 v206, v206
    v_mfma_f32_16x16x32_bf16 v[236:239], a[228:231], a[124:127], v[236:239]
    ds_read_b128 a[228:231], v241 offset:36992
    v_cvt_pk_bf16_f32 v188, v204, v205
    v_mfma_f32_16x16x32_bf16 v[236:239], a[232:235], a[128:131], v[236:239]
    ds_read_b128 a[232:235], v240 offset:37120
    v_add_u32 v240, 0xf000, v240
    v_mfma_f32_16x16x32_bf16 v[236:239], a[236:239], a[132:135], v[236:239]
    ds_read_b128 a[236:239], v241 offset:37120
    v_add_u32 v241, 0xf000, v241
    v_mfma_f32_16x16x32_bf16 v[236:239], a[240:243], a[136:139], v[236:239]
    ds_read_b128 a[240:243], v242 offset:3072
    v_sub_f32 v208, v208, v248
    v_mfma_f32_16x16x32_bf16 v[236:239], a[244:247], a[140:143], v[236:239]
    ds_read_b128 a[244:247], v243 offset:3072
    v_sub_f32 v209, v209, v248
    v_mfma_f32_16x16x32_bf16 v[228:231], a[0:3], a[216:219], 0
    s_waitcnt lgkmcnt(5)
    v_exp_f32 v207, v207
    v_mfma_f32_16x16x32_bf16 v[200:203], v[150:153], v[168:171], v[200:203]
    v_cvt_pk_bf16_f32 v191, v206, v207
    v_sub_f32 v196, v196, v248
    v_mfma_f32_16x16x32_bf16 v[200:203], v[152:155], v[170:173], v[200:203]
    ds_read_b128 v[204:207], v244 offset:0
    v_cvt_pk_bf16_f32 v84, v236, v237
    v_mfma_f32_16x16x32_bf16 v[212:215], v[8:11], v[188:191], v[212:215]
    v_cvt_pk_bf16_f32 v87, v238, v239
    v_sub_f32 v197, v197, v248
    v_mfma_f32_16x16x32_bf16 v[216:219], v[38:41], v[188:191], v[216:219]
    v_exp_f32 v208, v208
    v_mfma_f32_16x16x32_bf16 v[220:223], v[68:71], v[188:191], v[220:223]
    v_exp_f32 v209, v209
    v_mfma_f32_16x16x32_bf16 v[224:227], a[248:251], v[188:191], v[224:227]
    v_cvt_pk_bf16_f32 v192, v208, v209
    v_sub_f32 v200, v200, v248
    v_mfma_f32_16x16x32_bf16 v[228:231], a[4:7], a[220:223], v[228:231]
    ds_read_b128 v[208:211], v245 offset:0
    v_sub_f32 v201, v201, v248
    v_mfma_f32_16x16x32_bf16 v[228:231], a[8:11], a[224:227], v[228:231]
    s_waitcnt lgkmcnt(2)
    v_exp_f32 v196, v196
    v_mfma_f32_16x16x32_bf16 v[228:231], a[12:15], a[228:231], v[228:231]
    v_exp_f32 v197, v197
    v_mfma_f32_16x16x32_bf16 v[228:231], a[16:19], a[232:235], v[228:231]
    v_cvt_pk_bf16_f32 v193, v196, v197
    v_accvgpr_read_b32 v254, a254
    v_mfma_f32_16x16x32_bf16 v[228:231], a[20:23], a[236:239], v[228:231]
    ds_read_b128 v[196:199], v246 offset:0
    v_accvgpr_read_b32 v255, a252
    v_mfma_f32_16x16x32_bf16 v[232:235], a[24:27], a[216:219], 0
    buffer_load_dwordx4 v254, s[4:7], s43 offen lds
    v_accvgpr_read_b32 v254, a253
    v_mfma_f32_16x16x32_bf16 v[232:235], a[28:31], a[220:223], v[232:235]
    s_add_u32 m0, s46, 0x17400
    v_exp_f32 v200, v200
    v_mfma_f32_16x16x32_bf16 v[232:235], a[32:35], a[224:227], v[232:235]
    s_waitcnt lgkmcnt(2)
    v_cvt_pk_bf16_f32 v90, v228, v229
    v_cvt_pk_bf16_f32 v91, v230, v231
    v_mfma_f32_16x16x32_bf16 v[204:207], v[96:99], v[174:177], v[204:207]
    v_exp_f32 v201, v201
    v_mfma_f32_16x16x32_bf16 v[204:207], v[98:101], v[176:179], v[204:207]
    s_waitcnt lgkmcnt(1)
    v_cvt_pk_bf16_f32 v194, v200, v201
    v_mfma_f32_16x16x32_bf16 v[208:211], v[120:123], v[174:177], v[208:211]
    ds_read_b128 v[200:203], v244 offset:64
    v_mfma_f32_16x16x32_bf16 v[212:215], v[12:15], v[192:195], v[212:215]
    buffer_load_dwordx4 v255, s[4:7], s54 offen lds
    v_accvgpr_read_b32 v255, a254
    v_mfma_f32_16x16x32_bf16 v[216:219], v[42:45], v[192:195], v[216:219]
    s_add_u32 m0, s46, 0x17800
    v_max_f32 v248, v204, v205
    v_max3_f32 v248, v248, v206, v207
    v_mfma_f32_16x16x32_bf16 v[220:223], v[72:75], v[192:195], v[220:223]
    ds_read_b128 v[204:207], v245 offset:64
    s_mov_b32 s54, 0
    v_mfma_f32_16x16x32_bf16 v[224:227], a[248:251], v[192:195], v[224:227]
    s_waitcnt lgkmcnt(2)
    v_mfma_f32_16x16x32_bf16 v[208:211], v[122:125], v[176:179], v[208:211]
    v_mfma_f32_16x16x32_bf16 v[196:199], v[144:147], v[174:177], v[196:199]
    buffer_load_dwordx4 v254, s[4:7], s55 offen lds
    v_accvgpr_read_b32 v254, a252
    v_mfma_f32_16x16x32_bf16 v[196:199], v[146:149], v[176:179], v[196:199]
    s_add_u32 m0, s46, 0x17c00
    s_mov_b32 s55, 0
    v_mfma_f32_16x16x32_bf16 v[232:235], a[36:39], a[228:231], v[232:235]
    v_rcp_f32 v225, v224
    v_mfma_f32_16x16x32_bf16 v[232:235], a[40:43], a[232:235], v[232:235]
    s_waitcnt lgkmcnt(1)
    v_mul_f32 v212, v212, v225
    v_mul_f32 v213, v213, v225
    v_mfma_f32_16x16x32_bf16 v[200:203], v[102:105], v[174:177], v[200:203]
    v_mul_f32 v214, v214, v225
    v_mul_f32 v215, v215, v225
    v_mfma_f32_16x16x32_bf16 v[200:203], v[104:107], v[176:179], v[200:203]
    buffer_load_dwordx4 v255, s[4:7], s56 offen lds
    v_cvt_pk_bf16_f32 v212, v212, v213
    v_mfma_f32_16x16x32_bf16 v[232:235], a[44:47], a[236:239], v[232:235]
    s_add_u32 m0, s46, 0x18000
    v_cvt_pk_bf16_f32 v213, v214, v215
    v_mul_f32 v216, v216, v225
    v_mfma_f32_16x16x32_bf16 v[236:239], a[48:51], a[216:219], 0
    ds_write_b64 v251, v[212:213] offset:0
    v_mfma_f32_16x16x32_bf16 v[236:239], a[52:55], a[220:223], v[236:239]
    s_mov_b32 s56, 0
    v_mul_f32 v217, v217, v225
    v_cvt_pk_bf16_f32 v92, v232, v233
    v_mfma_f32_16x16x32_bf16 v[236:239], a[56:59], a[224:227], v[236:239]
    buffer_load_dwordx4 v254, s[4:7], s57 offen lds
    v_cvt_pk_bf16_f32 v93, v234, v235
    v_mfma_f32_16x16x32_bf16 v[236:239], a[60:63], a[228:231], v[236:239]
    s_add_u32 m0, s46, 0x18200
    v_mul_f32 v218, v218, v225
    v_mul_f32 v219, v219, v225
    v_mfma_f32_16x16x32_bf16 v[236:239], a[64:67], a[232:235], v[236:239]
    s_mov_b32 s57, 0
    v_cvt_pk_bf16_f32 v216, v216, v217
    v_cvt_pk_bf16_f32 v217, v218, v219
    v_mfma_f32_16x16x32_bf16 v[236:239], a[68:71], a[236:239], v[236:239]
    ds_write_b64 v251, v[216:217] offset:128
    v_mfma_f32_16x16x32_bf16 v[228:231], a[216:219], a[72:75], 0
    s_waitcnt lgkmcnt(2)
    v_mul_f32 v220, v220, v225
    v_mul_f32 v221, v221, v225
    v_mfma_f32_16x16x32_bf16 v[204:207], v[126:129], v[174:177], v[204:207]
    v_mul_f32 v222, v222, v225
    v_mul_f32 v223, v223, v225
    v_mfma_f32_16x16x32_bf16 v[204:207], v[128:131], v[176:179], v[204:207]
    v_cvt_pk_bf16_f32 v94, v236, v237
    v_cvt_pk_bf16_f32 v95, v238, v239
    v_mfma_f32_16x16x32_bf16 v[228:231], a[220:223], a[76:79], v[228:231]
    v_cvt_pk_bf16_f32 v220, v220, v221
    v_cvt_pk_bf16_f32 v221, v222, v223
    v_mfma_f32_16x16x32_bf16 v[228:231], a[224:227], a[80:83], v[228:231]
    ds_write_b64 v251, v[220:221] offset:256
    v_mfma_f32_16x16x32_bf16 v[228:231], a[228:231], a[84:87], v[228:231]
    v_accvgpr_read_b32 v255, a255
    v_max3_f32 v248, v248, v208, v209
    v_mfma_f32_16x16x32_bf16 v[228:231], a[232:235], a[88:91], v[228:231]
    buffer_load_dwordx4 v255, s[4:7], s58 offen lds
    v_max3_f32 v248, v248, v210, v211
    v_mfma_f32_16x16x32_bf16 v[228:231], a[236:239], a[92:95], v[228:231]
    ds_read_b128 v[208:211], v246 offset:64
    v_max3_f32 v248, v248, v196, v197
    v_mfma_f32_16x16x32_bf16 v[232:235], a[216:219], a[96:99], 0
    s_add_u32 m0, s46, 0
    v_max3_f32 v248, v248, v198, v199
    v_max3_f32 v248, v248, v200, v201
    v_mfma_f32_16x16x32_bf16 v[232:235], a[220:223], a[100:103], v[232:235]
    ds_read_b128 v[196:199], v244 offset:128
    v_cvt_pk_bf16_f32 v25, v228, v229
    v_mfma_f32_16x16x32_bf16 v[232:235], a[224:227], a[104:107], v[232:235]
    s_mov_b32 s58, 0x1000
    v_cvt_pk_bf16_f32 v28, v230, v231
    v_max3_f32 v248, v248, v202, v203
    v_mfma_f32_16x16x32_bf16 v[232:235], a[228:231], a[108:111], v[232:235]
    ds_read_b128 v[200:203], v245 offset:128
    v_max3_f32 v248, v248, v204, v205
    v_mfma_f32_16x16x32_bf16 v[232:235], a[232:235], a[112:115], v[232:235]
    v_max3_f32 v248, v248, v206, v207
    v_mbcnt_lo_u32_b32 v254, -1, 0
    v_mfma_f32_16x16x32_bf16 v[232:235], a[236:239], a[116:119], v[232:235]
    ds_read_b128 v[204:207], v246 offset:128
    v_mbcnt_hi_u32_b32 v254, -1, v254
    v_mfma_f32_16x16x32_bf16 v[236:239], a[216:219], a[120:123], 0
    ds_read_b128 a[216:219], v242 offset:3200
    v_bfe_u32 v254, v254, 1, 1
    v_mfma_f32_16x16x32_bf16 v[236:239], a[220:223], a[124:127], v[236:239]
    ds_read_b128 a[220:223], v243 offset:3200
    v_lshlrev_b32 v255, 4, v254
    v_mfma_f32_16x16x32_bf16 v[236:239], a[224:227], a[128:131], v[236:239]
    ds_read_b128 a[224:227], v242 offset:3328
    v_cvt_pk_bf16_f32 v55, v232, v233
    v_mfma_f32_16x16x32_bf16 v[236:239], a[228:231], a[132:135], v[236:239]
    ds_read_b128 a[228:231], v243 offset:3328
    v_cvt_pk_bf16_f32 v58, v234, v235
    v_mfma_f32_16x16x32_bf16 v[236:239], a[232:235], a[136:139], v[236:239]
    ds_read_b128 a[232:235], v240 offset:6144
    v_xor_b32 v255, v255, v242
    v_mfma_f32_16x16x32_bf16 v[236:239], a[236:239], a[140:143], v[236:239]
    ds_read_b128 a[236:239], v241 offset:6144
    v_mul_u32_u24 v254, 0x7500, v254
    v_mfma_f32_16x16x32_bf16 v[228:231], a[144:147], a[240:243], 0
    s_waitcnt lgkmcnt(7)
    v_add_u32 v254, v254, v255
    v_xor_b32 v255, 64, v254
    v_mfma_f32_16x16x32_bf16 v[208:211], v[150:153], v[174:177], v[208:211]
    v_mfma_f32_16x16x32_bf16 v[208:211], v[152:155], v[176:179], v[208:211]
    s_waitcnt lgkmcnt(6)
    v_cvt_pk_bf16_f32 v85, v236, v237
    v_cvt_pk_bf16_f32 v88, v238, v239
    v_mfma_f32_16x16x32_bf16 v[196:199], v[108:111], v[174:177], v[196:199]
    v_mfma_f32_16x16x32_bf16 v[196:199], v[110:113], v[176:179], v[196:199]
    v_mfma_f32_16x16x32_bf16 v[200:203], v[132:135], v[174:177], v[200:203]
    v_mfma_f32_16x16x32_bf16 v[200:203], v[134:137], v[176:179], v[200:203]
    v_mfma_f32_16x16x32_bf16 v[204:207], v[156:159], v[174:177], v[204:207]
    v_max3_f32 v248, v248, v208, v209
    v_max3_f32 v248, v248, v210, v211
    v_mfma_f32_16x16x32_bf16 v[204:207], v[158:161], v[176:179], v[204:207]
    ds_read_b128 v[208:211], v244 offset:0
    v_mfma_f32_16x16x32_bf16 v[228:231], a[148:151], a[244:247], v[228:231]
    s_waitcnt lgkmcnt(1)
    v_max3_f32 v248, v248, v196, v197
    v_max3_f32 v248, v248, v200, v201
    v_mfma_f32_16x16x32_bf16 v[228:231], a[152:155], a[216:219], v[228:231]
    ds_read_b128 v[196:199], v245 offset:0
    v_mfma_f32_16x16x32_bf16 v[228:231], a[156:159], a[220:223], v[228:231]
    ds_read_b128 v[200:203], v246 offset:0
    v_max3_f32 v248, v248, v204, v205
    v_mfma_f32_16x16x32_bf16 v[228:231], a[160:163], a[224:227], v[228:231]
    ds_read_b128 v[204:207], v244 offset:64
    v_mov_b32 v225, v248
    v_mfma_f32_16x16x32_bf16 v[228:231], a[164:167], a[228:231], v[228:231]
    v_mfma_f32_16x16x32_bf16 v[232:235], a[168:171], a[240:243], 0
    v_permlane16_swap_b32 v248, v225
    v_max_f32 v248, v248, v225
    v_mfma_f32_16x16x32_bf16 v[232:235], a[172:175], a[244:247], v[232:235]
    v_mov_b32 v225, v248
    v_mfma_f32_16x16x32_bf16 v[232:235], a[176:179], a[216:219], v[232:235]
    v_mfma_f32_16x16x32_bf16 v[232:235], a[180:183], a[220:223], v[232:235]
    s_waitcnt lgkmcnt(3)
    v_mul_f32 v228, s38, v228
    v_mul_f32 v229, s38, v229
    v_mfma_f32_16x16x32_bf16 v[208:211], v[96:99], v[174:177], v[208:211]
    v_mul_f32 v230, s38, v230
    v_mul_f32 v231, s38, v231
    v_mfma_f32_16x16x32_bf16 v[208:211], v[98:101], v[176:179], v[208:211]
    s_waitcnt lgkmcnt(2)
    v_cvt_pk_bf16_f32 v168, v228, v229
    v_cvt_pk_bf16_f32 v169, v230, v231
    v_mfma_f32_16x16x32_bf16 v[196:199], v[120:123], v[174:177], v[196:199]
    s_waitcnt lgkmcnt(1)
    v_permlane32_swap_b32 v248, v225
    v_max_f32 v248, v248, v225
    v_mfma_f32_16x16x32_bf16 v[196:199], v[122:125], v[176:179], v[196:199]
    s_waitcnt lgkmcnt(0)
    v_sub_f32 v208, v208, v248
    v_sub_f32 v209, v209, v248
    v_mfma_f32_16x16x32_bf16 v[200:203], v[144:147], v[174:177], v[200:203]
    v_exp_f32 v208, v208
    v_mfma_f32_16x16x32_bf16 v[200:203], v[146:149], v[176:179], v[200:203]
    v_exp_f32 v209, v209
    v_mfma_f32_16x16x32_bf16 v[204:207], v[102:105], v[174:177], v[204:207]
    v_sub_f32 v210, v210, v248
    v_sub_f32 v211, v211, v248
    v_mfma_f32_16x16x32_bf16 v[204:207], v[104:107], v[176:179], v[204:207]
    v_exp_f32 v210, v210
    v_mfma_f32_16x16x32_bf16 v[232:235], a[184:187], a[224:227], v[232:235]
    v_exp_f32 v211, v211
    v_mfma_f32_16x16x32_bf16 v[232:235], a[188:191], a[228:231], v[232:235]
    v_cvt_pk_bf16_f32 v180, v208, v209
    v_cvt_pk_bf16_f32 v183, v210, v211
    v_mfma_f32_16x16x32_bf16 v[236:239], a[192:195], a[240:243], 0
    ds_read_b128 a[240:243], v240 offset:6272
    v_sub_f32 v196, v196, v248
    v_mfma_f32_16x16x32_bf16 v[236:239], a[196:199], a[244:247], v[236:239]
    ds_read_b128 a[244:247], v241 offset:6272
    v_sub_f32 v197, v197, v248
    v_mfma_f32_16x16x32_bf16 v[236:239], a[200:203], a[216:219], v[236:239]
    ds_read_b128 a[216:219], v240 offset:6400
    v_mul_f32 v232, s3, v232
    v_mfma_f32_16x16x32_bf16 v[236:239], a[204:207], a[220:223], v[236:239]
    ds_read_b128 a[220:223], v241 offset:6400
    v_mul_f32 v233, s3, v233
    v_mfma_f32_16x16x32_bf16 v[236:239], a[208:211], a[224:227], v[236:239]
    ds_read_b128 a[224:227], v254 offset:4608
    v_mul_f32 v234, s3, v234
    v_mfma_f32_16x16x32_bf16 v[236:239], a[212:215], a[228:231], v[236:239]
    ds_read_b128 a[228:231], v255 offset:4608
    v_mul_f32 v235, s3, v235
    v_mfma_f32_16x16x32_bf16 v[228:231], a[0:3], a[232:235], 0
    ds_read_b128 v[208:211], v245 offset:64
    v_cvt_pk_bf16_f32 v170, v232, v233
    v_mfma_f32_16x16x32_bf16 v[228:231], a[4:7], a[236:239], v[228:231]
    v_cvt_pk_bf16_f32 v171, v234, v235
    v_sub_f32 v198, v198, v248
    v_mfma_f32_16x16x32_bf16 v[232:235], a[24:27], a[232:235], 0
    v_mul_f32 v236, s38, v236
    v_mul_f32 v237, s38, v237
    v_mfma_f32_16x16x32_bf16 v[232:235], a[28:31], a[236:239], v[232:235]
    s_waitcnt lgkmcnt(6)
    v_mul_f32 v238, s38, v238
    v_mul_f32 v239, s38, v239
    v_mfma_f32_16x16x32_bf16 v[228:231], a[8:11], a[240:243], v[228:231]
    s_waitcnt lgkmcnt(5)
    v_cvt_pk_bf16_f32 v172, v236, v237
    v_cvt_pk_bf16_f32 v173, v238, v239
    v_mfma_f32_16x16x32_bf16 v[228:231], a[12:15], a[244:247], v[228:231]
    s_waitcnt lgkmcnt(4)
    v_exp_f32 v196, v196
    v_mfma_f32_16x16x32_bf16 v[228:231], a[16:19], a[216:219], v[228:231]
    s_waitcnt lgkmcnt(3)
    v_exp_f32 v197, v197
    v_mfma_f32_16x16x32_bf16 v[228:231], a[20:23], a[220:223], v[228:231]
    v_exp_f32 v198, v198
    v_mfma_f32_16x16x32_bf16 v[232:235], a[32:35], a[240:243], v[232:235]
    v_sub_f32 v199, v199, v248
    v_cvt_pk_bf16_f32 v181, v196, v197
    v_mfma_f32_16x16x32_bf16 v[232:235], a[36:39], a[244:247], v[232:235]
    s_waitcnt lgkmcnt(0)
    v_exp_f32 v199, v199
    v_mfma_f32_16x16x32_bf16 v[208:211], v[126:129], v[174:177], v[208:211]
    v_cvt_pk_bf16_f32 v96, v228, v229
    v_cvt_pk_bf16_f32 v97, v230, v231
    v_mfma_f32_16x16x32_bf16 v[208:211], v[128:131], v[176:179], v[208:211]
    v_cvt_pk_bf16_f32 v184, v198, v199
    v_sub_f32 v200, v200, v248
    v_mfma_f32_16x16x32_bf16 v[232:235], a[40:43], a[216:219], v[232:235]
    ds_read_b128 v[196:199], v246 offset:64
    v_sub_f32 v201, v201, v248
    v_mfma_f32_16x16x32_bf16 v[232:235], a[44:47], a[220:223], v[232:235]
    v_exp_f32 v200, v200
    v_mfma_f32_16x16x32_bf16 v[236:239], a[48:51], a[232:235], 0
    v_exp_f32 v201, v201
    v_mfma_f32_16x16x32_bf16 v[236:239], a[52:55], a[236:239], v[236:239]
    v_sub_f32 v202, v202, v248
    v_sub_f32 v203, v203, v248
    v_mfma_f32_16x16x32_bf16 v[236:239], a[56:59], a[240:243], v[236:239]
    v_exp_f32 v202, v202
    v_mfma_f32_16x16x32_bf16 v[236:239], a[60:63], a[244:247], v[236:239]
    v_cvt_pk_bf16_f32 v98, v232, v233
    v_cvt_pk_bf16_f32 v99, v234, v235
    v_mfma_f32_16x16x32_bf16 v[236:239], a[64:67], a[216:219], v[236:239]
    v_exp_f32 v203, v203
    v_mfma_f32_16x16x32_bf16 v[236:239], a[68:71], a[220:223], v[236:239]
    v_cvt_pk_bf16_f32 v182, v200, v201
    v_cvt_pk_bf16_f32 v185, v202, v203
    v_mfma_f32_16x16x32_bf16 v[228:231], a[232:235], a[72:75], 0
    ds_read_b128 v[200:203], v244 offset:128
    v_sub_f32 v204, v204, v248
    v_mfma_f32_16x16x32_bf16 v[212:215], v[6:9], v[180:183], 0
    s_waitcnt lgkmcnt(1)
    v_exp_f32 v204, v204
    v_mfma_f32_16x16x32_bf16 v[216:219], v[36:39], v[180:183], 0
    v_cvt_pk_bf16_f32 v100, v236, v237
    v_cvt_pk_bf16_f32 v101, v238, v239
    v_mfma_f32_16x16x32_bf16 v[220:223], v[66:69], v[180:183], 0
    v_sub_f32 v205, v205, v248
    v_sub_f32 v206, v206, v248
    v_mfma_f32_16x16x32_bf16 v[224:227], a[248:251], v[180:183], 0
    v_exp_f32 v205, v205
    v_mfma_f32_16x16x32_bf16 v[196:199], v[150:153], v[174:177], v[196:199]
    v_exp_f32 v206, v206
    v_mfma_f32_16x16x32_bf16 v[196:199], v[152:155], v[176:179], v[196:199]
    v_sub_f32 v207, v207, v248
    v_cvt_pk_bf16_f32 v186, v204, v205
    v_mfma_f32_16x16x32_bf16 v[228:231], a[236:239], a[76:79], v[228:231]
    v_exp_f32 v207, v207
    v_mfma_f32_16x16x32_bf16 v[228:231], a[240:243], a[80:83], v[228:231]
    v_cvt_pk_bf16_f32 v189, v206, v207
    v_sub_f32 v208, v208, v248
    v_mfma_f32_16x16x32_bf16 v[228:231], a[244:247], a[84:87], v[228:231]
    ds_read_b128 v[204:207], v245 offset:128
    v_sub_f32 v209, v209, v248
    v_mfma_f32_16x16x32_bf16 v[228:231], a[216:219], a[88:91], v[228:231]
    s_waitcnt lgkmcnt(1)
    v_exp_f32 v208, v208
    v_mfma_f32_16x16x32_bf16 v[200:203], v[108:111], v[174:177], v[200:203]
    v_exp_f32 v209, v209
    v_mfma_f32_16x16x32_bf16 v[200:203], v[110:113], v[176:179], v[200:203]
    v_sub_f32 v210, v210, v248
    v_sub_f32 v211, v211, v248
    v_mfma_f32_16x16x32_bf16 v[228:231], a[220:223], a[92:95], v[228:231]
    v_exp_f32 v210, v210
    v_mfma_f32_16x16x32_bf16 v[232:235], a[232:235], a[96:99], 0
    v_exp_f32 v211, v211
    v_mfma_f32_16x16x32_bf16 v[232:235], a[236:239], a[100:103], v[232:235]
    v_cvt_pk_bf16_f32 v187, v208, v209
    v_cvt_pk_bf16_f32 v190, v210, v211
    v_mfma_f32_16x16x32_bf16 v[232:235], a[240:243], a[104:107], v[232:235]
    ds_read_b128 v[208:211], v246 offset:128
    v_cvt_pk_bf16_f32 v26, v228, v229
    v_mfma_f32_16x16x32_bf16 v[212:215], v[10:13], v[184:187], v[212:215]
    v_cvt_pk_bf16_f32 v29, v230, v231
    v_sub_f32 v196, v196, v248
    v_mfma_f32_16x16x32_bf16 v[216:219], v[40:43], v[184:187], v[216:219]
    s_waitcnt lgkmcnt(1)
    v_exp_f32 v196, v196
    v_mfma_f32_16x16x32_bf16 v[220:223], v[70:73], v[184:187], v[220:223]
    v_sub_f32 v197, v197, v248
    v_sub_f32 v198, v198, v248
    v_mfma_f32_16x16x32_bf16 v[224:227], a[248:251], v[184:187], v[224:227]
    v_exp_f32 v197, v197
    v_mfma_f32_16x16x32_bf16 v[204:207], v[132:135], v[174:177], v[204:207]
    v_exp_f32 v198, v198
    v_mfma_f32_16x16x32_bf16 v[204:207], v[134:137], v[176:179], v[204:207]
    v_sub_f32 v199, v199, v248
    v_cvt_pk_bf16_f32 v188, v196, v197
    v_mfma_f32_16x16x32_bf16 v[232:235], a[244:247], a[108:111], v[232:235]
    v_exp_f32 v199, v199
    v_mfma_f32_16x16x32_bf16 v[232:235], a[216:219], a[112:115], v[232:235]
    v_cvt_pk_bf16_f32 v191, v198, v199
    v_sub_f32 v200, v200, v248
    v_mfma_f32_16x16x32_bf16 v[232:235], a[220:223], a[116:119], v[232:235]
    ds_read_b128 v[196:199], v244 offset:0
    v_sub_f32 v201, v201, v248
    v_mfma_f32_16x16x32_bf16 v[212:215], v[14:17], v[188:191], v[212:215]
    s_waitcnt lgkmcnt(1)
    v_exp_f32 v200, v200
    v_mfma_f32_16x16x32_bf16 v[216:219], v[44:47], v[188:191], v[216:219]
    v_exp_f32 v201, v201
    v_mfma_f32_16x16x32_bf16 v[220:223], v[74:77], v[188:191], v[220:223]
    v_cvt_pk_bf16_f32 v56, v232, v233
    v_cvt_pk_bf16_f32 v59, v234, v235
    v_mfma_f32_16x16x32_bf16 v[224:227], a[248:251], v[188:191], v[224:227]
    v_cvt_pk_bf16_f32 v192, v200, v201
    v_sub_f32 v204, v204, v248
    v_mfma_f32_16x16x32_bf16 v[208:211], v[156:159], v[174:177], v[208:211]
    ds_read_b128 v[200:203], v245 offset:0
    v_sub_f32 v205, v205, v248
    v_mfma_f32_16x16x32_bf16 v[208:211], v[158:161], v[176:179], v[208:211]
    v_exp_f32 v204, v204
    v_mfma_f32_16x16x32_bf16 v[236:239], a[232:235], a[120:123], 0
    ds_read_b128 a[232:235], v254 offset:4736
    v_mfma_f32_16x16x32_bf16 v[236:239], a[236:239], a[124:127], v[236:239]
    ds_read_b128 a[236:239], v255 offset:4736
    s_waitcnt lgkmcnt(3)
    v_mfma_f32_16x16x32_bf16 v[196:199], v[102:105], v[168:171], v[196:199]
    v_exp_f32 v205, v205
    v_mfma_f32_16x16x32_bf16 v[196:199], v[104:107], v[170:173], v[196:199]
    v_cvt_pk_bf16_f32 v193, v204, v205
    v_sub_f32 v208, v208, v248
    v_mfma_f32_16x16x32_bf16 v[236:239], a[240:243], a[128:131], v[236:239]
    ds_read_b128 a[240:243], v254 offset:4864
    v_sub_f32 v209, v209, v248
    v_mfma_f32_16x16x32_bf16 v[236:239], a[244:247], a[132:135], v[236:239]
    ds_read_b128 a[244:247], v255 offset:4864
    v_accvgpr_read_b32 v254, a252
    v_mfma_f32_16x16x32_bf16 v[236:239], a[216:219], a[136:139], v[236:239]
    ds_read_b128 v[204:207], v246 offset:0
    v_accvgpr_read_b32 v255, a253
    v_mfma_f32_16x16x32_bf16 v[236:239], a[220:223], a[140:143], v[236:239]
    s_waitcnt lgkmcnt(5)
    v_exp_f32 v208, v208
    v_mfma_f32_16x16x32_bf16 v[200:203], v[126:129], v[168:171], v[200:203]
    v_exp_f32 v209, v209
    v_mfma_f32_16x16x32_bf16 v[200:203], v[128:131], v[170:173], v[200:203]
    v_cvt_pk_bf16_f32 v194, v208, v209
    v_max_f32 v248, v196, v197
    v_mfma_f32_16x16x32_bf16 v[228:231], a[144:147], a[224:227], 0
    ds_read_b128 v[208:211], v244 offset:64
    v_cvt_pk_bf16_f32 v86, v236, v237
    v_mfma_f32_16x16x32_bf16 v[212:215], v[18:21], v[192:195], v[212:215]
    v_cvt_pk_bf16_f32 v89, v238, v239
    v_max3_f32 v248, v248, v198, v199
    v_mfma_f32_16x16x32_bf16 v[216:219], v[48:51], v[192:195], v[216:219]
    ds_read_b128 v[196:199], v245 offset:64
    v_max3_f32 v248, v248, v200, v201
    v_mfma_f32_16x16x32_bf16 v[220:223], v[78:81], v[192:195], v[220:223]
    v_max3_f32 v248, v248, v202, v203
    s_waitcnt vmcnt(0) lgkmcnt(3)
    v_mfma_f32_16x16x32_bf16 v[224:227], a[248:251], v[192:195], v[224:227]
    ds_read_b128 v[200:203], v246 offset:64
    s_barrier
    v_mfma_f32_16x16x32_bf16 v[228:231], a[148:151], a[228:231], v[228:231]
    ds_read_b128 a[216:219], v240 offset:30720
    s_waitcnt lgkmcnt(4)
    v_mfma_f32_16x16x32_bf16 v[204:207], v[150:153], v[168:171], v[204:207]
    ds_read_b128 a[220:223], v241 offset:30720
    v_mfma_f32_16x16x32_bf16 v[204:207], v[152:155], v[170:173], v[204:207]
    buffer_load_dwordx4 v254, s[4:7], s44 offen lds
    v_accvgpr_read_b32 v254, a254
    v_mfma_f32_16x16x32_bf16 v[228:231], a[152:155], a[232:235], v[228:231]
    s_add_u32 m0, s46, 0x400
    v_rcp_f32 v225, v224
    v_mfma_f32_16x16x32_bf16 v[228:231], a[156:159], a[236:239], v[228:231]
    s_waitcnt lgkmcnt(4)
    v_mul_f32 v212, v212, v225
    v_mul_f32 v213, v213, v225
    v_mfma_f32_16x16x32_bf16 v[208:211], v[108:111], v[168:171], v[208:211]
    v_mul_f32 v214, v214, v225
    v_mul_f32 v215, v215, v225
    v_mfma_f32_16x16x32_bf16 v[208:211], v[110:113], v[170:173], v[208:211]
    s_waitcnt lgkmcnt(3)
    v_cvt_pk_bf16_f32 v212, v212, v213
    v_cvt_pk_bf16_f32 v213, v214, v215
    v_mfma_f32_16x16x32_bf16 v[196:199], v[132:135], v[168:171], v[196:199]
    ds_write_b64 v251, v[212:213] offset:6144
    v_mfma_f32_16x16x32_bf16 v[196:199], v[134:137], v[170:173], v[196:199]
    buffer_load_dwordx4 v255, s[4:7], s44 offen lds
    v_mul_f32 v216, v216, v225
    v_mfma_f32_16x16x32_bf16 v[228:231], a[160:163], a[240:243], v[228:231]
    s_add_u32 m0, s46, 0x800
    v_mul_f32 v217, v217, v225
    v_mul_f32 v218, v218, v225
    v_mfma_f32_16x16x32_bf16 v[228:231], a[164:167], a[244:247], v[228:231]
    s_waitcnt lgkmcnt(1)
    v_mul_f32 v219, v219, v225
    v_cvt_pk_bf16_f32 v216, v216, v217
    v_mfma_f32_16x16x32_bf16 v[200:203], v[156:159], v[168:171], v[200:203]
    v_cvt_pk_bf16_f32 v217, v218, v219
    v_mul_f32 v220, v220, v225
    v_mfma_f32_16x16x32_bf16 v[200:203], v[158:161], v[170:173], v[200:203]
    ds_write_b64 v251, v[216:217] offset:6272
    v_mfma_f32_16x16x32_bf16 v[232:235], a[168:171], a[224:227], 0
    buffer_load_dwordx4 v254, s[4:7], s44 offen lds
    v_mul_f32 v228, s38, v228
    v_mfma_f32_16x16x32_bf16 v[232:235], a[172:175], a[228:231], v[232:235]
    s_add_u32 m0, s46, 0xc00
    v_mul_f32 v229, s38, v229
    v_mul_f32 v230, s38, v230
    v_mfma_f32_16x16x32_bf16 v[232:235], a[176:179], a[232:235], v[232:235]
    v_mul_f32 v231, s38, v231
    v_cvt_pk_bf16_f32 v174, v228, v229
    v_mfma_f32_16x16x32_bf16 v[232:235], a[180:183], a[236:239], v[232:235]
    v_cvt_pk_bf16_f32 v175, v230, v231
    v_mul_f32 v221, v221, v225
    v_mfma_f32_16x16x32_bf16 v[232:235], a[184:187], a[240:243], v[232:235]
    ds_write_b64 v247, v[174:175] offset:0
    v_mfma_f32_16x16x32_bf16 v[232:235], a[188:191], a[244:247], v[232:235]
    v_mul_f32 v222, v222, v225
    v_mul_f32 v223, v223, v225
    v_mfma_f32_16x16x32_bf16 v[236:239], a[192:195], a[224:227], 0
    ds_read_b128 a[224:227], v240 offset:30848
    v_cvt_pk_bf16_f32 v220, v220, v221
    v_mfma_f32_16x16x32_bf16 v[236:239], a[196:199], a[228:231], v[236:239]
    ds_read_b128 a[228:231], v241 offset:30848
    v_cvt_pk_bf16_f32 v221, v222, v223
    v_mfma_f32_16x16x32_bf16 v[236:239], a[200:203], a[232:235], v[236:239]
    ds_read_b128 a[232:235], v240 offset:30976
    v_mul_f32 v232, s3, v232
    v_mfma_f32_16x16x32_bf16 v[236:239], a[204:207], a[236:239], v[236:239]
    ds_read_b128 a[236:239], v241 offset:30976
    v_mul_f32 v233, s3, v233
    v_mfma_f32_16x16x32_bf16 v[236:239], a[208:211], a[240:243], v[236:239]
    ds_read_b128 a[240:243], v242 offset:30720
    v_mul_f32 v234, s3, v234
    v_mfma_f32_16x16x32_bf16 v[236:239], a[212:215], a[244:247], v[236:239]
    ds_read_b128 a[244:247], v243 offset:30720
    v_mul_f32 v235, s3, v235
    v_mfma_f32_16x16x32_bf16 v[228:231], a[0:3], a[216:219], 0
    ds_write_b64 v251, v[220:221] offset:6400
    v_mfma_f32_16x16x32_bf16 v[228:231], a[4:7], a[220:223], v[228:231]
    v_cvt_pk_bf16_f32 v176, v232, v233
    v_cvt_pk_bf16_f32 v177, v234, v235
    v_mfma_f32_16x16x32_bf16 v[232:235], a[24:27], a[216:219], 0
    ds_write_b64 v247, v[176:177] offset:128
    v_mfma_f32_16x16x32_bf16 v[232:235], a[28:31], a[220:223], v[232:235]
    s_waitcnt lgkmcnt(6)
    v_mul_f32 v236, s38, v236
    v_mul_f32 v237, s38, v237
    v_mfma_f32_16x16x32_bf16 v[228:231], a[8:11], a[224:227], v[228:231]
    v_mul_f32 v238, s38, v238
    v_mul_f32 v239, s38, v239
    v_mfma_f32_16x16x32_bf16 v[228:231], a[12:15], a[228:231], v[228:231]
    s_waitcnt lgkmcnt(4)
    v_cvt_pk_bf16_f32 v178, v236, v237
    v_cvt_pk_bf16_f32 v179, v238, v239
    v_mfma_f32_16x16x32_bf16 v[228:231], a[16:19], a[232:235], v[228:231]
    ds_write_b64 v247, v[178:179] offset:256
    v_mfma_f32_16x16x32_bf16 v[228:231], a[20:23], a[236:239], v[228:231]
    v_accvgpr_read_b32 v255, a252
    v_accvgpr_read_b32 v254, a253
    v_mfma_f32_16x16x32_bf16 v[232:235], a[32:35], a[224:227], v[232:235]
    buffer_load_dwordx4 v255, s[4:7], s59 offen lds
    v_accvgpr_read_b32 v255, a254
    v_mfma_f32_16x16x32_bf16 v[232:235], a[36:39], a[228:231], v[232:235]
    s_add_u32 m0, s46, 0x1000
    v_max3_f32 v248, v248, v204, v205
    v_max3_f32 v248, v248, v206, v207
    v_mfma_f32_16x16x32_bf16 v[232:235], a[40:43], a[232:235], v[232:235]
    ds_read_b128 v[204:207], v244 offset:128
    v_max3_f32 v248, v248, v208, v209
    v_mfma_f32_16x16x32_bf16 v[232:235], a[44:47], a[236:239], v[232:235]
    s_mov_b32 s59, 0x1000
    v_max3_f32 v248, v248, v210, v211
    v_max3_f32 v248, v248, v196, v197
    v_mfma_f32_16x16x32_bf16 v[236:239], a[48:51], a[216:219], 0
    ds_read_b128 v[208:211], v245 offset:128
    v_max3_f32 v248, v248, v198, v199
    v_mfma_f32_16x16x32_bf16 v[236:239], a[52:55], a[220:223], v[236:239]
    ds_read_b128 v[196:199], v246 offset:128
    v_max3_f32 v248, v248, v200, v201
    v_mfma_f32_16x16x32_bf16 v[236:239], a[56:59], a[224:227], v[236:239]
    buffer_load_dwordx4 v254, s[4:7], s50 offen lds
    v_accvgpr_read_b32 v254, a252
    v_mfma_f32_16x16x32_bf16 v[236:239], a[60:63], a[228:231], v[236:239]
    s_add_u32 m0, s46, 0x1400
    v_max3_f32 v248, v248, v202, v203
    s_mov_b32 s50, 0x1000
    v_mfma_f32_16x16x32_bf16 v[236:239], a[64:67], a[232:235], v[236:239]
    ds_read_b128 v[200:203], v244 offset:0
    v_mfma_f32_16x16x32_bf16 v[236:239], a[68:71], a[236:239], v[236:239]
    s_waitcnt lgkmcnt(3)
    v_mfma_f32_16x16x32_bf16 v[204:207], v[162:165], v[168:171], v[204:207]
    buffer_load_dwordx4 v255, s[4:7], s51 offen lds
    v_accvgpr_read_b32 v255, a255
    v_mfma_f32_16x16x32_bf16 v[204:207], v[164:167], v[170:173], v[204:207]
    s_add_u32 m0, s46, 0x1800
    s_mov_b32 s51, 0x1000
    s_waitcnt lgkmcnt(2)
    v_mfma_f32_16x16x32_bf16 v[208:211], v[90:93], v[168:171], v[208:211]
    v_mfma_f32_16x16x32_bf16 v[208:211], v[92:95], v[170:173], v[208:211]
    s_waitcnt lgkmcnt(1)
    v_mfma_f32_16x16x32_bf16 v[196:199], v[96:99], v[168:171], v[196:199]
    v_mfma_f32_16x16x32_bf16 v[196:199], v[98:101], v[170:173], v[196:199]
    buffer_load_dwordx4 v254, s[4:7], s52 offen lds
    s_waitcnt lgkmcnt(0)
    v_mfma_f32_16x16x32_bf16 v[200:203], v[102:105], v[168:171], v[200:203]
    s_add_u32 m0, s46, 0x1a00
    v_cvt_pk_bf16_f32 v102, v228, v229
    v_cvt_pk_bf16_f32 v103, v230, v231
    v_mfma_f32_16x16x32_bf16 v[200:203], v[104:107], v[170:173], v[200:203]
    s_mov_b32 s52, 0x2000
    v_cvt_pk_bf16_f32 v104, v232, v233
    v_cvt_pk_bf16_f32 v105, v234, v235
    v_mfma_f32_16x16x32_bf16 v[228:231], a[216:219], a[72:75], 0
    v_cvt_pk_bf16_f32 v106, v236, v237
    v_cvt_pk_bf16_f32 v107, v238, v239
    v_mfma_f32_16x16x32_bf16 v[228:231], a[220:223], a[76:79], v[228:231]
    v_max3_f32 v248, v248, v204, v205
    v_max3_f32 v248, v248, v208, v209
    v_mfma_f32_16x16x32_bf16 v[228:231], a[224:227], a[80:83], v[228:231]
    ds_read_b128 v[204:207], v245 offset:0
    v_max3_f32 v248, v248, v196, v197
    v_mfma_f32_16x16x32_bf16 v[228:231], a[228:231], a[84:87], v[228:231]
    ds_read_b128 v[208:211], v246 offset:0
    v_mov_b32 v225, v248
    v_mfma_f32_16x16x32_bf16 v[228:231], a[232:235], a[88:91], v[228:231]
    ds_read_b128 v[196:199], v244 offset:64
    v_permlane16_swap_b32 v248, v225
    v_mfma_f32_16x16x32_bf16 v[228:231], a[236:239], a[92:95], v[228:231]
    buffer_load_dwordx4 v255, s[4:7], s53 offen lds
    v_max_f32 v248, v248, v225
    v_mfma_f32_16x16x32_bf16 v[232:235], a[216:219], a[96:99], 0
    s_mov_b32 s53, 0x2000
    v_mov_b32 v225, v248
    v_mbcnt_lo_u32_b32 v254, -1, 0
    v_mfma_f32_16x16x32_bf16 v[232:235], a[220:223], a[100:103], v[232:235]
    v_permlane32_swap_b32 v248, v225
    v_cvt_pk_bf16_f32 v0, v228, v229
    v_mfma_f32_16x16x32_bf16 v[232:235], a[224:227], a[104:107], v[232:235]
    v_cvt_pk_bf16_f32 v3, v230, v231
    v_max_f32 v248, v248, v225
    v_mfma_f32_16x16x32_bf16 v[232:235], a[228:231], a[108:111], v[232:235]
    v_sub_f32 v200, v200, v248
    v_sub_f32 v201, v201, v248
    v_mfma_f32_16x16x32_bf16 v[232:235], a[232:235], a[112:115], v[232:235]
    v_exp_f32 v200, v200
    v_mfma_f32_16x16x32_bf16 v[232:235], a[236:239], a[116:119], v[232:235]
    s_waitcnt lgkmcnt(2)
    v_exp_f32 v201, v201
    v_mfma_f32_16x16x32_bf16 v[204:207], v[126:129], v[168:171], v[204:207]
    s_waitcnt lgkmcnt(1)
    v_sub_f32 v202, v202, v248
    v_sub_f32 v203, v203, v248
    v_mfma_f32_16x16x32_bf16 v[204:207], v[128:131], v[170:173], v[204:207]
    s_waitcnt lgkmcnt(0)
    v_cvt_pk_bf16_f32 v30, v232, v233
    v_cvt_pk_bf16_f32 v33, v234, v235
    v_mfma_f32_16x16x32_bf16 v[208:211], v[150:153], v[168:171], v[208:211]
    v_exp_f32 v202, v202
    v_mfma_f32_16x16x32_bf16 v[208:211], v[152:155], v[170:173], v[208:211]
    v_exp_f32 v203, v203
    v_mfma_f32_16x16x32_bf16 v[196:199], v[108:111], v[168:171], v[196:199]
    v_cvt_pk_bf16_f32 v180, v200, v201
    v_cvt_pk_bf16_f32 v183, v202, v203
    v_mfma_f32_16x16x32_bf16 v[196:199], v[110:113], v[170:173], v[196:199]
    ds_read_b128 v[200:203], v245 offset:64
    v_sub_f32 v204, v204, v248
    v_mfma_f32_16x16x32_bf16 v[236:239], a[216:219], a[120:123], 0
    ds_read_b128 a[216:219], v242 offset:30848
    v_sub_f32 v205, v205, v248
    v_mfma_f32_16x16x32_bf16 v[236:239], a[220:223], a[124:127], v[236:239]
    ds_read_b128 a[220:223], v243 offset:30848
    v_sub_f32 v206, v206, v248
    v_mfma_f32_16x16x32_bf16 v[236:239], a[224:227], a[128:131], v[236:239]
    ds_read_b128 a[224:227], v242 offset:30976
    v_sub_f32 v207, v207, v248
    v_mfma_f32_16x16x32_bf16 v[236:239], a[228:231], a[132:135], v[236:239]
    ds_read_b128 a[228:231], v243 offset:30976
    v_sub_f32 v208, v208, v248
    v_mfma_f32_16x16x32_bf16 v[236:239], a[232:235], a[136:139], v[236:239]
    ds_read_b128 a[232:235], v242 offset:32256
    v_sub_f32 v209, v209, v248
    v_mfma_f32_16x16x32_bf16 v[236:239], a[236:239], a[140:143], v[236:239]
    ds_read_b128 a[236:239], v243 offset:32256
    v_sub_f32 v210, v210, v248
    v_mfma_f32_16x16x32_bf16 v[228:231], a[144:147], a[240:243], 0
    v_exp_f32 v204, v204
    v_mfma_f32_16x16x32_bf16 v[228:231], a[148:151], a[244:247], v[228:231]
    v_exp_f32 v205, v205
    v_mfma_f32_16x16x32_bf16 v[232:235], a[168:171], a[240:243], 0
    s_waitcnt lgkmcnt(6)
    v_cvt_pk_bf16_f32 v60, v236, v237
    v_cvt_pk_bf16_f32 v63, v238, v239
    v_mfma_f32_16x16x32_bf16 v[200:203], v[132:135], v[168:171], v[200:203]
    s_waitcnt lgkmcnt(5)
    v_exp_f32 v206, v206
    v_mfma_f32_16x16x32_bf16 v[200:203], v[134:137], v[170:173], v[200:203]
    v_exp_f32 v207, v207
    v_mfma_f32_16x16x32_bf16 v[228:231], a[152:155], a[216:219], v[228:231]
    s_waitcnt lgkmcnt(3)
    v_cvt_pk_bf16_f32 v181, v204, v205
    v_cvt_pk_bf16_f32 v184, v206, v207
    v_mfma_f32_16x16x32_bf16 v[228:231], a[156:159], a[220:223], v[228:231]
    ds_read_b128 v[204:207], v246 offset:64
    v_sub_f32 v211, v211, v248
    v_mfma_f32_16x16x32_bf16 v[228:231], a[160:163], a[224:227], v[228:231]
    s_waitcnt lgkmcnt(2)
    v_exp_f32 v208, v208
    v_mfma_f32_16x16x32_bf16 v[228:231], a[164:167], a[228:231], v[228:231]
    v_exp_f32 v209, v209
    v_mfma_f32_16x16x32_bf16 v[232:235], a[172:175], a[244:247], v[232:235]
    v_exp_f32 v210, v210
    v_mfma_f32_16x16x32_bf16 v[232:235], a[176:179], a[216:219], v[232:235]
    v_exp_f32 v211, v211
    v_mfma_f32_16x16x32_bf16 v[232:235], a[180:183], a[220:223], v[232:235]
    v_cvt_pk_bf16_f32 v182, v208, v209
    v_cvt_pk_bf16_f32 v185, v210, v211
    v_mfma_f32_16x16x32_bf16 v[232:235], a[184:187], a[224:227], v[232:235]
    ds_read_b128 v[208:211], v244 offset:128
    v_mul_f32 v228, s38, v228
    v_mfma_f32_16x16x32_bf16 v[212:215], v[12:15], v[180:183], 0
    v_mul_f32 v229, s38, v229
    v_mul_f32 v230, s38, v230
    v_mfma_f32_16x16x32_bf16 v[216:219], v[42:45], v[180:183], 0
    v_mul_f32 v231, s38, v231
    v_sub_f32 v196, v196, v248
    v_mfma_f32_16x16x32_bf16 v[220:223], v[72:75], v[180:183], 0
    s_waitcnt lgkmcnt(1)
    v_exp_f32 v196, v196
    v_mfma_f32_16x16x32_bf16 v[224:227], a[248:251], v[180:183], 0
    v_sub_f32 v197, v197, v248
    v_sub_f32 v198, v198, v248
    v_mfma_f32_16x16x32_bf16 v[204:207], v[156:159], v[168:171], v[204:207]
    v_exp_f32 v197, v197
    v_mfma_f32_16x16x32_bf16 v[204:207], v[158:161], v[170:173], v[204:207]
    v_exp_f32 v198, v198
    v_mfma_f32_16x16x32_bf16 v[232:235], a[188:191], a[228:231], v[232:235]
    v_sub_f32 v199, v199, v248
    v_cvt_pk_bf16_f32 v186, v196, v197
    v_mfma_f32_16x16x32_bf16 v[236:239], a[192:195], a[240:243], 0
    ds_read_b128 a[240:243], v242 offset:32384
    v_sub_f32 v200, v200, v248
    v_mfma_f32_16x16x32_bf16 v[236:239], a[196:199], a[244:247], v[236:239]
    ds_read_b128 a[244:247], v243 offset:32384
    v_sub_f32 v201, v201, v248
    v_mfma_f32_16x16x32_bf16 v[236:239], a[200:203], a[216:219], v[236:239]
    ds_read_b128 a[216:219], v242 offset:32512
    v_mul_f32 v232, s3, v232
    v_mfma_f32_16x16x32_bf16 v[236:239], a[204:207], a[220:223], v[236:239]
    ds_read_b128 a[220:223], v243 offset:32512
    v_mul_f32 v233, s3, v233
    v_mfma_f32_16x16x32_bf16 v[236:239], a[208:211], a[224:227], v[236:239]
    ds_read_b128 a[224:227], v242 offset:33792
    v_mul_f32 v234, s3, v234
    v_mfma_f32_16x16x32_bf16 v[236:239], a[212:215], a[228:231], v[236:239]
    s_waitcnt lgkmcnt(5)
    v_mul_f32 v235, s3, v235
    v_sub_f32 v202, v202, v248
    v_mfma_f32_16x16x32_bf16 v[208:211], v[162:165], v[168:171], v[208:211]
    ds_read_b128 a[228:231], v243 offset:33792
    v_sub_f32 v203, v203, v248
    v_mfma_f32_16x16x32_bf16 v[208:211], v[164:167], v[170:173], v[208:211]
    v_exp_f32 v199, v199
    v_mul_f32 v236, s38, v236
    v_mul_f32 v237, s38, v237
    v_mul_f32 v238, s38, v238
    v_mul_f32 v239, s38, v239
    v_cvt_pk_bf16_f32 v189, v198, v199
    ds_read_b128 v[196:199], v245 offset:128
    v_exp_f32 v200, v200
    v_exp_f32 v201, v201
    v_exp_f32 v202, v202
    v_exp_f32 v203, v203
    v_cvt_pk_bf16_f32 v187, v200, v201
    v_cvt_pk_bf16_f32 v190, v202, v203
    ds_read_b128 v[200:203], v246 offset:128
    v_mfma_f32_16x16x32_bf16 v[212:215], v[16:19], v[184:187], v[212:215]
    v_sub_f32 v204, v204, v248
    v_sub_f32 v205, v205, v248
    v_mfma_f32_16x16x32_bf16 v[216:219], v[46:49], v[184:187], v[216:219]
    v_exp_f32 v204, v204
    v_mfma_f32_16x16x32_bf16 v[220:223], v[76:79], v[184:187], v[220:223]
    v_exp_f32 v205, v205
    v_mfma_f32_16x16x32_bf16 v[224:227], a[248:251], v[184:187], v[224:227]
    v_sub_f32 v206, v206, v248
    v_exp_f32 v206, v206
    v_sub_f32 v207, v207, v248
    v_exp_f32 v207, v207
    v_cvt_pk_bf16_f32 v188, v204, v205
    v_cvt_pk_bf16_f32 v191, v206, v207
    s_waitcnt lgkmcnt(1)
    v_mfma_f32_16x16x32_bf16 v[196:199], v[90:93], v[168:171], v[196:199]
    ds_read_b128 v[204:207], v244 offset:0
    v_sub_f32 v208, v208, v248
    v_mfma_f32_16x16x32_bf16 v[212:215], v[20:23], v[188:191], v[212:215]
    v_exp_f32 v208, v208
    v_mfma_f32_16x16x32_bf16 v[216:219], v[50:53], v[188:191], v[216:219]
    s_waitcnt lgkmcnt(1)
    v_sub_f32 v209, v209, v248
    v_mbcnt_hi_u32_b32 v254, -1, v254
    v_mfma_f32_16x16x32_bf16 v[220:223], v[80:83], v[188:191], v[220:223]
    v_exp_f32 v209, v209
    v_mfma_f32_16x16x32_bf16 v[224:227], a[248:251], v[188:191], v[224:227]
    v_cvt_pk_bf16_f32 v192, v208, v209
    v_lshl_add_u32 v254, v254, 4, s66
    v_mfma_f32_16x16x32_bf16 v[196:199], v[92:95], v[170:173], v[196:199]
    ds_read_b128 v[208:211], v245 offset:0
    s_lshl_b32 s66, s28, 1
    v_mfma_f32_16x16x32_bf16 v[200:203], v[96:99], v[168:171], v[200:203]
    v_cvt_pk_bf16_f32 v168, v228, v229
    v_cvt_pk_bf16_f32 v169, v230, v231
    v_mfma_f32_16x16x32_bf16 v[200:203], v[98:101], v[170:173], v[200:203]
    v_cvt_pk_bf16_f32 v170, v232, v233
    v_cvt_pk_bf16_f32 v171, v234, v235
    v_mfma_f32_16x16x32_bf16 v[228:231], a[144:147], a[232:235], 0
    v_cvt_pk_bf16_f32 v172, v236, v237
    v_cvt_pk_bf16_f32 v173, v238, v239
    v_mfma_f32_16x16x32_bf16 v[228:231], a[148:151], a[236:239], v[228:231]
    s_waitcnt lgkmcnt(1)
    v_sub_f32 v196, v196, v248
    v_sub_f32 v197, v197, v248
    v_mfma_f32_16x16x32_bf16 v[204:207], v[108:111], v[174:177], v[204:207]
    v_exp_f32 v196, v196
    v_mfma_f32_16x16x32_bf16 v[204:207], v[110:113], v[176:179], v[204:207]
    v_exp_f32 v197, v197
    v_mfma_f32_16x16x32_bf16 v[228:231], a[152:155], a[240:243], v[228:231]
    v_cvt_pk_bf16_f32 v193, v196, v197
    v_sub_f32 v200, v200, v248
    v_mfma_f32_16x16x32_bf16 v[228:231], a[156:159], a[244:247], v[228:231]
    ds_read_b128 v[196:199], v246 offset:0
    v_sub_f32 v201, v201, v248
    v_mfma_f32_16x16x32_bf16 v[228:231], a[160:163], a[216:219], v[228:231]
    s_waitcnt lgkmcnt(1)
    v_exp_f32 v200, v200
    v_mfma_f32_16x16x32_bf16 v[208:211], v[132:135], v[174:177], v[208:211]
    v_exp_f32 v201, v201
    v_mfma_f32_16x16x32_bf16 v[208:211], v[134:137], v[176:179], v[208:211]
    v_cvt_pk_bf16_f32 v194, v200, v201
    v_max_f32 v248, v204, v205
    v_mfma_f32_16x16x32_bf16 v[228:231], a[164:167], a[220:223], v[228:231]
    ds_read_b128 v[200:203], v244 offset:64
    v_max3_f32 v248, v248, v206, v207
    v_mfma_f32_16x16x32_bf16 v[212:215], v[24:27], v[192:195], v[212:215]
    ds_read_b128 v[204:207], v245 offset:64
    v_mfma_f32_16x16x32_bf16 v[216:219], v[54:57], v[192:195], v[216:219]
    v_max3_f32 v248, v248, v208, v209
    v_max3_f32 v248, v248, v210, v211
    v_mfma_f32_16x16x32_bf16 v[220:223], v[84:87], v[192:195], v[220:223]
    ds_read_b128 v[208:211], v246 offset:64
    v_mul_f32 v228, s38, v228
    v_mfma_f32_16x16x32_bf16 v[224:227], a[248:251], v[192:195], v[224:227]
    v_mul_f32 v229, s38, v229
    v_mul_f32 v230, s38, v230
    v_mfma_f32_16x16x32_bf16 v[232:235], a[168:171], a[232:235], 0
    s_waitcnt lgkmcnt(3)
    v_mul_f32 v231, s38, v231
    v_cvt_pk_bf16_f32 v228, v228, v229
    v_mfma_f32_16x16x32_bf16 v[196:199], v[156:159], v[174:177], v[196:199]
    v_cvt_pk_bf16_f32 v229, v230, v231
    v_mfma_f32_16x16x32_bf16 v[196:199], v[158:161], v[176:179], v[196:199]
    ds_write_b64 v247, v[228:229] offset:12288
    v_mfma_f32_16x16x32_bf16 v[232:235], a[172:175], a[236:239], v[232:235]
    s_waitcnt lgkmcnt(3)
    v_rcp_f32 v225, v224
    v_mfma_f32_16x16x32_bf16 v[200:203], v[162:165], v[174:177], v[200:203]
    s_waitcnt lgkmcnt(2)
    v_mul_f32 v212, v212, v225
    v_mul_f32 v213, v213, v225
    v_mfma_f32_16x16x32_bf16 v[200:203], v[164:167], v[176:179], v[200:203]
    v_mul_f32 v214, v214, v225
    v_mul_f32 v215, v215, v225
    v_mfma_f32_16x16x32_bf16 v[204:207], v[90:93], v[174:177], v[204:207]
    s_waitcnt lgkmcnt(1)
    v_cvt_pk_bf16_f32 v212, v212, v213
    v_cvt_pk_bf16_f32 v213, v214, v215
    v_mfma_f32_16x16x32_bf16 v[204:207], v[92:95], v[176:179], v[204:207]
    ds_write_b64 v251, v[212:213] offset:12288
    v_mfma_f32_16x16x32_bf16 v[208:211], v[96:99], v[174:177], v[208:211]
    v_mul_f32 v216, v216, v225
    v_mul_f32 v217, v217, v225
    v_mfma_f32_16x16x32_bf16 v[208:211], v[98:101], v[176:179], v[208:211]
    v_mul_f32 v218, v218, v225
    v_mul_f32 v219, v219, v225
    v_mfma_f32_16x16x32_bf16 v[232:235], a[176:179], a[240:243], v[232:235]
    v_cvt_pk_bf16_f32 v216, v216, v217
    v_cvt_pk_bf16_f32 v217, v218, v219
    v_mfma_f32_16x16x32_bf16 v[232:235], a[180:183], a[244:247], v[232:235]
    ds_write_b64 v251, v[216:217] offset:12416
    v_mfma_f32_16x16x32_bf16 v[232:235], a[184:187], a[216:219], v[232:235]
    v_mul_f32 v220, v220, v225
    v_mul_f32 v221, v221, v225
    v_mfma_f32_16x16x32_bf16 v[232:235], a[188:191], a[220:223], v[232:235]
    v_mul_f32 v222, v222, v225
    v_mul_f32 v223, v223, v225
    v_mfma_f32_16x16x32_bf16 v[236:239], a[192:195], a[232:235], 0
    ds_read_b128 a[232:235], v242 offset:33920
    v_cvt_pk_bf16_f32 v220, v220, v221
    v_mfma_f32_16x16x32_bf16 v[236:239], a[196:199], a[236:239], v[236:239]
    ds_read_b128 a[236:239], v243 offset:33920
    v_cvt_pk_bf16_f32 v221, v222, v223
    v_mfma_f32_16x16x32_bf16 v[236:239], a[200:203], a[240:243], v[236:239]
    ds_read_b128 a[240:243], v242 offset:34048
    v_mul_f32 v232, s3, v232
    v_mfma_f32_16x16x32_bf16 v[236:239], a[204:207], a[244:247], v[236:239]
    ds_read_b128 a[244:247], v243 offset:34048
    v_mul_f32 v233, s3, v233
    v_mfma_f32_16x16x32_bf16 v[236:239], a[208:211], a[216:219], v[236:239]
    ds_read_b128 a[216:219], v240 offset:32256
    v_mul_f32 v234, s3, v234
    v_mfma_f32_16x16x32_bf16 v[236:239], a[212:215], a[220:223], v[236:239]
    ds_read_b128 a[220:223], v241 offset:32256
    v_mul_f32 v235, s3, v235
    v_mfma_f32_16x16x32_bf16 v[228:231], a[144:147], a[224:227], 0
    ds_write_b64 v251, v[220:221] offset:12544
    v_mfma_f32_16x16x32_bf16 v[228:231], a[148:151], a[228:231], v[228:231]
    v_cvt_pk_bf16_f32 v232, v232, v233
    v_cvt_pk_bf16_f32 v233, v234, v235
    ds_write_b64 v247, v[232:233] offset:12416
    v_mfma_f32_16x16x32_bf16 v[232:235], a[168:171], a[224:227], 0
    s_waitcnt lgkmcnt(6)
    v_mul_f32 v236, s38, v236
    v_mul_f32 v237, s38, v237
    v_mfma_f32_16x16x32_bf16 v[228:231], a[152:155], a[232:235], v[228:231]
    v_mul_f32 v238, s38, v238
    v_mul_f32 v239, s38, v239
    v_mfma_f32_16x16x32_bf16 v[228:231], a[156:159], a[236:239], v[228:231]
    s_waitcnt lgkmcnt(4)
    v_cvt_pk_bf16_f32 v236, v236, v237
    v_cvt_pk_bf16_f32 v237, v238, v239
    v_mfma_f32_16x16x32_bf16 v[228:231], a[160:163], a[240:243], v[228:231]
    ds_write_b64 v247, v[236:237] offset:12544
    v_mfma_f32_16x16x32_bf16 v[228:231], a[164:167], a[244:247], v[228:231]
    s_barrier
    v_max3_f32 v248, v248, v196, v197
    v_max3_f32 v248, v248, v198, v199
    v_mfma_f32_16x16x32_bf16 v[232:235], a[172:175], a[228:231], v[232:235]
    ds_read_b128 v[196:199], v244 offset:0
    v_max3_f32 v248, v248, v200, v201
    v_mfma_f32_16x16x32_bf16 v[232:235], a[176:179], a[232:235], v[232:235]
    v_max3_f32 v248, v248, v202, v203
    v_mul_f32 v228, s38, v228
    v_mfma_f32_16x16x32_bf16 v[232:235], a[180:183], a[236:239], v[232:235]
    ds_read_b128 v[200:203], v245 offset:0
    v_mul_f32 v229, s38, v229
    v_mfma_f32_16x16x32_bf16 v[232:235], a[184:187], a[240:243], v[232:235]
    v_mul_f32 v230, s38, v230
    v_mul_f32 v231, s38, v231
    v_mfma_f32_16x16x32_bf16 v[232:235], a[188:191], a[244:247], v[232:235]
    v_cvt_pk_bf16_f32 v228, v228, v229
    v_cvt_pk_bf16_f32 v229, v230, v231
    v_mfma_f32_16x16x32_bf16 v[236:239], a[192:195], a[224:227], 0
    ds_write_b64 v247, v[228:229] offset:18432
    v_mfma_f32_16x16x32_bf16 v[236:239], a[196:199], a[228:231], v[236:239]
    ds_read_b128 a[224:227], v240 offset:32384
    v_max3_f32 v248, v248, v204, v205
    v_mfma_f32_16x16x32_bf16 v[236:239], a[200:203], a[232:235], v[236:239]
    ds_read_b128 a[228:231], v241 offset:32384
    v_mul_f32 v232, s3, v232
    v_mfma_f32_16x16x32_bf16 v[236:239], a[204:207], a[236:239], v[236:239]
    ds_read_b128 a[232:235], v240 offset:32512
    v_mul_f32 v233, s3, v233
    v_mfma_f32_16x16x32_bf16 v[236:239], a[208:211], a[240:243], v[236:239]
    ds_read_b128 a[236:239], v241 offset:32512
    v_mul_f32 v234, s3, v234
    v_mfma_f32_16x16x32_bf16 v[236:239], a[212:215], a[244:247], v[236:239]
    s_waitcnt lgkmcnt(5)
    v_mul_f32 v235, s3, v235
    v_cvt_pk_bf16_f32 v232, v232, v233
    v_mfma_f32_16x16x32_bf16 v[196:199], v[108:111], v[174:177], v[196:199]
    ds_read_b128 a[240:243], v240 offset:33792
    v_cvt_pk_bf16_f32 v233, v234, v235
    v_mfma_f32_16x16x32_bf16 v[196:199], v[110:113], v[176:179], v[196:199]
    ds_write_b64 v247, v[232:233] offset:18560
    v_mfma_f32_16x16x32_bf16 v[200:203], v[132:135], v[174:177], v[200:203]
    ds_read_b128 a[244:247], v241 offset:33792
    v_mul_f32 v236, s38, v236
    v_mfma_f32_16x16x32_bf16 v[200:203], v[134:137], v[176:179], v[200:203]
    v_mul_f32 v237, s38, v237
    v_mul_f32 v238, s38, v238
    v_mfma_f32_16x16x32_bf16 v[228:231], a[0:3], a[216:219], 0
    v_mul_f32 v239, s38, v239
    v_cvt_pk_bf16_f32 v236, v236, v237
    v_mfma_f32_16x16x32_bf16 v[228:231], a[4:7], a[220:223], v[228:231]
    s_waitcnt lgkmcnt(4)
    v_cvt_pk_bf16_f32 v237, v238, v239
    v_max3_f32 v248, v248, v206, v207
    v_mfma_f32_16x16x32_bf16 v[228:231], a[8:11], a[224:227], v[228:231]
    ds_write_b64 v247, v[236:237] offset:18688
    v_mfma_f32_16x16x32_bf16 v[228:231], a[12:15], a[228:231], v[228:231]
    ds_read_b128 v[204:207], v246 offset:0
    v_max3_f32 v248, v248, v208, v209
    v_mfma_f32_16x16x32_bf16 v[228:231], a[16:19], a[232:235], v[228:231]
    s_waitcnt lgkmcnt(4)
    v_max3_f32 v248, v248, v210, v211
    v_mov_b32 v225, v248
    v_mfma_f32_16x16x32_bf16 v[228:231], a[20:23], a[236:239], v[228:231]
    ds_read_b128 v[208:211], v244 offset:64
    v_permlane16_swap_b32 v248, v225
    v_mfma_f32_16x16x32_bf16 v[232:235], a[24:27], a[216:219], 0
    v_max_f32 v248, v248, v225
    v_mov_b32 v225, v248
    v_mfma_f32_16x16x32_bf16 v[232:235], a[28:31], a[220:223], v[232:235]
    v_mfma_f32_16x16x32_bf16 v[232:235], a[32:35], a[224:227], v[232:235]
    v_permlane32_swap_b32 v248, v225
    v_cvt_pk_bf16_f32 v108, v228, v229
    v_mfma_f32_16x16x32_bf16 v[232:235], a[36:39], a[228:231], v[232:235]
    v_cvt_pk_bf16_f32 v109, v230, v231
    v_max_f32 v248, v248, v225
    v_mfma_f32_16x16x32_bf16 v[232:235], a[40:43], a[232:235], v[232:235]
    v_sub_f32 v196, v196, v248
    v_sub_f32 v197, v197, v248
    v_mfma_f32_16x16x32_bf16 v[232:235], a[44:47], a[236:239], v[232:235]
    v_exp_f32 v196, v196
    v_mfma_f32_16x16x32_bf16 v[236:239], a[48:51], a[216:219], 0
    s_waitcnt lgkmcnt(1)
    v_exp_f32 v197, v197
    v_mfma_f32_16x16x32_bf16 v[204:207], v[156:159], v[174:177], v[204:207]
    v_sub_f32 v198, v198, v248
    v_sub_f32 v199, v199, v248
    v_mfma_f32_16x16x32_bf16 v[204:207], v[158:161], v[176:179], v[204:207]
    s_waitcnt lgkmcnt(0)
    v_cvt_pk_bf16_f32 v110, v232, v233
    v_cvt_pk_bf16_f32 v111, v234, v235
    v_mfma_f32_16x16x32_bf16 v[208:211], v[162:165], v[174:177], v[208:211]
    v_exp_f32 v198, v198
    v_mfma_f32_16x16x32_bf16 v[208:211], v[164:167], v[176:179], v[208:211]
    v_exp_f32 v199, v199
    v_mfma_f32_16x16x32_bf16 v[236:239], a[52:55], a[220:223], v[236:239]
    v_cvt_pk_bf16_f32 v180, v196, v197
    v_cvt_pk_bf16_f32 v183, v198, v199
    v_mfma_f32_16x16x32_bf16 v[236:239], a[56:59], a[224:227], v[236:239]
    ds_read_b128 v[196:199], v245 offset:64
    v_sub_f32 v200, v200, v248
    v_mfma_f32_16x16x32_bf16 v[236:239], a[60:63], a[228:231], v[236:239]
    v_exp_f32 v200, v200
    v_mfma_f32_16x16x32_bf16 v[236:239], a[64:67], a[232:235], v[236:239]
    v_sub_f32 v201, v201, v248
    v_sub_f32 v202, v202, v248
    v_mfma_f32_16x16x32_bf16 v[236:239], a[68:71], a[236:239], v[236:239]
    v_exp_f32 v201, v201
    v_mfma_f32_16x16x32_bf16 v[228:231], a[216:219], a[72:75], 0
    v_exp_f32 v202, v202
    v_mfma_f32_16x16x32_bf16 v[228:231], a[220:223], a[76:79], v[228:231]
    v_sub_f32 v203, v203, v248
    v_cvt_pk_bf16_f32 v181, v200, v201
    v_mfma_f32_16x16x32_bf16 v[228:231], a[224:227], a[80:83], v[228:231]
    v_exp_f32 v203, v203
    v_mfma_f32_16x16x32_bf16 v[228:231], a[228:231], a[84:87], v[228:231]
    v_cvt_pk_bf16_f32 v112, v236, v237
    v_cvt_pk_bf16_f32 v113, v238, v239
    v_mfma_f32_16x16x32_bf16 v[228:231], a[232:235], a[88:91], v[228:231]
    v_cvt_pk_bf16_f32 v184, v202, v203
    v_sub_f32 v204, v204, v248
    v_mfma_f32_16x16x32_bf16 v[228:231], a[236:239], a[92:95], v[228:231]
    ds_read_b128 v[200:203], v246 offset:64
    v_sub_f32 v205, v205, v248
    v_mfma_f32_16x16x32_bf16 v[232:235], a[216:219], a[96:99], 0
    s_waitcnt lgkmcnt(1)
    v_exp_f32 v204, v204
    v_mfma_f32_16x16x32_bf16 v[196:199], v[90:93], v[174:177], v[196:199]
    v_exp_f32 v205, v205
    v_mfma_f32_16x16x32_bf16 v[196:199], v[92:95], v[176:179], v[196:199]
    v_cvt_pk_bf16_f32 v6, v228, v229
    v_cvt_pk_bf16_f32 v9, v230, v231
    v_mfma_f32_16x16x32_bf16 v[232:235], a[220:223], a[100:103], v[232:235]
    v_sub_f32 v206, v206, v248
    v_sub_f32 v207, v207, v248
    v_mfma_f32_16x16x32_bf16 v[232:235], a[224:227], a[104:107], v[232:235]
    v_exp_f32 v206, v206
    v_mfma_f32_16x16x32_bf16 v[232:235], a[228:231], a[108:111], v[232:235]
    v_exp_f32 v207, v207
    v_mfma_f32_16x16x32_bf16 v[232:235], a[232:235], a[112:115], v[232:235]
    v_cvt_pk_bf16_f32 v182, v204, v205
    v_cvt_pk_bf16_f32 v185, v206, v207
    v_mfma_f32_16x16x32_bf16 v[232:235], a[236:239], a[116:119], v[232:235]
    v_sub_f32 v208, v208, v248
    v_sub_f32 v209, v209, v248
    v_mfma_f32_16x16x32_bf16 v[212:215], v[18:21], v[180:183], 0
    s_waitcnt lgkmcnt(0)
    v_exp_f32 v208, v208
    v_mfma_f32_16x16x32_bf16 v[216:219], v[48:51], v[180:183], 0
    v_exp_f32 v209, v209
    v_mfma_f32_16x16x32_bf16 v[220:223], v[78:81], v[180:183], 0
    v_cvt_pk_bf16_f32 v36, v232, v233
    v_cvt_pk_bf16_f32 v39, v234, v235
    v_mfma_f32_16x16x32_bf16 v[224:227], a[248:251], v[180:183], 0
    v_sub_f32 v210, v210, v248
    v_sub_f32 v211, v211, v248
    v_mfma_f32_16x16x32_bf16 v[200:203], v[96:99], v[174:177], v[200:203]
    ds_read_b64 v[174:175], v247 offset:12288
    v_cvt_pk_bf16_f32 v186, v208, v209
    v_mfma_f32_16x16x32_bf16 v[200:203], v[98:101], v[176:179], v[200:203]
    ds_read_b64 v[176:177], v247 offset:12416
    v_sub_f32 v196, v196, v248
    v_mfma_f32_16x16x32_bf16 v[236:239], a[216:219], a[120:123], 0
    ds_read_b128 a[216:219], v240 offset:33920
    v_sub_f32 v197, v197, v248
    v_mfma_f32_16x16x32_bf16 v[236:239], a[220:223], a[124:127], v[236:239]
    ds_read_b128 a[220:223], v241 offset:33920
    v_sub_f32 v198, v198, v248
    v_mfma_f32_16x16x32_bf16 v[236:239], a[224:227], a[128:131], v[236:239]
    ds_read_b128 a[224:227], v240 offset:34048
    v_sub_f32 v199, v199, v248
    v_mfma_f32_16x16x32_bf16 v[236:239], a[228:231], a[132:135], v[236:239]
    ds_read_b128 a[228:231], v241 offset:34048
    v_sub_f32 v200, v200, v248
    v_mfma_f32_16x16x32_bf16 v[236:239], a[232:235], a[136:139], v[236:239]
    ds_read_b128 a[232:235], v242 offset:61440
    v_sub_f32 v201, v201, v248
    v_mfma_f32_16x16x32_bf16 v[236:239], a[236:239], a[140:143], v[236:239]
    ds_read_b128 a[236:239], v243 offset:61440
    v_sub_f32 v202, v202, v248
    v_mfma_f32_16x16x32_bf16 v[228:231], a[0:3], a[240:243], 0
    ds_read_b64 v[178:179], v247 offset:12544
    v_sub_f32 v203, v203, v248
    v_mfma_f32_16x16x32_bf16 v[228:231], a[4:7], a[244:247], v[228:231]
    v_exp_f32 v210, v210
    v_mfma_f32_16x16x32_bf16 v[232:235], a[24:27], a[240:243], 0
    v_cvt_pk_bf16_f32 v66, v236, v237
    v_cvt_pk_bf16_f32 v69, v238, v239
    v_mfma_f32_16x16x32_bf16 v[232:235], a[28:31], a[244:247], v[232:235]
    s_waitcnt lgkmcnt(6)
    v_exp_f32 v211, v211
    v_mfma_f32_16x16x32_bf16 v[228:231], a[8:11], a[216:219], v[228:231]
    s_waitcnt lgkmcnt(5)
    v_cvt_pk_bf16_f32 v189, v210, v211
    v_mbcnt_lo_u32_b32 v208, -1, 0
    v_mfma_f32_16x16x32_bf16 v[228:231], a[12:15], a[220:223], v[228:231]
    s_waitcnt lgkmcnt(4)
    v_exp_f32 v196, v196
    v_mfma_f32_16x16x32_bf16 v[228:231], a[16:19], a[224:227], v[228:231]
    s_waitcnt lgkmcnt(3)
    v_exp_f32 v197, v197
    v_mfma_f32_16x16x32_bf16 v[228:231], a[20:23], a[228:231], v[228:231]
    v_exp_f32 v198, v198
    v_mfma_f32_16x16x32_bf16 v[232:235], a[32:35], a[216:219], v[232:235]
    v_exp_f32 v199, v199
    v_mfma_f32_16x16x32_bf16 v[232:235], a[36:39], a[220:223], v[232:235]
    v_cvt_pk_bf16_f32 v187, v196, v197
    v_cvt_pk_bf16_f32 v190, v198, v199
    v_mfma_f32_16x16x32_bf16 v[232:235], a[40:43], a[224:227], v[232:235]
    v_exp_f32 v200, v200
    v_mfma_f32_16x16x32_bf16 v[212:215], v[22:25], v[184:187], v[212:215]
    v_cvt_pk_bf16_f32 v162, v228, v229
    v_cvt_pk_bf16_f32 v163, v230, v231
    v_mfma_f32_16x16x32_bf16 v[216:219], v[52:55], v[184:187], v[216:219]
    v_exp_f32 v201, v201
    v_mfma_f32_16x16x32_bf16 v[220:223], v[82:85], v[184:187], v[220:223]
    v_exp_f32 v202, v202
    v_mfma_f32_16x16x32_bf16 v[224:227], a[248:251], v[184:187], v[224:227]
    v_exp_f32 v203, v203
    v_mfma_f32_16x16x32_bf16 v[232:235], a[44:47], a[228:231], v[232:235]
    v_cvt_pk_bf16_f32 v188, v200, v201
    v_cvt_pk_bf16_f32 v191, v202, v203
    v_mfma_f32_16x16x32_bf16 v[236:239], a[48:51], a[240:243], 0
    v_mbcnt_hi_u32_b32 v208, -1, v208
    v_bfe_u32 v204, v208, 2, 2
    v_mfma_f32_16x16x32_bf16 v[212:215], v[26:29], v[188:191], v[212:215]
    v_and_b32 v205, 3, v208
    v_lshrrev_b32 v208, 4, v208
    v_mfma_f32_16x16x32_bf16 v[216:219], v[56:59], v[188:191], v[216:219]
    v_cvt_pk_bf16_f32 v164, v232, v233
    v_cvt_pk_bf16_f32 v165, v234, v235
    v_mfma_f32_16x16x32_bf16 v[220:223], v[86:89], v[188:191], v[220:223]
    v_sub_u32 v206, v208, v204
    v_mul_i32_i24 v206, 0x1c0, v206
    v_mfma_f32_16x16x32_bf16 v[224:227], a[248:251], v[188:191], v[224:227]
    v_lshlrev_b32 v207, 4, v205
    v_sub_u32 v206, v206, v207
    v_mfma_f32_16x16x32_bf16 v[236:239], a[52:55], a[244:247], v[236:239]
    v_add_u32 v206, s37, v206
    v_sub_u32 v207, v208, v204
    v_mfma_f32_16x16x32_bf16 v[236:239], a[56:59], a[216:219], v[236:239]
    v_add_u32 v244, 0, v207
    v_add_u32 v245, 4, v207
    v_mfma_f32_16x16x32_bf16 v[236:239], a[60:63], a[220:223], v[236:239]
    v_rcp_f32 v225, v224
    v_mfma_f32_16x16x32_bf16 v[236:239], a[64:67], a[224:227], v[236:239]
    v_mbcnt_lo_u32_b32 v226, -1, 0
    v_mbcnt_hi_u32_b32 v226, -1, v226
    v_mfma_f32_16x16x32_bf16 v[236:239], a[68:71], a[228:231], v[236:239]
    v_and_b32 v226, 2, v226
    v_cmp_eq_u32 vcc, 0, v226
    v_mfma_f32_16x16x32_bf16 v[228:231], a[240:243], a[72:75], 0
    v_add_u32 v226, 0xfffdd200, v247
    v_cndmask_b32 v226, 0, v226, vcc
    v_mfma_f32_16x16x32_bf16 v[228:231], a[244:247], a[76:79], v[228:231]
    v_add_u32 v226, 0x22e00, v226
    v_mul_f32 v212, v212, v225
    v_mfma_f32_16x16x32_bf16 v[228:231], a[216:219], a[80:83], v[228:231]
    v_cvt_pk_bf16_f32 v166, v236, v237
    v_cvt_pk_bf16_f32 v167, v238, v239
    v_mfma_f32_16x16x32_bf16 v[228:231], a[220:223], a[84:87], v[228:231]
    v_mul_f32 v213, v213, v225
    v_mul_f32 v214, v214, v225
    v_mfma_f32_16x16x32_bf16 v[228:231], a[224:227], a[88:91], v[228:231]
    v_mul_f32 v215, v215, v225
    v_cvt_pk_bf16_f32 v212, v212, v213
    v_mfma_f32_16x16x32_bf16 v[228:231], a[228:231], a[92:95], v[228:231]
    v_cvt_pk_bf16_f32 v213, v214, v215
    v_mul_f32 v216, v216, v225
    v_mfma_f32_16x16x32_bf16 v[232:235], a[240:243], a[96:99], 0
    ds_write_b64 v226, v[212:213] offset:0
    v_mfma_f32_16x16x32_bf16 v[232:235], a[244:247], a[100:103], v[232:235]
    v_mul_f32 v217, v217, v225
    v_mul_f32 v218, v218, v225
    v_mfma_f32_16x16x32_bf16 v[232:235], a[216:219], a[104:107], v[232:235]
    v_cvt_pk_bf16_f32 v12, v228, v229
    v_cvt_pk_bf16_f32 v15, v230, v231
    v_mfma_f32_16x16x32_bf16 v[232:235], a[220:223], a[108:111], v[232:235]
    s_waitcnt lgkmcnt(1)
    v_mul_f32 v219, v219, v225
    v_cvt_pk_bf16_f32 v216, v216, v217
    v_mfma_f32_16x16x32_bf16 v[232:235], a[224:227], a[112:115], v[232:235]
    v_cvt_pk_bf16_f32 v217, v218, v219
    v_mul_f32 v220, v220, v225
    v_mfma_f32_16x16x32_bf16 v[232:235], a[228:231], a[116:119], v[232:235]
    ds_write_b64 v226, v[216:217] offset:128
    v_mfma_f32_16x16x32_bf16 v[236:239], a[240:243], a[120:123], 0
    ds_read_b128 a[240:243], v242 offset:61568
    v_mul_f32 v221, v221, v225
    v_mfma_f32_16x16x32_bf16 v[236:239], a[244:247], a[124:127], v[236:239]
    ds_read_b128 a[244:247], v243 offset:61568
    v_mul_f32 v222, v222, v225
    v_mfma_f32_16x16x32_bf16 v[236:239], a[216:219], a[128:131], v[236:239]
    ds_read_b128 a[216:219], v242 offset:61696
    v_cvt_pk_bf16_f32 v42, v232, v233
    v_mfma_f32_16x16x32_bf16 v[236:239], a[220:223], a[132:135], v[236:239]
    ds_read_b128 a[220:223], v243 offset:61696
    v_cvt_pk_bf16_f32 v45, v234, v235
    v_mfma_f32_16x16x32_bf16 v[236:239], a[224:227], a[136:139], v[236:239]
    ds_read_b128 a[224:227], v242 offset:62976
    v_mul_f32 v223, v223, v225
    v_mfma_f32_16x16x32_bf16 v[236:239], a[228:231], a[140:143], v[236:239]
    ds_read_b128 a[228:231], v243 offset:62976
    v_cvt_pk_bf16_f32 v220, v220, v221
    v_mfma_f32_16x16x32_bf16 v[228:231], a[144:147], a[232:235], 0
    v_cvt_pk_bf16_f32 v221, v222, v223
    v_cmp_gt_u32 vcc, 7, v244
    v_mfma_f32_16x16x32_bf16 v[228:231], a[148:151], a[236:239], v[228:231]
    ds_write_b64 v226, v[220:221] offset:256
    v_mfma_f32_16x16x32_bf16 v[232:235], a[168:171], a[232:235], 0
    s_waitcnt lgkmcnt(6)
    v_cvt_pk_bf16_f32 v72, v236, v237
    v_cvt_pk_bf16_f32 v75, v238, v239
    v_mfma_f32_16x16x32_bf16 v[228:231], a[152:155], a[240:243], v[228:231]
    s_waitcnt lgkmcnt(5)
    v_add_u32 v244, 0xfffdc870, v206
    v_cndmask_b32 v244, 0, v244, vcc
    v_mfma_f32_16x16x32_bf16 v[228:231], a[156:159], a[244:247], v[228:231]
    s_waitcnt lgkmcnt(4)
    v_add_u32 v244, 0x237c0, v244
    v_cmp_gt_u32 vcc, 7, v245
    v_mfma_f32_16x16x32_bf16 v[228:231], a[160:163], a[216:219], v[228:231]
    ds_read_b128 v[200:203], v244 offset:256
    v_add_u32 v245, 0xfffdcf70, v206
    v_mfma_f32_16x16x32_bf16 v[232:235], a[172:175], a[236:239], v[232:235]
    s_waitcnt lgkmcnt(3)
    v_cndmask_b32 v245, 0, v245, vcc
    v_add_u32 v245, 0x237c0, v245
    v_mfma_f32_16x16x32_bf16 v[228:231], a[164:167], a[220:223], v[228:231]
    ds_read_b128 v[208:211], v245 offset:192
    v_add_u32 v246, 8, v207
    v_mfma_f32_16x16x32_bf16 v[232:235], a[176:179], a[240:243], v[232:235]
    v_cmp_gt_u32 vcc, 7, v246
    v_add_u32 v246, 0xfffdd670, v206
    v_mfma_f32_16x16x32_bf16 v[232:235], a[180:183], a[244:247], v[232:235]
    ds_read_b128 v[204:207], v244 offset:192
    v_cndmask_b32 v246, 0, v246, vcc
    v_mfma_f32_16x16x32_bf16 v[232:235], a[184:187], a[216:219], v[232:235]
    v_mul_f32 v228, s38, v228
    v_mul_f32 v229, s38, v229
    v_mfma_f32_16x16x32_bf16 v[232:235], a[188:191], a[220:223], v[232:235]
    v_mul_f32 v230, s38, v230
    v_mul_f32 v231, s38, v231
    v_mfma_f32_16x16x32_bf16 v[236:239], a[192:195], a[232:235], 0
    ds_read_b128 a[232:235], v242 offset:63104
    v_cvt_pk_bf16_f32 v228, v228, v229
    v_mfma_f32_16x16x32_bf16 v[236:239], a[196:199], a[236:239], v[236:239]
    ds_read_b128 a[236:239], v243 offset:63104
    v_cvt_pk_bf16_f32 v229, v230, v231
    v_mfma_f32_16x16x32_bf16 v[236:239], a[200:203], a[240:243], v[236:239]
    ds_write_b64 v247, v[228:229] offset:24576
    v_mfma_f32_16x16x32_bf16 v[236:239], a[204:207], a[244:247], v[236:239]
    ds_read_b128 a[240:243], v242 offset:63232
    v_mul_f32 v232, s3, v232
    v_mfma_f32_16x16x32_bf16 v[236:239], a[208:211], a[216:219], v[236:239]
    ds_read_b128 a[244:247], v243 offset:63232
    v_mul_f32 v233, s3, v233
    v_mfma_f32_16x16x32_bf16 v[236:239], a[212:215], a[220:223], v[236:239]
    ds_read_b128 a[216:219], v242 offset:64512
    v_mul_f32 v234, s3, v234
    v_mfma_f32_16x16x32_bf16 v[228:231], a[144:147], a[224:227], 0
    s_waitcnt lgkmcnt(6)
    v_mul_f32 v235, s3, v235
    v_cvt_pk_bf16_f32 v232, v232, v233
    v_mfma_f32_16x16x32_bf16 v[204:207], v[114:117], v[168:171], v[204:207]
    ds_read_b128 a[220:223], v243 offset:64512
    v_cvt_pk_bf16_f32 v233, v234, v235
    v_mfma_f32_16x16x32_bf16 v[204:207], v[116:119], v[170:173], v[204:207]
    ds_write_b64 v247, v[232:233] offset:24704
    v_mfma_f32_16x16x32_bf16 v[208:211], v[138:141], v[168:171], v[208:211]
    v_mul_f32 v236, s38, v236
    v_mul_f32 v237, s38, v237
    v_mfma_f32_16x16x32_bf16 v[208:211], v[140:143], v[170:173], v[208:211]
    v_mul_f32 v238, s38, v238
    v_mul_f32 v239, s38, v239
    v_mfma_f32_16x16x32_bf16 v[200:203], v[120:123], v[168:171], v[200:203]
    v_cvt_pk_bf16_f32 v236, v236, v237
    v_cvt_pk_bf16_f32 v237, v238, v239
    v_mfma_f32_16x16x32_bf16 v[200:203], v[122:125], v[170:173], v[200:203]
    ds_write_b64 v247, v[236:237] offset:24832
    v_mfma_f32_16x16x32_bf16 v[228:231], a[148:151], a[228:231], v[228:231]
    s_waitcnt lgkmcnt(3)
    v_add_u32 v246, 0x237c0, v246
    v_max_f32 v248, v204, v205
    v_mfma_f32_16x16x32_bf16 v[228:231], a[152:155], a[232:235], v[228:231]
    ds_read_b128 v[196:199], v246 offset:192
    v_max3_f32 v248, v248, v206, v207
    v_mfma_f32_16x16x32_bf16 v[228:231], a[156:159], a[236:239], v[228:231]
    ds_read_b128 v[204:207], v245 offset:256
    v_max3_f32 v248, v248, v208, v209
    v_mfma_f32_16x16x32_bf16 v[228:231], a[160:163], a[240:243], v[228:231]
    v_max3_f32 v248, v248, v210, v211
    v_mov_b32 v191, 0
    v_mfma_f32_16x16x32_bf16 v[228:231], a[164:167], a[244:247], v[228:231]
    ds_read_b128 v[208:211], v246 offset:256
    v_mfma_f32_16x16x32_bf16 v[232:235], a[168:171], a[224:227], 0
    v_mfma_f32_16x16x32_bf16 v[232:235], a[172:175], a[228:231], v[232:235]
    v_mfma_f32_16x16x32_bf16 v[232:235], a[176:179], a[232:235], v[232:235]
    v_mfma_f32_16x16x32_bf16 v[232:235], a[180:183], a[236:239], v[232:235]
    v_mfma_f32_16x16x32_bf16 v[232:235], a[184:187], a[240:243], v[232:235]
    v_mfma_f32_16x16x32_bf16 v[232:235], a[188:191], a[244:247], v[232:235]
    s_waitcnt lgkmcnt(2)
    v_mul_f32 v228, s38, v228
    v_mul_f32 v229, s38, v229
    v_mfma_f32_16x16x32_bf16 v[196:199], v[102:105], v[168:171], v[196:199]
    s_waitcnt lgkmcnt(1)
    v_mul_f32 v230, s38, v230
    v_mul_f32 v231, s38, v231
    v_mfma_f32_16x16x32_bf16 v[196:199], v[104:107], v[170:173], v[196:199]
    v_cvt_pk_bf16_f32 v228, v228, v229
    v_cvt_pk_bf16_f32 v229, v230, v231
    v_mfma_f32_16x16x32_bf16 v[204:207], v[144:147], v[168:171], v[204:207]
    ds_write_b64 v247, v[228:229] offset:30720
    v_mfma_f32_16x16x32_bf16 v[204:207], v[146:149], v[170:173], v[204:207]
    s_waitcnt lgkmcnt(1)
    v_mul_f32 v232, s3, v232
    v_mul_f32 v233, s3, v233
    v_mfma_f32_16x16x32_bf16 v[208:211], v[108:111], v[168:171], v[208:211]
    v_mul_f32 v234, s3, v234
    v_mul_f32 v235, s3, v235
    v_mfma_f32_16x16x32_bf16 v[208:211], v[110:113], v[170:173], v[208:211]
    v_cvt_pk_bf16_f32 v232, v232, v233
    v_cvt_pk_bf16_f32 v233, v234, v235
    v_mfma_f32_16x16x32_bf16 v[236:239], a[192:195], a[224:227], 0
    ds_write_b64 v247, v[232:233] offset:30848
    v_mfma_f32_16x16x32_bf16 v[236:239], a[196:199], a[228:231], v[236:239]
    ds_read_b128 a[224:227], v242 offset:64640
    v_max3_f32 v248, v248, v196, v197
    v_mfma_f32_16x16x32_bf16 v[236:239], a[200:203], a[232:235], v[236:239]
    ds_read_b128 a[228:231], v243 offset:64640
    v_max3_f32 v248, v248, v198, v199
    v_mfma_f32_16x16x32_bf16 v[236:239], a[204:207], a[236:239], v[236:239]
    ds_read_b128 a[232:235], v242 offset:64768
    v_add_u32 v242, 0xf000, v242
    v_mfma_f32_16x16x32_bf16 v[236:239], a[208:211], a[240:243], v[236:239]
    ds_read_b128 a[236:239], v243 offset:64768
    v_add_u32 v243, 0xf000, v243
    v_mfma_f32_16x16x32_bf16 v[236:239], a[212:215], a[244:247], v[236:239]
    ds_read_b128 a[240:243], v242 offset:4608
    v_max3_f32 v248, v248, v200, v201
    v_mfma_f32_16x16x32_bf16 v[228:231], a[144:147], a[216:219], 0
    ds_read_b128 a[244:247], v243 offset:4608
    v_max3_f32 v248, v248, v202, v203
    v_mfma_f32_16x16x32_bf16 v[228:231], a[148:151], a[220:223], v[228:231]
    ds_read_b128 v[196:199], v244 offset:320
    v_max3_f32 v248, v248, v204, v205
    v_mfma_f32_16x16x32_bf16 v[232:235], a[168:171], a[216:219], 0
    ds_read_b128 v[200:203], v245 offset:320
    v_mul_f32 v236, s38, v236
    v_mfma_f32_16x16x32_bf16 v[232:235], a[172:175], a[220:223], v[232:235]
    v_mul_f32 v237, s38, v237
    s_waitcnt lgkmcnt(7)
    v_mfma_f32_16x16x32_bf16 v[228:231], a[152:155], a[224:227], v[228:231]
    v_mul_f32 v238, s38, v238
    v_mul_f32 v239, s38, v239
    v_mfma_f32_16x16x32_bf16 v[232:235], a[176:179], a[224:227], v[232:235]
    s_waitcnt lgkmcnt(6)
    v_cvt_pk_bf16_f32 v236, v236, v237
    v_cvt_pk_bf16_f32 v237, v238, v239
    v_mfma_f32_16x16x32_bf16 v[228:231], a[156:159], a[228:231], v[228:231]
    ds_write_b64 v247, v[236:237] offset:30976
    v_mfma_f32_16x16x32_bf16 v[232:235], a[180:183], a[228:231], v[232:235]
    s_waitcnt lgkmcnt(4)
    v_max3_f32 v248, v248, v206, v207
    v_max3_f32 v248, v248, v208, v209
    v_mfma_f32_16x16x32_bf16 v[228:231], a[160:163], a[232:235], v[228:231]
    ds_read_b128 v[204:207], v246 offset:320
    v_max3_f32 v248, v248, v210, v211
    v_mfma_f32_16x16x32_bf16 v[228:231], a[164:167], a[236:239], v[228:231]
    ds_read_b128 v[208:211], v244 offset:192
    s_waitcnt lgkmcnt(4)
    v_mfma_f32_16x16x32_bf16 v[196:199], v[126:129], v[168:171], v[196:199]
    s_waitcnt lgkmcnt(3)
    v_mfma_f32_16x16x32_bf16 v[196:199], v[128:131], v[170:173], v[196:199]
    v_mfma_f32_16x16x32_bf16 v[200:203], v[150:153], v[168:171], v[200:203]
    v_mfma_f32_16x16x32_bf16 v[200:203], v[152:155], v[170:173], v[200:203]
    v_mfma_f32_16x16x32_bf16 v[232:235], a[184:187], a[232:235], v[232:235]
    v_mul_f32 v228, s38, v228
    v_mul_f32 v229, s38, v229
    v_mfma_f32_16x16x32_bf16 v[232:235], a[188:191], a[236:239], v[232:235]
    v_mul_f32 v230, s38, v230
    v_mul_f32 v231, s38, v231
    v_mfma_f32_16x16x32_bf16 v[236:239], a[192:195], a[216:219], 0
    ds_read_b128 a[216:219], v242 offset:4736
    v_cvt_pk_bf16_f32 v228, v228, v229
    v_mfma_f32_16x16x32_bf16 v[236:239], a[196:199], a[220:223], v[236:239]
    ds_read_b128 a[220:223], v243 offset:4736
    v_cvt_pk_bf16_f32 v229, v230, v231
    v_mfma_f32_16x16x32_bf16 v[236:239], a[200:203], a[224:227], v[236:239]
    ds_write_b64 v247, v[228:229] offset:36864
    v_mfma_f32_16x16x32_bf16 v[236:239], a[204:207], a[228:231], v[236:239]
    ds_read_b128 a[224:227], v242 offset:4864
    v_mul_f32 v232, s3, v232
    v_mfma_f32_16x16x32_bf16 v[236:239], a[208:211], a[232:235], v[236:239]
    ds_read_b128 a[228:231], v243 offset:4864
    v_mul_f32 v233, s3, v233
    v_mfma_f32_16x16x32_bf16 v[236:239], a[212:215], a[236:239], v[236:239]
    ds_read_b128 a[232:235], v240 offset:35328
    v_mul_f32 v234, s3, v234
    v_mfma_f32_16x16x32_bf16 v[228:231], a[144:147], a[240:243], 0
    ds_read_b128 a[236:239], v241 offset:35328
    v_mul_f32 v235, s3, v235
    v_mfma_f32_16x16x32_bf16 v[228:231], a[148:151], a[244:247], v[228:231]
    s_waitcnt lgkmcnt(7)
    v_cvt_pk_bf16_f32 v232, v232, v233
    v_cvt_pk_bf16_f32 v233, v234, v235
    v_mfma_f32_16x16x32_bf16 v[204:207], v[162:165], v[168:171], v[204:207]
    ds_write_b64 v247, v[232:233] offset:36992
    v_mfma_f32_16x16x32_bf16 v[204:207], v[164:167], v[170:173], v[204:207]
    s_waitcnt lgkmcnt(6)
    v_mul_f32 v236, s38, v236
    v_mul_f32 v237, s38, v237
    v_mfma_f32_16x16x32_bf16 v[208:211], v[114:117], v[168:171], v[208:211]
    v_mul_f32 v238, s38, v238
    v_mul_f32 v239, s38, v239
    v_mfma_f32_16x16x32_bf16 v[208:211], v[116:119], v[170:173], v[208:211]
    v_cvt_pk_bf16_f32 v236, v236, v237
    v_cvt_pk_bf16_f32 v237, v238, v239
    v_mfma_f32_16x16x32_bf16 v[228:231], a[152:155], a[216:219], v[228:231]
    ds_write_b64 v247, v[236:237] offset:37120
    v_mfma_f32_16x16x32_bf16 v[228:231], a[156:159], a[220:223], v[228:231]
    s_waitcnt vmcnt(0) lgkmcnt(3)
    v_max3_f32 v248, v248, v196, v197
    v_max3_f32 v248, v248, v200, v201
    v_mfma_f32_16x16x32_bf16 v[228:231], a[160:163], a[224:227], v[228:231]
    ds_read_b128 v[196:199], v245 offset:192
    v_max3_f32 v248, v248, v204, v205
    v_mfma_f32_16x16x32_bf16 v[228:231], a[164:167], a[228:231], v[228:231]
    ds_read_b128 v[200:203], v246 offset:192
    v_mov_b32 v225, v248
    v_mfma_f32_16x16x32_bf16 v[232:235], a[168:171], a[240:243], 0
    ds_read_b128 v[204:207], v244 offset:256
    v_permlane16_swap_b32 v248, v225
    v_mfma_f32_16x16x32_bf16 v[232:235], a[172:175], a[244:247], v[232:235]
    s_barrier
    v_max_f32 v248, v248, v225
    v_mul_f32 v228, s38, v228
    v_mfma_f32_16x16x32_bf16 v[232:235], a[176:179], a[216:219], v[232:235]
    v_mul_f32 v229, s38, v229
    v_mul_f32 v230, s38, v230
    v_mfma_f32_16x16x32_bf16 v[232:235], a[180:183], a[220:223], v[232:235]
    v_mul_f32 v231, s38, v231
    v_cvt_pk_bf16_f32 v228, v228, v229
    v_mfma_f32_16x16x32_bf16 v[232:235], a[184:187], a[224:227], v[232:235]
    v_cvt_pk_bf16_f32 v229, v230, v231
    v_mov_b32 v225, v248
    v_mfma_f32_16x16x32_bf16 v[232:235], a[188:191], a[228:231], v[232:235]
    ds_write_b64 v247, v[228:229] offset:43008
    v_mfma_f32_16x16x32_bf16 v[236:239], a[192:195], a[240:243], 0
    ds_read_b128 a[240:243], v240 offset:35456
    v_permlane32_swap_b32 v248, v225
    v_mfma_f32_16x16x32_bf16 v[236:239], a[196:199], a[244:247], v[236:239]
    ds_read_b128 a[244:247], v241 offset:35456
    v_max_f32 v248, v248, v225
    v_mfma_f32_16x16x32_bf16 v[236:239], a[200:203], a[216:219], v[236:239]
    ds_read_b128 a[216:219], v240 offset:35584
    v_mul_f32 v232, s3, v232
    v_mfma_f32_16x16x32_bf16 v[236:239], a[204:207], a[220:223], v[236:239]
    ds_read_b128 a[220:223], v241 offset:35584
    v_mul_f32 v233, s3, v233
    v_mfma_f32_16x16x32_bf16 v[236:239], a[208:211], a[224:227], v[236:239]
    s_waitcnt lgkmcnt(5)
    v_mul_f32 v234, s3, v234
    v_mul_f32 v235, s3, v235
    v_mfma_f32_16x16x32_bf16 v[196:199], v[138:141], v[168:171], v[196:199]
    v_cvt_pk_bf16_f32 v232, v232, v233
    v_cvt_pk_bf16_f32 v233, v234, v235
    v_mfma_f32_16x16x32_bf16 v[196:199], v[140:143], v[170:173], v[196:199]
    ds_write_b64 v247, v[232:233] offset:43136
    v_mfma_f32_16x16x32_bf16 v[200:203], v[102:105], v[168:171], v[200:203]
    v_sub_f32 v208, v208, v248
    v_sub_f32 v209, v209, v248
    v_mfma_f32_16x16x32_bf16 v[200:203], v[104:107], v[170:173], v[200:203]
    v_exp_f32 v208, v208
    v_mfma_f32_16x16x32_bf16 v[204:207], v[120:123], v[168:171], v[204:207]
    v_exp_f32 v209, v209
    v_mfma_f32_16x16x32_bf16 v[204:207], v[122:125], v[170:173], v[204:207]
    v_sub_f32 v210, v210, v248
    v_sub_f32 v211, v211, v248
    v_mfma_f32_16x16x32_bf16 v[236:239], a[212:215], a[228:231], v[236:239]
    v_exp_f32 v210, v210
    v_mfma_f32_16x16x32_bf16 v[228:231], a[0:3], a[232:235], 0
    v_exp_f32 v211, v211
    v_mfma_f32_16x16x32_bf16 v[228:231], a[4:7], a[236:239], v[228:231]
    s_waitcnt lgkmcnt(1)
    v_cvt_pk_bf16_f32 v193, v208, v209
    v_cvt_pk_bf16_f32 v180, v210, v211
    v_mfma_f32_16x16x32_bf16 v[228:231], a[8:11], a[240:243], v[228:231]
    ds_read_b128 v[208:211], v245 offset:256
    v_mul_f32 v236, s38, v236
    v_mfma_f32_16x16x32_bf16 v[228:231], a[12:15], a[244:247], v[228:231]
    v_mul_f32 v237, s38, v237
    v_mul_f32 v238, s38, v238
    v_mfma_f32_16x16x32_bf16 v[228:231], a[16:19], a[216:219], v[228:231]
    v_mul_f32 v239, s38, v239
    v_cvt_pk_bf16_f32 v236, v236, v237
    v_mfma_f32_16x16x32_bf16 v[228:231], a[20:23], a[220:223], v[228:231]
    v_cvt_pk_bf16_f32 v237, v238, v239
    v_sub_f32 v196, v196, v248
    v_mfma_f32_16x16x32_bf16 v[232:235], a[24:27], a[232:235], 0
    ds_write_b64 v247, v[236:237] offset:43264
    v_mfma_f32_16x16x32_bf16 v[232:235], a[28:31], a[236:239], v[232:235]
    v_exp_f32 v196, v196
    v_mfma_f32_16x16x32_bf16 v[232:235], a[32:35], a[240:243], v[232:235]
    v_sub_f32 v197, v197, v248
    v_cvt_pk_bf16_f32 v114, v228, v229
    v_mfma_f32_16x16x32_bf16 v[232:235], a[36:39], a[244:247], v[232:235]
    v_cvt_pk_bf16_f32 v115, v230, v231
    v_sub_f32 v198, v198, v248
    v_mfma_f32_16x16x32_bf16 v[232:235], a[40:43], a[216:219], v[232:235]
    s_waitcnt lgkmcnt(1)
    v_exp_f32 v197, v197
    v_mfma_f32_16x16x32_bf16 v[208:211], v[144:147], v[168:171], v[208:211]
    v_exp_f32 v198, v198
    v_mfma_f32_16x16x32_bf16 v[208:211], v[146:149], v[170:173], v[208:211]
    v_sub_f32 v199, v199, v248
    v_cvt_pk_bf16_f32 v194, v196, v197
    v_mfma_f32_16x16x32_bf16 v[232:235], a[44:47], a[220:223], v[232:235]
    v_exp_f32 v199, v199
    v_mfma_f32_16x16x32_bf16 v[236:239], a[48:51], a[232:235], 0
    v_cvt_pk_bf16_f32 v181, v198, v199
    v_sub_f32 v200, v200, v248
    v_mfma_f32_16x16x32_bf16 v[236:239], a[52:55], a[236:239], v[236:239]
    ds_read_b128 v[196:199], v246 offset:256
    v_sub_f32 v201, v201, v248
    v_mfma_f32_16x16x32_bf16 v[236:239], a[56:59], a[240:243], v[236:239]
    v_cvt_pk_bf16_f32 v116, v232, v233
    v_cvt_pk_bf16_f32 v117, v234, v235
    v_mfma_f32_16x16x32_bf16 v[236:239], a[60:63], a[244:247], v[236:239]
    v_exp_f32 v200, v200
    v_mfma_f32_16x16x32_bf16 v[236:239], a[64:67], a[216:219], v[236:239]
    v_exp_f32 v201, v201
    v_mfma_f32_16x16x32_bf16 v[236:239], a[68:71], a[220:223], v[236:239]
    v_sub_f32 v202, v202, v248
    v_sub_f32 v203, v203, v248
    v_mfma_f32_16x16x32_bf16 v[228:231], a[232:235], a[72:75], 0
    v_exp_f32 v202, v202
    v_mfma_f32_16x16x32_bf16 v[228:231], a[236:239], a[76:79], v[228:231]
    v_exp_f32 v203, v203
    v_mfma_f32_16x16x32_bf16 v[228:231], a[240:243], a[80:83], v[228:231]
    v_cvt_pk_bf16_f32 v192, v200, v201
    v_cvt_pk_bf16_f32 v118, v236, v237
    v_mfma_f32_16x16x32_bf16 v[228:231], a[244:247], a[84:87], v[228:231]
    v_cvt_pk_bf16_f32 v119, v238, v239
    v_cvt_pk_bf16_f32 v195, v202, v203
    v_mfma_f32_16x16x32_bf16 v[228:231], a[216:219], a[88:91], v[228:231]
    ds_read_b128 v[200:203], v244 offset:320
    v_sub_f32 v204, v204, v248
    v_mfma_f32_16x16x32_bf16 v[212:215], v[0:3], v[192:195], 0
    s_waitcnt lgkmcnt(1)
    v_exp_f32 v204, v204
    v_mfma_f32_16x16x32_bf16 v[216:219], v[30:33], v[192:195], 0
    v_sub_f32 v205, v205, v248
    v_sub_f32 v206, v206, v248
    v_mfma_f32_16x16x32_bf16 v[220:223], v[60:63], v[192:195], 0
    v_exp_f32 v205, v205
    v_mfma_f32_16x16x32_bf16 v[224:227], a[248:251], v[192:195], 0
    v_exp_f32 v206, v206
    v_mfma_f32_16x16x32_bf16 v[196:199], v[108:111], v[168:171], v[196:199]
    v_sub_f32 v207, v207, v248
    v_cvt_pk_bf16_f32 v183, v204, v205
    v_mfma_f32_16x16x32_bf16 v[196:199], v[110:113], v[170:173], v[196:199]
    v_exp_f32 v207, v207
    v_mfma_f32_16x16x32_bf16 v[228:231], a[220:223], a[92:95], v[228:231]
    v_cvt_pk_bf16_f32 v186, v206, v207
    v_sub_f32 v208, v208, v248
    v_mfma_f32_16x16x32_bf16 v[232:235], a[232:235], a[96:99], 0
    ds_read_b128 v[204:207], v245 offset:320
    v_sub_f32 v209, v209, v248
    v_mfma_f32_16x16x32_bf16 v[232:235], a[236:239], a[100:103], v[232:235]
    s_waitcnt lgkmcnt(1)
    v_exp_f32 v208, v208
    v_mfma_f32_16x16x32_bf16 v[200:203], v[126:129], v[168:171], v[200:203]
    v_cvt_pk_bf16_f32 v18, v228, v229
    v_cvt_pk_bf16_f32 v21, v230, v231
    v_mfma_f32_16x16x32_bf16 v[200:203], v[128:131], v[170:173], v[200:203]
    v_exp_f32 v209, v209
    v_mfma_f32_16x16x32_bf16 v[232:235], a[240:243], a[104:107], v[232:235]
    v_sub_f32 v210, v210, v248
    v_sub_f32 v211, v211, v248
    v_mfma_f32_16x16x32_bf16 v[232:235], a[244:247], a[108:111], v[232:235]
    v_exp_f32 v210, v210
    v_mfma_f32_16x16x32_bf16 v[232:235], a[216:219], a[112:115], v[232:235]
    v_exp_f32 v211, v211
    v_mfma_f32_16x16x32_bf16 v[232:235], a[220:223], a[116:119], v[232:235]
    v_cvt_pk_bf16_f32 v184, v208, v209
    v_cvt_pk_bf16_f32 v187, v210, v211
    v_mfma_f32_16x16x32_bf16 v[236:239], a[232:235], a[120:123], 0
    ds_read_b128 v[208:211], v246 offset:320
    v_sub_f32 v196, v196, v248
    v_mfma_f32_16x16x32_bf16 v[236:239], a[236:239], a[124:127], v[236:239]
    s_waitcnt lgkmcnt(1)
    v_exp_f32 v196, v196
    v_mfma_f32_16x16x32_bf16 v[204:207], v[150:153], v[168:171], v[204:207]
    v_cvt_pk_bf16_f32 v48, v232, v233
    v_cvt_pk_bf16_f32 v51, v234, v235
    v_mfma_f32_16x16x32_bf16 v[204:207], v[152:155], v[170:173], v[204:207]
    v_sub_f32 v197, v197, v248
    v_sub_f32 v198, v198, v248
    v_mfma_f32_16x16x32_bf16 v[236:239], a[240:243], a[128:131], v[236:239]
    v_exp_f32 v197, v197
    v_mfma_f32_16x16x32_bf16 v[236:239], a[244:247], a[132:135], v[236:239]
    v_exp_f32 v198, v198
    v_mfma_f32_16x16x32_bf16 v[236:239], a[216:219], a[136:139], v[236:239]
    v_sub_f32 v199, v199, v248
    v_cvt_pk_bf16_f32 v182, v196, v197
    v_mfma_f32_16x16x32_bf16 v[236:239], a[220:223], a[140:143], v[236:239]
    v_exp_f32 v199, v199
    v_mfma_f32_16x16x32_bf16 v[212:215], v[4:7], v[180:183], v[212:215]
    v_cvt_pk_bf16_f32 v185, v198, v199
    v_sub_f32 v200, v200, v248
    v_mfma_f32_16x16x32_bf16 v[216:219], v[34:37], v[180:183], v[216:219]
    ds_read_b128 v[196:199], v244 offset:0
    v_sub_f32 v201, v201, v248
    v_mfma_f32_16x16x32_bf16 v[220:223], v[64:67], v[180:183], v[220:223]
    s_waitcnt lgkmcnt(1)
    v_cvt_pk_bf16_f32 v78, v236, v237
    v_cvt_pk_bf16_f32 v81, v238, v239
    v_mfma_f32_16x16x32_bf16 v[224:227], a[248:251], v[180:183], v[224:227]
    v_exp_f32 v200, v200
    v_mfma_f32_16x16x32_bf16 v[212:215], v[8:11], v[184:187], v[212:215]
    v_exp_f32 v201, v201
    v_mfma_f32_16x16x32_bf16 v[216:219], v[38:41], v[184:187], v[216:219]
    v_cvt_pk_bf16_f32 v189, v200, v201
    v_sub_f32 v204, v204, v248
    v_mfma_f32_16x16x32_bf16 v[220:223], v[68:71], v[184:187], v[220:223]
    ds_read_b128 v[200:203], v245 offset:0
    v_sub_f32 v205, v205, v248
    v_mfma_f32_16x16x32_bf16 v[224:227], a[248:251], v[184:187], v[224:227]
    v_exp_f32 v204, v204
    v_mfma_f32_16x16x32_bf16 v[208:211], v[162:165], v[168:171], v[208:211]
    ds_read_b64 v[168:169], v247 offset:18432
    v_mbcnt_lo_u32_b32 v228, -1, 0
    v_mfma_f32_16x16x32_bf16 v[208:211], v[164:167], v[170:173], v[208:211]
    ds_read_b64 v[170:171], v247 offset:18560
    s_waitcnt lgkmcnt(3)
    v_mfma_f32_16x16x32_bf16 v[196:199], v[120:123], v[174:177], v[196:199]
    ds_read_b64 v[172:173], v247 offset:18688
    v_mbcnt_hi_u32_b32 v228, -1, v228
    v_mfma_f32_16x16x32_bf16 v[196:199], v[122:125], v[176:179], v[196:199]
    v_exp_f32 v205, v205
    v_lshrrev_b32 v229, 4, v228
    v_cvt_pk_bf16_f32 v190, v204, v205
    ds_read_b128 v[204:207], v246 offset:0
    v_sub_f32 v208, v208, v248
    v_exp_f32 v208, v208
    v_sub_f32 v209, v209, v248
    v_exp_f32 v209, v209
    v_bfe_u32 v230, v228, 2, 1
    v_cvt_pk_bf16_f32 v188, v208, v209
    s_waitcnt lgkmcnt(4)
    v_mfma_f32_16x16x32_bf16 v[200:203], v[144:147], v[174:177], v[200:203]
    ds_read_b128 v[208:211], v244 offset:64
    v_add_u32 v230, 15, v230
    v_mfma_f32_16x16x32_bf16 v[212:215], v[12:15], v[188:191], v[212:215]
    v_and_b32 v230, 15, v230
    v_bfe_u32 v231, v228, 3, 1
    v_mfma_f32_16x16x32_bf16 v[216:219], v[42:45], v[188:191], v[216:219]
    v_and_b32 v228, 3, v228
    v_lshl_add_u32 v228, v231, 2, v228
    v_mfma_f32_16x16x32_bf16 v[220:223], v[72:75], v[188:191], v[220:223]
    v_add_u32 v228, 3, v228
    v_and_b32 v231, 3, v230
    v_mfma_f32_16x16x32_bf16 v[224:227], a[248:251], v[188:191], v[224:227]
    v_mul_u32_u24 v230, 0x1e00, v230
    v_lshlrev_b32 v231, 1, v231
    v_mfma_f32_16x16x32_bf16 v[200:203], v[146:149], v[176:179], v[200:203]
    v_bfe_u32 v243, v228, 1, 1
    s_waitcnt lgkmcnt(1)
    v_mfma_f32_16x16x32_bf16 v[204:207], v[108:111], v[174:177], v[204:207]
    v_or_b32 v231, v231, v243
    v_xor_b32 v231, v231, v229
    v_mfma_f32_16x16x32_bf16 v[204:207], v[110:113], v[176:179], v[204:207]
    v_rcp_f32 v225, v224
    v_lshl_add_u32 v230, v231, 4, v230
    v_mul_f32 v212, v212, v225
    v_mul_f32 v213, v213, v225
    v_mul_f32 v214, v214, v225
    v_mul_f32 v215, v215, v225
    v_cvt_pk_bf16_f32 v212, v212, v213
    v_cvt_pk_bf16_f32 v213, v214, v215
    ds_write_b64 v247, v[212:213] offset:6144
    v_mul_f32 v216, v216, v225
    v_mul_f32 v217, v217, v225
    v_mul_f32 v218, v218, v225
    v_mul_f32 v219, v219, v225
    v_cvt_pk_bf16_f32 v216, v216, v217
    v_cvt_pk_bf16_f32 v217, v218, v219
    ds_write_b64 v247, v[216:217] offset:6272
    v_mul_f32 v220, v220, v225
    v_mul_f32 v221, v221, v225
    v_mul_f32 v222, v222, v225
    v_mul_f32 v223, v223, v225
    v_cvt_pk_bf16_f32 v220, v220, v221
    v_cvt_pk_bf16_f32 v221, v222, v223
    ds_write_b64 v247, v[220:221] offset:6400
    v_mul_u32_u24 v231, 0x180, v228
    v_add_u32 v242, v230, v231
    ds_read_b128 a[224:227], v242 offset:0
    ds_read_b128 a[232:235], v242 offset:128
    ds_read_b128 a[240:243], v242 offset:256
    ds_read_b128 a[216:219], v242 offset:3072
    v_xor_b32 v243, 64, v242
    ds_read_b128 a[228:231], v243 offset:0
    ds_read_b128 a[236:239], v243 offset:128
    ds_read_b128 a[244:247], v243 offset:256
    ds_read_b128 a[220:223], v243 offset:3072
    v_max_f32 v248, v196, v197
    v_max3_f32 v248, v248, v198, v199
    ds_read_b128 v[196:199], v245 offset:64
    v_max3_f32 v248, v248, v200, v201
    v_max3_f32 v248, v248, v202, v203
    ds_read_b128 v[200:203], v246 offset:64
    v_max3_f32 v248, v248, v204, v205
    v_max3_f32 v248, v248, v206, v207
    ds_read_b128 v[204:207], v244 offset:128
    s_waitcnt lgkmcnt(11)
    v_mfma_f32_16x16x32_bf16 v[208:211], v[126:129], v[174:177], v[208:211]
    v_mfma_f32_16x16x32_bf16 v[208:211], v[128:131], v[176:179], v[208:211]
    s_waitcnt lgkmcnt(10)
    v_mfma_f32_16x16x32_bf16 v[232:235], a[144:147], a[224:227], 0
    v_mfma_f32_16x16x32_bf16 v[236:239], a[168:171], a[224:227], 0
    v_mfma_f32_16x16x32_bf16 v[228:231], a[192:195], a[224:227], 0
    ds_read_b128 a[224:227], v242 offset:3200
    s_waitcnt lgkmcnt(7)
    v_mfma_f32_16x16x32_bf16 v[232:235], a[148:151], a[228:231], v[232:235]
    v_mfma_f32_16x16x32_bf16 v[232:235], a[152:155], a[232:235], v[232:235]
    s_waitcnt lgkmcnt(6)
    v_max3_f32 v248, v248, v208, v209
    v_max3_f32 v248, v248, v210, v211
    v_mfma_f32_16x16x32_bf16 v[232:235], a[156:159], a[236:239], v[232:235]
    ds_read_b128 v[208:211], v245 offset:128
    v_mfma_f32_16x16x32_bf16 v[232:235], a[160:163], a[240:243], v[232:235]
    s_waitcnt lgkmcnt(5)
    v_mfma_f32_16x16x32_bf16 v[232:235], a[164:167], a[244:247], v[232:235]
    s_waitcnt lgkmcnt(4)
    v_mfma_f32_16x16x32_bf16 v[196:199], v[150:153], v[174:177], v[196:199]
    s_waitcnt lgkmcnt(3)
    v_mfma_f32_16x16x32_bf16 v[196:199], v[152:155], v[176:179], v[196:199]
    s_waitcnt lgkmcnt(2)
    v_mfma_f32_16x16x32_bf16 v[200:203], v[162:165], v[174:177], v[200:203]
    v_mfma_f32_16x16x32_bf16 v[200:203], v[164:167], v[176:179], v[200:203]
    v_mfma_f32_16x16x32_bf16 v[204:207], v[132:135], v[174:177], v[204:207]
    v_mul_f32 v232, s38, v232
    v_mul_f32 v233, s38, v233
    v_mfma_f32_16x16x32_bf16 v[204:207], v[134:137], v[176:179], v[204:207]
    v_mul_f32 v234, s38, v234
    v_mul_f32 v235, s38, v235
    v_mfma_f32_16x16x32_bf16 v[236:239], a[172:175], a[228:231], v[236:239]
    s_waitcnt lgkmcnt(0)
    v_cvt_pk_bf16_f32 v232, v232, v233
    v_cvt_pk_bf16_f32 v233, v234, v235
    v_mfma_f32_16x16x32_bf16 v[208:211], v[156:159], v[174:177], v[208:211]
    ds_write_b64 v247, v[232:233] offset:49152
    v_mfma_f32_16x16x32_bf16 v[208:211], v[158:161], v[176:179], v[208:211]
    v_max3_f32 v248, v248, v196, v197
    v_max3_f32 v248, v248, v198, v199
    v_mfma_f32_16x16x32_bf16 v[236:239], a[176:179], a[232:235], v[236:239]
    ds_read_b128 v[196:199], v246 offset:128
    v_max3_f32 v248, v248, v200, v201
    v_mfma_f32_16x16x32_bf16 v[236:239], a[180:183], a[236:239], v[236:239]
    v_max3_f32 v248, v248, v202, v203
    v_max3_f32 v248, v248, v204, v205
    v_mfma_f32_16x16x32_bf16 v[236:239], a[184:187], a[240:243], v[236:239]
    ds_read_b128 v[200:203], v244 offset:0
    v_max3_f32 v248, v248, v208, v209
    v_mfma_f32_16x16x32_bf16 v[236:239], a[188:191], a[244:247], v[236:239]
    ds_read_b128 v[204:207], v245 offset:0
    v_mfma_f32_16x16x32_bf16 v[228:231], a[196:199], a[228:231], v[228:231]
    ds_read_b128 a[228:231], v243 offset:3200
    v_mfma_f32_16x16x32_bf16 v[228:231], a[200:203], a[232:235], v[228:231]
    ds_read_b128 a[232:235], v242 offset:3328
    v_mfma_f32_16x16x32_bf16 v[228:231], a[204:207], a[236:239], v[228:231]
    ds_read_b128 a[236:239], v243 offset:3328
    v_mfma_f32_16x16x32_bf16 v[228:231], a[208:211], a[240:243], v[228:231]
    ds_read_b128 a[240:243], v240 offset:36864
    v_mul_f32 v236, s3, v236
    v_mfma_f32_16x16x32_bf16 v[228:231], a[212:215], a[244:247], v[228:231]
    ds_read_b128 a[244:247], v241 offset:36864
    v_mul_f32 v237, s3, v237
    v_mfma_f32_16x16x32_bf16 v[232:235], a[144:147], a[216:219], 0
    ds_read_b128 v[208:211], v246 offset:0
    v_mul_f32 v238, s3, v238
    v_mfma_f32_16x16x32_bf16 v[232:235], a[148:151], a[220:223], v[232:235]
    buffer_load_dwordx4 a[144:147], v254, s[24:27], s54 offen
    v_mul_f32 v239, s3, v239
    v_mfma_f32_16x16x32_bf16 v[232:235], a[152:155], a[224:227], v[232:235]
    s_waitcnt lgkmcnt(7)
    v_cvt_pk_bf16_f32 v236, v236, v237
    v_cvt_pk_bf16_f32 v237, v238, v239
    v_mfma_f32_16x16x32_bf16 v[196:199], v[114:117], v[174:177], v[196:199]
    ds_write_b64 v247, v[236:237] offset:49280
    v_mfma_f32_16x16x32_bf16 v[196:199], v[116:119], v[176:179], v[196:199]
    s_mov_b32 s54, 0x2000
    v_mul_f32 v228, s38, v228
    v_mul_f32 v229, s38, v229
    v_mfma_f32_16x16x32_bf16 v[200:203], v[120:123], v[174:177], v[200:203]
    buffer_load_dwordx4 a[148:151], v254, s[24:27], s55 offen offset:1024
    v_mul_f32 v230, s38, v230
    v_mfma_f32_16x16x32_bf16 v[200:203], v[122:125], v[176:179], v[200:203]
    s_mov_b32 s55, 0x2000
    v_mul_f32 v231, s38, v231
    v_cvt_pk_bf16_f32 v228, v228, v229
    v_mfma_f32_16x16x32_bf16 v[236:239], a[168:171], a[216:219], 0
    s_waitcnt lgkmcnt(2)
    v_cvt_pk_bf16_f32 v229, v230, v231
    v_max3_f32 v248, v248, v196, v197
    v_mfma_f32_16x16x32_bf16 v[204:207], v[144:147], v[174:177], v[204:207]
    ds_write_b64 v247, v[228:229] offset:49408
    v_mfma_f32_16x16x32_bf16 v[204:207], v[146:149], v[176:179], v[204:207]
    ds_read_b128 v[196:199], v244 offset:64
    v_mov_b32 v225, v248
    v_mfma_f32_16x16x32_bf16 v[232:235], a[156:159], a[228:231], v[232:235]
    buffer_load_dwordx4 a[152:155], v254, s[24:27], s56 offen offset:2048
    v_permlane16_swap_b32 v248, v225
    v_mfma_f32_16x16x32_bf16 v[232:235], a[160:163], a[232:235], v[232:235]
    s_mov_b32 s56, 0x3000
    v_max_f32 v248, v248, v225
    v_mov_b32 v225, v248
    v_mfma_f32_16x16x32_bf16 v[232:235], a[164:167], a[236:239], v[232:235]
    s_waitcnt lgkmcnt(2)
    v_permlane32_swap_b32 v248, v225
    v_max_f32 v248, v248, v225
    v_mfma_f32_16x16x32_bf16 v[208:211], v[108:111], v[174:177], v[208:211]
    v_sub_f32 v200, v200, v248
    v_sub_f32 v201, v201, v248
    v_mfma_f32_16x16x32_bf16 v[208:211], v[110:113], v[176:179], v[208:211]
    v_exp_f32 v200, v200
    v_mfma_f32_16x16x32_bf16 v[236:239], a[172:175], a[220:223], v[236:239]
    buffer_load_dwordx4 a[156:159], v254, s[24:27], s57 offen offset:3072
    v_mul_f32 v232, s38, v232
    v_mfma_f32_16x16x32_bf16 v[236:239], a[176:179], a[224:227], v[236:239]
    s_mov_b32 s57, 0x3000
    v_mul_f32 v233, s38, v233
    v_mul_f32 v234, s38, v234
    v_mfma_f32_16x16x32_bf16 v[236:239], a[180:183], a[228:231], v[236:239]
    v_mul_f32 v235, s38, v235
    v_cvt_pk_bf16_f32 v232, v232, v233
    v_mfma_f32_16x16x32_bf16 v[236:239], a[184:187], a[232:235], v[236:239]
    s_waitcnt lgkmcnt(0)
    v_cvt_pk_bf16_f32 v233, v234, v235
    v_sub_f32 v202, v202, v248
    v_mfma_f32_16x16x32_bf16 v[196:199], v[126:129], v[174:177], v[196:199]
    ds_write_b64 v247, v[232:233] offset:55296
    v_mfma_f32_16x16x32_bf16 v[196:199], v[128:131], v[176:179], v[196:199]
    buffer_load_dwordx4 a[160:163], v254, s[24:27], s58 offen
    v_mbcnt_lo_u32_b32 v232, -1, 0
    v_mfma_f32_16x16x32_bf16 v[236:239], a[188:191], a[236:239], v[236:239]
    s_mov_b32 s58, 0x3000
    v_mbcnt_hi_u32_b32 v232, -1, v232
    v_and_b32 v233, 15, v232
    v_mfma_f32_16x16x32_bf16 v[228:231], a[192:195], a[216:219], 0
    ds_read_b128 a[216:219], v240 offset:36992
    v_lshrrev_b32 v232, 4, v232
    v_mfma_f32_16x16x32_bf16 v[228:231], a[196:199], a[220:223], v[228:231]
    ds_read_b128 a[220:223], v241 offset:36992
    v_mul_f32 v236, s3, v236
    v_mfma_f32_16x16x32_bf16 v[228:231], a[200:203], a[224:227], v[228:231]
    ds_read_b128 a[224:227], v240 offset:37120
    v_mul_f32 v237, s3, v237
    v_mfma_f32_16x16x32_bf16 v[228:231], a[204:207], a[228:231], v[228:231]
    ds_read_b128 a[228:231], v241 offset:37120
    v_mul_f32 v238, s3, v238
    v_mfma_f32_16x16x32_bf16 v[228:231], a[208:211], a[232:235], v[228:231]
    buffer_load_dwordx4 a[164:167], v254, s[24:27], s59 offen offset:1024
    v_mul_f32 v239, s3, v239
    v_mfma_f32_16x16x32_bf16 v[228:231], a[212:215], a[236:239], v[228:231]
    s_mov_b32 s59, 0x3000
    v_cvt_pk_bf16_f32 v236, v236, v237
    v_cvt_pk_bf16_f32 v237, v238, v239
    ds_write_b64 v247, v[236:237] offset:55424
    v_mfma_f32_16x16x32_bf16 v[236:239], a[0:3], a[240:243], 0
    v_add_u32 v240, 0xffff1000, v240
    v_add_u32 v241, 0xffff1000, v241
    v_mfma_f32_16x16x32_bf16 v[236:239], a[4:7], a[244:247], v[236:239]
    s_waitcnt lgkmcnt(4)
    v_mul_f32 v228, s38, v228
    v_mul_f32 v229, s38, v229
    v_mfma_f32_16x16x32_bf16 v[236:239], a[8:11], a[216:219], v[236:239]
    s_waitcnt lgkmcnt(3)
    v_mul_f32 v230, s38, v230
    v_mul_f32 v231, s38, v231
    v_mfma_f32_16x16x32_bf16 v[236:239], a[12:15], a[220:223], v[236:239]
    s_waitcnt lgkmcnt(2)
    v_cvt_pk_bf16_f32 v228, v228, v229
    v_cvt_pk_bf16_f32 v229, v230, v231
    v_mfma_f32_16x16x32_bf16 v[236:239], a[16:19], a[224:227], v[236:239]
    s_waitcnt lgkmcnt(1)
    v_lshrrev_b32 v234, 1, v233
    v_mul_u32_u24 v235, 0x180, v233
    v_mfma_f32_16x16x32_bf16 v[236:239], a[20:23], a[228:231], v[236:239]
    ds_write_b64 v247, v[228:229] offset:55552
    v_mfma_f32_16x16x32_bf16 v[228:231], a[24:27], a[240:243], 0
    buffer_load_dwordx4 a[168:171], v254, s[24:27], s50 offen offset:2048
    v_xor_b32 v243, v232, v234
    v_mfma_f32_16x16x32_bf16 v[228:231], a[28:31], a[244:247], v[228:231]
    s_mov_b32 s50, 0x4000
    v_lshl_add_u32 v242, v243, 4, v235
    v_xor_b32 v243, 64, v242
    v_mfma_f32_16x16x32_bf16 v[228:231], a[32:35], a[216:219], v[228:231]
    v_cvt_pk_bf16_f32 v120, v236, v237
    v_cvt_pk_bf16_f32 v121, v238, v239
    v_mfma_f32_16x16x32_bf16 v[228:231], a[36:39], a[220:223], v[228:231]
    v_add_u32 v242, 0x1e000, v242
    v_add_u32 v243, 0x1e000, v243
    v_mfma_f32_16x16x32_bf16 v[228:231], a[40:43], a[224:227], v[228:231]
    ds_read_b128 a[232:235], v242 offset:0
    v_lshrrev_b32 v249, 1, v232
    v_mfma_f32_16x16x32_bf16 v[228:231], a[44:47], a[228:231], v[228:231]
    ds_read_b128 a[236:239], v243 offset:0
    v_or_b32 v249, s66, v249
    v_mfma_f32_16x16x32_bf16 v[236:239], a[240:243], a[72:75], 0
    buffer_load_dwordx4 a[172:175], v254, s[24:27], s51 offen offset:3072
    v_mov_b32 v253, v249
    v_mfma_f32_16x16x32_bf16 v[236:239], a[244:247], a[76:79], v[236:239]
    s_mov_b32 s51, 0x4000
    v_xor_b32 v249, v249, v234
    v_cvt_pk_bf16_f32 v122, v228, v229
    v_mfma_f32_16x16x32_bf16 v[236:239], a[216:219], a[80:83], v[236:239]
    v_cvt_pk_bf16_f32 v123, v230, v231
    v_lshl_add_u32 v249, v249, 4, v235
    v_mfma_f32_16x16x32_bf16 v[236:239], a[220:223], a[84:87], v[236:239]
    v_and_b32 v235, 1, v232
    v_lshl_add_u32 v249, v235, 3, v249
    v_mfma_f32_16x16x32_bf16 v[236:239], a[224:227], a[88:91], v[236:239]
    v_add_u32 v249, 0x1e000, v249
    v_mul_u32_u24 v232, 0x180, v232
    v_mfma_f32_16x16x32_bf16 v[236:239], a[228:231], a[92:95], v[236:239]
    buffer_load_dwordx4 a[176:179], v254, s[24:27], s52 offen
    v_add_u32 v232, s67, v232
    v_mfma_f32_16x16x32_bf16 v[228:231], a[240:243], a[96:99], 0
    s_add_u32 s52, s28, 3
    v_lshlrev_b32 v235, 3, v235
    v_xor_b32 v252, v233, v235
    v_mfma_f32_16x16x32_bf16 v[228:231], a[244:247], a[100:103], v[228:231]
    s_mul_i32 s52, s52, s30
    v_cvt_pk_bf16_f32 v24, v236, v237
    v_cvt_pk_bf16_f32 v27, v238, v239
    v_mfma_f32_16x16x32_bf16 v[228:231], a[216:219], a[104:107], v[228:231]
    v_xor_b32 v252, v252, v253
    v_lshl_add_u32 v252, v252, 4, v232
    v_mfma_f32_16x16x32_bf16 v[228:231], a[220:223], a[108:111], v[228:231]
    s_waitcnt vmcnt(8) lgkmcnt(0)
    v_add_u32 v252, 0x1e000, v252
    v_xor_b32 v253, v253, v234
    v_mfma_f32_16x16x32_bf16 v[228:231], a[224:227], a[112:115], v[228:231]
    buffer_load_dwordx4 a[180:183], v254, s[24:27], s53 offen offset:1024
    v_lshl_add_u32 v253, v253, 4, v232
    v_mfma_f32_16x16x32_bf16 v[228:231], a[228:231], a[116:119], v[228:231]
    s_mov_b32 s53, 3
    v_and_b32 v233, 1, v233
    v_lshl_add_u32 v253, v233, 3, v253
    v_mfma_f32_16x16x32_bf16 v[232:235], a[48:51], a[240:243], 0
    s_mul_i32 s53, s53, s31
    v_add_u32 v253, 0x1e000, v253
    v_sub_f32 v203, v203, v248
    v_mfma_f32_16x16x32_bf16 v[232:235], a[52:55], a[244:247], v[232:235]
    s_add_u32 s52, s52, s53
    v_cvt_pk_bf16_f32 v54, v228, v229
    v_cvt_pk_bf16_f32 v57, v230, v231
    v_mfma_f32_16x16x32_bf16 v[232:235], a[56:59], a[216:219], v[232:235]
    s_add_u32 s52, s52, s32
    v_exp_f32 v201, v201
    v_mfma_f32_16x16x32_bf16 v[232:235], a[60:63], a[220:223], v[232:235]
    buffer_load_dwordx4 a[184:187], v254, s[24:27], s54 offen offset:2048
    v_cvt_pk_bf16_f32 v193, v200, v201
    v_mfma_f32_16x16x32_bf16 v[232:235], a[64:67], a[224:227], v[232:235]
    s_mul_i32 s54, s30, 0
    v_exp_f32 v202, v202
    v_mfma_f32_16x16x32_bf16 v[232:235], a[68:71], a[228:231], v[232:235]
    s_mul_i32 s53, s31, 4
    v_exp_f32 v203, v203
    v_mfma_f32_16x16x32_bf16 v[236:239], a[144:147], a[232:235], 0
    s_waitcnt vmcnt(9)
    v_cvt_pk_bf16_f32 v180, v202, v203
    v_sub_f32 v204, v204, v248
    v_mfma_f32_16x16x32_bf16 v[236:239], a[148:151], a[236:239], v[236:239]
    ds_read_b128 v[200:203], v245 offset:64
    v_cvt_pk_bf16_f32 v124, v232, v233
    v_cvt_pk_bf16_f32 v125, v234, v235
    v_mfma_f32_16x16x32_bf16 v[232:235], a[240:243], a[120:123], 0
    ds_read_b128 a[240:243], v242 offset:128
    v_sub_f32 v205, v205, v248
    v_mfma_f32_16x16x32_bf16 v[232:235], a[244:247], a[124:127], v[232:235]
    ds_read_b128 a[244:247], v243 offset:128
    v_sub_f32 v206, v206, v248
    v_mfma_f32_16x16x32_bf16 v[232:235], a[216:219], a[128:131], v[232:235]
    ds_read_b128 a[216:219], v242 offset:256
    v_sub_f32 v207, v207, v248
    v_mfma_f32_16x16x32_bf16 v[232:235], a[220:223], a[132:135], v[232:235]
    ds_read_b128 a[220:223], v243 offset:256
    v_sub_f32 v208, v208, v248
    v_mfma_f32_16x16x32_bf16 v[232:235], a[224:227], a[136:139], v[232:235]
    buffer_load_dwordx4 a[188:191], v254, s[24:27], s55 offen offset:3072
    v_sub_f32 v209, v209, v248
    v_mfma_f32_16x16x32_bf16 v[232:235], a[228:231], a[140:143], v[232:235]
    s_mul_i32 s55, s31, 4
    v_exp_f32 v204, v204
    v_exp_f32 v205, v205
    v_exp_f32 v206, v206
    v_exp_f32 v207, v207
    v_cvt_pk_bf16_f32 v194, v204, v205
    v_cvt_pk_bf16_f32 v181, v206, v207
    ds_read_b128 v[204:207], v246 offset:64
    v_cvt_pk_bf16_f32 v84, v232, v233
    v_cvt_pk_bf16_f32 v87, v234, v235
    buffer_load_dwordx4 a[192:195], v254, s[24:27], s56 offen
    v_exp_f32 v208, v208
    v_exp_f32 v209, v209
    v_sub_f32 v210, v210, v248
    v_exp_f32 v210, v210
    v_sub_f32 v211, v211, v248
    v_exp_f32 v211, v211
    v_cvt_pk_bf16_f32 v192, v208, v209
    v_cvt_pk_bf16_f32 v195, v210, v211
    s_waitcnt vmcnt(10) lgkmcnt(1)
    v_mfma_f32_16x16x32_bf16 v[200:203], v[150:153], v[174:177], v[200:203]
    ds_read_b128 v[208:211], v244 offset:128
    v_sub_f32 v196, v196, v248
    v_mfma_f32_16x16x32_bf16 v[212:215], v[6:9], v[192:195], 0
    buffer_load_dwordx4 a[196:199], v254, s[24:27], s57 offen offset:1024
    v_sub_f32 v197, v197, v248
    v_mfma_f32_16x16x32_bf16 v[216:219], v[36:39], v[192:195], 0
    s_barrier
    v_exp_f32 v196, v196
    v_mfma_f32_16x16x32_bf16 v[220:223], v[66:69], v[192:195], 0
    ds_read_b128 a[224:227], v242 offset:6144
    v_sub_f32 v198, v198, v248
    v_mfma_f32_16x16x32_bf16 v[224:227], a[248:251], v[192:195], 0
    ds_read_b128 a[228:231], v243 offset:6144
    v_sub_f32 v199, v199, v248
    v_mfma_f32_16x16x32_bf16 v[200:203], v[152:155], v[176:179], v[200:203]
    s_add_u32 s54, s54, s55
    v_exp_f32 v197, v197
    v_mfma_f32_16x16x32_bf16 v[236:239], a[152:155], a[240:243], v[236:239]
    s_waitcnt vmcnt(10) lgkmcnt(3)
    v_exp_f32 v198, v198
    v_mfma_f32_16x16x32_bf16 v[204:207], v[162:165], v[174:177], v[204:207]
    buffer_load_dwordx4 a[200:203], v254, s[24:27], s58 offen offset:2048
    v_cvt_pk_bf16_f32 v183, v196, v197
    v_mfma_f32_16x16x32_bf16 v[204:207], v[164:167], v[176:179], v[204:207]
    s_mul_i32 s56, s30, 0
    v_exp_f32 v199, v199
    v_mfma_f32_16x16x32_bf16 v[236:239], a[156:159], a[244:247], v[236:239]
    s_waitcnt vmcnt(10) lgkmcnt(2)
    v_cvt_pk_bf16_f32 v186, v198, v199
    v_sub_f32 v200, v200, v248
    v_mfma_f32_16x16x32_bf16 v[208:211], v[132:135], v[174:177], v[208:211]
    ds_read_b128 v[196:199], v245 offset:128
    v_sub_f32 v201, v201, v248
    v_mfma_f32_16x16x32_bf16 v[208:211], v[134:137], v[176:179], v[208:211]
    s_mul_i32 s57, s31, 4
    v_exp_f32 v200, v200
    v_mfma_f32_16x16x32_bf16 v[236:239], a[160:163], a[216:219], v[236:239]
    s_waitcnt vmcnt(8)
    v_exp_f32 v201, v201
    v_mfma_f32_16x16x32_bf16 v[236:239], a[164:167], a[220:223], v[236:239]
    buffer_load_dwordx4 a[204:207], v254, s[24:27], s59 offen offset:3072
    v_sub_f32 v202, v202, v248
    v_mfma_f32_16x16x32_bf16 v[228:231], a[168:171], a[232:235], 0
    s_add_u32 s56, s56, s57
    v_exp_f32 v202, v202
    v_sub_f32 v203, v203, v248
    v_exp_f32 v203, v203
    v_cvt_pk_bf16_f32 v184, v200, v201
    v_cvt_pk_bf16_f32 v236, v236, v237
    v_cvt_pk_bf16_f32 v237, v238, v239
    ds_write_b64 v249, v[236:237] offset:0
    s_waitcnt vmcnt(8) lgkmcnt(2)
    v_mfma_f32_16x16x32_bf16 v[228:231], a[172:175], a[236:239], v[228:231]
    buffer_load_dwordx4 a[208:211], v254, s[24:27], s50 offen
    v_cvt_pk_bf16_f32 v187, v202, v203
    v_mfma_f32_16x16x32_bf16 v[236:239], a[144:147], a[224:227], 0
    ds_read_b128 v[200:203], v246 offset:128
    v_sub_f32 v204, v204, v248
    v_mfma_f32_16x16x32_bf16 v[236:239], a[148:151], a[228:231], v[236:239]
    s_waitcnt lgkmcnt(2)
    v_exp_f32 v204, v204
    v_mfma_f32_16x16x32_bf16 v[196:199], v[156:159], v[174:177], v[196:199]
    s_mul_i32 s58, s30, 4
    v_sub_f32 v205, v205, v248
    v_sub_f32 v206, v206, v248
    v_mfma_f32_16x16x32_bf16 v[196:199], v[158:161], v[176:179], v[196:199]
    s_waitcnt vmcnt(8)
    v_exp_f32 v205, v205
    v_mfma_f32_16x16x32_bf16 v[228:231], a[176:179], a[240:243], v[228:231]
    buffer_load_dwordx4 a[212:215], v254, s[24:27], s51 offen offset:1024
    v_exp_f32 v206, v206
    v_sub_f32 v207, v207, v248
    v_exp_f32 v207, v207
    v_cvt_pk_bf16_f32 v182, v204, v205
    v_cvt_pk_bf16_f32 v185, v206, v207
    ds_read_b128 v[204:207], v244 offset:0
    v_mfma_f32_16x16x32_bf16 v[212:215], v[10:13], v[180:183], v[212:215]
    s_mul_i32 s59, s31, -8
    v_sub_f32 v208, v208, v248
    v_sub_f32 v209, v209, v248
    v_mfma_f32_16x16x32_bf16 v[216:219], v[40:43], v[180:183], v[216:219]
    s_add_u32 s58, s58, s59
    v_exp_f32 v208, v208
    v_mfma_f32_16x16x32_bf16 v[220:223], v[70:73], v[180:183], v[220:223]
    s_mul_i32 s50, s30, 0
    v_exp_f32 v209, v209
    v_mfma_f32_16x16x32_bf16 v[224:227], a[248:251], v[180:183], v[224:227]
    s_mul_i32 s51, s31, 4
    v_cvt_pk_bf16_f32 v189, v208, v209
    v_sub_f32 v196, v196, v248
    v_mfma_f32_16x16x32_bf16 v[212:215], v[14:17], v[184:187], v[212:215]
    ds_read_b128 v[208:211], v245 offset:0
    v_sub_f32 v197, v197, v248
    v_mfma_f32_16x16x32_bf16 v[216:219], v[44:47], v[184:187], v[216:219]
    s_add_u32 s50, s50, s51
    v_exp_f32 v196, v196
    v_mfma_f32_16x16x32_bf16 v[220:223], v[74:77], v[184:187], v[220:223]
    s_mov_b32 s55, 15
    v_exp_f32 v197, v197
    v_mfma_f32_16x16x32_bf16 v[224:227], a[248:251], v[184:187], v[224:227]
    s_waitcnt vmcnt(8) lgkmcnt(2)
    v_cvt_pk_bf16_f32 v190, v196, v197
    v_mbcnt_lo_u32_b32 v254, -1, 0
    v_mfma_f32_16x16x32_bf16 v[200:203], v[114:117], v[174:177], v[200:203]
    ds_read_b128 v[196:199], v246 offset:0
    v_mbcnt_hi_u32_b32 v254, -1, v254
    v_mfma_f32_16x16x32_bf16 v[200:203], v[116:119], v[176:179], v[200:203]
    ds_read_b64 v[174:175], v247 offset:0
    v_lshrrev_b32 v255, 4, v254
    v_mfma_f32_16x16x32_bf16 v[228:231], a[180:183], a[244:247], v[228:231]
    s_waitcnt vmcnt(7) lgkmcnt(3)
    v_mul_i32_i24 v250, s31, v255
    v_add_u32 v250, s52, v250
    v_mfma_f32_16x16x32_bf16 v[204:207], v[126:129], v[168:171], v[204:207]
    ds_read_b64 v[176:177], v247 offset:128
    v_sub_f32 v200, v200, v248
    v_mfma_f32_16x16x32_bf16 v[204:207], v[128:131], v[170:173], v[204:207]
    ds_read_b64 v[178:179], v247 offset:256
    v_sub_f32 v201, v201, v248
    v_mfma_f32_16x16x32_bf16 v[228:231], a[184:187], a[216:219], v[228:231]
    s_waitcnt lgkmcnt(4)
    v_exp_f32 v200, v200
    v_mfma_f32_16x16x32_bf16 v[208:211], v[150:153], v[168:171], v[208:211]
    s_mul_i32 s52, s30, 0
    v_exp_f32 v201, v201
    v_mfma_f32_16x16x32_bf16 v[208:211], v[152:155], v[170:173], v[208:211]
    s_waitcnt vmcnt(6)
    v_cvt_pk_bf16_f32 v188, v200, v201
    v_and_b32 v254, 15, v254
    v_mfma_f32_16x16x32_bf16 v[228:231], a[188:191], a[220:223], v[228:231]
    ds_read_b128 v[200:203], v244 offset:64
    v_lshl_add_u32 v251, v254, 3, v250
    v_mfma_f32_16x16x32_bf16 v[212:215], v[18:21], v[188:191], v[212:215]
    s_add_u32 s52, s52, s53
    v_lshlrev_b32 v255, 3, v255
    v_and_b32 v255, 8, v255
    v_mfma_f32_16x16x32_bf16 v[216:219], v[48:51], v[188:191], v[216:219]
    s_mul_i32 s55, s55, s31
    v_cvt_pk_bf16_f32 v228, v228, v229
    v_cvt_pk_bf16_f32 v229, v230, v231
    v_mfma_f32_16x16x32_bf16 v[220:223], v[78:81], v[188:191], v[220:223]
    ds_write_b64 v249, v[228:229] offset:128
    v_mfma_f32_16x16x32_bf16 v[224:227], a[248:251], v[188:191], v[224:227]
    s_mov_b32 s57, 3
    v_xor_b32 v254, v254, v255
    v_lshl_add_u32 v250, v254, 4, v250
    v_mfma_f32_16x16x32_bf16 v[228:231], a[168:171], a[224:227], 0
    s_mul_i32 s57, s57, s31
    v_max_f32 v248, v204, v205
    v_max3_f32 v248, v248, v206, v207
    v_mfma_f32_16x16x32_bf16 v[228:231], a[172:175], a[228:231], v[228:231]
    s_waitcnt vmcnt(5) lgkmcnt(2)
    v_rcp_f32 v225, v224
    v_mfma_f32_16x16x32_bf16 v[196:199], v[162:165], v[168:171], v[196:199]
    ds_read_b128 v[204:207], v245 offset:64
    v_mul_f32 v212, v212, v225
    v_mfma_f32_16x16x32_bf16 v[196:199], v[164:167], v[170:173], v[196:199]
    s_mul_i32 s59, s31, 4
    v_mul_f32 v213, v213, v225
    v_mul_f32 v214, v214, v225
    v_mfma_f32_16x16x32_bf16 v[232:235], a[192:195], a[232:235], 0
    s_waitcnt vmcnt(4) lgkmcnt(2)
    v_mul_f32 v215, v215, v225
    v_cvt_pk_bf16_f32 v212, v212, v213
    v_mfma_f32_16x16x32_bf16 v[200:203], v[132:135], v[168:171], v[200:203]
    ds_read_b128 a[232:235], v242 offset:6272
    v_cvt_pk_bf16_f32 v213, v214, v215
    v_mfma_f32_16x16x32_bf16 v[200:203], v[134:137], v[170:173], v[200:203]
    ds_write_b64 v247, v[212:213] offset:12288
    v_mfma_f32_16x16x32_bf16 v[232:235], a[196:199], a[236:239], v[232:235]
    ds_read_b128 a[236:239], v243 offset:6272
    v_mul_f32 v216, v216, v225
    v_mul_f32 v217, v217, v225
    v_mul_f32 v218, v218, v225
    v_mul_f32 v219, v219, v225
    v_cvt_pk_bf16_f32 v216, v216, v217
    v_cvt_pk_bf16_f32 v217, v218, v219
    ds_write_b64 v247, v[216:217] offset:12416
    v_mul_f32 v220, v220, v225
    v_mul_f32 v221, v221, v225
    v_mul_f32 v222, v222, v225
    v_mul_f32 v223, v223, v225
    v_cvt_pk_bf16_f32 v220, v220, v221
    v_cvt_pk_bf16_f32 v221, v222, v223
    ds_write_b64 v247, v[220:221] offset:12544
    v_max3_f32 v248, v248, v208, v209
    v_max3_f32 v248, v248, v210, v211
    ds_read_b128 v[208:211], v246 offset:64
    v_max3_f32 v248, v248, v196, v197
    v_max3_f32 v248, v248, v198, v199
    ds_read_b128 v[196:199], v244 offset:128
    v_max3_f32 v248, v248, v200, v201
    v_max3_f32 v248, v248, v202, v203
    ds_read_b128 v[200:203], v245 offset:128
    s_mul_i32 s51, s31, 4
    s_mov_b32 s53, 15
    s_waitcnt vmcnt(3) lgkmcnt(5)
    v_mfma_f32_16x16x32_bf16 v[204:207], v[156:159], v[168:171], v[204:207]
    v_mfma_f32_16x16x32_bf16 v[204:207], v[158:161], v[170:173], v[204:207]
    v_mfma_f32_16x16x32_bf16 v[232:235], a[200:203], a[240:243], v[232:235]
    ds_read_b128 a[240:243], v242 offset:6400
    s_waitcnt vmcnt(2)
    v_mfma_f32_16x16x32_bf16 v[232:235], a[204:207], a[244:247], v[232:235]
    ds_read_b128 a[244:247], v243 offset:6400
    s_waitcnt vmcnt(1)
    v_mfma_f32_16x16x32_bf16 v[232:235], a[208:211], a[216:219], v[232:235]
    ds_read_b128 a[216:219], v240 offset:0
    v_max3_f32 v248, v248, v204, v205
    v_mfma_f32_16x16x32_bf16 v[236:239], a[152:155], a[232:235], v[236:239]
    s_waitcnt lgkmcnt(5)
    v_max3_f32 v248, v248, v206, v207
    s_waitcnt lgkmcnt(4)
    v_mfma_f32_16x16x32_bf16 v[208:211], v[114:117], v[168:171], v[208:211]
    ds_read_b128 v[204:207], v246 offset:128
    v_mfma_f32_16x16x32_bf16 v[208:211], v[116:119], v[170:173], v[208:211]
    s_waitcnt lgkmcnt(4)
    v_mfma_f32_16x16x32_bf16 v[196:199], v[90:93], v[168:171], v[196:199]
    s_waitcnt vmcnt(0)
    v_mfma_f32_16x16x32_bf16 v[196:199], v[92:95], v[170:173], v[196:199]
    v_mfma_f32_16x16x32_bf16 v[200:203], v[96:99], v[168:171], v[200:203]
    v_mfma_f32_16x16x32_bf16 v[200:203], v[98:101], v[170:173], v[200:203]
    v_mfma_f32_16x16x32_bf16 v[232:235], a[212:215], a[220:223], v[232:235]
    ds_read_b128 a[220:223], v241 offset:0
    v_max3_f32 v248, v248, v208, v209
    v_mfma_f32_16x16x32_bf16 v[236:239], a[156:159], a[236:239], v[236:239]
    s_waitcnt lgkmcnt(2)
    v_max3_f32 v248, v248, v210, v211
    v_max3_f32 v248, v248, v196, v197
    v_mfma_f32_16x16x32_bf16 v[236:239], a[160:163], a[240:243], v[236:239]
    ds_read_b128 v[208:211], v244 offset:0
    v_cvt_pk_bf16_f32 v232, v232, v233
    v_mfma_f32_16x16x32_bf16 v[236:239], a[164:167], a[244:247], v[236:239]
    ds_read_b128 v[196:199], v245 offset:0
    v_cvt_pk_bf16_f32 v233, v234, v235
    v_mfma_f32_16x16x32_bf16 v[228:231], a[176:179], a[232:235], v[228:231]
    ds_write_b64 v249, v[232:233] offset:256
    v_mfma_f32_16x16x32_bf16 v[228:231], a[180:183], a[236:239], v[228:231]
    s_waitcnt lgkmcnt(4)
    v_max3_f32 v248, v248, v200, v201
    v_mfma_f32_16x16x32_bf16 v[204:207], v[120:123], v[168:171], v[204:207]
    ds_read_b128 v[200:203], v246 offset:0
    v_cvt_pk_bf16_f32 v236, v236, v237
    v_mfma_f32_16x16x32_bf16 v[204:207], v[122:125], v[170:173], v[204:207]
    v_cvt_pk_bf16_f32 v237, v238, v239
    v_mfma_f32_16x16x32_bf16 v[228:231], a[184:187], a[240:243], v[228:231]
    v_mfma_f32_16x16x32_bf16 v[228:231], a[188:191], a[244:247], v[228:231]
    v_mfma_f32_16x16x32_bf16 v[232:235], a[192:195], a[224:227], 0
    ds_read_b128 a[224:227], v240 offset:128
    s_waitcnt lgkmcnt(4)
    v_mfma_f32_16x16x32_bf16 v[208:211], v[126:129], v[168:171], v[208:211]
    s_waitcnt lgkmcnt(3)
    v_max3_f32 v248, v248, v204, v205
    v_mov_b32 v225, v248
    v_mfma_f32_16x16x32_bf16 v[208:211], v[128:131], v[170:173], v[208:211]
    ds_read_b128 v[204:207], v244 offset:64
    v_cvt_pk_bf16_f32 v228, v228, v229
    v_mfma_f32_16x16x32_bf16 v[196:199], v[150:153], v[168:171], v[196:199]
    s_waitcnt lgkmcnt(3)
    v_cvt_pk_bf16_f32 v229, v230, v231
    v_permlane16_swap_b32 v248, v225
    v_mfma_f32_16x16x32_bf16 v[196:199], v[152:155], v[170:173], v[196:199]
    s_barrier
    v_max_f32 v248, v248, v225
    v_mov_b32 v225, v248
    v_mfma_f32_16x16x32_bf16 v[232:235], a[196:199], a[228:231], v[232:235]
    ds_write_b64 v249, v[236:237] offset:6144
    v_mfma_f32_16x16x32_bf16 v[232:235], a[200:203], a[232:235], v[232:235]
    ds_write_b64 v249, v[228:229] offset:6272
    v_mfma_f32_16x16x32_bf16 v[232:235], a[204:207], a[236:239], v[232:235]
    ds_read_b128 a[228:231], v241 offset:128
    v_permlane32_swap_b32 v248, v225
    v_mfma_f32_16x16x32_bf16 v[232:235], a[208:211], a[240:243], v[232:235]
    ds_read_b128 a[232:235], v240 offset:256
    v_max_f32 v248, v248, v225
    v_mfma_f32_16x16x32_bf16 v[232:235], a[212:215], a[244:247], v[232:235]
    ds_read_b128 a[236:239], v241 offset:256
    v_sub_f32 v208, v208, v248
    v_mfma_f32_16x16x32_bf16 v[236:239], a[0:3], a[216:219], 0
    ds_read_b128 a[240:243], v242 offset:12288
    v_sub_f32 v209, v209, v248
    v_mfma_f32_16x16x32_bf16 v[236:239], a[4:7], a[220:223], v[236:239]
    ds_read_b128 a[244:247], v243 offset:12288
    v_sub_f32 v210, v210, v248
    v_mfma_f32_16x16x32_bf16 v[228:231], a[24:27], a[216:219], 0
    ds_read_b128 a[252:255], v252 offset:0
    v_cvt_pk_bf16_f32 v232, v232, v233
    v_mfma_f32_16x16x32_bf16 v[228:231], a[28:31], a[220:223], v[228:231]
    s_waitcnt lgkmcnt(7)
    v_cvt_pk_bf16_f32 v233, v234, v235
    v_sub_f32 v211, v211, v248
    v_mfma_f32_16x16x32_bf16 v[200:203], v[162:165], v[168:171], v[200:203]
    ds_write_b64 v249, v[232:233] offset:6400
    v_mfma_f32_16x16x32_bf16 v[200:203], v[164:167], v[170:173], v[200:203]
    ds_read_b64 v[254:255], v253 offset:256
    v_sub_f32 v196, v196, v248
    v_mfma_f32_16x16x32_bf16 v[204:207], v[132:135], v[168:171], v[204:207]
    v_exp_f32 v208, v208
    v_mfma_f32_16x16x32_bf16 v[204:207], v[134:137], v[170:173], v[204:207]
    v_exp_f32 v209, v209
    v_mfma_f32_16x16x32_bf16 v[236:239], a[8:11], a[224:227], v[236:239]
    s_waitcnt lgkmcnt(4)
    v_exp_f32 v210, v210
    v_mfma_f32_16x16x32_bf16 v[236:239], a[12:15], a[228:231], v[236:239]
    v_exp_f32 v211, v211
    v_mfma_f32_16x16x32_bf16 v[236:239], a[16:19], a[232:235], v[236:239]
    s_waitcnt lgkmcnt(2)
    v_cvt_pk_bf16_f32 v193, v208, v209
    v_cvt_pk_bf16_f32 v180, v210, v211
    v_mfma_f32_16x16x32_bf16 v[236:239], a[20:23], a[236:239], v[236:239]
    ds_read_b128 v[208:211], v245 offset:64
    v_sub_f32 v197, v197, v248
    v_mfma_f32_16x16x32_bf16 v[228:231], a[32:35], a[224:227], v[228:231]
    buffer_store_dwordx4 a[252:255], v250, s[20:23], 0 offen nt
    v_mfma_f32_16x16x32_bf16 v[228:231], a[36:39], a[228:231], v[228:231]
    s_waitcnt lgkmcnt(1)
    v_exp_f32 v196, v196
    v_mfma_f32_16x16x32_bf16 v[228:231], a[40:43], a[232:235], v[228:231]
    v_cvt_pk_bf16_f32 v126, v236, v237
    v_cvt_pk_bf16_f32 v127, v238, v239
    v_mfma_f32_16x16x32_bf16 v[228:231], a[44:47], a[236:239], v[228:231]
    v_exp_f32 v197, v197
    v_mfma_f32_16x16x32_bf16 v[232:235], a[48:51], a[216:219], 0
    buffer_store_dwordx2 v[254:255], v251, s[20:23], 0 offen offset:256 nt
    v_mfma_f32_16x16x32_bf16 v[232:235], a[52:55], a[220:223], v[232:235]
    v_sub_f32 v198, v198, v248
    v_sub_f32 v199, v199, v248
    v_mfma_f32_16x16x32_bf16 v[232:235], a[56:59], a[224:227], v[232:235]
    v_exp_f32 v198, v198
    v_mfma_f32_16x16x32_bf16 v[232:235], a[60:63], a[228:231], v[232:235]
    s_waitcnt lgkmcnt(0)
    v_cvt_pk_bf16_f32 v128, v228, v229
    v_cvt_pk_bf16_f32 v129, v230, v231
    v_mfma_f32_16x16x32_bf16 v[208:211], v[156:159], v[168:171], v[208:211]
    v_exp_f32 v199, v199
    v_mfma_f32_16x16x32_bf16 v[208:211], v[158:161], v[170:173], v[208:211]
    v_cvt_pk_bf16_f32 v194, v196, v197
    v_cvt_pk_bf16_f32 v181, v198, v199
    v_mfma_f32_16x16x32_bf16 v[232:235], a[64:67], a[232:235], v[232:235]
    ds_read_b128 v[196:199], v246 offset:64
    v_sub_f32 v200, v200, v248
    v_mfma_f32_16x16x32_bf16 v[232:235], a[68:71], a[236:239], v[232:235]
    v_exp_f32 v200, v200
    v_mfma_f32_16x16x32_bf16 v[236:239], a[216:219], a[72:75], 0
    v_sub_f32 v201, v201, v248
    v_sub_f32 v202, v202, v248
    v_mfma_f32_16x16x32_bf16 v[236:239], a[220:223], a[76:79], v[236:239]
    v_exp_f32 v201, v201
    v_mfma_f32_16x16x32_bf16 v[236:239], a[224:227], a[80:83], v[236:239]
    v_exp_f32 v202, v202
    v_mfma_f32_16x16x32_bf16 v[236:239], a[228:231], a[84:87], v[236:239]
    v_cvt_pk_bf16_f32 v130, v232, v233
    v_cvt_pk_bf16_f32 v131, v234, v235
    v_mfma_f32_16x16x32_bf16 v[236:239], a[232:235], a[88:91], v[236:239]
    v_sub_f32 v203, v203, v248
    v_cvt_pk_bf16_f32 v192, v200, v201
    v_mfma_f32_16x16x32_bf16 v[236:239], a[236:239], a[92:95], v[236:239]
    v_exp_f32 v203, v203
    v_mfma_f32_16x16x32_bf16 v[228:231], a[216:219], a[96:99], 0
    v_cvt_pk_bf16_f32 v195, v202, v203
    v_sub_f32 v204, v204, v248
    v_mfma_f32_16x16x32_bf16 v[228:231], a[220:223], a[100:103], v[228:231]
    ds_read_b128 v[200:203], v244 offset:128
    v_sub_f32 v205, v205, v248
    v_mfma_f32_16x16x32_bf16 v[212:215], v[12:15], v[192:195], 0
    s_waitcnt lgkmcnt(1)
    v_cvt_pk_bf16_f32 v1, v236, v237
    v_cvt_pk_bf16_f32 v4, v238, v239
    v_mfma_f32_16x16x32_bf16 v[216:219], v[42:45], v[192:195], 0
    v_exp_f32 v204, v204
    v_mfma_f32_16x16x32_bf16 v[220:223], v[72:75], v[192:195], 0
    v_exp_f32 v205, v205
    v_mfma_f32_16x16x32_bf16 v[224:227], a[248:251], v[192:195], 0
    v_sub_f32 v206, v206, v248
    v_sub_f32 v207, v207, v248
    v_mfma_f32_16x16x32_bf16 v[196:199], v[114:117], v[168:171], v[196:199]
    v_exp_f32 v206, v206
    v_mfma_f32_16x16x32_bf16 v[196:199], v[116:119], v[170:173], v[196:199]
    v_exp_f32 v207, v207
    v_mfma_f32_16x16x32_bf16 v[228:231], a[224:227], a[104:107], v[228:231]
    v_cvt_pk_bf16_f32 v183, v204, v205
    v_cvt_pk_bf16_f32 v186, v206, v207
    v_mfma_f32_16x16x32_bf16 v[228:231], a[228:231], a[108:111], v[228:231]
    ds_read_b128 v[204:207], v245 offset:128
    v_sub_f32 v208, v208, v248
    v_mfma_f32_16x16x32_bf16 v[228:231], a[232:235], a[112:115], v[228:231]
    s_waitcnt lgkmcnt(1)
    v_exp_f32 v208, v208
    v_mfma_f32_16x16x32_bf16 v[200:203], v[90:93], v[168:171], v[200:203]
    v_sub_f32 v209, v209, v248
    v_sub_f32 v210, v210, v248
    v_mfma_f32_16x16x32_bf16 v[200:203], v[92:95], v[170:173], v[200:203]
    v_exp_f32 v209, v209
    v_mfma_f32_16x16x32_bf16 v[228:231], a[236:239], a[116:119], v[228:231]
    v_exp_f32 v210, v210
    v_mfma_f32_16x16x32_bf16 v[232:235], a[216:219], a[120:123], 0
    ds_read_b128 a[216:219], v242 offset:12416
    v_sub_f32 v211, v211, v248
    v_mfma_f32_16x16x32_bf16 v[232:235], a[220:223], a[124:127], v[232:235]
    ds_read_b128 a[220:223], v243 offset:12416
    v_cvt_pk_bf16_f32 v184, v208, v209
    v_mfma_f32_16x16x32_bf16 v[232:235], a[224:227], a[128:131], v[232:235]
    ds_read_b128 a[224:227], v242 offset:12544
    v_cvt_pk_bf16_f32 v31, v228, v229
    v_mfma_f32_16x16x32_bf16 v[232:235], a[228:231], a[132:135], v[232:235]
    ds_read_b128 a[228:231], v243 offset:12544
    v_cvt_pk_bf16_f32 v34, v230, v231
    v_mfma_f32_16x16x32_bf16 v[232:235], a[232:235], a[136:139], v[232:235]
    s_waitcnt lgkmcnt(4)
    v_add_u32 v242, 0xfffe9800, v242
    v_add_u32 v243, 0xfffe9800, v243
    v_mfma_f32_16x16x32_bf16 v[204:207], v[96:99], v[168:171], v[204:207]
    v_exp_f32 v211, v211
    v_mfma_f32_16x16x32_bf16 v[204:207], v[98:101], v[170:173], v[204:207]
    v_cvt_pk_bf16_f32 v187, v210, v211
    v_sub_f32 v196, v196, v248
    v_mfma_f32_16x16x32_bf16 v[232:235], a[236:239], a[140:143], v[232:235]
    ds_read_b128 v[208:211], v246 offset:128
    v_sub_f32 v197, v197, v248
    v_mfma_f32_16x16x32_bf16 v[236:239], a[144:147], a[240:243], 0
    v_exp_f32 v196, v196
    v_mfma_f32_16x16x32_bf16 v[236:239], a[148:151], a[244:247], v[236:239]
    s_waitcnt lgkmcnt(4)
    v_exp_f32 v197, v197
    v_mfma_f32_16x16x32_bf16 v[236:239], a[152:155], a[216:219], v[236:239]
    s_waitcnt lgkmcnt(3)
    v_cvt_pk_bf16_f32 v61, v232, v233
    v_cvt_pk_bf16_f32 v64, v234, v235
    v_mfma_f32_16x16x32_bf16 v[236:239], a[156:159], a[220:223], v[236:239]
    s_waitcnt lgkmcnt(2)
    v_sub_f32 v198, v198, v248
    v_sub_f32 v199, v199, v248
    v_mfma_f32_16x16x32_bf16 v[236:239], a[160:163], a[224:227], v[236:239]
    s_waitcnt lgkmcnt(1)
    v_exp_f32 v198, v198
    v_mfma_f32_16x16x32_bf16 v[236:239], a[164:167], a[228:231], v[236:239]
    s_barrier
    v_exp_f32 v199, v199
    v_mfma_f32_16x16x32_bf16 v[228:231], a[168:171], a[240:243], 0
    ds_read_b128 a[232:235], v242 offset:6144
    v_cvt_pk_bf16_f32 v182, v196, v197
    v_mfma_f32_16x16x32_bf16 v[228:231], a[172:175], a[244:247], v[228:231]
    ds_read_b128 a[236:239], v243 offset:6144
    v_cvt_pk_bf16_f32 v185, v198, v199
    v_mfma_f32_16x16x32_bf16 v[212:215], v[16:19], v[180:183], v[212:215]
    ds_read_b128 v[196:199], v244 offset:32
    v_cvt_pk_bf16_f32 v236, v236, v237
    v_mfma_f32_16x16x32_bf16 v[216:219], v[46:49], v[180:183], v[216:219]
    ds_read_b128 a[252:255], v252 offset:6144
    v_cvt_pk_bf16_f32 v237, v238, v239
    v_mfma_f32_16x16x32_bf16 v[220:223], v[76:79], v[180:183], v[220:223]
    ds_write_b64 v249, v[236:237] offset:12288
    v_mfma_f32_16x16x32_bf16 v[224:227], a[248:251], v[180:183], v[224:227]
    ds_read_b64 v[254:255], v253 offset:6400
    v_sub_f32 v200, v200, v248
    v_mfma_f32_16x16x32_bf16 v[212:215], v[20:23], v[184:187], v[212:215]
    s_waitcnt lgkmcnt(6)
    v_exp_f32 v200, v200
    v_mfma_f32_16x16x32_bf16 v[216:219], v[50:53], v[184:187], v[216:219]
    v_sub_f32 v201, v201, v248
    v_sub_f32 v204, v204, v248
    v_mfma_f32_16x16x32_bf16 v[220:223], v[80:83], v[184:187], v[220:223]
    s_waitcnt lgkmcnt(5)
    v_exp_f32 v201, v201
    v_mfma_f32_16x16x32_bf16 v[224:227], a[248:251], v[184:187], v[224:227]
    v_cvt_pk_bf16_f32 v189, v200, v201
    v_sub_f32 v205, v205, v248
    v_mfma_f32_16x16x32_bf16 v[208:211], v[120:123], v[168:171], v[208:211]
    ds_read_b128 v[200:203], v245 offset:32
    v_add_u32 v250, s54, v250
    v_mfma_f32_16x16x32_bf16 v[208:211], v[122:125], v[170:173], v[208:211]
    ds_read_b64 v[168:169], v247 offset:24576
    v_add_u32 v251, s54, v251
    v_mfma_f32_16x16x32_bf16 v[228:231], a[176:179], a[216:219], v[228:231]
    ds_read_b64 v[170:171], v247 offset:24704
    s_add_u32 s54, s28, 3
    v_mfma_f32_16x16x32_bf16 v[228:231], a[180:183], a[220:223], v[228:231]
    ds_read_b64 v[172:173], v247 offset:24832
    s_mul_i32 s54, s54, s30
    v_mfma_f32_16x16x32_bf16 v[228:231], a[184:187], a[224:227], v[228:231]
    s_add_u32 s54, s54, s55
    v_exp_f32 v204, v204
    v_mfma_f32_16x16x32_bf16 v[228:231], a[188:191], a[228:231], v[228:231]
    s_add_u32 s54, s54, s32
    v_exp_f32 v205, v205
    v_mfma_f32_16x16x32_bf16 v[232:235], a[192:195], a[240:243], 0
    ds_read_b128 a[240:243], v242 offset:6272
    v_cvt_pk_bf16_f32 v190, v204, v205
    v_mfma_f32_16x16x32_bf16 v[232:235], a[196:199], a[244:247], v[232:235]
    ds_read_b128 a[244:247], v243 offset:6272
    v_sub_f32 v208, v208, v248
    v_mfma_f32_16x16x32_bf16 v[232:235], a[200:203], a[216:219], v[232:235]
    ds_read_b128 a[216:219], v242 offset:6400
    v_cvt_pk_bf16_f32 v228, v228, v229
    v_mfma_f32_16x16x32_bf16 v[232:235], a[204:207], a[220:223], v[232:235]
    ds_read_b128 a[220:223], v243 offset:6400
    v_cvt_pk_bf16_f32 v229, v230, v231
    v_mfma_f32_16x16x32_bf16 v[232:235], a[208:211], a[224:227], v[232:235]
    ds_write_b64 v249, v[228:229] offset:12416
    v_mfma_f32_16x16x32_bf16 v[232:235], a[212:215], a[228:231], v[232:235]
    ds_read_b128 a[224:227], v240 offset:1536
    v_sub_f32 v209, v209, v248
    v_mfma_f32_16x16x32_bf16 v[236:239], a[144:147], a[232:235], 0
    ds_read_b128 a[228:231], v241 offset:1536
    s_lshr_b32 s55, s28, 1
    v_mfma_f32_16x16x32_bf16 v[228:231], a[168:171], a[232:235], 0
    s_waitcnt lgkmcnt(7)
    v_exp_f32 v208, v208
    v_mfma_f32_16x16x32_bf16 v[196:199], v[132:135], v[174:177], v[196:199]
    ds_read_b128 v[204:207], v246 offset:32
    v_cvt_pk_bf16_f32 v232, v232, v233
    v_mfma_f32_16x16x32_bf16 v[196:199], v[134:137], v[176:179], v[196:199]
    buffer_store_dwordx4 a[252:255], v250, s[20:23], 0 offen nt
    v_mfma_f32_16x16x32_bf16 v[200:203], v[156:159], v[174:177], v[200:203]
    s_lshl2_add_u32 s55, s55, 3
    v_cvt_pk_bf16_f32 v233, v234, v235
    v_add_u32 v250, s56, v250
    v_mfma_f32_16x16x32_bf16 v[200:203], v[158:161], v[176:179], v[200:203]
    ds_write_b64 v249, v[232:233] offset:12544
    v_mfma_f32_16x16x32_bf16 v[236:239], a[148:151], a[236:239], v[236:239]
    s_mul_i32 s55, s55, s31
    v_add_u32 v249, 0xfffe9800, v249
    v_max_f32 v248, v196, v197
    v_mfma_f32_16x16x32_bf16 v[228:231], a[172:175], a[236:239], v[228:231]
    buffer_store_dwordx2 v[254:255], v251, s[20:23], 0 offen offset:256 nt
    v_mfma_f32_16x16x32_bf16 v[232:235], a[192:195], a[232:235], 0
    ds_read_b128 a[232:235], v240 offset:1664
    v_add_u32 v251, s56, v251
    v_mfma_f32_16x16x32_bf16 v[232:235], a[196:199], a[236:239], v[232:235]
    s_waitcnt lgkmcnt(2)
    v_exp_f32 v209, v209
    v_mfma_f32_16x16x32_bf16 v[204:207], v[114:117], v[174:177], v[204:207]
    ds_read_b128 a[236:239], v241 offset:1664
    v_cvt_pk_bf16_f32 v188, v208, v209
    v_mfma_f32_16x16x32_bf16 v[204:207], v[116:119], v[176:179], v[204:207]
    ds_read_b128 v[208:211], v244 offset:96
    v_max3_f32 v248, v248, v198, v199
    v_mfma_f32_16x16x32_bf16 v[212:215], v[24:27], v[188:191], v[212:215]
    ds_read_b128 v[196:199], v245 offset:96
    v_max3_f32 v248, v248, v200, v201
    v_mfma_f32_16x16x32_bf16 v[216:219], v[54:57], v[188:191], v[216:219]
    s_add_u32 s56, s28, 11
    v_max3_f32 v248, v248, v202, v203
    v_max3_f32 v248, v248, v204, v205
    v_mfma_f32_16x16x32_bf16 v[220:223], v[84:87], v[188:191], v[220:223]
    ds_read_b128 v[200:203], v246 offset:96
    v_max3_f32 v248, v248, v206, v207
    v_mfma_f32_16x16x32_bf16 v[224:227], a[248:251], v[188:191], v[224:227]
    ds_read_b128 v[204:207], v244 offset:32
    s_mul_i32 s56, s56, s30
    v_mfma_f32_16x16x32_bf16 v[236:239], a[152:155], a[240:243], v[236:239]
    s_add_u32 s56, s56, s57
    s_add_u32 s56, s56, s32
    s_lshr_b32 s57, s28, 1
    v_mfma_f32_16x16x32_bf16 v[236:239], a[156:159], a[244:247], v[236:239]
    s_lshl2_add_u32 s57, s57, 11
    v_rcp_f32 v225, v224
    v_mfma_f32_16x16x32_bf16 v[236:239], a[160:163], a[216:219], v[236:239]
    s_waitcnt lgkmcnt(5)
    v_mul_f32 v212, v212, v225
    v_mul_f32 v213, v213, v225
    v_mfma_f32_16x16x32_bf16 v[236:239], a[164:167], a[220:223], v[236:239]
    s_barrier
    v_mul_f32 v214, v214, v225
    v_mul_f32 v215, v215, v225
    v_mfma_f32_16x16x32_bf16 v[228:231], a[176:179], a[240:243], v[228:231]
    ds_read_b128 a[252:255], v252 offset:12288
    v_add_u32 v252, 0xfffe9800, v252
    v_mfma_f32_16x16x32_bf16 v[228:231], a[180:183], a[244:247], v[228:231]
    ds_read_b64 v[254:255], v253 offset:12544
    v_cvt_pk_bf16_f32 v236, v236, v237
    v_mfma_f32_16x16x32_bf16 v[228:231], a[184:187], a[216:219], v[228:231]
    s_waitcnt lgkmcnt(4)
    v_cvt_pk_bf16_f32 v237, v238, v239
    v_add_u32 v253, 0xfffe9800, v253
    v_mfma_f32_16x16x32_bf16 v[208:211], v[90:93], v[174:177], v[208:211]
    ds_write_b64 v249, v[236:237] offset:6144
    v_mfma_f32_16x16x32_bf16 v[208:211], v[92:95], v[176:179], v[208:211]
    s_waitcnt lgkmcnt(3)
    v_cvt_pk_bf16_f32 v212, v212, v213
    v_cvt_pk_bf16_f32 v213, v214, v215
    v_mfma_f32_16x16x32_bf16 v[196:199], v[96:99], v[174:177], v[196:199]
    ds_write_b64 v247, v[212:213] offset:18432
    v_mfma_f32_16x16x32_bf16 v[196:199], v[98:101], v[176:179], v[196:199]
    v_mul_f32 v216, v216, v225
    v_mul_f32 v217, v217, v225
    v_mfma_f32_16x16x32_bf16 v[200:203], v[120:123], v[174:177], v[200:203]
    v_mul_f32 v218, v218, v225
    v_mul_f32 v219, v219, v225
    v_mfma_f32_16x16x32_bf16 v[200:203], v[122:125], v[176:179], v[200:203]
    s_waitcnt lgkmcnt(3)
    v_cvt_pk_bf16_f32 v216, v216, v217
    v_cvt_pk_bf16_f32 v217, v218, v219
    v_mfma_f32_16x16x32_bf16 v[204:207], v[132:135], v[174:177], v[204:207]
    ds_write_b64 v247, v[216:217] offset:18560
    v_mfma_f32_16x16x32_bf16 v[204:207], v[134:137], v[176:179], v[204:207]
    buffer_store_dwordx4 a[252:255], v250, s[20:23], 0 offen nt
    v_mfma_f32_16x16x32_bf16 v[228:231], a[188:191], a[220:223], v[228:231]
    s_waitcnt lgkmcnt(2)
    v_mul_f32 v220, v220, v225
    v_mul_f32 v221, v221, v225
    v_mfma_f32_16x16x32_bf16 v[232:235], a[200:203], a[240:243], v[232:235]
    ds_read_b128 a[240:243], v240 offset:1792
    v_mul_f32 v222, v222, v225
    v_mfma_f32_16x16x32_bf16 v[232:235], a[204:207], a[244:247], v[232:235]
    ds_read_b128 a[244:247], v241 offset:1792
    v_cvt_pk_bf16_f32 v228, v228, v229
    v_mfma_f32_16x16x32_bf16 v[232:235], a[208:211], a[216:219], v[232:235]
    ds_read_b128 a[216:219], v240 offset:3072
    v_cvt_pk_bf16_f32 v229, v230, v231
    v_mfma_f32_16x16x32_bf16 v[232:235], a[212:215], a[220:223], v[232:235]
    ds_write_b64 v249, v[228:229] offset:6272
    v_mfma_f32_16x16x32_bf16 v[236:239], a[0:3], a[224:227], 0
    ds_read_b128 a[220:223], v241 offset:3072
    v_mul_f32 v223, v223, v225
    v_mfma_f32_16x16x32_bf16 v[236:239], a[4:7], a[228:231], v[236:239]
    buffer_store_dwordx2 v[254:255], v251, s[20:23], 0 offen offset:256 nt
    v_mfma_f32_16x16x32_bf16 v[236:239], a[8:11], a[232:235], v[236:239]
    v_cvt_pk_bf16_f32 v220, v220, v221
    v_cvt_pk_bf16_f32 v232, v232, v233
    v_mfma_f32_16x16x32_bf16 v[236:239], a[12:15], a[236:239], v[236:239]
    v_cvt_pk_bf16_f32 v233, v234, v235
    v_cvt_pk_bf16_f32 v221, v222, v223
    v_mfma_f32_16x16x32_bf16 v[228:231], a[24:27], a[224:227], 0
    ds_write_b64 v249, v[232:233] offset:6400
    v_mfma_f32_16x16x32_bf16 v[228:231], a[28:31], a[228:231], v[228:231]
    ds_write_b64 v247, v[220:221] offset:18688
    v_mfma_f32_16x16x32_bf16 v[228:231], a[32:35], a[232:235], v[228:231]
    s_waitcnt lgkmcnt(4)
    v_max3_f32 v248, v248, v208, v209
    v_max3_f32 v248, v248, v210, v211
    v_mfma_f32_16x16x32_bf16 v[236:239], a[16:19], a[240:243], v[236:239]
    ds_read_b128 v[208:211], v245 offset:32
    v_max3_f32 v248, v248, v196, v197
    v_mfma_f32_16x16x32_bf16 v[236:239], a[20:23], a[244:247], v[236:239]
    v_max3_f32 v248, v248, v198, v199
    v_max3_f32 v248, v248, v200, v201
    v_mfma_f32_16x16x32_bf16 v[228:231], a[36:39], a[236:239], v[228:231]
    ds_read_b128 v[196:199], v246 offset:32
    v_max3_f32 v248, v248, v202, v203
    v_mfma_f32_16x16x32_bf16 v[228:231], a[40:43], a[240:243], v[228:231]
    ds_read_b128 v[200:203], v244 offset:96
    v_mov_b32 v225, v248
    v_mfma_f32_16x16x32_bf16 v[228:231], a[44:47], a[244:247], v[228:231]
    v_cvt_pk_bf16_f32 v132, v236, v237
    v_cvt_pk_bf16_f32 v133, v238, v239
    v_mfma_f32_16x16x32_bf16 v[232:235], a[48:51], a[224:227], 0
    v_permlane16_swap_b32 v248, v225
    v_max_f32 v248, v248, v225
    v_mfma_f32_16x16x32_bf16 v[232:235], a[52:55], a[228:231], v[232:235]
    v_mov_b32 v225, v248
    v_add_u32 v250, s58, v250
    v_mfma_f32_16x16x32_bf16 v[232:235], a[56:59], a[232:235], v[232:235]
    v_cvt_pk_bf16_f32 v134, v228, v229
    v_cvt_pk_bf16_f32 v135, v230, v231
    v_mfma_f32_16x16x32_bf16 v[232:235], a[60:63], a[236:239], v[232:235]
    v_permlane32_swap_b32 v248, v225
    v_max_f32 v248, v248, v225
    v_mfma_f32_16x16x32_bf16 v[232:235], a[64:67], a[240:243], v[232:235]
    s_waitcnt lgkmcnt(2)
    v_sub_f32 v204, v204, v248
    v_sub_f32 v205, v205, v248
    v_mfma_f32_16x16x32_bf16 v[208:211], v[156:159], v[174:177], v[208:211]
    v_exp_f32 v204, v204
    v_mfma_f32_16x16x32_bf16 v[208:211], v[158:161], v[176:179], v[208:211]
    s_waitcnt lgkmcnt(1)
    v_exp_f32 v205, v205
    v_mfma_f32_16x16x32_bf16 v[196:199], v[114:117], v[174:177], v[196:199]
    s_waitcnt lgkmcnt(0)
    v_sub_f32 v206, v206, v248
    v_sub_f32 v207, v207, v248
    v_mfma_f32_16x16x32_bf16 v[196:199], v[116:119], v[176:179], v[196:199]
    v_exp_f32 v206, v206
    v_mfma_f32_16x16x32_bf16 v[200:203], v[90:93], v[174:177], v[200:203]
    v_exp_f32 v207, v207
    v_mfma_f32_16x16x32_bf16 v[200:203], v[92:95], v[176:179], v[200:203]
    v_cvt_pk_bf16_f32 v193, v204, v205
    v_cvt_pk_bf16_f32 v180, v206, v207
    v_mfma_f32_16x16x32_bf16 v[232:235], a[68:71], a[244:247], v[232:235]
    ds_read_b128 v[204:207], v245 offset:96
    v_sub_f32 v208, v208, v248
    v_mfma_f32_16x16x32_bf16 v[236:239], a[224:227], a[72:75], 0
    v_exp_f32 v208, v208
    v_mfma_f32_16x16x32_bf16 v[236:239], a[228:231], a[76:79], v[236:239]
    v_sub_f32 v209, v209, v248
    v_sub_f32 v210, v210, v248
    v_mfma_f32_16x16x32_bf16 v[236:239], a[232:235], a[80:83], v[236:239]
    v_cvt_pk_bf16_f32 v136, v232, v233
    v_cvt_pk_bf16_f32 v137, v234, v235
    v_mfma_f32_16x16x32_bf16 v[236:239], a[236:239], a[84:87], v[236:239]
    v_exp_f32 v209, v209
    v_mfma_f32_16x16x32_bf16 v[236:239], a[240:243], a[88:91], v[236:239]
    v_exp_f32 v210, v210
    v_mfma_f32_16x16x32_bf16 v[236:239], a[244:247], a[92:95], v[236:239]
    v_sub_f32 v211, v211, v248
    v_cvt_pk_bf16_f32 v194, v208, v209
    v_mfma_f32_16x16x32_bf16 v[228:231], a[224:227], a[96:99], 0
    v_exp_f32 v211, v211
    v_mfma_f32_16x16x32_bf16 v[228:231], a[228:231], a[100:103], v[228:231]
    v_cvt_pk_bf16_f32 v181, v210, v211
    v_sub_f32 v196, v196, v248
    v_mfma_f32_16x16x32_bf16 v[228:231], a[232:235], a[104:107], v[228:231]
    ds_read_b128 v[208:211], v246 offset:96
    v_cvt_pk_bf16_f32 v7, v236, v237
    v_mfma_f32_16x16x32_bf16 v[228:231], a[236:239], a[108:111], v[228:231]
    s_waitcnt lgkmcnt(1)
    v_cvt_pk_bf16_f32 v10, v238, v239
    v_sub_f32 v197, v197, v248
    v_mfma_f32_16x16x32_bf16 v[204:207], v[96:99], v[174:177], v[204:207]
    v_exp_f32 v196, v196
    v_mfma_f32_16x16x32_bf16 v[204:207], v[98:101], v[176:179], v[204:207]
    v_exp_f32 v197, v197
    v_mfma_f32_16x16x32_bf16 v[228:231], a[240:243], a[112:115], v[228:231]
    v_sub_f32 v198, v198, v248
    v_sub_f32 v199, v199, v248
    v_mfma_f32_16x16x32_bf16 v[228:231], a[244:247], a[116:119], v[228:231]
    v_exp_f32 v198, v198
    v_mfma_f32_16x16x32_bf16 v[232:235], a[224:227], a[120:123], 0
    ds_read_b128 a[224:227], v240 offset:3200
    v_cvt_pk_bf16_f32 v192, v196, v197
    v_mfma_f32_16x16x32_bf16 v[232:235], a[228:231], a[124:127], v[232:235]
    ds_read_b128 a[228:231], v241 offset:3200
    v_sub_f32 v200, v200, v248
    v_mfma_f32_16x16x32_bf16 v[232:235], a[232:235], a[128:131], v[232:235]
    ds_read_b128 a[232:235], v240 offset:3328
    v_cvt_pk_bf16_f32 v37, v228, v229
    v_mfma_f32_16x16x32_bf16 v[232:235], a[236:239], a[132:135], v[232:235]
    ds_read_b128 a[236:239], v241 offset:3328
    v_cvt_pk_bf16_f32 v40, v230, v231
    v_mfma_f32_16x16x32_bf16 v[232:235], a[240:243], a[136:139], v[232:235]
    ds_read_b128 a[240:243], v242 offset:12288
    v_sub_f32 v201, v201, v248
    v_mfma_f32_16x16x32_bf16 v[232:235], a[244:247], a[140:143], v[232:235]
    ds_read_b128 a[244:247], v243 offset:12288
    v_sub_f32 v202, v202, v248
    v_mfma_f32_16x16x32_bf16 v[236:239], a[0:3], a[216:219], 0
    s_waitcnt lgkmcnt(6)
    v_exp_f32 v199, v199
    v_mfma_f32_16x16x32_bf16 v[208:211], v[120:123], v[174:177], v[208:211]
    ds_read_b64 v[174:175], v247 offset:30720
    v_cvt_pk_bf16_f32 v195, v198, v199
    v_mfma_f32_16x16x32_bf16 v[208:211], v[122:125], v[176:179], v[208:211]
    ds_read_b128 v[196:199], v244 offset:192
    v_cvt_pk_bf16_f32 v67, v232, v233
    v_mfma_f32_16x16x32_bf16 v[212:215], v[18:21], v[192:195], 0
    ds_read_b64 v[176:177], v247 offset:30848
    v_cvt_pk_bf16_f32 v70, v234, v235
    v_mfma_f32_16x16x32_bf16 v[216:219], v[48:51], v[192:195], 0
    ds_read_b64 v[178:179], v247 offset:30976
    v_sub_f32 v203, v203, v248
    v_mfma_f32_16x16x32_bf16 v[220:223], v[78:81], v[192:195], 0
    v_exp_f32 v200, v200
    v_mfma_f32_16x16x32_bf16 v[224:227], a[248:251], v[192:195], 0
    v_exp_f32 v201, v201
    v_mfma_f32_16x16x32_bf16 v[236:239], a[4:7], a[220:223], v[236:239]
    s_waitcnt lgkmcnt(5)
    v_exp_f32 v202, v202
    v_mfma_f32_16x16x32_bf16 v[236:239], a[8:11], a[224:227], v[236:239]
    v_exp_f32 v203, v203
    v_mfma_f32_16x16x32_bf16 v[236:239], a[12:15], a[228:231], v[236:239]
    v_cvt_pk_bf16_f32 v183, v200, v201
    v_cvt_pk_bf16_f32 v186, v202, v203
    v_mfma_f32_16x16x32_bf16 v[236:239], a[16:19], a[232:235], v[236:239]
    ds_read_b128 v[200:203], v245 offset:192
    v_sub_f32 v204, v204, v248
    v_mfma_f32_16x16x32_bf16 v[236:239], a[20:23], a[236:239], v[236:239]
    s_waitcnt lgkmcnt(3)
    v_exp_f32 v204, v204
    v_mfma_f32_16x16x32_bf16 v[196:199], v[138:141], v[168:171], v[196:199]
    v_sub_f32 v205, v205, v248
    v_sub_f32 v206, v206, v248
    v_mfma_f32_16x16x32_bf16 v[196:199], v[140:143], v[170:173], v[196:199]
    v_exp_f32 v205, v205
    v_mfma_f32_16x16x32_bf16 v[228:231], a[24:27], a[216:219], 0
    v_cvt_pk_bf16_f32 v90, v236, v237
    v_cvt_pk_bf16_f32 v91, v238, v239
    v_mfma_f32_16x16x32_bf16 v[228:231], a[28:31], a[220:223], v[228:231]
    v_exp_f32 v206, v206
    v_mfma_f32_16x16x32_bf16 v[228:231], a[32:35], a[224:227], v[228:231]
    v_sub_f32 v207, v207, v248
    v_cvt_pk_bf16_f32 v184, v204, v205
    v_mfma_f32_16x16x32_bf16 v[228:231], a[36:39], a[228:231], v[228:231]
    v_exp_f32 v207, v207
    v_mfma_f32_16x16x32_bf16 v[228:231], a[40:43], a[232:235], v[228:231]
    v_cvt_pk_bf16_f32 v187, v206, v207
    v_sub_f32 v208, v208, v248
    v_mfma_f32_16x16x32_bf16 v[228:231], a[44:47], a[236:239], v[228:231]
    ds_read_b128 v[204:207], v246 offset:192
    v_sub_f32 v209, v209, v248
    v_mfma_f32_16x16x32_bf16 v[232:235], a[48:51], a[216:219], 0
    s_waitcnt lgkmcnt(1)
    v_exp_f32 v208, v208
    v_mfma_f32_16x16x32_bf16 v[200:203], v[102:105], v[168:171], v[200:203]
    v_exp_f32 v209, v209
    v_mfma_f32_16x16x32_bf16 v[200:203], v[104:107], v[170:173], v[200:203]
    v_cvt_pk_bf16_f32 v92, v228, v229
    v_cvt_pk_bf16_f32 v93, v230, v231
    v_mfma_f32_16x16x32_bf16 v[232:235], a[52:55], a[220:223], v[232:235]
    v_sub_f32 v210, v210, v248
    v_sub_f32 v211, v211, v248
    v_mfma_f32_16x16x32_bf16 v[232:235], a[56:59], a[224:227], v[232:235]
    v_exp_f32 v210, v210
    v_mfma_f32_16x16x32_bf16 v[232:235], a[60:63], a[228:231], v[232:235]
    v_exp_f32 v211, v211
    v_mfma_f32_16x16x32_bf16 v[232:235], a[64:67], a[232:235], v[232:235]
    v_cvt_pk_bf16_f32 v182, v208, v209
    v_cvt_pk_bf16_f32 v185, v210, v211
    v_mfma_f32_16x16x32_bf16 v[232:235], a[68:71], a[236:239], v[232:235]
    ds_read_b128 v[208:211], v244 offset:256
    v_add_u32 v251, s58, v251
    v_mfma_f32_16x16x32_bf16 v[212:215], v[22:25], v[180:183], v[212:215]
    s_mul_i32 s58, s30, 0
    v_max_f32 v248, v196, v197
    v_max3_f32 v248, v248, v198, v199
    v_mfma_f32_16x16x32_bf16 v[216:219], v[52:55], v[180:183], v[216:219]
    ds_read_b128 v[196:199], v245 offset:256
    v_cvt_pk_bf16_f32 v94, v232, v233
    v_mfma_f32_16x16x32_bf16 v[220:223], v[82:85], v[180:183], v[220:223]
    s_add_u32 s58, s58, s59
    v_cvt_pk_bf16_f32 v95, v234, v235
    v_max3_f32 v248, v248, v200, v201
    v_mfma_f32_16x16x32_bf16 v[224:227], a[248:251], v[180:183], v[224:227]
    s_waitcnt lgkmcnt(2)
    v_max3_f32 v248, v248, v202, v203
    v_mfma_f32_16x16x32_bf16 v[212:215], v[26:29], v[184:187], v[212:215]
    ds_read_b128 v[200:203], v246 offset:256
    v_mfma_f32_16x16x32_bf16 v[216:219], v[56:59], v[184:187], v[216:219]
    v_mfma_f32_16x16x32_bf16 v[220:223], v[86:89], v[184:187], v[220:223]
    v_mfma_f32_16x16x32_bf16 v[224:227], a[248:251], v[184:187], v[224:227]
    v_mov_b32 v187, 0
    s_waitcnt lgkmcnt(2)
    v_mfma_f32_16x16x32_bf16 v[204:207], v[126:129], v[168:171], v[204:207]
    v_mfma_f32_16x16x32_bf16 v[204:207], v[128:131], v[170:173], v[204:207]
    v_mfma_f32_16x16x32_bf16 v[208:211], v[144:147], v[168:171], v[208:211]
    s_waitcnt lgkmcnt(1)
    v_mfma_f32_16x16x32_bf16 v[208:211], v[146:149], v[170:173], v[208:211]
    v_mfma_f32_16x16x32_bf16 v[196:199], v[108:111], v[168:171], v[196:199]
    v_rcp_f32 v225, v224
    v_mfma_f32_16x16x32_bf16 v[196:199], v[110:113], v[170:173], v[196:199]
    s_waitcnt lgkmcnt(0)
    v_mbcnt_lo_u32_b32 v226, -1, 0
    v_mbcnt_hi_u32_b32 v226, -1, v226
    v_mfma_f32_16x16x32_bf16 v[200:203], v[132:135], v[168:171], v[200:203]
    v_and_b32 v226, 2, v226
    v_cmp_eq_u32 vcc, 2, v226
    v_mfma_f32_16x16x32_bf16 v[200:203], v[134:137], v[170:173], v[200:203]
    v_add_u32 v226, 0xfffdd200, v247
    v_cndmask_b32 v226, 0, v226, vcc
    v_mfma_f32_16x16x32_bf16 v[236:239], a[216:219], a[72:75], 0
    v_add_u32 v226, 0x22e00, v226
    v_mul_f32 v212, v212, v225
    v_mfma_f32_16x16x32_bf16 v[236:239], a[220:223], a[76:79], v[236:239]
    v_mul_f32 v213, v213, v225
    v_mul_f32 v214, v214, v225
    v_mfma_f32_16x16x32_bf16 v[236:239], a[224:227], a[80:83], v[236:239]
    v_mul_f32 v215, v215, v225
    v_cvt_pk_bf16_f32 v212, v212, v213
    v_mfma_f32_16x16x32_bf16 v[236:239], a[228:231], a[84:87], v[236:239]
    v_cvt_pk_bf16_f32 v213, v214, v215
    v_mul_f32 v216, v216, v225
    v_mfma_f32_16x16x32_bf16 v[236:239], a[232:235], a[88:91], v[236:239]
    ds_write_b64 v226, v[212:213] offset:0
    v_mfma_f32_16x16x32_bf16 v[236:239], a[236:239], a[92:95], v[236:239]
    v_mul_f32 v217, v217, v225
    v_mul_f32 v218, v218, v225
    v_mfma_f32_16x16x32_bf16 v[228:231], a[216:219], a[96:99], 0
    v_mul_f32 v219, v219, v225
    v_cvt_pk_bf16_f32 v216, v216, v217
    v_mfma_f32_16x16x32_bf16 v[228:231], a[220:223], a[100:103], v[228:231]
    v_cvt_pk_bf16_f32 v217, v218, v219
    v_mul_f32 v220, v220, v225
    v_mfma_f32_16x16x32_bf16 v[228:231], a[224:227], a[104:107], v[228:231]
    ds_write_b64 v226, v[216:217] offset:128
    v_mfma_f32_16x16x32_bf16 v[228:231], a[228:231], a[108:111], v[228:231]
    v_cvt_pk_bf16_f32 v13, v236, v237
    v_cvt_pk_bf16_f32 v16, v238, v239
    v_mfma_f32_16x16x32_bf16 v[228:231], a[232:235], a[112:115], v[228:231]
    v_mul_f32 v221, v221, v225
    v_mul_f32 v222, v222, v225
    v_mfma_f32_16x16x32_bf16 v[228:231], a[236:239], a[116:119], v[228:231]
    v_mul_f32 v223, v223, v225
    v_cvt_pk_bf16_f32 v220, v220, v221
    v_mfma_f32_16x16x32_bf16 v[232:235], a[216:219], a[120:123], 0
    ds_read_b128 a[216:219], v242 offset:12416
    v_cvt_pk_bf16_f32 v221, v222, v223
    v_mfma_f32_16x16x32_bf16 v[232:235], a[220:223], a[124:127], v[232:235]
    ds_read_b128 a[220:223], v243 offset:12416
    v_max3_f32 v248, v248, v204, v205
    v_mfma_f32_16x16x32_bf16 v[232:235], a[224:227], a[128:131], v[232:235]
    ds_read_b128 a[224:227], v242 offset:12544
    v_cvt_pk_bf16_f32 v43, v228, v229
    v_mfma_f32_16x16x32_bf16 v[232:235], a[228:231], a[132:135], v[232:235]
    ds_read_b128 a[228:231], v243 offset:12544
    v_cvt_pk_bf16_f32 v46, v230, v231
    v_mfma_f32_16x16x32_bf16 v[232:235], a[232:235], a[136:139], v[232:235]
    ds_read_b128 a[232:235], v240 offset:4608
    v_max3_f32 v248, v248, v206, v207
    v_mfma_f32_16x16x32_bf16 v[232:235], a[236:239], a[140:143], v[232:235]
    ds_read_b128 a[236:239], v241 offset:4608
    v_max3_f32 v248, v248, v208, v209
    v_mfma_f32_16x16x32_bf16 v[236:239], a[144:147], a[240:243], 0
    ds_read_b128 v[204:207], v244 offset:320
    v_max3_f32 v248, v248, v210, v211
    v_mfma_f32_16x16x32_bf16 v[236:239], a[148:151], a[244:247], v[236:239]
    ds_read_b128 v[208:211], v245 offset:320
    v_max3_f32 v248, v248, v196, v197
    v_mfma_f32_16x16x32_bf16 v[228:231], a[168:171], a[240:243], 0
    ds_write_b64 v226, v[220:221] offset:256
    v_mfma_f32_16x16x32_bf16 v[228:231], a[172:175], a[244:247], v[228:231]
    s_waitcnt lgkmcnt(7)
    v_cvt_pk_bf16_f32 v73, v232, v233
    v_cvt_pk_bf16_f32 v76, v234, v235
    v_mfma_f32_16x16x32_bf16 v[236:239], a[152:155], a[216:219], v[236:239]
    v_max3_f32 v248, v248, v198, v199
    v_max3_f32 v248, v248, v200, v201
    v_mfma_f32_16x16x32_bf16 v[236:239], a[156:159], a[220:223], v[236:239]
    ds_read_b128 v[196:199], v246 offset:320
    v_max3_f32 v248, v248, v202, v203
    v_mfma_f32_16x16x32_bf16 v[228:231], a[176:179], a[216:219], v[228:231]
    ds_read_b128 v[200:203], v244 offset:192
    s_waitcnt lgkmcnt(6)
    v_mfma_f32_16x16x32_bf16 v[236:239], a[160:163], a[224:227], v[236:239]
    s_barrier
    ds_read_b128 a[252:255], v252 offset:6144
    v_mfma_f32_16x16x32_bf16 v[236:239], a[164:167], a[228:231], v[236:239]
    ds_read_b64 v[254:255], v253 offset:6400
    s_waitcnt lgkmcnt(6)
    v_mfma_f32_16x16x32_bf16 v[204:207], v[150:153], v[168:171], v[204:207]
    s_waitcnt lgkmcnt(5)
    v_mfma_f32_16x16x32_bf16 v[204:207], v[152:155], v[170:173], v[204:207]
    v_mfma_f32_16x16x32_bf16 v[208:211], v[162:165], v[168:171], v[208:211]
    v_mfma_f32_16x16x32_bf16 v[208:211], v[164:167], v[170:173], v[208:211]
    v_mfma_f32_16x16x32_bf16 v[228:231], a[180:183], a[220:223], v[228:231]
    v_cvt_pk_bf16_f32 v236, v236, v237
    v_cvt_pk_bf16_f32 v237, v238, v239
    v_mfma_f32_16x16x32_bf16 v[228:231], a[184:187], a[224:227], v[228:231]
    ds_write_b64 v249, v[236:237] offset:12288
    v_mfma_f32_16x16x32_bf16 v[228:231], a[188:191], a[228:231], v[228:231]
    s_waitcnt lgkmcnt(3)
    v_max3_f32 v248, v248, v204, v205
    v_max3_f32 v248, v248, v208, v209
    v_mfma_f32_16x16x32_bf16 v[196:199], v[90:93], v[168:171], v[196:199]
    ds_read_b128 v[204:207], v245 offset:192
    s_waitcnt lgkmcnt(2)
    v_mfma_f32_16x16x32_bf16 v[196:199], v[92:95], v[170:173], v[196:199]
    ds_read_b128 v[208:211], v246 offset:192
    v_cvt_pk_bf16_f32 v228, v228, v229
    v_mfma_f32_16x16x32_bf16 v[200:203], v[138:141], v[168:171], v[200:203]
    buffer_store_dwordx4 a[252:255], v250, s[20:23], 0 offen nt
    v_mfma_f32_16x16x32_bf16 v[200:203], v[140:143], v[170:173], v[200:203]
    v_cvt_pk_bf16_f32 v229, v230, v231
    v_add_u32 v250, s50, v250
    v_mfma_f32_16x16x32_bf16 v[232:235], a[192:195], a[240:243], 0
    ds_write_b64 v249, v[228:229] offset:12416
    v_mfma_f32_16x16x32_bf16 v[232:235], a[196:199], a[244:247], v[232:235]
    ds_read_b128 a[240:243], v240 offset:4736
    v_max3_f32 v248, v248, v196, v197
    v_mfma_f32_16x16x32_bf16 v[232:235], a[200:203], a[216:219], v[232:235]
    ds_read_b128 a[244:247], v241 offset:4736
    v_mov_b32 v225, v248
    v_mfma_f32_16x16x32_bf16 v[232:235], a[204:207], a[220:223], v[232:235]
    ds_read_b128 a[216:219], v240 offset:4864
    v_permlane16_swap_b32 v248, v225
    v_mfma_f32_16x16x32_bf16 v[232:235], a[208:211], a[224:227], v[232:235]
    ds_read_b128 a[220:223], v241 offset:4864
    v_max_f32 v248, v248, v225
    v_mfma_f32_16x16x32_bf16 v[232:235], a[212:215], a[228:231], v[232:235]
    ds_read_b128 a[224:227], v242 offset:18432
    v_mov_b32 v225, v248
    v_mfma_f32_16x16x32_bf16 v[236:239], a[0:3], a[232:235], 0
    ds_read_b128 a[228:231], v243 offset:18432
    v_permlane32_swap_b32 v248, v225
    v_mfma_f32_16x16x32_bf16 v[236:239], a[4:7], a[236:239], v[236:239]
    ds_read_b128 v[196:199], v244 offset:256
    v_max_f32 v248, v248, v225
    v_mfma_f32_16x16x32_bf16 v[228:231], a[24:27], a[232:235], 0
    buffer_store_dwordx2 v[254:255], v251, s[20:23], 0 offen offset:256 nt
    v_mfma_f32_16x16x32_bf16 v[228:231], a[28:31], a[236:239], v[228:231]
    s_waitcnt lgkmcnt(6)
    v_cvt_pk_bf16_f32 v232, v232, v233
    v_cvt_pk_bf16_f32 v233, v234, v235
    v_mfma_f32_16x16x32_bf16 v[204:207], v[102:105], v[168:171], v[204:207]
    ds_write_b64 v249, v[232:233] offset:12544
    v_mfma_f32_16x16x32_bf16 v[204:207], v[104:107], v[170:173], v[204:207]
    v_sub_f32 v200, v200, v248
    v_sub_f32 v201, v201, v248
    v_mfma_f32_16x16x32_bf16 v[208:211], v[126:129], v[168:171], v[208:211]
    v_exp_f32 v200, v200
    v_mfma_f32_16x16x32_bf16 v[208:211], v[128:131], v[170:173], v[208:211]
    v_exp_f32 v201, v201
    v_mfma_f32_16x16x32_bf16 v[236:239], a[8:11], a[240:243], v[236:239]
    s_waitcnt lgkmcnt(2)
    v_sub_f32 v202, v202, v248
    v_sub_f32 v203, v203, v248
    v_mfma_f32_16x16x32_bf16 v[236:239], a[12:15], a[244:247], v[236:239]
    s_waitcnt lgkmcnt(1)
    v_exp_f32 v202, v202
    v_mfma_f32_16x16x32_bf16 v[196:199], v[144:147], v[168:171], v[196:199]
    v_exp_f32 v203, v203
    v_mfma_f32_16x16x32_bf16 v[196:199], v[146:149], v[170:173], v[196:199]
    v_cvt_pk_bf16_f32 v190, v200, v201
    v_cvt_pk_bf16_f32 v193, v202, v203
    v_mfma_f32_16x16x32_bf16 v[236:239], a[16:19], a[216:219], v[236:239]
    ds_read_b128 v[200:203], v245 offset:256
    v_sub_f32 v204, v204, v248
    v_mfma_f32_16x16x32_bf16 v[236:239], a[20:23], a[220:223], v[236:239]
    v_exp_f32 v204, v204
    v_mfma_f32_16x16x32_bf16 v[228:231], a[32:35], a[240:243], v[228:231]
    v_sub_f32 v205, v205, v248
    v_sub_f32 v206, v206, v248
    v_mfma_f32_16x16x32_bf16 v[228:231], a[36:39], a[244:247], v[228:231]
    v_exp_f32 v205, v205
    v_mfma_f32_16x16x32_bf16 v[228:231], a[40:43], a[216:219], v[228:231]
    v_exp_f32 v206, v206
    v_mfma_f32_16x16x32_bf16 v[228:231], a[44:47], a[220:223], v[228:231]
    v_cvt_pk_bf16_f32 v138, v236, v237
    v_cvt_pk_bf16_f32 v139, v238, v239
    v_mfma_f32_16x16x32_bf16 v[232:235], a[48:51], a[232:235], 0
    v_sub_f32 v207, v207, v248
    v_cvt_pk_bf16_f32 v188, v204, v205
    v_mfma_f32_16x16x32_bf16 v[232:235], a[52:55], a[236:239], v[232:235]
    v_exp_f32 v207, v207
    v_mfma_f32_16x16x32_bf16 v[232:235], a[56:59], a[240:243], v[232:235]
    v_cvt_pk_bf16_f32 v140, v228, v229
    v_cvt_pk_bf16_f32 v141, v230, v231
    v_mfma_f32_16x16x32_bf16 v[232:235], a[60:63], a[244:247], v[232:235]
    s_waitcnt lgkmcnt(0)
    v_cvt_pk_bf16_f32 v191, v206, v207
    v_sub_f32 v208, v208, v248
    v_mfma_f32_16x16x32_bf16 v[200:203], v[108:111], v[168:171], v[200:203]
    ds_read_b128 v[204:207], v246 offset:256
    v_sub_f32 v209, v209, v248
    v_mfma_f32_16x16x32_bf16 v[200:203], v[110:113], v[170:173], v[200:203]
    v_exp_f32 v208, v208
    v_mfma_f32_16x16x32_bf16 v[232:235], a[64:67], a[216:219], v[232:235]
    v_exp_f32 v209, v209
    v_mfma_f32_16x16x32_bf16 v[232:235], a[68:71], a[220:223], v[232:235]
    v_sub_f32 v210, v210, v248
    v_sub_f32 v211, v211, v248
    v_mfma_f32_16x16x32_bf16 v[236:239], a[232:235], a[72:75], 0
    v_exp_f32 v210, v210
    v_mfma_f32_16x16x32_bf16 v[236:239], a[236:239], a[76:79], v[236:239]
    v_exp_f32 v211, v211
    v_mfma_f32_16x16x32_bf16 v[236:239], a[240:243], a[80:83], v[236:239]
    v_cvt_pk_bf16_f32 v189, v208, v209
    v_cvt_pk_bf16_f32 v142, v232, v233
    v_mfma_f32_16x16x32_bf16 v[236:239], a[244:247], a[84:87], v[236:239]
    v_cvt_pk_bf16_f32 v143, v234, v235
    v_cvt_pk_bf16_f32 v192, v210, v211
    v_mfma_f32_16x16x32_bf16 v[212:215], v[0:3], v[188:191], 0
    ds_read_b128 v[208:211], v244 offset:320
    v_sub_f32 v196, v196, v248
    v_mfma_f32_16x16x32_bf16 v[216:219], v[30:33], v[188:191], 0
    s_waitcnt lgkmcnt(1)
    v_exp_f32 v196, v196
    v_mfma_f32_16x16x32_bf16 v[220:223], v[60:63], v[188:191], 0
    v_sub_f32 v197, v197, v248
    v_sub_f32 v198, v198, v248
    v_mfma_f32_16x16x32_bf16 v[224:227], a[248:251], v[188:191], 0
    v_exp_f32 v197, v197
    v_mfma_f32_16x16x32_bf16 v[204:207], v[132:135], v[168:171], v[204:207]
    v_exp_f32 v198, v198
    v_mfma_f32_16x16x32_bf16 v[204:207], v[134:137], v[170:173], v[204:207]
    v_sub_f32 v199, v199, v248
    v_cvt_pk_bf16_f32 v180, v196, v197
    v_mfma_f32_16x16x32_bf16 v[236:239], a[216:219], a[88:91], v[236:239]
    v_exp_f32 v199, v199
    v_mfma_f32_16x16x32_bf16 v[236:239], a[220:223], a[92:95], v[236:239]
    v_cvt_pk_bf16_f32 v183, v198, v199
    v_sub_f32 v200, v200, v248
    v_mfma_f32_16x16x32_bf16 v[228:231], a[232:235], a[96:99], 0
    ds_read_b128 v[196:199], v245 offset:320
    v_sub_f32 v201, v201, v248
    v_mfma_f32_16x16x32_bf16 v[228:231], a[236:239], a[100:103], v[228:231]
    s_waitcnt lgkmcnt(1)
    v_exp_f32 v200, v200
    v_mfma_f32_16x16x32_bf16 v[208:211], v[150:153], v[168:171], v[208:211]
    v_cvt_pk_bf16_f32 v19, v236, v237
    v_cvt_pk_bf16_f32 v22, v238, v239
    v_mfma_f32_16x16x32_bf16 v[208:211], v[152:155], v[170:173], v[208:211]
    v_exp_f32 v201, v201
    v_mfma_f32_16x16x32_bf16 v[228:231], a[240:243], a[104:107], v[228:231]
    v_sub_f32 v202, v202, v248
    v_sub_f32 v203, v203, v248
    v_mfma_f32_16x16x32_bf16 v[228:231], a[244:247], a[108:111], v[228:231]
    v_exp_f32 v202, v202
    v_mfma_f32_16x16x32_bf16 v[228:231], a[216:219], a[112:115], v[228:231]
    v_exp_f32 v203, v203
    v_mfma_f32_16x16x32_bf16 v[228:231], a[220:223], a[116:119], v[228:231]
    v_cvt_pk_bf16_f32 v194, v200, v201
    v_cvt_pk_bf16_f32 v181, v202, v203
    v_mfma_f32_16x16x32_bf16 v[232:235], a[232:235], a[120:123], 0
    ds_read_b128 a[232:235], v242 offset:18560
    v_sub_f32 v204, v204, v248
    v_mfma_f32_16x16x32_bf16 v[232:235], a[236:239], a[124:127], v[232:235]
    ds_read_b128 a[236:239], v243 offset:18560
    v_sub_f32 v205, v205, v248
    v_mfma_f32_16x16x32_bf16 v[232:235], a[240:243], a[128:131], v[232:235]
    ds_read_b128 a[240:243], v242 offset:18688
    v_cvt_pk_bf16_f32 v49, v228, v229
    v_mfma_f32_16x16x32_bf16 v[232:235], a[244:247], a[132:135], v[232:235]
    ds_read_b128 a[244:247], v243 offset:18688
    v_cvt_pk_bf16_f32 v52, v230, v231
    v_mfma_f32_16x16x32_bf16 v[232:235], a[216:219], a[136:139], v[232:235]
    ds_read_b128 v[200:203], v246 offset:320
    v_sub_f32 v206, v206, v248
    v_mfma_f32_16x16x32_bf16 v[232:235], a[220:223], a[140:143], v[232:235]
    s_waitcnt lgkmcnt(5)
    v_exp_f32 v204, v204
    v_mfma_f32_16x16x32_bf16 v[196:199], v[162:165], v[168:171], v[196:199]
    v_exp_f32 v205, v205
    v_mfma_f32_16x16x32_bf16 v[196:199], v[164:167], v[170:173], v[196:199]
    v_exp_f32 v206, v206
    v_mfma_f32_16x16x32_bf16 v[236:239], a[144:147], a[224:227], 0
    v_sub_f32 v207, v207, v248
    v_cvt_pk_bf16_f32 v79, v232, v233
    v_mfma_f32_16x16x32_bf16 v[236:239], a[148:151], a[228:231], v[236:239]
    s_waitcnt lgkmcnt(4)
    v_cvt_pk_bf16_f32 v82, v234, v235
    v_cvt_pk_bf16_f32 v195, v204, v205
    v_mfma_f32_16x16x32_bf16 v[236:239], a[152:155], a[232:235], v[236:239]
    s_waitcnt lgkmcnt(3)
    v_exp_f32 v207, v207
    v_mfma_f32_16x16x32_bf16 v[212:215], v[4:7], v[192:195], v[212:215]
    v_cvt_pk_bf16_f32 v182, v206, v207
    v_sub_f32 v208, v208, v248
    v_mfma_f32_16x16x32_bf16 v[216:219], v[34:37], v[192:195], v[216:219]
    ds_read_b128 v[204:207], v244 offset:0
    v_sub_f32 v209, v209, v248
    v_mfma_f32_16x16x32_bf16 v[220:223], v[64:67], v[192:195], v[220:223]
    s_waitcnt lgkmcnt(1)
    v_exp_f32 v208, v208
    v_mfma_f32_16x16x32_bf16 v[224:227], a[248:251], v[192:195], v[224:227]
    s_barrier
    v_exp_f32 v209, v209
    v_mfma_f32_16x16x32_bf16 v[212:215], v[8:11], v[180:183], v[212:215]
    ds_read_b128 a[216:219], v242 offset:0
    v_cvt_pk_bf16_f32 v186, v208, v209
    v_mfma_f32_16x16x32_bf16 v[216:219], v[38:41], v[180:183], v[216:219]
    ds_read_b128 a[220:223], v243 offset:0
    v_sub_f32 v196, v196, v248
    v_mfma_f32_16x16x32_bf16 v[220:223], v[68:71], v[180:183], v[220:223]
    ds_read_b128 v[208:211], v245 offset:0
    v_sub_f32 v197, v197, v248
    v_mfma_f32_16x16x32_bf16 v[224:227], a[248:251], v[180:183], v[224:227]
    ds_read_b128 a[252:255], v252 offset:12288
    v_add_u32 v251, s50, v251
    v_mfma_f32_16x16x32_bf16 v[200:203], v[90:93], v[168:171], v[200:203]
    ds_read_b64 v[168:169], v247 offset:36864
    s_mul_i32 s50, s30, 0
    v_mfma_f32_16x16x32_bf16 v[200:203], v[92:95], v[170:173], v[200:203]
    ds_read_b64 v[170:171], v247 offset:36992
    s_add_u32 s50, s50, s51
    v_mfma_f32_16x16x32_bf16 v[236:239], a[156:159], a[236:239], v[236:239]
    ds_read_b64 v[172:173], v247 offset:37120
    s_waitcnt lgkmcnt(7)
    v_mfma_f32_16x16x32_bf16 v[204:207], v[144:147], v[174:177], v[204:207]
    ds_read_b64 v[254:255], v253 offset:12544
    v_mfma_f32_16x16x32_bf16 v[204:207], v[146:149], v[176:179], v[204:207]
    v_exp_f32 v196, v196
    v_mfma_f32_16x16x32_bf16 v[236:239], a[160:163], a[240:243], v[236:239]
    v_exp_f32 v197, v197
    v_mfma_f32_16x16x32_bf16 v[236:239], a[164:167], a[244:247], v[236:239]
    v_cvt_pk_bf16_f32 v184, v196, v197
    v_sub_f32 v200, v200, v248
    v_mfma_f32_16x16x32_bf16 v[228:231], a[168:171], a[224:227], 0
    ds_read_b128 v[196:199], v246 offset:0
    v_sub_f32 v201, v201, v248
    v_mfma_f32_16x16x32_bf16 v[228:231], a[172:175], a[228:231], v[228:231]
    s_waitcnt lgkmcnt(5)
    v_exp_f32 v200, v200
    v_mfma_f32_16x16x32_bf16 v[208:211], v[108:111], v[174:177], v[208:211]
    buffer_store_dwordx4 a[252:255], v250, s[20:23], 0 offen nt
    v_mfma_f32_16x16x32_bf16 v[208:211], v[110:113], v[176:179], v[208:211]
    v_cvt_pk_bf16_f32 v236, v236, v237
    v_cvt_pk_bf16_f32 v237, v238, v239
    v_mfma_f32_16x16x32_bf16 v[228:231], a[176:179], a[232:235], v[228:231]
    ds_write_b64 v249, v[236:237] offset:18432
    v_mfma_f32_16x16x32_bf16 v[228:231], a[180:183], a[236:239], v[228:231]
    s_waitcnt lgkmcnt(2)
    v_exp_f32 v201, v201
    v_mfma_f32_16x16x32_bf16 v[228:231], a[184:187], a[240:243], v[228:231]
    buffer_store_dwordx2 v[254:255], v251, s[20:23], 0 offen offset:256 nt
    v_mfma_f32_16x16x32_bf16 v[228:231], a[188:191], a[244:247], v[228:231]
    s_waitcnt lgkmcnt(1)
    v_cvt_pk_bf16_f32 v185, v200, v201
    v_add_u32 v250, s52, v250
    v_mfma_f32_16x16x32_bf16 v[196:199], v[132:135], v[174:177], v[196:199]
    ds_read_b128 v[200:203], v244 offset:64
    v_add_u32 v251, s52, v251
    v_mfma_f32_16x16x32_bf16 v[212:215], v[12:15], v[184:187], v[212:215]
    s_add_u32 s52, s28, 11
    v_cvt_pk_bf16_f32 v228, v228, v229
    v_cvt_pk_bf16_f32 v229, v230, v231
    v_mfma_f32_16x16x32_bf16 v[216:219], v[42:45], v[184:187], v[216:219]
    ds_write_b64 v249, v[228:229] offset:18560
    v_mfma_f32_16x16x32_bf16 v[220:223], v[72:75], v[184:187], v[220:223]
    s_mul_i32 s52, s52, s30
    v_max_f32 v248, v204, v205
    v_max3_f32 v248, v248, v206, v207
    v_mfma_f32_16x16x32_bf16 v[224:227], a[248:251], v[184:187], v[224:227]
    ds_read_b128 v[204:207], v245 offset:64
    v_max3_f32 v248, v248, v208, v209
    v_mfma_f32_16x16x32_bf16 v[196:199], v[134:137], v[176:179], v[196:199]
    v_max3_f32 v248, v248, v210, v211
    v_mfma_f32_16x16x32_bf16 v[232:235], a[192:195], a[224:227], 0
    ds_read_b128 a[224:227], v242 offset:128
    v_mfma_f32_16x16x32_bf16 v[232:235], a[196:199], a[228:231], v[232:235]
    ds_read_b128 a[228:231], v243 offset:128
    v_mfma_f32_16x16x32_bf16 v[232:235], a[200:203], a[232:235], v[232:235]
    ds_read_b128 a[232:235], v242 offset:256
    s_waitcnt lgkmcnt(5)
    v_mfma_f32_16x16x32_bf16 v[200:203], v[150:153], v[174:177], v[200:203]
    ds_read_b128 v[208:211], v246 offset:64
    v_max3_f32 v248, v248, v196, v197
    v_mfma_f32_16x16x32_bf16 v[200:203], v[152:155], v[176:179], v[200:203]
    v_rcp_f32 v225, v224
    v_mfma_f32_16x16x32_bf16 v[232:235], a[204:207], a[236:239], v[232:235]
    ds_read_b128 a[236:239], v243 offset:256
    v_mul_f32 v212, v212, v225
    v_mfma_f32_16x16x32_bf16 v[232:235], a[208:211], a[240:243], v[232:235]
    ds_read_b128 a[240:243], v240 offset:6144
    v_mul_f32 v213, v213, v225
    v_mfma_f32_16x16x32_bf16 v[232:235], a[212:215], a[244:247], v[232:235]
    ds_read_b128 a[244:247], v241 offset:6144
    v_mul_f32 v214, v214, v225
    v_mfma_f32_16x16x32_bf16 v[236:239], a[144:147], a[216:219], 0
    s_waitcnt lgkmcnt(7)
    v_mul_f32 v215, v215, v225
    v_cvt_pk_bf16_f32 v212, v212, v213
    v_mfma_f32_16x16x32_bf16 v[204:207], v[162:165], v[174:177], v[204:207]
    v_cvt_pk_bf16_f32 v213, v214, v215
    v_cvt_pk_bf16_f32 v232, v232, v233
    v_mfma_f32_16x16x32_bf16 v[204:207], v[164:167], v[176:179], v[204:207]
    ds_write_b64 v247, v[212:213] offset:24576
    v_mfma_f32_16x16x32_bf16 v[236:239], a[148:151], a[220:223], v[236:239]
    s_waitcnt lgkmcnt(4)
    v_cvt_pk_bf16_f32 v233, v234, v235
    v_mul_f32 v216, v216, v225
    v_mfma_f32_16x16x32_bf16 v[208:211], v[90:93], v[174:177], v[208:211]
    ds_write_b64 v249, v[232:233] offset:18688
    v_mfma_f32_16x16x32_bf16 v[208:211], v[92:95], v[176:179], v[208:211]
    v_mul_f32 v217, v217, v225
    v_mul_f32 v218, v218, v225
    v_mfma_f32_16x16x32_bf16 v[236:239], a[152:155], a[224:227], v[236:239]
    v_mul_f32 v219, v219, v225
    v_cvt_pk_bf16_f32 v216, v216, v217
    v_mfma_f32_16x16x32_bf16 v[236:239], a[156:159], a[228:231], v[236:239]
    v_cvt_pk_bf16_f32 v217, v218, v219
    v_mul_f32 v220, v220, v225
    v_mfma_f32_16x16x32_bf16 v[236:239], a[160:163], a[232:235], v[236:239]
    ds_write_b64 v247, v[216:217] offset:24704
    v_mfma_f32_16x16x32_bf16 v[228:231], a[168:171], a[216:219], 0
    s_waitcnt lgkmcnt(3)
    v_mul_f32 v221, v221, v225
    v_mul_f32 v222, v222, v225
    v_mfma_f32_16x16x32_bf16 v[236:239], a[164:167], a[236:239], v[236:239]
    v_mul_f32 v223, v223, v225
    v_cvt_pk_bf16_f32 v220, v220, v221
    v_mfma_f32_16x16x32_bf16 v[228:231], a[172:175], a[220:223], v[228:231]
    v_cvt_pk_bf16_f32 v221, v222, v223
    v_max3_f32 v248, v248, v198, v199
    v_mfma_f32_16x16x32_bf16 v[228:231], a[176:179], a[224:227], v[228:231]
    ds_read_b128 v[196:199], v244 offset:128
    v_max3_f32 v248, v248, v200, v201
    v_mfma_f32_16x16x32_bf16 v[228:231], a[180:183], a[228:231], v[228:231]
    ds_write_b64 v247, v[220:221] offset:24832
    v_mfma_f32_16x16x32_bf16 v[228:231], a[184:187], a[232:235], v[228:231]
    v_cvt_pk_bf16_f32 v236, v236, v237
    v_cvt_pk_bf16_f32 v237, v238, v239
    v_mfma_f32_16x16x32_bf16 v[228:231], a[188:191], a[236:239], v[228:231]
    v_max3_f32 v248, v248, v202, v203
    v_max3_f32 v248, v248, v204, v205
    v_mfma_f32_16x16x32_bf16 v[232:235], a[192:195], a[216:219], 0
    ds_read_b128 a[216:219], v240 offset:6272
    v_max3_f32 v248, v248, v206, v207
    v_mfma_f32_16x16x32_bf16 v[232:235], a[196:199], a[220:223], v[232:235]
    ds_read_b128 a[220:223], v241 offset:6272
    v_max3_f32 v248, v248, v208, v209
    v_mfma_f32_16x16x32_bf16 v[232:235], a[200:203], a[224:227], v[232:235]
    ds_read_b128 a[224:227], v240 offset:6400
    v_cvt_pk_bf16_f32 v228, v228, v229
    v_mfma_f32_16x16x32_bf16 v[232:235], a[204:207], a[228:231], v[232:235]
    ds_read_b128 a[228:231], v241 offset:6400
    v_cvt_pk_bf16_f32 v229, v230, v231
    v_mfma_f32_16x16x32_bf16 v[232:235], a[208:211], a[232:235], v[232:235]
    ds_read_b128 v[200:203], v245 offset:128
    v_max3_f32 v248, v248, v210, v211
    v_mfma_f32_16x16x32_bf16 v[232:235], a[212:215], a[236:239], v[232:235]
    s_waitcnt lgkmcnt(6)
    ds_read_b128 v[204:207], v246 offset:128
    v_mfma_f32_16x16x32_bf16 v[196:199], v[156:159], v[174:177], v[196:199]
    ds_read_b128 v[208:211], v244 offset:0
    s_waitcnt lgkmcnt(7)
    v_mfma_f32_16x16x32_bf16 v[196:199], v[158:161], v[176:179], v[196:199]
    s_barrier
    ds_write_b64 v249, v[236:237] offset:0
    v_mfma_f32_16x16x32_bf16 v[236:239], a[0:3], a[240:243], 0
    ds_write_b64 v249, v[228:229] offset:128
    v_mfma_f32_16x16x32_bf16 v[236:239], a[4:7], a[244:247], v[236:239]
    ds_read_b128 a[232:235], v242 offset:24576
    v_cvt_pk_bf16_f32 v232, v232, v233
    v_mfma_f32_16x16x32_bf16 v[228:231], a[24:27], a[240:243], 0
    ds_read_b128 a[236:239], v243 offset:24576
    v_cvt_pk_bf16_f32 v233, v234, v235
    v_mfma_f32_16x16x32_bf16 v[228:231], a[28:31], a[244:247], v[228:231]
    s_waitcnt lgkmcnt(7)
    v_max3_f32 v248, v248, v196, v197
    s_waitcnt lgkmcnt(6)
    v_mfma_f32_16x16x32_bf16 v[200:203], v[114:117], v[174:177], v[200:203]
    ds_write_b64 v249, v[232:233] offset:256
    v_mfma_f32_16x16x32_bf16 v[200:203], v[116:119], v[176:179], v[200:203]
    ds_read_b128 v[196:199], v245 offset:0
    s_waitcnt lgkmcnt(6)
    v_mfma_f32_16x16x32_bf16 v[204:207], v[138:141], v[174:177], v[204:207]
    ds_read_b128 a[252:255], v252 offset:18432
    v_mfma_f32_16x16x32_bf16 v[204:207], v[140:143], v[176:179], v[204:207]
    ds_read_b64 v[254:255], v253 offset:18688
    v_mfma_f32_16x16x32_bf16 v[208:211], v[144:147], v[174:177], v[208:211]
    v_mfma_f32_16x16x32_bf16 v[208:211], v[146:149], v[176:179], v[208:211]
    v_max3_f32 v248, v248, v200, v201
    v_mfma_f32_16x16x32_bf16 v[236:239], a[8:11], a[216:219], v[236:239]
    ds_read_b128 v[200:203], v246 offset:0
    v_mfma_f32_16x16x32_bf16 v[236:239], a[12:15], a[220:223], v[236:239]
    v_mfma_f32_16x16x32_bf16 v[236:239], a[16:19], a[224:227], v[236:239]
    v_max3_f32 v248, v248, v204, v205
    v_mov_b32 v225, v248
    v_mfma_f32_16x16x32_bf16 v[236:239], a[20:23], a[228:231], v[236:239]
    ds_read_b128 v[204:207], v244 offset:64
    v_permlane16_swap_b32 v248, v225
    v_mfma_f32_16x16x32_bf16 v[228:231], a[32:35], a[216:219], v[228:231]
    s_waitcnt lgkmcnt(4)
    v_max_f32 v248, v248, v225
    v_mov_b32 v225, v248
    v_mfma_f32_16x16x32_bf16 v[196:199], v[108:111], v[174:177], v[196:199]
    s_waitcnt lgkmcnt(3)
    v_cvt_pk_bf16_f32 v144, v236, v237
    v_cvt_pk_bf16_f32 v145, v238, v239
    v_mfma_f32_16x16x32_bf16 v[196:199], v[110:113], v[176:179], v[196:199]
    buffer_store_dwordx4 a[252:255], v250, s[20:23], 0 offen nt
    v_mfma_f32_16x16x32_bf16 v[228:231], a[36:39], a[220:223], v[228:231]
    s_waitcnt lgkmcnt(2)
    v_permlane32_swap_b32 v248, v225
    v_max_f32 v248, v248, v225
    v_mfma_f32_16x16x32_bf16 v[228:231], a[40:43], a[224:227], v[228:231]
    s_waitcnt lgkmcnt(1)
    v_sub_f32 v208, v208, v248
    v_sub_f32 v209, v209, v248
    v_mfma_f32_16x16x32_bf16 v[200:203], v[132:135], v[174:177], v[200:203]
    v_exp_f32 v208, v208
    v_mfma_f32_16x16x32_bf16 v[200:203], v[134:137], v[176:179], v[200:203]
    buffer_store_dwordx2 v[254:255], v251, s[20:23], 0 offen offset:256 nt
    v_mfma_f32_16x16x32_bf16 v[228:231], a[44:47], a[228:231], v[228:231]
    s_waitcnt lgkmcnt(0)
    v_exp_f32 v209, v209
    v_mfma_f32_16x16x32_bf16 v[204:207], v[150:153], v[174:177], v[204:207]
    v_sub_f32 v210, v210, v248
    v_sub_f32 v211, v211, v248
    v_mfma_f32_16x16x32_bf16 v[204:207], v[152:155], v[176:179], v[204:207]
    v_exp_f32 v210, v210
    v_mfma_f32_16x16x32_bf16 v[232:235], a[48:51], a[240:243], 0
    v_cvt_pk_bf16_f32 v146, v228, v229
    v_cvt_pk_bf16_f32 v147, v230, v231
    v_mfma_f32_16x16x32_bf16 v[232:235], a[52:55], a[244:247], v[232:235]
    v_exp_f32 v211, v211
    v_mfma_f32_16x16x32_bf16 v[232:235], a[56:59], a[216:219], v[232:235]
    v_cvt_pk_bf16_f32 v190, v208, v209
    v_cvt_pk_bf16_f32 v193, v210, v211
    v_mfma_f32_16x16x32_bf16 v[232:235], a[60:63], a[220:223], v[232:235]
    ds_read_b128 v[208:211], v245 offset:64
    v_sub_f32 v196, v196, v248
    v_mfma_f32_16x16x32_bf16 v[232:235], a[64:67], a[224:227], v[232:235]
    v_exp_f32 v196, v196
    v_mfma_f32_16x16x32_bf16 v[232:235], a[68:71], a[228:231], v[232:235]
    v_sub_f32 v197, v197, v248
    v_sub_f32 v198, v198, v248
    v_mfma_f32_16x16x32_bf16 v[236:239], a[240:243], a[72:75], 0
    v_exp_f32 v197, v197
    v_mfma_f32_16x16x32_bf16 v[236:239], a[244:247], a[76:79], v[236:239]
    v_exp_f32 v198, v198
    v_mfma_f32_16x16x32_bf16 v[236:239], a[216:219], a[80:83], v[236:239]
    v_sub_f32 v199, v199, v248
    v_cvt_pk_bf16_f32 v148, v232, v233
    v_mfma_f32_16x16x32_bf16 v[236:239], a[220:223], a[84:87], v[236:239]
    v_cvt_pk_bf16_f32 v149, v234, v235
    v_cvt_pk_bf16_f32 v188, v196, v197
    v_mfma_f32_16x16x32_bf16 v[236:239], a[224:227], a[88:91], v[236:239]
    v_exp_f32 v199, v199
    v_mfma_f32_16x16x32_bf16 v[236:239], a[228:231], a[92:95], v[236:239]
    v_cvt_pk_bf16_f32 v191, v198, v199
    v_sub_f32 v200, v200, v248
    v_mfma_f32_16x16x32_bf16 v[228:231], a[240:243], a[96:99], 0
    ds_read_b128 v[196:199], v246 offset:64
    v_sub_f32 v201, v201, v248
    v_mfma_f32_16x16x32_bf16 v[228:231], a[244:247], a[100:103], v[228:231]
    s_waitcnt lgkmcnt(1)
    v_exp_f32 v200, v200
    v_mfma_f32_16x16x32_bf16 v[208:211], v[162:165], v[174:177], v[208:211]
    v_cvt_pk_bf16_f32 v25, v236, v237
    v_cvt_pk_bf16_f32 v28, v238, v239
    v_mfma_f32_16x16x32_bf16 v[208:211], v[164:167], v[176:179], v[208:211]
    v_exp_f32 v201, v201
    v_mfma_f32_16x16x32_bf16 v[228:231], a[216:219], a[104:107], v[228:231]
    v_sub_f32 v202, v202, v248
    v_sub_f32 v203, v203, v248
    v_mfma_f32_16x16x32_bf16 v[228:231], a[220:223], a[108:111], v[228:231]
    v_exp_f32 v202, v202
    v_mfma_f32_16x16x32_bf16 v[228:231], a[224:227], a[112:115], v[228:231]
    v_exp_f32 v203, v203
    v_mfma_f32_16x16x32_bf16 v[228:231], a[228:231], a[116:119], v[228:231]
    v_cvt_pk_bf16_f32 v189, v200, v201
    v_cvt_pk_bf16_f32 v192, v202, v203
    v_mfma_f32_16x16x32_bf16 v[232:235], a[240:243], a[120:123], 0
    ds_read_b128 a[240:243], v242 offset:24704
    v_sub_f32 v204, v204, v248
    v_mfma_f32_16x16x32_bf16 v[212:215], v[6:9], v[188:191], 0
    ds_read_b128 v[200:203], v244 offset:128
    v_sub_f32 v205, v205, v248
    v_mfma_f32_16x16x32_bf16 v[216:219], v[36:39], v[188:191], 0
    s_waitcnt lgkmcnt(2)
    v_cvt_pk_bf16_f32 v55, v228, v229
    v_cvt_pk_bf16_f32 v58, v230, v231
    v_mfma_f32_16x16x32_bf16 v[220:223], v[66:69], v[188:191], 0
    v_exp_f32 v204, v204
    v_mfma_f32_16x16x32_bf16 v[224:227], a[248:251], v[188:191], 0
    v_exp_f32 v205, v205
    v_mfma_f32_16x16x32_bf16 v[196:199], v[90:93], v[174:177], v[196:199]
    v_sub_f32 v206, v206, v248
    v_sub_f32 v207, v207, v248
    v_mfma_f32_16x16x32_bf16 v[196:199], v[92:95], v[176:179], v[196:199]
    v_exp_f32 v206, v206
    v_mfma_f32_16x16x32_bf16 v[232:235], a[244:247], a[124:127], v[232:235]
    ds_read_b128 a[244:247], v243 offset:24704
    v_cvt_pk_bf16_f32 v180, v204, v205
    v_mfma_f32_16x16x32_bf16 v[232:235], a[216:219], a[128:131], v[232:235]
    ds_read_b128 a[216:219], v242 offset:24832
    v_sub_f32 v208, v208, v248
    v_mfma_f32_16x16x32_bf16 v[232:235], a[220:223], a[132:135], v[232:235]
    ds_read_b128 a[220:223], v243 offset:24832
    v_sub_f32 v209, v209, v248
    v_mfma_f32_16x16x32_bf16 v[232:235], a[224:227], a[136:139], v[232:235]
    s_waitcnt lgkmcnt(3)
    v_exp_f32 v207, v207
    v_mfma_f32_16x16x32_bf16 v[200:203], v[156:159], v[174:177], v[200:203]
    v_cvt_pk_bf16_f32 v183, v206, v207
    v_sub_f32 v210, v210, v248
    v_mfma_f32_16x16x32_bf16 v[200:203], v[158:161], v[176:179], v[200:203]
    ds_read_b128 v[204:207], v245 offset:128
    v_sub_f32 v211, v211, v248
    v_mfma_f32_16x16x32_bf16 v[232:235], a[228:231], a[140:143], v[232:235]
    v_exp_f32 v208, v208
    v_mfma_f32_16x16x32_bf16 v[236:239], a[144:147], a[232:235], 0
    v_exp_f32 v209, v209
    v_mfma_f32_16x16x32_bf16 v[236:239], a[148:151], a[236:239], v[236:239]
    v_exp_f32 v210, v210
    v_mfma_f32_16x16x32_bf16 v[236:239], a[152:155], a[240:243], v[236:239]
    s_waitcnt lgkmcnt(3)
    v_exp_f32 v211, v211
    v_mfma_f32_16x16x32_bf16 v[236:239], a[156:159], a[244:247], v[236:239]
    s_waitcnt lgkmcnt(2)
    v_cvt_pk_bf16_f32 v85, v232, v233
    v_cvt_pk_bf16_f32 v88, v234, v235
    v_mfma_f32_16x16x32_bf16 v[236:239], a[160:163], a[216:219], v[236:239]
    s_waitcnt lgkmcnt(1)
    v_cvt_pk_bf16_f32 v194, v208, v209
    v_cvt_pk_bf16_f32 v181, v210, v211
    v_mfma_f32_16x16x32_bf16 v[236:239], a[164:167], a[220:223], v[236:239]
    ds_read_b128 v[208:211], v246 offset:128
    v_sub_f32 v196, v196, v248
    v_mfma_f32_16x16x32_bf16 v[228:231], a[168:171], a[232:235], 0
    v_exp_f32 v196, v196
    v_mfma_f32_16x16x32_bf16 v[228:231], a[172:175], a[236:239], v[228:231]
    s_waitcnt lgkmcnt(1)
    v_sub_f32 v197, v197, v248
    v_sub_f32 v198, v198, v248
    v_mfma_f32_16x16x32_bf16 v[204:207], v[114:117], v[174:177], v[204:207]
    v_cvt_pk_bf16_f32 v236, v236, v237
    v_cvt_pk_bf16_f32 v237, v238, v239
    v_mfma_f32_16x16x32_bf16 v[204:207], v[116:119], v[176:179], v[204:207]
    v_exp_f32 v197, v197
    v_mfma_f32_16x16x32_bf16 v[228:231], a[176:179], a[240:243], v[228:231]
    v_exp_f32 v198, v198
    v_mfma_f32_16x16x32_bf16 v[228:231], a[180:183], a[244:247], v[228:231]
    v_sub_f32 v199, v199, v248
    v_cvt_pk_bf16_f32 v195, v196, v197
    v_mfma_f32_16x16x32_bf16 v[228:231], a[184:187], a[216:219], v[228:231]
    v_exp_f32 v199, v199
    v_mfma_f32_16x16x32_bf16 v[212:215], v[10:13], v[192:195], v[212:215]
    v_cvt_pk_bf16_f32 v182, v198, v199
    v_sub_f32 v200, v200, v248
    v_mfma_f32_16x16x32_bf16 v[216:219], v[40:43], v[192:195], v[216:219]
    ds_read_b128 v[196:199], v244 offset:0
    v_sub_f32 v201, v201, v248
    v_mfma_f32_16x16x32_bf16 v[220:223], v[70:73], v[192:195], v[220:223]
    s_waitcnt lgkmcnt(1)
    v_exp_f32 v200, v200
    v_mfma_f32_16x16x32_bf16 v[224:227], a[248:251], v[192:195], v[224:227]
    v_exp_f32 v201, v201
    v_mfma_f32_16x16x32_bf16 v[212:215], v[14:17], v[180:183], v[212:215]
    v_cvt_pk_bf16_f32 v186, v200, v201
    v_sub_f32 v204, v204, v248
    v_mfma_f32_16x16x32_bf16 v[216:219], v[44:47], v[180:183], v[216:219]
    ds_read_b128 v[200:203], v245 offset:0
    v_sub_f32 v205, v205, v248
    v_mfma_f32_16x16x32_bf16 v[220:223], v[74:77], v[180:183], v[220:223]
    v_exp_f32 v204, v204
    v_mfma_f32_16x16x32_bf16 v[224:227], a[248:251], v[180:183], v[224:227]
    v_exp_f32 v205, v205
    v_mfma_f32_16x16x32_bf16 v[208:211], v[138:141], v[174:177], v[208:211]
    ds_read_b64 v[174:175], v247 offset:43008
    v_cvt_pk_bf16_f32 v184, v204, v205
    v_mfma_f32_16x16x32_bf16 v[208:211], v[140:143], v[176:179], v[208:211]
    ds_read_b128 v[204:207], v246 offset:0
    v_mbcnt_lo_u32_b32 v254, -1, 0
    v_mfma_f32_16x16x32_bf16 v[228:231], a[188:191], a[220:223], v[228:231]
    ds_read_b64 v[176:177], v247 offset:43136
    v_mbcnt_hi_u32_b32 v254, -1, v254
    v_mfma_f32_16x16x32_bf16 v[232:235], a[192:195], a[232:235], 0
    ds_read_b64 v[178:179], v247 offset:43264
    v_lshrrev_b32 v255, 4, v254
    v_mfma_f32_16x16x32_bf16 v[232:235], a[196:199], a[236:239], v[232:235]
    s_waitcnt lgkmcnt(5)
    v_sub_f32 v208, v208, v248
    v_cvt_pk_bf16_f32 v228, v228, v229
    v_mfma_f32_16x16x32_bf16 v[196:199], v[150:153], v[168:171], v[196:199]
    v_cvt_pk_bf16_f32 v229, v230, v231
    v_sub_f32 v209, v209, v248
    v_mfma_f32_16x16x32_bf16 v[196:199], v[152:155], v[170:173], v[196:199]
    s_waitcnt lgkmcnt(4)
    v_exp_f32 v208, v208
    v_mfma_f32_16x16x32_bf16 v[200:203], v[162:165], v[168:171], v[200:203]
    v_exp_f32 v209, v209
    v_mfma_f32_16x16x32_bf16 v[200:203], v[164:167], v[170:173], v[200:203]
    v_cvt_pk_bf16_f32 v185, v208, v209
    v_and_b32 v251, 2, v255
    v_mfma_f32_16x16x32_bf16 v[232:235], a[200:203], a[240:243], v[232:235]
    ds_read_b128 v[208:211], v244 offset:64
    v_lshlrev_b32 v251, 1, v251
    v_mfma_f32_16x16x32_bf16 v[212:215], v[18:21], v[184:187], v[212:215]
    s_waitcnt lgkmcnt(3)
    v_mul_i32_i24 v251, s30, v251
    v_and_b32 v250, 1, v255
    v_mfma_f32_16x16x32_bf16 v[216:219], v[48:51], v[184:187], v[216:219]
    v_mad_i32_i24 v250, v250, s31, v251
    v_add_u32 v250, s54, v250
    v_mfma_f32_16x16x32_bf16 v[220:223], v[78:81], v[184:187], v[220:223]
    s_and_b32 s54, s28, 1
    v_and_b32 v254, 15, v254
    v_lshl_add_u32 v251, v254, 3, v250
    v_mfma_f32_16x16x32_bf16 v[224:227], a[248:251], v[184:187], v[224:227]
    s_add_u32 s54, s54, 15
    v_lshlrev_b32 v255, 3, v255
    v_and_b32 v255, 8, v255
    v_mfma_f32_16x16x32_bf16 v[204:207], v[90:93], v[168:171], v[204:207]
    s_mul_i32 s54, s54, s30
    v_xor_b32 v254, v254, v255
    v_lshl_add_u32 v250, v254, 4, v250
    v_mfma_f32_16x16x32_bf16 v[204:207], v[92:95], v[170:173], v[204:207]
    s_add_u32 s54, s54, s55
    v_rcp_f32 v225, v224
    v_mfma_f32_16x16x32_bf16 v[232:235], a[204:207], a[244:247], v[232:235]
    s_add_u32 s54, s54, s32
    v_mul_f32 v212, v212, v225
    v_mul_f32 v213, v213, v225
    v_mfma_f32_16x16x32_bf16 v[232:235], a[208:211], a[216:219], v[232:235]
    v_mul_f32 v214, v214, v225
    v_mul_f32 v215, v215, v225
    v_mfma_f32_16x16x32_bf16 v[232:235], a[212:215], a[220:223], v[232:235]
    s_waitcnt lgkmcnt(0)
    v_cvt_pk_bf16_f32 v212, v212, v213
    v_cvt_pk_bf16_f32 v213, v214, v215
    v_mfma_f32_16x16x32_bf16 v[208:211], v[156:159], v[168:171], v[208:211]
    ds_write_b64 v247, v[212:213] offset:30720
    v_mfma_f32_16x16x32_bf16 v[208:211], v[158:161], v[170:173], v[208:211]
    v_mul_f32 v216, v216, v225
    v_mul_f32 v217, v217, v225
    v_cvt_pk_bf16_f32 v232, v232, v233
    v_cvt_pk_bf16_f32 v233, v234, v235
    v_mul_f32 v218, v218, v225
    v_mul_f32 v219, v219, v225
    v_cvt_pk_bf16_f32 v216, v216, v217
    v_cvt_pk_bf16_f32 v217, v218, v219
    ds_write_b64 v247, v[216:217] offset:30848
    v_mul_f32 v220, v220, v225
    v_mul_f32 v221, v221, v225
    v_mul_f32 v222, v222, v225
    v_mul_f32 v223, v223, v225
    v_cvt_pk_bf16_f32 v220, v220, v221
    v_cvt_pk_bf16_f32 v221, v222, v223
    ds_write_b64 v247, v[220:221] offset:30976
    v_max_f32 v248, v196, v197
    v_max3_f32 v248, v248, v198, v199
    ds_read_b128 v[196:199], v245 offset:64
    v_max3_f32 v248, v248, v200, v201
    v_max3_f32 v248, v248, v202, v203
    ds_read_b128 v[200:203], v246 offset:64
    v_max3_f32 v248, v248, v204, v205
    v_max3_f32 v248, v248, v206, v207
    ds_read_b128 v[204:207], v244 offset:128
    v_max3_f32 v248, v248, v208, v209
    v_max3_f32 v248, v248, v210, v211
    ds_read_b128 v[208:211], v245 offset:128
    s_waitcnt lgkmcnt(4)
    s_barrier
    ds_write_b64 v249, v[236:237] offset:24576
    ds_write_b64 v249, v[228:229] offset:24704
    ds_write_b64 v249, v[232:233] offset:24832
    ds_read_b128 a[224:227], v242 offset:30720
    ds_read_b128 a[228:231], v243 offset:30720
    ds_read_b128 a[232:235], v242 offset:30848
    ds_read_b128 a[236:239], v243 offset:30848
    ds_read_b128 a[240:243], v242 offset:30976
    ds_read_b128 a[244:247], v243 offset:30976
    ds_read_b128 a[252:255], v252 offset:0
    ds_read_b64 v[254:255], v253 offset:256
    s_waitcnt lgkmcnt(11)
    v_mfma_f32_16x16x32_bf16 v[196:199], v[114:117], v[168:171], v[196:199]
    v_mfma_f32_16x16x32_bf16 v[196:199], v[116:119], v[170:173], v[196:199]
    v_mfma_f32_16x16x32_bf16 v[200:203], v[138:141], v[168:171], v[200:203]
    v_mfma_f32_16x16x32_bf16 v[200:203], v[140:143], v[170:173], v[200:203]
    v_mfma_f32_16x16x32_bf16 v[204:207], v[96:99], v[168:171], v[204:207]
    v_mfma_f32_16x16x32_bf16 v[204:207], v[98:101], v[170:173], v[204:207]
    v_mfma_f32_16x16x32_bf16 v[208:211], v[120:123], v[168:171], v[208:211]
    s_waitcnt lgkmcnt(7)
    v_mfma_f32_16x16x32_bf16 v[208:211], v[122:125], v[170:173], v[208:211]
    v_mfma_f32_16x16x32_bf16 v[236:239], a[144:147], a[224:227], 0
    s_waitcnt lgkmcnt(5)
    v_max3_f32 v248, v248, v196, v197
    v_max3_f32 v248, v248, v198, v199
    v_mfma_f32_16x16x32_bf16 v[236:239], a[148:151], a[228:231], v[236:239]
    ds_read_b128 v[196:199], v246 offset:128
    v_max3_f32 v248, v248, v200, v201
    v_mfma_f32_16x16x32_bf16 v[236:239], a[152:155], a[232:235], v[236:239]
    s_waitcnt lgkmcnt(4)
    v_max3_f32 v248, v248, v202, v203
    v_max3_f32 v248, v248, v204, v205
    v_mfma_f32_16x16x32_bf16 v[236:239], a[156:159], a[236:239], v[236:239]
    ds_read_b128 v[200:203], v244 offset:0
    v_max3_f32 v248, v248, v208, v209
    v_mfma_f32_16x16x32_bf16 v[236:239], a[160:163], a[240:243], v[236:239]
    ds_read_b128 v[204:207], v245 offset:0
    s_waitcnt lgkmcnt(3)
    v_mfma_f32_16x16x32_bf16 v[236:239], a[164:167], a[244:247], v[236:239]
    ds_read_b128 v[208:211], v246 offset:0
    v_mfma_f32_16x16x32_bf16 v[228:231], a[168:171], a[224:227], 0
    buffer_store_dwordx4 a[252:255], v250, s[20:23], 0 offen nt
    v_mfma_f32_16x16x32_bf16 v[228:231], a[172:175], a[228:231], v[228:231]
    v_mfma_f32_16x16x32_bf16 v[228:231], a[176:179], a[232:235], v[228:231]
    v_mfma_f32_16x16x32_bf16 v[228:231], a[180:183], a[236:239], v[228:231]
    s_waitcnt lgkmcnt(3)
    v_mfma_f32_16x16x32_bf16 v[196:199], v[144:147], v[168:171], v[196:199]
    buffer_store_dwordx2 v[254:255], v251, s[20:23], 0 offen offset:256 nt
    v_mfma_f32_16x16x32_bf16 v[196:199], v[146:149], v[170:173], v[196:199]
    s_waitcnt lgkmcnt(2)
    v_cvt_pk_bf16_f32 v236, v236, v237
    v_cvt_pk_bf16_f32 v237, v238, v239
    v_mfma_f32_16x16x32_bf16 v[200:203], v[150:153], v[168:171], v[200:203]
    s_waitcnt lgkmcnt(1)
    v_mbcnt_lo_u32_b32 v254, -1, 0
    v_mbcnt_hi_u32_b32 v254, -1, v254
    v_mfma_f32_16x16x32_bf16 v[200:203], v[152:155], v[170:173], v[200:203]
    s_waitcnt lgkmcnt(0)
    v_max3_f32 v248, v248, v196, v197
    v_mov_b32 v225, v248
    v_mfma_f32_16x16x32_bf16 v[204:207], v[162:165], v[168:171], v[204:207]
    ds_read_b128 v[196:199], v244 offset:64
    v_permlane16_swap_b32 v248, v225
    v_mfma_f32_16x16x32_bf16 v[204:207], v[164:167], v[170:173], v[204:207]
    v_max_f32 v248, v248, v225
    v_mov_b32 v225, v248
    v_mfma_f32_16x16x32_bf16 v[208:211], v[90:93], v[168:171], v[208:211]
    v_lshrrev_b32 v255, 4, v254
    v_permlane32_swap_b32 v248, v225
    v_mfma_f32_16x16x32_bf16 v[208:211], v[92:95], v[170:173], v[208:211]
    v_max_f32 v248, v248, v225
    v_sub_f32 v200, v200, v248
    v_mfma_f32_16x16x32_bf16 v[228:231], a[184:187], a[240:243], v[228:231]
    v_exp_f32 v200, v200
    v_mfma_f32_16x16x32_bf16 v[228:231], a[188:191], a[244:247], v[228:231]
    v_sub_f32 v201, v201, v248
    v_sub_f32 v202, v202, v248
    v_mfma_f32_16x16x32_bf16 v[232:235], a[192:195], a[224:227], 0
    v_exp_f32 v201, v201
    v_mfma_f32_16x16x32_bf16 v[232:235], a[196:199], a[228:231], v[232:235]
    v_exp_f32 v202, v202
    v_mfma_f32_16x16x32_bf16 v[232:235], a[200:203], a[232:235], v[232:235]
    v_sub_f32 v203, v203, v248
    v_cvt_pk_bf16_f32 v228, v228, v229
    v_mfma_f32_16x16x32_bf16 v[232:235], a[204:207], a[236:239], v[232:235]
    s_waitcnt lgkmcnt(0)
    v_cvt_pk_bf16_f32 v229, v230, v231
    v_cvt_pk_bf16_f32 v190, v200, v201
    v_mfma_f32_16x16x32_bf16 v[196:199], v[156:159], v[168:171], v[196:199]
    v_exp_f32 v203, v203
    v_mfma_f32_16x16x32_bf16 v[196:199], v[158:161], v[170:173], v[196:199]
    v_cvt_pk_bf16_f32 v193, v202, v203
    v_sub_f32 v204, v204, v248
    v_mfma_f32_16x16x32_bf16 v[232:235], a[208:211], a[240:243], v[232:235]
    ds_read_b128 v[200:203], v245 offset:64
    v_sub_f32 v205, v205, v248
    v_mfma_f32_16x16x32_bf16 v[232:235], a[212:215], a[244:247], v[232:235]
    v_exp_f32 v204, v204
    v_exp_f32 v205, v205
    v_sub_f32 v206, v206, v248
    v_exp_f32 v206, v206
    v_sub_f32 v207, v207, v248
    v_exp_f32 v207, v207
    v_cvt_pk_bf16_f32 v188, v204, v205
    v_cvt_pk_bf16_f32 v191, v206, v207
    v_cvt_pk_bf16_f32 v232, v232, v233
    v_cvt_pk_bf16_f32 v233, v234, v235
    ds_read_b128 v[204:207], v246 offset:64
    v_sub_f32 v208, v208, v248
    v_exp_f32 v208, v208
    v_sub_f32 v209, v209, v248
    v_exp_f32 v209, v209
    v_sub_f32 v210, v210, v248
    v_exp_f32 v210, v210
    v_sub_f32 v211, v211, v248
    v_exp_f32 v211, v211
    v_cvt_pk_bf16_f32 v189, v208, v209
    s_waitcnt lgkmcnt(1)
    v_mfma_f32_16x16x32_bf16 v[200:203], v[114:117], v[168:171], v[200:203]
    v_cvt_pk_bf16_f32 v192, v210, v211
    v_sub_f32 v196, v196, v248
    v_mfma_f32_16x16x32_bf16 v[212:215], v[12:15], v[188:191], 0
    ds_read_b128 v[208:211], v244 offset:128
    v_sub_f32 v197, v197, v248
    v_mfma_f32_16x16x32_bf16 v[216:219], v[42:45], v[188:191], 0
    v_exp_f32 v196, v196
    v_mfma_f32_16x16x32_bf16 v[220:223], v[72:75], v[188:191], 0
    v_exp_f32 v197, v197
    v_mfma_f32_16x16x32_bf16 v[224:227], a[248:251], v[188:191], 0
    s_waitcnt lgkmcnt(1)
    v_sub_f32 v198, v198, v248
    v_sub_f32 v199, v199, v248
    v_mfma_f32_16x16x32_bf16 v[200:203], v[116:119], v[170:173], v[200:203]
    v_exp_f32 v198, v198
    v_mfma_f32_16x16x32_bf16 v[204:207], v[138:141], v[168:171], v[204:207]
    v_exp_f32 v199, v199
    v_mfma_f32_16x16x32_bf16 v[204:207], v[140:143], v[170:173], v[204:207]
    v_cvt_pk_bf16_f32 v180, v196, v197
    v_cvt_pk_bf16_f32 v183, v198, v199
    ds_read_b128 v[196:199], v245 offset:128
    v_mul_i32_i24 v250, s31, v255
    v_sub_f32 v200, v200, v248
    v_exp_f32 v200, v200
    v_sub_f32 v201, v201, v248
    v_exp_f32 v201, v201
    v_sub_f32 v202, v202, v248
    v_exp_f32 v202, v202
    v_sub_f32 v203, v203, v248
    v_exp_f32 v203, v203
    v_cvt_pk_bf16_f32 v194, v200, v201
    v_cvt_pk_bf16_f32 v181, v202, v203
    ds_read_b128 v[200:203], v246 offset:128
    v_sub_f32 v204, v204, v248
    v_exp_f32 v204, v204
    v_sub_f32 v205, v205, v248
    v_exp_f32 v205, v205
    v_sub_f32 v206, v206, v248
    v_exp_f32 v206, v206
    v_sub_f32 v207, v207, v248
    v_exp_f32 v207, v207
    v_cvt_pk_bf16_f32 v195, v204, v205
    s_waitcnt lgkmcnt(1)
    v_mfma_f32_16x16x32_bf16 v[208:211], v[96:99], v[168:171], v[208:211]
    v_cvt_pk_bf16_f32 v182, v206, v207
    v_add_u32 v250, s56, v250
    v_mfma_f32_16x16x32_bf16 v[212:215], v[16:19], v[192:195], v[212:215]
    ds_read_b128 v[204:207], v244 offset:0
    v_and_b32 v254, 15, v254
    v_mfma_f32_16x16x32_bf16 v[216:219], v[46:49], v[192:195], v[216:219]
    s_and_b32 s56, s28, 1
    v_lshl_add_u32 v251, v254, 3, v250
    v_lshlrev_b32 v255, 3, v255
    v_mfma_f32_16x16x32_bf16 v[220:223], v[76:79], v[192:195], v[220:223]
    s_add_u32 s56, s56, 15
    v_and_b32 v255, 8, v255
    v_xor_b32 v254, v254, v255
    v_mfma_f32_16x16x32_bf16 v[224:227], a[248:251], v[192:195], v[224:227]
    s_mul_i32 s56, s56, s30
    v_lshl_add_u32 v250, v254, 4, v250
    s_waitcnt lgkmcnt(1)
    v_mfma_f32_16x16x32_bf16 v[212:215], v[20:23], v[180:183], v[212:215]
    v_mfma_f32_16x16x32_bf16 v[216:219], v[50:53], v[180:183], v[216:219]
    v_mfma_f32_16x16x32_bf16 v[220:223], v[80:83], v[180:183], v[220:223]
    v_mfma_f32_16x16x32_bf16 v[224:227], a[248:251], v[180:183], v[224:227]
    v_mfma_f32_16x16x32_bf16 v[208:211], v[98:101], v[170:173], v[208:211]
    v_mfma_f32_16x16x32_bf16 v[196:199], v[120:123], v[168:171], v[196:199]
    s_waitcnt lgkmcnt(0)
    v_mfma_f32_16x16x32_bf16 v[196:199], v[122:125], v[170:173], v[196:199]
    v_mfma_f32_16x16x32_bf16 v[200:203], v[144:147], v[168:171], v[200:203]
    ds_read_b64 v[168:169], v247 offset:49152
    v_mfma_f32_16x16x32_bf16 v[200:203], v[146:149], v[170:173], v[200:203]
    ds_read_b64 v[170:171], v247 offset:49280
    v_mfma_f32_16x16x32_bf16 v[204:207], v[156:159], v[174:177], v[204:207]
    ds_read_b64 v[172:173], v247 offset:49408
    v_sub_f32 v208, v208, v248
    v_mfma_f32_16x16x32_bf16 v[204:207], v[158:161], v[176:179], v[204:207]
    v_exp_f32 v208, v208
    v_sub_f32 v209, v209, v248
    v_exp_f32 v209, v209
    v_sub_f32 v196, v196, v248
    v_cvt_pk_bf16_f32 v186, v208, v209
    ds_read_b128 v[208:211], v245 offset:0
    v_exp_f32 v196, v196
    v_sub_f32 v197, v197, v248
    v_exp_f32 v197, v197
    v_sub_f32 v200, v200, v248
    v_cvt_pk_bf16_f32 v184, v196, v197
    ds_read_b128 v[196:199], v246 offset:0
    v_exp_f32 v200, v200
    v_sub_f32 v201, v201, v248
    v_exp_f32 v201, v201
    v_max_f32 v248, v204, v205
    v_cvt_pk_bf16_f32 v185, v200, v201
    ds_read_b128 v[200:203], v244 offset:64
    v_max3_f32 v248, v248, v206, v207
    v_mfma_f32_16x16x32_bf16 v[212:215], v[24:27], v[184:187], v[212:215]
    ds_read_b128 v[204:207], v245 offset:64
    v_mfma_f32_16x16x32_bf16 v[216:219], v[54:57], v[184:187], v[216:219]
    v_mfma_f32_16x16x32_bf16 v[220:223], v[84:87], v[184:187], v[220:223]
    v_mfma_f32_16x16x32_bf16 v[224:227], a[248:251], v[184:187], v[224:227]
    s_waitcnt lgkmcnt(3)
    v_mov_b32 v186, 0
    v_mfma_f32_16x16x32_bf16 v[208:211], v[114:117], v[174:177], v[208:211]
    v_mfma_f32_16x16x32_bf16 v[208:211], v[116:119], v[176:179], v[208:211]
    s_waitcnt lgkmcnt(2)
    v_mfma_f32_16x16x32_bf16 v[196:199], v[138:141], v[174:177], v[196:199]
    v_mfma_f32_16x16x32_bf16 v[196:199], v[140:143], v[176:179], v[196:199]
    s_nop 0
    s_waitcnt lgkmcnt(1)
    v_mfma_f32_16x16x32_bf16 v[200:203], v[96:99], v[174:177], v[200:203]
    v_rcp_f32 v225, v224
    v_mfma_f32_16x16x32_bf16 v[200:203], v[98:101], v[176:179], v[200:203]
    s_waitcnt lgkmcnt(0)
    v_mul_f32 v212, v212, v225
    v_mul_f32 v213, v213, v225
    v_mfma_f32_16x16x32_bf16 v[204:207], v[120:123], v[174:177], v[204:207]
    v_mul_f32 v214, v214, v225
    v_mul_f32 v215, v215, v225
    v_mfma_f32_16x16x32_bf16 v[204:207], v[122:125], v[176:179], v[204:207]
    v_cvt_pk_bf16_f32 v212, v212, v213
    v_cvt_pk_bf16_f32 v213, v214, v215
    ds_write_b64 v247, v[212:213] offset:36864
    v_mul_f32 v216, v216, v225
    v_mul_f32 v217, v217, v225
    v_mul_f32 v218, v218, v225
    v_mul_f32 v219, v219, v225
    v_cvt_pk_bf16_f32 v216, v216, v217
    v_cvt_pk_bf16_f32 v217, v218, v219
    ds_write_b64 v247, v[216:217] offset:36992
    v_mul_f32 v220, v220, v225
    v_mul_f32 v221, v221, v225
    v_mul_f32 v222, v222, v225
    v_mul_f32 v223, v223, v225
    v_cvt_pk_bf16_f32 v220, v220, v221
    v_cvt_pk_bf16_f32 v221, v222, v223
    ds_write_b64 v247, v[220:221] offset:37120
    v_max3_f32 v248, v248, v208, v209
    v_max3_f32 v248, v248, v210, v211
    ds_read_b128 v[208:211], v246 offset:64
    v_max3_f32 v248, v248, v196, v197
    v_max3_f32 v248, v248, v198, v199
    ds_read_b128 v[196:199], v244 offset:0
    v_max3_f32 v248, v248, v200, v201
    v_max3_f32 v248, v248, v202, v203
    ds_read_b128 v[200:203], v245 offset:0
    v_max3_f32 v248, v248, v204, v205
    v_max3_f32 v248, v248, v206, v207
    ds_read_b128 v[204:207], v246 offset:0
    s_waitcnt lgkmcnt(4)
    s_barrier
    ds_write_b64 v249, v[236:237] offset:30720
    ds_write_b64 v249, v[228:229] offset:30848
    ds_write_b64 v249, v[232:233] offset:30976
    ds_read_b128 a[216:219], v242 offset:36864
    ds_read_b128 a[220:223], v243 offset:36864
    ds_read_b128 a[224:227], v242 offset:36992
    ds_read_b128 a[228:231], v243 offset:36992
    ds_read_b128 a[232:235], v242 offset:37120
    ds_read_b128 a[236:239], v243 offset:37120
    ds_read_b128 a[252:255], v252 offset:24576
    ds_read_b64 v[254:255], v253 offset:24832
    s_waitcnt lgkmcnt(11)
    v_mfma_f32_16x16x32_bf16 v[208:211], v[144:147], v[174:177], v[208:211]
    v_mfma_f32_16x16x32_bf16 v[208:211], v[146:149], v[176:179], v[208:211]
    v_mfma_f32_16x16x32_bf16 v[196:199], v[156:159], v[174:177], v[196:199]
    v_mfma_f32_16x16x32_bf16 v[196:199], v[158:161], v[176:179], v[196:199]
    v_mfma_f32_16x16x32_bf16 v[200:203], v[114:117], v[174:177], v[200:203]
    v_mfma_f32_16x16x32_bf16 v[200:203], v[116:119], v[176:179], v[200:203]
    v_mfma_f32_16x16x32_bf16 v[204:207], v[138:141], v[174:177], v[204:207]
    s_waitcnt lgkmcnt(7)
    v_mfma_f32_16x16x32_bf16 v[204:207], v[140:143], v[176:179], v[204:207]
    v_mfma_f32_16x16x32_bf16 v[236:239], a[144:147], a[216:219], 0
    s_waitcnt lgkmcnt(5)
    v_max3_f32 v248, v248, v208, v209
    v_max3_f32 v248, v248, v210, v211
    v_mfma_f32_16x16x32_bf16 v[236:239], a[148:151], a[220:223], v[236:239]
    ds_read_b128 v[208:211], v244 offset:64
    v_mov_b32 v225, v248
    v_mfma_f32_16x16x32_bf16 v[236:239], a[152:155], a[224:227], v[236:239]
    s_waitcnt lgkmcnt(4)
    v_permlane16_swap_b32 v248, v225
    v_max_f32 v248, v248, v225
    v_mfma_f32_16x16x32_bf16 v[236:239], a[156:159], a[228:231], v[236:239]
    v_mov_b32 v225, v248
    v_mfma_f32_16x16x32_bf16 v[236:239], a[160:163], a[232:235], v[236:239]
    s_waitcnt lgkmcnt(2)
    v_permlane32_swap_b32 v248, v225
    v_max_f32 v248, v248, v225
    v_mfma_f32_16x16x32_bf16 v[236:239], a[164:167], a[236:239], v[236:239]
    buffer_store_dwordx4 a[252:255], v250, s[20:23], 0 offen nt
    v_mfma_f32_16x16x32_bf16 v[228:231], a[168:171], a[216:219], 0
    s_waitcnt lgkmcnt(1)
    v_sub_f32 v196, v196, v248
    v_sub_f32 v197, v197, v248
    v_mfma_f32_16x16x32_bf16 v[228:231], a[172:175], a[220:223], v[228:231]
    v_exp_f32 v196, v196
    v_mfma_f32_16x16x32_bf16 v[228:231], a[176:179], a[224:227], v[228:231]
    v_cvt_pk_bf16_f32 v236, v236, v237
    v_cvt_pk_bf16_f32 v237, v238, v239
    v_mfma_f32_16x16x32_bf16 v[228:231], a[180:183], a[228:231], v[228:231]
    buffer_store_dwordx2 v[254:255], v251, s[20:23], 0 offen offset:256 nt
    v_mfma_f32_16x16x32_bf16 v[228:231], a[184:187], a[232:235], v[228:231]
    s_waitcnt lgkmcnt(0)
    v_exp_f32 v197, v197
    v_mfma_f32_16x16x32_bf16 v[208:211], v[96:99], v[174:177], v[208:211]
    v_sub_f32 v198, v198, v248
    v_sub_f32 v199, v199, v248
    v_mfma_f32_16x16x32_bf16 v[208:211], v[98:101], v[176:179], v[208:211]
    v_exp_f32 v198, v198
    v_mfma_f32_16x16x32_bf16 v[228:231], a[188:191], a[236:239], v[228:231]
    v_exp_f32 v199, v199
    v_mfma_f32_16x16x32_bf16 v[232:235], a[192:195], a[216:219], 0
    v_cvt_pk_bf16_f32 v190, v196, v197
    v_cvt_pk_bf16_f32 v193, v198, v199
    v_mfma_f32_16x16x32_bf16 v[232:235], a[196:199], a[220:223], v[232:235]
    ds_read_b128 v[196:199], v245 offset:64
    v_sub_f32 v200, v200, v248
    v_mfma_f32_16x16x32_bf16 v[232:235], a[200:203], a[224:227], v[232:235]
    v_cvt_pk_bf16_f32 v228, v228, v229
    v_cvt_pk_bf16_f32 v229, v230, v231
    v_mfma_f32_16x16x32_bf16 v[232:235], a[204:207], a[228:231], v[232:235]
    v_exp_f32 v200, v200
    v_mfma_f32_16x16x32_bf16 v[232:235], a[208:211], a[232:235], v[232:235]
    v_sub_f32 v201, v201, v248
    v_sub_f32 v202, v202, v248
    v_mfma_f32_16x16x32_bf16 v[232:235], a[212:215], a[236:239], v[232:235]
    v_exp_f32 v201, v201
    v_exp_f32 v202, v202
    v_sub_f32 v203, v203, v248
    v_exp_f32 v203, v203
    v_cvt_pk_bf16_f32 v188, v200, v201
    v_cvt_pk_bf16_f32 v191, v202, v203
    ds_read_b128 v[200:203], v246 offset:64
    v_sub_f32 v204, v204, v248
    v_cvt_pk_bf16_f32 v232, v232, v233
    v_cvt_pk_bf16_f32 v233, v234, v235
    v_exp_f32 v204, v204
    v_sub_f32 v205, v205, v248
    v_exp_f32 v205, v205
    v_sub_f32 v206, v206, v248
    v_exp_f32 v206, v206
    v_sub_f32 v207, v207, v248
    v_exp_f32 v207, v207
    v_cvt_pk_bf16_f32 v189, v204, v205
    s_waitcnt lgkmcnt(1)
    v_mfma_f32_16x16x32_bf16 v[196:199], v[120:123], v[174:177], v[196:199]
    v_cvt_pk_bf16_f32 v192, v206, v207
    v_sub_f32 v208, v208, v248
    v_mfma_f32_16x16x32_bf16 v[212:215], v[18:21], v[188:191], 0
    v_exp_f32 v208, v208
    v_mfma_f32_16x16x32_bf16 v[216:219], v[48:51], v[188:191], 0
    v_sub_f32 v209, v209, v248
    v_sub_f32 v210, v210, v248
    v_mfma_f32_16x16x32_bf16 v[220:223], v[78:81], v[188:191], 0
    v_exp_f32 v209, v209
    v_mfma_f32_16x16x32_bf16 v[224:227], a[248:251], v[188:191], 0
    s_waitcnt lgkmcnt(0)
    v_exp_f32 v210, v210
    v_mfma_f32_16x16x32_bf16 v[196:199], v[122:125], v[176:179], v[196:199]
    v_sub_f32 v211, v211, v248
    v_cvt_pk_bf16_f32 v180, v208, v209
    v_mfma_f32_16x16x32_bf16 v[200:203], v[144:147], v[174:177], v[200:203]
    ds_read_b64 v[174:175], v247 offset:55296
    v_add_u32 v250, s58, v250
    v_mfma_f32_16x16x32_bf16 v[200:203], v[146:149], v[176:179], v[200:203]
    ds_read_b64 v[176:177], v247 offset:55424
    ds_read_b64 v[178:179], v247 offset:55552
    v_exp_f32 v211, v211
    v_sub_f32 v196, v196, v248
    v_cvt_pk_bf16_f32 v183, v210, v211
    v_exp_f32 v196, v196
    v_sub_f32 v197, v197, v248
    v_exp_f32 v197, v197
    v_sub_f32 v198, v198, v248
    v_exp_f32 v198, v198
    v_sub_f32 v199, v199, v248
    v_exp_f32 v199, v199
    v_cvt_pk_bf16_f32 v194, v196, v197
    v_cvt_pk_bf16_f32 v181, v198, v199
    v_sub_f32 v200, v200, v248
    v_exp_f32 v200, v200
    v_sub_f32 v201, v201, v248
    v_exp_f32 v201, v201
    v_sub_f32 v202, v202, v248
    v_exp_f32 v202, v202
    v_sub_f32 v203, v203, v248
    v_exp_f32 v203, v203
    v_cvt_pk_bf16_f32 v195, v200, v201
    v_cvt_pk_bf16_f32 v182, v202, v203
    v_add_u32 v251, s58, v251
    v_mfma_f32_16x16x32_bf16 v[212:215], v[22:25], v[192:195], v[212:215]
    v_mbcnt_lo_u32_b32 v208, -1, 0
    v_mbcnt_hi_u32_b32 v208, -1, v208
    v_mfma_f32_16x16x32_bf16 v[216:219], v[52:55], v[192:195], v[216:219]
    v_bfe_u32 v204, v208, 2, 1
    v_lshrrev_b32 v205, 1, v208
    v_mfma_f32_16x16x32_bf16 v[220:223], v[82:85], v[192:195], v[220:223]
    v_and_b32 v205, 4, v205
    v_and_or_b32 v205, v208, 3, v205
    v_mfma_f32_16x16x32_bf16 v[224:227], a[248:251], v[192:195], v[224:227]
    v_bfe_u32 v209, v208, 3, 1
    v_lshrrev_b32 v208, 4, v208
    v_mfma_f32_16x16x32_bf16 v[212:215], v[26:29], v[180:183], v[212:215]
    v_sub_u32 v206, v208, v204
    v_mul_i32_i24 v206, 0x1c0, v206
    v_mfma_f32_16x16x32_bf16 v[216:219], v[56:59], v[180:183], v[216:219]
    v_lshlrev_b32 v207, 4, v205
    v_sub_u32 v206, v206, v207
    v_mfma_f32_16x16x32_bf16 v[220:223], v[86:89], v[180:183], v[220:223]
    v_add_u32 v206, s37, v206
    v_sub_u32 v207, v208, v204
    v_mfma_f32_16x16x32_bf16 v[224:227], a[248:251], v[180:183], v[224:227]
    v_add_u32 v244, 0, v207
    v_cmp_gt_u32 vcc, 7, v244
    v_add_u32 v244, 0xfffdc870, v206
    v_add_u32 v245, 4, v207
    v_cndmask_b32 v244, 0, v244, vcc
    v_add_u32 v244, 0x237c0, v244
    v_cmp_gt_u32 vcc, 7, v245
    v_add_u32 v245, 0xfffdcf70, v206
    v_rcp_f32 v225, v224
    v_cndmask_b32 v245, 0, v245, vcc
    v_mul_f32 v212, v212, v225
    v_mul_f32 v213, v213, v225
    v_mul_f32 v214, v214, v225
    v_mul_f32 v215, v215, v225
    v_cvt_pk_bf16_f32 v212, v212, v213
    v_cvt_pk_bf16_f32 v213, v214, v215
    ds_write_b64 v247, v[212:213] offset:43008
    v_mul_f32 v216, v216, v225
    v_mul_f32 v217, v217, v225
    v_mul_f32 v218, v218, v225
    v_mul_f32 v219, v219, v225
    v_cvt_pk_bf16_f32 v216, v216, v217
    v_cvt_pk_bf16_f32 v217, v218, v219
    ds_write_b64 v247, v[216:217] offset:43136
    v_mul_f32 v220, v220, v225
    v_mul_f32 v221, v221, v225
    v_mul_f32 v222, v222, v225
    v_mul_f32 v223, v223, v225
    v_cvt_pk_bf16_f32 v220, v220, v221
    v_cvt_pk_bf16_f32 v221, v222, v223
    ds_write_b64 v247, v[220:221] offset:43264
    v_add_u32 v245, 0x237c0, v245
    v_add_u32 v246, 8, v207
    v_cmp_gt_u32 vcc, 7, v246
    v_add_u32 v246, 0xfffdd670, v206
    v_xor_b32 v209, 1, v209
    v_cndmask_b32 v246, 0, v246, vcc
    v_add_u32 v246, 0x237c0, v246
    v_mul_u32_u24 v246, 0xc0, v209
    v_add_u32 v244, v244, v246
    v_add_u32 v245, v245, v246
    v_mov_b32 v189, 0
    v_mov_b32 v192, 0
    v_mov_b32 v195, 0
    v_mov_b32 v182, 0
    s_waitcnt lgkmcnt(0)
    s_barrier
    ds_write_b64 v249, v[236:237] offset:36864
    ds_write_b64 v249, v[228:229] offset:36992
    ds_write_b64 v249, v[232:233] offset:37120
    ds_read_b128 a[240:243], v242 offset:43008
    ds_read_b128 a[244:247], v243 offset:43008
    ds_read_b128 a[216:219], v242 offset:43136
    ds_read_b128 a[220:223], v243 offset:43136
    ds_read_b128 a[224:227], v242 offset:43264
    ds_read_b128 a[228:231], v243 offset:43264
    ds_read_b128 v[204:207], v244 offset:0
    ds_read_b128 v[208:211], v245 offset:0
    ds_read_b128 v[196:199], v244 offset:64
    ds_read_b128 v[200:203], v245 offset:64
    ds_read_b128 a[252:255], v252 offset:30720
    ds_read_b64 v[254:255], v253 offset:30976
    s_waitcnt lgkmcnt(11)
    v_mfma_f32_16x16x32_bf16 v[236:239], a[144:147], a[240:243], 0
    v_mfma_f32_16x16x32_bf16 v[228:231], a[168:171], a[240:243], 0
    s_waitcnt lgkmcnt(10)
    v_mfma_f32_16x16x32_bf16 v[236:239], a[148:151], a[244:247], v[236:239]
    s_waitcnt lgkmcnt(9)
    v_mfma_f32_16x16x32_bf16 v[236:239], a[152:155], a[216:219], v[236:239]
    s_waitcnt lgkmcnt(8)
    v_mfma_f32_16x16x32_bf16 v[236:239], a[156:159], a[220:223], v[236:239]
    s_waitcnt lgkmcnt(7)
    v_mfma_f32_16x16x32_bf16 v[236:239], a[160:163], a[224:227], v[236:239]
    s_waitcnt lgkmcnt(6)
    v_mfma_f32_16x16x32_bf16 v[236:239], a[164:167], a[228:231], v[236:239]
    s_waitcnt lgkmcnt(5)
    v_mfma_f32_16x16x32_bf16 v[204:207], v[102:105], v[168:171], v[204:207]
    s_waitcnt lgkmcnt(4)
    v_mfma_f32_16x16x32_bf16 v[204:207], v[104:107], v[170:173], v[204:207]
    s_waitcnt lgkmcnt(3)
    v_mfma_f32_16x16x32_bf16 v[208:211], v[126:129], v[168:171], v[208:211]
    s_waitcnt lgkmcnt(2)
    v_mfma_f32_16x16x32_bf16 v[208:211], v[128:131], v[170:173], v[208:211]
    s_waitcnt lgkmcnt(0)
    v_cvt_pk_bf16_f32 v236, v236, v237
    v_cvt_pk_bf16_f32 v237, v238, v239
    v_mfma_f32_16x16x32_bf16 v[196:199], v[108:111], v[168:171], v[196:199]
    buffer_store_dwordx4 a[252:255], v250, s[20:23], 0 offen nt
    v_mfma_f32_16x16x32_bf16 v[196:199], v[110:113], v[170:173], v[196:199]
    v_max_f32 v248, v204, v205
    v_max3_f32 v248, v248, v206, v207
    v_mfma_f32_16x16x32_bf16 v[200:203], v[132:135], v[168:171], v[200:203]
    ds_read_b128 v[204:207], v244 offset:128
    v_max3_f32 v248, v248, v208, v209
    v_mfma_f32_16x16x32_bf16 v[200:203], v[134:137], v[170:173], v[200:203]
    v_max3_f32 v248, v248, v210, v211
    v_add_u32 v250, s50, v250
    v_mfma_f32_16x16x32_bf16 v[228:231], a[172:175], a[244:247], v[228:231]
    ds_read_b128 v[208:211], v245 offset:128
    v_max3_f32 v248, v248, v196, v197
    v_mfma_f32_16x16x32_bf16 v[228:231], a[176:179], a[216:219], v[228:231]
    buffer_store_dwordx2 v[254:255], v251, s[20:23], 0 offen offset:256 nt
    v_mfma_f32_16x16x32_bf16 v[228:231], a[180:183], a[220:223], v[228:231]
    v_max3_f32 v248, v248, v198, v199
    v_max3_f32 v248, v248, v200, v201
    v_mfma_f32_16x16x32_bf16 v[228:231], a[184:187], a[224:227], v[228:231]
    ds_read_b128 v[196:199], v244 offset:192
    v_max3_f32 v248, v248, v202, v203
    v_mfma_f32_16x16x32_bf16 v[228:231], a[188:191], a[228:231], v[228:231]
    ds_read_b128 v[200:203], v245 offset:192
    v_add_u32 v251, s50, v251
    v_mfma_f32_16x16x32_bf16 v[232:235], a[192:195], a[240:243], 0
    v_mfma_f32_16x16x32_bf16 v[232:235], a[196:199], a[244:247], v[232:235]
    s_waitcnt lgkmcnt(3)
    v_mfma_f32_16x16x32_bf16 v[204:207], v[162:165], v[168:171], v[204:207]
    v_mfma_f32_16x16x32_bf16 v[204:207], v[164:167], v[170:173], v[204:207]
    s_waitcnt lgkmcnt(2)
    v_cvt_pk_bf16_f32 v228, v228, v229
    v_cvt_pk_bf16_f32 v229, v230, v231
    v_mfma_f32_16x16x32_bf16 v[208:211], v[90:93], v[168:171], v[208:211]
    v_mfma_f32_16x16x32_bf16 v[208:211], v[92:95], v[170:173], v[208:211]
    v_mfma_f32_16x16x32_bf16 v[232:235], a[200:203], a[216:219], v[232:235]
    v_mfma_f32_16x16x32_bf16 v[232:235], a[204:207], a[220:223], v[232:235]
    s_waitcnt lgkmcnt(1)
    v_max3_f32 v248, v248, v204, v205
    v_max3_f32 v248, v248, v206, v207
    v_mfma_f32_16x16x32_bf16 v[196:199], v[114:117], v[168:171], v[196:199]
    ds_read_b128 v[204:207], v244 offset:0
    s_waitcnt lgkmcnt(1)
    v_mfma_f32_16x16x32_bf16 v[196:199], v[116:119], v[170:173], v[196:199]
    v_max3_f32 v248, v248, v208, v209
    v_max3_f32 v248, v248, v210, v211
    v_mfma_f32_16x16x32_bf16 v[200:203], v[138:141], v[168:171], v[200:203]
    ds_read_b128 v[208:211], v245 offset:0
    v_mfma_f32_16x16x32_bf16 v[200:203], v[140:143], v[170:173], v[200:203]
    v_mfma_f32_16x16x32_bf16 v[232:235], a[208:211], a[224:227], v[232:235]
    v_mfma_f32_16x16x32_bf16 v[232:235], a[212:215], a[228:231], v[232:235]
    s_nop 0
    v_max3_f32 v248, v248, v196, v197
    ds_read_b128 v[196:199], v244 offset:64
    s_nop 2
    v_max3_f32 v248, v248, v200, v201
    ds_read_b128 v[200:203], v245 offset:64
    v_cvt_pk_bf16_f32 v232, v232, v233
    v_cvt_pk_bf16_f32 v233, v234, v235
    v_mov_b32 v225, v248
    s_waitcnt lgkmcnt(3)
    v_mfma_f32_16x16x32_bf16 v[204:207], v[102:105], v[168:171], v[204:207]
    v_permlane16_swap_b32 v248, v225
    v_max_f32 v248, v248, v225
    v_mfma_f32_16x16x32_bf16 v[204:207], v[104:107], v[170:173], v[204:207]
    s_waitcnt lgkmcnt(2)
    v_mov_b32 v225, v248
    v_mfma_f32_16x16x32_bf16 v[208:211], v[126:129], v[168:171], v[208:211]
    v_mfma_f32_16x16x32_bf16 v[208:211], v[128:131], v[170:173], v[208:211]
    v_permlane32_swap_b32 v248, v225
    v_max_f32 v248, v248, v225
    s_nop 1
    v_sub_f32 v204, v204, v248
    v_exp_f32 v204, v204
    v_sub_f32 v205, v205, v248
    v_exp_f32 v205, v205
    v_sub_f32 v206, v206, v248
    v_exp_f32 v206, v206
    v_sub_f32 v207, v207, v248
    v_exp_f32 v207, v207
    v_cvt_pk_bf16_f32 v184, v204, v205
    v_cvt_pk_bf16_f32 v187, v206, v207
    ds_read_b128 v[204:207], v244 offset:128
    v_sub_f32 v208, v208, v248
    v_exp_f32 v208, v208
    v_sub_f32 v209, v209, v248
    v_exp_f32 v209, v209
    v_sub_f32 v210, v210, v248
    v_exp_f32 v210, v210
    v_sub_f32 v211, v211, v248
    v_exp_f32 v211, v211
    v_cvt_pk_bf16_f32 v185, v208, v209
    s_waitcnt lgkmcnt(1)
    v_mfma_f32_16x16x32_bf16 v[196:199], v[108:111], v[168:171], v[196:199]
    v_cvt_pk_bf16_f32 v188, v210, v211
    v_mfma_f32_16x16x32_bf16 v[212:215], v[0:3], v[184:187], 0
    ds_read_b128 v[208:211], v245 offset:128
    v_mfma_f32_16x16x32_bf16 v[216:219], v[30:33], v[184:187], 0
    v_mfma_f32_16x16x32_bf16 v[220:223], v[60:63], v[184:187], 0
    v_mfma_f32_16x16x32_bf16 v[224:227], a[248:251], v[184:187], 0
    s_waitcnt lgkmcnt(1)
    v_mov_b32 v185, 0
    v_mfma_f32_16x16x32_bf16 v[196:199], v[110:113], v[170:173], v[196:199]
    v_mfma_f32_16x16x32_bf16 v[200:203], v[132:135], v[168:171], v[200:203]
    v_mfma_f32_16x16x32_bf16 v[200:203], v[134:137], v[170:173], v[200:203]
    v_mfma_f32_16x16x32_bf16 v[204:207], v[162:165], v[168:171], v[204:207]
    v_mfma_f32_16x16x32_bf16 v[204:207], v[164:167], v[170:173], v[204:207]
    s_nop 3
    s_waitcnt lgkmcnt(0)
    v_mfma_f32_16x16x32_bf16 v[208:211], v[90:93], v[168:171], v[208:211]
    v_sub_f32 v196, v196, v248
    v_sub_f32 v197, v197, v248
    v_mfma_f32_16x16x32_bf16 v[208:211], v[92:95], v[170:173], v[208:211]
    v_exp_f32 v196, v196
    v_exp_f32 v197, v197
    v_sub_f32 v198, v198, v248
    v_exp_f32 v198, v198
    v_sub_f32 v199, v199, v248
    v_exp_f32 v199, v199
    v_cvt_pk_bf16_f32 v190, v196, v197
    v_cvt_pk_bf16_f32 v193, v198, v199
    ds_read_b128 v[196:199], v244 offset:192
    v_sub_f32 v200, v200, v248
    v_exp_f32 v200, v200
    v_sub_f32 v201, v201, v248
    v_exp_f32 v201, v201
    v_sub_f32 v202, v202, v248
    v_exp_f32 v202, v202
    v_sub_f32 v203, v203, v248
    v_exp_f32 v203, v203
    v_cvt_pk_bf16_f32 v191, v200, v201
    v_cvt_pk_bf16_f32 v194, v202, v203
    ds_read_b128 v[200:203], v245 offset:192
    v_mfma_f32_16x16x32_bf16 v[212:215], v[4:7], v[188:191], v[212:215]
    v_sub_f32 v204, v204, v248
    v_sub_f32 v205, v205, v248
    v_mfma_f32_16x16x32_bf16 v[216:219], v[34:37], v[188:191], v[216:219]
    v_exp_f32 v204, v204
    v_mfma_f32_16x16x32_bf16 v[220:223], v[64:67], v[188:191], v[220:223]
    v_exp_f32 v205, v205
    v_mfma_f32_16x16x32_bf16 v[224:227], a[248:251], v[188:191], v[224:227]
    v_sub_f32 v206, v206, v248
    v_sub_f32 v207, v207, v248
    v_mfma_f32_16x16x32_bf16 v[212:215], v[8:11], v[192:195], v[212:215]
    s_waitcnt lgkmcnt(1)
    v_exp_f32 v206, v206
    v_mfma_f32_16x16x32_bf16 v[216:219], v[38:41], v[192:195], v[216:219]
    v_exp_f32 v207, v207
    v_mfma_f32_16x16x32_bf16 v[220:223], v[68:71], v[192:195], v[220:223]
    v_cvt_pk_bf16_f32 v180, v204, v205
    v_cvt_pk_bf16_f32 v183, v206, v207
    v_mfma_f32_16x16x32_bf16 v[224:227], a[248:251], v[192:195], v[224:227]
    v_sub_f32 v208, v208, v248
    v_sub_f32 v209, v209, v248
    v_mfma_f32_16x16x32_bf16 v[196:199], v[114:117], v[168:171], v[196:199]
    s_waitcnt lgkmcnt(0)
    v_exp_f32 v208, v208
    v_mfma_f32_16x16x32_bf16 v[196:199], v[116:119], v[170:173], v[196:199]
    v_exp_f32 v209, v209
    v_mfma_f32_16x16x32_bf16 v[200:203], v[138:141], v[168:171], v[200:203]
    v_sub_f32 v210, v210, v248
    v_sub_f32 v211, v211, v248
    v_mfma_f32_16x16x32_bf16 v[200:203], v[140:143], v[170:173], v[200:203]
    v_exp_f32 v210, v210
    v_exp_f32 v211, v211
    v_cvt_pk_bf16_f32 v181, v208, v209
    v_cvt_pk_bf16_f32 v184, v210, v211
    v_sub_f32 v196, v196, v248
    v_mfma_f32_16x16x32_bf16 v[212:215], v[12:15], v[180:183], v[212:215]
    v_exp_f32 v196, v196
    v_mfma_f32_16x16x32_bf16 v[216:219], v[42:45], v[180:183], v[216:219]
    v_sub_f32 v197, v197, v248
    v_sub_f32 v200, v200, v248
    v_mfma_f32_16x16x32_bf16 v[220:223], v[72:75], v[180:183], v[220:223]
    v_exp_f32 v197, v197
    v_mfma_f32_16x16x32_bf16 v[224:227], a[248:251], v[180:183], v[224:227]
    v_cvt_pk_bf16_f32 v186, v196, v197
    v_exp_f32 v200, v200
    v_sub_f32 v201, v201, v248
    v_exp_f32 v201, v201
    v_sub_u32 v244, v244, v246
    ds_read_b128 v[204:207], v244 offset:0
    ds_read_b128 v[196:199], v244 offset:64
    v_cvt_pk_bf16_f32 v187, v200, v201
    v_sub_u32 v245, v245, v246
    ds_read_b128 v[208:211], v245 offset:0
    v_mfma_f32_16x16x32_bf16 v[212:215], v[16:19], v[184:187], v[212:215]
    ds_read_b128 v[200:203], v245 offset:64
    v_mov_b32 v190, 0
    v_mfma_f32_16x16x32_bf16 v[216:219], v[46:49], v[184:187], v[216:219]
    v_mov_b32 v193, 0
    v_mov_b32 v180, 0
    v_mfma_f32_16x16x32_bf16 v[220:223], v[76:79], v[184:187], v[220:223]
    v_mov_b32 v183, 0
    v_mfma_f32_16x16x32_bf16 v[224:227], a[248:251], v[184:187], v[224:227]
    v_mov_b32 v186, 0
    s_nop 6
    v_rcp_f32 v225, v224
    s_nop 0
    v_mul_f32 v212, v212, v225
    v_mul_f32 v213, v213, v225
    v_mul_f32 v214, v214, v225
    v_mul_f32 v215, v215, v225
    v_cvt_pk_bf16_f32 v212, v212, v213
    v_cvt_pk_bf16_f32 v213, v214, v215
    ds_write_b64 v247, v[212:213] offset:49152
    v_mul_f32 v216, v216, v225
    v_mul_f32 v217, v217, v225
    v_mul_f32 v218, v218, v225
    v_mul_f32 v219, v219, v225
    v_cvt_pk_bf16_f32 v216, v216, v217
    v_cvt_pk_bf16_f32 v217, v218, v219
    ds_write_b64 v247, v[216:217] offset:49280
    v_mul_f32 v220, v220, v225
    v_mul_f32 v221, v221, v225
    v_mul_f32 v222, v222, v225
    v_mul_f32 v223, v223, v225
    v_cvt_pk_bf16_f32 v220, v220, v221
    v_cvt_pk_bf16_f32 v221, v222, v223
    ds_write_b64 v247, v[220:221] offset:49408
    s_waitcnt lgkmcnt(3)
    v_mfma_f32_16x16x32_bf16 v[204:207], v[162:165], v[174:177], v[204:207]
    v_mfma_f32_16x16x32_bf16 v[204:207], v[164:167], v[176:179], v[204:207]
    v_mfma_f32_16x16x32_bf16 v[208:211], v[90:93], v[174:177], v[208:211]
    v_mfma_f32_16x16x32_bf16 v[208:211], v[92:95], v[176:179], v[208:211]
    v_mfma_f32_16x16x32_bf16 v[196:199], v[114:117], v[174:177], v[196:199]
    v_mfma_f32_16x16x32_bf16 v[196:199], v[116:119], v[176:179], v[196:199]
    v_mfma_f32_16x16x32_bf16 v[200:203], v[138:141], v[174:177], v[200:203]
    v_mfma_f32_16x16x32_bf16 v[200:203], v[140:143], v[176:179], v[200:203]
    s_waitcnt lgkmcnt(0)
    s_barrier
    ds_write_b64 v249, v[236:237] offset:43008
    ds_write_b64 v249, v[228:229] offset:43136
    ds_write_b64 v249, v[232:233] offset:43264
    ds_read_b128 a[232:235], v242 offset:49152
    ds_read_b128 a[236:239], v243 offset:49152
    ds_read_b128 a[240:243], v242 offset:49280
    ds_read_b128 a[244:247], v243 offset:49280
    ds_read_b128 a[216:219], v242 offset:49408
    ds_read_b128 a[220:223], v243 offset:49408
    ds_read_b128 a[252:255], v252 offset:36864
    ds_read_b64 v[254:255], v253 offset:37120
    v_max_f32 v248, v204, v205
    v_max3_f32 v248, v248, v206, v207
    ds_read_b128 v[204:207], v244 offset:128
    v_max3_f32 v248, v248, v208, v209
    v_max3_f32 v248, v248, v210, v211
    ds_read_b128 v[208:211], v245 offset:128
    v_max3_f32 v248, v248, v196, v197
    v_max3_f32 v248, v248, v198, v199
    ds_read_b128 v[196:199], v244 offset:0
    v_max3_f32 v248, v248, v200, v201
    v_max3_f32 v248, v248, v202, v203
    ds_read_b128 v[200:203], v245 offset:0
    s_waitcnt lgkmcnt(11)
    v_mfma_f32_16x16x32_bf16 v[236:239], a[144:147], a[232:235], 0
    v_mfma_f32_16x16x32_bf16 v[228:231], a[168:171], a[232:235], 0
    s_waitcnt lgkmcnt(10)
    v_mfma_f32_16x16x32_bf16 v[236:239], a[148:151], a[236:239], v[236:239]
    s_waitcnt lgkmcnt(9)
    v_mfma_f32_16x16x32_bf16 v[236:239], a[152:155], a[240:243], v[236:239]
    s_waitcnt lgkmcnt(8)
    v_mfma_f32_16x16x32_bf16 v[236:239], a[156:159], a[244:247], v[236:239]
    s_waitcnt lgkmcnt(7)
    v_mfma_f32_16x16x32_bf16 v[236:239], a[160:163], a[216:219], v[236:239]
    s_waitcnt lgkmcnt(6)
    v_mfma_f32_16x16x32_bf16 v[236:239], a[164:167], a[220:223], v[236:239]
    s_waitcnt lgkmcnt(4)
    v_mfma_f32_16x16x32_bf16 v[228:231], a[172:175], a[236:239], v[228:231]
    buffer_store_dwordx4 a[252:255], v250, s[20:23], 0 offen nt
    v_mfma_f32_16x16x32_bf16 v[228:231], a[176:179], a[240:243], v[228:231]
    s_waitcnt lgkmcnt(2)
    s_waitcnt lgkmcnt(1)
    v_mfma_f32_16x16x32_bf16 v[204:207], v[120:123], v[174:177], v[204:207]
    v_mfma_f32_16x16x32_bf16 v[204:207], v[122:125], v[176:179], v[204:207]
    s_waitcnt lgkmcnt(0)
    v_cvt_pk_bf16_f32 v236, v236, v237
    v_cvt_pk_bf16_f32 v237, v238, v239
    v_mfma_f32_16x16x32_bf16 v[208:211], v[144:147], v[174:177], v[208:211]
    buffer_store_dwordx2 v[254:255], v251, s[20:23], 0 offen offset:256 nt
    v_mfma_f32_16x16x32_bf16 v[208:211], v[146:149], v[176:179], v[208:211]
    v_mbcnt_lo_u32_b32 v254, -1, 0
    v_mbcnt_hi_u32_b32 v254, -1, v254
    v_mfma_f32_16x16x32_bf16 v[196:199], v[162:165], v[174:177], v[196:199]
    v_max3_f32 v248, v248, v204, v205
    v_max3_f32 v248, v248, v206, v207
    v_mfma_f32_16x16x32_bf16 v[196:199], v[164:167], v[176:179], v[196:199]
    ds_read_b128 v[204:207], v244 offset:64
    v_lshrrev_b32 v255, 4, v254
    v_mfma_f32_16x16x32_bf16 v[200:203], v[90:93], v[174:177], v[200:203]
    v_max3_f32 v248, v248, v208, v209
    v_max3_f32 v248, v248, v210, v211
    v_mfma_f32_16x16x32_bf16 v[200:203], v[92:95], v[176:179], v[200:203]
    ds_read_b128 v[208:211], v245 offset:64
    v_mov_b32 v225, v248
    v_mfma_f32_16x16x32_bf16 v[228:231], a[180:183], a[244:247], v[228:231]
    v_add_u32 v251, s53, v255
    v_permlane16_swap_b32 v248, v225
    v_mfma_f32_16x16x32_bf16 v[228:231], a[184:187], a[216:219], v[228:231]
    s_mul_i32 s53, s53, s31
    v_max_f32 v248, v248, v225
    v_mov_b32 v225, v248
    v_mfma_f32_16x16x32_bf16 v[228:231], a[188:191], a[220:223], v[228:231]
    s_add_u32 s52, s52, s53
    v_permlane32_swap_b32 v248, v225
    v_max_f32 v248, v248, v225
    v_mfma_f32_16x16x32_bf16 v[232:235], a[192:195], a[232:235], 0
    s_add_u32 s52, s52, s32
    v_sub_f32 v196, v196, v248
    v_sub_f32 v197, v197, v248
    v_mfma_f32_16x16x32_bf16 v[232:235], a[196:199], a[236:239], v[232:235]
    v_cvt_pk_bf16_f32 v228, v228, v229
    v_cvt_pk_bf16_f32 v229, v230, v231
    v_mfma_f32_16x16x32_bf16 v[232:235], a[200:203], a[240:243], v[232:235]
    v_exp_f32 v196, v196
    v_mfma_f32_16x16x32_bf16 v[232:235], a[204:207], a[244:247], v[232:235]
    s_waitcnt lgkmcnt(1)
    v_exp_f32 v197, v197
    v_mfma_f32_16x16x32_bf16 v[204:207], v[114:117], v[174:177], v[204:207]
    v_sub_f32 v198, v198, v248
    v_sub_f32 v199, v199, v248
    v_mfma_f32_16x16x32_bf16 v[204:207], v[116:119], v[176:179], v[204:207]
    s_waitcnt lgkmcnt(0)
    v_exp_f32 v198, v198
    v_mfma_f32_16x16x32_bf16 v[208:211], v[138:141], v[174:177], v[208:211]
    v_exp_f32 v199, v199
    v_mfma_f32_16x16x32_bf16 v[208:211], v[140:143], v[176:179], v[208:211]
    v_cvt_pk_bf16_f32 v188, v196, v197
    v_cvt_pk_bf16_f32 v191, v198, v199
    v_mfma_f32_16x16x32_bf16 v[232:235], a[208:211], a[216:219], v[232:235]
    ds_read_b128 v[196:199], v244 offset:128
    v_sub_f32 v200, v200, v248
    v_mfma_f32_16x16x32_bf16 v[232:235], a[212:215], a[220:223], v[232:235]
    v_exp_f32 v200, v200
    v_sub_f32 v201, v201, v248
    v_exp_f32 v201, v201
    v_sub_f32 v202, v202, v248
    v_exp_f32 v202, v202
    v_sub_f32 v203, v203, v248
    v_exp_f32 v203, v203
    v_cvt_pk_bf16_f32 v189, v200, v201
    v_cvt_pk_bf16_f32 v232, v232, v233
    v_cvt_pk_bf16_f32 v233, v234, v235
    v_mfma_f32_16x16x32_bf16 v[212:215], v[12:15], v[188:191], 0
    v_cvt_pk_bf16_f32 v192, v202, v203
    v_sub_f32 v204, v204, v248
    v_mfma_f32_16x16x32_bf16 v[216:219], v[42:45], v[188:191], 0
    ds_read_b128 v[200:203], v245 offset:128
    v_sub_f32 v205, v205, v248
    v_mfma_f32_16x16x32_bf16 v[220:223], v[72:75], v[188:191], 0
    v_exp_f32 v204, v204
    v_mfma_f32_16x16x32_bf16 v[224:227], a[248:251], v[188:191], 0
    v_exp_f32 v205, v205
    s_waitcnt lgkmcnt(1)
    v_mfma_f32_16x16x32_bf16 v[196:199], v[120:123], v[174:177], v[196:199]
    v_sub_f32 v206, v206, v248
    v_sub_f32 v207, v207, v248
    v_mfma_f32_16x16x32_bf16 v[196:199], v[122:125], v[176:179], v[196:199]
    v_exp_f32 v206, v206
    v_exp_f32 v207, v207
    v_cvt_pk_bf16_f32 v194, v204, v205
    v_cvt_pk_bf16_f32 v181, v206, v207
    v_sub_f32 v208, v208, v248
    v_exp_f32 v208, v208
    v_sub_f32 v209, v209, v248
    v_exp_f32 v209, v209
    v_sub_f32 v210, v210, v248
    v_exp_f32 v210, v210
    v_sub_f32 v211, v211, v248
    v_exp_f32 v211, v211
    v_cvt_pk_bf16_f32 v195, v208, v209
    s_waitcnt lgkmcnt(0)
    v_mfma_f32_16x16x32_bf16 v[200:203], v[144:147], v[174:177], v[200:203]
    v_cvt_pk_bf16_f32 v182, v210, v211
    v_sub_f32 v196, v196, v248
    v_mfma_f32_16x16x32_bf16 v[212:215], v[16:19], v[192:195], v[212:215]
    v_exp_f32 v196, v196
    v_mfma_f32_16x16x32_bf16 v[216:219], v[46:49], v[192:195], v[216:219]
    v_sub_f32 v197, v197, v248
    v_sub_f32 v198, v198, v248
    v_mfma_f32_16x16x32_bf16 v[220:223], v[76:79], v[192:195], v[220:223]
    v_exp_f32 v197, v197
    v_mfma_f32_16x16x32_bf16 v[224:227], a[248:251], v[192:195], v[224:227]
    v_exp_f32 v198, v198
    v_mfma_f32_16x16x32_bf16 v[212:215], v[20:23], v[180:183], v[212:215]
    v_sub_f32 v199, v199, v248
    v_cvt_pk_bf16_f32 v184, v196, v197
    v_mfma_f32_16x16x32_bf16 v[216:219], v[50:53], v[180:183], v[216:219]
    v_exp_f32 v199, v199
    v_mfma_f32_16x16x32_bf16 v[220:223], v[80:83], v[180:183], v[220:223]
    v_cvt_pk_bf16_f32 v187, v198, v199
    v_mov_b32 v189, 0
    v_mfma_f32_16x16x32_bf16 v[224:227], a[248:251], v[180:183], v[224:227]
    v_mov_b32 v191, 0
    v_cmp_gt_u32 vcc, 17, v251
    v_mfma_f32_16x16x32_bf16 v[200:203], v[146:149], v[176:179], v[200:203]
    v_mul_i32_i24 v250, s31, v255
    v_add_u32 v250, s52, v250
    v_add_u32 v250, 0x80000000, v250
    v_cndmask_b32 v250, 0, v250, vcc
    v_add_u32 v250, 0x80000000, v250
    v_and_b32 v254, 15, v254
    v_lshl_add_u32 v251, v254, 3, v250
    v_lshlrev_b32 v255, 3, v255
    v_sub_f32 v200, v200, v248
    v_exp_f32 v200, v200
    v_sub_f32 v201, v201, v248
    v_exp_f32 v201, v201
    v_sub_f32 v202, v202, v248
    v_exp_f32 v202, v202
    v_sub_f32 v203, v203, v248
    v_exp_f32 v203, v203
    v_cvt_pk_bf16_f32 v185, v200, v201
    v_cvt_pk_bf16_f32 v188, v202, v203
    v_and_b32 v255, 8, v255
    v_mfma_f32_16x16x32_bf16 v[212:215], v[24:27], v[184:187], v[212:215]
    v_xor_b32 v254, v254, v255
    v_lshl_add_u32 v250, v254, 4, v250
    v_mfma_f32_16x16x32_bf16 v[216:219], v[54:57], v[184:187], v[216:219]
    v_mfma_f32_16x16x32_bf16 v[220:223], v[84:87], v[184:187], v[220:223]
    v_mfma_f32_16x16x32_bf16 v[224:227], a[248:251], v[184:187], v[224:227]
    v_mfma_f32_16x16x32_bf16 v[212:215], v[28:31], v[188:191], v[212:215]
    v_mfma_f32_16x16x32_bf16 v[216:219], v[58:61], v[188:191], v[216:219]
    v_mfma_f32_16x16x32_bf16 v[220:223], v[88:91], v[188:191], v[220:223]
    v_mfma_f32_16x16x32_bf16 v[224:227], a[248:251], v[188:191], v[224:227]
    s_nop 7
    v_rcp_f32 v225, v224
    s_nop 0
    v_mul_f32 v212, v212, v225
    v_mul_f32 v213, v213, v225
    v_mul_f32 v214, v214, v225
    v_mul_f32 v215, v215, v225
    v_cvt_pk_bf16_f32 v212, v212, v213
    v_cvt_pk_bf16_f32 v213, v214, v215
    ds_write_b64 v247, v[212:213] offset:55296
    v_mul_f32 v216, v216, v225
    v_mul_f32 v217, v217, v225
    v_mul_f32 v218, v218, v225
    v_mul_f32 v219, v219, v225
    v_cvt_pk_bf16_f32 v216, v216, v217
    v_cvt_pk_bf16_f32 v217, v218, v219
    ds_write_b64 v247, v[216:217] offset:55424
    v_mul_f32 v220, v220, v225
    v_mul_f32 v221, v221, v225
    v_mul_f32 v222, v222, v225
    v_mul_f32 v223, v223, v225
    v_cvt_pk_bf16_f32 v220, v220, v221
    v_cvt_pk_bf16_f32 v221, v222, v223
    ds_write_b64 v247, v[220:221] offset:55552
    s_waitcnt lgkmcnt(0)
    s_barrier
    ds_write_b64 v249, v[236:237] offset:49152
    ds_write_b64 v249, v[228:229] offset:49280
    ds_write_b64 v249, v[232:233] offset:49408
    ds_read_b128 a[224:227], v242 offset:55296
    ds_read_b128 a[228:231], v243 offset:55296
    ds_read_b128 a[232:235], v242 offset:55424
    ds_read_b128 a[236:239], v243 offset:55424
    ds_read_b128 a[240:243], v242 offset:55552
    ds_read_b128 a[244:247], v243 offset:55552
    ds_read_b128 a[252:255], v252 offset:43008
    ds_read_b64 v[254:255], v253 offset:43264
    s_waitcnt lgkmcnt(7)
    v_mfma_f32_16x16x32_bf16 v[236:239], a[144:147], a[224:227], 0
    v_mfma_f32_16x16x32_bf16 v[228:231], a[168:171], a[224:227], 0
    s_waitcnt lgkmcnt(6)
    v_mfma_f32_16x16x32_bf16 v[236:239], a[148:151], a[228:231], v[236:239]
    s_waitcnt lgkmcnt(5)
    v_mfma_f32_16x16x32_bf16 v[236:239], a[152:155], a[232:235], v[236:239]
    s_waitcnt lgkmcnt(4)
    v_mfma_f32_16x16x32_bf16 v[236:239], a[156:159], a[236:239], v[236:239]
    s_waitcnt lgkmcnt(3)
    v_mfma_f32_16x16x32_bf16 v[236:239], a[160:163], a[240:243], v[236:239]
    s_waitcnt lgkmcnt(2)
    s_barrier
    s_waitcnt lgkmcnt(1)
    v_mfma_f32_16x16x32_bf16 v[236:239], a[164:167], a[244:247], v[236:239]
    buffer_store_dwordx4 a[252:255], v250, s[20:23], 0 offen nt
    v_mfma_f32_16x16x32_bf16 v[228:231], a[172:175], a[228:231], v[228:231]
    s_waitcnt lgkmcnt(0)
    ds_read_b128 a[252:255], v252 offset:49152
    v_mfma_f32_16x16x32_bf16 v[228:231], a[176:179], a[232:235], v[228:231]
    v_mfma_f32_16x16x32_bf16 v[228:231], a[180:183], a[236:239], v[228:231]
    v_mfma_f32_16x16x32_bf16 v[228:231], a[184:187], a[240:243], v[228:231]
    buffer_store_dwordx2 v[254:255], v251, s[20:23], 0 offen offset:256 nt
    v_mfma_f32_16x16x32_bf16 v[228:231], a[188:191], a[244:247], v[228:231]
    v_cvt_pk_bf16_f32 v236, v236, v237
    v_cvt_pk_bf16_f32 v237, v238, v239
    v_mfma_f32_16x16x32_bf16 v[232:235], a[192:195], a[224:227], 0
    ds_write_b64 v249, v[236:237] offset:55296
    v_mfma_f32_16x16x32_bf16 v[232:235], a[196:199], a[228:231], v[232:235]
    v_mbcnt_lo_u32_b32 v254, -1, 0
    v_mbcnt_hi_u32_b32 v254, -1, v254
    v_mfma_f32_16x16x32_bf16 v[232:235], a[200:203], a[232:235], v[232:235]
    v_cvt_pk_bf16_f32 v228, v228, v229
    v_cvt_pk_bf16_f32 v229, v230, v231
    v_mfma_f32_16x16x32_bf16 v[232:235], a[204:207], a[236:239], v[232:235]
    ds_write_b64 v249, v[228:229] offset:55424
    v_mfma_f32_16x16x32_bf16 v[232:235], a[208:211], a[240:243], v[232:235]
    v_lshrrev_b32 v255, 4, v254
    v_mul_i32_i24 v250, s31, v255
    v_mfma_f32_16x16x32_bf16 v[232:235], a[212:215], a[244:247], v[232:235]
    v_add_u32 v250, s54, v250
    v_and_b32 v254, 15, v254
    v_lshl_add_u32 v251, v254, 3, v250
    v_lshlrev_b32 v255, 3, v255
    v_and_b32 v255, 8, v255
    v_xor_b32 v254, v254, v255
    v_lshl_add_u32 v250, v254, 4, v250
    ds_read_b64 v[254:255], v253 offset:49408
    v_cvt_pk_bf16_f32 v232, v232, v233
    v_cvt_pk_bf16_f32 v233, v234, v235
    ds_write_b64 v249, v[232:233] offset:55552
    s_waitcnt lgkmcnt(3)
    buffer_store_dwordx4 a[252:255], v250, s[20:23], 0 offen nt
    s_waitcnt lgkmcnt(1)
    buffer_store_dwordx2 v[254:255], v251, s[20:23], 0 offen offset:256 nt
    v_mbcnt_lo_u32_b32 v254, -1, 0
    v_mbcnt_hi_u32_b32 v254, -1, v254
    v_lshrrev_b32 v255, 4, v254
    v_add_u32 v251, s57, v255
    v_cmp_gt_u32 vcc, 17, v251
    s_mul_i32 s57, s57, s31
    s_add_u32 s56, s56, s57
    s_add_u32 s56, s56, s32
    v_mul_i32_i24 v250, s31, v255
    v_add_u32 v250, s56, v250
    v_add_u32 v250, 0x80000000, v250
    v_cndmask_b32 v250, 0, v250, vcc
    v_add_u32 v250, 0x80000000, v250
    v_and_b32 v254, 15, v254
    v_lshl_add_u32 v251, v254, 3, v250
    v_lshlrev_b32 v255, 3, v255
    v_and_b32 v255, 8, v255
    v_xor_b32 v254, v254, v255
    v_lshl_add_u32 v250, v254, 4, v250
    s_waitcnt lgkmcnt(0)
    s_barrier
    ds_read_b128 a[252:255], v252 offset:55296
    ds_read_b64 v[254:255], v253 offset:55552
    s_waitcnt lgkmcnt(1)
    buffer_store_dwordx4 a[252:255], v250, s[20:23], 0 offen nt
    s_waitcnt lgkmcnt(0)
    buffer_store_dwordx2 v[254:255], v251, s[20:23], 0 offen offset:256 nt
    s_endpgm
.section .rodata,"a"
.p2align 6
.amdhsa_kernel standalone__neighborhood_dinat__vision_kernel
  .amdhsa_next_free_vgpr 512
  .amdhsa_next_free_sgpr 102
  .amdhsa_accum_offset 256
  .amdhsa_group_segment_fixed_size 0
  .amdhsa_kernarg_size 56
  .amdhsa_user_sgpr_count 2
  .amdhsa_user_sgpr_kernarg_segment_ptr 1
  .amdhsa_system_sgpr_workgroup_id_x 1
.end_amdhsa_kernel
```

```asm
; @launch grid=(256,1,1) block=(256,1,1) lds=163840
.amdgcn_target "amdgcn-amd-amdhsa--gfx950"
.text
.globl standalone__neighborhood_dinat__vision_kernel
.p2align 8
.type standalone__neighborhood_dinat__vision_kernel,@function
standalone__neighborhood_dinat__vision_kernel:
    s_cmpk_ge_u32 s2, 0x100
    s_cbranch_scc1 L_exit
    s_load_dwordx2 s[4:5], s[0:1], 0
    s_load_dwordx2 s[8:9], s[0:1], 8
    s_load_dwordx2 s[12:13], s[0:1], 16
    s_load_dwordx2 s[16:17], s[0:1], 24
    s_load_dwordx2 s[20:21], s[0:1], 32
    s_getpc_b64 s[68:69]
    v_lshrrev_b32 v4, 6, v0
    s_bfe_u32 s65, s2, 0x30003
    v_readfirstlane_b32 s28, v4
    s_lshl_b32 s66, s65, 13
    v_lshl_add_u32 v12, v0, 5, s66
    global_load_dword v11, v12, s[68:69]
    s_lshr_b32 s66, s2, 6
    s_and_b32 s67, s2, 1
    s_lshl2_add_u32 s64, s67, s66
    s_mov_b32 s30, 0x2a000
    s_mul_i32 s66, s64, 14
    s_bitcmp1_b32 s64, 0
    s_cselect_b32 s67, 16, -3
    s_cselect_b32 s35, -1, 1
    s_add_u32 s66, s66, s67
    s_mul_i32 s32, s66, s30
    s_mul_i32 s40, s30, 0x6f
    s_mul_i32 s30, s30, s35
    s_mul_i32 s66, s65, 28
    s_cmp_eq_u32 s65, 7
    s_cselect_b32 s36, 1, 0
    s_cselect_b32 s67, 18, -6
    s_cselect_b32 s31, -3, 3
    s_add_u32 s66, s66, s67
    s_bfe_u32 s67, s2, 0x10001
    s_add_u32 s66, s66, s67
    s_bfe_u32 s67, s2, 0x10002
    s_mulk_i32 s67, 0xe0
    s_add_u32 s66, s66, s67
    s_mulk_i32 s66, 0x180
    s_lshl_b32 s67, s36, 11
    s_sub_u32 s66, s66, s67
    s_lshl_b32 s45, s31, 11
    s_lshl_b32 s31, s31, 8
    s_mul_i32 s67, s30, s28
    s_add_u32 s67, s67, s32
    s_add_u32 s32, s32, s66
    s_min_i32 s40, s40, s67
    s_max_i32 s40, s40, 0
    s_add_u32 s40, s40, s66
    s_add_u32 s67, s67, s66
    s_lshl2_add_u32 s41, s30, s67
    s_mul_i32 s46, s28, 0x1e00
    s_mul_i32 s29, s28, 0x3000
    s_add_u32 s29, s29, 0x16800
    s_mul_i32 s39, s28, 0x60
    s_mov_b32 s6, 0x1260000
    s_mov_b32 s7, 0x20000
    s_mov_b32 s10, 0x36000
    s_mov_b32 s11, 0x20000
    v_mbcnt_lo_u32_b32 v1, -1, 0
    v_mbcnt_hi_u32_b32 v1, -1, v1
    s_lshl_b32 s51, s28, 1
    s_add_u32 s50, s31, 0xfffffe80
    s_mul_i32 s52, s36, 0x1d00
    v_lshrrev_b32 v2, 3, v1
    v_and_b32 v3, 7, v1
    v_xor_b32 v3, s51, v3
    v_lshl_add_u32 v4, v2, 7, s52
    v_mul_u32_u24 v8, 11, v2
    v_bfe_u32 v9, v8, 6, 1
    v_lshrrev_b32 v8, 5, v8
    v_xor_b32 v9, v3, v9
    v_mad_i32_i24 v8, v8, s50, v4
    v_lshl_add_u32 v168, v9, 4, v8
    v_add_u32 v8, 8, v2
    v_mul_u32_u24 v8, 11, v8
    v_bfe_u32 v9, v8, 6, 1
    v_lshrrev_b32 v8, 5, v8
    v_xor_b32 v9, v3, v9
    v_mad_i32_i24 v8, v8, s50, v4
    v_lshl_add_u32 v169, v9, 4, v8
    v_add_u32 v8, 16, v2
    v_mul_u32_u24 v8, 11, v8
    v_bfe_u32 v9, v8, 6, 1
    v_lshrrev_b32 v8, 5, v8
    v_xor_b32 v9, v3, v9
    v_mad_i32_i24 v8, v8, s50, v4
    v_lshl_add_u32 v170, v9, 4, v8
    s_movk_i32 s53, 0x480
    s_movk_i32 s54, -96
    v_lshrrev_b32 v10, 1, v1
    v_lshlrev_b32 v12, 4, v1
    v_mul_u32_u24 v8, 43, v10
    v_lshrrev_b32 v9, 8, v8
    v_lshrrev_b32 v8, 7, v8
    v_and_b32 v9, 4, v9
    v_xor_b32 v9, v8, v9
    v_mad_i32_i24 v8, v8, s54, v12
    v_mad_u32_u24 v172, v9, s53, v8
    v_add_u32 v8, 32, v10
    v_mul_u32_u24 v8, 43, v8
    v_lshrrev_b32 v9, 8, v8
    v_lshrrev_b32 v8, 7, v8
    v_and_b32 v9, 4, v9
    v_xor_b32 v9, v8, v9
    v_mad_i32_i24 v8, v8, s54, v12
    v_mad_u32_u24 v173, v9, s53, v8
    v_add_u32 v8, 64, v10
    v_mul_u32_u24 v8, 43, v8
    v_lshrrev_b32 v9, 8, v8
    v_lshrrev_b32 v8, 7, v8
    v_and_b32 v9, 4, v9
    v_xor_b32 v9, v8, v9
    v_mad_i32_i24 v8, v8, s54, v12
    v_mad_u32_u24 v174, v9, s53, v8
    s_waitcnt lgkmcnt(0)
    s_add_u32 m0, s46, 0xc00
    s_add_u32 s59, s40, s45
    buffer_load_dwordx4 v168, s[4:7], s59 offen lds
    s_add_u32 m0, s29, 0
    s_add_u32 s60, s39, 0x180
    buffer_load_dwordx4 v172, s[8:11], s60 offen lds
    s_add_u32 m0, s46, 0xc00
    s_add_u32 s52, s40, 0
    buffer_load_dwordx4 v169, s[4:7], s59 offen offset:1024 lds
    s_add_u32 m0, s29, 0
    v_add_u32 v5, s52, v168
    buffer_load_dwordx4 v173, s[8:11], s60 offen offset:1024 lds
    s_add_u32 m0, s46, 0xc00
    v_max_i32 v5, 0, v5
    buffer_load_dwordx4 v170, s[4:7], s59 offen offset:2048 lds
    s_add_u32 m0, s29, 0
    s_add_u32 s61, s39, 0x9180
    buffer_load_dwordx4 v174, s[8:11], s60 offen offset:2048 lds
    s_add_u32 m0, s46, 0
    s_add_u32 s53, s40, 0x400
    buffer_load_dwordx4 v5, s[4:7], 0 offen lds
    s_add_u32 m0, s29, 0xc00
    v_add_u32 v6, s53, v169
    buffer_load_dwordx4 v172, s[8:11], s61 offen lds
    s_add_u32 m0, s46, 0x400
    v_max_i32 v6, 0, v6
    buffer_load_dwordx4 v6, s[4:7], 0 offen lds
    s_add_u32 m0, s29, 0xc00
    s_add_u32 s54, s40, 0x800
    buffer_load_dwordx4 v173, s[8:11], s61 offen offset:1024 lds
    s_add_u32 m0, s46, 0x800
    v_add_u32 v7, s54, v170
    v_max_i32 v7, 0, v7
    buffer_load_dwordx4 v7, s[4:7], 0 offen lds
    s_add_u32 m0, s29, 0xc00
    s_add_u32 s62, s39, 0x12180
    buffer_load_dwordx4 v174, s[8:11], s61 offen offset:2048 lds
    s_add_u32 m0, s46, 0x7800
    s_mov_b32 s33, 0
    s_add_u32 s66, s64, 1
    s_and_b32 s66, s66, 6
    s_cselect_b32 s33, 0, 3
    s_add_u32 s66, s65, 1
    s_and_b32 s66, s66, 6
    s_cselect_b32 s34, 0, 1
    s_cmp_lt_i32 s30, 0
    s_cselect_b32 s35, 1, 0
    s_cselect_b32 s49, -1, 1
    s_mul_i32 s49, s49, 0x1c0
    s_cselect_b32 s48, 0, 0x4e
    s_mul_i32 s66, s28, 0x152
    s_add_u32 s48, s48, s66
    s_lshl2_add_u32 s42, s30, s41
    s_lshl2_add_u32 s43, s30, s42
    s_lshl2_add_u32 s44, s30, s43
    s_mul_i32 s66, s36, 0x1d00
    s_add_u32 s32, s32, s66
    s_mul_i32 s37, s28, 0x1180
    s_add_u32 s37, s37, 0x239c0
    s_mov_b32 s38, 0x3e553b95
    s_mov_b32 s3, 0x3dd53b95
    s_mov_b32 s14, 0x12000
    s_mov_b32 s15, 0x20000
    s_mov_b32 s18, 0x548
    s_mov_b32 s19, 0x20000
    s_mov_b32 s22, 0x1260000
    s_mov_b32 s23, 0x20000
    s_mov_b32 s26, 0x1000000
    s_mov_b32 s27, 0x20000
    s_add_u32 s59, s41, s45
    s_add_u32 s63, s39, 0x1b180
    v_and_b32 v13, 15, v1
    v_lshrrev_b32 v14, 4, v1
    v_lshrrev_b32 v15, 2, v13
    v_and_b32 v17, 1, v14
    v_lshl_add_u32 v18, v14, 3, v15
    v_xor_b32 v19, 0, v17
    v_lshl_add_u32 v19, v19, 2, v18
    v_and_b32 v16, 3, v13
    v_mul_u32_u24 v19, 0x60, v19
    v_lshl_add_u32 v19, v16, 3, v19
    v_add_u32 v249, s29, v19
    v_xor_b32 v19, 1, v17
    v_lshl_add_u32 v19, v19, 2, v18
    v_mov_b32 v17, v15
    v_and_b32 v18, 3, v17
    v_lshlrev_b32 v18, 1, v18
    v_bfe_u32 v241, v16, 1, 1
    v_or_b32 v18, v18, v241
    v_mul_u32_u24 v17, 0x1e00, v17
    v_xor_b32 v18, v18, v14
    v_mul_u32_u24 v19, 0x60, v19
    v_lshl_add_u32 v17, v18, 4, v17
    v_lshl_add_u32 v19, v16, 3, v19
    v_mul_u32_u24 v18, 0x180, v16
    v_add_u32 v250, s29, v19
    v_add_u32 v240, v17, v18
    v_xor_b32 v241, 64, v240
    s_add_u32 s60, s39, 0x24180
    s_add_u32 s61, s39, 0x2d180
    s_and_b32 s65, s48, 0xfff0
    s_lshl1_add_u32 s58, s45, s40
    s_add_u32 s55, s28, 3
    s_mov_b32 s56, 3
    s_mul_i32 s55, s55, s30
    s_mul_i32 s56, s56, s31
    s_add_u32 s55, s55, s56
    s_add_u32 s55, s55, s32
    s_mul_i32 s57, s30, 0
    s_mul_i32 s51, s31, 4
    s_add_u32 s57, s57, s51
    s_mul_i32 s52, s30, 0
    s_mul_i32 s53, s31, 4
    s_add_u32 s52, s52, s53
    s_mul_i32 s54, s30, 4
    s_mul_i32 s56, s30, 0
    s_mul_i32 s51, s30, 0
    s_add_u32 s53, s28, 3
    s_mul_i32 s53, s53, s30
    buffer_load_dwordx4 v168, s[4:7], s41 offen lds
    s_add_u32 m0, s29, 0x1800
    s_nop 0
    buffer_load_dwordx4 v172, s[8:11], s62 offen lds
    s_add_u32 m0, s46, 0x7800
    s_nop 0
    buffer_load_dwordx4 v169, s[4:7], s41 offen offset:1024 lds
    s_add_u32 m0, s29, 0x1800
    s_nop 0
    buffer_load_dwordx4 v173, s[8:11], s62 offen offset:1024 lds
    s_add_u32 m0, s46, 0x7800
    s_nop 0
    buffer_load_dwordx4 v170, s[4:7], s41 offen offset:2048 lds
    s_add_u32 m0, s29, 0x1800
    s_nop 0
    buffer_load_dwordx4 v174, s[8:11], s62 offen offset:2048 lds
    s_add_u32 m0, s46, 0x8400
    s_waitcnt vmcnt(12)
    ds_read_b64_tr_b16 a[0:1], v249 offset:0
    ds_read_b64_tr_b16 a[2:3], v250 offset:0
    ds_read_b64_tr_b16 a[24:25], v249 offset:32
    ds_read_b64_tr_b16 a[26:27], v250 offset:32
    ds_read_b64_tr_b16 a[48:49], v249 offset:64
    ds_read_b64_tr_b16 a[50:51], v250 offset:64
    s_add_u32 s62, s39, 0x300
    buffer_load_dwordx4 v168, s[4:7], s59 offen lds
    s_add_u32 m0, s29, 0x2400
    s_nop 0
    buffer_load_dwordx4 v172, s[8:11], s63 offen lds
    s_add_u32 m0, s46, 0x8400
    s_nop 0
    buffer_load_dwordx4 v169, s[4:7], s59 offen offset:1024 lds
    s_add_u32 m0, s29, 0x2400
    s_nop 0
    buffer_load_dwordx4 v173, s[8:11], s63 offen offset:1024 lds
    s_add_u32 m0, s46, 0x8400
    s_nop 0
    buffer_load_dwordx4 v170, s[4:7], s59 offen offset:2048 lds
    s_waitcnt vmcnt(12)
    s_barrier
    ds_read_b128 a[216:219], v240 offset:0
    ds_read_b128 a[220:223], v240 offset:1536
    ds_read_b128 a[224:227], v240 offset:3072
    ds_read_b128 a[228:231], v240 offset:4608
    ds_read_b128 a[232:235], v241 offset:0
    ds_read_b128 a[236:239], v241 offset:1536
    s_add_u32 m0, s29, 0x2400
    ds_read_b128 a[240:243], v241 offset:3072
    ds_read_b128 a[244:247], v241 offset:4608
    s_add_u32 s59, s42, s45
    s_waitcnt vmcnt(11)
    ds_read_b64_tr_b16 a[4:5], v249 offset:3072
    ds_read_b64_tr_b16 a[6:7], v250 offset:3072
    ds_read_b64_tr_b16 a[28:29], v249 offset:3104
    ds_read_b64_tr_b16 a[30:31], v250 offset:3104
    ds_read_b64_tr_b16 a[52:53], v249 offset:3136
    ds_read_b64_tr_b16 a[54:55], v250 offset:3136
    buffer_load_dwordx4 v174, s[8:11], s63 offen offset:2048 lds
    s_add_u32 m0, s29, 0
    s_waitcnt lgkmcnt(14)
    s_add_u32 s63, s39, 0x9300
    s_waitcnt lgkmcnt(13)
    v_mfma_f32_16x16x32_bf16 v[180:183], a[0:3], a[216:219], 0
    v_mfma_f32_16x16x32_bf16 v[184:187], a[24:27], a[216:219], 0
    s_waitcnt lgkmcnt(12)
    buffer_load_dwordx4 v172, s[8:11], s60 offen lds
    v_mfma_f32_16x16x32_bf16 v[188:191], a[48:51], a[216:219], 0
    s_waitcnt lgkmcnt(11)
    ds_read_b128 a[216:219], v240 offset:128
    v_mfma_f32_16x16x32_bf16 v[192:195], a[0:3], a[220:223], 0
    s_waitcnt lgkmcnt(11)
    v_mfma_f32_16x16x32_bf16 v[196:199], a[24:27], a[220:223], 0
    v_mfma_f32_16x16x32_bf16 v[200:203], a[48:51], a[220:223], 0
    ds_read_b128 a[220:223], v240 offset:1664
    buffer_load_dwordx4 v173, s[8:11], s60 offen offset:1024 lds
    v_mfma_f32_16x16x32_bf16 v[204:207], a[0:3], a[224:227], 0
    v_mfma_f32_16x16x32_bf16 v[208:211], a[24:27], a[224:227], 0
    v_mfma_f32_16x16x32_bf16 v[212:215], a[48:51], a[224:227], 0
    s_waitcnt lgkmcnt(5)
    ds_read_b128 a[224:227], v240 offset:3200
    v_mfma_f32_16x16x32_bf16 v[216:219], a[0:3], a[228:231], 0
    s_waitcnt lgkmcnt(4)
    buffer_load_dwordx4 v174, s[8:11], s60 offen offset:2048 lds
    v_mfma_f32_16x16x32_bf16 v[220:223], a[24:27], a[228:231], 0
    s_waitcnt lgkmcnt(3)
    s_add_u32 m0, s29, 0xc00
    s_add_u32 s60, s39, 0x12300
    v_mfma_f32_16x16x32_bf16 v[224:227], a[48:51], a[228:231], 0
    ds_read_b128 a[228:231], v240 offset:4736
    v_mfma_f32_16x16x32_bf16 v[180:183], a[4:7], a[232:235], v[180:183]
    v_mfma_f32_16x16x32_bf16 v[184:187], a[28:31], a[232:235], v[184:187]
    buffer_load_dwordx4 v172, s[8:11], s61 offen lds
    v_mfma_f32_16x16x32_bf16 v[188:191], a[52:55], a[232:235], v[188:191]
    v_mfma_f32_16x16x32_bf16 v[192:195], a[4:7], a[236:239], v[192:195]
    v_mfma_f32_16x16x32_bf16 v[196:199], a[28:31], a[236:239], v[196:199]
    v_mfma_f32_16x16x32_bf16 v[200:203], a[52:55], a[236:239], v[200:203]
    buffer_load_dwordx4 v173, s[8:11], s61 offen offset:1024 lds
    v_mfma_f32_16x16x32_bf16 v[204:207], a[4:7], a[240:243], v[204:207]
    v_mfma_f32_16x16x32_bf16 v[208:211], a[28:31], a[240:243], v[208:211]
    v_mfma_f32_16x16x32_bf16 v[212:215], a[52:55], a[240:243], v[212:215]
    v_mfma_f32_16x16x32_bf16 v[216:219], a[4:7], a[244:247], v[216:219]
    s_waitcnt vmcnt(11)
    ds_read_b64_tr_b16 a[8:9], v249 offset:6144
    v_mfma_f32_16x16x32_bf16 v[220:223], a[28:31], a[244:247], v[220:223]
    ds_read_b64_tr_b16 a[10:11], v250 offset:6144
    ds_read_b64_tr_b16 a[32:33], v249 offset:6176
    v_mfma_f32_16x16x32_bf16 v[224:227], a[52:55], a[244:247], v[224:227]
    ds_read_b64_tr_b16 a[34:35], v250 offset:6176
    ds_read_b64_tr_b16 a[56:57], v249 offset:6208
    ds_read_b64_tr_b16 a[58:59], v250 offset:6208
    buffer_load_dwordx4 v174, s[8:11], s61 offen offset:2048 lds
    s_add_u32 m0, s37, 0xd80
    s_add_u32 s61, s39, 0x1b300
    v_add_u32 v17, 3, v15
    v_add_u32 v19, 3, v16
    v_and_b32 v18, 3, v17
    v_lshlrev_b32 v18, 1, v18
    v_bfe_u32 v243, v19, 1, 1
    v_or_b32 v18, v18, v243
    v_mul_u32_u24 v17, 0x1e00, v17
    v_xor_b32 v18, v18, v14
    v_lshl_add_u32 v17, v18, 4, v17
    buffer_load_dwordx4 v12, s[16:19], s65 offen lds
    s_add_u32 m0, s29, 0x1800
    v_mul_u32_u24 v18, 0x180, v19
    v_add_u32 v242, v17, v18
    v_mov_b32 v17, 0x3f803f80
    s_and_b32 s66, s28, 1
    v_lshrrev_b32 v18, 1, v13
    v_accvgpr_write_b32 a248, v17
    s_waitcnt lgkmcnt(4)
    v_mfma_f32_16x16x32_bf16 v[180:183], a[8:11], a[216:219], v[180:183]
    s_lshl_b32 s66, s66, 2
    v_accvgpr_write_b32 a249, v17
    s_waitcnt lgkmcnt(2)
    v_mfma_f32_16x16x32_bf16 v[184:187], a[32:35], a[216:219], v[184:187]
    s_lshr_b32 s67, s28, 1
    v_accvgpr_write_b32 a250, v17
    s_waitcnt lgkmcnt(0)
    v_mfma_f32_16x16x32_bf16 v[188:191], a[56:59], a[216:219], v[188:191]
    buffer_load_dwordx4 v172, s[8:11], s62 offen lds
    v_accvgpr_write_b32 a251, v17
    v_mfma_f32_16x16x32_bf16 v[192:195], a[8:11], a[220:223], v[192:195]
    s_lshl_b32 s67, s67, 3
    v_xor_b32 v18, v14, v18
    v_xor_b32 v18, s66, v18
    v_mfma_f32_16x16x32_bf16 v[196:199], a[32:35], a[220:223], v[196:199]
    s_lshl_b32 s66, s36, 1
    v_mul_u32_u24 v17, 0x180, v13
    v_lshl_add_u32 v17, v18, 4, v17
    v_mfma_f32_16x16x32_bf16 v[200:203], a[56:59], a[220:223], v[200:203]
    s_sub_u32 s66, 1, s66
    v_add_u32 v17, s67, v17
    v_add_u32 v247, 0x7800, v17
    v_mfma_f32_16x16x32_bf16 v[204:207], a[8:11], a[224:227], v[204:207]
    buffer_load_dwordx4 v173, s[8:11], s62 offen offset:1024 lds
    v_add_u32 v251, 0x1e000, v17
    v_mfma_f32_16x16x32_bf16 v[208:211], a[32:35], a[224:227], v[208:211]
    s_mul_i32 s64, s35, 0xfc0
    v_sub_u32 v17, v14, v15
    v_mul_i32_i24 v17, 0x1c0, v17
    v_mfma_f32_16x16x32_bf16 v[212:215], a[56:59], a[224:227], v[212:215]
    s_add_u32 s64, s64, s37
    v_lshlrev_b32 v18, 4, v16
    v_sub_u32 v17, v17, v18
    v_mfma_f32_16x16x32_bf16 v[216:219], a[8:11], a[228:231], v[216:219]
    s_add_u32 s50, s31, 0xfffffe80
    v_max_u32 v18, s33, v15
    v_sub_u32 v18, v14, v18
    v_mfma_f32_16x16x32_bf16 v[220:223], a[32:35], a[228:231], v[220:223]
    buffer_load_dwordx4 v174, s[8:11], s62 offen offset:2048 lds
    v_add_u32 v244, 0, v18
    v_mfma_f32_16x16x32_bf16 v[224:227], a[56:59], a[228:231], v[224:227]
    s_add_u32 m0, s29, 0x2400
    s_add_u32 s62, s39, 0x24300
    v_cmp_gt_u32 vcc, 7, v244
    v_add_u32 v17, s37, v17
    s_waitcnt vmcnt(11)
    s_barrier
    ds_read_b128 a[232:235], v240 offset:30720
    ds_read_b128 a[236:239], v240 offset:32256
    ds_read_b128 a[240:243], v240 offset:33792
    ds_read_b128 a[244:247], v240 offset:35328
    ds_read_b128 a[216:219], v241 offset:30720
    ds_read_b128 a[220:223], v241 offset:32256
    ds_read_b128 a[224:227], v241 offset:33792
    ds_read_b128 a[228:231], v241 offset:35328
    v_add_u32 v244, 0xfffdc870, v17
    v_cndmask_b32 v244, 0, v244, vcc
    v_add_u32 v245, 4, v18
    v_cmp_gt_u32 vcc, 7, v245
    v_add_u32 v245, 0xfffdcf70, v17
    s_waitcnt vmcnt(10)
    ds_read_b64_tr_b16 a[12:13], v249 offset:9216
    ds_read_b64_tr_b16 a[14:15], v250 offset:9216
    ds_read_b64_tr_b16 a[36:37], v249 offset:9248
    ds_read_b64_tr_b16 a[38:39], v250 offset:9248
    ds_read_b64_tr_b16 a[60:61], v249 offset:9280
    ds_read_b64_tr_b16 a[62:63], v250 offset:9280
    v_cndmask_b32 v245, 0, v245, vcc
    v_add_u32 v246, 8, v18
    v_cmp_gt_u32 vcc, 7, v246
    v_add_u32 v246, 0xfffdd670, v17
    v_min_u32 v20, 55, v1
    v_cndmask_b32 v246, 0, v246, vcc
    v_lshrrev_b32 v21, 1, v20
    v_cmp_lt_u32 vcc, 11, v21
    s_waitcnt lgkmcnt(13)
    v_mfma_f32_16x16x32_bf16 v[228:231], a[0:3], a[232:235], 0
    s_mul_i32 s67, s28, 0x600
    v_lshlrev_b32 v62, 3, v20
    s_waitcnt lgkmcnt(12)
    v_mfma_f32_16x16x32_bf16 v[232:235], a[24:27], a[232:235], 0
    v_add_u32 v22, -12, v21
    s_waitcnt lgkmcnt(11)
    v_mfma_f32_16x16x32_bf16 v[236:239], a[48:51], a[232:235], 0
    ds_read_b128 a[232:235], v240 offset:30848
    s_waitcnt lgkmcnt(11)
    v_mfma_f32_16x16x32_bf16 v[138:141], a[0:3], a[236:239], 0
    v_mov_b32 v23, s34
    s_waitcnt lgkmcnt(10)
    v_mfma_f32_16x16x32_bf16 v[142:145], a[24:27], a[236:239], 0
    v_and_b32 v20, 1, v20
    s_waitcnt lgkmcnt(9)
    v_mfma_f32_16x16x32_bf16 v[146:149], a[48:51], a[236:239], 0
    ds_read_b128 a[236:239], v240 offset:32384
    v_cndmask_b32 v22, v21, v22, vcc
    v_mfma_f32_16x16x32_bf16 v[150:153], a[0:3], a[240:243], 0
    s_waitcnt lgkmcnt(9)
    v_cndmask_b32 v23, 0, v23, vcc
    v_lshlrev_b32 v20, 1, v20
    v_mfma_f32_16x16x32_bf16 v[154:157], a[24:27], a[240:243], 0
    v_cmp_ne_u32 vcc, 0, v23
    v_add_u32 v63, 0, v20
    v_mfma_f32_16x16x32_bf16 v[158:161], a[48:51], a[240:243], 0
    ds_read_b128 a[240:243], v240 offset:33920
    v_add3_u32 v64, v22, v63, -6
    v_mfma_f32_16x16x32_bf16 v[162:165], a[0:3], a[244:247], 0
    s_waitcnt lgkmcnt(4)
    v_and_b32 v66, 12, v22
    v_add_u32 v65, 3, v64
    v_mfma_f32_16x16x32_bf16 v[24:27], a[24:27], a[244:247], 0
    s_waitcnt lgkmcnt(3)
    v_add3_u32 v66, v66, v63, -3
    v_cndmask_b32 v65, v65, v66, vcc
    v_mfma_f32_16x16x32_bf16 v[54:57], a[48:51], a[244:247], 0
    ds_read_b128 a[244:247], v240 offset:35456
    v_cmp_gt_u32 vcc, 7, v65
    v_mfma_f32_16x16x32_bf16 v[228:231], a[4:7], a[216:219], v[228:231]
    s_waitcnt lgkmcnt(3)
    v_mul_i32_i24 v64, s66, v64
    v_add_lshl_u32 v64, v64, 6, 1
    v_mfma_f32_16x16x32_bf16 v[232:235], a[28:31], a[216:219], v[232:235]
    buffer_load_dwordx4 v172, s[8:11], s63 offen lds
    v_cndmask_b32 v50, 0, v64, vcc
    v_mfma_f32_16x16x32_bf16 v[236:239], a[52:55], a[216:219], v[236:239]
    ds_read_b128 a[216:219], v241 offset:128
    v_mov_b32 v64, 0x3fb8aa3b
    v_mfma_f32_16x16x32_bf16 v[138:141], a[4:7], a[220:223], v[138:141]
    s_waitcnt lgkmcnt(3)
    v_cndmask_b32 v52, 0, v64, vcc
    v_mov_b32 v64, 0
    v_mfma_f32_16x16x32_bf16 v[142:145], a[28:31], a[220:223], v[142:145]
    v_mov_b32 v65, 0xf149f2ca
    v_cndmask_b32 v60, v65, v64, vcc
    v_mfma_f32_16x16x32_bf16 v[146:149], a[52:55], a[220:223], v[146:149]
    ds_read_b128 a[220:223], v241 offset:1664
    v_cmp_ne_u32 vcc, 0, v23
    v_mfma_f32_16x16x32_bf16 v[150:153], a[4:7], a[224:227], v[150:153]
    s_waitcnt lgkmcnt(3)
    v_add_u32 v63, 1, v20
    v_add3_u32 v64, v22, v63, -6
    v_mfma_f32_16x16x32_bf16 v[154:157], a[28:31], a[224:227], v[154:157]
    buffer_load_dwordx4 v173, s[8:11], s63 offen offset:1024 lds
    v_and_b32 v66, 12, v22
    v_mfma_f32_16x16x32_bf16 v[158:161], a[52:55], a[224:227], v[158:161]
    ds_read_b128 a[224:227], v241 offset:3200
    v_add_u32 v65, 3, v64
    v_mfma_f32_16x16x32_bf16 v[162:165], a[4:7], a[228:231], v[162:165]
    s_waitcnt lgkmcnt(3)
    v_add3_u32 v66, v66, v63, -3
    v_cndmask_b32 v65, v65, v66, vcc
    v_mfma_f32_16x16x32_bf16 v[24:27], a[28:31], a[228:231], v[24:27]
    v_cmp_gt_u32 vcc, 7, v65
    s_waitcnt lgkmcnt(2)
    v_mfma_f32_16x16x32_bf16 v[54:57], a[52:55], a[228:231], v[54:57]
    ds_read_b128 a[228:231], v241 offset:4736
    v_add_u32 v62, s64, v62
    v_mfma_f32_16x16x32_bf16 v[228:231], a[8:11], a[232:235], v[228:231]
    buffer_load_dwordx4 v174, s[8:11], s63 offen offset:2048 lds
    v_mul_i32_i24 v64, s66, v64
    v_mfma_f32_16x16x32_bf16 v[232:235], a[32:35], a[232:235], v[232:235]
    s_add_u32 m0, s29, 0
    s_waitcnt lgkmcnt(2)
    v_add_lshl_u32 v64, v64, 6, 1
    v_mfma_f32_16x16x32_bf16 v[236:239], a[56:59], a[232:235], v[236:239]
    ds_read_b128 a[232:235], v241 offset:30848
    v_cndmask_b32 v51, 0, v64, vcc
    v_mfma_f32_16x16x32_bf16 v[138:141], a[8:11], a[236:239], v[138:141]
    s_add_u32 s63, s39, 0x2d300
    v_mov_b32 v64, 0x3fb8aa3b
    v_cndmask_b32 v53, 0, v64, vcc
    v_mfma_f32_16x16x32_bf16 v[142:145], a[32:35], a[236:239], v[142:145]
    s_and_b32 s64, s48, 15
    s_waitcnt lgkmcnt(2)
    v_mov_b32 v64, 0
    v_mfma_f32_16x16x32_bf16 v[146:149], a[56:59], a[236:239], v[146:149]
    ds_read_b128 a[236:239], v241 offset:32384
    v_mov_b32 v65, 0xf149f2ca
    v_mfma_f32_16x16x32_bf16 v[150:153], a[8:11], a[240:243], v[150:153]
    s_add_u32 s64, s64, s37
    v_add_u32 v50, s64, v50
    v_add_u32 v51, s64, v51
    v_mfma_f32_16x16x32_bf16 v[154:157], a[32:35], a[240:243], v[154:157]
    s_mul_i32 s66, s28, 0xffffee00
    s_waitcnt lgkmcnt(2)
    v_cndmask_b32 v61, v65, v64, vcc
    v_mfma_f32_16x16x32_bf16 v[158:161], a[56:59], a[240:243], v[158:161]
    ds_read_b128 a[240:243], v241 offset:33920
    s_waitcnt vmcnt(10)
    v_mfma_f32_16x16x32_bf16 v[162:165], a[8:11], a[244:247], v[162:165]
    ds_read_b64_tr_b16 a[16:17], v249 offset:0
    ds_read_b64_tr_b16 a[18:19], v250 offset:0
    v_mfma_f32_16x16x32_bf16 v[24:27], a[32:35], a[244:247], v[24:27]
    ds_read_b64_tr_b16 a[40:41], v249 offset:32
    s_waitcnt lgkmcnt(5)
    v_mfma_f32_16x16x32_bf16 v[54:57], a[56:59], a[244:247], v[54:57]
    ds_read_b128 a[244:247], v241 offset:35456
    ds_read_b64_tr_b16 a[42:43], v250 offset:32
    v_mfma_f32_16x16x32_bf16 v[180:183], a[12:15], a[216:219], v[180:183]
    ds_read_b64_tr_b16 a[64:65], v249 offset:64
    ds_read_b64_tr_b16 a[66:67], v250 offset:64
    v_mfma_f32_16x16x32_bf16 v[184:187], a[36:39], a[216:219], v[184:187]
    s_waitcnt lgkmcnt(8)
    v_lshlrev_b32 v63, 3, v1
    v_mov_b32 v64, 0xf149f2ca
    v_mfma_f32_16x16x32_bf16 v[188:191], a[60:63], a[216:219], v[188:191]
    ds_read_b128 a[216:219], v240 offset:256
    v_mov_b32 v65, 0xf149f2ca
    v_mfma_f32_16x16x32_bf16 v[192:195], a[12:15], a[220:223], v[192:195]
    v_add_u32 v63, 0x237c0, v63
    v_mbcnt_lo_u32_b32 v67, -1, 0
    v_mfma_f32_16x16x32_bf16 v[196:199], a[36:39], a[220:223], v[196:199]
    s_waitcnt lgkmcnt(8)
    v_mbcnt_hi_u32_b32 v67, -1, v67
    v_lshrrev_b32 v68, 1, v67
    v_mfma_f32_16x16x32_bf16 v[200:203], a[60:63], a[220:223], v[200:203]
    ds_read_b128 a[220:223], v240 offset:1792
    v_add_u32 v68, 0, v68
    v_mfma_f32_16x16x32_bf16 v[204:207], a[12:15], a[224:227], v[204:207]
    ds_write_b64 v63, v[64:65] offset:0
    v_mfma_f32_16x16x32_bf16 v[208:211], a[36:39], a[224:227], v[208:211]
    s_waitcnt lgkmcnt(6)
    v_mul_u32_u24 v69, 43, v68
    v_lshrrev_b32 v70, 8, v69
    v_mfma_f32_16x16x32_bf16 v[212:215], a[60:63], a[224:227], v[212:215]
    ds_read_b128 a[224:227], v240 offset:3328
    v_lshrrev_b32 v69, 7, v69
    v_mfma_f32_16x16x32_bf16 v[216:219], a[12:15], a[228:231], v[216:219]
    s_waitcnt lgkmcnt(4)
    v_mad_i32_i24 v68, v69, -3, v68
    v_and_b32 v70, 4, v70
    v_mfma_f32_16x16x32_bf16 v[220:223], a[36:39], a[228:231], v[220:223]
    s_waitcnt lgkmcnt(3)
    v_xor_b32 v69, v69, v70
    v_and_b32 v70, 4, v69
    v_mfma_f32_16x16x32_bf16 v[224:227], a[60:63], a[228:231], v[224:227]
    ds_read_b128 a[228:231], v240 offset:4864
    v_mul_u32_u24 v252, 24, v70
    v_mfma_f32_16x16x32_bf16 v[228:231], a[12:15], a[232:235], v[228:231]
    buffer_load_dwordx4 v172, s[8:11], s60 offen lds
    v_lshrrev_b32 v70, 3, v69
    v_mfma_f32_16x16x32_bf16 v[232:235], a[36:39], a[232:235], v[232:235]
    s_waitcnt lgkmcnt(3)
    v_lshl_add_u32 v252, v70, 2, v252
    v_and_or_b32 v252, v69, 3, v252
    v_mfma_f32_16x16x32_bf16 v[236:239], a[60:63], a[232:235], v[236:239]
    ds_read_b128 a[232:235], v240 offset:30976
    v_mad_u32_u24 v252, v252, 3, v68
    v_mfma_f32_16x16x32_bf16 v[138:141], a[12:15], a[236:239], v[138:141]
    v_lshrrev_b32 v68, 1, v67
    v_and_b32 v70, 1, v67
    v_mfma_f32_16x16x32_bf16 v[142:145], a[36:39], a[236:239], v[142:145]
    buffer_load_dwordx4 v173, s[8:11], s60 offen offset:1024 lds
    s_waitcnt lgkmcnt(2)
    v_mfma_f32_16x16x32_bf16 v[146:149], a[60:63], a[236:239], v[146:149]
    ds_read_b128 a[236:239], v240 offset:32512
    v_add_u32 v68, 32, v68
    v_mfma_f32_16x16x32_bf16 v[150:153], a[12:15], a[240:243], v[150:153]
    v_lshl_add_u32 v252, v252, 3, v70
    v_mul_u32_u24 v69, 43, v68
    v_mfma_f32_16x16x32_bf16 v[154:157], a[36:39], a[240:243], v[154:157]
    v_lshrrev_b32 v70, 8, v69
    s_waitcnt lgkmcnt(2)
    v_mfma_f32_16x16x32_bf16 v[158:161], a[60:63], a[240:243], v[158:161]
    ds_read_b128 a[240:243], v240 offset:34048
    s_waitcnt vmcnt(9)
    v_mfma_f32_16x16x32_bf16 v[162:165], a[12:15], a[244:247], v[162:165]
    ds_read_b64_tr_b16 a[20:21], v249 offset:3072
    ds_read_b64_tr_b16 a[22:23], v250 offset:3072
    v_mfma_f32_16x16x32_bf16 v[24:27], a[36:39], a[244:247], v[24:27]
    ds_read_b64_tr_b16 a[44:45], v249 offset:3104
    s_waitcnt lgkmcnt(5)
    v_mfma_f32_16x16x32_bf16 v[54:57], a[60:63], a[244:247], v[54:57]
    ds_read_b128 a[244:247], v240 offset:35584
    ds_read_b64_tr_b16 a[46:47], v250 offset:3104
    v_mfma_f32_16x16x32_bf16 v[180:183], a[16:19], a[216:219], v[180:183]
    ds_read_b64_tr_b16 a[68:69], v249 offset:3136
    ds_read_b64_tr_b16 a[70:71], v250 offset:3136
    v_mfma_f32_16x16x32_bf16 v[184:187], a[40:43], a[216:219], v[184:187]
    s_waitcnt lgkmcnt(8)
    v_lshrrev_b32 v69, 7, v69
    v_mad_i32_i24 v68, v69, -3, v68
    v_mfma_f32_16x16x32_bf16 v[188:191], a[64:67], a[216:219], v[188:191]
    ds_read_b128 a[216:219], v241 offset:256
    v_and_b32 v70, 4, v70
    v_mfma_f32_16x16x32_bf16 v[192:195], a[16:19], a[220:223], v[192:195]
    buffer_load_dwordx4 v174, s[8:11], s60 offen offset:2048 lds
    v_xor_b32 v69, v69, v70
    v_mfma_f32_16x16x32_bf16 v[196:199], a[40:43], a[220:223], v[196:199]
    s_waitcnt lgkmcnt(8)
    v_and_b32 v70, 4, v69
    v_mul_u32_u24 v253, 24, v70
    v_mfma_f32_16x16x32_bf16 v[200:203], a[64:67], a[220:223], v[200:203]
    ds_read_b128 a[220:223], v241 offset:1792
    v_lshrrev_b32 v70, 3, v69
    v_mfma_f32_16x16x32_bf16 v[204:207], a[16:19], a[224:227], v[204:207]
    s_add_u32 m0, s29, 0xc00
    v_lshl_add_u32 v253, v70, 2, v253
    v_and_b32 v70, 1, v67
    v_mfma_f32_16x16x32_bf16 v[208:211], a[40:43], a[224:227], v[208:211]
    s_waitcnt lgkmcnt(5)
    v_add_u32 v8, 4, v2
    v_and_or_b32 v253, v69, 3, v253
    v_mfma_f32_16x16x32_bf16 v[212:215], a[64:67], a[224:227], v[212:215]
    ds_read_b128 a[224:227], v241 offset:3328
    v_mad_u32_u24 v253, v253, 3, v68
    v_mfma_f32_16x16x32_bf16 v[216:219], a[16:19], a[228:231], v[216:219]
    s_waitcnt lgkmcnt(3)
    v_lshl_add_u32 v253, v253, 3, v70
    v_mul_u32_u24 v8, 11, v8
    v_mfma_f32_16x16x32_bf16 v[220:223], a[40:43], a[228:231], v[220:223]
    buffer_load_dwordx4 v172, s[8:11], s61 offen lds
    s_waitcnt lgkmcnt(2)
    v_mfma_f32_16x16x32_bf16 v[224:227], a[64:67], a[228:231], v[224:227]
    ds_read_b128 a[228:231], v241 offset:4864
    v_bfe_u32 v9, v8, 6, 1
    v_mfma_f32_16x16x32_bf16 v[228:231], a[16:19], a[232:235], v[228:231]
    s_add_u32 s60, s39, 0
    v_lshrrev_b32 v8, 5, v8
    v_xor_b32 v9, v3, v9
    v_mfma_f32_16x16x32_bf16 v[232:235], a[40:43], a[232:235], v[232:235]
    v_mad_i32_i24 v8, v8, s50, v4
    s_waitcnt lgkmcnt(2)
    v_mfma_f32_16x16x32_bf16 v[236:239], a[64:67], a[232:235], v[236:239]
    ds_read_b128 a[232:235], v241 offset:30976
    v_lshl_add_u32 v171, v9, 4, v8
    v_mfma_f32_16x16x32_bf16 v[138:141], a[16:19], a[236:239], v[138:141]
    buffer_load_dwordx4 v173, s[8:11], s61 offen offset:1024 lds
    v_xor_b32 v243, 64, v242
    v_mfma_f32_16x16x32_bf16 v[142:145], a[40:43], a[236:239], v[142:145]
    s_waitcnt vmcnt(11)
    s_waitcnt lgkmcnt(2)
    v_add_u32 v244, 0x237c0, v244
    v_mfma_f32_16x16x32_bf16 v[146:149], a[64:67], a[236:239], v[146:149]
    ds_read_b128 a[236:239], v241 offset:32512
    v_add_u32 v245, 0x237c0, v245
    v_mfma_f32_16x16x32_bf16 v[150:153], a[16:19], a[240:243], v[150:153]
    ds_read_u16 v30, v50 offset:3456
    v_add_u32 v246, 0x237c0, v246
    v_mfma_f32_16x16x32_bf16 v[154:157], a[40:43], a[240:243], v[154:157]
    buffer_load_dwordx4 v174, s[8:11], s61 offen offset:2048 lds
    s_waitcnt lgkmcnt(3)
    v_mfma_f32_16x16x32_bf16 v[158:161], a[64:67], a[240:243], v[158:161]
    ds_read_b128 a[240:243], v241 offset:34048
    s_waitcnt vmcnt(9)
    v_mfma_f32_16x16x32_bf16 v[162:165], a[16:19], a[244:247], v[162:165]
    ds_read_b64_tr_b16 a[72:73], v249 offset:6144
    ds_read_b64_tr_b16 a[74:75], v250 offset:6144
    v_mfma_f32_16x16x32_bf16 v[24:27], a[40:43], a[244:247], v[24:27]
    ds_read_b64_tr_b16 a[96:97], v249 offset:6176
    s_waitcnt lgkmcnt(6)
    v_mfma_f32_16x16x32_bf16 v[54:57], a[64:67], a[244:247], v[54:57]
    ds_read_b128 a[244:247], v241 offset:35584
    ds_read_b64_tr_b16 a[98:99], v250 offset:6176
    v_mfma_f32_16x16x32_bf16 v[180:183], a[20:23], a[216:219], v[180:183]
    ds_read_b64_tr_b16 a[120:121], v249 offset:6208
    ds_read_b64_tr_b16 a[122:123], v250 offset:6208
    v_mfma_f32_16x16x32_bf16 v[184:187], a[44:47], a[216:219], v[184:187]
    s_waitcnt lgkmcnt(9)
    v_accvgpr_write_b32 a252, v168
    v_accvgpr_write_b32 a253, v169
    v_mfma_f32_16x16x32_bf16 v[188:191], a[68:71], a[216:219], v[188:191]
    ds_read_b128 a[216:219], v240 offset:0
    v_cvt_pk_bf16_f32 v90, v180, v181
    v_mfma_f32_16x16x32_bf16 v[192:195], a[20:23], a[220:223], v[192:195]
    s_add_u32 m0, s46, 0xf000
    v_cvt_pk_bf16_f32 v91, v182, v183
    v_cvt_pk_bf16_f32 v92, v184, v185
    v_mfma_f32_16x16x32_bf16 v[196:199], a[44:47], a[220:223], v[196:199]
    s_waitcnt lgkmcnt(8)
    v_cvt_pk_bf16_f32 v93, v186, v187
    v_cvt_pk_bf16_f32 v94, v188, v189
    v_mfma_f32_16x16x32_bf16 v[200:203], a[68:71], a[220:223], v[200:203]
    ds_read_b128 a[220:223], v240 offset:1536
    v_cvt_pk_bf16_f32 v95, v190, v191
    v_mfma_f32_16x16x32_bf16 v[204:207], a[20:23], a[224:227], v[204:207]
    s_add_u32 s61, s39, 0x9000
    v_cvt_pk_bf16_f32 v96, v192, v193
    v_cvt_pk_bf16_f32 v97, v194, v195
    v_mfma_f32_16x16x32_bf16 v[208:211], a[44:47], a[224:227], v[208:211]
    s_waitcnt lgkmcnt(5)
    v_cvt_pk_bf16_f32 v98, v196, v197
    v_cvt_pk_bf16_f32 v99, v198, v199
    v_mfma_f32_16x16x32_bf16 v[212:215], a[68:71], a[224:227], v[212:215]
    ds_read_b128 a[224:227], v240 offset:3072
    v_cvt_pk_bf16_f32 v100, v200, v201
    v_mfma_f32_16x16x32_bf16 v[216:219], a[20:23], a[228:231], v[216:219]
    buffer_load_dwordx4 v168, s[4:7], s42 offen lds
    v_cvt_pk_bf16_f32 v101, v202, v203
    v_mfma_f32_16x16x32_bf16 v[220:223], a[44:47], a[228:231], v[220:223]
    s_add_u32 m0, s29, 0x1800
    s_waitcnt lgkmcnt(2)
    v_cvt_pk_bf16_f32 v102, v204, v205
    v_mfma_f32_16x16x32_bf16 v[224:227], a[68:71], a[228:231], v[224:227]
    ds_read_b128 a[228:231], v240 offset:4608
    v_cvt_pk_bf16_f32 v103, v206, v207
    v_mfma_f32_16x16x32_bf16 v[228:231], a[20:23], a[232:235], v[228:231]
    v_cvt_pk_bf16_f32 v104, v208, v209
    v_cvt_pk_bf16_f32 v105, v210, v211
    v_mfma_f32_16x16x32_bf16 v[232:235], a[44:47], a[232:235], v[232:235]
    v_cvt_pk_bf16_f32 v106, v212, v213
    s_waitcnt lgkmcnt(2)
    v_mfma_f32_16x16x32_bf16 v[236:239], a[68:71], a[232:235], v[236:239]
    ds_read_b128 a[232:235], v240 offset:30720
    v_cvt_pk_bf16_f32 v107, v214, v215
    v_mfma_f32_16x16x32_bf16 v[138:141], a[20:23], a[236:239], v[138:141]
    v_cvt_pk_bf16_f32 v108, v216, v217
    v_cvt_pk_bf16_f32 v109, v218, v219
    v_mfma_f32_16x16x32_bf16 v[142:145], a[44:47], a[236:239], v[142:145]
    buffer_load_dwordx4 v172, s[8:11], s62 offen lds
    s_waitcnt lgkmcnt(2)
    v_mfma_f32_16x16x32_bf16 v[146:149], a[68:71], a[236:239], v[146:149]
    ds_read_b128 a[236:239], v240 offset:32256
    v_cvt_pk_bf16_f32 v110, v220, v221
    v_mfma_f32_16x16x32_bf16 v[150:153], a[20:23], a[240:243], v[150:153]
    s_add_u32 m0, s46, 0xf000
    v_cvt_pk_bf16_f32 v111, v222, v223
    v_cvt_pk_bf16_f32 v112, v224, v225
    v_mfma_f32_16x16x32_bf16 v[154:157], a[44:47], a[240:243], v[154:157]
    v_cvt_pk_bf16_f32 v113, v226, v227
    s_waitcnt vmcnt(8) lgkmcnt(2)
    v_mfma_f32_16x16x32_bf16 v[158:161], a[68:71], a[240:243], v[158:161]
    ds_read_b128 a[240:243], v240 offset:33792
    v_cvt_pk_bf16_f32 v114, v228, v229
    v_mfma_f32_16x16x32_bf16 v[162:165], a[20:23], a[244:247], v[162:165]
    v_cvt_pk_bf16_f32 v115, v230, v231
    v_cvt_pk_bf16_f32 v116, v232, v233
    v_mfma_f32_16x16x32_bf16 v[24:27], a[44:47], a[244:247], v[24:27]
    ds_read_b64_tr_b16 a[76:77], v249 offset:9216
    s_waitcnt lgkmcnt(3)
    v_mfma_f32_16x16x32_bf16 v[54:57], a[68:71], a[244:247], v[54:57]
    ds_read_b128 a[244:247], v240 offset:35328
    v_cvt_pk_bf16_f32 v117, v234, v235
    v_mfma_f32_16x16x32_bf16 v[84:87], a[216:219], a[72:75], 0
    ds_read_b64_tr_b16 a[78:79], v250 offset:9216
    v_cvt_pk_bf16_f32 v118, v236, v237
    v_mfma_f32_16x16x32_bf16 v[180:183], a[216:219], a[96:99], 0
    buffer_load_dwordx4 v169, s[4:7], s42 offen offset:1024 lds
    v_cvt_pk_bf16_f32 v119, v238, v239
    v_mfma_f32_16x16x32_bf16 v[184:187], a[216:219], a[120:123], 0
    s_waitcnt lgkmcnt(4)
    ds_read_b128 a[216:219], v241 offset:0
    v_mfma_f32_16x16x32_bf16 v[188:191], a[220:223], a[72:75], 0
    ds_read_b64_tr_b16 a[100:101], v249 offset:9248
    ds_read_b64_tr_b16 a[102:103], v250 offset:9248
    v_mfma_f32_16x16x32_bf16 v[192:195], a[220:223], a[96:99], 0
    s_add_u32 m0, s29, 0x1800
    v_cvt_pk_bf16_f32 v120, v138, v139
    v_cvt_pk_bf16_f32 v121, v140, v141
    v_mfma_f32_16x16x32_bf16 v[196:199], a[220:223], a[120:123], 0
    ds_read_b64_tr_b16 a[124:125], v249 offset:9280
    ds_read_b64_tr_b16 a[126:127], v250 offset:9280
    v_mfma_f32_16x16x32_bf16 v[200:203], a[224:227], a[72:75], 0
    v_cvt_pk_bf16_f32 v122, v142, v143
    v_cvt_pk_bf16_f32 v123, v144, v145
    v_mfma_f32_16x16x32_bf16 v[204:207], a[224:227], a[96:99], 0
    ds_read_b128 a[220:223], v241 offset:1536
    v_cvt_pk_bf16_f32 v124, v146, v147
    v_mfma_f32_16x16x32_bf16 v[208:211], a[224:227], a[120:123], 0
    v_cvt_pk_bf16_f32 v125, v148, v149
    s_waitcnt lgkmcnt(6)
    v_mfma_f32_16x16x32_bf16 v[212:215], a[228:231], a[72:75], 0
    v_cvt_pk_bf16_f32 v126, v150, v151
    v_cvt_pk_bf16_f32 v127, v152, v153
    v_mfma_f32_16x16x32_bf16 v[216:219], a[228:231], a[96:99], 0
    buffer_load_dwordx4 v173, s[8:11], s62 offen offset:1024 lds
    v_cvt_pk_bf16_f32 v128, v154, v155
    v_mfma_f32_16x16x32_bf16 v[220:223], a[228:231], a[120:123], 0
    ds_read_b128 a[224:227], v241 offset:3072
    v_cvt_pk_bf16_f32 v129, v156, v157
    v_mfma_f32_16x16x32_bf16 v[224:227], a[232:235], a[72:75], 0
    s_waitcnt lgkmcnt(4)
    v_cvt_pk_bf16_f32 v130, v158, v159
    v_cvt_pk_bf16_f32 v131, v160, v161
    v_mfma_f32_16x16x32_bf16 v[228:231], a[232:235], a[96:99], 0
    s_add_u32 m0, s46, 0xf000
    v_cvt_pk_bf16_f32 v132, v162, v163
    v_cvt_pk_bf16_f32 v133, v164, v165
    v_mfma_f32_16x16x32_bf16 v[232:235], a[232:235], a[120:123], 0
    s_waitcnt lgkmcnt(2)
    v_cvt_pk_bf16_f32 v134, v24, v25
    v_cvt_pk_bf16_f32 v135, v26, v27
    v_mfma_f32_16x16x32_bf16 v[236:239], a[236:239], a[72:75], 0
    ds_read_b128 a[228:231], v241 offset:4608
    buffer_load_dwordx4 v170, s[4:7], s42 offen offset:2048 lds
    v_mfma_f32_16x16x32_bf16 v[138:141], a[236:239], a[96:99], 0
    s_waitcnt lgkmcnt(2)
    ds_read_b128 a[232:235], v241 offset:30720
    v_mfma_f32_16x16x32_bf16 v[142:145], a[236:239], a[120:123], 0
    s_add_u32 m0, s29, 0x1800
    ds_read_b128 a[236:239], v241 offset:32256
    v_mfma_f32_16x16x32_bf16 v[146:149], a[240:243], a[72:75], 0
    ds_read_u16 v31, v51 offset:3456
    v_lshlrev_b32 v30, 16, v30
    v_mfma_f32_16x16x32_bf16 v[150:153], a[240:243], a[96:99], 0
    buffer_load_dwordx4 v174, s[8:11], s62 offen offset:2048 lds
    s_waitcnt vmcnt(9) lgkmcnt(4)
    v_mfma_f32_16x16x32_bf16 v[154:157], a[240:243], a[120:123], 0
    s_add_u32 m0, s46, 0xfc00
    ds_read_b128 a[240:243], v241 offset:33792
    v_mfma_f32_16x16x32_bf16 v[158:161], a[244:247], a[72:75], 0
    ds_read_b64_tr_b16 a[80:81], v249 offset:0
    ds_read_b64_tr_b16 a[82:83], v250 offset:0
    v_mfma_f32_16x16x32_bf16 v[162:165], a[244:247], a[96:99], 0
    ds_read_b64_tr_b16 a[104:105], v249 offset:32
    ds_read_b64_tr_b16 a[106:107], v250 offset:32
    v_mfma_f32_16x16x32_bf16 v[24:27], a[244:247], a[120:123], 0
    s_waitcnt lgkmcnt(8)
    buffer_load_dwordx4 v168, s[4:7], s59 offen lds
    v_mfma_f32_16x16x32_bf16 v[84:87], a[216:219], a[76:79], v[84:87]
    ds_read_b128 a[244:247], v241 offset:35328
    s_waitcnt lgkmcnt(8)
    v_mfma_f32_16x16x32_bf16 v[180:183], a[216:219], a[100:103], v[180:183]
    s_add_u32 m0, s29, 0x2400
    s_waitcnt lgkmcnt(7)
    v_fma_f32 v30, v30, v52, v60
    v_mfma_f32_16x16x32_bf16 v[184:187], a[216:219], a[124:127], v[184:187]
    ds_read_b128 a[216:219], v240 offset:128
    ds_read_b64_tr_b16 a[128:129], v249 offset:64
    v_mfma_f32_16x16x32_bf16 v[188:191], a[220:223], a[76:79], v[188:191]
    buffer_load_dwordx4 v172, s[8:11], s63 offen lds
    ds_read_b64_tr_b16 a[130:131], v250 offset:64
    v_mfma_f32_16x16x32_bf16 v[192:195], a[220:223], a[100:103], v[192:195]
    s_add_u32 m0, s46, 0xfc00
    s_waitcnt lgkmcnt(8)
    v_lshlrev_b32 v31, 16, v31
    v_mfma_f32_16x16x32_bf16 v[196:199], a[220:223], a[124:127], v[196:199]
    ds_read_b128 a[220:223], v240 offset:1664
    v_fma_f32 v31, v31, v53, v61
    v_mfma_f32_16x16x32_bf16 v[200:203], a[224:227], a[76:79], v[200:203]
    ds_read_u16 v32, v50 offset:3482
    v_accvgpr_write_b32 a254, v170
    v_mfma_f32_16x16x32_bf16 v[204:207], a[224:227], a[100:103], v[204:207]
    buffer_load_dwordx4 v169, s[4:7], s59 offen offset:1024 lds
    s_add_u32 m0, s29, 0x2400
    v_mfma_f32_16x16x32_bf16 v[208:211], a[224:227], a[124:127], v[208:211]
    s_waitcnt lgkmcnt(5)
    ds_read_b128 a[224:227], v240 offset:3200
    v_mfma_f32_16x16x32_bf16 v[212:215], a[228:231], a[76:79], v[212:215]
    ds_read_u16 v33, v51 offset:3482
    v_accvgpr_write_b32 a255, v171
    v_mfma_f32_16x16x32_bf16 v[216:219], a[228:231], a[100:103], v[216:219]
    s_waitcnt lgkmcnt(6)
    v_mov_b32 v248, 0
    v_cvt_pk_bf16_f32 v136, v54, v55
    v_mfma_f32_16x16x32_bf16 v[220:223], a[228:231], a[124:127], v[220:223]
    buffer_load_dwordx4 v173, s[8:11], s63 offen offset:1024 lds
    ds_read_b128 a[228:231], v240 offset:4736
    v_mfma_f32_16x16x32_bf16 v[224:227], a[232:235], a[76:79], v[224:227]
    s_waitcnt lgkmcnt(5)
    s_add_u32 m0, s46, 0xfc00
    v_cvt_pk_bf16_f32 v137, v56, v57
    v_mfma_f32_16x16x32_bf16 v[228:231], a[232:235], a[100:103], v[228:231]
    ds_read_u16 v34, v50 offset:3508
    s_waitcnt lgkmcnt(5)
    v_mfma_f32_16x16x32_bf16 v[232:235], a[232:235], a[124:127], v[232:235]
    ds_read_b128 a[232:235], v240 offset:30848
    v_accvgpr_read_b32 v254, a252
    v_mfma_f32_16x16x32_bf16 v[236:239], a[236:239], a[76:79], v[236:239]
    buffer_load_dwordx4 v170, s[4:7], s59 offen offset:2048 lds
    s_add_u32 m0, s29, 0x2400
    v_mfma_f32_16x16x32_bf16 v[138:141], a[236:239], a[100:103], v[138:141]
    ds_read_u16 v35, v51 offset:3508
    s_waitcnt lgkmcnt(5)
    v_mfma_f32_16x16x32_bf16 v[142:145], a[236:239], a[124:127], v[142:145]
    ds_read_b128 a[236:239], v240 offset:32384
    v_lshlrev_b32 v32, 16, v32
    v_mfma_f32_16x16x32_bf16 v[146:149], a[240:243], a[76:79], v[146:149]
    s_add_u32 s62, s39, 0x12000
    v_fma_f32 v32, v32, v52, v60
    v_accvgpr_read_b32 v255, a253
    v_mfma_f32_16x16x32_bf16 v[150:153], a[240:243], a[100:103], v[150:153]
    buffer_load_dwordx4 v174, s[8:11], s63 offen offset:2048 lds
    s_waitcnt vmcnt(12) lgkmcnt(4)
    v_mfma_f32_16x16x32_bf16 v[154:157], a[240:243], a[124:127], v[154:157]
    ds_read_b128 a[240:243], v240 offset:33920
    ds_read_b64_tr_b16 a[84:85], v249 offset:3072
    v_mfma_f32_16x16x32_bf16 v[158:161], a[244:247], a[76:79], v[158:161]
    ds_read_b64_tr_b16 a[86:87], v250 offset:3072
    ds_read_b64_tr_b16 a[108:109], v249 offset:3104
    v_mfma_f32_16x16x32_bf16 v[162:165], a[244:247], a[100:103], v[162:165]
    s_waitcnt lgkmcnt(6)
    ds_read_b64_tr_b16 a[110:111], v250 offset:3104
    v_mfma_f32_16x16x32_bf16 v[24:27], a[244:247], a[124:127], v[24:27]
    ds_read_b128 a[244:247], v240 offset:35456
    ds_read_b64_tr_b16 a[132:133], v249 offset:3136
    v_mfma_f32_16x16x32_bf16 v[84:87], a[216:219], a[80:83], v[84:87]
    ds_read_b64_tr_b16 a[134:135], v250 offset:3136
    v_lshlrev_b32 v33, 16, v33
    v_mfma_f32_16x16x32_bf16 v[180:183], a[216:219], a[104:107], v[180:183]
    s_waitcnt lgkmcnt(8)
    v_fma_f32 v33, v33, v53, v61
    v_lshlrev_b32 v34, 16, v34
    v_mfma_f32_16x16x32_bf16 v[184:187], a[216:219], a[128:131], v[184:187]
    ds_read_b128 a[216:219], v241 offset:128
    v_lshlrev_b32 v35, 16, v35
    v_mfma_f32_16x16x32_bf16 v[188:191], a[220:223], a[80:83], v[188:191]
    s_add_u32 m0, s29, 0
    v_fma_f32 v34, v34, v52, v60
    v_fma_f32 v35, v35, v53, v61
    v_mfma_f32_16x16x32_bf16 v[192:195], a[220:223], a[104:107], v[192:195]
    s_waitcnt lgkmcnt(8)
    v_lshlrev_b32 v252, 4, v252
    v_lshlrev_b32 v253, 4, v253
    v_mfma_f32_16x16x32_bf16 v[196:199], a[220:223], a[128:131], v[196:199]
    ds_read_b128 a[220:223], v241 offset:1664
    v_add_u32 v253, 0xfffffc00, v253
    v_mfma_f32_16x16x32_bf16 v[200:203], a[224:227], a[80:83], v[200:203]
    buffer_load_dwordx4 v172, s[8:11], s60 offen lds
    ds_read_u16 v36, v50 offset:3534
    v_mfma_f32_16x16x32_bf16 v[204:207], a[224:227], a[104:107], v[204:207]
    ds_read_u16 v37, v51 offset:3534
    s_waitcnt lgkmcnt(6)
    v_mfma_f32_16x16x32_bf16 v[208:211], a[224:227], a[128:131], v[208:211]
    ds_read_b128 a[224:227], v241 offset:3200
    ds_read_u16 v38, v50 offset:3560
    v_mfma_f32_16x16x32_bf16 v[212:215], a[228:231], a[80:83], v[212:215]
    ds_read_u16 v39, v51 offset:3560
    ds_read_u16 v40, v50 offset:3586
    v_mfma_f32_16x16x32_bf16 v[216:219], a[228:231], a[104:107], v[216:219]
    s_waitcnt lgkmcnt(7)
    ds_read_u16 v41, v51 offset:3586
    v_mfma_f32_16x16x32_bf16 v[220:223], a[228:231], a[128:131], v[220:223]
    ds_read_b128 a[228:231], v241 offset:4736
    ds_read_u16 v42, v50 offset:3612
    v_mfma_f32_16x16x32_bf16 v[224:227], a[232:235], a[80:83], v[224:227]
    ds_read_u16 v43, v51 offset:3612
    buffer_load_dwordx4 v173, s[8:11], s60 offen offset:1024 lds
    v_mfma_f32_16x16x32_bf16 v[228:231], a[232:235], a[104:107], v[228:231]
    s_waitcnt lgkmcnt(10)
    ds_read_u16 v44, v50 offset:3638
    v_mfma_f32_16x16x32_bf16 v[232:235], a[232:235], a[128:131], v[232:235]
    ds_read_b128 a[232:235], v241 offset:30848
    ds_read_u16 v45, v51 offset:3638
    v_mfma_f32_16x16x32_bf16 v[236:239], a[236:239], a[80:83], v[236:239]
    ds_read_u16 v46, v50 offset:3664
    ds_read_u16 v47, v51 offset:3664
    v_mfma_f32_16x16x32_bf16 v[138:141], a[236:239], a[104:107], v[138:141]
    s_waitcnt lgkmcnt(12)
    v_lshlrev_b32 v37, 16, v37
    v_fma_f32 v37, v37, v53, v61
    v_mfma_f32_16x16x32_bf16 v[142:145], a[236:239], a[128:131], v[142:145]
    ds_read_b128 a[236:239], v241 offset:32384
    v_lshlrev_b32 v36, 16, v36
    v_mfma_f32_16x16x32_bf16 v[146:149], a[240:243], a[80:83], v[146:149]
    ds_read_u16 v48, v50 offset:3690
    v_fma_f32 v36, v36, v52, v60
    v_mfma_f32_16x16x32_bf16 v[150:153], a[240:243], a[104:107], v[150:153]
    ds_read_u16 v49, v51 offset:3690
    s_waitcnt lgkmcnt(9)
    v_mfma_f32_16x16x32_bf16 v[154:157], a[240:243], a[128:131], v[154:157]
    ds_read_b128 a[240:243], v241 offset:33920
    buffer_load_dwordx4 v174, s[8:11], s60 offen offset:2048 lds
    v_mfma_f32_16x16x32_bf16 v[158:161], a[244:247], a[80:83], v[158:161]
    s_waitcnt vmcnt(9) lgkmcnt(9)
    ds_read_b64_tr_b16 a[88:89], v249 offset:6144
    v_mfma_f32_16x16x32_bf16 v[162:165], a[244:247], a[104:107], v[162:165]
    ds_read_b64_tr_b16 a[90:91], v250 offset:6144
    s_waitcnt lgkmcnt(8)
    v_mfma_f32_16x16x32_bf16 v[24:27], a[244:247], a[128:131], v[24:27]
    ds_read_b128 a[244:247], v241 offset:35456
    ds_read_b64_tr_b16 a[112:113], v249 offset:6176
    v_mfma_f32_16x16x32_bf16 v[84:87], a[216:219], a[84:87], v[84:87]
    ds_read_b64_tr_b16 a[114:115], v250 offset:6176
    ds_read_b64_tr_b16 a[136:137], v249 offset:6208
    v_mfma_f32_16x16x32_bf16 v[180:183], a[216:219], a[108:111], v[180:183]
    s_waitcnt lgkmcnt(9)
    ds_read_b64_tr_b16 a[138:139], v250 offset:6208
    v_mfma_f32_16x16x32_bf16 v[184:187], a[216:219], a[132:135], v[184:187]
    ds_read_b128 a[216:219], v240 offset:256
    s_add_u32 m0, s29, 0xc00
    v_mfma_f32_16x16x32_bf16 v[188:191], a[220:223], a[84:87], v[188:191]
    buffer_load_dwordx4 v172, s[8:11], s61 offen lds
    v_lshlrev_b32 v39, 16, v39
    v_mfma_f32_16x16x32_bf16 v[192:195], a[220:223], a[108:111], v[192:195]
    s_waitcnt lgkmcnt(8)
    v_lshlrev_b32 v41, 16, v41
    v_lshlrev_b32 v43, 16, v43
    v_mfma_f32_16x16x32_bf16 v[196:199], a[220:223], a[132:135], v[196:199]
    ds_read_b128 a[220:223], v240 offset:1792
    v_lshlrev_b32 v45, 16, v45
    v_mfma_f32_16x16x32_bf16 v[200:203], a[224:227], a[84:87], v[200:203]
    ds_write_b64 v62, v[30:31] offset:0
    v_mfma_f32_16x16x32_bf16 v[204:207], a[224:227], a[108:111], v[204:207]
    s_waitcnt lgkmcnt(7)
    v_add_u32 v62, s49, v62
    v_lshlrev_b32 v47, 16, v47
    v_mfma_f32_16x16x32_bf16 v[208:211], a[224:227], a[132:135], v[208:211]
    ds_read_b128 a[224:227], v240 offset:3328
    v_lshlrev_b32 v49, 16, v49
    v_mfma_f32_16x16x32_bf16 v[212:215], a[228:231], a[84:87], v[212:215]
    ds_write_b64 v62, v[32:33] offset:0
    v_mfma_f32_16x16x32_bf16 v[216:219], a[228:231], a[108:111], v[216:219]
    s_waitcnt lgkmcnt(4)
    buffer_load_dwordx4 v173, s[8:11], s61 offen offset:1024 lds
    v_mfma_f32_16x16x32_bf16 v[220:223], a[228:231], a[132:135], v[220:223]
    ds_read_b128 a[228:231], v240 offset:4864
    v_add_u32 v62, s49, v62
    v_mfma_f32_16x16x32_bf16 v[224:227], a[232:235], a[84:87], v[224:227]
    ds_write_b64 v62, v[34:35] offset:0
    v_mfma_f32_16x16x32_bf16 v[228:231], a[232:235], a[108:111], v[228:231]
    s_waitcnt lgkmcnt(5)
    v_fma_f32 v39, v39, v53, v61
    v_fma_f32 v41, v41, v53, v61
    v_mfma_f32_16x16x32_bf16 v[232:235], a[232:235], a[132:135], v[232:235]
    ds_read_b128 a[232:235], v240 offset:30976
    v_fma_f32 v43, v43, v53, v61
    v_mfma_f32_16x16x32_bf16 v[236:239], a[236:239], a[84:87], v[236:239]
    s_add_u32 s63, s39, 0x1b000
    v_fma_f32 v45, v45, v53, v61
    v_fma_f32 v47, v47, v53, v61
    v_mfma_f32_16x16x32_bf16 v[138:141], a[236:239], a[108:111], v[138:141]
    s_waitcnt lgkmcnt(4)
    v_fma_f32 v49, v49, v53, v61
    v_add_u32 v62, s49, v62
    v_mfma_f32_16x16x32_bf16 v[142:145], a[236:239], a[132:135], v[142:145]
    ds_read_b128 a[236:239], v240 offset:32512
    buffer_load_dwordx4 v174, s[8:11], s61 offen offset:2048 lds
    v_mfma_f32_16x16x32_bf16 v[146:149], a[240:243], a[84:87], v[146:149]
    s_add_u32 m0, s29, 0x1800
    v_lshlrev_b32 v38, 16, v38
    v_fma_f32 v38, v38, v52, v60
    v_mfma_f32_16x16x32_bf16 v[150:153], a[240:243], a[108:111], v[150:153]
    s_waitcnt lgkmcnt(3)
    v_lshlrev_b32 v40, 16, v40
    v_fma_f32 v40, v40, v52, v60
    v_mfma_f32_16x16x32_bf16 v[154:157], a[240:243], a[132:135], v[154:157]
    ds_read_b128 a[240:243], v240 offset:34048
    v_lshlrev_b32 v42, 16, v42
    v_mfma_f32_16x16x32_bf16 v[158:161], a[244:247], a[84:87], v[158:161]
    s_add_u32 s60, s39, 0x24000
    v_fma_f32 v42, v42, v52, v60
    v_lshlrev_b32 v44, 16, v44
    v_mfma_f32_16x16x32_bf16 v[162:165], a[244:247], a[108:111], v[162:165]
    s_waitcnt vmcnt(6)
    s_waitcnt lgkmcnt(2)
    v_fma_f32 v44, v44, v52, v60
    v_mfma_f32_16x16x32_bf16 v[24:27], a[244:247], a[132:135], v[24:27]
    ds_read_b128 a[244:247], v240 offset:35584
    ds_read_b64_tr_b16 a[92:93], v249 offset:9216
    v_mfma_f32_16x16x32_bf16 v[84:87], a[216:219], a[88:91], v[84:87]
    ds_read_b64_tr_b16 a[94:95], v250 offset:9216
    ds_read_b64_tr_b16 a[116:117], v249 offset:9248
    v_mfma_f32_16x16x32_bf16 v[180:183], a[216:219], a[112:115], v[180:183]
    s_waitcnt lgkmcnt(5)
    ds_read_b64_tr_b16 a[118:119], v250 offset:9248
    v_mfma_f32_16x16x32_bf16 v[184:187], a[216:219], a[136:139], v[184:187]
    ds_read_b128 a[216:219], v241 offset:256
    ds_read_b64_tr_b16 a[140:141], v249 offset:9280
    v_mfma_f32_16x16x32_bf16 v[188:191], a[220:223], a[88:91], v[188:191]
    ds_read_b64_tr_b16 a[142:143], v250 offset:9280
    buffer_load_dwordx4 v172, s[8:11], s62 offen lds
    v_mfma_f32_16x16x32_bf16 v[192:195], a[220:223], a[112:115], v[192:195]
    s_waitcnt lgkmcnt(8)
    v_lshlrev_b32 v46, 16, v46
    v_fma_f32 v46, v46, v52, v60
    v_mfma_f32_16x16x32_bf16 v[196:199], a[220:223], a[136:139], v[196:199]
    ds_read_b128 a[220:223], v241 offset:1792
    v_lshlrev_b32 v48, 16, v48
    v_mfma_f32_16x16x32_bf16 v[200:203], a[224:227], a[88:91], v[200:203]
    s_barrier
    v_fma_f32 v48, v48, v52, v60
    s_add_u32 s61, s39, 0x2d000
    v_mfma_f32_16x16x32_bf16 v[204:207], a[224:227], a[112:115], v[204:207]
    s_waitcnt lgkmcnt(8)
    s_add_u32 s59, s43, s45
    v_mfma_f32_16x16x32_bf16 v[208:211], a[224:227], a[136:139], v[208:211]
    ds_read_b128 a[224:227], v241 offset:3328
    v_mfma_f32_16x16x32_bf16 v[212:215], a[228:231], a[88:91], v[212:215]
    ds_write_b64 v62, v[36:37] offset:0
    v_mfma_f32_16x16x32_bf16 v[216:219], a[228:231], a[112:115], v[216:219]
    s_waitcnt lgkmcnt(5)
    buffer_load_dwordx4 v173, s[8:11], s62 offen offset:1024 lds
    v_mfma_f32_16x16x32_bf16 v[220:223], a[228:231], a[136:139], v[220:223]
    ds_read_b128 a[228:231], v241 offset:4864
    s_waitcnt lgkmcnt(4)
    v_mfma_f32_16x16x32_bf16 v[224:227], a[232:235], a[88:91], v[224:227]
    v_add_u32 v62, s49, v62
    v_mfma_f32_16x16x32_bf16 v[228:231], a[232:235], a[112:115], v[228:231]
    s_waitcnt lgkmcnt(3)
    v_mfma_f32_16x16x32_bf16 v[232:235], a[232:235], a[136:139], v[232:235]
    ds_read_b128 a[232:235], v241 offset:30976
    v_mfma_f32_16x16x32_bf16 v[236:239], a[236:239], a[88:91], v[236:239]
    ds_write_b64 v62, v[38:39] offset:0
    v_mfma_f32_16x16x32_bf16 v[138:141], a[236:239], a[112:115], v[138:141]
    s_waitcnt lgkmcnt(4)
    v_add_u32 v62, s49, v62
    v_mfma_f32_16x16x32_bf16 v[142:145], a[236:239], a[136:139], v[142:145]
    ds_read_b128 a[236:239], v241 offset:32512
    buffer_load_dwordx4 v174, s[8:11], s62 offen offset:2048 lds
    v_mfma_f32_16x16x32_bf16 v[146:149], a[240:243], a[88:91], v[146:149]
    s_add_u32 m0, s29, 0x2400
    s_lshl_b32 s62, s28, 5
    s_add_u32 s62, s62, 0
    v_mfma_f32_16x16x32_bf16 v[150:153], a[240:243], a[112:115], v[150:153]
    s_waitcnt lgkmcnt(3)
    v_mfma_f32_16x16x32_bf16 v[154:157], a[240:243], a[136:139], v[154:157]
    ds_read_b128 a[240:243], v241 offset:34048
    v_mfma_f32_16x16x32_bf16 v[158:161], a[244:247], a[88:91], v[158:161]
    ds_write_b64 v62, v[40:41] offset:0
    v_mfma_f32_16x16x32_bf16 v[162:165], a[244:247], a[112:115], v[162:165]
    s_waitcnt lgkmcnt(4)
    v_add_u32 v62, s49, v62
    v_mfma_f32_16x16x32_bf16 v[24:27], a[244:247], a[136:139], v[24:27]
    ds_read_b128 a[244:247], v241 offset:35584
    v_mfma_f32_16x16x32_bf16 v[84:87], a[216:219], a[92:95], v[84:87]
    buffer_load_dwordx4 v172, s[8:11], s63 offen lds
    v_mfma_f32_16x16x32_bf16 v[180:183], a[216:219], a[116:119], v[180:183]
    s_waitcnt lgkmcnt(3)
    v_mfma_f32_16x16x32_bf16 v[184:187], a[216:219], a[140:143], v[184:187]
    ds_read_b128 a[216:219], v240 offset:61440
    v_mfma_f32_16x16x32_bf16 v[188:191], a[220:223], a[92:95], v[188:191]
    ds_write_b64 v62, v[42:43] offset:0
    v_mfma_f32_16x16x32_bf16 v[192:195], a[220:223], a[116:119], v[192:195]
    s_waitcnt lgkmcnt(4)
    v_add_u32 v62, s49, v62
    v_cvt_pk_bf16_f32 v30, v180, v181
    v_mfma_f32_16x16x32_bf16 v[196:199], a[220:223], a[140:143], v[196:199]
    ds_read_b128 a[220:223], v241 offset:61440
    v_cvt_pk_bf16_f32 v33, v182, v183
    v_mfma_f32_16x16x32_bf16 v[200:203], a[224:227], a[92:95], v[200:203]
    ds_write_b64 v62, v[44:45] offset:0
    v_mfma_f32_16x16x32_bf16 v[204:207], a[224:227], a[116:119], v[204:207]
    s_waitcnt vmcnt(7) lgkmcnt(4)
    buffer_load_dwordx4 v173, s[8:11], s63 offen offset:1024 lds
    v_mfma_f32_16x16x32_bf16 v[208:211], a[224:227], a[140:143], v[208:211]
    ds_read_b128 a[224:227], v240 offset:61568
    ds_read_b64_tr_b16 a[144:145], v249 offset:0
    v_mfma_f32_16x16x32_bf16 v[212:215], a[228:231], a[92:95], v[212:215]
    ds_read_b64_tr_b16 a[146:147], v250 offset:0
    ds_read_b64_tr_b16 a[168:169], v249 offset:32
    v_mfma_f32_16x16x32_bf16 v[216:219], a[228:231], a[116:119], v[216:219]
    ds_read_b64_tr_b16 a[170:171], v250 offset:32
    ds_read_b64_tr_b16 a[192:193], v249 offset:64
    v_mfma_f32_16x16x32_bf16 v[220:223], a[228:231], a[140:143], v[220:223]
    ds_read_b128 a[228:231], v241 offset:61568
    ds_read_b64_tr_b16 a[194:195], v250 offset:64
    v_mfma_f32_16x16x32_bf16 v[224:227], a[232:235], a[92:95], v[224:227]
    v_add_u32 v62, s49, v62
    v_cvt_pk_bf16_f32 v66, v196, v197
    v_mfma_f32_16x16x32_bf16 v[228:231], a[232:235], a[116:119], v[228:231]
    ds_write_b64 v62, v[46:47] offset:0
    v_mfma_f32_16x16x32_bf16 v[232:235], a[232:235], a[140:143], v[232:235]
    ds_read_b128 a[232:235], v240 offset:61696
    buffer_load_dwordx4 v174, s[8:11], s63 offen offset:2048 lds
    v_mfma_f32_16x16x32_bf16 v[236:239], a[236:239], a[92:95], v[236:239]
    s_add_u32 m0, s29, 0
    v_add_u32 v62, s49, v62
    v_cvt_pk_bf16_f32 v69, v198, v199
    v_mfma_f32_16x16x32_bf16 v[138:141], a[236:239], a[116:119], v[138:141]
    s_lshl_b32 s63, s28, 5
    v_cvt_pk_bf16_f32 v31, v228, v229
    v_cvt_pk_bf16_f32 v34, v230, v231
    v_mfma_f32_16x16x32_bf16 v[142:145], a[236:239], a[140:143], v[142:145]
    ds_read_b128 a[236:239], v241 offset:61696
    s_waitcnt lgkmcnt(7)
    v_mfma_f32_16x16x32_bf16 v[146:149], a[240:243], a[92:95], v[146:149]
    s_add_u32 s63, s63, 0x4800
    v_cvt_pk_bf16_f32 v61, v232, v233
    v_cvt_pk_bf16_f32 v64, v234, v235
    v_mfma_f32_16x16x32_bf16 v[150:153], a[240:243], a[116:119], v[150:153]
    v_cvt_pk_bf16_f32 v7, v236, v237
    v_cvt_pk_bf16_f32 v10, v238, v239
    v_mfma_f32_16x16x32_bf16 v[154:157], a[240:243], a[140:143], v[154:157]
    s_waitcnt lgkmcnt(3)
    v_cvt_pk_bf16_f32 v37, v138, v139
    v_cvt_pk_bf16_f32 v40, v140, v141
    v_mfma_f32_16x16x32_bf16 v[158:161], a[244:247], a[92:95], v[158:161]
    buffer_load_dwordx4 v172, s[8:11], s60 offen lds
    v_cvt_pk_bf16_f32 v67, v142, v143
    v_mfma_f32_16x16x32_bf16 v[162:165], a[244:247], a[116:119], v[162:165]
    ds_read_b128 a[240:243], v240 offset:62976
    v_cvt_pk_bf16_f32 v70, v144, v145
    v_mfma_f32_16x16x32_bf16 v[24:27], a[244:247], a[140:143], v[24:27]
    ds_read_b128 a[244:247], v241 offset:62976
    v_cvt_pk_bf16_f32 v13, v146, v147
    v_mfma_f32_16x16x32_bf16 v[228:231], a[0:3], a[216:219], 0
    ds_write_b64 v62, v[48:49] offset:0
    v_mfma_f32_16x16x32_bf16 v[228:231], a[4:7], a[220:223], v[228:231]
    v_add_u32 v62, s49, v62
    v_cvt_pk_bf16_f32 v16, v148, v149
    v_mfma_f32_16x16x32_bf16 v[228:231], a[8:11], a[224:227], v[228:231]
    v_cvt_pk_bf16_f32 v43, v150, v151
    v_cvt_pk_bf16_f32 v46, v152, v153
    v_mfma_f32_16x16x32_bf16 v[228:231], a[12:15], a[228:231], v[228:231]
    s_waitcnt vmcnt(7) lgkmcnt(3)
    ds_read_b64_tr_b16 a[148:149], v249 offset:3072
    v_mfma_f32_16x16x32_bf16 v[228:231], a[16:19], a[232:235], v[228:231]
    buffer_load_dwordx4 v173, s[8:11], s60 offen offset:1024 lds
    ds_read_b64_tr_b16 a[150:151], v250 offset:3072
    v_mfma_f32_16x16x32_bf16 v[228:231], a[20:23], a[236:239], v[228:231]
    ds_read_b64_tr_b16 a[172:173], v249 offset:3104
    ds_read_b64_tr_b16 a[174:175], v250 offset:3104
    v_mfma_f32_16x16x32_bf16 v[232:235], a[24:27], a[216:219], 0
    ds_read_b64_tr_b16 a[196:197], v249 offset:3136
    ds_read_b64_tr_b16 a[198:199], v250 offset:3136
    v_mfma_f32_16x16x32_bf16 v[232:235], a[28:31], a[220:223], v[232:235]
    ds_read_b128 v[196:199], v244 offset:192
    v_cvt_pk_bf16_f32 v73, v154, v155
    v_mfma_f32_16x16x32_bf16 v[232:235], a[32:35], a[224:227], v[232:235]
    v_cvt_pk_bf16_f32 v138, v228, v229
    v_cvt_pk_bf16_f32 v139, v230, v231
    v_mfma_f32_16x16x32_bf16 v[232:235], a[36:39], a[228:231], v[232:235]
    v_cvt_pk_bf16_f32 v12, v200, v201
    v_cvt_pk_bf16_f32 v15, v202, v203
    v_mfma_f32_16x16x32_bf16 v[232:235], a[40:43], a[232:235], v[232:235]
    ds_read_b128 v[200:203], v245 offset:192
    buffer_load_dwordx4 v174, s[8:11], s60 offen offset:2048 lds
    v_mfma_f32_16x16x32_bf16 v[232:235], a[44:47], a[236:239], v[232:235]
    s_add_u32 m0, s29, 0xc00
    v_cvt_pk_bf16_f32 v42, v204, v205
    v_cvt_pk_bf16_f32 v45, v206, v207
    v_mfma_f32_16x16x32_bf16 v[236:239], a[48:51], a[216:219], 0
    ds_read_b128 v[204:207], v246 offset:192
    v_cvt_pk_bf16_f32 v72, v208, v209
    v_mfma_f32_16x16x32_bf16 v[236:239], a[52:55], a[220:223], v[236:239]
    s_lshl_b32 s60, s28, 5
    v_cvt_pk_bf16_f32 v140, v232, v233
    v_cvt_pk_bf16_f32 v141, v234, v235
    v_mfma_f32_16x16x32_bf16 v[236:239], a[56:59], a[224:227], v[236:239]
    s_add_u32 s60, s60, 0x1800
    v_cvt_pk_bf16_f32 v75, v210, v211
    s_waitcnt lgkmcnt(3)
    v_mfma_f32_16x16x32_bf16 v[236:239], a[60:63], a[228:231], v[236:239]
    ds_read_b128 v[208:211], v244 offset:256
    v_cvt_pk_bf16_f32 v60, v184, v185
    v_mfma_f32_16x16x32_bf16 v[236:239], a[64:67], a[232:235], v[236:239]
    v_cvt_pk_bf16_f32 v76, v156, v157
    v_cvt_pk_bf16_f32 v0, v84, v85
    v_mfma_f32_16x16x32_bf16 v[236:239], a[68:71], a[236:239], v[236:239]
    v_cvt_pk_bf16_f32 v3, v86, v87
    v_cvt_pk_bf16_f32 v1, v224, v225
    v_mfma_f32_16x16x32_bf16 v[228:231], a[216:219], a[72:75], 0
    buffer_load_dwordx4 v172, s[8:11], s61 offen lds
    v_cvt_pk_bf16_f32 v18, v212, v213
    v_mfma_f32_16x16x32_bf16 v[228:231], a[220:223], a[76:79], v[228:231]
    v_cvt_pk_bf16_f32 v21, v214, v215
    v_cvt_pk_bf16_f32 v48, v216, v217
    v_mfma_f32_16x16x32_bf16 v[228:231], a[224:227], a[80:83], v[228:231]
    v_cvt_pk_bf16_f32 v142, v236, v237
    v_cvt_pk_bf16_f32 v143, v238, v239
    v_mfma_f32_16x16x32_bf16 v[228:231], a[228:231], a[84:87], v[228:231]
    v_cvt_pk_bf16_f32 v51, v218, v219
    v_cvt_pk_bf16_f32 v63, v186, v187
    v_mfma_f32_16x16x32_bf16 v[228:231], a[232:235], a[88:91], v[228:231]
    v_cvt_pk_bf16_f32 v78, v220, v221
    v_cvt_pk_bf16_f32 v81, v222, v223
    v_mfma_f32_16x16x32_bf16 v[228:231], a[236:239], a[92:95], v[228:231]
    v_cvt_pk_bf16_f32 v4, v226, v227
    v_cvt_pk_bf16_f32 v6, v188, v189
    v_mfma_f32_16x16x32_bf16 v[232:235], a[216:219], a[96:99], 0
    v_cvt_pk_bf16_f32 v36, v192, v193
    v_cvt_pk_bf16_f32 v9, v190, v191
    v_mfma_f32_16x16x32_bf16 v[232:235], a[220:223], a[100:103], v[232:235]
    buffer_load_dwordx4 v173, s[8:11], s61 offen offset:1024 lds
    v_cvt_pk_bf16_f32 v19, v158, v159
    v_mfma_f32_16x16x32_bf16 v[232:235], a[224:227], a[104:107], v[232:235]
    v_cvt_pk_bf16_f32 v2, v228, v229
    v_cvt_pk_bf16_f32 v5, v230, v231
    v_mfma_f32_16x16x32_bf16 v[232:235], a[228:231], a[108:111], v[232:235]
    v_cvt_pk_bf16_f32 v39, v194, v195
    v_cvt_pk_bf16_f32 v22, v160, v161
    v_mfma_f32_16x16x32_bf16 v[232:235], a[232:235], a[112:115], v[232:235]
    v_mov_b32 v195, 0
    v_cvt_pk_bf16_f32 v49, v162, v163
    v_mfma_f32_16x16x32_bf16 v[232:235], a[236:239], a[116:119], v[232:235]
    v_cvt_pk_bf16_f32 v52, v164, v165
    v_cvt_pk_bf16_f32 v79, v24, v25
    v_mfma_f32_16x16x32_bf16 v[236:239], a[216:219], a[120:123], 0
    ds_read_b128 a[216:219], v240 offset:63104
    v_cvt_pk_bf16_f32 v82, v26, v27
    v_mfma_f32_16x16x32_bf16 v[236:239], a[220:223], a[124:127], v[236:239]
    ds_read_b128 a[220:223], v241 offset:63104
    v_mfma_f32_16x16x32_bf16 v[236:239], a[224:227], a[128:131], v[236:239]
    ds_read_b128 a[224:227], v240 offset:63232
    v_cvt_pk_bf16_f32 v32, v232, v233
    v_mfma_f32_16x16x32_bf16 v[236:239], a[228:231], a[132:135], v[236:239]
    ds_read_b128 a[228:231], v241 offset:63232
    v_cvt_pk_bf16_f32 v35, v234, v235
    v_mfma_f32_16x16x32_bf16 v[236:239], a[232:235], a[136:139], v[236:239]
    buffer_load_dwordx4 v174, s[8:11], s61 offen offset:2048 lds
    ds_read_b128 a[232:235], v240 offset:64512
    v_mfma_f32_16x16x32_bf16 v[236:239], a[236:239], a[140:143], v[236:239]
    ds_read_b128 a[236:239], v241 offset:64512
    s_add_u32 m0, s46, 0x1800
    v_mfma_f32_16x16x32_bf16 v[228:231], a[0:3], a[240:243], 0
    s_lshl_b32 s61, s28, 5
    s_add_u32 s61, s61, 0x6000
    v_mfma_f32_16x16x32_bf16 v[228:231], a[4:7], a[244:247], v[228:231]
    v_mfma_f32_16x16x32_bf16 v[232:235], a[24:27], a[240:243], 0
    v_mfma_f32_16x16x32_bf16 v[232:235], a[28:31], a[244:247], v[232:235]
    s_waitcnt lgkmcnt(5)
    v_cvt_pk_bf16_f32 v62, v236, v237
    v_cvt_pk_bf16_f32 v65, v238, v239
    v_mfma_f32_16x16x32_bf16 v[228:231], a[8:11], a[216:219], v[228:231]
    s_waitcnt lgkmcnt(4)
    v_mfma_f32_16x16x32_bf16 v[228:231], a[12:15], a[220:223], v[228:231]
    s_waitcnt lgkmcnt(3)
    buffer_load_dwordx4 v168, s[4:7], s58 offen lds
    v_mfma_f32_16x16x32_bf16 v[228:231], a[16:19], a[224:227], v[228:231]
    s_waitcnt lgkmcnt(2)
    v_mfma_f32_16x16x32_bf16 v[228:231], a[20:23], a[228:231], v[228:231]
    v_mfma_f32_16x16x32_bf16 v[232:235], a[32:35], a[216:219], v[232:235]
    v_mfma_f32_16x16x32_bf16 v[232:235], a[36:39], a[220:223], v[232:235]
    buffer_load_dwordx4 v171, s[4:7], s58 offen offset:512 lds
    s_add_u32 m0, s46, 0x9000
    v_mfma_f32_16x16x32_bf16 v[232:235], a[40:43], a[224:227], v[232:235]
    s_lshl1_add_u32 s58, s45, s41
    v_mfma_f32_16x16x32_bf16 v[232:235], a[44:47], a[228:231], v[232:235]
    v_mfma_f32_16x16x32_bf16 v[236:239], a[48:51], a[240:243], 0
    v_cvt_pk_bf16_f32 v144, v228, v229
    v_cvt_pk_bf16_f32 v145, v230, v231
    v_mfma_f32_16x16x32_bf16 v[236:239], a[52:55], a[244:247], v[236:239]
    buffer_load_dwordx4 v168, s[4:7], s58 offen lds
    v_mfma_f32_16x16x32_bf16 v[236:239], a[56:59], a[216:219], v[236:239]
    v_mfma_f32_16x16x32_bf16 v[236:239], a[60:63], a[220:223], v[236:239]
    v_mfma_f32_16x16x32_bf16 v[236:239], a[64:67], a[224:227], v[236:239]
    v_cvt_pk_bf16_f32 v146, v232, v233
    v_cvt_pk_bf16_f32 v147, v234, v235
    v_mfma_f32_16x16x32_bf16 v[236:239], a[68:71], a[228:231], v[236:239]
    buffer_load_dwordx4 v171, s[4:7], s58 offen offset:512 lds
    s_add_u32 m0, s46, 0x10800
    v_mfma_f32_16x16x32_bf16 v[228:231], a[240:243], a[72:75], 0
    s_lshl1_add_u32 s58, s45, s42
    v_mfma_f32_16x16x32_bf16 v[228:231], a[244:247], a[76:79], v[228:231]
    v_mfma_f32_16x16x32_bf16 v[228:231], a[216:219], a[80:83], v[228:231]
    v_mfma_f32_16x16x32_bf16 v[228:231], a[220:223], a[84:87], v[228:231]
    buffer_load_dwordx4 v168, s[4:7], s58 offen lds
    v_cvt_pk_bf16_f32 v148, v236, v237
    v_mfma_f32_16x16x32_bf16 v[228:231], a[224:227], a[88:91], v[228:231]
    v_cvt_pk_bf16_f32 v149, v238, v239
    v_mfma_f32_16x16x32_bf16 v[228:231], a[228:231], a[92:95], v[228:231]
    v_mfma_f32_16x16x32_bf16 v[232:235], a[240:243], a[96:99], 0
    v_mfma_f32_16x16x32_bf16 v[232:235], a[244:247], a[100:103], v[232:235]
    buffer_load_dwordx4 v171, s[4:7], s58 offen offset:512 lds
    s_add_u32 m0, s46, 0x16800
    v_mfma_f32_16x16x32_bf16 v[232:235], a[216:219], a[104:107], v[232:235]
    s_lshl1_add_u32 s58, s45, s43
    v_mfma_f32_16x16x32_bf16 v[232:235], a[220:223], a[108:111], v[232:235]
    v_mfma_f32_16x16x32_bf16 v[232:235], a[224:227], a[112:115], v[232:235]
    v_cvt_pk_bf16_f32 v8, v228, v229
    v_cvt_pk_bf16_f32 v11, v230, v231
    v_mfma_f32_16x16x32_bf16 v[232:235], a[228:231], a[116:119], v[232:235]
    s_waitcnt lgkmcnt(0)
    v_mfma_f32_16x16x32_bf16 v[236:239], a[240:243], a[120:123], 0
    ds_read_b128 a[240:243], v240 offset:64640
    v_mfma_f32_16x16x32_bf16 v[236:239], a[244:247], a[124:127], v[236:239]
    ds_read_b128 a[244:247], v241 offset:64640
    s_waitcnt vmcnt(15)
    v_mfma_f32_16x16x32_bf16 v[236:239], a[216:219], a[128:131], v[236:239]
    ds_read_b128 a[216:219], v240 offset:64768
    v_cvt_pk_bf16_f32 v38, v232, v233
    v_mfma_f32_16x16x32_bf16 v[236:239], a[220:223], a[132:135], v[236:239]
    ds_read_b128 a[220:223], v241 offset:64768
    v_cvt_pk_bf16_f32 v41, v234, v235
    v_mfma_f32_16x16x32_bf16 v[236:239], a[224:227], a[136:139], v[236:239]
    ds_read_b128 a[224:227], v242 offset:0
    v_add_u32 v240, 0xf000, v240
    v_mfma_f32_16x16x32_bf16 v[236:239], a[228:231], a[140:143], v[236:239]
    ds_read_b128 a[228:231], v243 offset:0
    v_add_u32 v241, 0xf000, v241
    v_mfma_f32_16x16x32_bf16 v[228:231], a[0:3], a[232:235], 0
    ds_read_b64_tr_b16 a[152:153], v249 offset:6144
    ds_read_b64_tr_b16 a[154:155], v250 offset:6144
    v_mfma_f32_16x16x32_bf16 v[228:231], a[4:7], a[236:239], v[228:231]
    ds_read_b64_tr_b16 a[176:177], v249 offset:6176
    ds_read_b64_tr_b16 a[178:179], v250 offset:6176
    v_mfma_f32_16x16x32_bf16 v[232:235], a[24:27], a[232:235], 0
    s_waitcnt lgkmcnt(9)
    v_cvt_pk_bf16_f32 v68, v236, v237
    v_cvt_pk_bf16_f32 v71, v238, v239
    v_mfma_f32_16x16x32_bf16 v[228:231], a[8:11], a[240:243], v[228:231]
    s_waitcnt lgkmcnt(8)
    ds_read_b64_tr_b16 a[200:201], v249 offset:6208
    v_mfma_f32_16x16x32_bf16 v[228:231], a[12:15], a[244:247], v[228:231]
    s_waitcnt lgkmcnt(8)
    ds_read_b64_tr_b16 a[202:203], v250 offset:6208
    v_mfma_f32_16x16x32_bf16 v[228:231], a[16:19], a[216:219], v[228:231]
    s_waitcnt lgkmcnt(8)
    v_mfma_f32_16x16x32_bf16 v[228:231], a[20:23], a[220:223], v[228:231]
    v_mfma_f32_16x16x32_bf16 v[232:235], a[28:31], a[236:239], v[232:235]
    v_mfma_f32_16x16x32_bf16 v[232:235], a[32:35], a[240:243], v[232:235]
    s_waitcnt vmcnt(12)
    ds_read_b64_tr_b16 a[156:157], v249 offset:9216
    v_mfma_f32_16x16x32_bf16 v[232:235], a[36:39], a[244:247], v[232:235]
    ds_read_b64_tr_b16 a[158:159], v250 offset:9216
    s_waitcnt vmcnt(9)
    v_mfma_f32_16x16x32_bf16 v[232:235], a[40:43], a[216:219], v[232:235]
    v_cvt_pk_bf16_f32 v150, v228, v229
    v_cvt_pk_bf16_f32 v151, v230, v231
    v_mfma_f32_16x16x32_bf16 v[232:235], a[44:47], a[220:223], v[232:235]
    ds_read_b64_tr_b16 a[160:161], v249 offset:0
    ds_read_b64_tr_b16 a[162:163], v250 offset:0
    v_mfma_f32_16x16x32_bf16 v[236:239], a[48:51], a[232:235], 0
    s_waitcnt vmcnt(6)
    ds_read_b64_tr_b16 a[164:165], v249 offset:3072
    v_mfma_f32_16x16x32_bf16 v[236:239], a[52:55], a[236:239], v[236:239]
    ds_read_b64_tr_b16 a[166:167], v250 offset:3072
    ds_read_b64_tr_b16 a[180:181], v249 offset:9248
    v_mfma_f32_16x16x32_bf16 v[236:239], a[56:59], a[240:243], v[236:239]
    v_cvt_pk_bf16_f32 v152, v232, v233
    v_cvt_pk_bf16_f32 v153, v234, v235
    v_mfma_f32_16x16x32_bf16 v[236:239], a[60:63], a[244:247], v[236:239]
    ds_read_b64_tr_b16 a[182:183], v250 offset:9248
    ds_read_b64_tr_b16 a[184:185], v249 offset:32
    v_mfma_f32_16x16x32_bf16 v[236:239], a[64:67], a[216:219], v[236:239]
    ds_read_b64_tr_b16 a[186:187], v250 offset:32
    ds_read_b64_tr_b16 a[188:189], v249 offset:3104
    v_mfma_f32_16x16x32_bf16 v[236:239], a[68:71], a[220:223], v[236:239]
    ds_read_b64_tr_b16 a[190:191], v250 offset:3104
    ds_read_b64_tr_b16 a[204:205], v249 offset:9280
    v_mfma_f32_16x16x32_bf16 v[228:231], a[232:235], a[72:75], 0
    ds_read_b64_tr_b16 a[206:207], v250 offset:9280
    ds_read_b64_tr_b16 a[208:209], v249 offset:64
    v_mfma_f32_16x16x32_bf16 v[228:231], a[236:239], a[76:79], v[228:231]
    ds_read_b64_tr_b16 a[210:211], v250 offset:64
    ds_read_b64_tr_b16 a[212:213], v249 offset:3136
    v_mfma_f32_16x16x32_bf16 v[228:231], a[240:243], a[80:83], v[228:231]
    v_cvt_pk_bf16_f32 v154, v236, v237
    v_cvt_pk_bf16_f32 v155, v238, v239
    v_mfma_f32_16x16x32_bf16 v[228:231], a[244:247], a[84:87], v[228:231]
    ds_read_b64_tr_b16 a[214:215], v250 offset:3136
    v_add_u32 v249, s66, v249
    v_mfma_f32_16x16x32_bf16 v[228:231], a[216:219], a[88:91], v[228:231]
    v_add_u32 v250, s66, v250
    s_lshl_b32 s66, s28, 1
    v_mfma_f32_16x16x32_bf16 v[228:231], a[220:223], a[92:95], v[228:231]
    v_mfma_f32_16x16x32_bf16 v[232:235], a[232:235], a[96:99], 0
    v_mfma_f32_16x16x32_bf16 v[232:235], a[236:239], a[100:103], v[232:235]
    v_mfma_f32_16x16x32_bf16 v[232:235], a[240:243], a[104:107], v[232:235]
    v_mfma_f32_16x16x32_bf16 v[232:235], a[244:247], a[108:111], v[232:235]
    v_mfma_f32_16x16x32_bf16 v[232:235], a[216:219], a[112:115], v[232:235]
    v_mfma_f32_16x16x32_bf16 v[232:235], a[220:223], a[116:119], v[232:235]
    v_mfma_f32_16x16x32_bf16 v[236:239], a[232:235], a[120:123], 0
    ds_read_b128 a[232:235], v242 offset:128
    v_cvt_pk_bf16_f32 v14, v228, v229
    v_mfma_f32_16x16x32_bf16 v[236:239], a[236:239], a[124:127], v[236:239]
    ds_read_b128 a[236:239], v243 offset:128
    v_cvt_pk_bf16_f32 v17, v230, v231
    v_mfma_f32_16x16x32_bf16 v[236:239], a[240:243], a[128:131], v[236:239]
    ds_read_b128 a[240:243], v242 offset:256
    s_waitcnt lgkmcnt(3)
    v_mfma_f32_16x16x32_bf16 v[236:239], a[244:247], a[132:135], v[236:239]
    ds_read_b128 a[244:247], v243 offset:256
    v_cvt_pk_bf16_f32 v44, v232, v233
    v_mfma_f32_16x16x32_bf16 v[236:239], a[216:219], a[136:139], v[236:239]
    ds_read_b128 a[216:219], v240 offset:4608
    v_cvt_pk_bf16_f32 v47, v234, v235
    v_mfma_f32_16x16x32_bf16 v[236:239], a[220:223], a[140:143], v[236:239]
    ds_read_b128 a[220:223], v241 offset:4608
    v_mfma_f32_16x16x32_bf16 v[228:231], a[144:147], a[224:227], 0
    v_mfma_f32_16x16x32_bf16 v[228:231], a[148:151], a[228:231], v[228:231]
    v_mfma_f32_16x16x32_bf16 v[232:235], a[168:171], a[224:227], 0
    v_mfma_f32_16x16x32_bf16 v[232:235], a[172:175], a[228:231], v[232:235]
    s_waitcnt lgkmcnt(5)
    v_mfma_f32_16x16x32_bf16 v[228:231], a[152:155], a[232:235], v[228:231]
    s_waitcnt lgkmcnt(4)
    v_cvt_pk_bf16_f32 v74, v236, v237
    v_cvt_pk_bf16_f32 v77, v238, v239
    v_mfma_f32_16x16x32_bf16 v[228:231], a[156:159], a[236:239], v[228:231]
    s_waitcnt lgkmcnt(3)
    v_mfma_f32_16x16x32_bf16 v[228:231], a[160:163], a[240:243], v[228:231]
    s_waitcnt lgkmcnt(2)
    v_mfma_f32_16x16x32_bf16 v[228:231], a[164:167], a[244:247], v[228:231]
    v_mfma_f32_16x16x32_bf16 v[232:235], a[176:179], a[232:235], v[232:235]
    v_mfma_f32_16x16x32_bf16 v[232:235], a[180:183], a[236:239], v[232:235]
    v_mfma_f32_16x16x32_bf16 v[232:235], a[184:187], a[240:243], v[232:235]
    v_mfma_f32_16x16x32_bf16 v[232:235], a[188:191], a[244:247], v[232:235]
    v_mfma_f32_16x16x32_bf16 v[236:239], a[192:195], a[224:227], 0
    ds_read_b128 a[224:227], v240 offset:4736
    v_mfma_f32_16x16x32_bf16 v[236:239], a[196:199], a[228:231], v[236:239]
    ds_read_b128 a[228:231], v241 offset:4736
    v_mul_f32 v228, s38, v228
    v_mfma_f32_16x16x32_bf16 v[236:239], a[200:203], a[232:235], v[236:239]
    v_mul_f32 v229, s38, v229
    v_mul_f32 v230, s38, v230
    v_mfma_f32_16x16x32_bf16 v[236:239], a[204:207], a[236:239], v[236:239]
    v_mul_f32 v231, s38, v231
    v_cvt_pk_bf16_f32 v168, v228, v229
    v_mfma_f32_16x16x32_bf16 v[236:239], a[208:211], a[240:243], v[236:239]
    v_cvt_pk_bf16_f32 v169, v230, v231
    s_waitcnt lgkmcnt(2)
    v_mfma_f32_16x16x32_bf16 v[236:239], a[212:215], a[244:247], v[236:239]
    v_mul_f32 v232, s3, v232
    v_mul_f32 v233, s3, v233
    v_mfma_f32_16x16x32_bf16 v[228:231], a[0:3], a[216:219], 0
    v_mul_f32 v234, s3, v234
    v_mul_f32 v235, s3, v235
    v_mfma_f32_16x16x32_bf16 v[228:231], a[4:7], a[220:223], v[228:231]
    v_cvt_pk_bf16_f32 v170, v232, v233
    v_cvt_pk_bf16_f32 v171, v234, v235
    v_mfma_f32_16x16x32_bf16 v[232:235], a[24:27], a[216:219], 0
    ds_read_b128 a[232:235], v240 offset:4864
    ds_read_b128 a[236:239], v241 offset:4864
    v_mfma_f32_16x16x32_bf16 v[196:199], v[90:93], v[168:171], v[196:199]
    s_waitcnt lgkmcnt(3)
    v_mul_f32 v236, s38, v236
    v_mul_f32 v237, s38, v237
    v_mfma_f32_16x16x32_bf16 v[200:203], v[114:117], v[168:171], v[200:203]
    v_mul_f32 v238, s38, v238
    v_mul_f32 v239, s38, v239
    v_mfma_f32_16x16x32_bf16 v[204:207], v[138:141], v[168:171], v[204:207]
    v_cvt_pk_bf16_f32 v172, v236, v237
    v_cvt_pk_bf16_f32 v173, v238, v239
    v_mfma_f32_16x16x32_bf16 v[208:211], v[96:99], v[168:171], v[208:211]
    ds_read_b128 a[240:243], v242 offset:1536
    v_add_u32 v240, 0xffff1000, v240
    v_mfma_f32_16x16x32_bf16 v[196:199], v[92:95], v[170:173], v[196:199]
    ds_read_b128 a[244:247], v243 offset:1536
    v_add_u32 v241, 0xffff1000, v241
    v_mfma_f32_16x16x32_bf16 v[200:203], v[116:119], v[170:173], v[200:203]
    v_mfma_f32_16x16x32_bf16 v[204:207], v[140:143], v[170:173], v[204:207]
    v_mfma_f32_16x16x32_bf16 v[208:211], v[98:101], v[170:173], v[208:211]
    v_mfma_f32_16x16x32_bf16 v[228:231], a[8:11], a[224:227], v[228:231]
    s_waitcnt lgkmcnt(3)
    v_mfma_f32_16x16x32_bf16 v[228:231], a[12:15], a[228:231], v[228:231]
    v_exp_f32 v196, v196
    v_mfma_f32_16x16x32_bf16 v[228:231], a[16:19], a[232:235], v[228:231]
    s_waitcnt lgkmcnt(2)
    v_exp_f32 v197, v197
    v_mfma_f32_16x16x32_bf16 v[228:231], a[20:23], a[236:239], v[228:231]
    v_exp_f32 v198, v198
    v_mfma_f32_16x16x32_bf16 v[232:235], a[28:31], a[220:223], v[232:235]
    v_exp_f32 v199, v199
    v_mfma_f32_16x16x32_bf16 v[232:235], a[32:35], a[224:227], v[232:235]
    v_cvt_pk_bf16_f32 v180, v196, v197
    v_cvt_pk_bf16_f32 v183, v198, v199
    v_mfma_f32_16x16x32_bf16 v[232:235], a[36:39], a[228:231], v[232:235]
    ds_read_b128 v[196:199], v245 offset:256
    v_cvt_pk_bf16_f32 v156, v228, v229
    v_mfma_f32_16x16x32_bf16 v[232:235], a[40:43], a[232:235], v[232:235]
    v_exp_f32 v200, v200
    v_mfma_f32_16x16x32_bf16 v[232:235], a[44:47], a[236:239], v[232:235]
    v_exp_f32 v201, v201
    v_mfma_f32_16x16x32_bf16 v[236:239], a[48:51], a[216:219], 0
    v_exp_f32 v202, v202
    v_mfma_f32_16x16x32_bf16 v[236:239], a[52:55], a[220:223], v[236:239]
    v_exp_f32 v203, v203
    v_mfma_f32_16x16x32_bf16 v[236:239], a[56:59], a[224:227], v[236:239]
    v_cvt_pk_bf16_f32 v181, v200, v201
    v_cvt_pk_bf16_f32 v184, v202, v203
    v_mfma_f32_16x16x32_bf16 v[236:239], a[60:63], a[228:231], v[236:239]
    ds_read_b128 v[200:203], v246 offset:256
    v_cvt_pk_bf16_f32 v157, v230, v231
    v_mfma_f32_16x16x32_bf16 v[236:239], a[64:67], a[232:235], v[236:239]
    v_exp_f32 v204, v204
    v_mfma_f32_16x16x32_bf16 v[236:239], a[68:71], a[236:239], v[236:239]
    v_exp_f32 v205, v205
    v_mfma_f32_16x16x32_bf16 v[228:231], a[216:219], a[72:75], 0
    s_waitcnt lgkmcnt(1)
    v_exp_f32 v206, v206
    v_mfma_f32_16x16x32_bf16 v[196:199], v[120:123], v[168:171], v[196:199]
    v_exp_f32 v207, v207
    v_mfma_f32_16x16x32_bf16 v[196:199], v[122:125], v[170:173], v[196:199]
    v_cvt_pk_bf16_f32 v182, v204, v205
    v_cvt_pk_bf16_f32 v185, v206, v207
    v_mfma_f32_16x16x32_bf16 v[228:231], a[220:223], a[76:79], v[228:231]
    ds_read_b128 v[204:207], v244 offset:320
    v_cvt_pk_bf16_f32 v158, v232, v233
    v_mfma_f32_16x16x32_bf16 v[212:215], v[0:3], v[180:183], 0
    v_exp_f32 v208, v208
    v_mfma_f32_16x16x32_bf16 v[216:219], v[30:33], v[180:183], 0
    v_exp_f32 v209, v209
    v_mfma_f32_16x16x32_bf16 v[220:223], v[60:63], v[180:183], 0
    s_waitcnt lgkmcnt(1)
    v_exp_f32 v210, v210
    v_mfma_f32_16x16x32_bf16 v[224:227], a[248:251], v[180:183], 0
    v_exp_f32 v211, v211
    v_mfma_f32_16x16x32_bf16 v[200:203], v[144:147], v[168:171], v[200:203]
    v_cvt_pk_bf16_f32 v186, v208, v209
    v_cvt_pk_bf16_f32 v189, v210, v211
    v_mfma_f32_16x16x32_bf16 v[200:203], v[146:149], v[170:173], v[200:203]
    ds_read_b128 v[208:211], v245 offset:320
    v_cvt_pk_bf16_f32 v159, v234, v235
    v_mfma_f32_16x16x32_bf16 v[228:231], a[224:227], a[80:83], v[228:231]
    v_exp_f32 v196, v196
    v_mfma_f32_16x16x32_bf16 v[228:231], a[228:231], a[84:87], v[228:231]
    s_waitcnt vmcnt(0)
    s_waitcnt lgkmcnt(1)
    v_cvt_pk_bf16_f32 v160, v236, v237
    v_mfma_f32_16x16x32_bf16 v[204:207], v[102:105], v[168:171], v[204:207]
    s_barrier
    v_exp_f32 v197, v197
    v_mfma_f32_16x16x32_bf16 v[204:207], v[104:107], v[170:173], v[204:207]
    v_cvt_pk_bf16_f32 v187, v196, v197
    v_cvt_pk_bf16_f32 v161, v238, v239
    v_mfma_f32_16x16x32_bf16 v[228:231], a[232:235], a[88:91], v[228:231]
    v_exp_f32 v198, v198
    v_mfma_f32_16x16x32_bf16 v[212:215], v[4:7], v[184:187], v[212:215]
    v_exp_f32 v199, v199
    v_mfma_f32_16x16x32_bf16 v[216:219], v[34:37], v[184:187], v[216:219]
    buffer_load_dwordx4 v254, s[4:7], s43 offen lds
    v_cvt_pk_bf16_f32 v190, v198, v199
    v_mfma_f32_16x16x32_bf16 v[220:223], v[64:67], v[184:187], v[220:223]
    ds_read_b128 v[196:199], v246 offset:320
    s_waitcnt lgkmcnt(1)
    v_mfma_f32_16x16x32_bf16 v[224:227], a[248:251], v[184:187], v[224:227]
    v_exp_f32 v200, v200
    v_mfma_f32_16x16x32_bf16 v[208:211], v[126:129], v[168:171], v[208:211]
    v_exp_f32 v201, v201
    v_mfma_f32_16x16x32_bf16 v[208:211], v[128:131], v[170:173], v[208:211]
    v_exp_f32 v202, v202
    v_mfma_f32_16x16x32_bf16 v[228:231], a[236:239], a[92:95], v[228:231]
    v_exp_f32 v203, v203
    v_mfma_f32_16x16x32_bf16 v[232:235], a[216:219], a[96:99], 0
    v_cvt_pk_bf16_f32 v188, v200, v201
    v_cvt_pk_bf16_f32 v191, v202, v203
    v_mfma_f32_16x16x32_bf16 v[232:235], a[220:223], a[100:103], v[232:235]
    v_exp_f32 v204, v204
    v_mfma_f32_16x16x32_bf16 v[212:215], v[8:11], v[188:191], v[212:215]
    v_exp_f32 v205, v205
    v_mfma_f32_16x16x32_bf16 v[216:219], v[38:41], v[188:191], v[216:219]
    v_exp_f32 v208, v208
    v_mfma_f32_16x16x32_bf16 v[220:223], v[68:71], v[188:191], v[220:223]
    s_waitcnt lgkmcnt(0)
    v_exp_f32 v209, v209
    v_mfma_f32_16x16x32_bf16 v[224:227], a[248:251], v[188:191], v[224:227]
    v_cvt_pk_bf16_f32 v192, v204, v205
    v_cvt_pk_bf16_f32 v193, v208, v209
    v_mfma_f32_16x16x32_bf16 v[196:199], v[150:153], v[168:171], v[196:199]
    v_cvt_pk_bf16_f32 v20, v228, v229
    v_cvt_pk_bf16_f32 v23, v230, v231
    v_mfma_f32_16x16x32_bf16 v[196:199], v[152:155], v[170:173], v[196:199]
    ds_read_b128 v[200:203], v244 offset:0
    ds_read_b128 v[204:207], v245 offset:0
    v_mfma_f32_16x16x32_bf16 v[232:235], a[224:227], a[104:107], v[232:235]
    ds_read_b128 v[208:211], v246 offset:0
    v_accvgpr_read_b32 v254, a254
    v_mfma_f32_16x16x32_bf16 v[232:235], a[228:231], a[108:111], v[232:235]
    buffer_load_dwordx4 v255, s[4:7], s43 offen offset:1024 lds
    v_accvgpr_read_b32 v255, a252
    v_mfma_f32_16x16x32_bf16 v[232:235], a[232:235], a[112:115], v[232:235]
    v_exp_f32 v196, v196
    v_mfma_f32_16x16x32_bf16 v[232:235], a[236:239], a[116:119], v[232:235]
    v_exp_f32 v197, v197
    v_mfma_f32_16x16x32_bf16 v[236:239], a[216:219], a[120:123], 0
    ds_read_b128 a[216:219], v242 offset:1664
    v_cvt_pk_bf16_f32 v194, v196, v197
    v_mfma_f32_16x16x32_bf16 v[236:239], a[220:223], a[124:127], v[236:239]
    ds_read_b128 a[220:223], v243 offset:1664
    ds_read_b128 v[196:199], v244 offset:64
    v_mfma_f32_16x16x32_bf16 v[212:215], v[12:15], v[192:195], v[212:215]
    v_cvt_pk_bf16_f32 v50, v232, v233
    v_cvt_pk_bf16_f32 v53, v234, v235
    v_mfma_f32_16x16x32_bf16 v[216:219], v[42:45], v[192:195], v[216:219]
    buffer_load_dwordx4 v254, s[4:7], s43 offen offset:2048 lds
    v_accvgpr_read_b32 v254, a253
    v_mfma_f32_16x16x32_bf16 v[220:223], v[72:75], v[192:195], v[220:223]
    s_add_u32 m0, s46, 0x17400
    v_mfma_f32_16x16x32_bf16 v[224:227], a[248:251], v[192:195], v[224:227]
    v_mfma_f32_16x16x32_bf16 v[236:239], a[224:227], a[128:131], v[236:239]
    ds_read_b128 a[224:227], v242 offset:1792
    v_mfma_f32_16x16x32_bf16 v[236:239], a[228:231], a[132:135], v[236:239]
    ds_read_b128 a[228:231], v243 offset:1792
    buffer_load_dwordx4 v255, s[4:7], s59 offen lds
    v_mfma_f32_16x16x32_bf16 v[236:239], a[232:235], a[136:139], v[236:239]
    ds_read_b128 a[232:235], v240 offset:6144
    v_accvgpr_read_b32 v255, a254
    v_mfma_f32_16x16x32_bf16 v[236:239], a[236:239], a[140:143], v[236:239]
    ds_read_b128 a[236:239], v241 offset:6144
    v_mfma_f32_16x16x32_bf16 v[228:231], a[144:147], a[240:243], 0
    v_rcp_f32 v225, v224
    v_mfma_f32_16x16x32_bf16 v[228:231], a[148:151], a[244:247], v[228:231]
    s_waitcnt lgkmcnt(4)
    v_mul_f32 v212, v212, v225
    v_mul_f32 v213, v213, v225
    v_mfma_f32_16x16x32_bf16 v[228:231], a[152:155], a[216:219], v[228:231]
    v_cvt_pk_bf16_f32 v80, v236, v237
    v_cvt_pk_bf16_f32 v83, v238, v239
    v_mfma_f32_16x16x32_bf16 v[228:231], a[156:159], a[220:223], v[228:231]
    v_mul_f32 v214, v214, v225
    v_mul_f32 v215, v215, v225
    v_mfma_f32_16x16x32_bf16 v[232:235], a[168:171], a[240:243], 0
    v_cvt_pk_bf16_f32 v212, v212, v213
    s_waitcnt lgkmcnt(3)
    v_mfma_f32_16x16x32_bf16 v[228:231], a[160:163], a[224:227], v[228:231]
    v_cvt_pk_bf16_f32 v213, v214, v215
    s_waitcnt lgkmcnt(2)
    v_mfma_f32_16x16x32_bf16 v[228:231], a[164:167], a[228:231], v[228:231]
    ds_write_b64 v251, v[212:213] offset:0
    v_mfma_f32_16x16x32_bf16 v[232:235], a[172:175], a[244:247], v[232:235]
    v_mul_f32 v216, v216, v225
    v_mul_f32 v217, v217, v225
    v_mfma_f32_16x16x32_bf16 v[232:235], a[176:179], a[216:219], v[232:235]
    v_mul_f32 v218, v218, v225
    v_mul_f32 v219, v219, v225
    v_mfma_f32_16x16x32_bf16 v[232:235], a[180:183], a[220:223], v[232:235]
    v_mul_f32 v228, s38, v228
    v_mul_f32 v229, s38, v229
    v_mfma_f32_16x16x32_bf16 v[232:235], a[184:187], a[224:227], v[232:235]
    v_mul_f32 v230, s38, v230
    v_mul_f32 v231, s38, v231
    v_mfma_f32_16x16x32_bf16 v[232:235], a[188:191], a[228:231], v[232:235]
    v_cvt_pk_bf16_f32 v174, v228, v229
    v_cvt_pk_bf16_f32 v175, v230, v231
    v_mfma_f32_16x16x32_bf16 v[236:239], a[192:195], a[240:243], 0
    ds_read_b128 a[240:243], v240 offset:6272
    s_waitcnt lgkmcnt(2)
    v_mfma_f32_16x16x32_bf16 v[236:239], a[196:199], a[244:247], v[236:239]
    ds_read_b128 a[244:247], v241 offset:6272
    v_cvt_pk_bf16_f32 v216, v216, v217
    v_mfma_f32_16x16x32_bf16 v[236:239], a[200:203], a[216:219], v[236:239]
    v_mul_f32 v232, s3, v232
    v_mul_f32 v233, s3, v233
    v_mfma_f32_16x16x32_bf16 v[236:239], a[204:207], a[220:223], v[236:239]
    v_mul_f32 v234, s3, v234
    v_mul_f32 v235, s3, v235
    v_mfma_f32_16x16x32_bf16 v[236:239], a[208:211], a[224:227], v[236:239]
    v_cvt_pk_bf16_f32 v176, v232, v233
    v_cvt_pk_bf16_f32 v177, v234, v235
    v_mfma_f32_16x16x32_bf16 v[236:239], a[212:215], a[228:231], v[236:239]
    ds_read_b128 a[216:219], v240 offset:6400
    ds_read_b128 a[220:223], v241 offset:6400
    v_mfma_f32_16x16x32_bf16 v[200:203], v[96:99], v[174:177], v[200:203]
    ds_read_b128 a[224:227], v240 offset:6144
    ds_read_b128 a[228:231], v241 offset:6144
    v_mfma_f32_16x16x32_bf16 v[204:207], v[120:123], v[174:177], v[204:207]
    v_cvt_pk_bf16_f32 v217, v218, v219
    v_mul_f32 v220, v220, v225
    v_mfma_f32_16x16x32_bf16 v[208:211], v[144:147], v[174:177], v[208:211]
    v_mul_f32 v236, s38, v236
    v_mul_f32 v237, s38, v237
    v_mfma_f32_16x16x32_bf16 v[196:199], v[102:105], v[174:177], v[196:199]
    v_mul_f32 v238, s38, v238
    v_mul_f32 v239, s38, v239
    v_mfma_f32_16x16x32_bf16 v[228:231], a[0:3], a[232:235], 0
    v_cvt_pk_bf16_f32 v178, v236, v237
    v_cvt_pk_bf16_f32 v179, v238, v239
    v_mfma_f32_16x16x32_bf16 v[228:231], a[4:7], a[236:239], v[228:231]
    s_waitcnt lgkmcnt(4)
    v_mul_f32 v221, v221, v225
    v_mul_f32 v222, v222, v225
    v_mfma_f32_16x16x32_bf16 v[200:203], v[98:101], v[176:179], v[200:203]
    ds_write_b64 v251, v[216:217] offset:128
    v_mfma_f32_16x16x32_bf16 v[204:207], v[122:125], v[176:179], v[204:207]
    v_mul_f32 v223, v223, v225
    v_cvt_pk_bf16_f32 v220, v220, v221
    v_mfma_f32_16x16x32_bf16 v[208:211], v[146:149], v[176:179], v[208:211]
    v_cvt_pk_bf16_f32 v221, v222, v223
    v_max3_f32 v248, v248, v224, v225
    v_mfma_f32_16x16x32_bf16 v[196:199], v[104:107], v[176:179], v[196:199]
    v_exp_f32 v200, v200
    v_mfma_f32_16x16x32_bf16 v[228:231], a[8:11], a[240:243], v[228:231]
    v_exp_f32 v201, v201
    v_mfma_f32_16x16x32_bf16 v[228:231], a[12:15], a[244:247], v[228:231]
    s_waitcnt lgkmcnt(1)
    v_exp_f32 v202, v202
    v_mfma_f32_16x16x32_bf16 v[228:231], a[16:19], a[216:219], v[228:231]
    v_exp_f32 v203, v203
    v_mfma_f32_16x16x32_bf16 v[228:231], a[20:23], a[220:223], v[228:231]
    v_cvt_pk_bf16_f32 v180, v200, v201
    v_cvt_pk_bf16_f32 v183, v202, v203
    v_mfma_f32_16x16x32_bf16 v[232:235], a[24:27], a[232:235], 0
    ds_read_b128 v[200:203], v245 offset:64
    buffer_load_dwordx4 v254, s[4:7], s59 offen offset:1024 lds
    v_mfma_f32_16x16x32_bf16 v[232:235], a[28:31], a[236:239], v[232:235]
    v_exp_f32 v204, v204
    v_mfma_f32_16x16x32_bf16 v[232:235], a[32:35], a[240:243], v[232:235]
    v_exp_f32 v205, v205
    v_mfma_f32_16x16x32_bf16 v[232:235], a[36:39], a[244:247], v[232:235]
    v_exp_f32 v206, v206
    v_mfma_f32_16x16x32_bf16 v[232:235], a[40:43], a[216:219], v[232:235]
    v_exp_f32 v207, v207
    v_mfma_f32_16x16x32_bf16 v[232:235], a[44:47], a[220:223], v[232:235]
    v_cvt_pk_bf16_f32 v181, v204, v205
    v_cvt_pk_bf16_f32 v184, v206, v207
    v_mfma_f32_16x16x32_bf16 v[236:239], a[48:51], a[232:235], 0
    ds_read_b128 a[232:235], v240 offset:6272
    ds_read_b128 v[204:207], v246 offset:64
    v_mfma_f32_16x16x32_bf16 v[236:239], a[52:55], a[236:239], v[236:239]
    ds_read_b128 a[236:239], v241 offset:6272
    v_cvt_pk_bf16_f32 v162, v228, v229
    v_mfma_f32_16x16x32_bf16 v[236:239], a[56:59], a[240:243], v[236:239]
    s_waitcnt lgkmcnt(3)
    v_cvt_pk_bf16_f32 v163, v230, v231
    v_cvt_pk_bf16_f32 v164, v232, v233
    v_mfma_f32_16x16x32_bf16 v[200:203], v[126:129], v[174:177], v[200:203]
    ds_read_b128 a[240:243], v240 offset:6400
    v_cvt_pk_bf16_f32 v165, v234, v235
    v_mfma_f32_16x16x32_bf16 v[200:203], v[128:131], v[176:179], v[200:203]
    v_exp_f32 v208, v208
    v_mfma_f32_16x16x32_bf16 v[236:239], a[60:63], a[244:247], v[236:239]
    v_exp_f32 v209, v209
    v_mfma_f32_16x16x32_bf16 v[236:239], a[64:67], a[216:219], v[236:239]
    v_exp_f32 v210, v210
    v_mfma_f32_16x16x32_bf16 v[236:239], a[68:71], a[220:223], v[236:239]
    v_exp_f32 v211, v211
    v_mfma_f32_16x16x32_bf16 v[228:231], a[224:227], a[72:75], 0
    v_cvt_pk_bf16_f32 v182, v208, v209
    v_cvt_pk_bf16_f32 v185, v210, v211
    v_mfma_f32_16x16x32_bf16 v[228:231], a[228:231], a[76:79], v[228:231]
    s_waitcnt lgkmcnt(3)
    ds_read_b128 v[208:211], v244 offset:128
    v_mfma_f32_16x16x32_bf16 v[212:215], v[6:9], v[180:183], 0
    ds_read_b128 a[244:247], v241 offset:6400
    s_waitcnt lgkmcnt(3)
    v_mfma_f32_16x16x32_bf16 v[216:219], v[36:39], v[180:183], 0
    ds_write_b64 v251, v[220:221] offset:256
    v_mfma_f32_16x16x32_bf16 v[220:223], v[66:69], v[180:183], 0
    v_exp_f32 v196, v196
    v_mfma_f32_16x16x32_bf16 v[224:227], a[248:251], v[180:183], 0
    v_exp_f32 v197, v197
    v_mfma_f32_16x16x32_bf16 v[204:207], v[150:153], v[174:177], v[204:207]
    v_exp_f32 v198, v198
    v_mfma_f32_16x16x32_bf16 v[204:207], v[152:155], v[176:179], v[204:207]
    v_exp_f32 v199, v199
    v_mfma_f32_16x16x32_bf16 v[228:231], a[232:235], a[80:83], v[228:231]
    v_cvt_pk_bf16_f32 v186, v196, v197
    v_cvt_pk_bf16_f32 v189, v198, v199
    v_mfma_f32_16x16x32_bf16 v[228:231], a[236:239], a[84:87], v[228:231]
    s_waitcnt lgkmcnt(3)
    ds_read_b128 v[196:199], v245 offset:128
    v_mfma_f32_16x16x32_bf16 v[228:231], a[240:243], a[88:91], v[228:231]
    s_waitcnt lgkmcnt(3)
    s_waitcnt lgkmcnt(2)
    v_cvt_pk_bf16_f32 v166, v236, v237
    v_mfma_f32_16x16x32_bf16 v[208:211], v[108:111], v[174:177], v[208:211]
    v_exp_f32 v200, v200
    v_mfma_f32_16x16x32_bf16 v[208:211], v[110:113], v[176:179], v[208:211]
    v_exp_f32 v201, v201
    v_mfma_f32_16x16x32_bf16 v[228:231], a[244:247], a[92:95], v[228:231]
    ds_read_b128 a[216:219], v240 offset:36864
    v_cvt_pk_bf16_f32 v187, v200, v201
    v_mfma_f32_16x16x32_bf16 v[232:235], a[224:227], a[96:99], 0
    v_exp_f32 v202, v202
    v_mfma_f32_16x16x32_bf16 v[212:215], v[10:13], v[184:187], v[212:215]
    v_exp_f32 v203, v203
    v_mfma_f32_16x16x32_bf16 v[216:219], v[40:43], v[184:187], v[216:219]
    v_cvt_pk_bf16_f32 v190, v202, v203
    v_cvt_pk_bf16_f32 v167, v238, v239
    v_mfma_f32_16x16x32_bf16 v[220:223], v[70:73], v[184:187], v[220:223]
    ds_read_b128 v[200:203], v246 offset:128
    s_waitcnt lgkmcnt(2)
    v_mfma_f32_16x16x32_bf16 v[224:227], a[248:251], v[184:187], v[224:227]
    v_exp_f32 v204, v204
    v_mfma_f32_16x16x32_bf16 v[196:199], v[132:135], v[174:177], v[196:199]
    v_exp_f32 v205, v205
    v_mfma_f32_16x16x32_bf16 v[196:199], v[134:137], v[176:179], v[196:199]
    v_exp_f32 v206, v206
    v_mfma_f32_16x16x32_bf16 v[232:235], a[228:231], a[100:103], v[232:235]
    v_exp_f32 v207, v207
    v_mfma_f32_16x16x32_bf16 v[232:235], a[232:235], a[104:107], v[232:235]
    v_cvt_pk_bf16_f32 v188, v204, v205
    v_cvt_pk_bf16_f32 v191, v206, v207
    v_mfma_f32_16x16x32_bf16 v[232:235], a[236:239], a[108:111], v[232:235]
    ds_read_b128 a[220:223], v241 offset:36864
    v_cvt_pk_bf16_f32 v24, v228, v229
    v_mfma_f32_16x16x32_bf16 v[212:215], v[14:17], v[188:191], v[212:215]
    v_exp_f32 v208, v208
    v_mfma_f32_16x16x32_bf16 v[216:219], v[44:47], v[188:191], v[216:219]
    v_exp_f32 v209, v209
    v_mfma_f32_16x16x32_bf16 v[220:223], v[74:77], v[188:191], v[220:223]
    s_waitcnt lgkmcnt(1)
    v_exp_f32 v196, v196
    v_mfma_f32_16x16x32_bf16 v[224:227], a[248:251], v[188:191], v[224:227]
    v_exp_f32 v197, v197
    v_mfma_f32_16x16x32_bf16 v[200:203], v[156:159], v[174:177], v[200:203]
    v_cvt_pk_bf16_f32 v27, v230, v231
    v_cvt_pk_bf16_f32 v192, v208, v209
    v_mfma_f32_16x16x32_bf16 v[200:203], v[158:161], v[176:179], v[200:203]
    ds_read_b128 v[204:207], v244 offset:0
    v_cvt_pk_bf16_f32 v193, v196, v197
    v_mfma_f32_16x16x32_bf16 v[232:235], a[240:243], a[112:115], v[232:235]
    ds_read_b128 v[208:211], v245 offset:0
    v_accvgpr_read_b32 v254, a252
    v_mfma_f32_16x16x32_bf16 v[232:235], a[244:247], a[116:119], v[232:235]
    ds_read_b128 v[196:199], v246 offset:0
    buffer_load_dwordx4 v255, s[4:7], s59 offen offset:2048 lds
    v_mfma_f32_16x16x32_bf16 v[236:239], a[224:227], a[120:123], 0
    ds_read_b128 a[224:227], v240 offset:36992
    v_accvgpr_read_b32 v255, a255
    v_mfma_f32_16x16x32_bf16 v[236:239], a[228:231], a[124:127], v[236:239]
    ds_read_b128 a[228:231], v241 offset:36992
    s_add_u32 m0, s46, 0x18000
    v_mfma_f32_16x16x32_bf16 v[236:239], a[232:235], a[128:131], v[236:239]
    ds_read_b128 a[232:235], v240 offset:37120
    v_cvt_pk_bf16_f32 v54, v232, v233
    v_mfma_f32_16x16x32_bf16 v[236:239], a[236:239], a[132:135], v[236:239]
    s_add_u32 s59, s44, s45
    v_exp_f32 v200, v200
    v_mfma_f32_16x16x32_bf16 v[236:239], a[240:243], a[136:139], v[236:239]
    v_exp_f32 v201, v201
    v_mfma_f32_16x16x32_bf16 v[236:239], a[244:247], a[140:143], v[236:239]
    ds_read_b128 a[236:239], v241 offset:37120
    v_cvt_pk_bf16_f32 v194, v200, v201
    v_mfma_f32_16x16x32_bf16 v[228:231], a[0:3], a[216:219], 0
    s_waitcnt lgkmcnt(6)
    v_cvt_pk_bf16_f32 v57, v234, v235
    v_add_u32 v240, 0xf000, v240
    v_mfma_f32_16x16x32_bf16 v[212:215], v[18:21], v[192:195], v[212:215]
    ds_read_b128 a[240:243], v242 offset:3072
    v_cvt_pk_bf16_f32 v84, v236, v237
    v_mfma_f32_16x16x32_bf16 v[216:219], v[48:51], v[192:195], v[216:219]
    ds_read_b128 a[244:247], v243 offset:3072
    v_cvt_pk_bf16_f32 v87, v238, v239
    v_mfma_f32_16x16x32_bf16 v[220:223], v[78:81], v[192:195], v[220:223]
    ds_read_b128 v[200:203], v244 offset:64
    v_add_u32 v241, 0xf000, v241
    v_mfma_f32_16x16x32_bf16 v[224:227], a[248:251], v[192:195], v[224:227]
    buffer_load_dwordx4 v254, s[4:7], s58 offen lds
    v_mbcnt_lo_u32_b32 v254, -1, 0
    v_mfma_f32_16x16x32_bf16 v[228:231], a[4:7], a[220:223], v[228:231]
    s_waitcnt lgkmcnt(4)
    v_mbcnt_hi_u32_b32 v254, -1, v254
    v_bfe_u32 v254, v254, 1, 1
    v_mfma_f32_16x16x32_bf16 v[228:231], a[8:11], a[224:227], v[228:231]
    v_mfma_f32_16x16x32_bf16 v[228:231], a[12:15], a[228:231], v[228:231]
    v_rcp_f32 v225, v224
    v_mfma_f32_16x16x32_bf16 v[228:231], a[16:19], a[232:235], v[228:231]
    s_waitcnt lgkmcnt(3)
    v_mul_f32 v212, v212, v225
    v_mul_f32 v213, v213, v225
    v_mfma_f32_16x16x32_bf16 v[228:231], a[20:23], a[236:239], v[228:231]
    v_mul_f32 v214, v214, v225
    v_mul_f32 v215, v215, v225
    v_mfma_f32_16x16x32_bf16 v[232:235], a[24:27], a[216:219], 0
    v_cvt_pk_bf16_f32 v212, v212, v213
    v_cvt_pk_bf16_f32 v213, v214, v215
    v_mfma_f32_16x16x32_bf16 v[232:235], a[28:31], a[220:223], v[232:235]
    ds_write_b64 v251, v[212:213] offset:6144
    v_mfma_f32_16x16x32_bf16 v[232:235], a[32:35], a[224:227], v[232:235]
    v_cvt_pk_bf16_f32 v90, v228, v229
    v_cvt_pk_bf16_f32 v91, v230, v231
    v_mfma_f32_16x16x32_bf16 v[232:235], a[36:39], a[228:231], v[232:235]
    v_mul_f32 v216, v216, v225
    v_mul_f32 v217, v217, v225
    v_mfma_f32_16x16x32_bf16 v[232:235], a[40:43], a[232:235], v[232:235]
    v_mul_f32 v218, v218, v225
    v_mul_f32 v219, v219, v225
    v_mfma_f32_16x16x32_bf16 v[232:235], a[44:47], a[236:239], v[232:235]
    v_cvt_pk_bf16_f32 v216, v216, v217
    v_cvt_pk_bf16_f32 v217, v218, v219
    v_mfma_f32_16x16x32_bf16 v[236:239], a[48:51], a[216:219], 0
    ds_write_b64 v251, v[216:217] offset:6272
    v_mfma_f32_16x16x32_bf16 v[236:239], a[52:55], a[220:223], v[236:239]
    v_mul_f32 v220, v220, v225
    v_mul_f32 v221, v221, v225
    v_mfma_f32_16x16x32_bf16 v[236:239], a[56:59], a[224:227], v[236:239]
    v_cvt_pk_bf16_f32 v92, v232, v233
    v_cvt_pk_bf16_f32 v93, v234, v235
    v_mfma_f32_16x16x32_bf16 v[236:239], a[60:63], a[228:231], v[236:239]
    v_mul_f32 v222, v222, v225
    v_mul_f32 v223, v223, v225
    v_mfma_f32_16x16x32_bf16 v[236:239], a[64:67], a[232:235], v[236:239]
    v_cvt_pk_bf16_f32 v220, v220, v221
    v_cvt_pk_bf16_f32 v221, v222, v223
    v_mfma_f32_16x16x32_bf16 v[236:239], a[68:71], a[236:239], v[236:239]
    ds_write_b64 v251, v[220:221] offset:6400
    v_mfma_f32_16x16x32_bf16 v[228:231], a[216:219], a[72:75], 0
    buffer_load_dwordx4 v255, s[4:7], s58 offen offset:512 lds
    v_max3_f32 v248, v248, v224, v225
    v_mfma_f32_16x16x32_bf16 v[228:231], a[220:223], a[76:79], v[228:231]
    s_add_u32 m0, s46, 0
    v_lshlrev_b32 v255, 4, v254
    v_xor_b32 v255, v255, v242
    v_mfma_f32_16x16x32_bf16 v[228:231], a[224:227], a[80:83], v[228:231]
    s_lshl1_add_u32 s58, s45, s44
    v_cvt_pk_bf16_f32 v94, v236, v237
    v_cvt_pk_bf16_f32 v95, v238, v239
    v_mfma_f32_16x16x32_bf16 v[228:231], a[228:231], a[84:87], v[228:231]
    v_mul_u32_u24 v254, 0x7500, v254
    v_add_u32 v254, v254, v255
    v_mfma_f32_16x16x32_bf16 v[228:231], a[232:235], a[88:91], v[228:231]
    v_xor_b32 v255, 64, v254
    v_mfma_f32_16x16x32_bf16 v[228:231], a[236:239], a[92:95], v[228:231]
    v_mfma_f32_16x16x32_bf16 v[232:235], a[216:219], a[96:99], 0
    v_mfma_f32_16x16x32_bf16 v[232:235], a[220:223], a[100:103], v[232:235]
    v_mfma_f32_16x16x32_bf16 v[232:235], a[224:227], a[104:107], v[232:235]
    v_mfma_f32_16x16x32_bf16 v[232:235], a[228:231], a[108:111], v[232:235]
    v_mfma_f32_16x16x32_bf16 v[232:235], a[232:235], a[112:115], v[232:235]
    v_mfma_f32_16x16x32_bf16 v[232:235], a[236:239], a[116:119], v[232:235]
    v_mfma_f32_16x16x32_bf16 v[236:239], a[216:219], a[120:123], 0
    ds_read_b128 a[216:219], v242 offset:3200
    v_cvt_pk_bf16_f32 v25, v228, v229
    v_mfma_f32_16x16x32_bf16 v[236:239], a[220:223], a[124:127], v[236:239]
    ds_read_b128 a[220:223], v243 offset:3200
    v_cvt_pk_bf16_f32 v28, v230, v231
    v_mfma_f32_16x16x32_bf16 v[236:239], a[224:227], a[128:131], v[236:239]
    ds_read_b128 a[224:227], v242 offset:3328
    s_waitcnt lgkmcnt(3)
    v_mfma_f32_16x16x32_bf16 v[236:239], a[228:231], a[132:135], v[236:239]
    ds_read_b128 a[228:231], v243 offset:3328
    v_cvt_pk_bf16_f32 v55, v232, v233
    v_mfma_f32_16x16x32_bf16 v[236:239], a[232:235], a[136:139], v[236:239]
    ds_read_b128 a[232:235], v240 offset:6144
    v_cvt_pk_bf16_f32 v58, v234, v235
    v_mfma_f32_16x16x32_bf16 v[236:239], a[236:239], a[140:143], v[236:239]
    ds_read_b128 a[236:239], v241 offset:6144
    v_mfma_f32_16x16x32_bf16 v[228:231], a[144:147], a[240:243], 0
    v_mfma_f32_16x16x32_bf16 v[228:231], a[148:151], a[244:247], v[228:231]
    v_mfma_f32_16x16x32_bf16 v[232:235], a[168:171], a[240:243], 0
    v_mfma_f32_16x16x32_bf16 v[232:235], a[172:175], a[244:247], v[232:235]
    s_waitcnt lgkmcnt(5)
    v_mfma_f32_16x16x32_bf16 v[228:231], a[152:155], a[216:219], v[228:231]
    s_waitcnt lgkmcnt(4)
    v_cvt_pk_bf16_f32 v85, v236, v237
    v_cvt_pk_bf16_f32 v88, v238, v239
    v_mfma_f32_16x16x32_bf16 v[228:231], a[156:159], a[220:223], v[228:231]
    s_waitcnt lgkmcnt(3)
    v_mfma_f32_16x16x32_bf16 v[228:231], a[160:163], a[224:227], v[228:231]
    s_waitcnt lgkmcnt(2)
    v_mfma_f32_16x16x32_bf16 v[228:231], a[164:167], a[228:231], v[228:231]
    v_mfma_f32_16x16x32_bf16 v[232:235], a[176:179], a[216:219], v[232:235]
    v_mfma_f32_16x16x32_bf16 v[232:235], a[180:183], a[220:223], v[232:235]
    v_mfma_f32_16x16x32_bf16 v[232:235], a[184:187], a[224:227], v[232:235]
    v_mfma_f32_16x16x32_bf16 v[232:235], a[188:191], a[228:231], v[232:235]
    v_mfma_f32_16x16x32_bf16 v[236:239], a[192:195], a[240:243], 0
    ds_read_b128 a[240:243], v240 offset:6272
    v_mfma_f32_16x16x32_bf16 v[236:239], a[196:199], a[244:247], v[236:239]
    ds_read_b128 a[244:247], v241 offset:6272
    v_mul_f32 v228, s38, v228
    v_mfma_f32_16x16x32_bf16 v[236:239], a[200:203], a[216:219], v[236:239]
    v_mul_f32 v229, s38, v229
    v_mul_f32 v230, s38, v230
    v_mfma_f32_16x16x32_bf16 v[236:239], a[204:207], a[220:223], v[236:239]
    v_mul_f32 v231, s38, v231
    v_cvt_pk_bf16_f32 v168, v228, v229
    v_mfma_f32_16x16x32_bf16 v[236:239], a[208:211], a[224:227], v[236:239]
    v_cvt_pk_bf16_f32 v169, v230, v231
    s_waitcnt lgkmcnt(2)
    v_mfma_f32_16x16x32_bf16 v[236:239], a[212:215], a[228:231], v[236:239]
    v_mul_f32 v232, s3, v232
    v_mul_f32 v233, s3, v233
    v_mfma_f32_16x16x32_bf16 v[228:231], a[0:3], a[232:235], 0
    v_mul_f32 v234, s3, v234
    v_mul_f32 v235, s3, v235
    v_mfma_f32_16x16x32_bf16 v[228:231], a[4:7], a[236:239], v[228:231]
    v_cvt_pk_bf16_f32 v170, v232, v233
    v_cvt_pk_bf16_f32 v171, v234, v235
    v_mfma_f32_16x16x32_bf16 v[232:235], a[24:27], a[232:235], 0
    ds_read_b128 a[216:219], v240 offset:6400
    ds_read_b128 a[220:223], v241 offset:6400
    v_mfma_f32_16x16x32_bf16 v[204:207], v[102:105], v[168:171], v[204:207]
    s_waitcnt lgkmcnt(3)
    v_mul_f32 v236, s38, v236
    v_mul_f32 v237, s38, v237
    v_mfma_f32_16x16x32_bf16 v[208:211], v[126:129], v[168:171], v[208:211]
    v_mul_f32 v238, s38, v238
    v_mul_f32 v239, s38, v239
    v_mfma_f32_16x16x32_bf16 v[196:199], v[150:153], v[168:171], v[196:199]
    v_cvt_pk_bf16_f32 v172, v236, v237
    v_cvt_pk_bf16_f32 v173, v238, v239
    v_mfma_f32_16x16x32_bf16 v[200:203], v[108:111], v[168:171], v[200:203]
    ds_read_b128 a[224:227], v254 offset:4608
    ds_read_b128 a[228:231], v255 offset:4608
    v_mfma_f32_16x16x32_bf16 v[204:207], v[104:107], v[170:173], v[204:207]
    v_mfma_f32_16x16x32_bf16 v[208:211], v[128:131], v[170:173], v[208:211]
    v_mfma_f32_16x16x32_bf16 v[196:199], v[152:155], v[170:173], v[196:199]
    v_mfma_f32_16x16x32_bf16 v[200:203], v[110:113], v[170:173], v[200:203]
    v_mfma_f32_16x16x32_bf16 v[228:231], a[8:11], a[240:243], v[228:231]
    s_waitcnt lgkmcnt(2)
    v_mfma_f32_16x16x32_bf16 v[228:231], a[12:15], a[244:247], v[228:231]
    v_mfma_f32_16x16x32_bf16 v[228:231], a[16:19], a[216:219], v[228:231]
    v_mfma_f32_16x16x32_bf16 v[228:231], a[20:23], a[220:223], v[228:231]
    v_exp_f32 v204, v204
    v_mfma_f32_16x16x32_bf16 v[232:235], a[28:31], a[236:239], v[232:235]
    v_exp_f32 v205, v205
    v_mfma_f32_16x16x32_bf16 v[232:235], a[32:35], a[240:243], v[232:235]
    v_exp_f32 v206, v206
    v_mfma_f32_16x16x32_bf16 v[232:235], a[36:39], a[244:247], v[232:235]
    v_exp_f32 v207, v207
    v_mfma_f32_16x16x32_bf16 v[232:235], a[40:43], a[216:219], v[232:235]
    v_cvt_pk_bf16_f32 v180, v204, v205
    v_cvt_pk_bf16_f32 v183, v206, v207
    v_mfma_f32_16x16x32_bf16 v[232:235], a[44:47], a[220:223], v[232:235]
    ds_read_b128 v[204:207], v245 offset:64
    v_cvt_pk_bf16_f32 v96, v228, v229
    v_mfma_f32_16x16x32_bf16 v[236:239], a[48:51], a[232:235], 0
    v_exp_f32 v208, v208
    v_mfma_f32_16x16x32_bf16 v[236:239], a[52:55], a[236:239], v[236:239]
    v_exp_f32 v209, v209
    v_mfma_f32_16x16x32_bf16 v[236:239], a[56:59], a[240:243], v[236:239]
    v_exp_f32 v210, v210
    v_mfma_f32_16x16x32_bf16 v[236:239], a[60:63], a[244:247], v[236:239]
    v_exp_f32 v211, v211
    v_mfma_f32_16x16x32_bf16 v[236:239], a[64:67], a[216:219], v[236:239]
    v_cvt_pk_bf16_f32 v181, v208, v209
    v_cvt_pk_bf16_f32 v184, v210, v211
    v_mfma_f32_16x16x32_bf16 v[236:239], a[68:71], a[220:223], v[236:239]
    ds_read_b128 v[208:211], v246 offset:64
    v_cvt_pk_bf16_f32 v97, v230, v231
    v_mfma_f32_16x16x32_bf16 v[228:231], a[232:235], a[72:75], 0
    v_exp_f32 v196, v196
    v_mfma_f32_16x16x32_bf16 v[228:231], a[236:239], a[76:79], v[228:231]
    v_exp_f32 v197, v197
    v_mfma_f32_16x16x32_bf16 v[228:231], a[240:243], a[80:83], v[228:231]
    s_waitcnt lgkmcnt(1)
    v_cvt_pk_bf16_f32 v182, v196, v197
    v_cvt_pk_bf16_f32 v98, v232, v233
    v_mfma_f32_16x16x32_bf16 v[204:207], v[132:135], v[168:171], v[204:207]
    v_exp_f32 v198, v198
    v_mfma_f32_16x16x32_bf16 v[212:215], v[12:15], v[180:183], 0
    v_exp_f32 v199, v199
    v_mfma_f32_16x16x32_bf16 v[216:219], v[42:45], v[180:183], 0
    v_cvt_pk_bf16_f32 v185, v198, v199
    v_cvt_pk_bf16_f32 v99, v234, v235
    v_mfma_f32_16x16x32_bf16 v[220:223], v[72:75], v[180:183], 0
    ds_read_b128 v[196:199], v244 offset:128
    v_cvt_pk_bf16_f32 v100, v236, v237
    v_mfma_f32_16x16x32_bf16 v[224:227], a[248:251], v[180:183], 0
    v_exp_f32 v200, v200
    v_mfma_f32_16x16x32_bf16 v[204:207], v[134:137], v[170:173], v[204:207]
    s_waitcnt lgkmcnt(1)
    v_exp_f32 v201, v201
    v_mfma_f32_16x16x32_bf16 v[208:211], v[156:159], v[168:171], v[208:211]
    v_exp_f32 v202, v202
    v_mfma_f32_16x16x32_bf16 v[208:211], v[158:161], v[170:173], v[208:211]
    v_exp_f32 v203, v203
    v_mfma_f32_16x16x32_bf16 v[228:231], a[244:247], a[84:87], v[228:231]
    v_cvt_pk_bf16_f32 v186, v200, v201
    v_cvt_pk_bf16_f32 v189, v202, v203
    v_mfma_f32_16x16x32_bf16 v[228:231], a[216:219], a[88:91], v[228:231]
    v_exp_f32 v204, v204
    v_mfma_f32_16x16x32_bf16 v[228:231], a[220:223], a[92:95], v[228:231]
    v_exp_f32 v205, v205
    v_mfma_f32_16x16x32_bf16 v[232:235], a[232:235], a[96:99], 0
    ds_read_b128 v[200:203], v245 offset:128
    v_cvt_pk_bf16_f32 v187, v204, v205
    v_mfma_f32_16x16x32_bf16 v[232:235], a[236:239], a[100:103], v[232:235]
    s_waitcnt lgkmcnt(1)
    v_exp_f32 v206, v206
    v_mfma_f32_16x16x32_bf16 v[212:215], v[16:19], v[184:187], v[212:215]
    v_exp_f32 v207, v207
    v_mfma_f32_16x16x32_bf16 v[216:219], v[46:49], v[184:187], v[216:219]
    v_cvt_pk_bf16_f32 v190, v206, v207
    v_cvt_pk_bf16_f32 v101, v238, v239
    v_mfma_f32_16x16x32_bf16 v[220:223], v[76:79], v[184:187], v[220:223]
    ds_read_b128 v[204:207], v246 offset:128
    v_cvt_pk_bf16_f32 v26, v228, v229
    v_mfma_f32_16x16x32_bf16 v[224:227], a[248:251], v[184:187], v[224:227]
    v_exp_f32 v208, v208
    v_mfma_f32_16x16x32_bf16 v[196:199], v[162:165], v[168:171], v[196:199]
    v_exp_f32 v209, v209
    v_mfma_f32_16x16x32_bf16 v[196:199], v[164:167], v[170:173], v[196:199]
    v_exp_f32 v210, v210
    v_mfma_f32_16x16x32_bf16 v[232:235], a[240:243], a[104:107], v[232:235]
    v_exp_f32 v211, v211
    v_mfma_f32_16x16x32_bf16 v[232:235], a[244:247], a[108:111], v[232:235]
    s_waitcnt lgkmcnt(1)
    v_cvt_pk_bf16_f32 v188, v208, v209
    v_cvt_pk_bf16_f32 v191, v210, v211
    v_mfma_f32_16x16x32_bf16 v[200:203], v[90:93], v[168:171], v[200:203]
    ds_read_b128 v[208:211], v244 offset:0
    v_cvt_pk_bf16_f32 v29, v230, v231
    v_mfma_f32_16x16x32_bf16 v[212:215], v[20:23], v[188:191], v[212:215]
    v_exp_f32 v196, v196
    v_mfma_f32_16x16x32_bf16 v[216:219], v[50:53], v[188:191], v[216:219]
    v_exp_f32 v197, v197
    v_mfma_f32_16x16x32_bf16 v[220:223], v[80:83], v[188:191], v[220:223]
    s_waitcnt lgkmcnt(1)
    v_cvt_pk_bf16_f32 v192, v196, v197
    v_mfma_f32_16x16x32_bf16 v[224:227], a[248:251], v[188:191], v[224:227]
    ds_read_b128 v[196:199], v245 offset:0
    v_mfma_f32_16x16x32_bf16 v[200:203], v[92:95], v[170:173], v[200:203]
    v_mfma_f32_16x16x32_bf16 v[204:207], v[96:99], v[168:171], v[204:207]
    v_mfma_f32_16x16x32_bf16 v[204:207], v[98:101], v[170:173], v[204:207]
    v_mfma_f32_16x16x32_bf16 v[232:235], a[216:219], a[112:115], v[232:235]
    v_mfma_f32_16x16x32_bf16 v[232:235], a[220:223], a[116:119], v[232:235]
    v_mfma_f32_16x16x32_bf16 v[236:239], a[232:235], a[120:123], 0
    ds_read_b128 a[232:235], v254 offset:4736
    v_mfma_f32_16x16x32_bf16 v[236:239], a[236:239], a[124:127], v[236:239]
    ds_read_b128 a[236:239], v255 offset:4736
    v_mfma_f32_16x16x32_bf16 v[236:239], a[240:243], a[128:131], v[236:239]
    ds_read_b128 a[240:243], v254 offset:4864
    v_accvgpr_read_b32 v254, a252
    v_mfma_f32_16x16x32_bf16 v[236:239], a[244:247], a[132:135], v[236:239]
    ds_read_b128 a[244:247], v255 offset:4864
    v_cvt_pk_bf16_f32 v56, v232, v233
    v_mfma_f32_16x16x32_bf16 v[236:239], a[216:219], a[136:139], v[236:239]
    buffer_load_dwordx4 v254, s[4:7], s44 offen lds
    v_cvt_pk_bf16_f32 v59, v234, v235
    v_mfma_f32_16x16x32_bf16 v[236:239], a[220:223], a[140:143], v[236:239]
    v_exp_f32 v200, v200
    v_mfma_f32_16x16x32_bf16 v[228:231], a[144:147], a[224:227], 0
    v_exp_f32 v201, v201
    v_mfma_f32_16x16x32_bf16 v[228:231], a[148:151], a[228:231], v[228:231]
    v_exp_f32 v204, v204
    v_mfma_f32_16x16x32_bf16 v[232:235], a[168:171], a[224:227], 0
    v_exp_f32 v205, v205
    v_mfma_f32_16x16x32_bf16 v[232:235], a[172:175], a[228:231], v[232:235]
    s_waitcnt lgkmcnt(3)
    v_cvt_pk_bf16_f32 v193, v200, v201
    v_cvt_pk_bf16_f32 v194, v204, v205
    v_mfma_f32_16x16x32_bf16 v[228:231], a[152:155], a[232:235], v[228:231]
    s_waitcnt lgkmcnt(2)
    v_cvt_pk_bf16_f32 v86, v236, v237
    v_cvt_pk_bf16_f32 v89, v238, v239
    v_mfma_f32_16x16x32_bf16 v[212:215], v[24:27], v[192:195], v[212:215]
    ds_read_b128 v[200:203], v246 offset:0
    ds_read_b128 v[204:207], v244 offset:64
    v_mfma_f32_16x16x32_bf16 v[216:219], v[54:57], v[192:195], v[216:219]
    s_waitcnt vmcnt(6) lgkmcnt(2)
    s_barrier
    v_accvgpr_read_b32 v255, a253
    v_mfma_f32_16x16x32_bf16 v[220:223], v[84:87], v[192:195], v[220:223]
    ds_read_b128 a[216:219], v240 offset:30720
    ds_read_b128 a[220:223], v241 offset:30720
    v_mfma_f32_16x16x32_bf16 v[224:227], a[248:251], v[192:195], v[224:227]
    buffer_load_dwordx4 v255, s[4:7], s44 offen offset:1024 lds
    v_accvgpr_read_b32 v254, a254
    v_mfma_f32_16x16x32_bf16 v[228:231], a[156:159], a[236:239], v[228:231]
    v_accvgpr_read_b32 v255, a252
    v_mfma_f32_16x16x32_bf16 v[228:231], a[160:163], a[240:243], v[228:231]
    v_mfma_f32_16x16x32_bf16 v[228:231], a[164:167], a[244:247], v[228:231]
    v_mfma_f32_16x16x32_bf16 v[232:235], a[176:179], a[232:235], v[232:235]
    buffer_load_dwordx4 v254, s[4:7], s44 offen offset:2048 lds
    v_accvgpr_read_b32 v254, a253
    v_mfma_f32_16x16x32_bf16 v[232:235], a[180:183], a[236:239], v[232:235]
    s_add_u32 m0, s46, 0xc00
    v_rcp_f32 v225, v224
    v_mfma_f32_16x16x32_bf16 v[232:235], a[184:187], a[240:243], v[232:235]
    v_mul_f32 v212, v212, v225
    v_mul_f32 v228, s38, v228
    v_mfma_f32_16x16x32_bf16 v[232:235], a[188:191], a[244:247], v[232:235]
    v_mul_f32 v229, s38, v229
    v_mul_f32 v230, s38, v230
    v_mfma_f32_16x16x32_bf16 v[236:239], a[192:195], a[224:227], 0
    v_mul_f32 v231, s38, v231
    v_cvt_pk_bf16_f32 v174, v228, v229
    v_mfma_f32_16x16x32_bf16 v[236:239], a[196:199], a[228:231], v[236:239]
    ds_read_b128 a[224:227], v240 offset:30848
    v_cvt_pk_bf16_f32 v175, v230, v231
    v_mfma_f32_16x16x32_bf16 v[236:239], a[200:203], a[232:235], v[236:239]
    s_waitcnt lgkmcnt(1)
    v_mul_f32 v232, s3, v232
    v_mul_f32 v233, s3, v233
    v_mfma_f32_16x16x32_bf16 v[236:239], a[204:207], a[236:239], v[236:239]
    v_mul_f32 v234, s3, v234
    v_mul_f32 v235, s3, v235
    v_mfma_f32_16x16x32_bf16 v[236:239], a[208:211], a[240:243], v[236:239]
    v_cvt_pk_bf16_f32 v176, v232, v233
    v_cvt_pk_bf16_f32 v177, v234, v235
    v_mfma_f32_16x16x32_bf16 v[236:239], a[212:215], a[244:247], v[236:239]
    ds_read_b128 a[228:231], v241 offset:30848
    ds_read_b128 a[232:235], v240 offset:30976
    v_mfma_f32_16x16x32_bf16 v[208:211], v[108:111], v[174:177], v[208:211]
    ds_read_b128 a[236:239], v241 offset:30976
    v_mul_f32 v213, v213, v225
    v_mfma_f32_16x16x32_bf16 v[196:199], v[132:135], v[174:177], v[196:199]
    v_mul_f32 v214, v214, v225
    v_mul_f32 v215, v215, v225
    v_mfma_f32_16x16x32_bf16 v[200:203], v[156:159], v[174:177], v[200:203]
    v_mul_f32 v236, s38, v236
    v_mul_f32 v237, s38, v237
    v_mfma_f32_16x16x32_bf16 v[204:207], v[162:165], v[174:177], v[204:207]
    v_mul_f32 v238, s38, v238
    v_mul_f32 v239, s38, v239
    v_mfma_f32_16x16x32_bf16 v[228:231], a[0:3], a[216:219], 0
    v_cvt_pk_bf16_f32 v178, v236, v237
    v_cvt_pk_bf16_f32 v179, v238, v239
    v_mfma_f32_16x16x32_bf16 v[228:231], a[4:7], a[220:223], v[228:231]
    s_waitcnt lgkmcnt(3)
    v_cvt_pk_bf16_f32 v212, v212, v213
    v_cvt_pk_bf16_f32 v213, v214, v215
    v_mfma_f32_16x16x32_bf16 v[208:211], v[110:113], v[176:179], v[208:211]
    ds_write_b64 v251, v[212:213] offset:12288
    v_mfma_f32_16x16x32_bf16 v[196:199], v[134:137], v[176:179], v[196:199]
    v_mul_f32 v216, v216, v225
    v_mul_f32 v217, v217, v225
    v_mfma_f32_16x16x32_bf16 v[200:203], v[158:161], v[176:179], v[200:203]
    v_mul_f32 v218, v218, v225
    v_mul_f32 v219, v219, v225
    v_mfma_f32_16x16x32_bf16 v[204:207], v[164:167], v[176:179], v[204:207]
    v_exp_f32 v208, v208
    v_mfma_f32_16x16x32_bf16 v[228:231], a[8:11], a[224:227], v[228:231]
    s_waitcnt lgkmcnt(1)
    v_exp_f32 v209, v209
    v_mfma_f32_16x16x32_bf16 v[228:231], a[12:15], a[228:231], v[228:231]
    v_exp_f32 v210, v210
    v_mfma_f32_16x16x32_bf16 v[228:231], a[16:19], a[232:235], v[228:231]
    v_exp_f32 v211, v211
    v_mfma_f32_16x16x32_bf16 v[228:231], a[20:23], a[236:239], v[228:231]
    v_cvt_pk_bf16_f32 v180, v208, v209
    v_cvt_pk_bf16_f32 v183, v210, v211
    v_mfma_f32_16x16x32_bf16 v[232:235], a[24:27], a[216:219], 0
    ds_read_b128 v[208:211], v245 offset:64
    v_cvt_pk_bf16_f32 v216, v216, v217
    v_mfma_f32_16x16x32_bf16 v[232:235], a[28:31], a[220:223], v[232:235]
    v_exp_f32 v196, v196
    v_mfma_f32_16x16x32_bf16 v[232:235], a[32:35], a[224:227], v[232:235]
    v_exp_f32 v197, v197
    v_mfma_f32_16x16x32_bf16 v[232:235], a[36:39], a[228:231], v[232:235]
    v_exp_f32 v198, v198
    v_mfma_f32_16x16x32_bf16 v[232:235], a[40:43], a[232:235], v[232:235]
    v_exp_f32 v199, v199
    v_mfma_f32_16x16x32_bf16 v[232:235], a[44:47], a[236:239], v[232:235]
    v_cvt_pk_bf16_f32 v181, v196, v197
    v_cvt_pk_bf16_f32 v184, v198, v199
    v_mfma_f32_16x16x32_bf16 v[236:239], a[48:51], a[216:219], 0
    ds_read_b128 v[196:199], v246 offset:64
    v_cvt_pk_bf16_f32 v217, v218, v219
    v_mfma_f32_16x16x32_bf16 v[236:239], a[52:55], a[220:223], v[236:239]
    v_exp_f32 v200, v200
    v_mfma_f32_16x16x32_bf16 v[236:239], a[56:59], a[224:227], v[236:239]
    v_exp_f32 v201, v201
    v_mfma_f32_16x16x32_bf16 v[236:239], a[60:63], a[228:231], v[236:239]
    s_waitcnt lgkmcnt(1)
    v_cvt_pk_bf16_f32 v182, v200, v201
    v_max3_f32 v248, v248, v224, v225
    v_mfma_f32_16x16x32_bf16 v[208:211], v[90:93], v[174:177], v[208:211]
    ds_write_b64 v251, v[216:217] offset:12416
    v_mfma_f32_16x16x32_bf16 v[212:215], v[18:21], v[180:183], 0
    v_mul_f32 v220, v220, v225
    v_mul_f32 v221, v221, v225
    v_mfma_f32_16x16x32_bf16 v[216:219], v[48:51], v[180:183], 0
    v_mul_f32 v222, v222, v225
    v_mul_f32 v223, v223, v225
    v_mfma_f32_16x16x32_bf16 v[224:227], a[248:251], v[180:183], 0
    v_cvt_pk_bf16_f32 v220, v220, v221
    v_cvt_pk_bf16_f32 v221, v222, v223
    v_mfma_f32_16x16x32_bf16 v[208:211], v[92:95], v[176:179], v[208:211]
    s_waitcnt lgkmcnt(1)
    v_cvt_pk_bf16_f32 v102, v228, v229
    v_cvt_pk_bf16_f32 v103, v230, v231
    v_mfma_f32_16x16x32_bf16 v[196:199], v[96:99], v[174:177], v[196:199]
    ds_write_b64 v251, v[220:221] offset:12544
    v_mfma_f32_16x16x32_bf16 v[220:223], v[78:81], v[180:183], 0
    v_exp_f32 v202, v202
    v_mfma_f32_16x16x32_bf16 v[196:199], v[98:101], v[176:179], v[196:199]
    v_exp_f32 v203, v203
    v_mfma_f32_16x16x32_bf16 v[236:239], a[64:67], a[232:235], v[236:239]
    v_exp_f32 v204, v204
    v_mfma_f32_16x16x32_bf16 v[236:239], a[68:71], a[236:239], v[236:239]
    v_exp_f32 v205, v205
    v_mfma_f32_16x16x32_bf16 v[228:231], a[216:219], a[72:75], 0
    v_exp_f32 v208, v208
    v_mfma_f32_16x16x32_bf16 v[228:231], a[220:223], a[76:79], v[228:231]
    v_exp_f32 v209, v209
    v_mfma_f32_16x16x32_bf16 v[228:231], a[224:227], a[80:83], v[228:231]
    v_cvt_pk_bf16_f32 v185, v202, v203
    v_cvt_pk_bf16_f32 v186, v204, v205
    v_mfma_f32_16x16x32_bf16 v[228:231], a[228:231], a[84:87], v[228:231]
    v_cvt_pk_bf16_f32 v187, v208, v209
    v_cvt_pk_bf16_f32 v104, v232, v233
    v_mfma_f32_16x16x32_bf16 v[228:231], a[232:235], a[88:91], v[228:231]
    v_cvt_pk_bf16_f32 v105, v234, v235
    v_cvt_pk_bf16_f32 v106, v236, v237
    v_mfma_f32_16x16x32_bf16 v[212:215], v[22:25], v[184:187], v[212:215]
    ds_read_b128 a[240:243], v242 offset:30720
    v_cvt_pk_bf16_f32 v107, v238, v239
    v_mfma_f32_16x16x32_bf16 v[216:219], v[52:55], v[184:187], v[216:219]
    ds_read_b128 a[244:247], v243 offset:30720
    v_mbcnt_lo_u32_b32 v204, -1, 0
    v_mfma_f32_16x16x32_bf16 v[220:223], v[82:85], v[184:187], v[220:223]
    v_exp_f32 v206, v206
    v_mfma_f32_16x16x32_bf16 v[224:227], a[248:251], v[184:187], v[224:227]
    v_exp_f32 v207, v207
    v_mfma_f32_16x16x32_bf16 v[228:231], a[236:239], a[92:95], v[228:231]
    v_exp_f32 v210, v210
    v_mfma_f32_16x16x32_bf16 v[232:235], a[216:219], a[96:99], 0
    v_exp_f32 v211, v211
    v_mfma_f32_16x16x32_bf16 v[232:235], a[220:223], a[100:103], v[232:235]
    v_exp_f32 v196, v196
    v_mfma_f32_16x16x32_bf16 v[232:235], a[224:227], a[104:107], v[232:235]
    v_exp_f32 v197, v197
    v_mfma_f32_16x16x32_bf16 v[232:235], a[228:231], a[108:111], v[232:235]
    v_exp_f32 v198, v198
    v_mfma_f32_16x16x32_bf16 v[232:235], a[232:235], a[112:115], v[232:235]
    v_exp_f32 v199, v199
    v_mfma_f32_16x16x32_bf16 v[232:235], a[236:239], a[116:119], v[232:235]
    v_cvt_pk_bf16_f32 v189, v206, v207
    v_cvt_pk_bf16_f32 v190, v210, v211
    v_mfma_f32_16x16x32_bf16 v[236:239], a[216:219], a[120:123], 0
    ds_read_b128 a[216:219], v242 offset:30848
    v_cvt_pk_bf16_f32 v188, v196, v197
    v_mfma_f32_16x16x32_bf16 v[236:239], a[220:223], a[124:127], v[236:239]
    ds_read_b128 a[220:223], v243 offset:30848
    v_cvt_pk_bf16_f32 v191, v198, v199
    v_mfma_f32_16x16x32_bf16 v[236:239], a[224:227], a[128:131], v[236:239]
    ds_read_b128 a[224:227], v242 offset:30976
    v_cvt_pk_bf16_f32 v0, v228, v229
    v_mfma_f32_16x16x32_bf16 v[212:215], v[26:29], v[188:191], v[212:215]
    v_cvt_pk_bf16_f32 v3, v230, v231
    s_waitcnt lgkmcnt(3)
    v_mfma_f32_16x16x32_bf16 v[216:219], v[56:59], v[188:191], v[216:219]
    v_cvt_pk_bf16_f32 v30, v232, v233
    v_cvt_pk_bf16_f32 v33, v234, v235
    v_mfma_f32_16x16x32_bf16 v[220:223], v[86:89], v[188:191], v[220:223]
    buffer_load_dwordx4 v255, s[4:7], s59 offen lds
    v_mbcnt_hi_u32_b32 v204, -1, v204
    v_mfma_f32_16x16x32_bf16 v[224:227], a[248:251], v[188:191], v[224:227]
    v_bfe_u32 v200, v204, 2, 2
    v_and_b32 v201, 3, v204
    v_mfma_f32_16x16x32_bf16 v[236:239], a[228:231], a[132:135], v[236:239]
    ds_read_b128 a[228:231], v243 offset:30976
    v_lshrrev_b32 v204, 4, v204
    v_mfma_f32_16x16x32_bf16 v[236:239], a[232:235], a[136:139], v[236:239]
    v_sub_u32 v202, v204, v200
    v_mul_i32_i24 v202, 0x1c0, v202
    v_mfma_f32_16x16x32_bf16 v[236:239], a[236:239], a[140:143], v[236:239]
    v_mbcnt_lo_u32_b32 v226, -1, 0
    v_mbcnt_hi_u32_b32 v226, -1, v226
    v_mfma_f32_16x16x32_bf16 v[228:231], a[144:147], a[240:243], 0
    v_and_b32 v226, 2, v226
    v_cmp_eq_u32 vcc, 0, v226
    v_mfma_f32_16x16x32_bf16 v[228:231], a[148:151], a[244:247], v[228:231]
    s_waitcnt lgkmcnt(1)
    v_lshlrev_b32 v203, 4, v201
    v_sub_u32 v202, v202, v203
    v_mfma_f32_16x16x32_bf16 v[228:231], a[152:155], a[216:219], v[228:231]
    v_add_u32 v226, 0xfffdd200, v247
    v_sub_u32 v203, v204, v200
    v_mfma_f32_16x16x32_bf16 v[228:231], a[156:159], a[220:223], v[228:231]
    v_cndmask_b32 v226, 0, v226, vcc
    v_add_u32 v244, 0, v203
    v_mfma_f32_16x16x32_bf16 v[228:231], a[160:163], a[224:227], v[228:231]
    ds_read_b128 a[232:235], v240 offset:32256
    v_cmp_gt_u32 vcc, 7, v244
    v_mfma_f32_16x16x32_bf16 v[232:235], a[168:171], a[240:243], 0
    ds_read_b128 a[236:239], v241 offset:32256
    s_waitcnt lgkmcnt(2)
    v_mfma_f32_16x16x32_bf16 v[228:231], a[164:167], a[228:231], v[228:231]
    v_add_u32 v202, s37, v202
    v_add_u32 v244, 0xfffdc870, v202
    v_mfma_f32_16x16x32_bf16 v[232:235], a[172:175], a[244:247], v[232:235]
    v_cndmask_b32 v244, 0, v244, vcc
    v_add_u32 v244, 0x237c0, v244
    v_mfma_f32_16x16x32_bf16 v[232:235], a[176:179], a[216:219], v[232:235]
    ds_read_b128 v[196:199], v244 offset:256
    v_cvt_pk_bf16_f32 v60, v236, v237
    v_mfma_f32_16x16x32_bf16 v[232:235], a[180:183], a[220:223], v[232:235]
    v_cvt_pk_bf16_f32 v63, v238, v239
    v_mul_f32 v228, s38, v228
    v_mfma_f32_16x16x32_bf16 v[232:235], a[184:187], a[224:227], v[232:235]
    v_mul_f32 v229, s38, v229
    v_mul_f32 v230, s38, v230
    v_mfma_f32_16x16x32_bf16 v[232:235], a[188:191], a[228:231], v[232:235]
    v_mul_f32 v231, s38, v231
    v_cvt_pk_bf16_f32 v168, v228, v229
    v_mfma_f32_16x16x32_bf16 v[236:239], a[192:195], a[240:243], 0
    ds_read_b128 a[240:243], v240 offset:32384
    v_cvt_pk_bf16_f32 v169, v230, v231
    v_mfma_f32_16x16x32_bf16 v[236:239], a[196:199], a[244:247], v[236:239]
    ds_read_b128 a[244:247], v241 offset:32384
    s_waitcnt lgkmcnt(3)
    v_mfma_f32_16x16x32_bf16 v[236:239], a[200:203], a[216:219], v[236:239]
    ds_read_b128 a[216:219], v240 offset:32512
    v_mul_f32 v232, s3, v232
    v_mfma_f32_16x16x32_bf16 v[236:239], a[204:207], a[220:223], v[236:239]
    ds_read_b128 a[220:223], v241 offset:32512
    v_mul_f32 v233, s3, v233
    v_mfma_f32_16x16x32_bf16 v[236:239], a[208:211], a[224:227], v[236:239]
    v_mul_f32 v234, s3, v234
    v_mul_f32 v235, s3, v235
    v_mfma_f32_16x16x32_bf16 v[236:239], a[212:215], a[228:231], v[236:239]
    v_cvt_pk_bf16_f32 v170, v232, v233
    v_cvt_pk_bf16_f32 v171, v234, v235
    v_mfma_f32_16x16x32_bf16 v[228:231], a[0:3], a[232:235], 0
    s_waitcnt lgkmcnt(4)
    v_add_u32 v245, 4, v203
    v_cmp_gt_u32 vcc, 7, v245
    v_mfma_f32_16x16x32_bf16 v[196:199], v[120:123], v[168:171], v[196:199]
    v_add_u32 v245, 0xfffdcf70, v202
    v_mul_f32 v236, s38, v236
    v_mfma_f32_16x16x32_bf16 v[228:231], a[4:7], a[236:239], v[228:231]
    v_mul_f32 v237, s38, v237
    s_waitcnt lgkmcnt(3)
    v_mfma_f32_16x16x32_bf16 v[228:231], a[8:11], a[240:243], v[228:231]
    v_mul_f32 v238, s38, v238
    s_waitcnt lgkmcnt(2)
    v_mfma_f32_16x16x32_bf16 v[228:231], a[12:15], a[244:247], v[228:231]
    v_mul_f32 v239, s38, v239
    s_waitcnt lgkmcnt(1)
    v_mfma_f32_16x16x32_bf16 v[228:231], a[16:19], a[216:219], v[228:231]
    v_cndmask_b32 v245, 0, v245, vcc
    v_add_u32 v246, 8, v203
    v_mfma_f32_16x16x32_bf16 v[232:235], a[24:27], a[232:235], 0
    s_waitcnt lgkmcnt(0)
    v_cvt_pk_bf16_f32 v172, v236, v237
    v_cvt_pk_bf16_f32 v173, v238, v239
    v_mfma_f32_16x16x32_bf16 v[228:231], a[20:23], a[220:223], v[228:231]
    v_cmp_gt_u32 vcc, 7, v246
    v_add_u32 v246, 0xfffdd670, v202
    v_mfma_f32_16x16x32_bf16 v[196:199], v[122:125], v[170:173], v[196:199]
    ds_read_b128 v[200:203], v244 offset:192
    v_add_u32 v245, 0x237c0, v245
    v_mfma_f32_16x16x32_bf16 v[232:235], a[28:31], a[236:239], v[232:235]
    ds_read_b128 v[204:207], v245 offset:192
    v_cndmask_b32 v246, 0, v246, vcc
    v_mfma_f32_16x16x32_bf16 v[232:235], a[32:35], a[240:243], v[232:235]
    v_add_u32 v246, 0x237c0, v246
    v_cvt_pk_bf16_f32 v108, v228, v229
    v_mfma_f32_16x16x32_bf16 v[232:235], a[36:39], a[244:247], v[232:235]
    ds_read_b128 v[208:211], v246 offset:192
    v_cvt_pk_bf16_f32 v109, v230, v231
    v_mfma_f32_16x16x32_bf16 v[232:235], a[40:43], a[216:219], v[232:235]
    v_rcp_f32 v225, v224
    v_mfma_f32_16x16x32_bf16 v[232:235], a[44:47], a[220:223], v[232:235]
    ds_write_b64 v247, v[174:175] offset:0
    v_mfma_f32_16x16x32_bf16 v[236:239], a[48:51], a[232:235], 0
    v_mul_f32 v212, v212, v225
    v_mul_f32 v213, v213, v225
    v_mfma_f32_16x16x32_bf16 v[236:239], a[52:55], a[236:239], v[236:239]
    ds_write_b64 v247, v[176:177] offset:128
    v_mfma_f32_16x16x32_bf16 v[236:239], a[56:59], a[240:243], v[236:239]
    s_waitcnt lgkmcnt(4)
    v_cvt_pk_bf16_f32 v110, v232, v233
    v_cvt_pk_bf16_f32 v111, v234, v235
    v_mfma_f32_16x16x32_bf16 v[200:203], v[114:117], v[168:171], v[200:203]
    s_waitcnt lgkmcnt(3)
    v_mul_f32 v214, v214, v225
    v_mul_f32 v215, v215, v225
    v_mfma_f32_16x16x32_bf16 v[200:203], v[116:119], v[170:173], v[200:203]
    v_cvt_pk_bf16_f32 v212, v212, v213
    v_add_u32 v226, 0x22e00, v226
    v_mfma_f32_16x16x32_bf16 v[204:207], v[138:141], v[168:171], v[204:207]
    s_waitcnt lgkmcnt(2)
    v_cvt_pk_bf16_f32 v213, v214, v215
    v_mul_f32 v216, v216, v225
    v_mfma_f32_16x16x32_bf16 v[204:207], v[140:143], v[170:173], v[204:207]
    ds_write_b64 v247, v[178:179] offset:256
    v_mfma_f32_16x16x32_bf16 v[208:211], v[102:105], v[168:171], v[208:211]
    v_exp_f32 v200, v200
    v_mfma_f32_16x16x32_bf16 v[208:211], v[104:107], v[170:173], v[208:211]
    v_exp_f32 v201, v201
    v_mfma_f32_16x16x32_bf16 v[236:239], a[60:63], a[244:247], v[236:239]
    v_exp_f32 v202, v202
    v_mfma_f32_16x16x32_bf16 v[236:239], a[64:67], a[216:219], v[236:239]
    v_exp_f32 v203, v203
    v_mfma_f32_16x16x32_bf16 v[236:239], a[68:71], a[220:223], v[236:239]
    v_cvt_pk_bf16_f32 v193, v200, v201
    v_cvt_pk_bf16_f32 v180, v202, v203
    v_mfma_f32_16x16x32_bf16 v[228:231], a[232:235], a[72:75], 0
    ds_read_b128 v[200:203], v245 offset:256
    ds_read_b128 a[224:227], v242 offset:32256
    v_mfma_f32_16x16x32_bf16 v[228:231], a[236:239], a[76:79], v[228:231]
    v_exp_f32 v204, v204
    v_mfma_f32_16x16x32_bf16 v[228:231], a[240:243], a[80:83], v[228:231]
    v_exp_f32 v205, v205
    v_mfma_f32_16x16x32_bf16 v[228:231], a[244:247], a[84:87], v[228:231]
    v_exp_f32 v206, v206
    v_mfma_f32_16x16x32_bf16 v[228:231], a[216:219], a[88:91], v[228:231]
    v_exp_f32 v207, v207
    v_mfma_f32_16x16x32_bf16 v[228:231], a[220:223], a[92:95], v[228:231]
    v_cvt_pk_bf16_f32 v194, v204, v205
    v_cvt_pk_bf16_f32 v181, v206, v207
    v_mfma_f32_16x16x32_bf16 v[232:235], a[232:235], a[96:99], 0
    ds_read_b128 v[204:207], v246 offset:256
    v_cvt_pk_bf16_f32 v112, v236, v237
    v_mfma_f32_16x16x32_bf16 v[232:235], a[236:239], a[100:103], v[232:235]
    v_exp_f32 v208, v208
    v_mfma_f32_16x16x32_bf16 v[232:235], a[240:243], a[104:107], v[232:235]
    v_exp_f32 v209, v209
    v_mfma_f32_16x16x32_bf16 v[232:235], a[244:247], a[108:111], v[232:235]
    s_waitcnt lgkmcnt(2)
    v_exp_f32 v210, v210
    v_mfma_f32_16x16x32_bf16 v[200:203], v[144:147], v[168:171], v[200:203]
    v_exp_f32 v211, v211
    v_mfma_f32_16x16x32_bf16 v[200:203], v[146:149], v[170:173], v[200:203]
    v_cvt_pk_bf16_f32 v192, v208, v209
    v_cvt_pk_bf16_f32 v195, v210, v211
    v_mfma_f32_16x16x32_bf16 v[232:235], a[216:219], a[112:115], v[232:235]
    ds_read_b128 v[208:211], v244 offset:320
    v_cvt_pk_bf16_f32 v113, v238, v239
    v_mfma_f32_16x16x32_bf16 v[232:235], a[220:223], a[116:119], v[232:235]
    ds_write_b64 v226, v[212:213] offset:0
    v_mfma_f32_16x16x32_bf16 v[212:215], v[0:3], v[192:195], 0
    s_waitcnt lgkmcnt(2)
    ds_read_b128 a[228:231], v243 offset:32256
    v_mfma_f32_16x16x32_bf16 v[204:207], v[108:111], v[168:171], v[204:207]
    v_mul_f32 v217, v217, v225
    v_mul_f32 v218, v218, v225
    v_mfma_f32_16x16x32_bf16 v[204:207], v[110:113], v[170:173], v[204:207]
    v_mul_f32 v219, v219, v225
    v_cvt_pk_bf16_f32 v216, v216, v217
    v_mfma_f32_16x16x32_bf16 v[236:239], a[232:235], a[120:123], 0
    ds_read_b128 a[232:235], v242 offset:32384
    v_cvt_pk_bf16_f32 v217, v218, v219
    v_mfma_f32_16x16x32_bf16 v[236:239], a[236:239], a[124:127], v[236:239]
    ds_write_b64 v226, v[216:217] offset:128
    v_mfma_f32_16x16x32_bf16 v[216:219], v[30:33], v[192:195], 0
    ds_read_b128 a[236:239], v243 offset:32384
    v_mul_f32 v220, v220, v225
    v_mfma_f32_16x16x32_bf16 v[236:239], a[240:243], a[128:131], v[236:239]
    s_waitcnt lgkmcnt(5)
    ds_read_b128 a[240:243], v242 offset:32512
    v_mfma_f32_16x16x32_bf16 v[208:211], v[126:129], v[168:171], v[208:211]
    v_mul_f32 v221, v221, v225
    v_mul_f32 v222, v222, v225
    v_mfma_f32_16x16x32_bf16 v[208:211], v[128:131], v[170:173], v[208:211]
    v_mul_f32 v223, v223, v225
    v_cvt_pk_bf16_f32 v220, v220, v221
    v_mfma_f32_16x16x32_bf16 v[236:239], a[244:247], a[132:135], v[236:239]
    ds_read_b128 a[244:247], v243 offset:32512
    v_cvt_pk_bf16_f32 v221, v222, v223
    v_mfma_f32_16x16x32_bf16 v[236:239], a[216:219], a[136:139], v[236:239]
    ds_write_b64 v226, v[220:221] offset:256
    v_mfma_f32_16x16x32_bf16 v[220:223], v[60:63], v[192:195], 0
    v_max3_f32 v248, v248, v224, v225
    v_cvt_pk_bf16_f32 v6, v228, v229
    v_mfma_f32_16x16x32_bf16 v[224:227], a[248:251], v[192:195], 0
    v_cvt_pk_bf16_f32 v9, v230, v231
    v_cvt_pk_bf16_f32 v36, v232, v233
    v_mfma_f32_16x16x32_bf16 v[236:239], a[220:223], a[140:143], v[236:239]
    v_exp_f32 v196, v196
    v_mfma_f32_16x16x32_bf16 v[228:231], a[144:147], a[224:227], 0
    s_waitcnt lgkmcnt(3)
    v_exp_f32 v197, v197
    v_mfma_f32_16x16x32_bf16 v[228:231], a[148:151], a[228:231], v[228:231]
    v_exp_f32 v198, v198
    v_mfma_f32_16x16x32_bf16 v[228:231], a[152:155], a[232:235], v[228:231]
    v_exp_f32 v199, v199
    v_mfma_f32_16x16x32_bf16 v[228:231], a[156:159], a[236:239], v[228:231]
    s_waitcnt lgkmcnt(1)
    v_cvt_pk_bf16_f32 v183, v196, v197
    v_cvt_pk_bf16_f32 v186, v198, v199
    v_mfma_f32_16x16x32_bf16 v[228:231], a[160:163], a[240:243], v[228:231]
    ds_read_b128 v[196:199], v245 offset:320
    v_cvt_pk_bf16_f32 v39, v234, v235
    v_mfma_f32_16x16x32_bf16 v[228:231], a[164:167], a[244:247], v[228:231]
    v_exp_f32 v204, v204
    v_mfma_f32_16x16x32_bf16 v[232:235], a[168:171], a[224:227], 0
    v_exp_f32 v205, v205
    v_mfma_f32_16x16x32_bf16 v[232:235], a[172:175], a[228:231], v[232:235]
    v_cvt_pk_bf16_f32 v182, v204, v205
    v_cvt_pk_bf16_f32 v66, v236, v237
    v_mfma_f32_16x16x32_bf16 v[232:235], a[176:179], a[232:235], v[232:235]
    ds_read_b128 a[216:219], v242 offset:33792
    ds_read_b128 a[220:223], v243 offset:33792
    v_mfma_f32_16x16x32_bf16 v[212:215], v[4:7], v[180:183], v[212:215]
    v_cvt_pk_bf16_f32 v69, v238, v239
    v_mul_f32 v228, s38, v228
    v_mfma_f32_16x16x32_bf16 v[216:219], v[34:37], v[180:183], v[216:219]
    v_mul_f32 v229, s38, v229
    v_mul_f32 v230, s38, v230
    v_mfma_f32_16x16x32_bf16 v[220:223], v[64:67], v[180:183], v[220:223]
    v_mul_f32 v231, s38, v231
    v_cvt_pk_bf16_f32 v174, v228, v229
    v_mfma_f32_16x16x32_bf16 v[224:227], a[248:251], v[180:183], v[224:227]
    v_cvt_pk_bf16_f32 v175, v230, v231
    s_waitcnt lgkmcnt(2)
    v_mfma_f32_16x16x32_bf16 v[196:199], v[150:153], v[168:171], v[196:199]
    v_exp_f32 v200, v200
    v_mfma_f32_16x16x32_bf16 v[196:199], v[152:155], v[170:173], v[196:199]
    v_exp_f32 v201, v201
    v_mfma_f32_16x16x32_bf16 v[232:235], a[180:183], a[236:239], v[232:235]
    v_exp_f32 v202, v202
    v_mfma_f32_16x16x32_bf16 v[232:235], a[184:187], a[240:243], v[232:235]
    v_exp_f32 v203, v203
    v_mfma_f32_16x16x32_bf16 v[232:235], a[188:191], a[244:247], v[232:235]
    s_waitcnt lgkmcnt(1)
    v_exp_f32 v206, v206
    v_mfma_f32_16x16x32_bf16 v[236:239], a[192:195], a[224:227], 0
    ds_read_b128 a[224:227], v242 offset:33920
    v_cvt_pk_bf16_f32 v184, v200, v201
    v_mfma_f32_16x16x32_bf16 v[236:239], a[196:199], a[228:231], v[236:239]
    ds_read_b128 a[228:231], v243 offset:33920
    v_cvt_pk_bf16_f32 v187, v202, v203
    v_mfma_f32_16x16x32_bf16 v[236:239], a[200:203], a[232:235], v[236:239]
    ds_read_b128 a[232:235], v242 offset:34048
    v_mul_f32 v232, s3, v232
    v_mfma_f32_16x16x32_bf16 v[236:239], a[204:207], a[236:239], v[236:239]
    ds_read_b128 a[236:239], v243 offset:34048
    v_mul_f32 v233, s3, v233
    v_mfma_f32_16x16x32_bf16 v[236:239], a[208:211], a[240:243], v[236:239]
    v_exp_f32 v207, v207
    v_mfma_f32_16x16x32_bf16 v[236:239], a[212:215], a[244:247], v[236:239]
    v_cvt_pk_bf16_f32 v185, v206, v207
    v_mul_f32 v234, s3, v234
    v_mfma_f32_16x16x32_bf16 v[228:231], a[144:147], a[216:219], 0
    s_waitcnt lgkmcnt(4)
    ds_read_b128 v[204:207], v244 offset:0
    v_mfma_f32_16x16x32_bf16 v[212:215], v[8:11], v[184:187], v[212:215]
    v_mul_f32 v235, s3, v235
    v_cvt_pk_bf16_f32 v176, v232, v233
    v_mfma_f32_16x16x32_bf16 v[216:219], v[38:41], v[184:187], v[216:219]
    v_cvt_pk_bf16_f32 v177, v234, v235
    v_mul_f32 v236, s38, v236
    v_mfma_f32_16x16x32_bf16 v[220:223], v[68:71], v[184:187], v[220:223]
    v_exp_f32 v208, v208
    v_mfma_f32_16x16x32_bf16 v[224:227], a[248:251], v[184:187], v[224:227]
    v_exp_f32 v209, v209
    v_mfma_f32_16x16x32_bf16 v[228:231], a[148:151], a[220:223], v[228:231]
    s_waitcnt lgkmcnt(2)
    v_cvt_pk_bf16_f32 v189, v208, v209
    v_mul_f32 v237, s38, v237
    v_mfma_f32_16x16x32_bf16 v[228:231], a[152:155], a[224:227], v[228:231]
    ds_read_b128 v[208:211], v245 offset:0
    v_mul_f32 v238, s38, v238
    v_mfma_f32_16x16x32_bf16 v[228:231], a[156:159], a[228:231], v[228:231]
    s_waitcnt vmcnt(4) lgkmcnt(2)
    v_mul_f32 v239, s38, v239
    v_cvt_pk_bf16_f32 v178, v236, v237
    v_mfma_f32_16x16x32_bf16 v[228:231], a[160:163], a[232:235], v[228:231]
    s_barrier
    v_cvt_pk_bf16_f32 v179, v238, v239
    s_waitcnt lgkmcnt(1)
    v_mfma_f32_16x16x32_bf16 v[204:207], v[120:123], v[174:177], v[204:207]
    ds_read_b128 a[240:243], v240 offset:33792
    ds_read_b128 a[244:247], v241 offset:33792
    v_mfma_f32_16x16x32_bf16 v[204:207], v[122:125], v[176:179], v[204:207]
    v_exp_f32 v196, v196
    v_mfma_f32_16x16x32_bf16 v[228:231], a[164:167], a[236:239], v[228:231]
    v_exp_f32 v197, v197
    v_mfma_f32_16x16x32_bf16 v[232:235], a[168:171], a[216:219], 0
    ds_read_b128 v[200:203], v246 offset:320
    v_cvt_pk_bf16_f32 v190, v196, v197
    v_mfma_f32_16x16x32_bf16 v[232:235], a[172:175], a[220:223], v[232:235]
    ds_read_b128 v[196:199], v246 offset:0
    v_mov_b32 v191, 0
    v_mfma_f32_16x16x32_bf16 v[232:235], a[176:179], a[224:227], v[232:235]
    v_mul_f32 v228, s38, v228
    s_waitcnt lgkmcnt(4)
    v_mfma_f32_16x16x32_bf16 v[208:211], v[144:147], v[174:177], v[208:211]
    v_mul_f32 v229, s38, v229
    v_mul_f32 v230, s38, v230
    v_mfma_f32_16x16x32_bf16 v[208:211], v[146:149], v[176:179], v[208:211]
    v_mul_f32 v231, s38, v231
    v_cvt_pk_bf16_f32 v228, v228, v229
    v_mfma_f32_16x16x32_bf16 v[232:235], a[180:183], a[228:231], v[232:235]
    buffer_load_dwordx4 v254, s[4:7], s59 offen offset:1024 lds
    v_cvt_pk_bf16_f32 v229, v230, v231
    v_mfma_f32_16x16x32_bf16 v[232:235], a[184:187], a[232:235], v[232:235]
    ds_write_b64 v247, v[228:229] offset:18432
    v_mfma_f32_16x16x32_bf16 v[232:235], a[188:191], a[236:239], v[232:235]
    s_waitcnt lgkmcnt(3)
    v_exp_f32 v204, v204
    v_mfma_f32_16x16x32_bf16 v[236:239], a[192:195], a[216:219], 0
    ds_read_b128 a[216:219], v240 offset:33920
    v_accvgpr_read_b32 v255, a254
    v_mfma_f32_16x16x32_bf16 v[236:239], a[196:199], a[220:223], v[236:239]
    ds_read_b128 a[220:223], v241 offset:33920
    s_waitcnt lgkmcnt(3)
    v_mfma_f32_16x16x32_bf16 v[196:199], v[108:111], v[174:177], v[196:199]
    v_exp_f32 v205, v205
    v_mfma_f32_16x16x32_bf16 v[196:199], v[110:113], v[176:179], v[196:199]
    v_exp_f32 v206, v206
    v_mfma_f32_16x16x32_bf16 v[236:239], a[200:203], a[224:227], v[236:239]
    ds_read_b128 a[224:227], v240 offset:34048
    v_cvt_pk_bf16_f32 v193, v204, v205
    v_mfma_f32_16x16x32_bf16 v[236:239], a[204:207], a[228:231], v[236:239]
    ds_read_b128 a[228:231], v241 offset:34048
    v_mul_f32 v232, s3, v232
    v_mfma_f32_16x16x32_bf16 v[236:239], a[208:211], a[232:235], v[236:239]
    v_exp_f32 v207, v207
    v_mfma_f32_16x16x32_bf16 v[236:239], a[212:215], a[236:239], v[236:239]
    v_cvt_pk_bf16_f32 v180, v206, v207
    v_mul_f32 v233, s3, v233
    v_mfma_f32_16x16x32_bf16 v[228:231], a[0:3], a[240:243], 0
    ds_read_b128 v[204:207], v245 offset:64
    v_mul_f32 v234, s3, v234
    v_mfma_f32_16x16x32_bf16 v[228:231], a[4:7], a[244:247], v[228:231]
    s_waitcnt lgkmcnt(4)
    v_mul_f32 v235, s3, v235
    v_cvt_pk_bf16_f32 v232, v232, v233
    v_mfma_f32_16x16x32_bf16 v[228:231], a[8:11], a[216:219], v[228:231]
    s_waitcnt lgkmcnt(3)
    v_cvt_pk_bf16_f32 v233, v234, v235
    v_mul_f32 v236, s38, v236
    v_mfma_f32_16x16x32_bf16 v[228:231], a[12:15], a[220:223], v[228:231]
    ds_write_b64 v247, v[232:233] offset:18560
    v_mfma_f32_16x16x32_bf16 v[232:235], a[24:27], a[240:243], 0
    s_waitcnt lgkmcnt(3)
    v_mul_f32 v237, s38, v237
    v_mul_f32 v238, s38, v238
    v_mfma_f32_16x16x32_bf16 v[228:231], a[16:19], a[224:227], v[228:231]
    s_waitcnt lgkmcnt(2)
    v_mul_f32 v239, s38, v239
    v_cvt_pk_bf16_f32 v236, v236, v237
    v_mfma_f32_16x16x32_bf16 v[228:231], a[20:23], a[228:231], v[228:231]
    ds_read_b128 a[232:235], v242 offset:61440
    v_cvt_pk_bf16_f32 v237, v238, v239
    v_mfma_f32_16x16x32_bf16 v[232:235], a[28:31], a[244:247], v[232:235]
    ds_write_b64 v247, v[236:237] offset:18688
    v_mfma_f32_16x16x32_bf16 v[232:235], a[32:35], a[216:219], v[232:235]
    s_waitcnt lgkmcnt(3)
    v_exp_f32 v208, v208
    v_mfma_f32_16x16x32_bf16 v[204:207], v[150:153], v[174:177], v[204:207]
    v_cvt_pk_bf16_f32 v162, v228, v229
    v_cvt_pk_bf16_f32 v163, v230, v231
    v_mfma_f32_16x16x32_bf16 v[204:207], v[152:155], v[176:179], v[204:207]
    v_exp_f32 v209, v209
    v_mfma_f32_16x16x32_bf16 v[232:235], a[36:39], a[220:223], v[232:235]
    v_exp_f32 v210, v210
    v_mfma_f32_16x16x32_bf16 v[232:235], a[40:43], a[224:227], v[232:235]
    v_exp_f32 v211, v211
    v_mfma_f32_16x16x32_bf16 v[232:235], a[44:47], a[228:231], v[232:235]
    v_cvt_pk_bf16_f32 v194, v208, v209
    v_cvt_pk_bf16_f32 v181, v210, v211
    v_mfma_f32_16x16x32_bf16 v[236:239], a[48:51], a[240:243], 0
    ds_read_b128 v[208:211], v246 offset:64
    ds_read_b128 a[236:239], v243 offset:61440
    v_mfma_f32_16x16x32_bf16 v[236:239], a[52:55], a[244:247], v[236:239]
    v_exp_f32 v196, v196
    v_mfma_f32_16x16x32_bf16 v[236:239], a[56:59], a[216:219], v[236:239]
    v_cvt_pk_bf16_f32 v164, v232, v233
    v_cvt_pk_bf16_f32 v165, v234, v235
    v_mfma_f32_16x16x32_bf16 v[236:239], a[60:63], a[220:223], v[236:239]
    v_exp_f32 v197, v197
    v_mfma_f32_16x16x32_bf16 v[200:203], v[162:165], v[168:171], v[200:203]
    v_exp_f32 v198, v198
    v_mfma_f32_16x16x32_bf16 v[236:239], a[64:67], a[224:227], v[236:239]
    v_exp_f32 v199, v199
    v_mfma_f32_16x16x32_bf16 v[236:239], a[68:71], a[228:231], v[236:239]
    v_cvt_pk_bf16_f32 v192, v196, v197
    v_cvt_pk_bf16_f32 v195, v198, v199
    v_mfma_f32_16x16x32_bf16 v[228:231], a[240:243], a[72:75], 0
    ds_read_b128 v[196:199], v244 offset:128
    v_accvgpr_read_b32 v254, a252
    v_mfma_f32_16x16x32_bf16 v[228:231], a[244:247], a[76:79], v[228:231]
    v_exp_f32 v204, v204
    v_mfma_f32_16x16x32_bf16 v[228:231], a[216:219], a[80:83], v[228:231]
    s_waitcnt lgkmcnt(2)
    v_cvt_pk_bf16_f32 v166, v236, v237
    v_cvt_pk_bf16_f32 v167, v238, v239
    v_mfma_f32_16x16x32_bf16 v[208:211], v[162:165], v[174:177], v[208:211]
    v_exp_f32 v205, v205
    v_mfma_f32_16x16x32_bf16 v[200:203], v[164:167], v[170:173], v[200:203]
    v_exp_f32 v206, v206
    v_mfma_f32_16x16x32_bf16 v[208:211], v[164:167], v[176:179], v[208:211]
    v_exp_f32 v207, v207
    v_mfma_f32_16x16x32_bf16 v[228:231], a[220:223], a[84:87], v[228:231]
    ds_read_b64 v[168:169], v247 offset:18432
    v_cvt_pk_bf16_f32 v184, v204, v205
    v_mfma_f32_16x16x32_bf16 v[228:231], a[224:227], a[88:91], v[228:231]
    ds_read_b64 v[170:171], v247 offset:18560
    v_cvt_pk_bf16_f32 v187, v206, v207
    v_mfma_f32_16x16x32_bf16 v[228:231], a[228:231], a[92:95], v[228:231]
    v_exp_f32 v200, v200
    v_mfma_f32_16x16x32_bf16 v[232:235], a[240:243], a[96:99], 0
    s_waitcnt lgkmcnt(2)
    v_exp_f32 v201, v201
    v_mfma_f32_16x16x32_bf16 v[196:199], v[132:135], v[174:177], v[196:199]
    ds_read_b64 v[172:173], v247 offset:18688
    v_cvt_pk_bf16_f32 v188, v200, v201
    v_mfma_f32_16x16x32_bf16 v[196:199], v[134:137], v[176:179], v[196:199]
    ds_read_b128 v[200:203], v244 offset:64
    v_cvt_pk_bf16_f32 v12, v228, v229
    v_mfma_f32_16x16x32_bf16 v[224:227], a[248:251], v[188:191], v[224:227]
    ds_read_b128 v[204:207], v246 offset:128
    v_cvt_pk_bf16_f32 v15, v230, v231
    v_mfma_f32_16x16x32_bf16 v[232:235], a[244:247], a[100:103], v[232:235]
    v_exp_f32 v208, v208
    v_mfma_f32_16x16x32_bf16 v[212:215], v[12:15], v[188:191], v[212:215]
    v_exp_f32 v209, v209
    v_mfma_f32_16x16x32_bf16 v[232:235], a[216:219], a[104:107], v[232:235]
    buffer_load_dwordx4 v255, s[4:7], s59 offen offset:2048 lds
    v_cvt_pk_bf16_f32 v182, v208, v209
    v_mfma_f32_16x16x32_bf16 v[232:235], a[220:223], a[108:111], v[232:235]
    s_add_u32 m0, s46, 0x1800
    v_rcp_f32 v225, v224
    v_mfma_f32_16x16x32_bf16 v[232:235], a[224:227], a[112:115], v[232:235]
    v_mul_f32 v212, v212, v225
    v_mul_f32 v213, v213, v225
    v_mfma_f32_16x16x32_bf16 v[232:235], a[228:231], a[116:119], v[232:235]
    v_mul_f32 v214, v214, v225
    v_mul_f32 v215, v215, v225
    v_mfma_f32_16x16x32_bf16 v[236:239], a[240:243], a[120:123], 0
    ds_read_b128 a[240:243], v242 offset:61568
    s_waitcnt lgkmcnt(2)
    v_mfma_f32_16x16x32_bf16 v[200:203], v[126:129], v[174:177], v[200:203]
    v_cvt_pk_bf16_f32 v212, v212, v213
    v_cvt_pk_bf16_f32 v213, v214, v215
    v_mfma_f32_16x16x32_bf16 v[200:203], v[128:131], v[176:179], v[200:203]
    ds_write_b64 v247, v[212:213] offset:6144
    v_mfma_f32_16x16x32_bf16 v[212:215], v[6:9], v[192:195], 0
    v_cvt_pk_bf16_f32 v42, v232, v233
    v_cvt_pk_bf16_f32 v45, v234, v235
    v_mfma_f32_16x16x32_bf16 v[236:239], a[244:247], a[124:127], v[236:239]
    ds_read_b128 a[244:247], v243 offset:61568
    v_max3_f32 v248, v248, v224, v225
    v_mfma_f32_16x16x32_bf16 v[216:219], v[42:45], v[188:191], v[216:219]
    v_exp_f32 v200, v200
    v_mfma_f32_16x16x32_bf16 v[236:239], a[216:219], a[128:131], v[236:239]
    ds_read_b128 a[216:219], v242 offset:61696
    v_accvgpr_read_b32 v255, a255
    v_mfma_f32_16x16x32_bf16 v[236:239], a[220:223], a[132:135], v[236:239]
    ds_read_b128 a[220:223], v243 offset:61696
    buffer_load_dwordx4 v254, s[4:7], s58 offen lds
    v_mfma_f32_16x16x32_bf16 v[236:239], a[224:227], a[136:139], v[236:239]
    v_mul_f32 v216, v216, v225
    v_mul_f32 v217, v217, v225
    v_mfma_f32_16x16x32_bf16 v[236:239], a[228:231], a[140:143], v[236:239]
    v_mul_f32 v218, v218, v225
    v_mul_f32 v219, v219, v225
    v_mfma_f32_16x16x32_bf16 v[228:231], a[144:147], a[232:235], 0
    ds_read_b128 a[224:227], v242 offset:62976
    v_cvt_pk_bf16_f32 v216, v216, v217
    v_mfma_f32_16x16x32_bf16 v[228:231], a[148:151], a[236:239], v[228:231]
    s_waitcnt lgkmcnt(4)
    v_cvt_pk_bf16_f32 v217, v218, v219
    v_cvt_pk_bf16_f32 v72, v236, v237
    v_mfma_f32_16x16x32_bf16 v[228:231], a[152:155], a[240:243], v[228:231]
    ds_read_b128 a[228:231], v243 offset:62976
    v_cvt_pk_bf16_f32 v75, v238, v239
    v_mfma_f32_16x16x32_bf16 v[232:235], a[168:171], a[232:235], 0
    s_waitcnt lgkmcnt(4)
    v_exp_f32 v201, v201
    v_mfma_f32_16x16x32_bf16 v[220:223], v[72:75], v[188:191], v[220:223]
    ds_write_b64 v247, v[216:217] offset:6272
    v_mfma_f32_16x16x32_bf16 v[216:219], v[36:39], v[192:195], 0
    buffer_load_dwordx4 v255, s[4:7], s58 offen offset:512 lds
    v_cvt_pk_bf16_f32 v183, v200, v201
    v_mfma_f32_16x16x32_bf16 v[228:231], a[156:159], a[244:247], v[228:231]
    s_waitcnt lgkmcnt(3)
    v_exp_f32 v202, v202
    v_mfma_f32_16x16x32_bf16 v[212:215], v[10:13], v[180:183], v[212:215]
    s_add_u32 m0, s46, 0x16800
    v_mul_f32 v220, v220, v225
    v_mul_f32 v221, v221, v225
    v_mfma_f32_16x16x32_bf16 v[216:219], v[40:43], v[180:183], v[216:219]
    v_mul_f32 v222, v222, v225
    v_mul_f32 v223, v223, v225
    v_mfma_f32_16x16x32_bf16 v[224:227], a[248:251], v[192:195], 0
    v_exp_f32 v203, v203
    v_mfma_f32_16x16x32_bf16 v[224:227], a[248:251], v[180:183], v[224:227]
    v_cvt_pk_bf16_f32 v186, v202, v203
    v_cvt_pk_bf16_f32 v220, v220, v221
    v_mfma_f32_16x16x32_bf16 v[228:231], a[160:163], a[216:219], v[228:231]
    ds_read_b128 v[200:203], v245 offset:128
    v_cvt_pk_bf16_f32 v221, v222, v223
    v_mfma_f32_16x16x32_bf16 v[228:231], a[164:167], a[220:223], v[228:231]
    ds_write_b64 v247, v[220:221] offset:6400
    v_mfma_f32_16x16x32_bf16 v[220:223], v[66:69], v[192:195], 0
    v_exp_f32 v210, v210
    v_mfma_f32_16x16x32_bf16 v[220:223], v[70:73], v[180:183], v[220:223]
    v_exp_f32 v211, v211
    v_mfma_f32_16x16x32_bf16 v[232:235], a[172:175], a[236:239], v[232:235]
    v_cvt_pk_bf16_f32 v185, v210, v211
    v_mbcnt_lo_u32_b32 v254, -1, 0
    v_mfma_f32_16x16x32_bf16 v[232:235], a[176:179], a[240:243], v[232:235]
    ds_read_b128 v[208:211], v244 offset:0
    v_mul_f32 v228, s38, v228
    v_mfma_f32_16x16x32_bf16 v[212:215], v[14:17], v[184:187], v[212:215]
    v_exp_f32 v196, v196
    v_mfma_f32_16x16x32_bf16 v[216:219], v[44:47], v[184:187], v[216:219]
    v_exp_f32 v197, v197
    v_mfma_f32_16x16x32_bf16 v[220:223], v[74:77], v[184:187], v[220:223]
    s_waitcnt lgkmcnt(2)
    v_cvt_pk_bf16_f32 v189, v196, v197
    v_mul_f32 v229, s38, v229
    v_mfma_f32_16x16x32_bf16 v[224:227], a[248:251], v[184:187], v[224:227]
    ds_read_b128 v[196:199], v245 offset:0
    v_mul_f32 v230, s38, v230
    v_mfma_f32_16x16x32_bf16 v[200:203], v[156:159], v[174:177], v[200:203]
    v_mul_f32 v231, s38, v231
    v_cvt_pk_bf16_f32 v228, v228, v229
    v_mfma_f32_16x16x32_bf16 v[200:203], v[158:161], v[176:179], v[200:203]
    v_cvt_pk_bf16_f32 v229, v230, v231
    v_mbcnt_hi_u32_b32 v254, -1, v254
    v_mfma_f32_16x16x32_bf16 v[232:235], a[180:183], a[244:247], v[232:235]
    ds_write_b64 v247, v[228:229] offset:24576
    v_mfma_f32_16x16x32_bf16 v[232:235], a[184:187], a[216:219], v[232:235]
    s_waitcnt lgkmcnt(2)
    v_lshrrev_b32 v255, 4, v254
    v_and_b32 v254, 15, v254
    v_mfma_f32_16x16x32_bf16 v[208:211], v[126:129], v[168:171], v[208:211]
    v_exp_f32 v200, v200
    v_mfma_f32_16x16x32_bf16 v[208:211], v[128:131], v[170:173], v[208:211]
    v_exp_f32 v201, v201
    v_mfma_f32_16x16x32_bf16 v[232:235], a[188:191], a[220:223], v[232:235]
    v_cvt_pk_bf16_f32 v190, v200, v201
    v_mfma_f32_16x16x32_bf16 v[236:239], a[192:195], a[232:235], 0
    s_waitcnt lgkmcnt(1)
    ds_read_b128 v[200:203], v246 offset:0
    v_mfma_f32_16x16x32_bf16 v[196:199], v[150:153], v[168:171], v[196:199]
    ds_read_b128 a[232:235], v242 offset:63104
    v_mfma_f32_16x16x32_bf16 v[196:199], v[152:155], v[170:173], v[196:199]
    v_exp_f32 v208, v208
    v_mfma_f32_16x16x32_bf16 v[236:239], a[196:199], a[236:239], v[236:239]
    ds_read_b128 a[236:239], v243 offset:63104
    v_mul_f32 v232, s3, v232
    v_mfma_f32_16x16x32_bf16 v[236:239], a[200:203], a[240:243], v[236:239]
    ds_read_b128 a[240:243], v242 offset:63232
    v_mul_f32 v233, s3, v233
    v_mfma_f32_16x16x32_bf16 v[236:239], a[204:207], a[244:247], v[236:239]
    ds_read_b128 a[244:247], v243 offset:63232
    v_mul_f32 v234, s3, v234
    v_mfma_f32_16x16x32_bf16 v[236:239], a[208:211], a[216:219], v[236:239]
    v_mul_f32 v235, s3, v235
    v_cvt_pk_bf16_f32 v232, v232, v233
    v_mfma_f32_16x16x32_bf16 v[236:239], a[212:215], a[220:223], v[236:239]
    ds_read_b128 a[216:219], v240 offset:35328
    v_cvt_pk_bf16_f32 v233, v234, v235
    v_mfma_f32_16x16x32_bf16 v[228:231], a[144:147], a[224:227], 0
    ds_write_b64 v247, v[232:233] offset:24704
    v_mfma_f32_16x16x32_bf16 v[228:231], a[148:151], a[228:231], v[228:231]
    s_waitcnt lgkmcnt(6)
    s_waitcnt lgkmcnt(5)
    v_mfma_f32_16x16x32_bf16 v[200:203], v[162:165], v[168:171], v[200:203]
    v_exp_f32 v209, v209
    v_mfma_f32_16x16x32_bf16 v[200:203], v[164:167], v[170:173], v[200:203]
    v_exp_f32 v210, v210
    v_mfma_f32_16x16x32_bf16 v[228:231], a[152:155], a[232:235], v[228:231]
    s_waitcnt lgkmcnt(3)
    v_exp_f32 v211, v211
    v_mfma_f32_16x16x32_bf16 v[228:231], a[156:159], a[236:239], v[228:231]
    v_cvt_pk_bf16_f32 v193, v208, v209
    v_cvt_pk_bf16_f32 v180, v210, v211
    v_mfma_f32_16x16x32_bf16 v[228:231], a[160:163], a[240:243], v[228:231]
    s_waitcnt lgkmcnt(2)
    ds_read_b128 v[208:211], v245 offset:64
    v_mfma_f32_16x16x32_bf16 v[228:231], a[164:167], a[244:247], v[228:231]
    v_mul_f32 v236, s38, v236
    v_mul_f32 v237, s38, v237
    v_mfma_f32_16x16x32_bf16 v[232:235], a[168:171], a[224:227], 0
    v_mul_f32 v238, s38, v238
    v_mul_f32 v239, s38, v239
    v_mfma_f32_16x16x32_bf16 v[232:235], a[172:175], a[228:231], v[232:235]
    ds_read_b128 a[220:223], v241 offset:35328
    v_cvt_pk_bf16_f32 v236, v236, v237
    v_mfma_f32_16x16x32_bf16 v[232:235], a[176:179], a[232:235], v[232:235]
    v_cvt_pk_bf16_f32 v237, v238, v239
    v_mul_f32 v228, s38, v228
    v_mfma_f32_16x16x32_bf16 v[232:235], a[180:183], a[236:239], v[232:235]
    ds_write_b64 v247, v[236:237] offset:24832
    v_mfma_f32_16x16x32_bf16 v[232:235], a[184:187], a[240:243], v[232:235]
    v_mul_f32 v229, s38, v229
    v_mul_f32 v230, s38, v230
    v_mfma_f32_16x16x32_bf16 v[232:235], a[188:191], a[244:247], v[232:235]
    v_mul_f32 v231, s38, v231
    v_cvt_pk_bf16_f32 v228, v228, v229
    v_mfma_f32_16x16x32_bf16 v[236:239], a[192:195], a[224:227], 0
    ds_read_b128 a[224:227], v240 offset:35456
    s_waitcnt lgkmcnt(3)
    v_mfma_f32_16x16x32_bf16 v[208:211], v[156:159], v[168:171], v[208:211]
    v_cvt_pk_bf16_f32 v229, v230, v231
    v_mfma_f32_16x16x32_bf16 v[208:211], v[158:161], v[170:173], v[208:211]
    ds_write_b64 v247, v[228:229] offset:30720
    v_mfma_f32_16x16x32_bf16 v[236:239], a[196:199], a[228:231], v[236:239]
    ds_read_b128 a[228:231], v241 offset:35456
    v_mul_f32 v232, s3, v232
    v_mfma_f32_16x16x32_bf16 v[236:239], a[200:203], a[232:235], v[236:239]
    ds_read_b128 a[232:235], v240 offset:35584
    v_mul_f32 v233, s3, v233
    v_mfma_f32_16x16x32_bf16 v[236:239], a[204:207], a[236:239], v[236:239]
    ds_read_b128 a[236:239], v241 offset:35584
    v_mul_f32 v234, s3, v234
    v_mfma_f32_16x16x32_bf16 v[236:239], a[208:211], a[240:243], v[236:239]
    v_mul_f32 v235, s3, v235
    v_cvt_pk_bf16_f32 v232, v232, v233
    v_mfma_f32_16x16x32_bf16 v[236:239], a[212:215], a[244:247], v[236:239]
    ds_read_b128 a[240:243], v242 offset:64512
    v_cvt_pk_bf16_f32 v233, v234, v235
    v_mfma_f32_16x16x32_bf16 v[228:231], a[0:3], a[216:219], 0
    s_waitcnt lgkmcnt(5)
    v_exp_f32 v196, v196
    v_mfma_f32_16x16x32_bf16 v[228:231], a[4:7], a[220:223], v[228:231]
    ds_write_b64 v247, v[232:233] offset:30848
    v_mfma_f32_16x16x32_bf16 v[228:231], a[8:11], a[224:227], v[228:231]
    v_exp_f32 v197, v197
    v_mfma_f32_16x16x32_bf16 v[232:235], a[24:27], a[216:219], 0
    s_waitcnt lgkmcnt(4)
    v_exp_f32 v198, v198
    v_mfma_f32_16x16x32_bf16 v[228:231], a[12:15], a[228:231], v[228:231]
    s_waitcnt lgkmcnt(3)
    v_exp_f32 v199, v199
    v_mfma_f32_16x16x32_bf16 v[228:231], a[16:19], a[232:235], v[228:231]
    s_waitcnt lgkmcnt(2)
    v_cvt_pk_bf16_f32 v194, v196, v197
    v_cvt_pk_bf16_f32 v181, v198, v199
    v_mfma_f32_16x16x32_bf16 v[228:231], a[20:23], a[236:239], v[228:231]
    ds_read_b128 v[196:199], v246 offset:64
    v_mul_f32 v236, s38, v236
    v_mfma_f32_16x16x32_bf16 v[232:235], a[28:31], a[220:223], v[232:235]
    v_mul_f32 v237, s38, v237
    v_mul_f32 v238, s38, v238
    v_mfma_f32_16x16x32_bf16 v[232:235], a[32:35], a[224:227], v[232:235]
    v_mul_f32 v239, s38, v239
    v_cvt_pk_bf16_f32 v236, v236, v237
    v_mfma_f32_16x16x32_bf16 v[232:235], a[36:39], a[228:231], v[232:235]
    v_cvt_pk_bf16_f32 v237, v238, v239
    v_cvt_pk_bf16_f32 v114, v228, v229
    v_mfma_f32_16x16x32_bf16 v[232:235], a[40:43], a[232:235], v[232:235]
    ds_write_b64 v247, v[236:237] offset:30976
    v_mfma_f32_16x16x32_bf16 v[232:235], a[44:47], a[236:239], v[232:235]
    ds_read_b128 a[244:247], v243 offset:64512
    v_cvt_pk_bf16_f32 v115, v230, v231
    v_mfma_f32_16x16x32_bf16 v[236:239], a[48:51], a[216:219], 0
    v_exp_f32 v200, v200
    v_mfma_f32_16x16x32_bf16 v[236:239], a[52:55], a[220:223], v[236:239]
    v_exp_f32 v201, v201
    v_mfma_f32_16x16x32_bf16 v[236:239], a[56:59], a[224:227], v[236:239]
    v_exp_f32 v202, v202
    v_mfma_f32_16x16x32_bf16 v[236:239], a[60:63], a[228:231], v[236:239]
    v_cvt_pk_bf16_f32 v116, v232, v233
    v_cvt_pk_bf16_f32 v117, v234, v235
    v_mfma_f32_16x16x32_bf16 v[236:239], a[64:67], a[232:235], v[236:239]
    s_waitcnt lgkmcnt(2)
    v_exp_f32 v203, v203
    v_mfma_f32_16x16x32_bf16 v[204:207], v[114:117], v[174:177], v[204:207]
    v_cvt_pk_bf16_f32 v192, v200, v201
    v_cvt_pk_bf16_f32 v195, v202, v203
    v_mfma_f32_16x16x32_bf16 v[196:199], v[114:117], v[168:171], v[196:199]
    ds_read_b128 v[200:203], v244 offset:128
    ds_read_b64 v[174:175], v247 offset:0
    v_mfma_f32_16x16x32_bf16 v[236:239], a[68:71], a[236:239], v[236:239]
    v_exp_f32 v208, v208
    v_mfma_f32_16x16x32_bf16 v[228:231], a[216:219], a[72:75], 0
    v_exp_f32 v209, v209
    v_mfma_f32_16x16x32_bf16 v[228:231], a[220:223], a[76:79], v[228:231]
    v_exp_f32 v210, v210
    v_mfma_f32_16x16x32_bf16 v[228:231], a[224:227], a[80:83], v[228:231]
    v_exp_f32 v211, v211
    v_mfma_f32_16x16x32_bf16 v[228:231], a[228:231], a[84:87], v[228:231]
    v_cvt_pk_bf16_f32 v118, v236, v237
    v_cvt_pk_bf16_f32 v119, v238, v239
    v_mfma_f32_16x16x32_bf16 v[228:231], a[232:235], a[88:91], v[228:231]
    v_cvt_pk_bf16_f32 v184, v208, v209
    v_cvt_pk_bf16_f32 v187, v210, v211
    v_mfma_f32_16x16x32_bf16 v[204:207], v[116:119], v[176:179], v[204:207]
    ds_read_b64 v[176:177], v247 offset:128
    ds_read_b64 v[178:179], v247 offset:256
    v_mfma_f32_16x16x32_bf16 v[196:199], v[116:119], v[170:173], v[196:199]
    s_waitcnt lgkmcnt(3)
    ds_read_b128 v[208:211], v246 offset:128
    v_mfma_f32_16x16x32_bf16 v[200:203], v[90:93], v[168:171], v[200:203]
    v_mfma_f32_16x16x32_bf16 v[200:203], v[92:95], v[170:173], v[200:203]
    v_mfma_f32_16x16x32_bf16 v[228:231], a[236:239], a[92:95], v[228:231]
    v_exp_f32 v204, v204
    v_mfma_f32_16x16x32_bf16 v[232:235], a[216:219], a[96:99], 0
    v_exp_f32 v205, v205
    v_mfma_f32_16x16x32_bf16 v[232:235], a[220:223], a[100:103], v[232:235]
    v_cvt_pk_bf16_f32 v188, v204, v205
    v_mfma_f32_16x16x32_bf16 v[232:235], a[224:227], a[104:107], v[232:235]
    ds_read_b128 v[204:207], v244 offset:64
    v_mfma_f32_16x16x32_bf16 v[224:227], a[248:251], v[188:191], v[224:227]
    v_cvt_pk_bf16_f32 v18, v228, v229
    v_cvt_pk_bf16_f32 v21, v230, v231
    v_mfma_f32_16x16x32_bf16 v[232:235], a[228:231], a[108:111], v[232:235]
    v_exp_f32 v196, v196
    v_mfma_f32_16x16x32_bf16 v[212:215], v[18:21], v[188:191], v[212:215]
    v_exp_f32 v197, v197
    v_mfma_f32_16x16x32_bf16 v[232:235], a[232:235], a[112:115], v[232:235]
    v_cvt_pk_bf16_f32 v182, v196, v197
    v_mfma_f32_16x16x32_bf16 v[232:235], a[236:239], a[116:119], v[232:235]
    v_rcp_f32 v225, v224
    v_mfma_f32_16x16x32_bf16 v[236:239], a[216:219], a[120:123], 0
    ds_read_b128 a[216:219], v242 offset:64640
    v_max3_f32 v248, v248, v224, v225
    v_mfma_f32_16x16x32_bf16 v[236:239], a[220:223], a[124:127], v[236:239]
    ds_read_b128 a[220:223], v243 offset:64640
    v_mul_f32 v212, v212, v225
    v_mfma_f32_16x16x32_bf16 v[236:239], a[224:227], a[128:131], v[236:239]
    v_cvt_pk_bf16_f32 v48, v232, v233
    v_cvt_pk_bf16_f32 v51, v234, v235
    v_mfma_f32_16x16x32_bf16 v[236:239], a[228:231], a[132:135], v[236:239]
    s_waitcnt lgkmcnt(2)
    ds_read_b128 a[224:227], v242 offset:64768
    v_mfma_f32_16x16x32_bf16 v[216:219], v[48:51], v[188:191], v[216:219]
    v_mul_f32 v213, v213, v225
    v_mul_f32 v214, v214, v225
    v_mfma_f32_16x16x32_bf16 v[204:207], v[132:135], v[168:171], v[204:207]
    v_mul_f32 v215, v215, v225
    v_cvt_pk_bf16_f32 v212, v212, v213
    v_mfma_f32_16x16x32_bf16 v[204:207], v[134:137], v[170:173], v[204:207]
    ds_read_b128 a[228:231], v243 offset:64768
    v_cvt_pk_bf16_f32 v213, v214, v215
    v_mfma_f32_16x16x32_bf16 v[236:239], a[232:235], a[136:139], v[236:239]
    ds_write_b64 v247, v[212:213] offset:12288
    v_mfma_f32_16x16x32_bf16 v[212:215], v[12:15], v[192:195], 0
    s_waitcnt vmcnt(0)
    v_mul_f32 v216, v216, v225
    v_mul_f32 v217, v217, v225
    v_mfma_f32_16x16x32_bf16 v[236:239], a[236:239], a[140:143], v[236:239]
    s_barrier
    v_mul_f32 v218, v218, v225
    v_mul_f32 v219, v219, v225
    v_mfma_f32_16x16x32_bf16 v[228:231], a[144:147], a[240:243], 0
    v_cvt_pk_bf16_f32 v216, v216, v217
    v_cvt_pk_bf16_f32 v217, v218, v219
    v_mfma_f32_16x16x32_bf16 v[228:231], a[148:151], a[244:247], v[228:231]
    s_waitcnt lgkmcnt(3)
    v_cvt_pk_bf16_f32 v78, v236, v237
    v_cvt_pk_bf16_f32 v81, v238, v239
    v_mfma_f32_16x16x32_bf16 v[228:231], a[152:155], a[216:219], v[228:231]
    ds_write_b64 v247, v[216:217] offset:12416
    v_mfma_f32_16x16x32_bf16 v[220:223], v[78:81], v[188:191], v[220:223]
    v_exp_f32 v204, v204
    v_mfma_f32_16x16x32_bf16 v[216:219], v[42:45], v[192:195], 0
    v_exp_f32 v205, v205
    v_mfma_f32_16x16x32_bf16 v[228:231], a[156:159], a[220:223], v[228:231]
    s_waitcnt lgkmcnt(2)
    v_cvt_pk_bf16_f32 v183, v204, v205
    v_add_u32 v242, 0xf000, v242
    v_mfma_f32_16x16x32_bf16 v[228:231], a[160:163], a[224:227], v[228:231]
    v_mul_f32 v220, v220, v225
    v_mul_f32 v221, v221, v225
    v_mfma_f32_16x16x32_bf16 v[212:215], v[16:19], v[180:183], v[212:215]
    v_mul_f32 v222, v222, v225
    v_mul_f32 v223, v223, v225
    v_mfma_f32_16x16x32_bf16 v[224:227], a[248:251], v[192:195], 0
    ds_read_b128 a[232:235], v242 offset:4608
    v_cvt_pk_bf16_f32 v220, v220, v221
    v_mfma_f32_16x16x32_bf16 v[216:219], v[46:49], v[180:183], v[216:219]
    v_add_u32 v243, 0xf000, v243
    v_cvt_pk_bf16_f32 v221, v222, v223
    v_mfma_f32_16x16x32_bf16 v[224:227], a[248:251], v[180:183], v[224:227]
    ds_read_b128 a[236:239], v243 offset:4608
    v_mfma_f32_16x16x32_bf16 v[228:231], a[164:167], a[228:231], v[228:231]
    ds_write_b64 v247, v[220:221] offset:12544
    v_mfma_f32_16x16x32_bf16 v[220:223], v[72:75], v[192:195], 0
    v_exp_f32 v206, v206
    v_mfma_f32_16x16x32_bf16 v[220:223], v[76:79], v[180:183], v[220:223]
    v_exp_f32 v207, v207
    v_mfma_f32_16x16x32_bf16 v[232:235], a[168:171], a[240:243], 0
    v_cvt_pk_bf16_f32 v186, v206, v207
    v_mfma_f32_16x16x32_bf16 v[232:235], a[172:175], a[244:247], v[232:235]
    v_mul_f32 v228, s38, v228
    v_mul_f32 v229, s38, v229
    v_mfma_f32_16x16x32_bf16 v[232:235], a[176:179], a[216:219], v[232:235]
    v_mul_f32 v230, s38, v230
    v_mul_f32 v231, s38, v231
    v_mfma_f32_16x16x32_bf16 v[232:235], a[180:183], a[220:223], v[232:235]
    ds_read_b128 v[204:207], v245 offset:128
    v_cvt_pk_bf16_f32 v228, v228, v229
    v_mfma_f32_16x16x32_bf16 v[232:235], a[184:187], a[224:227], v[232:235]
    v_cvt_pk_bf16_f32 v229, v230, v231
    v_mfma_f32_16x16x32_bf16 v[232:235], a[188:191], a[228:231], v[232:235]
    ds_write_b64 v247, v[228:229] offset:36864
    v_mfma_f32_16x16x32_bf16 v[236:239], a[192:195], a[240:243], 0
    ds_read_b128 a[240:243], v242 offset:4736
    s_waitcnt lgkmcnt(3)
    v_mfma_f32_16x16x32_bf16 v[236:239], a[196:199], a[244:247], v[236:239]
    ds_read_b128 a[244:247], v243 offset:4736
    v_mfma_f32_16x16x32_bf16 v[236:239], a[200:203], a[216:219], v[236:239]
    ds_read_b128 a[216:219], v242 offset:4864
    v_mul_f32 v232, s3, v232
    v_mfma_f32_16x16x32_bf16 v[236:239], a[204:207], a[220:223], v[236:239]
    ds_read_b128 a[220:223], v243 offset:4864
    v_mul_f32 v233, s3, v233
    v_mfma_f32_16x16x32_bf16 v[236:239], a[208:211], a[224:227], v[236:239]
    v_mul_f32 v234, s3, v234
    v_mul_f32 v235, s3, v235
    v_mfma_f32_16x16x32_bf16 v[236:239], a[212:215], a[228:231], v[236:239]
    s_waitcnt lgkmcnt(5)
    v_cvt_pk_bf16_f32 v232, v232, v233
    v_cvt_pk_bf16_f32 v233, v234, v235
    v_mfma_f32_16x16x32_bf16 v[204:207], v[96:99], v[168:171], v[204:207]
    ds_write_b64 v247, v[232:233] offset:36992
    v_mfma_f32_16x16x32_bf16 v[204:207], v[98:101], v[170:173], v[204:207]
    v_exp_f32 v198, v198
    v_mfma_f32_16x16x32_bf16 v[228:231], a[144:147], a[232:235], 0
    v_exp_f32 v199, v199
    v_mfma_f32_16x16x32_bf16 v[228:231], a[148:151], a[236:239], v[228:231]
    s_waitcnt lgkmcnt(3)
    v_cvt_pk_bf16_f32 v185, v198, v199
    v_mul_f32 v236, s38, v236
    v_mfma_f32_16x16x32_bf16 v[228:231], a[152:155], a[240:243], v[228:231]
    ds_read_b128 v[196:199], v244 offset:32
    v_mul_f32 v237, s38, v237
    v_mfma_f32_16x16x32_bf16 v[212:215], v[20:23], v[184:187], v[212:215]
    v_mul_f32 v238, s38, v238
    v_mul_f32 v239, s38, v239
    v_mfma_f32_16x16x32_bf16 v[216:219], v[50:53], v[184:187], v[216:219]
    v_cvt_pk_bf16_f32 v236, v236, v237
    v_cvt_pk_bf16_f32 v237, v238, v239
    v_mfma_f32_16x16x32_bf16 v[220:223], v[80:83], v[184:187], v[220:223]
    ds_write_b64 v247, v[236:237] offset:37120
    v_mfma_f32_16x16x32_bf16 v[224:227], a[248:251], v[184:187], v[224:227]
    v_exp_f32 v200, v200
    v_mfma_f32_16x16x32_bf16 v[228:231], a[156:159], a[244:247], v[228:231]
    s_waitcnt lgkmcnt(2)
    v_exp_f32 v201, v201
    v_mfma_f32_16x16x32_bf16 v[228:231], a[160:163], a[216:219], v[228:231]
    v_cvt_pk_bf16_f32 v189, v200, v201
    v_mfma_f32_16x16x32_bf16 v[228:231], a[164:167], a[220:223], v[228:231]
    ds_read_b128 v[200:203], v245 offset:32
    v_mfma_f32_16x16x32_bf16 v[232:235], a[168:171], a[232:235], 0
    s_waitcnt lgkmcnt(2)
    v_exp_f32 v204, v204
    v_mfma_f32_16x16x32_bf16 v[196:199], v[132:135], v[174:177], v[196:199]
    v_exp_f32 v205, v205
    v_mfma_f32_16x16x32_bf16 v[196:199], v[134:137], v[176:179], v[196:199]
    v_cvt_pk_bf16_f32 v190, v204, v205
    v_mul_f32 v228, s38, v228
    v_mfma_f32_16x16x32_bf16 v[232:235], a[172:175], a[236:239], v[232:235]
    v_mul_f32 v229, s38, v229
    v_mul_f32 v230, s38, v230
    v_mfma_f32_16x16x32_bf16 v[232:235], a[176:179], a[240:243], v[232:235]
    v_mul_f32 v231, s38, v231
    v_cvt_pk_bf16_f32 v228, v228, v229
    v_mfma_f32_16x16x32_bf16 v[232:235], a[180:183], a[244:247], v[232:235]
    ds_read_b128 v[204:207], v246 offset:32
    v_cvt_pk_bf16_f32 v229, v230, v231
    v_mfma_f32_16x16x32_bf16 v[232:235], a[184:187], a[216:219], v[232:235]
    ds_write_b64 v247, v[228:229] offset:43008
    v_mfma_f32_16x16x32_bf16 v[232:235], a[188:191], a[220:223], v[232:235]
    s_waitcnt lgkmcnt(2)
    v_mbcnt_lo_u32_b32 v228, -1, 0
    v_mbcnt_hi_u32_b32 v228, -1, v228
    v_mfma_f32_16x16x32_bf16 v[200:203], v[156:159], v[174:177], v[200:203]
    v_lshrrev_b32 v229, 4, v228
    v_bfe_u32 v230, v228, 2, 1
    v_mfma_f32_16x16x32_bf16 v[200:203], v[158:161], v[176:179], v[200:203]
    v_bfe_u32 v231, v228, 3, 1
    v_add_u32 v230, 15, v230
    v_mfma_f32_16x16x32_bf16 v[236:239], a[192:195], a[232:235], 0
    v_and_b32 v228, 3, v228
    v_and_b32 v230, 15, v230
    v_mfma_f32_16x16x32_bf16 v[236:239], a[196:199], a[236:239], v[236:239]
    v_lshl_add_u32 v228, v231, 2, v228
    v_add_u32 v228, 3, v228
    v_mfma_f32_16x16x32_bf16 v[236:239], a[200:203], a[240:243], v[236:239]
    v_and_b32 v231, 3, v230
    v_lshlrev_b32 v231, 1, v231
    v_mfma_f32_16x16x32_bf16 v[236:239], a[204:207], a[244:247], v[236:239]
    s_waitcnt lgkmcnt(1)
    v_bfe_u32 v243, v228, 1, 1
    v_or_b32 v231, v231, v243
    v_mfma_f32_16x16x32_bf16 v[204:207], v[114:117], v[174:177], v[204:207]
    v_mul_u32_u24 v230, 0x1e00, v230
    v_xor_b32 v231, v231, v229
    v_mfma_f32_16x16x32_bf16 v[204:207], v[116:119], v[176:179], v[204:207]
    v_lshl_add_u32 v230, v231, 4, v230
    v_mul_u32_u24 v231, 0x180, v228
    v_mfma_f32_16x16x32_bf16 v[236:239], a[208:211], a[216:219], v[236:239]
    v_add_u32 v242, v230, v231
    v_xor_b32 v243, 64, v242
    v_mfma_f32_16x16x32_bf16 v[236:239], a[212:215], a[220:223], v[236:239]
    ds_read_b128 a[224:227], v242 offset:0
    ds_read_b128 a[228:231], v243 offset:0
    ds_read_b128 a[232:235], v242 offset:128
    ds_read_b128 a[236:239], v243 offset:128
    ds_read_b128 a[240:243], v242 offset:256
    ds_read_b128 a[244:247], v243 offset:256
    v_mul_f32 v232, s3, v232
    v_mul_f32 v233, s3, v233
    v_mul_f32 v234, s3, v234
    v_mul_f32 v235, s3, v235
    v_cvt_pk_bf16_f32 v232, v232, v233
    v_cvt_pk_bf16_f32 v233, v234, v235
    ds_write_b64 v247, v[232:233] offset:43136
    v_mul_f32 v236, s38, v236
    v_mul_f32 v237, s38, v237
    v_mul_f32 v238, s38, v238
    v_mul_f32 v239, s38, v239
    v_cvt_pk_bf16_f32 v236, v236, v237
    v_cvt_pk_bf16_f32 v237, v238, v239
    ds_write_b64 v247, v[236:237] offset:43264
    ds_read_b128 a[216:219], v240 offset:36864
    ds_read_b128 a[220:223], v241 offset:36864
    s_waitcnt lgkmcnt(9)
    v_mfma_f32_16x16x32_bf16 v[232:235], a[144:147], a[224:227], 0
    v_exp_f32 v196, v196
    v_mfma_f32_16x16x32_bf16 v[236:239], a[168:171], a[224:227], 0
    s_waitcnt lgkmcnt(8)
    v_exp_f32 v197, v197
    v_mfma_f32_16x16x32_bf16 v[232:235], a[148:151], a[228:231], v[232:235]
    s_waitcnt lgkmcnt(7)
    v_exp_f32 v198, v198
    v_mfma_f32_16x16x32_bf16 v[232:235], a[152:155], a[232:235], v[232:235]
    s_waitcnt lgkmcnt(6)
    v_exp_f32 v199, v199
    v_mfma_f32_16x16x32_bf16 v[232:235], a[156:159], a[236:239], v[232:235]
    s_waitcnt lgkmcnt(5)
    v_cvt_pk_bf16_f32 v193, v196, v197
    v_cvt_pk_bf16_f32 v180, v198, v199
    v_mfma_f32_16x16x32_bf16 v[232:235], a[160:163], a[240:243], v[232:235]
    s_waitcnt lgkmcnt(4)
    ds_read_b128 v[196:199], v245 offset:96
    v_mfma_f32_16x16x32_bf16 v[232:235], a[164:167], a[244:247], v[232:235]
    v_exp_f32 v200, v200
    v_mfma_f32_16x16x32_bf16 v[236:239], a[172:175], a[228:231], v[236:239]
    v_exp_f32 v201, v201
    v_mfma_f32_16x16x32_bf16 v[236:239], a[176:179], a[232:235], v[236:239]
    v_exp_f32 v202, v202
    v_mfma_f32_16x16x32_bf16 v[236:239], a[180:183], a[236:239], v[236:239]
    v_exp_f32 v203, v203
    v_mfma_f32_16x16x32_bf16 v[236:239], a[184:187], a[240:243], v[236:239]
    v_mul_f32 v232, s38, v232
    v_mul_f32 v233, s38, v233
    v_mfma_f32_16x16x32_bf16 v[236:239], a[188:191], a[244:247], v[236:239]
    v_mul_f32 v234, s38, v234
    v_mul_f32 v235, s38, v235
    v_mfma_f32_16x16x32_bf16 v[228:231], a[192:195], a[224:227], 0
    ds_read_b128 a[224:227], v240 offset:36992
    v_cvt_pk_bf16_f32 v232, v232, v233
    v_mfma_f32_16x16x32_bf16 v[228:231], a[196:199], a[228:231], v[228:231]
    ds_read_b128 a[228:231], v241 offset:36992
    v_cvt_pk_bf16_f32 v233, v234, v235
    v_mfma_f32_16x16x32_bf16 v[228:231], a[200:203], a[232:235], v[228:231]
    ds_read_b128 a[232:235], v240 offset:37120
    v_mul_f32 v236, s3, v236
    v_mfma_f32_16x16x32_bf16 v[228:231], a[204:207], a[236:239], v[228:231]
    ds_read_b128 a[236:239], v241 offset:37120
    v_mul_f32 v237, s3, v237
    v_mfma_f32_16x16x32_bf16 v[228:231], a[208:211], a[240:243], v[228:231]
    ds_write_b64 v247, v[232:233] offset:49152
    v_mfma_f32_16x16x32_bf16 v[228:231], a[212:215], a[244:247], v[228:231]
    s_waitcnt lgkmcnt(5)
    v_mul_f32 v238, s3, v238
    v_mul_f32 v239, s3, v239
    v_mfma_f32_16x16x32_bf16 v[196:199], v[96:99], v[174:177], v[196:199]
    v_cvt_pk_bf16_f32 v236, v236, v237
    v_cvt_pk_bf16_f32 v237, v238, v239
    v_mfma_f32_16x16x32_bf16 v[196:199], v[98:101], v[176:179], v[196:199]
    ds_write_b64 v247, v[236:237] offset:49280
    v_mfma_f32_16x16x32_bf16 v[232:235], a[0:3], a[216:219], 0
    v_cvt_pk_bf16_f32 v194, v200, v201
    v_cvt_pk_bf16_f32 v181, v202, v203
    v_mfma_f32_16x16x32_bf16 v[232:235], a[4:7], a[220:223], v[232:235]
    s_waitcnt lgkmcnt(4)
    ds_read_b128 v[200:203], v246 offset:96
    v_mfma_f32_16x16x32_bf16 v[232:235], a[8:11], a[224:227], v[232:235]
    v_mul_f32 v228, s38, v228
    v_mul_f32 v229, s38, v229
    v_mfma_f32_16x16x32_bf16 v[232:235], a[12:15], a[228:231], v[232:235]
    s_waitcnt lgkmcnt(3)
    v_mul_f32 v230, s38, v230
    v_mul_f32 v231, s38, v231
    v_mfma_f32_16x16x32_bf16 v[232:235], a[16:19], a[232:235], v[232:235]
    ds_read_b128 a[240:243], v242 offset:3072
    v_cvt_pk_bf16_f32 v228, v228, v229
    v_mfma_f32_16x16x32_bf16 v[232:235], a[20:23], a[236:239], v[232:235]
    ds_read_b128 a[244:247], v243 offset:3072
    v_cvt_pk_bf16_f32 v229, v230, v231
    v_mfma_f32_16x16x32_bf16 v[236:239], a[24:27], a[216:219], 0
    ds_write_b64 v247, v[228:229] offset:49408
    v_mfma_f32_16x16x32_bf16 v[236:239], a[28:31], a[220:223], v[236:239]
    v_exp_f32 v204, v204
    v_mfma_f32_16x16x32_bf16 v[236:239], a[32:35], a[224:227], v[236:239]
    v_exp_f32 v205, v205
    v_mfma_f32_16x16x32_bf16 v[236:239], a[36:39], a[228:231], v[236:239]
    v_cvt_pk_bf16_f32 v120, v232, v233
    v_cvt_pk_bf16_f32 v121, v234, v235
    v_mfma_f32_16x16x32_bf16 v[236:239], a[40:43], a[232:235], v[236:239]
    v_exp_f32 v206, v206
    v_mfma_f32_16x16x32_bf16 v[236:239], a[44:47], a[236:239], v[236:239]
    v_exp_f32 v207, v207
    v_mfma_f32_16x16x32_bf16 v[228:231], a[48:51], a[216:219], 0
    v_cvt_pk_bf16_f32 v192, v204, v205
    v_cvt_pk_bf16_f32 v195, v206, v207
    v_mfma_f32_16x16x32_bf16 v[228:231], a[52:55], a[220:223], v[228:231]
    ds_read_b128 v[204:207], v244 offset:192
    v_add_u32 v240, 0xffff1000, v240
    v_mfma_f32_16x16x32_bf16 v[228:231], a[56:59], a[224:227], v[228:231]
    v_cvt_pk_bf16_f32 v122, v236, v237
    v_cvt_pk_bf16_f32 v123, v238, v239
    v_mfma_f32_16x16x32_bf16 v[228:231], a[60:63], a[228:231], v[228:231]
    s_waitcnt lgkmcnt(1)
    v_exp_f32 v196, v196
    v_mfma_f32_16x16x32_bf16 v[208:211], v[120:123], v[168:171], v[208:211]
    ds_read_b64 v[168:169], v247 offset:24576
    v_add_u32 v241, 0xffff1000, v241
    v_mfma_f32_16x16x32_bf16 v[200:203], v[120:123], v[174:177], v[200:203]
    v_exp_f32 v197, v197
    v_mfma_f32_16x16x32_bf16 v[228:231], a[64:67], a[232:235], v[228:231]
    v_exp_f32 v198, v198
    v_mfma_f32_16x16x32_bf16 v[228:231], a[68:71], a[236:239], v[228:231]
    v_exp_f32 v199, v199
    v_mfma_f32_16x16x32_bf16 v[232:235], a[216:219], a[72:75], 0
    v_cvt_pk_bf16_f32 v184, v196, v197
    v_cvt_pk_bf16_f32 v187, v198, v199
    v_mfma_f32_16x16x32_bf16 v[232:235], a[220:223], a[76:79], v[232:235]
    ds_read_b128 v[196:199], v246 offset:192
    v_mfma_f32_16x16x32_bf16 v[232:235], a[224:227], a[80:83], v[232:235]
    v_mfma_f32_16x16x32_bf16 v[232:235], a[228:231], a[84:87], v[232:235]
    v_cvt_pk_bf16_f32 v124, v228, v229
    v_cvt_pk_bf16_f32 v125, v230, v231
    v_mfma_f32_16x16x32_bf16 v[232:235], a[232:235], a[88:91], v[232:235]
    v_mfma_f32_16x16x32_bf16 v[232:235], a[236:239], a[92:95], v[232:235]
    v_mfma_f32_16x16x32_bf16 v[208:211], v[122:125], v[170:173], v[208:211]
    ds_read_b64 v[170:171], v247 offset:24704
    ds_read_b64 v[172:173], v247 offset:24832
    v_mfma_f32_16x16x32_bf16 v[200:203], v[122:125], v[176:179], v[200:203]
    v_mfma_f32_16x16x32_bf16 v[236:239], a[216:219], a[96:99], 0
    v_mfma_f32_16x16x32_bf16 v[236:239], a[220:223], a[100:103], v[236:239]
    v_mfma_f32_16x16x32_bf16 v[236:239], a[224:227], a[104:107], v[236:239]
    v_mfma_f32_16x16x32_bf16 v[236:239], a[228:231], a[108:111], v[236:239]
    v_cvt_pk_bf16_f32 v24, v232, v233
    v_cvt_pk_bf16_f32 v27, v234, v235
    v_mfma_f32_16x16x32_bf16 v[236:239], a[232:235], a[112:115], v[236:239]
    v_exp_f32 v208, v208
    v_mfma_f32_16x16x32_bf16 v[236:239], a[236:239], a[116:119], v[236:239]
    v_exp_f32 v209, v209
    v_mfma_f32_16x16x32_bf16 v[228:231], a[216:219], a[120:123], 0
    ds_read_b128 a[216:219], v242 offset:3200
    v_cvt_pk_bf16_f32 v188, v208, v209
    v_mfma_f32_16x16x32_bf16 v[228:231], a[220:223], a[124:127], v[228:231]
    ds_read_b128 v[208:211], v244 offset:96
    s_waitcnt lgkmcnt(2)
    v_mfma_f32_16x16x32_bf16 v[212:215], v[24:27], v[188:191], v[212:215]
    v_cvt_pk_bf16_f32 v54, v236, v237
    v_cvt_pk_bf16_f32 v57, v238, v239
    v_mfma_f32_16x16x32_bf16 v[224:227], a[248:251], v[188:191], v[224:227]
    ds_read_b128 a[220:223], v243 offset:3200
    v_mbcnt_lo_u32_b32 v232, -1, 0
    v_mfma_f32_16x16x32_bf16 v[216:219], v[54:57], v[188:191], v[216:219]
    v_mbcnt_hi_u32_b32 v232, -1, v232
    v_lshrrev_b32 v233, 1, v232
    v_mfma_f32_16x16x32_bf16 v[204:207], v[138:141], v[168:171], v[204:207]
    v_add_u32 v233, 64, v233
    v_mul_u32_u24 v234, 43, v233
    v_mfma_f32_16x16x32_bf16 v[204:207], v[140:143], v[170:173], v[204:207]
    v_rcp_f32 v225, v224
    v_mfma_f32_16x16x32_bf16 v[228:231], a[224:227], a[128:131], v[228:231]
    v_mul_f32 v212, v212, v225
    v_mul_f32 v213, v213, v225
    v_mfma_f32_16x16x32_bf16 v[228:231], a[228:231], a[132:135], v[228:231]
    v_mul_f32 v214, v214, v225
    v_mul_f32 v215, v215, v225
    v_mfma_f32_16x16x32_bf16 v[228:231], a[232:235], a[136:139], v[228:231]
    ds_read_b128 a[224:227], v242 offset:3328
    s_waitcnt lgkmcnt(2)
    v_mfma_f32_16x16x32_bf16 v[208:211], v[90:93], v[174:177], v[208:211]
    ds_read_b128 a[228:231], v243 offset:3328
    v_cvt_pk_bf16_f32 v212, v212, v213
    v_mfma_f32_16x16x32_bf16 v[208:211], v[92:95], v[176:179], v[208:211]
    v_cvt_pk_bf16_f32 v213, v214, v215
    v_lshrrev_b32 v235, 8, v234
    v_mfma_f32_16x16x32_bf16 v[228:231], a[236:239], a[140:143], v[228:231]
    ds_write_b64 v247, v[212:213] offset:18432
    v_mfma_f32_16x16x32_bf16 v[212:215], v[18:21], v[192:195], 0
    ds_read_b128 a[232:235], v240 offset:0
    v_lshrrev_b32 v234, 7, v234
    v_mfma_f32_16x16x32_bf16 v[236:239], a[144:147], a[240:243], 0
    v_mad_i32_i24 v233, v234, -3, v233
    v_and_b32 v235, 4, v235
    v_mfma_f32_16x16x32_bf16 v[236:239], a[148:151], a[244:247], v[236:239]
    v_cvt_pk_bf16_f32 v84, v228, v229
    v_cvt_pk_bf16_f32 v87, v230, v231
    v_mfma_f32_16x16x32_bf16 v[236:239], a[152:155], a[216:219], v[236:239]
    s_waitcnt lgkmcnt(4)
    v_xor_b32 v234, v234, v235
    v_and_b32 v235, 4, v234
    v_mfma_f32_16x16x32_bf16 v[220:223], v[84:87], v[188:191], v[220:223]
    ds_read_b128 a[236:239], v241 offset:0
    v_mul_u32_u24 v251, 24, v235
    v_mfma_f32_16x16x32_bf16 v[236:239], a[156:159], a[220:223], v[236:239]
    s_waitcnt lgkmcnt(3)
    s_barrier
    v_lshrrev_b32 v235, 3, v234
    v_mfma_f32_16x16x32_bf16 v[236:239], a[160:163], a[224:227], v[236:239]
    buffer_load_dwordx4 v252, s[12:15], s62 offen lds
    v_lshl_add_u32 v251, v235, 2, v251
    v_mfma_f32_16x16x32_bf16 v[236:239], a[164:167], a[228:231], v[236:239]
    v_and_or_b32 v251, v234, 3, v251
    v_mad_u32_u24 v251, v251, 3, v233
    v_mfma_f32_16x16x32_bf16 v[228:231], a[168:171], a[240:243], 0
    v_and_b32 v235, 1, v232
    v_lshl_add_u32 v251, v251, 3, v235
    v_mfma_f32_16x16x32_bf16 v[228:231], a[172:175], a[244:247], v[228:231]
    v_lshlrev_b32 v251, 4, v251
    v_add_u32 v251, 0xfffff800, v251
    v_mfma_f32_16x16x32_bf16 v[228:231], a[176:179], a[216:219], v[228:231]
    buffer_load_dwordx4 v253, s[12:15], s62 offen offset:1024 lds
    v_mul_f32 v236, s38, v236
    v_mfma_f32_16x16x32_bf16 v[228:231], a[180:183], a[220:223], v[228:231]
    v_mul_f32 v237, s38, v237
    v_mul_f32 v238, s38, v238
    v_mfma_f32_16x16x32_bf16 v[228:231], a[184:187], a[224:227], v[228:231]
    v_mul_f32 v239, s38, v239
    v_cvt_pk_bf16_f32 v236, v236, v237
    v_mfma_f32_16x16x32_bf16 v[228:231], a[188:191], a[228:231], v[228:231]
    v_cvt_pk_bf16_f32 v237, v238, v239
    v_mul_f32 v216, v216, v225
    v_mfma_f32_16x16x32_bf16 v[232:235], a[192:195], a[240:243], 0
    ds_read_b128 a[240:243], v240 offset:128
    buffer_load_dwordx4 v251, s[12:15], s62 offen offset:2048 lds
    v_mfma_f32_16x16x32_bf16 v[232:235], a[196:199], a[244:247], v[232:235]
    ds_read_b128 a[244:247], v241 offset:128
    s_add_u32 m0, s46, 0x17400
    v_mfma_f32_16x16x32_bf16 v[232:235], a[200:203], a[216:219], v[232:235]
    ds_read_b128 a[216:219], v240 offset:256
    v_mul_f32 v228, s3, v228
    v_mfma_f32_16x16x32_bf16 v[232:235], a[204:207], a[220:223], v[232:235]
    ds_write_b64 v247, v[236:237] offset:55296
    v_mfma_f32_16x16x32_bf16 v[232:235], a[208:211], a[224:227], v[232:235]
    s_waitcnt lgkmcnt(4)
    ds_read_b128 a[220:223], v241 offset:256
    v_mfma_f32_16x16x32_bf16 v[232:235], a[212:215], a[228:231], v[232:235]
    s_lshl_b32 s62, s28, 5
    v_mul_f32 v229, s3, v229
    v_mul_f32 v230, s3, v230
    v_mfma_f32_16x16x32_bf16 v[236:239], a[0:3], a[232:235], 0
    s_add_u32 s62, s62, 0x3000
    v_mul_f32 v231, s3, v231
    v_cvt_pk_bf16_f32 v228, v228, v229
    v_mfma_f32_16x16x32_bf16 v[236:239], a[4:7], a[236:239], v[236:239]
    v_cvt_pk_bf16_f32 v229, v230, v231
    ds_write_b64 v247, v[228:229] offset:55424
    v_mfma_f32_16x16x32_bf16 v[228:231], a[24:27], a[232:235], 0
    s_waitcnt lgkmcnt(4)
    buffer_load_dwordx4 v252, s[12:15], s63 offen lds
    v_mfma_f32_16x16x32_bf16 v[236:239], a[8:11], a[240:243], v[236:239]
    v_mul_f32 v217, v217, v225
    v_mul_f32 v218, v218, v225
    v_mfma_f32_16x16x32_bf16 v[236:239], a[12:15], a[244:247], v[236:239]
    s_waitcnt lgkmcnt(3)
    v_mul_f32 v219, v219, v225
    v_cvt_pk_bf16_f32 v216, v216, v217
    v_mfma_f32_16x16x32_bf16 v[236:239], a[16:19], a[216:219], v[236:239]
    v_cvt_pk_bf16_f32 v217, v218, v219
    s_waitcnt lgkmcnt(1)
    v_mfma_f32_16x16x32_bf16 v[236:239], a[20:23], a[220:223], v[236:239]
    ds_write_b64 v247, v[216:217] offset:18560
    v_mfma_f32_16x16x32_bf16 v[216:219], v[48:51], v[192:195], 0
    buffer_load_dwordx4 v253, s[12:15], s63 offen offset:1024 lds
    v_max3_f32 v248, v248, v224, v225
    v_mfma_f32_16x16x32_bf16 v[228:231], a[28:31], a[236:239], v[228:231]
    v_mul_f32 v220, v220, v225
    v_mul_f32 v221, v221, v225
    v_mfma_f32_16x16x32_bf16 v[228:231], a[32:35], a[240:243], v[228:231]
    v_mul_f32 v222, v222, v225
    v_mul_f32 v223, v223, v225
    v_mfma_f32_16x16x32_bf16 v[224:227], a[248:251], v[192:195], 0
    v_cvt_pk_bf16_f32 v220, v220, v221
    v_cvt_pk_bf16_f32 v221, v222, v223
    v_mfma_f32_16x16x32_bf16 v[228:231], a[36:39], a[244:247], v[228:231]
    ds_write_b64 v247, v[220:221] offset:18688
    v_mfma_f32_16x16x32_bf16 v[220:223], v[78:81], v[192:195], 0
    buffer_load_dwordx4 v251, s[12:15], s63 offen offset:2048 lds
    v_mul_f32 v232, s38, v232
    v_mfma_f32_16x16x32_bf16 v[228:231], a[40:43], a[216:219], v[228:231]
    s_add_u32 m0, s46, 0x16800
    v_mul_f32 v233, s38, v233
    v_mul_f32 v234, s38, v234
    v_mfma_f32_16x16x32_bf16 v[228:231], a[44:47], a[220:223], v[228:231]
    v_mul_f32 v235, s38, v235
    v_cvt_pk_bf16_f32 v232, v232, v233
    v_cvt_pk_bf16_f32 v233, v234, v235
    ds_write_b64 v247, v[232:233] offset:55552
    v_mfma_f32_16x16x32_bf16 v[232:235], a[48:51], a[232:235], 0
    s_lshl_b32 s63, s28, 5
    v_cvt_pk_bf16_f32 v126, v236, v237
    v_cvt_pk_bf16_f32 v127, v238, v239
    v_mfma_f32_16x16x32_bf16 v[232:235], a[52:55], a[236:239], v[232:235]
    s_add_u32 s63, s63, 0x7800
    v_exp_f32 v208, v208
    v_mfma_f32_16x16x32_bf16 v[232:235], a[56:59], a[240:243], v[232:235]
    v_exp_f32 v209, v209
    v_mfma_f32_16x16x32_bf16 v[232:235], a[60:63], a[244:247], v[232:235]
    v_exp_f32 v210, v210
    v_mfma_f32_16x16x32_bf16 v[232:235], a[64:67], a[216:219], v[232:235]
    v_exp_f32 v211, v211
    v_mfma_f32_16x16x32_bf16 v[232:235], a[68:71], a[220:223], v[232:235]
    v_cvt_pk_bf16_f32 v183, v208, v209
    v_cvt_pk_bf16_f32 v186, v210, v211
    v_mfma_f32_16x16x32_bf16 v[236:239], a[232:235], a[72:75], 0
    v_exp_f32 v200, v200
    v_mfma_f32_16x16x32_bf16 v[236:239], a[236:239], a[76:79], v[236:239]
    v_exp_f32 v201, v201
    v_mfma_f32_16x16x32_bf16 v[236:239], a[240:243], a[80:83], v[236:239]
    ds_read_b128 v[208:211], v245 offset:192
    v_cvt_pk_bf16_f32 v182, v200, v201
    v_mfma_f32_16x16x32_bf16 v[236:239], a[244:247], a[84:87], v[236:239]
    v_exp_f32 v202, v202
    v_mfma_f32_16x16x32_bf16 v[212:215], v[22:25], v[180:183], v[212:215]
    v_exp_f32 v203, v203
    v_mfma_f32_16x16x32_bf16 v[216:219], v[52:55], v[180:183], v[216:219]
    v_cvt_pk_bf16_f32 v185, v202, v203
    v_cvt_pk_bf16_f32 v128, v228, v229
    v_mfma_f32_16x16x32_bf16 v[220:223], v[82:85], v[180:183], v[220:223]
    ds_read_b128 v[200:203], v244 offset:256
    v_cvt_pk_bf16_f32 v129, v230, v231
    v_mfma_f32_16x16x32_bf16 v[224:227], a[248:251], v[180:183], v[224:227]
    v_exp_f32 v204, v204
    v_mfma_f32_16x16x32_bf16 v[212:215], v[26:29], v[184:187], v[212:215]
    v_exp_f32 v205, v205
    v_mfma_f32_16x16x32_bf16 v[216:219], v[56:59], v[184:187], v[216:219]
    v_exp_f32 v206, v206
    v_mfma_f32_16x16x32_bf16 v[220:223], v[86:89], v[184:187], v[220:223]
    v_exp_f32 v207, v207
    v_mfma_f32_16x16x32_bf16 v[224:227], a[248:251], v[184:187], v[224:227]
    s_waitcnt lgkmcnt(1)
    v_cvt_pk_bf16_f32 v190, v204, v205
    v_cvt_pk_bf16_f32 v193, v206, v207
    v_mfma_f32_16x16x32_bf16 v[208:211], v[102:105], v[168:171], v[208:211]
    ds_read_b128 v[204:207], v245 offset:256
    v_cvt_pk_bf16_f32 v130, v232, v233
    v_mfma_f32_16x16x32_bf16 v[208:211], v[104:107], v[170:173], v[208:211]
    ds_read_b128 a[224:227], v240 offset:1536
    v_cvt_pk_bf16_f32 v131, v234, v235
    v_mfma_f32_16x16x32_bf16 v[196:199], v[126:129], v[168:171], v[196:199]
    ds_read_b128 a[228:231], v241 offset:1536
    s_waitcnt lgkmcnt(3)
    v_mfma_f32_16x16x32_bf16 v[196:199], v[128:131], v[170:173], v[196:199]
    ds_read_b64 v[174:175], v247 offset:30720
    v_mbcnt_lo_u32_b32 v226, -1, 0
    v_mfma_f32_16x16x32_bf16 v[200:203], v[144:147], v[168:171], v[200:203]
    v_exp_f32 v208, v208
    v_mfma_f32_16x16x32_bf16 v[200:203], v[146:149], v[170:173], v[200:203]
    v_exp_f32 v209, v209
    v_mfma_f32_16x16x32_bf16 v[236:239], a[216:219], a[88:91], v[236:239]
    v_exp_f32 v210, v210
    v_mfma_f32_16x16x32_bf16 v[236:239], a[220:223], a[92:95], v[236:239]
    v_exp_f32 v211, v211
    v_mfma_f32_16x16x32_bf16 v[228:231], a[232:235], a[96:99], 0
    v_cvt_pk_bf16_f32 v188, v208, v209
    s_waitcnt vmcnt(3) lgkmcnt(3)
    v_mfma_f32_16x16x32_bf16 v[204:207], v[108:111], v[168:171], v[204:207]
    ds_read_b64_tr_b16 a[144:145], v249 offset:0
    ds_read_b64_tr_b16 a[146:147], v250 offset:0
    v_mfma_f32_16x16x32_bf16 v[204:207], v[110:113], v[170:173], v[204:207]
    v_cvt_pk_bf16_f32 v1, v236, v237
    v_cvt_pk_bf16_f32 v4, v238, v239
    v_mfma_f32_16x16x32_bf16 v[228:231], a[236:239], a[100:103], v[228:231]
    s_waitcnt lgkmcnt(3)
    ds_read_b64_tr_b16 a[168:169], v249 offset:32
    v_mfma_f32_16x16x32_bf16 v[228:231], a[240:243], a[104:107], v[228:231]
    ds_read_b64_tr_b16 a[170:171], v250 offset:32
    ds_read_b64_tr_b16 a[192:193], v249 offset:64
    v_mfma_f32_16x16x32_bf16 v[228:231], a[244:247], a[108:111], v[228:231]
    ds_read_b64_tr_b16 a[194:195], v250 offset:64
    v_cvt_pk_bf16_f32 v191, v210, v211
    v_mfma_f32_16x16x32_bf16 v[228:231], a[216:219], a[112:115], v[228:231]
    ds_read_b128 v[208:211], v246 offset:256
    v_mbcnt_hi_u32_b32 v226, -1, v226
    v_mfma_f32_16x16x32_bf16 v[228:231], a[220:223], a[116:119], v[228:231]
    v_exp_f32 v196, v196
    v_mfma_f32_16x16x32_bf16 v[232:235], a[232:235], a[120:123], 0
    ds_read_b128 a[232:235], v240 offset:1664
    v_and_b32 v226, 2, v226
    v_mfma_f32_16x16x32_bf16 v[232:235], a[236:239], a[124:127], v[232:235]
    ds_read_b128 a[236:239], v241 offset:1664
    v_cmp_eq_u32 vcc, 2, v226
    v_mfma_f32_16x16x32_bf16 v[232:235], a[240:243], a[128:131], v[232:235]
    ds_read_b128 a[240:243], v240 offset:1792
    v_cvt_pk_bf16_f32 v31, v228, v229
    v_mfma_f32_16x16x32_bf16 v[232:235], a[244:247], a[132:135], v[232:235]
    ds_read_b128 a[244:247], v241 offset:1792
    v_cvt_pk_bf16_f32 v34, v230, v231
    v_mfma_f32_16x16x32_bf16 v[232:235], a[216:219], a[136:139], v[232:235]
    v_exp_f32 v197, v197
    v_mfma_f32_16x16x32_bf16 v[232:235], a[220:223], a[140:143], v[232:235]
    v_exp_f32 v198, v198
    v_mfma_f32_16x16x32_bf16 v[236:239], a[0:3], a[224:227], 0
    s_waitcnt lgkmcnt(5)
    v_exp_f32 v199, v199
    v_mfma_f32_16x16x32_bf16 v[236:239], a[4:7], a[228:231], v[236:239]
    v_cvt_pk_bf16_f32 v189, v196, v197
    v_cvt_pk_bf16_f32 v192, v198, v199
    v_mfma_f32_16x16x32_bf16 v[228:231], a[24:27], a[224:227], 0
    ds_read_b128 v[196:199], v244 offset:320
    s_waitcnt lgkmcnt(4)
    v_mfma_f32_16x16x32_bf16 v[236:239], a[8:11], a[232:235], v[236:239]
    buffer_load_dwordx4 v252, s[12:15], s60 offen lds
    s_waitcnt lgkmcnt(3)
    v_mfma_f32_16x16x32_bf16 v[236:239], a[12:15], a[236:239], v[236:239]
    v_cvt_pk_bf16_f32 v61, v232, v233
    s_waitcnt lgkmcnt(2)
    v_mfma_f32_16x16x32_bf16 v[236:239], a[16:19], a[240:243], v[236:239]
    v_cvt_pk_bf16_f32 v64, v234, v235
    s_waitcnt vmcnt(1) lgkmcnt(1)
    v_mfma_f32_16x16x32_bf16 v[236:239], a[20:23], a[244:247], v[236:239]
    ds_read_b64_tr_b16 a[148:149], v249 offset:3072
    ds_read_b64_tr_b16 a[150:151], v250 offset:3072
    v_mfma_f32_16x16x32_bf16 v[228:231], a[28:31], a[228:231], v[228:231]
    ds_read_b64_tr_b16 a[172:173], v249 offset:3104
    ds_read_b64_tr_b16 a[174:175], v250 offset:3104
    v_mfma_f32_16x16x32_bf16 v[228:231], a[32:35], a[232:235], v[228:231]
    ds_read_b64_tr_b16 a[196:197], v249 offset:3136
    ds_read_b64_tr_b16 a[198:199], v250 offset:3136
    v_mfma_f32_16x16x32_bf16 v[228:231], a[36:39], a[236:239], v[228:231]
    v_cvt_pk_bf16_f32 v132, v236, v237
    v_cvt_pk_bf16_f32 v133, v238, v239
    v_mfma_f32_16x16x32_bf16 v[228:231], a[40:43], a[240:243], v[228:231]
    buffer_load_dwordx4 v253, s[12:15], s60 offen offset:1024 lds
    s_waitcnt lgkmcnt(6)
    v_mfma_f32_16x16x32_bf16 v[196:199], v[150:153], v[168:171], v[196:199]
    v_rcp_f32 v225, v224
    v_mfma_f32_16x16x32_bf16 v[196:199], v[152:155], v[170:173], v[196:199]
    v_add_u32 v226, 0xfffdd200, v247
    v_mul_f32 v212, v212, v225
    v_mfma_f32_16x16x32_bf16 v[228:231], a[44:47], a[244:247], v[228:231]
    v_mul_f32 v213, v213, v225
    v_cndmask_b32 v226, 0, v226, vcc
    v_mfma_f32_16x16x32_bf16 v[232:235], a[48:51], a[224:227], 0
    v_mul_f32 v214, v214, v225
    v_mul_f32 v215, v215, v225
    v_mfma_f32_16x16x32_bf16 v[232:235], a[52:55], a[228:231], v[232:235]
    v_cvt_pk_bf16_f32 v212, v212, v213
    v_add_u32 v226, 0x22e00, v226
    v_mfma_f32_16x16x32_bf16 v[232:235], a[56:59], a[232:235], v[232:235]
    v_cvt_pk_bf16_f32 v134, v228, v229
    v_cvt_pk_bf16_f32 v135, v230, v231
    v_mfma_f32_16x16x32_bf16 v[232:235], a[60:63], a[236:239], v[232:235]
    buffer_load_dwordx4 v251, s[12:15], s60 offen offset:2048 lds
    v_cvt_pk_bf16_f32 v213, v214, v215
    v_mfma_f32_16x16x32_bf16 v[208:211], v[132:135], v[168:171], v[208:211]
    ds_write_b64 v226, v[212:213] offset:0
    v_mfma_f32_16x16x32_bf16 v[212:215], v[0:3], v[188:191], 0
    s_add_u32 m0, s46, 0x17400
    v_mul_f32 v216, v216, v225
    v_mul_f32 v217, v217, v225
    v_mfma_f32_16x16x32_bf16 v[232:235], a[64:67], a[240:243], v[232:235]
    s_waitcnt lgkmcnt(1)
    v_mul_f32 v218, v218, v225
    v_mul_f32 v219, v219, v225
    v_mfma_f32_16x16x32_bf16 v[232:235], a[68:71], a[244:247], v[232:235]
    buffer_load_dwordx4 v252, s[12:15], s61 offen lds
    v_cvt_pk_bf16_f32 v216, v216, v217
    v_mfma_f32_16x16x32_bf16 v[236:239], a[224:227], a[72:75], 0
    v_cvt_pk_bf16_f32 v217, v218, v219
    v_mul_f32 v220, v220, v225
    v_mfma_f32_16x16x32_bf16 v[236:239], a[228:231], a[76:79], v[236:239]
    ds_write_b64 v226, v[216:217] offset:128
    v_mfma_f32_16x16x32_bf16 v[216:219], v[30:33], v[188:191], 0
    v_cvt_pk_bf16_f32 v136, v232, v233
    v_cvt_pk_bf16_f32 v137, v234, v235
    v_mfma_f32_16x16x32_bf16 v[236:239], a[232:235], a[80:83], v[236:239]
    buffer_load_dwordx4 v253, s[12:15], s61 offen offset:1024 lds
    v_mul_f32 v221, v221, v225
    v_mfma_f32_16x16x32_bf16 v[208:211], v[134:137], v[170:173], v[208:211]
    v_mul_f32 v222, v222, v225
    v_mul_f32 v223, v223, v225
    v_mfma_f32_16x16x32_bf16 v[236:239], a[236:239], a[84:87], v[236:239]
    v_cvt_pk_bf16_f32 v220, v220, v221
    v_cvt_pk_bf16_f32 v221, v222, v223
    v_mfma_f32_16x16x32_bf16 v[236:239], a[240:243], a[88:91], v[236:239]
    ds_write_b64 v226, v[220:221] offset:256
    v_mfma_f32_16x16x32_bf16 v[220:223], v[60:63], v[188:191], 0
    buffer_load_dwordx4 v251, s[12:15], s61 offen offset:2048 lds
    v_max3_f32 v248, v248, v224, v225
    v_mfma_f32_16x16x32_bf16 v[224:227], a[248:251], v[188:191], 0
    ds_read_b128 a[216:219], v240 offset:3072
    ds_read_b128 a[220:223], v241 offset:3072
    v_mfma_f32_16x16x32_bf16 v[236:239], a[244:247], a[92:95], v[236:239]
    s_add_u32 m0, s46, 0x16800
    v_exp_f32 v200, v200
    v_mfma_f32_16x16x32_bf16 v[228:231], a[224:227], a[96:99], 0
    v_exp_f32 v201, v201
    v_mfma_f32_16x16x32_bf16 v[228:231], a[228:231], a[100:103], v[228:231]
    v_exp_f32 v202, v202
    v_mfma_f32_16x16x32_bf16 v[228:231], a[232:235], a[104:107], v[228:231]
    v_exp_f32 v203, v203
    v_mfma_f32_16x16x32_bf16 v[228:231], a[236:239], a[108:111], v[228:231]
    v_cvt_pk_bf16_f32 v180, v200, v201
    v_cvt_pk_bf16_f32 v183, v202, v203
    v_mfma_f32_16x16x32_bf16 v[228:231], a[240:243], a[112:115], v[228:231]
    ds_read_b128 v[200:203], v245 offset:320
    v_cvt_pk_bf16_f32 v7, v236, v237
    v_mfma_f32_16x16x32_bf16 v[228:231], a[244:247], a[116:119], v[228:231]
    ds_read_b64 v[176:177], v247 offset:30848
    v_cvt_pk_bf16_f32 v10, v238, v239
    v_mfma_f32_16x16x32_bf16 v[232:235], a[224:227], a[120:123], 0
    ds_read_b128 a[224:227], v240 offset:3200
    s_waitcnt lgkmcnt(4)
    v_mfma_f32_16x16x32_bf16 v[232:235], a[228:231], a[124:127], v[232:235]
    ds_read_b128 a[228:231], v241 offset:3200
    ds_read_b64 v[178:179], v247 offset:30976
    v_mfma_f32_16x16x32_bf16 v[232:235], a[232:235], a[128:131], v[232:235]
    v_exp_f32 v204, v204
    v_mfma_f32_16x16x32_bf16 v[232:235], a[236:239], a[132:135], v[232:235]
    v_exp_f32 v205, v205
    v_mfma_f32_16x16x32_bf16 v[232:235], a[240:243], a[136:139], v[232:235]
    v_exp_f32 v208, v208
    v_mfma_f32_16x16x32_bf16 v[232:235], a[244:247], a[140:143], v[232:235]
    v_exp_f32 v209, v209
    v_mfma_f32_16x16x32_bf16 v[236:239], a[0:3], a[216:219], 0
    s_waitcnt lgkmcnt(5)
    v_cvt_pk_bf16_f32 v194, v204, v205
    v_cvt_pk_bf16_f32 v195, v208, v209
    v_mfma_f32_16x16x32_bf16 v[236:239], a[4:7], a[220:223], v[236:239]
    s_waitcnt lgkmcnt(4)
    v_cvt_pk_bf16_f32 v37, v228, v229
    v_cvt_pk_bf16_f32 v67, v232, v233
    v_mfma_f32_16x16x32_bf16 v[212:215], v[4:7], v[192:195], v[212:215]
    ds_read_b128 a[232:235], v240 offset:3328
    ds_read_b128 a[236:239], v241 offset:3328
    v_mfma_f32_16x16x32_bf16 v[216:219], v[34:37], v[192:195], v[216:219]
    s_waitcnt lgkmcnt(3)
    v_exp_f32 v210, v210
    v_mfma_f32_16x16x32_bf16 v[220:223], v[64:67], v[192:195], v[220:223]
    v_exp_f32 v211, v211
    v_mfma_f32_16x16x32_bf16 v[224:227], a[248:251], v[192:195], v[224:227]
    v_cvt_pk_bf16_f32 v182, v210, v211
    v_cvt_pk_bf16_f32 v40, v230, v231
    v_mfma_f32_16x16x32_bf16 v[200:203], v[162:165], v[168:171], v[200:203]
    ds_read_b128 v[208:211], v244 offset:0
    v_cvt_pk_bf16_f32 v70, v234, v235
    v_mfma_f32_16x16x32_bf16 v[200:203], v[164:167], v[170:173], v[200:203]
    v_exp_f32 v206, v206
    v_mfma_f32_16x16x32_bf16 v[236:239], a[8:11], a[224:227], v[236:239]
    v_exp_f32 v207, v207
    v_mfma_f32_16x16x32_bf16 v[236:239], a[12:15], a[228:231], v[236:239]
    v_cvt_pk_bf16_f32 v181, v206, v207
    v_mov_b32 v187, 0
    v_mfma_f32_16x16x32_bf16 v[228:231], a[24:27], a[216:219], 0
    v_exp_f32 v196, v196
    v_mfma_f32_16x16x32_bf16 v[212:215], v[8:11], v[180:183], v[212:215]
    s_waitcnt lgkmcnt(2)
    v_exp_f32 v197, v197
    v_mfma_f32_16x16x32_bf16 v[216:219], v[38:41], v[180:183], v[216:219]
    ds_read_b128 v[204:207], v246 offset:320
    v_cvt_pk_bf16_f32 v186, v196, v197
    v_mfma_f32_16x16x32_bf16 v[220:223], v[68:71], v[180:183], v[220:223]
    ds_read_b128 v[196:199], v245 offset:0
    ds_read_b128 a[240:243], v240 offset:4608
    v_mfma_f32_16x16x32_bf16 v[224:227], a[248:251], v[180:183], v[224:227]
    v_exp_f32 v200, v200
    v_mfma_f32_16x16x32_bf16 v[236:239], a[16:19], a[232:235], v[236:239]
    s_waitcnt lgkmcnt(3)
    v_exp_f32 v201, v201
    v_mfma_f32_16x16x32_bf16 v[208:211], v[144:147], v[174:177], v[208:211]
    ds_read_b128 a[244:247], v241 offset:4608
    v_cvt_pk_bf16_f32 v184, v200, v201
    v_mfma_f32_16x16x32_bf16 v[208:211], v[146:149], v[176:179], v[208:211]
    ds_read_b128 v[200:203], v246 offset:0
    v_mfma_f32_16x16x32_bf16 v[236:239], a[20:23], a[236:239], v[236:239]
    v_mfma_f32_16x16x32_bf16 v[228:231], a[28:31], a[220:223], v[228:231]
    v_mfma_f32_16x16x32_bf16 v[228:231], a[32:35], a[224:227], v[228:231]
    v_mfma_f32_16x16x32_bf16 v[228:231], a[36:39], a[228:231], v[228:231]
    v_mfma_f32_16x16x32_bf16 v[228:231], a[40:43], a[232:235], v[228:231]
    s_waitcnt vmcnt(3) lgkmcnt(3)
    ds_read_b64_tr_b16 a[152:153], v249 offset:0
    v_mfma_f32_16x16x32_bf16 v[196:199], v[108:111], v[174:177], v[196:199]
    v_exp_f32 v208, v208
    v_mfma_f32_16x16x32_bf16 v[196:199], v[110:113], v[176:179], v[196:199]
    v_exp_f32 v209, v209
    v_mfma_f32_16x16x32_bf16 v[228:231], a[44:47], a[236:239], v[228:231]
    v_exp_f32 v210, v210
    v_mfma_f32_16x16x32_bf16 v[232:235], a[48:51], a[216:219], 0
    s_waitcnt lgkmcnt(1)
    v_exp_f32 v211, v211
    v_mfma_f32_16x16x32_bf16 v[200:203], v[132:135], v[174:177], v[200:203]
    v_cvt_pk_bf16_f32 v190, v208, v209
    v_cvt_pk_bf16_f32 v193, v210, v211
    v_mfma_f32_16x16x32_bf16 v[200:203], v[134:137], v[176:179], v[200:203]
    ds_read_b128 v[208:211], v245 offset:64
    v_cvt_pk_bf16_f32 v90, v236, v237
    v_mfma_f32_16x16x32_bf16 v[232:235], a[52:55], a[220:223], v[232:235]
    v_cvt_pk_bf16_f32 v91, v238, v239
    v_cvt_pk_bf16_f32 v92, v228, v229
    v_mfma_f32_16x16x32_bf16 v[232:235], a[56:59], a[224:227], v[232:235]
    ds_read_b64_tr_b16 a[154:155], v250 offset:0
    v_cvt_pk_bf16_f32 v93, v230, v231
    v_mfma_f32_16x16x32_bf16 v[232:235], a[60:63], a[228:231], v[232:235]
    ds_read_b64_tr_b16 a[176:177], v249 offset:32
    ds_read_b64_tr_b16 a[178:179], v250 offset:32
    v_mfma_f32_16x16x32_bf16 v[204:207], v[90:93], v[168:171], v[204:207]
    ds_read_b64_tr_b16 a[200:201], v249 offset:64
    ds_read_b64_tr_b16 a[202:203], v250 offset:64
    v_mfma_f32_16x16x32_bf16 v[232:235], a[64:67], a[232:235], v[232:235]
    v_exp_f32 v196, v196
    v_mfma_f32_16x16x32_bf16 v[232:235], a[68:71], a[236:239], v[232:235]
    v_exp_f32 v197, v197
    v_mfma_f32_16x16x32_bf16 v[236:239], a[216:219], a[72:75], 0
    s_waitcnt vmcnt(0)
    v_exp_f32 v198, v198
    v_mfma_f32_16x16x32_bf16 v[236:239], a[220:223], a[76:79], v[236:239]
    s_waitcnt lgkmcnt(5)
    v_exp_f32 v199, v199
    v_mfma_f32_16x16x32_bf16 v[208:211], v[162:165], v[174:177], v[208:211]
    v_cvt_pk_bf16_f32 v188, v196, v197
    v_cvt_pk_bf16_f32 v191, v198, v199
    v_mfma_f32_16x16x32_bf16 v[208:211], v[164:167], v[176:179], v[208:211]
    ds_read_b128 v[196:199], v246 offset:64
    v_cvt_pk_bf16_f32 v94, v232, v233
    v_mfma_f32_16x16x32_bf16 v[236:239], a[224:227], a[80:83], v[236:239]
    ds_read_b64_tr_b16 a[156:157], v249 offset:3072
    v_cvt_pk_bf16_f32 v95, v234, v235
    v_mfma_f32_16x16x32_bf16 v[236:239], a[228:231], a[84:87], v[236:239]
    ds_read_b64_tr_b16 a[158:159], v250 offset:3072
    ds_read_b64_tr_b16 a[180:181], v249 offset:3104
    v_mfma_f32_16x16x32_bf16 v[204:207], v[92:95], v[170:173], v[204:207]
    s_waitcnt lgkmcnt(4)
    buffer_load_dwordx4 v252, s[12:15], s62 offen lds
    v_mfma_f32_16x16x32_bf16 v[236:239], a[232:235], a[88:91], v[236:239]
    ds_read_b64_tr_b16 a[182:183], v250 offset:3104
    ds_read_b64_tr_b16 a[204:205], v249 offset:3136
    v_mfma_f32_16x16x32_bf16 v[236:239], a[236:239], a[92:95], v[236:239]
    ds_read_b64_tr_b16 a[206:207], v250 offset:3136
    ds_read_b64 v[168:169], v247 offset:36864
    v_mfma_f32_16x16x32_bf16 v[228:231], a[216:219], a[96:99], 0
    v_exp_f32 v204, v204
    v_mfma_f32_16x16x32_bf16 v[228:231], a[220:223], a[100:103], v[228:231]
    v_exp_f32 v205, v205
    v_mfma_f32_16x16x32_bf16 v[228:231], a[224:227], a[104:107], v[228:231]
    s_waitcnt lgkmcnt(7)
    v_cvt_pk_bf16_f32 v185, v204, v205
    v_cvt_pk_bf16_f32 v13, v236, v237
    v_mfma_f32_16x16x32_bf16 v[196:199], v[90:93], v[174:177], v[196:199]
    ds_read_b128 v[204:207], v244 offset:64
    buffer_load_dwordx4 v253, s[12:15], s62 offen offset:1024 lds
    v_mfma_f32_16x16x32_bf16 v[212:215], v[12:15], v[184:187], v[212:215]
    v_exp_f32 v200, v200
    v_mfma_f32_16x16x32_bf16 v[224:227], a[248:251], v[184:187], v[224:227]
    v_exp_f32 v201, v201
    v_mfma_f32_16x16x32_bf16 v[196:199], v[92:95], v[176:179], v[196:199]
    v_cvt_pk_bf16_f32 v189, v200, v201
    v_cvt_pk_bf16_f32 v16, v238, v239
    v_mfma_f32_16x16x32_bf16 v[228:231], a[228:231], a[108:111], v[228:231]
    buffer_load_dwordx4 v251, s[12:15], s62 offen offset:2048 lds
    s_add_u32 m0, s46, 0x17400
    v_mfma_f32_16x16x32_bf16 v[228:231], a[232:235], a[112:115], v[228:231]
    s_waitcnt lgkmcnt(1)
    v_rcp_f32 v225, v224
    v_mfma_f32_16x16x32_bf16 v[228:231], a[236:239], a[116:119], v[228:231]
    v_mul_f32 v212, v212, v225
    v_mul_f32 v213, v213, v225
    v_mfma_f32_16x16x32_bf16 v[232:235], a[216:219], a[120:123], 0
    ds_read_b128 a[216:219], v240 offset:4736
    v_mul_f32 v214, v214, v225
    v_mfma_f32_16x16x32_bf16 v[232:235], a[220:223], a[124:127], v[232:235]
    buffer_load_dwordx4 v252, s[12:15], s63 offen lds
    s_waitcnt lgkmcnt(1)
    v_mfma_f32_16x16x32_bf16 v[204:207], v[150:153], v[174:177], v[204:207]
    v_cvt_pk_bf16_f32 v43, v228, v229
    v_mul_f32 v215, v215, v225
    v_mfma_f32_16x16x32_bf16 v[204:207], v[152:155], v[176:179], v[204:207]
    ds_read_b128 a[220:223], v241 offset:4736
    v_cvt_pk_bf16_f32 v212, v212, v213
    v_mfma_f32_16x16x32_bf16 v[216:219], v[42:45], v[184:187], v[216:219]
    v_cvt_pk_bf16_f32 v213, v214, v215
    v_max3_f32 v248, v248, v224, v225
    v_mfma_f32_16x16x32_bf16 v[232:235], a[224:227], a[128:131], v[232:235]
    buffer_load_dwordx4 v253, s[12:15], s63 offen offset:1024 lds
    ds_read_b128 a[224:227], v240 offset:4864
    v_mfma_f32_16x16x32_bf16 v[232:235], a[228:231], a[132:135], v[232:235]
    ds_write_b64 v247, v[212:213] offset:24576
    v_mfma_f32_16x16x32_bf16 v[212:215], v[6:9], v[188:191], 0
    v_exp_f32 v202, v202
    v_mfma_f32_16x16x32_bf16 v[232:235], a[232:235], a[136:139], v[232:235]
    v_exp_f32 v203, v203
    v_mfma_f32_16x16x32_bf16 v[232:235], a[236:239], a[140:143], v[232:235]
    buffer_load_dwordx4 v251, s[12:15], s63 offen offset:2048 lds
    v_cvt_pk_bf16_f32 v192, v202, v203
    v_mfma_f32_16x16x32_bf16 v[236:239], a[0:3], a[240:243], 0
    ds_read_b128 v[200:203], v244 offset:128
    ds_read_b128 a[228:231], v241 offset:4864
    v_mfma_f32_16x16x32_bf16 v[236:239], a[4:7], a[244:247], v[236:239]
    s_waitcnt lgkmcnt(4)
    v_mul_f32 v216, v216, v225
    v_cvt_pk_bf16_f32 v73, v232, v233
    v_mfma_f32_16x16x32_bf16 v[236:239], a[8:11], a[216:219], v[236:239]
    v_mul_f32 v217, v217, v225
    v_mul_f32 v218, v218, v225
    v_mfma_f32_16x16x32_bf16 v[220:223], v[72:75], v[184:187], v[220:223]
    v_mul_f32 v219, v219, v225
    v_cvt_pk_bf16_f32 v216, v216, v217
    v_mfma_f32_16x16x32_bf16 v[236:239], a[12:15], a[220:223], v[236:239]
    s_waitcnt lgkmcnt(3)
    v_cvt_pk_bf16_f32 v217, v218, v219
    v_cvt_pk_bf16_f32 v46, v230, v231
    v_mfma_f32_16x16x32_bf16 v[236:239], a[16:19], a[224:227], v[236:239]
    ds_write_b64 v247, v[216:217] offset:24704
    v_mfma_f32_16x16x32_bf16 v[216:219], v[36:39], v[188:191], 0
    v_mul_f32 v220, v220, v225
    v_mul_f32 v221, v221, v225
    v_mfma_f32_16x16x32_bf16 v[228:231], a[24:27], a[240:243], 0
    v_mul_f32 v222, v222, v225
    v_mul_f32 v223, v223, v225
    v_mfma_f32_16x16x32_bf16 v[224:227], a[248:251], v[188:191], 0
    s_waitcnt lgkmcnt(2)
    v_cvt_pk_bf16_f32 v220, v220, v221
    v_cvt_pk_bf16_f32 v221, v222, v223
    v_mfma_f32_16x16x32_bf16 v[200:203], v[156:159], v[174:177], v[200:203]
    ds_write_b64 v247, v[220:221] offset:24832
    v_mfma_f32_16x16x32_bf16 v[220:223], v[66:69], v[188:191], 0
    s_waitcnt lgkmcnt(2)
    v_exp_f32 v204, v204
    v_mfma_f32_16x16x32_bf16 v[200:203], v[158:161], v[176:179], v[200:203]
    v_exp_f32 v205, v205
    v_mfma_f32_16x16x32_bf16 v[236:239], a[20:23], a[228:231], v[236:239]
    v_exp_f32 v206, v206
    v_mfma_f32_16x16x32_bf16 v[228:231], a[28:31], a[244:247], v[228:231]
    v_exp_f32 v207, v207
    v_mfma_f32_16x16x32_bf16 v[228:231], a[32:35], a[216:219], v[228:231]
    v_cvt_pk_bf16_f32 v180, v204, v205
    v_cvt_pk_bf16_f32 v183, v206, v207
    v_mfma_f32_16x16x32_bf16 v[228:231], a[36:39], a[220:223], v[228:231]
    ds_read_b128 v[204:207], v245 offset:128
    v_cvt_pk_bf16_f32 v76, v234, v235
    v_mfma_f32_16x16x32_bf16 v[228:231], a[40:43], a[224:227], v[228:231]
    v_exp_f32 v208, v208
    v_mfma_f32_16x16x32_bf16 v[228:231], a[44:47], a[228:231], v[228:231]
    v_exp_f32 v209, v209
    v_mfma_f32_16x16x32_bf16 v[232:235], a[48:51], a[240:243], 0
    v_exp_f32 v196, v196
    v_mfma_f32_16x16x32_bf16 v[232:235], a[52:55], a[244:247], v[232:235]
    v_exp_f32 v197, v197
    v_mfma_f32_16x16x32_bf16 v[232:235], a[56:59], a[216:219], v[232:235]
    v_exp_f32 v210, v210
    v_mfma_f32_16x16x32_bf16 v[232:235], a[60:63], a[220:223], v[232:235]
    v_exp_f32 v211, v211
    v_mfma_f32_16x16x32_bf16 v[232:235], a[64:67], a[224:227], v[232:235]
    v_cvt_pk_bf16_f32 v194, v208, v209
    v_cvt_pk_bf16_f32 v195, v196, v197
    v_mfma_f32_16x16x32_bf16 v[232:235], a[68:71], a[228:231], v[232:235]
    ds_read_b64 v[170:171], v247 offset:36992
    s_waitcnt lgkmcnt(1)
    v_mfma_f32_16x16x32_bf16 v[212:215], v[10:13], v[192:195], v[212:215]
    ds_read_b64 v[172:173], v247 offset:37120
    v_cvt_pk_bf16_f32 v181, v210, v211
    v_mfma_f32_16x16x32_bf16 v[216:219], v[40:43], v[192:195], v[216:219]
    ds_read_b128 v[208:211], v246 offset:128
    v_cvt_pk_bf16_f32 v138, v236, v237
    v_mfma_f32_16x16x32_bf16 v[220:223], v[70:73], v[192:195], v[220:223]
    v_exp_f32 v198, v198
    v_mfma_f32_16x16x32_bf16 v[224:227], a[248:251], v[192:195], v[224:227]
    v_exp_f32 v199, v199
    v_mfma_f32_16x16x32_bf16 v[204:207], v[114:117], v[174:177], v[204:207]
    v_cvt_pk_bf16_f32 v182, v198, v199
    v_cvt_pk_bf16_f32 v139, v238, v239
    v_mfma_f32_16x16x32_bf16 v[204:207], v[116:119], v[176:179], v[204:207]
    ds_read_b128 v[196:199], v244 offset:0
    v_cvt_pk_bf16_f32 v140, v228, v229
    v_mfma_f32_16x16x32_bf16 v[212:215], v[14:17], v[180:183], v[212:215]
    v_exp_f32 v200, v200
    v_mfma_f32_16x16x32_bf16 v[216:219], v[44:47], v[180:183], v[216:219]
    v_exp_f32 v201, v201
    v_mfma_f32_16x16x32_bf16 v[220:223], v[74:77], v[180:183], v[220:223]
    v_cvt_pk_bf16_f32 v186, v200, v201
    v_cvt_pk_bf16_f32 v141, v230, v231
    v_mfma_f32_16x16x32_bf16 v[224:227], a[248:251], v[180:183], v[224:227]
    ds_read_b128 v[200:203], v245 offset:0
    s_waitcnt lgkmcnt(2)
    v_mfma_f32_16x16x32_bf16 v[208:211], v[138:141], v[174:177], v[208:211]
    v_exp_f32 v204, v204
    v_mfma_f32_16x16x32_bf16 v[236:239], a[240:243], a[72:75], 0
    v_exp_f32 v205, v205
    v_mfma_f32_16x16x32_bf16 v[236:239], a[244:247], a[76:79], v[236:239]
    v_cvt_pk_bf16_f32 v142, v232, v233
    v_cvt_pk_bf16_f32 v143, v234, v235
    v_mfma_f32_16x16x32_bf16 v[236:239], a[216:219], a[80:83], v[236:239]
    s_waitcnt vmcnt(3)
    s_waitcnt lgkmcnt(1)
    v_cvt_pk_bf16_f32 v184, v204, v205
    v_mfma_f32_16x16x32_bf16 v[208:211], v[140:143], v[176:179], v[208:211]
    ds_read_b128 v[204:207], v246 offset:0
    ds_read_b64_tr_b16 a[160:161], v249 offset:0
    v_mfma_f32_16x16x32_bf16 v[196:199], v[150:153], v[168:171], v[196:199]
    ds_read_b64_tr_b16 a[162:163], v250 offset:0
    ds_read_b64_tr_b16 a[184:185], v249 offset:32
    v_mfma_f32_16x16x32_bf16 v[196:199], v[152:155], v[170:173], v[196:199]
    ds_read_b64_tr_b16 a[186:187], v250 offset:32
    ds_read_b64_tr_b16 a[208:209], v249 offset:64
    v_mfma_f32_16x16x32_bf16 v[236:239], a[220:223], a[84:87], v[236:239]
    s_waitcnt lgkmcnt(6)
    v_exp_f32 v208, v208
    v_mfma_f32_16x16x32_bf16 v[200:203], v[162:165], v[168:171], v[200:203]
    v_exp_f32 v209, v209
    v_mfma_f32_16x16x32_bf16 v[200:203], v[164:167], v[170:173], v[200:203]
    ds_read_b64_tr_b16 a[210:211], v250 offset:64
    v_cvt_pk_bf16_f32 v185, v208, v209
    v_mfma_f32_16x16x32_bf16 v[236:239], a[224:227], a[88:91], v[236:239]
    ds_read_b128 v[208:211], v244 offset:64
    ds_read_b64 v[174:175], v247 offset:43008
    v_mfma_f32_16x16x32_bf16 v[224:227], a[248:251], v[184:187], v[224:227]
    v_exp_f32 v196, v196
    v_mfma_f32_16x16x32_bf16 v[236:239], a[228:231], a[92:95], v[236:239]
    s_waitcnt lgkmcnt(8)
    v_exp_f32 v197, v197
    v_mfma_f32_16x16x32_bf16 v[204:207], v[90:93], v[168:171], v[204:207]
    v_exp_f32 v198, v198
    v_mfma_f32_16x16x32_bf16 v[204:207], v[92:95], v[170:173], v[204:207]
    v_exp_f32 v199, v199
    v_mfma_f32_16x16x32_bf16 v[228:231], a[240:243], a[96:99], 0
    v_cvt_pk_bf16_f32 v190, v196, v197
    v_cvt_pk_bf16_f32 v19, v236, v237
    v_mfma_f32_16x16x32_bf16 v[228:231], a[244:247], a[100:103], v[228:231]
    s_waitcnt vmcnt(0)
    v_mbcnt_lo_u32_b32 v236, -1, 0
    v_mbcnt_hi_u32_b32 v236, -1, v236
    v_mfma_f32_16x16x32_bf16 v[212:215], v[18:21], v[184:187], v[212:215]
    v_cvt_pk_bf16_f32 v22, v238, v239
    v_and_b32 v237, 15, v236
    v_mfma_f32_16x16x32_bf16 v[228:231], a[216:219], a[104:107], v[228:231]
    v_lshrrev_b32 v236, 4, v236
    v_lshrrev_b32 v238, 1, v237
    v_mfma_f32_16x16x32_bf16 v[228:231], a[220:223], a[108:111], v[228:231]
    s_waitcnt lgkmcnt(0)
    v_mul_u32_u24 v239, 0x180, v237
    v_xor_b32 v243, v236, v238
    v_mfma_f32_16x16x32_bf16 v[208:211], v[156:159], v[168:171], v[208:211]
    ds_read_b64_tr_b16 a[164:165], v249 offset:3072
    v_lshl_add_u32 v242, v243, 4, v239
    v_mfma_f32_16x16x32_bf16 v[208:211], v[158:161], v[170:173], v[208:211]
    ds_read_b64_tr_b16 a[166:167], v250 offset:3072
    v_xor_b32 v243, 64, v242
    v_mfma_f32_16x16x32_bf16 v[228:231], a[224:227], a[112:115], v[228:231]
    v_add_u32 v242, 0x1e000, v242
    v_add_u32 v243, 0x1e000, v243
    v_mfma_f32_16x16x32_bf16 v[228:231], a[228:231], a[116:119], v[228:231]
    ds_read_b128 a[232:235], v242 offset:0
    ds_read_b128 a[236:239], v243 offset:0
    v_mfma_f32_16x16x32_bf16 v[232:235], a[240:243], a[120:123], 0
    ds_read_b128 a[240:243], v242 offset:128
    ds_read_b64_tr_b16 a[188:189], v249 offset:3104
    v_mfma_f32_16x16x32_bf16 v[232:235], a[244:247], a[124:127], v[232:235]
    ds_read_b128 a[244:247], v243 offset:128
    ds_read_b64_tr_b16 a[190:191], v250 offset:3104
    v_mfma_f32_16x16x32_bf16 v[232:235], a[216:219], a[128:131], v[232:235]
    ds_read_b128 a[216:219], v242 offset:256
    v_cvt_pk_bf16_f32 v49, v228, v229
    v_mfma_f32_16x16x32_bf16 v[232:235], a[220:223], a[132:135], v[232:235]
    ds_read_b128 a[220:223], v243 offset:256
    v_cvt_pk_bf16_f32 v52, v230, v231
    v_mfma_f32_16x16x32_bf16 v[216:219], v[48:51], v[184:187], v[216:219]
    ds_read_b64_tr_b16 a[212:213], v249 offset:3136
    v_lshrrev_b32 v249, 1, v236
    v_mfma_f32_16x16x32_bf16 v[232:235], a[224:227], a[136:139], v[232:235]
    ds_read_b64_tr_b16 a[214:215], v250 offset:3136
    v_or_b32 v249, s66, v249
    v_mfma_f32_16x16x32_bf16 v[232:235], a[228:231], a[140:143], v[232:235]
    v_mov_b32 v253, v249
    v_xor_b32 v249, v249, v238
    v_lshl_add_u32 v249, v249, 4, v239
    s_waitcnt lgkmcnt(9)
    v_mfma_f32_16x16x32_bf16 v[228:231], a[144:147], a[232:235], 0
    ds_read_b128 a[224:227], v242 offset:6144
    s_waitcnt lgkmcnt(9)
    v_mfma_f32_16x16x32_bf16 v[228:231], a[148:151], a[236:239], v[228:231]
    v_cvt_pk_bf16_f32 v79, v232, v233
    s_waitcnt lgkmcnt(8)
    v_mfma_f32_16x16x32_bf16 v[228:231], a[152:155], a[240:243], v[228:231]
    v_cvt_pk_bf16_f32 v82, v234, v235
    v_and_b32 v239, 1, v236
    v_mfma_f32_16x16x32_bf16 v[220:223], v[78:81], v[184:187], v[220:223]
    s_waitcnt lgkmcnt(6)
    v_lshl_add_u32 v249, v239, 3, v249
    v_lshlrev_b32 v239, 3, v239
    v_mfma_f32_16x16x32_bf16 v[228:231], a[156:159], a[244:247], v[228:231]
    v_xor_b32 v252, v237, v239
    s_waitcnt lgkmcnt(4)
    v_mfma_f32_16x16x32_bf16 v[228:231], a[160:163], a[216:219], v[228:231]
    v_mul_u32_u24 v236, 0x180, v236
    s_waitcnt lgkmcnt(3)
    v_mfma_f32_16x16x32_bf16 v[228:231], a[164:167], a[220:223], v[228:231]
    v_xor_b32 v252, v252, v253
    v_add_u32 v236, s67, v236
    v_mfma_f32_16x16x32_bf16 v[232:235], a[168:171], a[232:235], 0
    s_waitcnt lgkmcnt(1)
    v_xor_b32 v253, v253, v238
    v_cvt_pk_bf16_f32 v193, v198, v199
    v_mfma_f32_16x16x32_bf16 v[232:235], a[172:175], a[236:239], v[232:235]
    s_barrier
    v_lshl_add_u32 v253, v253, 4, v236
    v_and_b32 v237, 1, v237
    v_mfma_f32_16x16x32_bf16 v[232:235], a[176:179], a[240:243], v[232:235]
    ds_read_b128 v[196:199], v245 offset:64
    v_lshl_add_u32 v252, v252, 4, v236
    v_mfma_f32_16x16x32_bf16 v[232:235], a[180:183], a[244:247], v[232:235]
    ds_read_b128 a[228:231], v243 offset:6144
    v_lshl_add_u32 v253, v237, 3, v253
    v_mfma_f32_16x16x32_bf16 v[232:235], a[184:187], a[216:219], v[232:235]
    s_lshl2_add_u32 s67, s28, 0x23000
    v_cvt_pk_bf16_f32 v228, v228, v229
    v_add_u32 v249, 0x16800, v249
    v_mfma_f32_16x16x32_bf16 v[232:235], a[188:191], a[220:223], v[232:235]
    ds_read_b64 v[176:177], v247 offset:43136
    v_cvt_pk_bf16_f32 v229, v230, v231
    v_mfma_f32_16x16x32_bf16 v[236:239], a[192:195], a[232:235], 0
    ds_read_b128 a[232:235], v242 offset:6272
    v_add_u32 v252, 0x16800, v252
    v_mfma_f32_16x16x32_bf16 v[236:239], a[196:199], a[236:239], v[236:239]
    ds_read_b128 a[236:239], v243 offset:6272
    v_mul_i32_i24 v250, s31, v255
    v_mfma_f32_16x16x32_bf16 v[236:239], a[200:203], a[240:243], v[236:239]
    ds_read_b128 a[240:243], v242 offset:6400
    v_cvt_pk_bf16_f32 v232, v232, v233
    v_mfma_f32_16x16x32_bf16 v[236:239], a[204:207], a[244:247], v[236:239]
    ds_read_b128 a[244:247], v243 offset:6400
    v_cvt_pk_bf16_f32 v233, v234, v235
    v_mfma_f32_16x16x32_bf16 v[236:239], a[208:211], a[216:219], v[236:239]
    ds_write_b64 v249, v[228:229] offset:0
    v_mfma_f32_16x16x32_bf16 v[236:239], a[212:215], a[220:223], v[236:239]
    s_waitcnt lgkmcnt(6)
    v_exp_f32 v200, v200
    v_mfma_f32_16x16x32_bf16 v[196:199], v[114:117], v[168:171], v[196:199]
    v_exp_f32 v201, v201
    v_mfma_f32_16x16x32_bf16 v[196:199], v[116:119], v[170:173], v[196:199]
    v_exp_f32 v202, v202
    v_mfma_f32_16x16x32_bf16 v[228:231], a[144:147], a[224:227], 0
    v_exp_f32 v203, v203
    v_mfma_f32_16x16x32_bf16 v[228:231], a[148:151], a[228:231], v[228:231]
    s_waitcnt lgkmcnt(3)
    v_cvt_pk_bf16_f32 v188, v200, v201
    v_cvt_pk_bf16_f32 v191, v202, v203
    v_mfma_f32_16x16x32_bf16 v[228:231], a[152:155], a[232:235], v[228:231]
    ds_read_b128 v[200:203], v246 offset:64
    ds_read_b128 a[216:219], v242 offset:12288
    v_mfma_f32_16x16x32_bf16 v[228:231], a[156:159], a[236:239], v[228:231]
    s_waitcnt lgkmcnt(3)
    v_rcp_f32 v225, v224
    v_mfma_f32_16x16x32_bf16 v[228:231], a[160:163], a[240:243], v[228:231]
    ds_write_b64 v249, v[232:233] offset:128
    v_mfma_f32_16x16x32_bf16 v[228:231], a[164:167], a[244:247], v[228:231]
    v_exp_f32 v204, v204
    v_mfma_f32_16x16x32_bf16 v[232:235], a[168:171], a[224:227], 0
    v_exp_f32 v205, v205
    v_mfma_f32_16x16x32_bf16 v[232:235], a[172:175], a[228:231], v[232:235]
    v_mul_f32 v212, v212, v225
    v_mul_f32 v213, v213, v225
    v_mfma_f32_16x16x32_bf16 v[232:235], a[176:179], a[232:235], v[232:235]
    v_cvt_pk_bf16_f32 v189, v204, v205
    v_mul_f32 v214, v214, v225
    v_mfma_f32_16x16x32_bf16 v[232:235], a[180:183], a[236:239], v[232:235]
    v_mul_f32 v215, v215, v225
    v_cvt_pk_bf16_f32 v212, v212, v213
    v_mfma_f32_16x16x32_bf16 v[232:235], a[184:187], a[240:243], v[232:235]
    s_waitcnt lgkmcnt(2)
    v_cvt_pk_bf16_f32 v213, v214, v215
    v_cvt_pk_bf16_f32 v236, v236, v237
    v_mfma_f32_16x16x32_bf16 v[200:203], v[138:141], v[168:171], v[200:203]
    ds_read_b128 a[220:223], v243 offset:12288
    v_cvt_pk_bf16_f32 v237, v238, v239
    v_mfma_f32_16x16x32_bf16 v[200:203], v[140:143], v[170:173], v[200:203]
    ds_write_b64 v247, v[212:213] offset:30720
    v_mfma_f32_16x16x32_bf16 v[212:215], v[12:15], v[188:191], 0
    ds_write_b64 v249, v[236:237] offset:256
    v_mfma_f32_16x16x32_bf16 v[232:235], a[188:191], a[244:247], v[232:235]
    v_cvt_pk_bf16_f32 v228, v228, v229
    v_cvt_pk_bf16_f32 v229, v230, v231
    v_mfma_f32_16x16x32_bf16 v[236:239], a[192:195], a[224:227], 0
    ds_read_b128 a[224:227], v242 offset:12416
    v_mul_f32 v216, v216, v225
    v_mfma_f32_16x16x32_bf16 v[236:239], a[196:199], a[228:231], v[236:239]
    ds_read_b128 a[228:231], v243 offset:12416
    v_mul_f32 v217, v217, v225
    v_mfma_f32_16x16x32_bf16 v[236:239], a[200:203], a[232:235], v[236:239]
    ds_read_b128 a[232:235], v242 offset:12544
    v_mul_f32 v218, v218, v225
    v_mfma_f32_16x16x32_bf16 v[236:239], a[204:207], a[236:239], v[236:239]
    ds_read_b128 a[236:239], v243 offset:12544
    v_mul_f32 v219, v219, v225
    v_mfma_f32_16x16x32_bf16 v[236:239], a[208:211], a[240:243], v[236:239]
    ds_write_b64 v249, v[228:229] offset:6144
    v_mfma_f32_16x16x32_bf16 v[236:239], a[212:215], a[244:247], v[236:239]
    s_waitcnt lgkmcnt(6)
    v_cvt_pk_bf16_f32 v216, v216, v217
    v_cvt_pk_bf16_f32 v217, v218, v219
    v_mfma_f32_16x16x32_bf16 v[228:231], a[144:147], a[216:219], 0
    ds_write_b64 v247, v[216:217] offset:30848
    v_mfma_f32_16x16x32_bf16 v[216:219], v[42:45], v[188:191], 0
    v_cvt_pk_bf16_f32 v232, v232, v233
    v_cvt_pk_bf16_f32 v233, v234, v235
    v_mfma_f32_16x16x32_bf16 v[228:231], a[148:151], a[220:223], v[228:231]
    s_waitcnt lgkmcnt(5)
    v_max3_f32 v248, v248, v224, v225
    v_mul_f32 v220, v220, v225
    v_mfma_f32_16x16x32_bf16 v[228:231], a[152:155], a[224:227], v[228:231]
    s_waitcnt lgkmcnt(4)
    v_mul_f32 v221, v221, v225
    v_mul_f32 v222, v222, v225
    v_mfma_f32_16x16x32_bf16 v[228:231], a[156:159], a[228:231], v[228:231]
    s_waitcnt lgkmcnt(3)
    v_mul_f32 v223, v223, v225
    v_cvt_pk_bf16_f32 v220, v220, v221
    v_mfma_f32_16x16x32_bf16 v[224:227], a[248:251], v[188:191], 0
    ds_write_b64 v249, v[232:233] offset:6272
    v_mfma_f32_16x16x32_bf16 v[228:231], a[160:163], a[232:235], v[228:231]
    s_waitcnt lgkmcnt(2)
    v_cvt_pk_bf16_f32 v221, v222, v223
    v_add_u32 v242, 0xfffe9800, v242
    v_mfma_f32_16x16x32_bf16 v[228:231], a[164:167], a[236:239], v[228:231]
    ds_write_b64 v247, v[220:221] offset:30976
    v_mfma_f32_16x16x32_bf16 v[220:223], v[72:75], v[188:191], 0
    ds_read_b128 a[240:243], v242 offset:6144
    v_add_u32 v243, 0xfffe9800, v243
    v_mfma_f32_16x16x32_bf16 v[232:235], a[168:171], a[216:219], 0
    ds_read_b128 a[244:247], v243 offset:6144
    v_cvt_pk_bf16_f32 v236, v236, v237
    v_mfma_f32_16x16x32_bf16 v[232:235], a[172:175], a[220:223], v[232:235]
    v_cvt_pk_bf16_f32 v237, v238, v239
    v_cvt_pk_bf16_f32 v228, v228, v229
    v_mfma_f32_16x16x32_bf16 v[232:235], a[176:179], a[224:227], v[232:235]
    ds_write_b64 v249, v[236:237] offset:6400
    v_mfma_f32_16x16x32_bf16 v[232:235], a[180:183], a[228:231], v[232:235]
    v_exp_f32 v206, v206
    v_mfma_f32_16x16x32_bf16 v[232:235], a[184:187], a[232:235], v[232:235]
    v_exp_f32 v207, v207
    v_mfma_f32_16x16x32_bf16 v[232:235], a[188:191], a[236:239], v[232:235]
    v_cvt_pk_bf16_f32 v192, v206, v207
    v_cvt_pk_bf16_f32 v229, v230, v231
    v_mfma_f32_16x16x32_bf16 v[236:239], a[192:195], a[216:219], 0
    ds_read_b128 a[216:219], v242 offset:6272
    ds_read_b128 v[204:207], v244 offset:128
    v_mfma_f32_16x16x32_bf16 v[236:239], a[196:199], a[220:223], v[236:239]
    ds_read_b128 a[220:223], v243 offset:6272
    ds_read_b64 v[178:179], v247 offset:43264
    v_mfma_f32_16x16x32_bf16 v[236:239], a[200:203], a[224:227], v[236:239]
    ds_read_b128 a[224:227], v242 offset:6400
    v_cvt_pk_bf16_f32 v232, v232, v233
    v_mfma_f32_16x16x32_bf16 v[236:239], a[204:207], a[228:231], v[236:239]
    ds_read_b128 a[228:231], v243 offset:6400
    v_cvt_pk_bf16_f32 v233, v234, v235
    v_mfma_f32_16x16x32_bf16 v[236:239], a[208:211], a[232:235], v[236:239]
    ds_write_b64 v249, v[228:229] offset:12288
    v_mfma_f32_16x16x32_bf16 v[236:239], a[212:215], a[236:239], v[236:239]
    s_waitcnt lgkmcnt(7)
    v_exp_f32 v208, v208
    v_mfma_f32_16x16x32_bf16 v[228:231], a[144:147], a[240:243], 0
    ds_write_b64 v249, v[232:233] offset:12416
    v_mfma_f32_16x16x32_bf16 v[228:231], a[148:151], a[244:247], v[228:231]
    v_exp_f32 v209, v209
    v_mfma_f32_16x16x32_bf16 v[232:235], a[168:171], a[240:243], 0
    s_waitcnt lgkmcnt(7)
    v_exp_f32 v210, v210
    v_mfma_f32_16x16x32_bf16 v[228:231], a[152:155], a[216:219], v[228:231]
    s_waitcnt lgkmcnt(6)
    v_exp_f32 v211, v211
    v_mfma_f32_16x16x32_bf16 v[204:207], v[96:99], v[168:171], v[204:207]
    s_waitcnt lgkmcnt(4)
    v_cvt_pk_bf16_f32 v180, v208, v209
    v_cvt_pk_bf16_f32 v183, v210, v211
    v_mfma_f32_16x16x32_bf16 v[204:207], v[98:101], v[170:173], v[204:207]
    ds_read_b128 v[208:211], v245 offset:128
    v_cvt_pk_bf16_f32 v236, v236, v237
    v_mfma_f32_16x16x32_bf16 v[228:231], a[156:159], a[220:223], v[228:231]
    s_waitcnt lgkmcnt(3)
    v_cvt_pk_bf16_f32 v237, v238, v239
    v_add_u32 v250, s55, v250
    v_mfma_f32_16x16x32_bf16 v[228:231], a[160:163], a[224:227], v[228:231]
    ds_write_b64 v249, v[236:237] offset:12544
    v_mfma_f32_16x16x32_bf16 v[228:231], a[164:167], a[228:231], v[228:231]
    s_mul_i32 s55, s31, -8
    v_exp_f32 v196, v196
    v_mfma_f32_16x16x32_bf16 v[232:235], a[172:175], a[244:247], v[232:235]
    s_add_u32 s54, s54, s55
    v_exp_f32 v197, v197
    v_mfma_f32_16x16x32_bf16 v[232:235], a[176:179], a[216:219], v[232:235]
    s_add_u32 s55, s28, 11
    v_exp_f32 v200, v200
    v_mfma_f32_16x16x32_bf16 v[232:235], a[180:183], a[220:223], v[232:235]
    s_mul_i32 s55, s55, s30
    v_exp_f32 v201, v201
    v_mfma_f32_16x16x32_bf16 v[232:235], a[184:187], a[224:227], v[232:235]
    ds_read_b128 a[232:235], v240 offset:6144
    v_cvt_pk_bf16_f32 v194, v196, v197
    v_mfma_f32_16x16x32_bf16 v[232:235], a[188:191], a[228:231], v[232:235]
    s_waitcnt lgkmcnt(2)
    v_cvt_pk_bf16_f32 v195, v200, v201
    v_cvt_pk_bf16_f32 v228, v228, v229
    v_mfma_f32_16x16x32_bf16 v[208:211], v[120:123], v[168:171], v[208:211]
    ds_read_b128 a[236:239], v241 offset:6144
    v_cvt_pk_bf16_f32 v229, v230, v231
    v_mfma_f32_16x16x32_bf16 v[212:215], v[16:19], v[192:195], v[212:215]
    s_waitcnt lgkmcnt(2)
    v_exp_f32 v202, v202
    v_mfma_f32_16x16x32_bf16 v[216:219], v[46:49], v[192:195], v[216:219]
    s_barrier
    v_exp_f32 v203, v203
    v_mfma_f32_16x16x32_bf16 v[220:223], v[76:79], v[192:195], v[220:223]
    v_cvt_pk_bf16_f32 v182, v202, v203
    v_cvt_pk_bf16_f32 v232, v232, v233
    v_mfma_f32_16x16x32_bf16 v[224:227], a[248:251], v[192:195], v[224:227]
    ds_read_b128 v[200:203], v244 offset:0
    v_cvt_pk_bf16_f32 v233, v234, v235
    v_mfma_f32_16x16x32_bf16 v[208:211], v[122:125], v[170:173], v[208:211]
    ds_write_b64 v249, v[228:229] offset:18432
    v_mfma_f32_16x16x32_bf16 v[236:239], a[192:195], a[240:243], 0
    ds_read_b128 a[240:243], v240 offset:6272
    s_waitcnt lgkmcnt(4)
    v_mfma_f32_16x16x32_bf16 v[236:239], a[196:199], a[244:247], v[236:239]
    ds_read_b128 a[244:247], v241 offset:6272
    v_lshlrev_b32 v255, 3, v255
    v_mfma_f32_16x16x32_bf16 v[236:239], a[200:203], a[216:219], v[236:239]
    v_exp_f32 v198, v198
    v_mfma_f32_16x16x32_bf16 v[236:239], a[204:207], a[220:223], v[236:239]
    v_exp_f32 v199, v199
    v_mfma_f32_16x16x32_bf16 v[236:239], a[208:211], a[224:227], v[236:239]
    ds_read_b128 a[216:219], v240 offset:6400
    v_cvt_pk_bf16_f32 v181, v198, v199
    v_mfma_f32_16x16x32_bf16 v[236:239], a[212:215], a[228:231], v[236:239]
    ds_read_b128 a[220:223], v241 offset:6400
    ds_read_b128 v[196:199], v246 offset:128
    v_mfma_f32_16x16x32_bf16 v[212:215], v[20:23], v[180:183], v[212:215]
    s_waitcnt lgkmcnt(6)
    v_exp_f32 v204, v204
    v_mfma_f32_16x16x32_bf16 v[216:219], v[50:53], v[180:183], v[216:219]
    v_exp_f32 v205, v205
    v_mfma_f32_16x16x32_bf16 v[220:223], v[80:83], v[180:183], v[220:223]
    v_cvt_pk_bf16_f32 v186, v204, v205
    v_cvt_pk_bf16_f32 v236, v236, v237
    v_mfma_f32_16x16x32_bf16 v[224:227], a[248:251], v[180:183], v[224:227]
    ds_read_b128 v[204:207], v245 offset:0
    v_cvt_pk_bf16_f32 v237, v238, v239
    v_mfma_f32_16x16x32_bf16 v[200:203], v[156:159], v[174:177], v[200:203]
    v_exp_f32 v208, v208
    v_mfma_f32_16x16x32_bf16 v[200:203], v[158:161], v[176:179], v[200:203]
    v_exp_f32 v209, v209
    v_mfma_f32_16x16x32_bf16 v[228:231], a[0:3], a[232:235], 0
    ds_read_b128 a[224:227], v242 offset:12288
    v_cvt_pk_bf16_f32 v184, v208, v209
    v_mfma_f32_16x16x32_bf16 v[228:231], a[4:7], a[236:239], v[228:231]
    s_waitcnt lgkmcnt(4)
    ds_read_b128 v[208:211], v246 offset:0
    v_mfma_f32_16x16x32_bf16 v[228:231], a[8:11], a[240:243], v[228:231]
    ds_write_b64 v249, v[232:233] offset:18560
    v_mfma_f32_16x16x32_bf16 v[228:231], a[12:15], a[244:247], v[228:231]
    v_exp_f32 v200, v200
    v_mfma_f32_16x16x32_bf16 v[228:231], a[16:19], a[216:219], v[228:231]
    s_waitcnt lgkmcnt(4)
    v_exp_f32 v201, v201
    v_mfma_f32_16x16x32_bf16 v[228:231], a[20:23], a[220:223], v[228:231]
    s_waitcnt lgkmcnt(3)
    v_exp_f32 v202, v202
    v_mfma_f32_16x16x32_bf16 v[204:207], v[114:117], v[174:177], v[204:207]
    v_exp_f32 v203, v203
    v_mfma_f32_16x16x32_bf16 v[204:207], v[116:119], v[176:179], v[204:207]
    v_cvt_pk_bf16_f32 v190, v200, v201
    v_cvt_pk_bf16_f32 v193, v202, v203
    v_mfma_f32_16x16x32_bf16 v[232:235], a[24:27], a[232:235], 0
    ds_read_b128 v[200:203], v245 offset:64
    v_cvt_pk_bf16_f32 v144, v228, v229
    v_mfma_f32_16x16x32_bf16 v[232:235], a[28:31], a[236:239], v[232:235]
    ds_write_b64 v249, v[236:237] offset:18688
    v_mfma_f32_16x16x32_bf16 v[232:235], a[32:35], a[240:243], v[232:235]
    s_waitcnt lgkmcnt(3)
    v_exp_f32 v204, v204
    v_mfma_f32_16x16x32_bf16 v[208:211], v[138:141], v[174:177], v[208:211]
    v_exp_f32 v205, v205
    v_mfma_f32_16x16x32_bf16 v[208:211], v[140:143], v[176:179], v[208:211]
    v_exp_f32 v206, v206
    v_mfma_f32_16x16x32_bf16 v[232:235], a[36:39], a[244:247], v[232:235]
    v_exp_f32 v207, v207
    v_mfma_f32_16x16x32_bf16 v[232:235], a[40:43], a[216:219], v[232:235]
    v_cvt_pk_bf16_f32 v188, v204, v205
    v_cvt_pk_bf16_f32 v191, v206, v207
    v_mfma_f32_16x16x32_bf16 v[232:235], a[44:47], a[220:223], v[232:235]
    ds_read_b128 v[204:207], v246 offset:64
    v_cvt_pk_bf16_f32 v145, v230, v231
    v_mfma_f32_16x16x32_bf16 v[236:239], a[48:51], a[232:235], 0
    s_waitcnt lgkmcnt(2)
    ds_read_b128 a[228:231], v243 offset:12288
    v_mfma_f32_16x16x32_bf16 v[200:203], v[120:123], v[174:177], v[200:203]
    v_exp_f32 v208, v208
    v_mfma_f32_16x16x32_bf16 v[200:203], v[122:125], v[176:179], v[200:203]
    v_cvt_pk_bf16_f32 v146, v232, v233
    v_cvt_pk_bf16_f32 v147, v234, v235
    v_mfma_f32_16x16x32_bf16 v[236:239], a[52:55], a[236:239], v[236:239]
    v_exp_f32 v209, v209
    v_mfma_f32_16x16x32_bf16 v[196:199], v[144:147], v[168:171], v[196:199]
    ds_read_b128 a[252:255], v252 offset:0
    v_cvt_pk_bf16_f32 v189, v208, v209
    v_mfma_f32_16x16x32_bf16 v[236:239], a[56:59], a[240:243], v[236:239]
    v_lshl_add_u32 v251, v254, 3, v250
    v_and_b32 v255, 8, v255
    v_mfma_f32_16x16x32_bf16 v[236:239], a[60:63], a[244:247], v[236:239]
    v_xor_b32 v254, v254, v255
    v_lshl_add_u32 v250, v254, 4, v250
    v_mfma_f32_16x16x32_bf16 v[236:239], a[64:67], a[216:219], v[236:239]
    ds_read_b64 v[168:169], v247 offset:49152
    s_waitcnt lgkmcnt(3)
    v_mfma_f32_16x16x32_bf16 v[204:207], v[144:147], v[174:177], v[204:207]
    v_add_u32 v253, 0x16800, v253
    v_mfma_f32_16x16x32_bf16 v[236:239], a[68:71], a[220:223], v[236:239]
    ds_read_b64 v[254:255], v253 offset:256
    v_mfma_f32_16x16x32_bf16 v[228:231], a[232:235], a[72:75], 0
    v_exp_f32 v210, v210
    v_mfma_f32_16x16x32_bf16 v[228:231], a[236:239], a[76:79], v[228:231]
    v_exp_f32 v211, v211
    v_mfma_f32_16x16x32_bf16 v[228:231], a[240:243], a[80:83], v[228:231]
    v_exp_f32 v200, v200
    v_mfma_f32_16x16x32_bf16 v[228:231], a[244:247], a[84:87], v[228:231]
    s_waitcnt lgkmcnt(2)
    v_cvt_pk_bf16_f32 v148, v236, v237
    v_cvt_pk_bf16_f32 v149, v238, v239
    v_mfma_f32_16x16x32_bf16 v[228:231], a[216:219], a[88:91], v[228:231]
    buffer_store_dwordx4 a[252:255], v250, s[20:23], 0 offen nt
    v_mfma_f32_16x16x32_bf16 v[196:199], v[146:149], v[170:173], v[196:199]
    ds_read_b64 v[170:171], v247 offset:49280
    ds_read_b128 a[252:255], v252 offset:6144
    v_mfma_f32_16x16x32_bf16 v[204:207], v[146:149], v[176:179], v[204:207]
    v_add_u32 v250, s57, v250
    s_waitcnt lgkmcnt(2)
    v_mfma_f32_16x16x32_bf16 v[228:231], a[220:223], a[92:95], v[228:231]
    buffer_store_dwordx2 v[254:255], v251, s[20:23], 0 offen offset:256 nt
    v_mfma_f32_16x16x32_bf16 v[232:235], a[232:235], a[96:99], 0
    v_exp_f32 v196, v196
    v_mfma_f32_16x16x32_bf16 v[232:235], a[236:239], a[100:103], v[232:235]
    v_exp_f32 v197, v197
    v_mfma_f32_16x16x32_bf16 v[232:235], a[240:243], a[104:107], v[232:235]
    ds_read_b64 v[254:255], v253 offset:6400
    v_cvt_pk_bf16_f32 v185, v196, v197
    v_mfma_f32_16x16x32_bf16 v[232:235], a[244:247], a[108:111], v[232:235]
    ds_read_b128 v[196:199], v244 offset:64
    v_cvt_pk_bf16_f32 v25, v228, v229
    v_mfma_f32_16x16x32_bf16 v[224:227], a[248:251], v[184:187], v[224:227]
    v_cvt_pk_bf16_f32 v28, v230, v231
    v_add_u32 v251, s57, v251
    v_mfma_f32_16x16x32_bf16 v[212:215], v[24:27], v[184:187], v[212:215]
    ds_read_b64 v[172:173], v247 offset:49408
    v_cvt_pk_bf16_f32 v192, v210, v211
    v_mfma_f32_16x16x32_bf16 v[232:235], a[216:219], a[112:115], v[232:235]
    s_waitcnt lgkmcnt(3)
    v_exp_f32 v201, v201
    v_mfma_f32_16x16x32_bf16 v[232:235], a[220:223], a[116:119], v[232:235]
    s_mul_i32 s57, s31, 4
    v_rcp_f32 v225, v224
    v_mfma_f32_16x16x32_bf16 v[236:239], a[232:235], a[120:123], 0
    ds_read_b128 a[232:235], v242 offset:12416
    v_mul_f32 v212, v212, v225
    v_mfma_f32_16x16x32_bf16 v[236:239], a[236:239], a[124:127], v[236:239]
    ds_read_b128 a[236:239], v243 offset:12416
    v_mul_f32 v213, v213, v225
    v_mfma_f32_16x16x32_bf16 v[236:239], a[240:243], a[128:131], v[236:239]
    ds_read_b128 a[240:243], v242 offset:12544
    v_cvt_pk_bf16_f32 v55, v232, v233
    v_mfma_f32_16x16x32_bf16 v[236:239], a[244:247], a[132:135], v[236:239]
    ds_read_b128 a[244:247], v243 offset:12544
    s_waitcnt lgkmcnt(5)
    v_mfma_f32_16x16x32_bf16 v[216:219], v[54:57], v[184:187], v[216:219]
    s_add_u32 s56, s56, s57
    v_mul_f32 v214, v214, v225
    v_mul_f32 v215, v215, v225
    v_mfma_f32_16x16x32_bf16 v[196:199], v[96:99], v[174:177], v[196:199]
    s_mul_i32 s57, s30, 0
    v_cvt_pk_bf16_f32 v212, v212, v213
    v_cvt_pk_bf16_f32 v213, v214, v215
    v_mfma_f32_16x16x32_bf16 v[196:199], v[98:101], v[176:179], v[196:199]
    ds_write_b64 v247, v[212:213] offset:36864
    v_mfma_f32_16x16x32_bf16 v[212:215], v[18:21], v[188:191], 0
    v_mul_f32 v216, v216, v225
    v_mul_f32 v217, v217, v225
    v_mfma_f32_16x16x32_bf16 v[236:239], a[216:219], a[136:139], v[236:239]
    v_mul_f32 v218, v218, v225
    v_mul_f32 v219, v219, v225
    v_mfma_f32_16x16x32_bf16 v[236:239], a[220:223], a[140:143], v[236:239]
    v_cvt_pk_bf16_f32 v216, v216, v217
    v_cvt_pk_bf16_f32 v217, v218, v219
    v_mfma_f32_16x16x32_bf16 v[228:231], a[144:147], a[224:227], 0
    ds_write_b64 v247, v[216:217] offset:36992
    v_mfma_f32_16x16x32_bf16 v[216:219], v[48:51], v[188:191], 0
    v_cvt_pk_bf16_f32 v58, v234, v235
    v_max3_f32 v248, v248, v224, v225
    v_mfma_f32_16x16x32_bf16 v[228:231], a[148:151], a[228:231], v[228:231]
    s_waitcnt lgkmcnt(2)
    v_cvt_pk_bf16_f32 v85, v236, v237
    v_cvt_pk_bf16_f32 v88, v238, v239
    v_mfma_f32_16x16x32_bf16 v[228:231], a[152:155], a[232:235], v[228:231]
    ds_read_b128 a[216:219], v242 offset:18432
    ds_read_b128 a[220:223], v243 offset:18432
    v_mfma_f32_16x16x32_bf16 v[220:223], v[84:87], v[184:187], v[220:223]
    buffer_store_dwordx4 a[252:255], v250, s[20:23], 0 offen nt
    v_mfma_f32_16x16x32_bf16 v[228:231], a[156:159], a[236:239], v[228:231]
    v_exp_f32 v196, v196
    v_mfma_f32_16x16x32_bf16 v[228:231], a[160:163], a[240:243], v[228:231]
    ds_read_b128 a[252:255], v252 offset:12288
    v_cvt_pk_bf16_f32 v194, v200, v201
    v_mfma_f32_16x16x32_bf16 v[228:231], a[164:167], a[244:247], v[228:231]
    buffer_store_dwordx2 v[254:255], v251, s[20:23], 0 offen offset:256 nt
    v_mfma_f32_16x16x32_bf16 v[232:235], a[168:171], a[224:227], 0
    v_mul_f32 v220, v220, v225
    v_mul_f32 v221, v221, v225
    v_mfma_f32_16x16x32_bf16 v[232:235], a[172:175], a[228:231], v[232:235]
    v_mul_f32 v222, v222, v225
    v_mul_f32 v223, v223, v225
    v_mfma_f32_16x16x32_bf16 v[224:227], a[248:251], v[188:191], 0
    v_cvt_pk_bf16_f32 v220, v220, v221
    v_cvt_pk_bf16_f32 v221, v222, v223
    v_mfma_f32_16x16x32_bf16 v[232:235], a[176:179], a[232:235], v[232:235]
    ds_write_b64 v247, v[220:221] offset:37120
    v_mfma_f32_16x16x32_bf16 v[220:223], v[78:81], v[188:191], 0
    ds_read_b64 v[254:255], v253 offset:12544
    v_cvt_pk_bf16_f32 v228, v228, v229
    v_mfma_f32_16x16x32_bf16 v[232:235], a[180:183], a[236:239], v[232:235]
    v_cvt_pk_bf16_f32 v229, v230, v231
    v_mov_b32 v186, 0
    v_mfma_f32_16x16x32_bf16 v[232:235], a[184:187], a[240:243], v[232:235]
    ds_write_b64 v249, v[228:229] offset:24576
    v_mfma_f32_16x16x32_bf16 v[232:235], a[188:191], a[244:247], v[232:235]
    s_waitcnt lgkmcnt(3)
    v_exp_f32 v197, v197
    v_mfma_f32_16x16x32_bf16 v[236:239], a[192:195], a[224:227], 0
    ds_read_b128 a[224:227], v242 offset:18560
    v_cvt_pk_bf16_f32 v180, v196, v197
    v_mfma_f32_16x16x32_bf16 v[236:239], a[196:199], a[228:231], v[236:239]
    ds_read_b128 a[228:231], v243 offset:18560
    v_mbcnt_lo_u32_b32 v196, -1, 0
    v_mfma_f32_16x16x32_bf16 v[236:239], a[200:203], a[232:235], v[236:239]
    ds_read_b128 a[232:235], v242 offset:18688
    v_cvt_pk_bf16_f32 v232, v232, v233
    v_mfma_f32_16x16x32_bf16 v[236:239], a[204:207], a[236:239], v[236:239]
    ds_read_b128 a[236:239], v243 offset:18688
    v_cvt_pk_bf16_f32 v233, v234, v235
    v_mfma_f32_16x16x32_bf16 v[236:239], a[208:211], a[240:243], v[236:239]
    ds_write_b64 v249, v[232:233] offset:24704
    v_mfma_f32_16x16x32_bf16 v[236:239], a[212:215], a[244:247], v[236:239]
    ds_read_b128 a[240:243], v242 offset:0
    ds_read_b128 a[244:247], v243 offset:0
    v_mfma_f32_16x16x32_bf16 v[228:231], a[144:147], a[216:219], 0
    v_mbcnt_hi_u32_b32 v196, -1, v196
    v_lshrrev_b32 v209, 1, v196
    v_mfma_f32_16x16x32_bf16 v[228:231], a[148:151], a[220:223], v[228:231]
    v_and_b32 v209, 4, v209
    v_bfe_u32 v208, v196, 2, 1
    v_mfma_f32_16x16x32_bf16 v[232:235], a[168:171], a[216:219], 0
    s_waitcnt lgkmcnt(6)
    v_cvt_pk_bf16_f32 v236, v236, v237
    v_cvt_pk_bf16_f32 v237, v238, v239
    v_mfma_f32_16x16x32_bf16 v[228:231], a[152:155], a[224:227], v[228:231]
    s_waitcnt lgkmcnt(5)
    v_and_or_b32 v209, v196, 3, v209
    v_bfe_u32 v197, v196, 3, 1
    v_mfma_f32_16x16x32_bf16 v[228:231], a[156:159], a[228:231], v[228:231]
    s_waitcnt lgkmcnt(4)
    v_lshrrev_b32 v196, 4, v196
    v_sub_u32 v210, v196, v208
    v_mfma_f32_16x16x32_bf16 v[228:231], a[160:163], a[232:235], v[228:231]
    s_waitcnt lgkmcnt(3)
    v_mul_i32_i24 v210, 0x1c0, v210
    v_lshlrev_b32 v211, 4, v209
    v_mfma_f32_16x16x32_bf16 v[228:231], a[164:167], a[236:239], v[228:231]
    ds_write_b64 v249, v[236:237] offset:24832
    v_mfma_f32_16x16x32_bf16 v[232:235], a[172:175], a[220:223], v[232:235]
    v_sub_u32 v210, v210, v211
    v_sub_u32 v211, v196, v208
    v_mfma_f32_16x16x32_bf16 v[232:235], a[176:179], a[224:227], v[232:235]
    v_add_u32 v244, 0, v211
    v_cmp_gt_u32 vcc, 7, v244
    v_mfma_f32_16x16x32_bf16 v[232:235], a[180:183], a[228:231], v[232:235]
    v_cvt_pk_bf16_f32 v228, v228, v229
    v_cvt_pk_bf16_f32 v229, v230, v231
    v_mfma_f32_16x16x32_bf16 v[232:235], a[184:187], a[232:235], v[232:235]
    v_add_u32 v210, s37, v210
    v_add_u32 v244, 0xfffdc870, v210
    v_mfma_f32_16x16x32_bf16 v[232:235], a[188:191], a[236:239], v[232:235]
    v_cndmask_b32 v244, 0, v244, vcc
    v_add_u32 v245, 4, v211
    v_mfma_f32_16x16x32_bf16 v[236:239], a[192:195], a[216:219], 0
    ds_read_b128 a[216:219], v242 offset:128
    v_cmp_gt_u32 vcc, 7, v245
    v_mfma_f32_16x16x32_bf16 v[236:239], a[196:199], a[220:223], v[236:239]
    ds_read_b128 a[220:223], v243 offset:128
    v_add_u32 v245, 0xfffdcf70, v210
    v_mfma_f32_16x16x32_bf16 v[236:239], a[200:203], a[224:227], v[236:239]
    ds_read_b128 a[224:227], v242 offset:256
    s_waitcnt lgkmcnt(3)
    v_mfma_f32_16x16x32_bf16 v[236:239], a[204:207], a[228:231], v[236:239]
    ds_read_b128 a[228:231], v243 offset:256
    s_barrier
    v_mfma_f32_16x16x32_bf16 v[236:239], a[208:211], a[232:235], v[236:239]
    ds_write_b64 v249, v[228:229] offset:0
    v_mfma_f32_16x16x32_bf16 v[236:239], a[212:215], a[236:239], v[236:239]
    v_cvt_pk_bf16_f32 v232, v232, v233
    v_cvt_pk_bf16_f32 v233, v234, v235
    v_mfma_f32_16x16x32_bf16 v[228:231], a[144:147], a[240:243], 0
    ds_write_b64 v249, v[232:233] offset:128
    v_mfma_f32_16x16x32_bf16 v[228:231], a[148:151], a[244:247], v[228:231]
    v_cndmask_b32 v245, 0, v245, vcc
    v_add_u32 v246, 8, v211
    v_mfma_f32_16x16x32_bf16 v[232:235], a[168:171], a[240:243], 0
    s_waitcnt lgkmcnt(5)
    v_cmp_gt_u32 vcc, 7, v246
    v_add_u32 v246, 0xfffdd670, v210
    v_mfma_f32_16x16x32_bf16 v[228:231], a[152:155], a[216:219], v[228:231]
    s_waitcnt lgkmcnt(4)
    v_cndmask_b32 v246, 0, v246, vcc
    v_add_u32 v246, 0x237c0, v246
    v_mfma_f32_16x16x32_bf16 v[228:231], a[156:159], a[220:223], v[228:231]
    s_waitcnt lgkmcnt(3)
    v_xor_b32 v197, 1, v197
    v_add_u32 v244, 0x237c0, v244
    v_mfma_f32_16x16x32_bf16 v[228:231], a[160:163], a[224:227], v[228:231]
    s_waitcnt lgkmcnt(2)
    v_mul_u32_u24 v246, 0xc0, v197
    v_add_u32 v244, v244, v246
    v_mfma_f32_16x16x32_bf16 v[228:231], a[164:167], a[228:231], v[228:231]
    ds_read_b128 v[208:211], v244 offset:0
    v_add_u32 v245, 0x237c0, v245
    v_mfma_f32_16x16x32_bf16 v[232:235], a[172:175], a[244:247], v[232:235]
    v_exp_f32 v204, v204
    v_mfma_f32_16x16x32_bf16 v[232:235], a[176:179], a[216:219], v[232:235]
    v_exp_f32 v205, v205
    v_mfma_f32_16x16x32_bf16 v[232:235], a[180:183], a[220:223], v[232:235]
    v_cvt_pk_bf16_f32 v195, v204, v205
    v_add_u32 v245, v245, v246
    v_mfma_f32_16x16x32_bf16 v[232:235], a[184:187], a[224:227], v[232:235]
    v_exp_f32 v198, v198
    v_mfma_f32_16x16x32_bf16 v[212:215], v[22:25], v[192:195], v[212:215]
    v_exp_f32 v199, v199
    v_mfma_f32_16x16x32_bf16 v[216:219], v[52:55], v[192:195], v[216:219]
    v_cvt_pk_bf16_f32 v183, v198, v199
    v_cvt_pk_bf16_f32 v236, v236, v237
    v_mfma_f32_16x16x32_bf16 v[220:223], v[82:85], v[192:195], v[220:223]
    ds_read_b128 v[196:199], v245 offset:0
    v_cvt_pk_bf16_f32 v237, v238, v239
    v_mfma_f32_16x16x32_bf16 v[224:227], a[248:251], v[192:195], v[224:227]
    ds_write_b64 v249, v[236:237] offset:256
    v_mfma_f32_16x16x32_bf16 v[232:235], a[188:191], a[228:231], v[232:235]
    s_waitcnt lgkmcnt(2)
    v_exp_f32 v202, v202
    v_mfma_f32_16x16x32_bf16 v[208:211], v[102:105], v[168:171], v[208:211]
    v_exp_f32 v203, v203
    v_mfma_f32_16x16x32_bf16 v[208:211], v[104:107], v[170:173], v[208:211]
    ds_read_b128 a[232:235], v242 offset:24576
    v_cvt_pk_bf16_f32 v181, v202, v203
    v_mfma_f32_16x16x32_bf16 v[236:239], a[192:195], a[240:243], 0
    ds_read_b128 v[200:203], v244 offset:64
    ds_read_b128 a[236:239], v243 offset:24576
    v_mfma_f32_16x16x32_bf16 v[236:239], a[196:199], a[244:247], v[236:239]
    v_exp_f32 v206, v206
    v_mfma_f32_16x16x32_bf16 v[236:239], a[200:203], a[216:219], v[236:239]
    v_exp_f32 v207, v207
    v_mfma_f32_16x16x32_bf16 v[236:239], a[204:207], a[220:223], v[236:239]
    s_waitcnt lgkmcnt(4)
    v_cvt_pk_bf16_f32 v182, v206, v207
    v_cvt_pk_bf16_f32 v228, v228, v229
    v_mfma_f32_16x16x32_bf16 v[196:199], v[126:129], v[168:171], v[196:199]
    ds_read_b128 v[204:207], v245 offset:64
    ds_read_b128 a[240:243], v242 offset:24704
    v_mfma_f32_16x16x32_bf16 v[212:215], v[26:29], v[180:183], v[212:215]
    ds_read_b128 a[244:247], v243 offset:24704
    ds_read_b128 a[216:219], v242 offset:24832
    v_mfma_f32_16x16x32_bf16 v[216:219], v[56:59], v[180:183], v[216:219]
    v_exp_f32 v208, v208
    v_mfma_f32_16x16x32_bf16 v[220:223], v[86:89], v[180:183], v[220:223]
    v_exp_f32 v209, v209
    v_mfma_f32_16x16x32_bf16 v[224:227], a[248:251], v[180:183], v[224:227]
    s_waitcnt lgkmcnt(5)
    v_exp_f32 v210, v210
    v_mfma_f32_16x16x32_bf16 v[196:199], v[128:131], v[170:173], v[196:199]
    v_exp_f32 v211, v211
    v_mfma_f32_16x16x32_bf16 v[200:203], v[108:111], v[168:171], v[200:203]
    v_cvt_pk_bf16_f32 v184, v208, v209
    v_cvt_pk_bf16_f32 v187, v210, v211
    v_mfma_f32_16x16x32_bf16 v[200:203], v[110:113], v[170:173], v[200:203]
    ds_read_b128 v[208:211], v244 offset:128
    ds_read_b128 a[220:223], v243 offset:24832
    v_mfma_f32_16x16x32_bf16 v[236:239], a[208:211], a[224:227], v[236:239]
    s_waitcnt lgkmcnt(5)
    v_cvt_pk_bf16_f32 v229, v230, v231
    v_cvt_pk_bf16_f32 v232, v232, v233
    v_mfma_f32_16x16x32_bf16 v[204:207], v[132:135], v[168:171], v[204:207]
    ds_write_b64 v249, v[228:229] offset:6144
    v_mfma_f32_16x16x32_bf16 v[204:207], v[134:137], v[170:173], v[204:207]
    v_exp_f32 v196, v196
    v_mfma_f32_16x16x32_bf16 v[236:239], a[212:215], a[228:231], v[236:239]
    v_exp_f32 v197, v197
    v_mfma_f32_16x16x32_bf16 v[228:231], a[144:147], a[232:235], 0
    v_exp_f32 v198, v198
    v_mfma_f32_16x16x32_bf16 v[228:231], a[148:151], a[236:239], v[228:231]
    s_waitcnt lgkmcnt(3)
    v_exp_f32 v199, v199
    v_mfma_f32_16x16x32_bf16 v[228:231], a[152:155], a[240:243], v[228:231]
    v_cvt_pk_bf16_f32 v185, v196, v197
    v_cvt_pk_bf16_f32 v188, v198, v199
    v_mfma_f32_16x16x32_bf16 v[228:231], a[156:159], a[244:247], v[228:231]
    s_waitcnt lgkmcnt(2)
    ds_read_b128 v[196:199], v245 offset:128
    v_mfma_f32_16x16x32_bf16 v[208:211], v[162:165], v[168:171], v[208:211]
    v_cvt_pk_bf16_f32 v233, v234, v235
    v_cvt_pk_bf16_f32 v236, v236, v237
    v_mfma_f32_16x16x32_bf16 v[208:211], v[164:167], v[170:173], v[208:211]
    ds_write_b64 v249, v[232:233] offset:6272
    v_mfma_f32_16x16x32_bf16 v[228:231], a[160:163], a[216:219], v[228:231]
    s_waitcnt lgkmcnt(2)
    v_rcp_f32 v225, v224
    v_mfma_f32_16x16x32_bf16 v[228:231], a[164:167], a[220:223], v[228:231]
    v_mul_f32 v212, v212, v225
    v_mul_f32 v213, v213, v225
    v_mfma_f32_16x16x32_bf16 v[232:235], a[168:171], a[232:235], 0
    v_mul_f32 v214, v214, v225
    v_mul_f32 v215, v215, v225
    v_mfma_f32_16x16x32_bf16 v[232:235], a[172:175], a[236:239], v[232:235]
    v_cvt_pk_bf16_f32 v212, v212, v213
    v_cvt_pk_bf16_f32 v213, v214, v215
    v_mfma_f32_16x16x32_bf16 v[232:235], a[176:179], a[240:243], v[232:235]
    ds_write_b64 v247, v[212:213] offset:43008
    v_mfma_f32_16x16x32_bf16 v[212:215], v[0:3], v[184:187], 0
    s_waitcnt lgkmcnt(2)
    v_mul_f32 v216, v216, v225
    v_mul_f32 v217, v217, v225
    v_mfma_f32_16x16x32_bf16 v[196:199], v[90:93], v[168:171], v[196:199]
    v_mul_f32 v218, v218, v225
    v_mul_f32 v219, v219, v225
    v_mfma_f32_16x16x32_bf16 v[196:199], v[92:95], v[170:173], v[196:199]
    v_cvt_pk_bf16_f32 v216, v216, v217
    v_cvt_pk_bf16_f32 v217, v218, v219
    v_mfma_f32_16x16x32_bf16 v[232:235], a[180:183], a[244:247], v[232:235]
    ds_write_b64 v247, v[216:217] offset:43136
    v_mfma_f32_16x16x32_bf16 v[216:219], v[30:33], v[184:187], 0
    v_exp_f32 v200, v200
    v_mfma_f32_16x16x32_bf16 v[232:235], a[184:187], a[216:219], v[232:235]
    v_exp_f32 v201, v201
    v_mfma_f32_16x16x32_bf16 v[232:235], a[188:191], a[220:223], v[232:235]
    v_exp_f32 v202, v202
    v_exp_f32 v203, v203
    v_cvt_pk_bf16_f32 v190, v200, v201
    v_cvt_pk_bf16_f32 v193, v202, v203
    ds_read_b128 v[200:203], v244 offset:192
    v_mul_f32 v220, v220, v225
    v_mul_f32 v221, v221, v225
    v_mul_f32 v222, v222, v225
    v_mul_f32 v223, v223, v225
    v_cvt_pk_bf16_f32 v220, v220, v221
    v_cvt_pk_bf16_f32 v221, v222, v223
    ds_write_b64 v247, v[220:221] offset:43264
    v_mfma_f32_16x16x32_bf16 v[220:223], v[60:63], v[184:187], 0
    v_max3_f32 v248, v248, v224, v225
    v_cvt_pk_bf16_f32 v237, v238, v239
    v_mfma_f32_16x16x32_bf16 v[224:227], a[248:251], v[184:187], 0
    ds_write_b64 v249, v[236:237] offset:6400
    v_mfma_f32_16x16x32_bf16 v[236:239], a[192:195], a[232:235], 0
    v_exp_f32 v204, v204
    v_mfma_f32_16x16x32_bf16 v[236:239], a[196:199], a[236:239], v[236:239]
    v_exp_f32 v205, v205
    v_mfma_f32_16x16x32_bf16 v[236:239], a[200:203], a[240:243], v[236:239]
    v_exp_f32 v206, v206
    v_mfma_f32_16x16x32_bf16 v[236:239], a[204:207], a[244:247], v[236:239]
    s_waitcnt lgkmcnt(2)
    v_exp_f32 v207, v207
    v_mfma_f32_16x16x32_bf16 v[200:203], v[114:117], v[168:171], v[200:203]
    v_cvt_pk_bf16_f32 v191, v204, v205
    v_mov_b32 v189, 0
    v_mfma_f32_16x16x32_bf16 v[200:203], v[116:119], v[170:173], v[200:203]
    ds_read_b128 a[224:227], v242 offset:30720
    v_cvt_pk_bf16_f32 v194, v206, v207
    v_mfma_f32_16x16x32_bf16 v[212:215], v[4:7], v[188:191], v[212:215]
    ds_read_b128 v[204:207], v245 offset:192
    ds_read_b128 a[228:231], v243 offset:30720
    v_mfma_f32_16x16x32_bf16 v[216:219], v[34:37], v[188:191], v[216:219]
    v_mov_b32 v192, 0
    v_mov_b32 v195, 0
    v_mfma_f32_16x16x32_bf16 v[220:223], v[64:67], v[188:191], v[220:223]
    ds_read_b128 a[232:235], v242 offset:30848
    ds_read_b128 a[236:239], v243 offset:30848
    v_mfma_f32_16x16x32_bf16 v[224:227], a[248:251], v[188:191], v[224:227]
    ds_read_b128 a[240:243], v242 offset:30976
    ds_read_b128 a[244:247], v243 offset:30976
    v_mfma_f32_16x16x32_bf16 v[212:215], v[8:11], v[192:195], v[212:215]
    v_cvt_pk_bf16_f32 v228, v228, v229
    v_cvt_pk_bf16_f32 v229, v230, v231
    v_mfma_f32_16x16x32_bf16 v[216:219], v[38:41], v[192:195], v[216:219]
    ds_write_b64 v249, v[228:229] offset:12288
    v_mfma_f32_16x16x32_bf16 v[220:223], v[68:71], v[192:195], v[220:223]
    v_exp_f32 v208, v208
    v_mfma_f32_16x16x32_bf16 v[224:227], a[248:251], v[192:195], v[224:227]
    s_waitcnt lgkmcnt(7)
    v_exp_f32 v209, v209
    v_mfma_f32_16x16x32_bf16 v[236:239], a[208:211], a[216:219], v[236:239]
    s_waitcnt lgkmcnt(6)
    v_exp_f32 v210, v210
    v_mfma_f32_16x16x32_bf16 v[204:207], v[138:141], v[168:171], v[204:207]
    v_exp_f32 v211, v211
    v_mfma_f32_16x16x32_bf16 v[204:207], v[140:143], v[170:173], v[204:207]
    v_cvt_pk_bf16_f32 v180, v208, v209
    v_cvt_pk_bf16_f32 v183, v210, v211
    v_mfma_f32_16x16x32_bf16 v[236:239], a[212:215], a[220:223], v[236:239]
    ds_read_b64 v[174:175], v247 offset:55296
    v_sub_u32 v244, v244, v246
    v_mfma_f32_16x16x32_bf16 v[228:231], a[144:147], a[224:227], 0
    s_waitcnt lgkmcnt(3)
    ds_read_b64 v[176:177], v247 offset:55424
    v_mfma_f32_16x16x32_bf16 v[228:231], a[148:151], a[228:231], v[228:231]
    ds_read_b128 v[208:211], v244 offset:0
    ds_read_b64 v[178:179], v247 offset:55552
    v_mfma_f32_16x16x32_bf16 v[228:231], a[152:155], a[232:235], v[228:231]
    v_add_u32 v250, s52, v250
    v_cvt_pk_bf16_f32 v232, v232, v233
    v_mfma_f32_16x16x32_bf16 v[228:231], a[156:159], a[236:239], v[228:231]
    buffer_store_dwordx4 a[252:255], v250, s[20:23], 0 offen nt
    v_mfma_f32_16x16x32_bf16 v[228:231], a[160:163], a[240:243], v[228:231]
    s_waitcnt lgkmcnt(4)
    v_cvt_pk_bf16_f32 v233, v234, v235
    v_add_u32 v251, s52, v251
    v_mfma_f32_16x16x32_bf16 v[228:231], a[164:167], a[244:247], v[228:231]
    ds_read_b128 a[252:255], v252 offset:18432
    ds_write_b64 v249, v[232:233] offset:12416
    v_mfma_f32_16x16x32_bf16 v[232:235], a[168:171], a[224:227], 0
    buffer_store_dwordx2 v[254:255], v251, s[20:23], 0 offen offset:256 nt
    v_mfma_f32_16x16x32_bf16 v[232:235], a[172:175], a[228:231], v[232:235]
    ds_read_b64 v[254:255], v253 offset:18688
    v_cvt_pk_bf16_f32 v236, v236, v237
    v_mfma_f32_16x16x32_bf16 v[232:235], a[176:179], a[232:235], v[232:235]
    s_waitcnt lgkmcnt(4)
    v_cvt_pk_bf16_f32 v237, v238, v239
    v_sub_u32 v245, v245, v246
    v_mfma_f32_16x16x32_bf16 v[208:211], v[162:165], v[174:177], v[208:211]
    s_waitcnt lgkmcnt(3)
    v_exp_f32 v196, v196
    v_mfma_f32_16x16x32_bf16 v[208:211], v[164:167], v[176:179], v[208:211]
    ds_write_b64 v249, v[236:237] offset:12544
    v_mfma_f32_16x16x32_bf16 v[232:235], a[180:183], a[236:239], v[232:235]
    s_mul_i32 s52, s31, 4
    v_exp_f32 v197, v197
    v_mfma_f32_16x16x32_bf16 v[232:235], a[184:187], a[240:243], v[232:235]
    s_add_u32 s51, s51, s52
    v_exp_f32 v198, v198
    v_mfma_f32_16x16x32_bf16 v[232:235], a[188:191], a[244:247], v[232:235]
    s_mul_i32 s52, s30, 0
    v_exp_f32 v199, v199
    v_mfma_f32_16x16x32_bf16 v[236:239], a[192:195], a[224:227], 0
    v_cvt_pk_bf16_f32 v181, v196, v197
    v_cvt_pk_bf16_f32 v184, v198, v199
    v_mfma_f32_16x16x32_bf16 v[236:239], a[196:199], a[228:231], v[236:239]
    ds_read_b128 v[196:199], v245 offset:0
    v_add_u32 v250, s54, v250
    v_mfma_f32_16x16x32_bf16 v[236:239], a[200:203], a[232:235], v[236:239]
    s_waitcnt lgkmcnt(2)
    v_add_u32 v251, s54, v251
    v_mov_b32 v182, 0
    v_mfma_f32_16x16x32_bf16 v[236:239], a[204:207], a[236:239], v[236:239]
    buffer_store_dwordx4 a[252:255], v250, s[20:23], 0 offen nt
    v_mfma_f32_16x16x32_bf16 v[212:215], v[12:15], v[180:183], v[212:215]
    ds_read_b128 a[216:219], v242 offset:36864
    ds_read_b128 a[252:255], v252 offset:24576
    v_mfma_f32_16x16x32_bf16 v[216:219], v[42:45], v[180:183], v[216:219]
    ds_read_b128 a[220:223], v243 offset:36864
    ds_read_b128 a[224:227], v242 offset:36992
    v_mfma_f32_16x16x32_bf16 v[220:223], v[72:75], v[180:183], v[220:223]
    buffer_store_dwordx2 v[254:255], v251, s[20:23], 0 offen offset:256 nt
    v_mfma_f32_16x16x32_bf16 v[224:227], a[248:251], v[180:183], v[224:227]
    ds_read_b64 v[254:255], v253 offset:24832
    v_cvt_pk_bf16_f32 v228, v228, v229
    v_mfma_f32_16x16x32_bf16 v[236:239], a[208:211], a[240:243], v[236:239]
    s_waitcnt lgkmcnt(5)
    v_exp_f32 v200, v200
    v_mfma_f32_16x16x32_bf16 v[196:199], v[90:93], v[174:177], v[196:199]
    s_mov_b32 s54, 15
    v_exp_f32 v201, v201
    v_mfma_f32_16x16x32_bf16 v[196:199], v[92:95], v[176:179], v[196:199]
    s_mul_i32 s54, s54, s31
    v_cvt_pk_bf16_f32 v186, v200, v201
    v_cvt_pk_bf16_f32 v229, v230, v231
    v_mfma_f32_16x16x32_bf16 v[236:239], a[212:215], a[244:247], v[236:239]
    ds_read_b128 v[200:203], v244 offset:64
    ds_read_b128 a[228:231], v243 offset:36992
    v_cvt_pk_bf16_f32 v232, v232, v233
    v_cvt_pk_bf16_f32 v233, v234, v235
    ds_read_b128 a[232:235], v242 offset:37120
    ds_read_b128 a[236:239], v243 offset:37120
    v_exp_f32 v204, v204
    v_exp_f32 v205, v205
    v_mov_b32 v185, 0
    v_cvt_pk_bf16_f32 v187, v204, v205
    ds_read_b128 v[204:207], v245 offset:64
    s_waitcnt lgkmcnt(5)
    v_mfma_f32_16x16x32_bf16 v[212:215], v[16:19], v[184:187], v[212:215]
    s_barrier
    v_add_u32 v250, s56, v250
    v_add_u32 v251, s56, v251
    v_mfma_f32_16x16x32_bf16 v[216:219], v[46:49], v[184:187], v[216:219]
    ds_write_b64 v249, v[228:229] offset:18432
    v_mfma_f32_16x16x32_bf16 v[220:223], v[76:79], v[184:187], v[220:223]
    ds_write_b64 v249, v[232:233] offset:18560
    v_mfma_f32_16x16x32_bf16 v[224:227], a[248:251], v[184:187], v[224:227]
    s_waitcnt lgkmcnt(6)
    ds_read_b128 a[240:243], v242 offset:43008
    v_mfma_f32_16x16x32_bf16 v[200:203], v[114:117], v[174:177], v[200:203]
    buffer_store_dwordx4 a[252:255], v250, s[20:23], 0 offen nt
    v_mfma_f32_16x16x32_bf16 v[200:203], v[116:119], v[176:179], v[200:203]
    ds_read_b128 a[244:247], v243 offset:43008
    ds_read_b128 a[252:255], v252 offset:0
    v_mfma_f32_16x16x32_bf16 v[228:231], a[144:147], a[216:219], 0
    s_waitcnt lgkmcnt(5)
    v_cvt_pk_bf16_f32 v236, v236, v237
    v_cvt_pk_bf16_f32 v237, v238, v239
    v_mfma_f32_16x16x32_bf16 v[204:207], v[138:141], v[174:177], v[204:207]
    buffer_store_dwordx2 v[254:255], v251, s[20:23], 0 offen offset:256 nt
    v_mfma_f32_16x16x32_bf16 v[204:207], v[140:143], v[176:179], v[204:207]
    ds_read_b64 v[254:255], v253 offset:256
    v_add_u32 v251, s51, v251
    v_mfma_f32_16x16x32_bf16 v[228:231], a[148:151], a[220:223], v[228:231]
    ds_write_b64 v249, v[236:237] offset:18688
    v_mfma_f32_16x16x32_bf16 v[228:231], a[152:155], a[224:227], v[228:231]
    s_add_u32 s53, s53, s54
    v_add_u32 v250, s51, v250
    s_add_u32 s53, s53, s32
    v_mfma_f32_16x16x32_bf16 v[228:231], a[156:159], a[228:231], v[228:231]
    s_mov_b32 s56, 3
    v_rcp_f32 v225, v224
    v_mfma_f32_16x16x32_bf16 v[228:231], a[160:163], a[232:235], v[228:231]
    s_mul_i32 s56, s56, s31
    s_add_u32 s55, s55, s56
    v_mul_f32 v212, v212, v225
    v_mfma_f32_16x16x32_bf16 v[228:231], a[164:167], a[236:239], v[228:231]
    s_add_u32 s55, s55, s32
    v_mul_f32 v213, v213, v225
    v_mul_f32 v214, v214, v225
    v_mfma_f32_16x16x32_bf16 v[232:235], a[168:171], a[216:219], 0
    s_waitcnt lgkmcnt(2)
    v_mul_f32 v215, v215, v225
    v_cvt_pk_bf16_f32 v212, v212, v213
    v_mfma_f32_16x16x32_bf16 v[232:235], a[172:175], a[220:223], v[232:235]
    buffer_store_dwordx4 a[252:255], v250, s[20:23], 0 offen nt
    v_mfma_f32_16x16x32_bf16 v[232:235], a[176:179], a[224:227], v[232:235]
    s_waitcnt lgkmcnt(1)
    ds_read_b128 a[252:255], v252 offset:6144
    v_mfma_f32_16x16x32_bf16 v[232:235], a[180:183], a[228:231], v[232:235]
    s_mul_i32 s51, s31, 4
    v_cvt_pk_bf16_f32 v228, v228, v229
    v_cvt_pk_bf16_f32 v229, v230, v231
    v_mfma_f32_16x16x32_bf16 v[232:235], a[184:187], a[232:235], v[232:235]
    buffer_store_dwordx2 v[254:255], v251, s[20:23], 0 offen offset:256 nt
    v_mfma_f32_16x16x32_bf16 v[232:235], a[188:191], a[236:239], v[232:235]
    s_add_u32 s57, s57, s51
    v_mbcnt_lo_u32_b32 v254, -1, 0
    v_mbcnt_hi_u32_b32 v254, -1, v254
    v_mfma_f32_16x16x32_bf16 v[236:239], a[192:195], a[216:219], 0
    ds_read_b128 a[216:219], v242 offset:43136
    v_lshrrev_b32 v255, 4, v254
    v_mfma_f32_16x16x32_bf16 v[236:239], a[196:199], a[220:223], v[236:239]
    ds_read_b128 a[220:223], v243 offset:43136
    v_and_b32 v251, 2, v255
    v_mfma_f32_16x16x32_bf16 v[236:239], a[200:203], a[224:227], v[236:239]
    ds_read_b128 a[224:227], v242 offset:43264
    v_lshlrev_b32 v251, 1, v251
    v_mfma_f32_16x16x32_bf16 v[236:239], a[204:207], a[228:231], v[236:239]
    ds_read_b128 a[228:231], v243 offset:43264
    v_mul_i32_i24 v251, s30, v251
    v_mfma_f32_16x16x32_bf16 v[236:239], a[208:211], a[232:235], v[236:239]
    s_add_u32 s54, s28, 11
    v_and_b32 v250, 1, v255
    v_mad_i32_i24 v250, v250, s31, v251
    v_mfma_f32_16x16x32_bf16 v[236:239], a[212:215], a[236:239], v[236:239]
    v_add_u32 v250, s53, v250
    v_and_b32 v254, 15, v254
    v_lshlrev_b32 v255, 3, v255
    v_lshl_add_u32 v251, v254, 3, v250
    v_and_b32 v255, 8, v255
    v_xor_b32 v254, v254, v255
    v_lshl_add_u32 v250, v254, 4, v250
    ds_read_b64 v[254:255], v253 offset:6400
    ds_write_b64 v249, v[228:229] offset:24576
    v_mfma_f32_16x16x32_bf16 v[228:231], a[144:147], a[240:243], 0
    s_waitcnt lgkmcnt(5)
    v_cvt_pk_bf16_f32 v232, v232, v233
    v_cvt_pk_bf16_f32 v233, v234, v235
    v_mfma_f32_16x16x32_bf16 v[228:231], a[148:151], a[244:247], v[228:231]
    ds_write_b64 v249, v[232:233] offset:24704
    v_mfma_f32_16x16x32_bf16 v[228:231], a[152:155], a[216:219], v[228:231]
    s_waitcnt lgkmcnt(4)
    v_mul_f32 v216, v216, v225
    v_mul_f32 v217, v217, v225
    v_mfma_f32_16x16x32_bf16 v[228:231], a[156:159], a[220:223], v[228:231]
    buffer_store_dwordx4 a[252:255], v250, s[20:23], 0 offen nt
    v_mfma_f32_16x16x32_bf16 v[228:231], a[160:163], a[224:227], v[228:231]
    s_waitcnt lgkmcnt(3)
    v_cvt_pk_bf16_f32 v213, v214, v215
    v_mul_f32 v218, v218, v225
    v_mfma_f32_16x16x32_bf16 v[228:231], a[164:167], a[228:231], v[228:231]
    s_mul_i32 s53, s31, 4
    v_mul_f32 v219, v219, v225
    v_cvt_pk_bf16_f32 v216, v216, v217
    v_mfma_f32_16x16x32_bf16 v[232:235], a[168:171], a[240:243], 0
    s_waitcnt lgkmcnt(2)
    v_mul_f32 v220, v220, v225
    v_mul_f32 v221, v221, v225
    v_mfma_f32_16x16x32_bf16 v[232:235], a[172:175], a[244:247], v[232:235]
    buffer_store_dwordx2 v[254:255], v251, s[20:23], 0 offen offset:256 nt
    v_mfma_f32_16x16x32_bf16 v[232:235], a[176:179], a[216:219], v[232:235]
    s_add_u32 s52, s52, s53
    v_mbcnt_lo_u32_b32 v254, -1, 0
    v_mbcnt_hi_u32_b32 v254, -1, v254
    v_mfma_f32_16x16x32_bf16 v[232:235], a[180:183], a[220:223], v[232:235]
    s_mul_i32 s54, s54, s30
    v_lshrrev_b32 v255, 4, v254
    v_mul_i32_i24 v250, s31, v255
    v_mfma_f32_16x16x32_bf16 v[232:235], a[184:187], a[224:227], v[232:235]
    s_and_b32 s56, s28, 1
    v_add_u32 v250, s55, v250
    v_and_b32 v254, 15, v254
    v_mfma_f32_16x16x32_bf16 v[232:235], a[188:191], a[228:231], v[232:235]
    v_lshlrev_b32 v255, 3, v255
    v_lshl_add_u32 v251, v254, 3, v250
    v_and_b32 v255, 8, v255
    ds_write_b64 v247, v[212:213] offset:49152
    v_cvt_pk_bf16_f32 v217, v218, v219
    v_mul_f32 v222, v222, v225
    v_mul_f32 v223, v223, v225
    v_cvt_pk_bf16_f32 v220, v220, v221
    v_xor_b32 v254, v254, v255
    v_cvt_pk_bf16_f32 v236, v236, v237
    ds_write_b64 v247, v[216:217] offset:49280
    v_cvt_pk_bf16_f32 v221, v222, v223
    v_lshl_add_u32 v250, v254, 4, v250
    v_cvt_pk_bf16_f32 v237, v238, v239
    ds_write_b64 v247, v[220:221] offset:49408
    ds_read_b128 a[252:255], v252 offset:12288
    ds_read_b64 v[254:255], v253 offset:12544
    ds_write_b64 v249, v[236:237] offset:24832
    v_mfma_f32_16x16x32_bf16 v[236:239], a[192:195], a[240:243], 0
    s_mov_b32 s55, 15
    v_exp_f32 v208, v208
    v_mfma_f32_16x16x32_bf16 v[236:239], a[196:199], a[244:247], v[236:239]
    s_add_u32 s56, s56, 15
    v_exp_f32 v209, v209
    v_mfma_f32_16x16x32_bf16 v[236:239], a[200:203], a[216:219], v[236:239]
    s_mul_i32 s56, s56, s30
    v_exp_f32 v210, v210
    v_mfma_f32_16x16x32_bf16 v[236:239], a[204:207], a[220:223], v[236:239]
    s_and_b32 s51, s28, 1
    v_exp_f32 v211, v211
    v_mfma_f32_16x16x32_bf16 v[236:239], a[208:211], a[224:227], v[236:239]
    s_add_u32 s51, s51, 15
    v_cvt_pk_bf16_f32 v188, v208, v209
    v_cvt_pk_bf16_f32 v191, v210, v211
    v_mfma_f32_16x16x32_bf16 v[236:239], a[212:215], a[228:231], v[236:239]
    ds_read_b128 v[208:211], v244 offset:128
    v_exp_f32 v196, v196
    v_exp_f32 v197, v197
    v_exp_f32 v198, v198
    v_exp_f32 v199, v199
    v_cvt_pk_bf16_f32 v189, v196, v197
    v_cvt_pk_bf16_f32 v192, v198, v199
    ds_read_b128 v[196:199], v245 offset:128
    v_mov_b32 v190, 0
    s_waitcnt lgkmcnt(2)
    s_barrier
    v_mfma_f32_16x16x32_bf16 v[212:215], v[12:15], v[188:191], 0
    ds_read_b128 a[232:235], v242 offset:49152
    ds_read_b128 a[236:239], v243 offset:49152
    v_mfma_f32_16x16x32_bf16 v[216:219], v[42:45], v[188:191], 0
    buffer_store_dwordx4 a[252:255], v250, s[20:23], 0 offen nt
    v_mfma_f32_16x16x32_bf16 v[220:223], v[72:75], v[188:191], 0
    ds_read_b128 a[240:243], v242 offset:49280
    v_max3_f32 v248, v248, v224, v225
    v_mfma_f32_16x16x32_bf16 v[224:227], a[248:251], v[188:191], 0
    s_waitcnt lgkmcnt(4)
    ds_read_b128 a[244:247], v243 offset:49280
    v_mfma_f32_16x16x32_bf16 v[208:211], v[120:123], v[174:177], v[208:211]
    buffer_store_dwordx2 v[254:255], v251, s[20:23], 0 offen offset:256 nt
    v_mfma_f32_16x16x32_bf16 v[208:211], v[122:125], v[176:179], v[208:211]
    ds_read_b64 v[254:255], v253 offset:18688
    ds_read_b128 a[216:219], v242 offset:49408
    s_waitcnt lgkmcnt(6)
    v_mfma_f32_16x16x32_bf16 v[196:199], v[144:147], v[174:177], v[196:199]
    ds_read_b128 a[252:255], v252 offset:18432
    ds_read_b128 a[220:223], v243 offset:49408
    v_mfma_f32_16x16x32_bf16 v[196:199], v[146:149], v[176:179], v[196:199]
    v_exp_f32 v200, v200
    v_exp_f32 v201, v201
    v_exp_f32 v204, v204
    v_exp_f32 v205, v205
    v_cvt_pk_bf16_f32 v194, v200, v201
    v_cvt_pk_bf16_f32 v195, v204, v205
    v_mov_b32 v193, 0
    v_exp_f32 v202, v202
    v_exp_f32 v203, v203
    v_mfma_f32_16x16x32_bf16 v[212:215], v[16:19], v[192:195], v[212:215]
    s_mul_i32 s51, s51, s30
    v_exp_f32 v206, v206
    v_mfma_f32_16x16x32_bf16 v[216:219], v[46:49], v[192:195], v[216:219]
    v_exp_f32 v207, v207
    v_mfma_f32_16x16x32_bf16 v[220:223], v[76:79], v[192:195], v[220:223]
    v_exp_f32 v208, v208
    v_mfma_f32_16x16x32_bf16 v[224:227], a[248:251], v[192:195], v[224:227]
    v_exp_f32 v209, v209
    v_exp_f32 v210, v210
    v_exp_f32 v211, v211
    v_exp_f32 v196, v196
    v_exp_f32 v197, v197
    v_exp_f32 v198, v198
    v_exp_f32 v199, v199
    v_cvt_pk_bf16_f32 v181, v202, v203
    v_cvt_pk_bf16_f32 v182, v206, v207
    v_mov_b32 v180, 0
    v_mov_b32 v183, 0
    v_cvt_pk_bf16_f32 v184, v208, v209
    v_cvt_pk_bf16_f32 v187, v210, v211
    v_mfma_f32_16x16x32_bf16 v[212:215], v[20:23], v[180:183], v[212:215]
    v_cvt_pk_bf16_f32 v185, v196, v197
    v_mov_b32 v186, 0
    v_mfma_f32_16x16x32_bf16 v[216:219], v[50:53], v[180:183], v[216:219]
    v_cvt_pk_bf16_f32 v188, v198, v199
    v_mov_b32 v189, 0
    v_mfma_f32_16x16x32_bf16 v[220:223], v[80:83], v[180:183], v[220:223]
    v_mov_b32 v191, 0
    v_cvt_pk_bf16_f32 v228, v228, v229
    v_mfma_f32_16x16x32_bf16 v[224:227], a[248:251], v[180:183], v[224:227]
    v_cvt_pk_bf16_f32 v232, v232, v233
    v_cvt_pk_bf16_f32 v236, v236, v237
    v_mfma_f32_16x16x32_bf16 v[212:215], v[24:27], v[184:187], v[212:215]
    v_cvt_pk_bf16_f32 v229, v230, v231
    v_cvt_pk_bf16_f32 v233, v234, v235
    v_mfma_f32_16x16x32_bf16 v[216:219], v[54:57], v[184:187], v[216:219]
    v_cvt_pk_bf16_f32 v237, v238, v239
    v_add_u32 v251, s57, v251
    v_mfma_f32_16x16x32_bf16 v[220:223], v[84:87], v[184:187], v[220:223]
    ds_write_b64 v249, v[228:229] offset:0
    v_mfma_f32_16x16x32_bf16 v[224:227], a[248:251], v[184:187], v[224:227]
    s_waitcnt lgkmcnt(1)
    v_add_u32 v250, s57, v250
    s_lshr_b32 s57, s28, 1
    v_mfma_f32_16x16x32_bf16 v[212:215], v[28:31], v[188:191], v[212:215]
    ds_write_b64 v249, v[232:233] offset:128
    v_mfma_f32_16x16x32_bf16 v[216:219], v[58:61], v[188:191], v[216:219]
    ds_write_b64 v249, v[236:237] offset:256
    v_mfma_f32_16x16x32_bf16 v[220:223], v[88:91], v[188:191], v[220:223]
    buffer_store_dwordx2 v[254:255], v251, s[20:23], 0 offen offset:256 nt
    v_mfma_f32_16x16x32_bf16 v[224:227], a[248:251], v[188:191], v[224:227]
    ds_read_b64 v[254:255], v253 offset:24832
    v_add_u32 v251, s52, v251
    v_mfma_f32_16x16x32_bf16 v[228:231], a[144:147], a[232:235], 0
    s_lshl2_add_u32 s57, s57, 3
    s_mul_i32 s57, s57, s31
    s_add_u32 s56, s56, s57
    v_mfma_f32_16x16x32_bf16 v[228:231], a[148:151], a[236:239], v[228:231]
    s_add_u32 s56, s56, s32
    v_rcp_f32 v225, v224
    v_mfma_f32_16x16x32_bf16 v[228:231], a[152:155], a[240:243], v[228:231]
    buffer_store_dwordx4 a[252:255], v250, s[20:23], 0 offen nt
    v_mfma_f32_16x16x32_bf16 v[228:231], a[156:159], a[244:247], v[228:231]
    v_max3_f32 v248, v248, v224, v225
    v_mov_b32 v226, 0x5d800000
    v_mfma_f32_16x16x32_bf16 v[228:231], a[160:163], a[216:219], v[228:231]
    ds_read_b128 a[252:255], v252 offset:24576
    v_cmp_gt_f32 vcc, v248, v226
    v_mfma_f32_16x16x32_bf16 v[228:231], a[164:167], a[220:223], v[228:231]
    v_mul_f32 v212, v212, v225
    v_mul_f32 v213, v213, v225
    v_mfma_f32_16x16x32_bf16 v[232:235], a[168:171], a[232:235], 0
    s_cmp_lg_u64 vcc, 0
    s_cselect_b32 s66, 1, 0
    v_mul_f32 v214, v214, v225
    v_mul_f32 v215, v215, v225
    v_mfma_f32_16x16x32_bf16 v[232:235], a[172:175], a[236:239], v[232:235]
    s_waitcnt lgkmcnt(1)
    v_cvt_pk_bf16_f32 v212, v212, v213
    v_mul_f32 v216, v216, v225
    v_mfma_f32_16x16x32_bf16 v[232:235], a[176:179], a[240:243], v[232:235]
    v_mul_f32 v217, v217, v225
    v_cvt_pk_bf16_f32 v213, v214, v215
    v_mfma_f32_16x16x32_bf16 v[232:235], a[180:183], a[244:247], v[232:235]
    v_mul_f32 v218, v218, v225
    v_mul_f32 v219, v219, v225
    v_mfma_f32_16x16x32_bf16 v[232:235], a[184:187], a[216:219], v[232:235]
    v_cvt_pk_bf16_f32 v216, v216, v217
    v_mul_f32 v220, v220, v225
    v_mfma_f32_16x16x32_bf16 v[232:235], a[188:191], a[220:223], v[232:235]
    v_mul_f32 v221, v221, v225
    v_cvt_pk_bf16_f32 v217, v218, v219
    v_mfma_f32_16x16x32_bf16 v[236:239], a[192:195], a[232:235], 0
    ds_write_b64 v247, v[212:213] offset:55296
    v_mfma_f32_16x16x32_bf16 v[236:239], a[196:199], a[236:239], v[236:239]
    v_mul_f32 v222, v222, v225
    v_mul_f32 v223, v223, v225
    v_mfma_f32_16x16x32_bf16 v[236:239], a[200:203], a[240:243], v[236:239]
    v_cvt_pk_bf16_f32 v220, v220, v221
    v_cvt_pk_bf16_f32 v228, v228, v229
    v_mfma_f32_16x16x32_bf16 v[236:239], a[204:207], a[244:247], v[236:239]
    v_cvt_pk_bf16_f32 v232, v232, v233
    v_cvt_pk_bf16_f32 v221, v222, v223
    v_mfma_f32_16x16x32_bf16 v[236:239], a[208:211], a[216:219], v[236:239]
    ds_write_b64 v247, v[216:217] offset:55424
    v_mfma_f32_16x16x32_bf16 v[236:239], a[212:215], a[220:223], v[236:239]
    v_mov_b32 v225, s66
    v_mov_b32 v226, s67
    v_cvt_pk_bf16_f32 v229, v230, v231
    v_cvt_pk_bf16_f32 v233, v234, v235
    ds_write_b64 v247, v[220:221] offset:55552
    ds_write_b32 v226, v225 offset:0
    ds_write_b64 v249, v[228:229] offset:6144
    ds_write_b64 v249, v[232:233] offset:6272
    v_cvt_pk_bf16_f32 v236, v236, v237
    v_cvt_pk_bf16_f32 v237, v238, v239
    ds_write_b64 v249, v[236:237] offset:6400
    buffer_store_dwordx2 v[254:255], v251, s[20:23], 0 offen offset:256 nt
    v_mbcnt_lo_u32_b32 v254, -1, 0
    v_mbcnt_hi_u32_b32 v254, -1, v254
    v_add_u32 v250, s52, v250
    v_lshrrev_b32 v255, 4, v254
    s_waitcnt lgkmcnt(5)
    v_add_u32 v251, s55, v255
    s_mul_i32 s55, s55, s31
    s_add_u32 s54, s54, s55
    v_cmp_gt_u32 vcc, 17, v251
    s_add_u32 s54, s54, s32
    v_and_b32 v254, 15, v254
    buffer_store_dwordx4 a[252:255], v250, s[20:23], 0 offen nt
    s_lshr_b32 s52, s28, 1
    s_lshl2_add_u32 s52, s52, 11
    v_mul_i32_i24 v250, s31, v255
    v_add_u32 v250, s54, v250
    v_add_u32 v250, 0x80000000, v250
    v_cndmask_b32 v250, 0, v250, vcc
    v_add_u32 v250, 0x80000000, v250
    v_lshlrev_b32 v255, 3, v255
    v_lshl_add_u32 v251, v254, 3, v250
    v_and_b32 v255, 8, v255
    v_xor_b32 v254, v254, v255
    s_waitcnt lgkmcnt(0)
    s_barrier
    v_lshl_add_u32 v250, v254, 4, v250
    ds_read_b64 v[254:255], v253 offset:256
    ds_read_b128 a[252:255], v252 offset:0
    ds_read_b128 a[224:227], v242 offset:55296
    ds_read_b128 a[228:231], v243 offset:55296
    ds_read_b128 a[232:235], v242 offset:55424
    ds_read_b128 a[236:239], v243 offset:55424
    ds_read_b128 a[240:243], v242 offset:55552
    ds_read_b128 a[244:247], v243 offset:55552
    v_mov_b32 v226, 0x23000
    ds_read_b128 v[196:199], v226 offset:0
    s_waitcnt lgkmcnt(8)
    buffer_store_dwordx2 v[254:255], v251, s[20:23], 0 offen offset:256 nt
    s_waitcnt lgkmcnt(7)
    v_mbcnt_lo_u32_b32 v254, -1, 0
    v_mbcnt_hi_u32_b32 v254, -1, v254
    s_waitcnt lgkmcnt(6)
    v_mfma_f32_16x16x32_bf16 v[228:231], a[144:147], a[224:227], 0
    v_lshrrev_b32 v255, 4, v254
    s_waitcnt lgkmcnt(5)
    v_mfma_f32_16x16x32_bf16 v[228:231], a[148:151], a[228:231], v[228:231]
    v_and_b32 v254, 15, v254
    s_waitcnt lgkmcnt(4)
    v_mfma_f32_16x16x32_bf16 v[228:231], a[152:155], a[232:235], v[228:231]
    buffer_store_dwordx4 a[252:255], v250, s[20:23], 0 offen nt
    v_mfma_f32_16x16x32_bf16 v[232:235], a[168:171], a[224:227], 0
    s_waitcnt lgkmcnt(2)
    v_mul_i32_i24 v250, s31, v255
    v_add_u32 v250, s56, v250
    v_mfma_f32_16x16x32_bf16 v[228:231], a[156:159], a[236:239], v[228:231]
    v_lshlrev_b32 v255, 3, v255
    v_lshl_add_u32 v251, v254, 3, v250
    v_mfma_f32_16x16x32_bf16 v[228:231], a[160:163], a[240:243], v[228:231]
    s_waitcnt lgkmcnt(0)
    v_and_b32 v255, 8, v255
    v_xor_b32 v254, v254, v255
    v_mfma_f32_16x16x32_bf16 v[228:231], a[164:167], a[244:247], v[228:231]
    ds_read_b128 a[252:255], v252 offset:6144
    v_lshl_add_u32 v250, v254, 4, v250
    v_mfma_f32_16x16x32_bf16 v[232:235], a[172:175], a[228:231], v[232:235]
    ds_read_b64 v[254:255], v253 offset:6400
    v_or3_b32 v225, v196, v197, v198
    v_mfma_f32_16x16x32_bf16 v[232:235], a[176:179], a[232:235], v[232:235]
    v_or_b32 v225, v225, v199
    v_mfma_f32_16x16x32_bf16 v[232:235], a[180:183], a[236:239], v[232:235]
    v_cvt_pk_bf16_f32 v228, v228, v229
    v_cvt_pk_bf16_f32 v229, v230, v231
    v_mfma_f32_16x16x32_bf16 v[232:235], a[184:187], a[240:243], v[232:235]
    ds_write_b64 v249, v[228:229] offset:12288
    v_mfma_f32_16x16x32_bf16 v[232:235], a[188:191], a[244:247], v[232:235]
    v_readfirstlane_b32 s47, v225
    v_mfma_f32_16x16x32_bf16 v[236:239], a[192:195], a[224:227], 0
    v_mfma_f32_16x16x32_bf16 v[236:239], a[196:199], a[228:231], v[236:239]
    v_mfma_f32_16x16x32_bf16 v[236:239], a[200:203], a[232:235], v[236:239]
    s_waitcnt lgkmcnt(2)
    v_mfma_f32_16x16x32_bf16 v[236:239], a[204:207], a[236:239], v[236:239]
    s_waitcnt lgkmcnt(1)
    v_mfma_f32_16x16x32_bf16 v[236:239], a[208:211], a[240:243], v[236:239]
    v_cvt_pk_bf16_f32 v232, v232, v233
    v_cvt_pk_bf16_f32 v233, v234, v235
    v_mfma_f32_16x16x32_bf16 v[236:239], a[212:215], a[244:247], v[236:239]
    ds_write_b64 v249, v[232:233] offset:12416
    buffer_store_dwordx2 v[254:255], v251, s[20:23], 0 offen offset:256 nt
    v_mbcnt_lo_u32_b32 v254, -1, 0
    v_mbcnt_hi_u32_b32 v254, -1, v254
    v_lshrrev_b32 v255, 4, v254
    v_add_u32 v251, s52, v255
    s_mul_i32 s52, s52, s31
    s_add_u32 s51, s51, s52
    v_cvt_pk_bf16_f32 v236, v236, v237
    v_cvt_pk_bf16_f32 v237, v238, v239
    ds_write_b64 v249, v[236:237] offset:12544
    buffer_store_dwordx4 a[252:255], v250, s[20:23], 0 offen nt
    v_cmp_gt_u32 vcc, 17, v251
    s_add_u32 s51, s51, s32
    v_mul_i32_i24 v250, s31, v255
    v_add_u32 v250, s51, v250
    v_add_u32 v250, 0x80000000, v250
    v_cndmask_b32 v250, 0, v250, vcc
    v_add_u32 v250, 0x80000000, v250
    v_and_b32 v254, 15, v254
    v_lshlrev_b32 v255, 3, v255
    v_lshl_add_u32 v251, v254, 3, v250
    v_and_b32 v255, 8, v255
    v_xor_b32 v254, v254, v255
    v_lshl_add_u32 v250, v254, 4, v250
    s_waitcnt lgkmcnt(0)
    s_barrier
    ds_read_b128 a[252:255], v252 offset:12288
    ds_read_b64 v[254:255], v253 offset:12544
    s_waitcnt lgkmcnt(1)
    buffer_store_dwordx4 a[252:255], v250, s[20:23], 0 offen nt
    s_waitcnt lgkmcnt(0)
    buffer_store_dwordx2 v[254:255], v251, s[20:23], 0 offen offset:256 nt
    s_nop 4
    s_cmp_lg_u32 s47, 0
    s_cbranch_scc1 L_safe
L_exit:
    s_endpgm
L_safe:
    s_waitcnt vmcnt(0) lgkmcnt(0)
    s_nop 7
    s_barrier
    v_mbcnt_lo_u32_b32 v1, -1, 0
    v_mbcnt_hi_u32_b32 v1, -1, v1
    s_lshl_b32 s51, s28, 1
    s_add_u32 s50, s31, 0xfffffe80
    s_mul_i32 s52, s36, 0x1d00
    v_lshrrev_b32 v2, 3, v1
    v_and_b32 v3, 7, v1
    v_xor_b32 v3, s51, v3
    v_lshl_add_u32 v4, v2, 7, s52
    v_mul_u32_u24 v8, 11, v2
    v_bfe_u32 v9, v8, 6, 1
    v_lshrrev_b32 v8, 5, v8
    v_xor_b32 v9, v3, v9
    v_mad_i32_i24 v8, v8, s50, v4
    v_lshl_add_u32 v168, v9, 4, v8
    v_add_u32 v8, 8, v2
    v_mul_u32_u24 v8, 11, v8
    v_bfe_u32 v9, v8, 6, 1
    v_lshrrev_b32 v8, 5, v8
    v_xor_b32 v9, v3, v9
    v_mad_i32_i24 v8, v8, s50, v4
    v_lshl_add_u32 v169, v9, 4, v8
    v_add_u32 v8, 16, v2
    v_mul_u32_u24 v8, 11, v8
    v_bfe_u32 v9, v8, 6, 1
    v_lshrrev_b32 v8, 5, v8
    v_xor_b32 v9, v3, v9
    v_mad_i32_i24 v8, v8, s50, v4
    v_lshl_add_u32 v170, v9, 4, v8
    s_movk_i32 s53, 0x480
    s_movk_i32 s54, -96
    v_lshrrev_b32 v10, 1, v1
    v_lshlrev_b32 v12, 4, v1
    v_mul_u32_u24 v8, 43, v10
    v_lshrrev_b32 v9, 8, v8
    v_lshrrev_b32 v8, 7, v8
    v_and_b32 v9, 4, v9
    v_xor_b32 v9, v8, v9
    v_mad_i32_i24 v8, v8, s54, v12
    v_mad_u32_u24 v172, v9, s53, v8
    v_add_u32 v8, 32, v10
    v_mul_u32_u24 v8, 43, v8
    v_lshrrev_b32 v9, 8, v8
    v_lshrrev_b32 v8, 7, v8
    v_and_b32 v9, 4, v9
    v_xor_b32 v9, v8, v9
    v_mad_i32_i24 v8, v8, s54, v12
    v_mad_u32_u24 v173, v9, s53, v8
    v_add_u32 v8, 64, v10
    v_mul_u32_u24 v8, 43, v8
    v_lshrrev_b32 v9, 8, v8
    v_lshrrev_b32 v8, 7, v8
    v_and_b32 v9, 4, v9
    v_xor_b32 v9, v8, v9
    v_mad_i32_i24 v8, v8, s54, v12
    v_mad_u32_u24 v174, v9, s53, v8
L_safe2:
    s_add_u32 s59, s40, s45
    s_add_u32 m0, s46, 0xc00
    s_add_u32 s60, s39, 0x180
    buffer_load_dwordx4 v168, s[4:7], s59 offen lds
    s_add_u32 m0, s29, 0
    s_add_u32 s52, s40, 0
    buffer_load_dwordx4 v172, s[8:11], s60 offen lds
    s_add_u32 m0, s46, 0xc00
    v_add_u32 v5, s52, v168
    buffer_load_dwordx4 v169, s[4:7], s59 offen offset:1024 lds
    s_add_u32 m0, s29, 0
    v_max_i32 v5, 0, v5
    buffer_load_dwordx4 v173, s[8:11], s60 offen offset:1024 lds
    s_add_u32 m0, s46, 0xc00
    s_add_u32 s61, s39, 0x9180
    buffer_load_dwordx4 v170, s[4:7], s59 offen offset:2048 lds
    s_add_u32 m0, s29, 0
    s_add_u32 s53, s40, 0x400
    buffer_load_dwordx4 v174, s[8:11], s60 offen offset:2048 lds
    s_add_u32 m0, s46, 0
    v_add_u32 v6, s53, v169
    buffer_load_dwordx4 v5, s[4:7], 0 offen lds
    s_add_u32 m0, s29, 0xc00
    v_max_i32 v6, 0, v6
    buffer_load_dwordx4 v172, s[8:11], s61 offen lds
    s_add_u32 m0, s46, 0x400
    s_add_u32 s54, s40, 0x800
    buffer_load_dwordx4 v6, s[4:7], 0 offen lds
    s_add_u32 m0, s29, 0xc00
    v_add_u32 v7, s54, v170
    buffer_load_dwordx4 v173, s[8:11], s61 offen offset:1024 lds
    v_max_i32 v7, 0, v7
    s_add_u32 m0, s46, 0x800
    s_add_u32 s62, s39, 0x12180
    buffer_load_dwordx4 v7, s[4:7], 0 offen lds
    s_add_u32 m0, s29, 0xc00
    s_add_u32 s59, s41, s45
    buffer_load_dwordx4 v174, s[8:11], s61 offen offset:2048 lds
    s_add_u32 m0, s46, 0x7800
    s_add_u32 s63, s39, 0x1b180
    s_add_u32 s60, s39, 0x24180
    s_add_u32 s61, s39, 0x2d180
    s_and_b32 s65, s48, 0xfff0
    s_lshl1_add_u32 s58, s45, s40
    v_and_b32 v13, 15, v1
    v_lshrrev_b32 v14, 4, v1
    v_lshrrev_b32 v15, 2, v13
    v_and_b32 v16, 3, v13
    v_and_b32 v17, 1, v14
    v_lshl_add_u32 v18, v14, 3, v15
    v_xor_b32 v19, 0, v17
    v_lshl_add_u32 v19, v19, 2, v18
    v_mul_u32_u24 v19, 0x60, v19
    v_lshl_add_u32 v19, v16, 3, v19
    v_add_u32 v249, s29, v19
    v_xor_b32 v19, 1, v17
    v_lshl_add_u32 v19, v19, 2, v18
    v_mul_u32_u24 v19, 0x60, v19
    v_lshl_add_u32 v19, v16, 3, v19
    v_add_u32 v250, s29, v19
    v_mov_b32 v17, v15
    v_and_b32 v18, 3, v17
    v_mul_u32_u24 v17, 0x1e00, v17
    v_lshlrev_b32 v18, 1, v18
    v_bfe_u32 v241, v16, 1, 1
    v_or_b32 v18, v18, v241
    v_xor_b32 v18, v18, v14
    v_lshl_add_u32 v17, v18, 4, v17
    v_mul_u32_u24 v18, 0x180, v16
    v_add_u32 v240, v17, v18
    v_xor_b32 v241, 64, v240
    s_add_u32 s55, s28, 3
    s_mov_b32 s56, 3
    s_mul_i32 s55, s55, s30
    s_mul_i32 s56, s56, s31
    s_add_u32 s55, s55, s56
    s_add_u32 s55, s55, s32
    s_mul_i32 s57, s30, 0
    s_mul_i32 s51, s31, 4
    s_add_u32 s57, s57, s51
    s_mul_i32 s52, s30, 0
    s_mul_i32 s53, s31, 4
    s_add_u32 s52, s52, s53
    s_mul_i32 s54, s30, 4
    s_mul_i32 s56, s30, 0
    s_mul_i32 s51, s30, 0
    s_add_u32 s53, s28, 3
    s_mul_i32 s53, s53, s30
    buffer_load_dwordx4 v168, s[4:7], s41 offen lds
    s_add_u32 m0, s29, 0x1800
    s_nop 0
    buffer_load_dwordx4 v172, s[8:11], s62 offen lds
    s_add_u32 m0, s46, 0x7800
    s_nop 0
    buffer_load_dwordx4 v169, s[4:7], s41 offen offset:1024 lds
    s_add_u32 m0, s29, 0x1800
    s_nop 0
    buffer_load_dwordx4 v173, s[8:11], s62 offen offset:1024 lds
    s_add_u32 m0, s46, 0x7800
    s_nop 0
    buffer_load_dwordx4 v170, s[4:7], s41 offen offset:2048 lds
    s_add_u32 m0, s29, 0x1800
    s_nop 0
    buffer_load_dwordx4 v174, s[8:11], s62 offen offset:2048 lds
    s_add_u32 m0, s46, 0x8400
    s_add_u32 s62, s39, 0x300
    s_waitcnt vmcnt(12)
    ds_read_b64_tr_b16 a[0:1], v249 offset:0
    ds_read_b64_tr_b16 a[2:3], v250 offset:0
    ds_read_b64_tr_b16 a[24:25], v249 offset:32
    ds_read_b64_tr_b16 a[26:27], v250 offset:32
    ds_read_b64_tr_b16 a[48:49], v249 offset:64
    ds_read_b64_tr_b16 a[50:51], v250 offset:64
    buffer_load_dwordx4 v168, s[4:7], s59 offen lds
    s_add_u32 m0, s29, 0x2400
    s_nop 0
    buffer_load_dwordx4 v172, s[8:11], s63 offen lds
    s_add_u32 m0, s46, 0x8400
    s_nop 0
    buffer_load_dwordx4 v169, s[4:7], s59 offen offset:1024 lds
    s_add_u32 m0, s29, 0x2400
    s_nop 0
    buffer_load_dwordx4 v173, s[8:11], s63 offen offset:1024 lds
    s_add_u32 m0, s46, 0x8400
    s_nop 0
    buffer_load_dwordx4 v170, s[4:7], s59 offen offset:2048 lds
    s_add_u32 m0, s29, 0x2400
    s_add_u32 s59, s42, s45
    s_waitcnt vmcnt(12)
    s_barrier
    ds_read_b128 a[216:219], v240 offset:0
    ds_read_b128 a[220:223], v240 offset:1536
    ds_read_b128 a[224:227], v240 offset:3072
    ds_read_b128 a[228:231], v240 offset:4608
    ds_read_b128 a[232:235], v241 offset:0
    ds_read_b128 a[236:239], v241 offset:1536
    ds_read_b128 a[240:243], v241 offset:3072
    ds_read_b128 a[244:247], v241 offset:4608
    buffer_load_dwordx4 v174, s[8:11], s63 offen offset:2048 lds
    s_add_u32 m0, s29, 0
    s_waitcnt vmcnt(12) lgkmcnt(8)
    s_add_u32 s63, s39, 0x9300
    ds_read_b64_tr_b16 a[4:5], v249 offset:3072
    ds_read_b64_tr_b16 a[6:7], v250 offset:3072
    ds_read_b64_tr_b16 a[28:29], v249 offset:3104
    ds_read_b64_tr_b16 a[30:31], v250 offset:3104
    ds_read_b64_tr_b16 a[52:53], v249 offset:3136
    ds_read_b64_tr_b16 a[54:55], v250 offset:3136
    buffer_load_dwordx4 v172, s[8:11], s60 offen lds
    s_waitcnt lgkmcnt(13)
    v_mfma_f32_16x16x32_bf16 v[180:183], a[0:3], a[216:219], 0
    v_mfma_f32_16x16x32_bf16 v[184:187], a[24:27], a[216:219], 0
    s_waitcnt lgkmcnt(12)
    v_mfma_f32_16x16x32_bf16 v[188:191], a[48:51], a[216:219], 0
    ds_read_b128 a[216:219], v240 offset:128
    s_waitcnt lgkmcnt(11)
    v_mfma_f32_16x16x32_bf16 v[192:195], a[0:3], a[220:223], 0
    buffer_load_dwordx4 v173, s[8:11], s60 offen offset:1024 lds
    v_mfma_f32_16x16x32_bf16 v[196:199], a[24:27], a[220:223], 0
    v_mfma_f32_16x16x32_bf16 v[200:203], a[48:51], a[220:223], 0
    ds_read_b128 a[220:223], v240 offset:1664
    v_mfma_f32_16x16x32_bf16 v[204:207], a[0:3], a[224:227], 0
    v_mfma_f32_16x16x32_bf16 v[208:211], a[24:27], a[224:227], 0
    v_mfma_f32_16x16x32_bf16 v[212:215], a[48:51], a[224:227], 0
    buffer_load_dwordx4 v174, s[8:11], s60 offen offset:2048 lds
    s_add_u32 m0, s29, 0xc00
    v_mfma_f32_16x16x32_bf16 v[216:219], a[0:3], a[228:231], 0
    s_add_u32 s60, s39, 0x12300
    ds_read_b128 a[224:227], v240 offset:3200
    v_mfma_f32_16x16x32_bf16 v[220:223], a[24:27], a[228:231], 0
    s_waitcnt lgkmcnt(3)
    v_mfma_f32_16x16x32_bf16 v[224:227], a[48:51], a[228:231], 0
    ds_read_b128 a[228:231], v240 offset:4736
    v_mfma_f32_16x16x32_bf16 v[180:183], a[4:7], a[232:235], v[180:183]
    buffer_load_dwordx4 v172, s[8:11], s61 offen lds
    v_mfma_f32_16x16x32_bf16 v[184:187], a[28:31], a[232:235], v[184:187]
    v_mfma_f32_16x16x32_bf16 v[188:191], a[52:55], a[232:235], v[188:191]
    v_mfma_f32_16x16x32_bf16 v[192:195], a[4:7], a[236:239], v[192:195]
    v_mfma_f32_16x16x32_bf16 v[196:199], a[28:31], a[236:239], v[196:199]
    v_mfma_f32_16x16x32_bf16 v[200:203], a[52:55], a[236:239], v[200:203]
    buffer_load_dwordx4 v173, s[8:11], s61 offen offset:1024 lds
    v_mfma_f32_16x16x32_bf16 v[204:207], a[4:7], a[240:243], v[204:207]
    v_mfma_f32_16x16x32_bf16 v[208:211], a[28:31], a[240:243], v[208:211]
    v_mfma_f32_16x16x32_bf16 v[212:215], a[52:55], a[240:243], v[212:215]
    v_mfma_f32_16x16x32_bf16 v[216:219], a[4:7], a[244:247], v[216:219]
    buffer_load_dwordx4 v174, s[8:11], s61 offen offset:2048 lds
    s_add_u32 m0, s37, 0xd80
    v_mfma_f32_16x16x32_bf16 v[220:223], a[28:31], a[244:247], v[220:223]
    s_add_u32 s61, s39, 0x1b300
    s_waitcnt vmcnt(12)
    v_mfma_f32_16x16x32_bf16 v[224:227], a[52:55], a[244:247], v[224:227]
    ds_read_b64_tr_b16 a[8:9], v249 offset:6144
    ds_read_b64_tr_b16 a[10:11], v250 offset:6144
    ds_read_b64_tr_b16 a[32:33], v249 offset:6176
    ds_read_b64_tr_b16 a[34:35], v250 offset:6176
    ds_read_b64_tr_b16 a[56:57], v249 offset:6208
    ds_read_b64_tr_b16 a[58:59], v250 offset:6208
    buffer_load_dwordx4 v12, s[16:19], s65 offen lds
    s_add_u32 m0, s29, 0x1800
    s_waitcnt lgkmcnt(4)
    v_mfma_f32_16x16x32_bf16 v[180:183], a[8:11], a[216:219], v[180:183]
    v_mfma_f32_16x16x32_bf16 v[192:195], a[8:11], a[220:223], v[192:195]
    s_waitcnt lgkmcnt(1)
    v_mfma_f32_16x16x32_bf16 v[184:187], a[32:35], a[216:219], v[184:187]
    s_waitcnt lgkmcnt(0)
    buffer_load_dwordx4 v172, s[8:11], s62 offen lds
    v_mfma_f32_16x16x32_bf16 v[188:191], a[56:59], a[216:219], v[188:191]
    v_mfma_f32_16x16x32_bf16 v[196:199], a[32:35], a[220:223], v[196:199]
    v_mfma_f32_16x16x32_bf16 v[200:203], a[56:59], a[220:223], v[200:203]
    v_mfma_f32_16x16x32_bf16 v[204:207], a[8:11], a[224:227], v[204:207]
    buffer_load_dwordx4 v173, s[8:11], s62 offen offset:1024 lds
    s_add_u32 s50, s31, 0xfffffe80
    v_mfma_f32_16x16x32_bf16 v[208:211], a[32:35], a[224:227], v[208:211]
    s_and_b32 s66, s28, 1
    v_add_u32 v8, 4, v2
    v_mul_u32_u24 v8, 11, v8
    v_mfma_f32_16x16x32_bf16 v[212:215], a[56:59], a[224:227], v[212:215]
    s_lshl_b32 s66, s66, 2
    v_bfe_u32 v9, v8, 6, 1
    v_lshrrev_b32 v8, 5, v8
    v_mfma_f32_16x16x32_bf16 v[216:219], a[8:11], a[228:231], v[216:219]
    s_lshr_b32 s67, s28, 1
    v_xor_b32 v9, v3, v9
    v_mad_i32_i24 v8, v8, s50, v4
    v_mfma_f32_16x16x32_bf16 v[220:223], a[32:35], a[228:231], v[220:223]
    buffer_load_dwordx4 v174, s[8:11], s62 offen offset:2048 lds
    s_add_u32 m0, s29, 0x2400
    v_mfma_f32_16x16x32_bf16 v[224:227], a[56:59], a[228:231], v[224:227]
    s_add_u32 s62, s39, 0x24300
    s_waitcnt vmcnt(11)
    s_barrier
    ds_read_b128 a[232:235], v240 offset:30720
    ds_read_b128 a[236:239], v240 offset:32256
    ds_read_b128 a[240:243], v240 offset:33792
    ds_read_b128 a[244:247], v240 offset:35328
    ds_read_b128 a[216:219], v241 offset:30720
    ds_read_b128 a[220:223], v241 offset:32256
    ds_read_b128 a[224:227], v241 offset:33792
    ds_read_b128 a[228:231], v241 offset:35328
    v_lshl_add_u32 v171, v9, 4, v8
    s_waitcnt vmcnt(10)
    ds_read_b64_tr_b16 a[12:13], v249 offset:9216
    ds_read_b64_tr_b16 a[14:15], v250 offset:9216
    ds_read_b64_tr_b16 a[36:37], v249 offset:9248
    ds_read_b64_tr_b16 a[38:39], v250 offset:9248
    ds_read_b64_tr_b16 a[60:61], v249 offset:9280
    ds_read_b64_tr_b16 a[62:63], v250 offset:9280
    v_mbcnt_lo_u32_b32 v67, -1, 0
    v_mbcnt_hi_u32_b32 v67, -1, v67
    v_lshrrev_b32 v68, 1, v67
    v_add_u32 v68, 0, v68
    v_mul_u32_u24 v69, 43, v68
    v_lshrrev_b32 v70, 8, v69
    v_lshrrev_b32 v69, 7, v69
    v_mad_i32_i24 v68, v69, -3, v68
    v_and_b32 v70, 4, v70
    v_xor_b32 v69, v69, v70
    v_and_b32 v70, 4, v69
    v_mul_u32_u24 v252, 24, v70
    s_waitcnt lgkmcnt(13)
    v_mfma_f32_16x16x32_bf16 v[228:231], a[0:3], a[232:235], 0
    s_lshl_b32 s67, s67, 3
    v_lshrrev_b32 v70, 3, v69
    v_lshl_add_u32 v252, v70, 2, v252
    v_mfma_f32_16x16x32_bf16 v[232:235], a[24:27], a[232:235], 0
    s_mul_i32 s64, s35, 0xfc0
    v_and_or_b32 v252, v69, 3, v252
    v_mad_u32_u24 v252, v252, 3, v68
    v_mfma_f32_16x16x32_bf16 v[236:239], a[48:51], a[232:235], 0
    s_waitcnt lgkmcnt(11)
    ds_read_b128 a[232:235], v240 offset:30848
    v_mfma_f32_16x16x32_bf16 v[138:141], a[0:3], a[236:239], 0
    s_add_u32 s64, s64, s37
    v_and_b32 v70, 1, v67
    v_lshl_add_u32 v252, v252, 3, v70
    v_mfma_f32_16x16x32_bf16 v[142:145], a[24:27], a[236:239], 0
    s_waitcnt lgkmcnt(10)
    v_lshlrev_b32 v252, 4, v252
    v_lshrrev_b32 v68, 1, v67
    v_mfma_f32_16x16x32_bf16 v[146:149], a[48:51], a[236:239], 0
    ds_read_b128 a[236:239], v240 offset:32384
    v_add_u32 v68, 32, v68
    v_mfma_f32_16x16x32_bf16 v[150:153], a[0:3], a[240:243], 0
    s_waitcnt lgkmcnt(9)
    v_mul_u32_u24 v69, 43, v68
    v_lshrrev_b32 v70, 8, v69
    v_mfma_f32_16x16x32_bf16 v[154:157], a[24:27], a[240:243], 0
    v_lshrrev_b32 v69, 7, v69
    s_waitcnt vmcnt(7)
    v_mfma_f32_16x16x32_bf16 v[158:161], a[48:51], a[240:243], 0
    ds_read_b64_tr_b16 a[16:17], v249 offset:0
    ds_read_b64_tr_b16 a[18:19], v250 offset:0
    v_mfma_f32_16x16x32_bf16 v[162:165], a[0:3], a[244:247], 0
    ds_read_b64_tr_b16 a[40:41], v249 offset:32
    s_waitcnt lgkmcnt(5)
    v_mfma_f32_16x16x32_bf16 v[24:27], a[24:27], a[244:247], 0
    buffer_load_dwordx4 v172, s[8:11], s63 offen lds
    ds_read_b64_tr_b16 a[42:43], v250 offset:32
    v_mfma_f32_16x16x32_bf16 v[54:57], a[48:51], a[244:247], 0
    ds_read_b64_tr_b16 a[64:65], v249 offset:64
    ds_read_b64_tr_b16 a[66:67], v250 offset:64
    v_mfma_f32_16x16x32_bf16 v[228:231], a[4:7], a[216:219], v[228:231]
    ds_read_b128 a[240:243], v240 offset:33920
    ds_read_b128 a[244:247], v240 offset:35456
    v_mfma_f32_16x16x32_bf16 v[232:235], a[28:31], a[216:219], v[232:235]
    s_waitcnt lgkmcnt(8)
    v_mad_i32_i24 v68, v69, -3, v68
    v_and_b32 v70, 4, v70
    v_mfma_f32_16x16x32_bf16 v[236:239], a[52:55], a[216:219], v[236:239]
    buffer_load_dwordx4 v173, s[8:11], s63 offen offset:1024 lds
    ds_read_b128 a[216:219], v241 offset:128
    v_mfma_f32_16x16x32_bf16 v[138:141], a[4:7], a[220:223], v[138:141]
    v_xor_b32 v69, v69, v70
    v_and_b32 v70, 4, v69
    v_mfma_f32_16x16x32_bf16 v[142:145], a[28:31], a[220:223], v[142:145]
    v_mul_u32_u24 v253, 24, v70
    v_lshrrev_b32 v70, 3, v69
    v_mfma_f32_16x16x32_bf16 v[146:149], a[52:55], a[220:223], v[146:149]
    ds_read_b128 a[220:223], v241 offset:1664
    v_lshl_add_u32 v253, v70, 2, v253
    v_mfma_f32_16x16x32_bf16 v[150:153], a[4:7], a[224:227], v[150:153]
    buffer_load_dwordx4 v174, s[8:11], s63 offen offset:2048 lds
    s_add_u32 m0, s29, 0
    v_mfma_f32_16x16x32_bf16 v[154:157], a[28:31], a[224:227], v[154:157]
    s_add_u32 s63, s39, 0x2d300
    v_and_or_b32 v253, v69, 3, v253
    s_waitcnt lgkmcnt(4)
    v_mfma_f32_16x16x32_bf16 v[158:161], a[52:55], a[224:227], v[158:161]
    ds_read_b128 a[224:227], v241 offset:3200
    s_waitcnt vmcnt(7) lgkmcnt(4)
    v_mfma_f32_16x16x32_bf16 v[162:165], a[4:7], a[228:231], v[162:165]
    ds_read_b64_tr_b16 a[20:21], v249 offset:3072
    ds_read_b64_tr_b16 a[22:23], v250 offset:3072
    v_mfma_f32_16x16x32_bf16 v[24:27], a[28:31], a[228:231], v[24:27]
    buffer_load_dwordx4 v172, s[8:11], s60 offen lds
    ds_read_b64_tr_b16 a[44:45], v249 offset:3104
    v_mfma_f32_16x16x32_bf16 v[54:57], a[52:55], a[228:231], v[54:57]
    ds_read_b64_tr_b16 a[46:47], v250 offset:3104
    ds_read_b64_tr_b16 a[68:69], v249 offset:3136
    v_mfma_f32_16x16x32_bf16 v[228:231], a[8:11], a[232:235], v[228:231]
    ds_read_b64_tr_b16 a[70:71], v250 offset:3136
    ds_read_b128 a[228:231], v241 offset:4736
    v_mfma_f32_16x16x32_bf16 v[232:235], a[32:35], a[232:235], v[232:235]
    s_waitcnt lgkmcnt(8)
    v_mad_u32_u24 v253, v253, 3, v68
    v_and_b32 v70, 1, v67
    v_mfma_f32_16x16x32_bf16 v[236:239], a[56:59], a[232:235], v[236:239]
    buffer_load_dwordx4 v173, s[8:11], s60 offen offset:1024 lds
    ds_read_b128 a[232:235], v241 offset:30848
    v_mfma_f32_16x16x32_bf16 v[138:141], a[8:11], a[236:239], v[138:141]
    v_lshl_add_u32 v253, v253, 3, v70
    v_lshlrev_b32 v253, 4, v253
    v_mfma_f32_16x16x32_bf16 v[142:145], a[32:35], a[236:239], v[142:145]
    s_waitcnt lgkmcnt(8)
    v_add_u32 v253, 0xfffffc00, v253
    v_add_u32 v17, 3, v15
    v_mfma_f32_16x16x32_bf16 v[146:149], a[56:59], a[236:239], v[146:149]
    ds_read_b128 a[236:239], v241 offset:32384
    v_add_u32 v19, 3, v16
    v_mfma_f32_16x16x32_bf16 v[150:153], a[8:11], a[240:243], v[150:153]
    buffer_load_dwordx4 v174, s[8:11], s60 offen offset:2048 lds
    s_add_u32 m0, s29, 0xc00
    v_mfma_f32_16x16x32_bf16 v[154:157], a[32:35], a[240:243], v[154:157]
    s_add_u32 s60, s39, 0
    v_and_b32 v18, 3, v17
    v_mul_u32_u24 v17, 0x1e00, v17
    v_mfma_f32_16x16x32_bf16 v[158:161], a[56:59], a[240:243], v[158:161]
    s_waitcnt lgkmcnt(3)
    ds_read_b128 a[240:243], v241 offset:33920
    v_mfma_f32_16x16x32_bf16 v[162:165], a[8:11], a[244:247], v[162:165]
    s_waitcnt lgkmcnt(3)
    v_lshlrev_b32 v18, 1, v18
    v_bfe_u32 v243, v19, 1, 1
    v_mfma_f32_16x16x32_bf16 v[24:27], a[32:35], a[244:247], v[24:27]
    buffer_load_dwordx4 v172, s[8:11], s61 offen lds
    v_or_b32 v18, v18, v243
    v_mfma_f32_16x16x32_bf16 v[54:57], a[56:59], a[244:247], v[54:57]
    ds_read_b128 a[244:247], v241 offset:35456
    v_xor_b32 v18, v18, v14
    v_mfma_f32_16x16x32_bf16 v[180:183], a[12:15], a[216:219], v[180:183]
    s_waitcnt lgkmcnt(3)
    v_lshl_add_u32 v17, v18, 4, v17
    v_mul_u32_u24 v18, 0x180, v19
    v_mfma_f32_16x16x32_bf16 v[184:187], a[36:39], a[216:219], v[184:187]
    v_add_u32 v242, v17, v18
    v_xor_b32 v243, 64, v242
    v_mfma_f32_16x16x32_bf16 v[188:191], a[60:63], a[216:219], v[188:191]
    buffer_load_dwordx4 v173, s[8:11], s61 offen offset:1024 lds
    ds_read_b128 a[216:219], v240 offset:256
    v_mfma_f32_16x16x32_bf16 v[192:195], a[12:15], a[220:223], v[192:195]
    s_waitcnt lgkmcnt(3)
    v_accvgpr_write_b32 a252, v168
    v_accvgpr_read_b32 v254, a252
    v_mfma_f32_16x16x32_bf16 v[196:199], a[36:39], a[220:223], v[196:199]
    s_waitcnt vmcnt(8)
    ds_read_b64_tr_b16 a[72:73], v249 offset:6144
    v_mfma_f32_16x16x32_bf16 v[200:203], a[60:63], a[220:223], v[200:203]
    ds_read_b64_tr_b16 a[74:75], v250 offset:6144
    ds_read_b64_tr_b16 a[96:97], v249 offset:6176
    v_mfma_f32_16x16x32_bf16 v[204:207], a[12:15], a[224:227], v[204:207]
    buffer_load_dwordx4 v174, s[8:11], s61 offen offset:2048 lds
    s_add_u32 m0, s46, 0xf000
    v_mfma_f32_16x16x32_bf16 v[208:211], a[36:39], a[224:227], v[208:211]
    s_add_u32 s61, s39, 0x9000
    ds_read_b64_tr_b16 a[98:99], v250 offset:6176
    v_mfma_f32_16x16x32_bf16 v[212:215], a[60:63], a[224:227], v[212:215]
    ds_read_b64_tr_b16 a[120:121], v249 offset:6208
    ds_read_b64_tr_b16 a[122:123], v250 offset:6208
    v_mfma_f32_16x16x32_bf16 v[216:219], a[12:15], a[228:231], v[216:219]
    ds_read_b128 a[220:223], v240 offset:1792
    ds_read_b128 a[224:227], v240 offset:3328
    v_mfma_f32_16x16x32_bf16 v[220:223], a[36:39], a[228:231], v[220:223]
    buffer_load_dwordx4 v168, s[4:7], s42 offen lds
    s_add_u32 m0, s29, 0x1800
    v_mfma_f32_16x16x32_bf16 v[224:227], a[60:63], a[228:231], v[224:227]
    ds_read_b128 a[228:231], v240 offset:4864
    v_accvgpr_write_b32 a253, v169
    v_mfma_f32_16x16x32_bf16 v[228:231], a[12:15], a[232:235], v[228:231]
    s_waitcnt lgkmcnt(9)
    v_accvgpr_read_b32 v255, a253
    v_accvgpr_write_b32 a254, v170
    v_mfma_f32_16x16x32_bf16 v[232:235], a[36:39], a[232:235], v[232:235]
    v_accvgpr_write_b32 a255, v171
    v_mov_b32 v17, 0x3f803f80
    v_mfma_f32_16x16x32_bf16 v[236:239], a[60:63], a[232:235], v[236:239]
    ds_read_b128 a[232:235], v240 offset:30976
    v_accvgpr_write_b32 a248, v17
    v_mfma_f32_16x16x32_bf16 v[138:141], a[12:15], a[236:239], v[138:141]
    v_accvgpr_write_b32 a249, v17
    v_accvgpr_write_b32 a250, v17
    v_mfma_f32_16x16x32_bf16 v[142:145], a[36:39], a[236:239], v[142:145]
    v_accvgpr_write_b32 a251, v17
    s_waitcnt lgkmcnt(4)
    v_mfma_f32_16x16x32_bf16 v[146:149], a[60:63], a[236:239], v[146:149]
    buffer_load_dwordx4 v172, s[8:11], s62 offen lds
    s_add_u32 m0, s46, 0xf000
    v_mfma_f32_16x16x32_bf16 v[150:153], a[12:15], a[240:243], v[150:153]
    ds_read_b128 a[236:239], v240 offset:32512
    v_mov_b32 v248, 0
    v_mfma_f32_16x16x32_bf16 v[154:157], a[36:39], a[240:243], v[154:157]
    s_waitcnt lgkmcnt(3)
    v_lshrrev_b32 v18, 1, v13
    v_xor_b32 v18, v14, v18
    v_mfma_f32_16x16x32_bf16 v[158:161], a[60:63], a[240:243], v[158:161]
    ds_read_b128 a[240:243], v240 offset:34048
    v_xor_b32 v18, s66, v18
    v_mfma_f32_16x16x32_bf16 v[162:165], a[12:15], a[244:247], v[162:165]
    buffer_load_dwordx4 v169, s[4:7], s42 offen offset:1024 lds
    s_add_u32 m0, s29, 0x1800
    v_mfma_f32_16x16x32_bf16 v[24:27], a[36:39], a[244:247], v[24:27]
    s_lshl_b32 s66, s36, 1
    v_mul_u32_u24 v17, 0x180, v13
    v_lshl_add_u32 v17, v18, 4, v17
    v_mfma_f32_16x16x32_bf16 v[54:57], a[60:63], a[244:247], v[54:57]
    ds_read_b128 a[244:247], v240 offset:35584
    v_add_u32 v17, s67, v17
    v_mfma_f32_16x16x32_bf16 v[180:183], a[16:19], a[216:219], v[180:183]
    s_mul_i32 s67, s28, 0x600
    v_add_u32 v247, 0x7800, v17
    v_add_u32 v251, 0x1e000, v17
    v_mfma_f32_16x16x32_bf16 v[184:187], a[40:43], a[216:219], v[184:187]
    buffer_load_dwordx4 v173, s[8:11], s62 offen offset:1024 lds
    s_add_u32 m0, s46, 0xf000
    v_mfma_f32_16x16x32_bf16 v[188:191], a[64:67], a[216:219], v[188:191]
    ds_read_b128 a[216:219], v241 offset:256
    v_sub_u32 v17, v14, v15
    v_mfma_f32_16x16x32_bf16 v[192:195], a[16:19], a[220:223], v[192:195]
    s_sub_u32 s66, 1, s66
    v_mul_i32_i24 v17, 0x1c0, v17
    v_lshlrev_b32 v18, 4, v16
    v_mfma_f32_16x16x32_bf16 v[196:199], a[40:43], a[220:223], v[196:199]
    s_waitcnt lgkmcnt(3)
    v_sub_u32 v17, v17, v18
    v_add_u32 v17, s37, v17
    v_mfma_f32_16x16x32_bf16 v[200:203], a[64:67], a[220:223], v[200:203]
    buffer_load_dwordx4 v170, s[4:7], s42 offen offset:2048 lds
    s_add_u32 m0, s29, 0x1800
    v_mfma_f32_16x16x32_bf16 v[204:207], a[16:19], a[224:227], v[204:207]
    ds_read_b128 a[220:223], v241 offset:1792
    v_max_u32 v18, s33, v15
    v_mfma_f32_16x16x32_bf16 v[208:211], a[40:43], a[224:227], v[208:211]
    s_waitcnt lgkmcnt(3)
    v_sub_u32 v18, v14, v18
    v_add_u32 v244, 0, v18
    v_mfma_f32_16x16x32_bf16 v[212:215], a[64:67], a[224:227], v[212:215]
    s_waitcnt vmcnt(11) lgkmcnt(2)
    ds_read_b64_tr_b16 a[76:77], v249 offset:9216
    v_mfma_f32_16x16x32_bf16 v[216:219], a[16:19], a[228:231], v[216:219]
    buffer_load_dwordx4 v174, s[8:11], s62 offen offset:2048 lds
    s_add_u32 m0, s46, 0xfc00
    v_mfma_f32_16x16x32_bf16 v[220:223], a[40:43], a[228:231], v[220:223]
    s_add_u32 s62, s39, 0x12000
    ds_read_b64_tr_b16 a[78:79], v250 offset:9216
    v_mfma_f32_16x16x32_bf16 v[224:227], a[64:67], a[228:231], v[224:227]
    ds_read_b64_tr_b16 a[100:101], v249 offset:9248
    ds_read_b64_tr_b16 a[102:103], v250 offset:9248
    v_mfma_f32_16x16x32_bf16 v[228:231], a[16:19], a[232:235], v[228:231]
    ds_read_b64_tr_b16 a[124:125], v249 offset:9280
    ds_read_b64_tr_b16 a[126:127], v250 offset:9280
    v_mfma_f32_16x16x32_bf16 v[232:235], a[40:43], a[232:235], v[232:235]
    buffer_load_dwordx4 v168, s[4:7], s59 offen lds
    s_add_u32 m0, s29, 0x2400
    v_mfma_f32_16x16x32_bf16 v[236:239], a[64:67], a[232:235], v[236:239]
    ds_read_b128 a[224:227], v241 offset:3328
    ds_read_b128 a[228:231], v241 offset:4864
    v_mfma_f32_16x16x32_bf16 v[138:141], a[16:19], a[236:239], v[138:141]
    ds_read_b128 a[232:235], v241 offset:30976
    v_cmp_gt_u32 vcc, 7, v244
    v_mfma_f32_16x16x32_bf16 v[142:145], a[40:43], a[236:239], v[142:145]
    s_waitcnt lgkmcnt(9)
    v_add_u32 v244, 0xfffdc870, v17
    v_cndmask_b32 v244, 0, v244, vcc
    v_mfma_f32_16x16x32_bf16 v[146:149], a[64:67], a[236:239], v[146:149]
    ds_read_b128 a[236:239], v241 offset:32512
    v_add_u32 v244, 0x237c0, v244
    v_mfma_f32_16x16x32_bf16 v[150:153], a[16:19], a[240:243], v[150:153]
    v_add_u32 v245, 4, v18
    v_cmp_gt_u32 vcc, 7, v245
    v_mfma_f32_16x16x32_bf16 v[154:157], a[40:43], a[240:243], v[154:157]
    v_add_u32 v245, 0xfffdcf70, v17
    v_cndmask_b32 v245, 0, v245, vcc
    v_mfma_f32_16x16x32_bf16 v[158:161], a[64:67], a[240:243], v[158:161]
    ds_read_b128 a[240:243], v241 offset:34048
    s_waitcnt lgkmcnt(5)
    v_mfma_f32_16x16x32_bf16 v[162:165], a[16:19], a[244:247], v[162:165]
    buffer_load_dwordx4 v172, s[8:11], s63 offen lds
    s_add_u32 m0, s46, 0xfc00
    v_mfma_f32_16x16x32_bf16 v[24:27], a[40:43], a[244:247], v[24:27]
    s_waitcnt vmcnt(11)
    ds_read_b64_tr_b16 a[80:81], v249 offset:0
    v_mfma_f32_16x16x32_bf16 v[54:57], a[64:67], a[244:247], v[54:57]
    ds_read_b64_tr_b16 a[82:83], v250 offset:0
    ds_read_b64_tr_b16 a[104:105], v249 offset:32
    v_mfma_f32_16x16x32_bf16 v[180:183], a[20:23], a[216:219], v[180:183]
    ds_read_b64_tr_b16 a[106:107], v250 offset:32
    ds_read_b64_tr_b16 a[128:129], v249 offset:64
    v_mfma_f32_16x16x32_bf16 v[184:187], a[44:47], a[216:219], v[184:187]
    buffer_load_dwordx4 v169, s[4:7], s59 offen offset:1024 lds
    s_add_u32 m0, s29, 0x2400
    v_mfma_f32_16x16x32_bf16 v[188:191], a[68:71], a[216:219], v[188:191]
    ds_read_b64_tr_b16 a[130:131], v250 offset:64
    ds_read_b128 a[244:247], v241 offset:35584
    v_mfma_f32_16x16x32_bf16 v[192:195], a[20:23], a[220:223], v[192:195]
    s_waitcnt lgkmcnt(8)
    v_cvt_pk_bf16_f32 v90, v180, v181
    v_cvt_pk_bf16_f32 v91, v182, v183
    v_mfma_f32_16x16x32_bf16 v[196:199], a[44:47], a[220:223], v[196:199]
    s_waitcnt lgkmcnt(7)
    v_cvt_pk_bf16_f32 v92, v184, v185
    v_cvt_pk_bf16_f32 v93, v186, v187
    v_mfma_f32_16x16x32_bf16 v[200:203], a[68:71], a[220:223], v[200:203]
    buffer_load_dwordx4 v173, s[8:11], s63 offen offset:1024 lds
    s_add_u32 m0, s46, 0xfc00
    v_mfma_f32_16x16x32_bf16 v[204:207], a[20:23], a[224:227], v[204:207]
    v_cvt_pk_bf16_f32 v94, v188, v189
    v_cvt_pk_bf16_f32 v95, v190, v191
    v_mfma_f32_16x16x32_bf16 v[208:211], a[44:47], a[224:227], v[208:211]
    v_cvt_pk_bf16_f32 v96, v192, v193
    v_cvt_pk_bf16_f32 v97, v194, v195
    v_mfma_f32_16x16x32_bf16 v[212:215], a[68:71], a[224:227], v[212:215]
    v_cvt_pk_bf16_f32 v98, v196, v197
    v_cvt_pk_bf16_f32 v99, v198, v199
    v_mfma_f32_16x16x32_bf16 v[216:219], a[20:23], a[228:231], v[216:219]
    buffer_load_dwordx4 v170, s[4:7], s59 offen offset:2048 lds
    s_add_u32 m0, s29, 0x2400
    v_mfma_f32_16x16x32_bf16 v[220:223], a[44:47], a[228:231], v[220:223]
    s_waitcnt vmcnt(11)
    ds_read_b64_tr_b16 a[84:85], v249 offset:3072
    v_mfma_f32_16x16x32_bf16 v[224:227], a[68:71], a[228:231], v[224:227]
    ds_read_b64_tr_b16 a[86:87], v250 offset:3072
    ds_read_b64_tr_b16 a[108:109], v249 offset:3104
    v_mfma_f32_16x16x32_bf16 v[228:231], a[20:23], a[232:235], v[228:231]
    ds_read_b64_tr_b16 a[110:111], v250 offset:3104
    ds_read_b64_tr_b16 a[132:133], v249 offset:3136
    v_mfma_f32_16x16x32_bf16 v[232:235], a[44:47], a[232:235], v[232:235]
    buffer_load_dwordx4 v174, s[8:11], s63 offen offset:2048 lds
    s_add_u32 m0, s29, 0
    v_mfma_f32_16x16x32_bf16 v[236:239], a[68:71], a[232:235], v[236:239]
    s_waitcnt lgkmcnt(5)
    s_add_u32 s63, s39, 0x1b000
    v_cvt_pk_bf16_f32 v100, v200, v201
    v_mfma_f32_16x16x32_bf16 v[138:141], a[20:23], a[236:239], v[138:141]
    ds_read_b64_tr_b16 a[134:135], v250 offset:3136
    v_cvt_pk_bf16_f32 v101, v202, v203
    v_mfma_f32_16x16x32_bf16 v[142:145], a[44:47], a[236:239], v[142:145]
    s_add_u32 s59, s43, s45
    v_cvt_pk_bf16_f32 v102, v204, v205
    v_cvt_pk_bf16_f32 v103, v206, v207
    v_mfma_f32_16x16x32_bf16 v[146:149], a[68:71], a[236:239], v[146:149]
    buffer_load_dwordx4 v172, s[8:11], s60 offen lds
    v_cvt_pk_bf16_f32 v104, v208, v209
    v_mfma_f32_16x16x32_bf16 v[150:153], a[20:23], a[240:243], v[150:153]
    v_cvt_pk_bf16_f32 v105, v210, v211
    v_cvt_pk_bf16_f32 v106, v212, v213
    v_mfma_f32_16x16x32_bf16 v[154:157], a[44:47], a[240:243], v[154:157]
    v_cvt_pk_bf16_f32 v107, v214, v215
    v_cvt_pk_bf16_f32 v108, v216, v217
    v_mfma_f32_16x16x32_bf16 v[158:161], a[68:71], a[240:243], v[158:161]
    v_cvt_pk_bf16_f32 v109, v218, v219
    v_cvt_pk_bf16_f32 v110, v220, v221
    v_mfma_f32_16x16x32_bf16 v[162:165], a[20:23], a[244:247], v[162:165]
    v_cvt_pk_bf16_f32 v111, v222, v223
    v_cvt_pk_bf16_f32 v112, v224, v225
    v_mfma_f32_16x16x32_bf16 v[24:27], a[44:47], a[244:247], v[24:27]
    v_cvt_pk_bf16_f32 v113, v226, v227
    v_cvt_pk_bf16_f32 v114, v228, v229
    v_mfma_f32_16x16x32_bf16 v[54:57], a[68:71], a[244:247], v[54:57]
    v_cvt_pk_bf16_f32 v115, v230, v231
    v_cvt_pk_bf16_f32 v116, v232, v233
    buffer_load_dwordx4 v173, s[8:11], s60 offen offset:1024 lds
    v_cvt_pk_bf16_f32 v117, v234, v235
    v_cvt_pk_bf16_f32 v118, v236, v237
    v_cvt_pk_bf16_f32 v119, v238, v239
    v_cvt_pk_bf16_f32 v120, v138, v139
    v_cvt_pk_bf16_f32 v121, v140, v141
    v_cvt_pk_bf16_f32 v122, v142, v143
    v_cvt_pk_bf16_f32 v123, v144, v145
    v_cvt_pk_bf16_f32 v124, v146, v147
    v_cvt_pk_bf16_f32 v125, v148, v149
    v_cvt_pk_bf16_f32 v126, v150, v151
    v_cvt_pk_bf16_f32 v127, v152, v153
    v_cvt_pk_bf16_f32 v128, v154, v155
    v_cvt_pk_bf16_f32 v129, v156, v157
    v_cvt_pk_bf16_f32 v130, v158, v159
    v_cvt_pk_bf16_f32 v131, v160, v161
    v_cvt_pk_bf16_f32 v132, v162, v163
    v_cvt_pk_bf16_f32 v133, v164, v165
    v_cvt_pk_bf16_f32 v134, v24, v25
    v_cvt_pk_bf16_f32 v135, v26, v27
    v_cvt_pk_bf16_f32 v136, v54, v55
    v_cvt_pk_bf16_f32 v137, v56, v57
    ds_read_b128 a[216:219], v240 offset:0
    ds_read_b128 a[220:223], v240 offset:1536
    buffer_load_dwordx4 v174, s[8:11], s60 offen offset:2048 lds
    s_add_u32 m0, s29, 0xc00
    s_waitcnt lgkmcnt(2)
    s_add_u32 s60, s39, 0x24000
    ds_read_b128 a[224:227], v240 offset:3072
    ds_read_b128 a[228:231], v240 offset:4608
    ds_read_b128 a[232:235], v240 offset:30720
    ds_read_b128 a[236:239], v240 offset:32256
    ds_read_b128 a[240:243], v240 offset:33792
    ds_read_b128 a[244:247], v240 offset:35328
    v_add_u32 v245, 0x237c0, v245
    v_add_u32 v246, 8, v18
    v_cmp_gt_u32 vcc, 7, v246
    v_add_u32 v246, 0xfffdd670, v17
    v_min_u32 v20, 55, v1
    v_cndmask_b32 v246, 0, v246, vcc
    v_add_u32 v246, 0x237c0, v246
    v_lshlrev_b32 v62, 3, v20
    v_add_u32 v62, s64, v62
    s_waitcnt vmcnt(9)
    ds_read_b64_tr_b16 a[88:89], v249 offset:6144
    ds_read_b64_tr_b16 a[90:91], v250 offset:6144
    ds_read_b64_tr_b16 a[112:113], v249 offset:6176
    buffer_load_dwordx4 v172, s[8:11], s61 offen lds
    ds_read_b64_tr_b16 a[114:115], v250 offset:6176
    s_waitcnt lgkmcnt(11)
    v_mfma_f32_16x16x32_bf16 v[84:87], a[216:219], a[72:75], 0
    ds_read_b64_tr_b16 a[136:137], v249 offset:6208
    ds_read_b64_tr_b16 a[138:139], v250 offset:6208
    v_mfma_f32_16x16x32_bf16 v[180:183], a[216:219], a[96:99], 0
    s_and_b32 s64, s48, 15
    v_lshrrev_b32 v21, 1, v20
    v_and_b32 v20, 1, v20
    v_mfma_f32_16x16x32_bf16 v[184:187], a[216:219], a[120:123], 0
    s_waitcnt lgkmcnt(11)
    ds_read_b128 a[216:219], v241 offset:0
    v_mfma_f32_16x16x32_bf16 v[188:191], a[220:223], a[72:75], 0
    s_add_u32 s64, s64, s37
    v_lshlrev_b32 v20, 1, v20
    v_add_u32 v22, -12, v21
    v_mfma_f32_16x16x32_bf16 v[192:195], a[220:223], a[96:99], 0
    s_waitcnt lgkmcnt(10)
    v_cmp_lt_u32 vcc, 11, v21
    v_mov_b32 v23, s34
    v_mfma_f32_16x16x32_bf16 v[196:199], a[220:223], a[120:123], 0
    ds_read_b128 a[220:223], v241 offset:1536
    v_cndmask_b32 v22, v21, v22, vcc
    v_mfma_f32_16x16x32_bf16 v[200:203], a[224:227], a[72:75], 0
    buffer_load_dwordx4 v173, s[8:11], s61 offen offset:1024 lds
    v_cndmask_b32 v23, 0, v23, vcc
    v_mfma_f32_16x16x32_bf16 v[204:207], a[224:227], a[96:99], 0
    s_waitcnt lgkmcnt(7)
    v_add_u32 v63, 0, v20
    v_add3_u32 v64, v22, v63, -6
    v_mfma_f32_16x16x32_bf16 v[208:211], a[224:227], a[120:123], 0
    ds_read_b128 a[224:227], v241 offset:3072
    v_add_u32 v65, 3, v64
    v_mfma_f32_16x16x32_bf16 v[212:215], a[228:231], a[72:75], 0
    v_and_b32 v66, 12, v22
    v_add3_u32 v66, v66, v63, -3
    v_mfma_f32_16x16x32_bf16 v[216:219], a[228:231], a[96:99], 0
    v_cmp_ne_u32 vcc, 0, v23
    v_mul_i32_i24 v64, s66, v64
    v_mfma_f32_16x16x32_bf16 v[220:223], a[228:231], a[120:123], 0
    ds_read_b128 a[228:231], v241 offset:4608
    v_cndmask_b32 v65, v65, v66, vcc
    v_mfma_f32_16x16x32_bf16 v[224:227], a[232:235], a[72:75], 0
    s_waitcnt lgkmcnt(3)
    v_cmp_gt_u32 vcc, 7, v65
    s_waitcnt vmcnt(8)
    v_mfma_f32_16x16x32_bf16 v[228:231], a[232:235], a[96:99], 0
    buffer_load_dwordx4 v174, s[8:11], s61 offen offset:2048 lds
    s_add_u32 m0, s29, 0x1800
    v_mfma_f32_16x16x32_bf16 v[232:235], a[232:235], a[120:123], 0
    s_add_u32 s61, s39, 0x2d000
    ds_read_b128 a[232:235], v241 offset:30720
    v_mfma_f32_16x16x32_bf16 v[236:239], a[236:239], a[72:75], 0
    s_barrier
    v_add_lshl_u32 v64, v64, 6, 1
    v_cndmask_b32 v50, 0, v64, vcc
    v_mfma_f32_16x16x32_bf16 v[138:141], a[236:239], a[96:99], 0
    s_waitcnt lgkmcnt(3)
    v_mov_b32 v64, 0x3fb8aa3b
    v_cndmask_b32 v52, 0, v64, vcc
    v_mfma_f32_16x16x32_bf16 v[142:145], a[236:239], a[120:123], 0
    ds_read_b128 a[236:239], v241 offset:32256
    v_mov_b32 v64, 0
    v_mfma_f32_16x16x32_bf16 v[146:149], a[240:243], a[72:75], 0
    s_waitcnt lgkmcnt(3)
    v_mov_b32 v65, 0xf149f2ca
    v_cndmask_b32 v60, v65, v64, vcc
    v_mfma_f32_16x16x32_bf16 v[150:153], a[240:243], a[96:99], 0
    v_add_u32 v63, 1, v20
    v_add3_u32 v64, v22, v63, -6
    v_mfma_f32_16x16x32_bf16 v[154:157], a[240:243], a[120:123], 0
    buffer_load_dwordx4 v172, s[8:11], s62 offen lds
    ds_read_b128 a[240:243], v241 offset:33792
    v_mfma_f32_16x16x32_bf16 v[158:161], a[244:247], a[72:75], 0
    s_waitcnt lgkmcnt(3)
    v_add_u32 v65, 3, v64
    v_and_b32 v66, 12, v22
    v_mfma_f32_16x16x32_bf16 v[162:165], a[244:247], a[96:99], 0
    v_add3_u32 v66, v66, v63, -3
    v_cmp_ne_u32 vcc, 0, v23
    v_mfma_f32_16x16x32_bf16 v[24:27], a[244:247], a[120:123], 0
    ds_read_b128 a[244:247], v241 offset:35328
    v_cndmask_b32 v65, v65, v66, vcc
    v_mfma_f32_16x16x32_bf16 v[84:87], a[216:219], a[76:79], v[84:87]
    s_waitcnt lgkmcnt(3)
    v_cmp_gt_u32 vcc, 7, v65
    v_mul_i32_i24 v64, s66, v64
    v_mfma_f32_16x16x32_bf16 v[180:183], a[216:219], a[100:103], v[180:183]
    s_mul_i32 s66, s28, 0xffffee00
    v_add_lshl_u32 v64, v64, 6, 1
    s_waitcnt vmcnt(7) lgkmcnt(2)
    v_mfma_f32_16x16x32_bf16 v[184:187], a[216:219], a[124:127], v[184:187]
    ds_read_b64_tr_b16 a[92:93], v249 offset:9216
    ds_read_b64_tr_b16 a[94:95], v250 offset:9216
    v_mfma_f32_16x16x32_bf16 v[188:191], a[220:223], a[76:79], v[188:191]
    buffer_load_dwordx4 v173, s[8:11], s62 offen offset:1024 lds
    ds_read_b64_tr_b16 a[116:117], v249 offset:9248
    v_mfma_f32_16x16x32_bf16 v[192:195], a[220:223], a[100:103], v[192:195]
    ds_read_b64_tr_b16 a[118:119], v250 offset:9248
    ds_read_b64_tr_b16 a[140:141], v249 offset:9280
    v_mfma_f32_16x16x32_bf16 v[196:199], a[220:223], a[124:127], v[196:199]
    ds_read_b64_tr_b16 a[142:143], v250 offset:9280
    ds_read_b128 a[216:219], v240 offset:128
    v_mfma_f32_16x16x32_bf16 v[200:203], a[224:227], a[76:79], v[200:203]
    ds_read_b128 a[220:223], v240 offset:1664
    v_cndmask_b32 v51, 0, v64, vcc
    v_mfma_f32_16x16x32_bf16 v[204:207], a[224:227], a[100:103], v[204:207]
    s_waitcnt lgkmcnt(8)
    v_mov_b32 v64, 0x3fb8aa3b
    v_cndmask_b32 v53, 0, v64, vcc
    v_mfma_f32_16x16x32_bf16 v[208:211], a[224:227], a[124:127], v[208:211]
    ds_read_b128 a[224:227], v240 offset:3200
    v_mov_b32 v64, 0
    v_mfma_f32_16x16x32_bf16 v[212:215], a[228:231], a[76:79], v[212:215]
    v_mov_b32 v65, 0xf149f2ca
    v_cndmask_b32 v61, v65, v64, vcc
    v_mfma_f32_16x16x32_bf16 v[216:219], a[228:231], a[100:103], v[216:219]
    buffer_load_dwordx4 v174, s[8:11], s62 offen offset:2048 lds
    s_add_u32 m0, s29, 0x2400
    v_mfma_f32_16x16x32_bf16 v[220:223], a[228:231], a[124:127], v[220:223]
    s_lshl_b32 s62, s28, 5
    s_add_u32 s62, s62, 0
    v_add_u32 v50, s64, v50
    v_mfma_f32_16x16x32_bf16 v[224:227], a[232:235], a[76:79], v[224:227]
    ds_read_b128 a[228:231], v240 offset:4736
    v_add_u32 v51, s64, v51
    v_mfma_f32_16x16x32_bf16 v[228:231], a[232:235], a[100:103], v[228:231]
    ds_read_u16 v30, v50 offset:3456
    s_waitcnt lgkmcnt(5)
    v_mfma_f32_16x16x32_bf16 v[232:235], a[232:235], a[124:127], v[232:235]
    ds_read_b128 a[232:235], v240 offset:30848
    ds_read_u16 v31, v51 offset:3456
    v_mfma_f32_16x16x32_bf16 v[236:239], a[236:239], a[76:79], v[236:239]
    ds_read_u16 v32, v50 offset:3482
    ds_read_u16 v33, v51 offset:3482
    v_mfma_f32_16x16x32_bf16 v[138:141], a[236:239], a[100:103], v[138:141]
    ds_read_u16 v34, v50 offset:3508
    buffer_load_dwordx4 v172, s[8:11], s63 offen lds
    v_mfma_f32_16x16x32_bf16 v[142:145], a[236:239], a[124:127], v[142:145]
    ds_read_b128 a[236:239], v240 offset:32384
    s_waitcnt vmcnt(7) lgkmcnt(8)
    v_mfma_f32_16x16x32_bf16 v[146:149], a[240:243], a[76:79], v[146:149]
    ds_read_b64_tr_b16 a[144:145], v249 offset:0
    ds_read_b64_tr_b16 a[146:147], v250 offset:0
    v_mfma_f32_16x16x32_bf16 v[150:153], a[240:243], a[100:103], v[150:153]
    ds_read_b64_tr_b16 a[168:169], v249 offset:32
    ds_read_b64_tr_b16 a[170:171], v250 offset:32
    v_mfma_f32_16x16x32_bf16 v[154:157], a[240:243], a[124:127], v[154:157]
    ds_read_b64_tr_b16 a[192:193], v249 offset:64
    ds_read_b64_tr_b16 a[194:195], v250 offset:64
    v_mfma_f32_16x16x32_bf16 v[158:161], a[244:247], a[76:79], v[158:161]
    ds_read_b128 a[240:243], v240 offset:33920
    ds_read_u16 v35, v51 offset:3508
    v_mfma_f32_16x16x32_bf16 v[162:165], a[244:247], a[100:103], v[162:165]
    ds_read_u16 v36, v50 offset:3534
    ds_read_u16 v37, v51 offset:3534
    v_mfma_f32_16x16x32_bf16 v[24:27], a[244:247], a[124:127], v[24:27]
    buffer_load_dwordx4 v173, s[8:11], s63 offen offset:1024 lds
    ds_read_b128 a[244:247], v240 offset:35456
    v_mfma_f32_16x16x32_bf16 v[84:87], a[216:219], a[80:83], v[84:87]
    ds_read_u16 v38, v50 offset:3560
    ds_read_u16 v39, v51 offset:3560
    v_mfma_f32_16x16x32_bf16 v[180:183], a[216:219], a[104:107], v[180:183]
    ds_read_u16 v40, v50 offset:3586
    s_waitcnt lgkmcnt(14)
    v_mfma_f32_16x16x32_bf16 v[184:187], a[216:219], a[128:131], v[184:187]
    ds_read_b128 a[216:219], v241 offset:128
    ds_read_u16 v41, v51 offset:3586
    v_mfma_f32_16x16x32_bf16 v[188:191], a[220:223], a[80:83], v[188:191]
    ds_read_u16 v42, v50 offset:3612
    ds_read_u16 v43, v51 offset:3612
    v_mfma_f32_16x16x32_bf16 v[192:195], a[220:223], a[104:107], v[192:195]
    ds_read_u16 v44, v50 offset:3638
    ds_read_u16 v45, v51 offset:3638
    v_mfma_f32_16x16x32_bf16 v[196:199], a[220:223], a[128:131], v[196:199]
    v_lshlrev_b32 v30, 16, v30
    v_fma_f32 v30, v30, v52, v60
    v_mfma_f32_16x16x32_bf16 v[200:203], a[224:227], a[80:83], v[200:203]
    buffer_load_dwordx4 v174, s[8:11], s63 offen offset:2048 lds
    s_add_u32 m0, s29, 0
    v_mfma_f32_16x16x32_bf16 v[204:207], a[224:227], a[104:107], v[204:207]
    s_waitcnt lgkmcnt(10)
    s_lshl_b32 s63, s28, 5
    s_add_u32 s63, s63, 0x4800
    v_mfma_f32_16x16x32_bf16 v[208:211], a[224:227], a[128:131], v[208:211]
    ds_read_b128 a[220:223], v241 offset:1664
    ds_read_b128 a[224:227], v241 offset:3200
    v_mfma_f32_16x16x32_bf16 v[212:215], a[228:231], a[80:83], v[212:215]
    ds_read_u16 v46, v50 offset:3664
    ds_read_u16 v47, v51 offset:3664
    v_mfma_f32_16x16x32_bf16 v[216:219], a[228:231], a[104:107], v[216:219]
    ds_read_u16 v48, v50 offset:3690
    ds_read_u16 v49, v51 offset:3690
    v_mfma_f32_16x16x32_bf16 v[220:223], a[228:231], a[128:131], v[220:223]
    ds_read_b128 a[228:231], v241 offset:4736
    v_lshlrev_b32 v31, 16, v31
    v_mfma_f32_16x16x32_bf16 v[224:227], a[232:235], a[80:83], v[224:227]
    s_waitcnt lgkmcnt(8)
    v_fma_f32 v31, v31, v53, v61
    v_lshlrev_b32 v32, 16, v32
    v_mfma_f32_16x16x32_bf16 v[228:231], a[232:235], a[104:107], v[228:231]
    buffer_load_dwordx4 v172, s[8:11], s60 offen lds
    v_fma_f32 v32, v32, v52, v60
    v_mfma_f32_16x16x32_bf16 v[232:235], a[232:235], a[128:131], v[232:235]
    s_waitcnt vmcnt(7) lgkmcnt(7)
    ds_read_b64_tr_b16 a[148:149], v249 offset:3072
    v_mfma_f32_16x16x32_bf16 v[236:239], a[236:239], a[80:83], v[236:239]
    ds_read_b64_tr_b16 a[150:151], v250 offset:3072
    ds_read_b64_tr_b16 a[172:173], v249 offset:3104
    v_mfma_f32_16x16x32_bf16 v[138:141], a[236:239], a[104:107], v[138:141]
    ds_read_b64_tr_b16 a[174:175], v250 offset:3104
    ds_read_b64_tr_b16 a[196:197], v249 offset:3136
    v_mfma_f32_16x16x32_bf16 v[142:145], a[236:239], a[128:131], v[142:145]
    ds_read_b64_tr_b16 a[198:199], v250 offset:3136
    ds_read_b128 a[232:235], v241 offset:30848
    v_mfma_f32_16x16x32_bf16 v[146:149], a[240:243], a[80:83], v[146:149]
    ds_read_b128 a[236:239], v241 offset:32384
    v_lshlrev_b32 v33, 16, v33
    v_mfma_f32_16x16x32_bf16 v[150:153], a[240:243], a[104:107], v[150:153]
    ds_write_b64 v62, v[30:31] offset:0
    v_mfma_f32_16x16x32_bf16 v[154:157], a[240:243], a[128:131], v[154:157]
    buffer_load_dwordx4 v173, s[8:11], s60 offen offset:1024 lds
    ds_read_b128 a[240:243], v241 offset:33920
    v_mfma_f32_16x16x32_bf16 v[158:161], a[244:247], a[80:83], v[158:161]
    s_waitcnt lgkmcnt(10)
    v_add_u32 v62, s49, v62
    v_fma_f32 v33, v33, v53, v61
    v_mfma_f32_16x16x32_bf16 v[162:165], a[244:247], a[104:107], v[162:165]
    ds_write_b64 v62, v[32:33] offset:0
    v_mfma_f32_16x16x32_bf16 v[24:27], a[244:247], a[128:131], v[24:27]
    ds_read_b128 a[244:247], v241 offset:35456
    v_add_u32 v62, s49, v62
    v_mfma_f32_16x16x32_bf16 v[84:87], a[216:219], a[84:87], v[84:87]
    v_lshlrev_b32 v34, 16, v34
    v_fma_f32 v34, v34, v52, v60
    v_mfma_f32_16x16x32_bf16 v[180:183], a[216:219], a[108:111], v[180:183]
    v_lshlrev_b32 v35, 16, v35
    v_fma_f32 v35, v35, v53, v61
    v_mfma_f32_16x16x32_bf16 v[184:187], a[216:219], a[132:135], v[184:187]
    ds_read_b128 a[216:219], v240 offset:256
    buffer_load_dwordx4 v174, s[8:11], s60 offen offset:2048 lds
    v_mfma_f32_16x16x32_bf16 v[188:191], a[220:223], a[84:87], v[188:191]
    s_add_u32 m0, s29, 0xc00
    s_waitcnt lgkmcnt(5)
    s_lshl_b32 s60, s28, 5
    v_mfma_f32_16x16x32_bf16 v[192:195], a[220:223], a[108:111], v[192:195]
    s_add_u32 s60, s60, 0x1800
    v_lshlrev_b32 v36, 16, v36
    v_fma_f32 v36, v36, v52, v60
    v_mfma_f32_16x16x32_bf16 v[196:199], a[220:223], a[132:135], v[196:199]
    ds_read_b128 a[220:223], v240 offset:1792
    v_lshlrev_b32 v37, 16, v37
    v_mfma_f32_16x16x32_bf16 v[200:203], a[224:227], a[84:87], v[200:203]
    ds_write_b64 v62, v[34:35] offset:0
    v_mfma_f32_16x16x32_bf16 v[204:207], a[224:227], a[108:111], v[204:207]
    s_waitcnt lgkmcnt(4)
    v_add_u32 v62, s49, v62
    v_fma_f32 v37, v37, v53, v61
    v_mfma_f32_16x16x32_bf16 v[208:211], a[224:227], a[132:135], v[208:211]
    ds_read_b128 a[224:227], v240 offset:3328
    v_lshlrev_b32 v38, 16, v38
    v_mfma_f32_16x16x32_bf16 v[212:215], a[228:231], a[84:87], v[212:215]
    buffer_load_dwordx4 v172, s[8:11], s61 offen lds
    v_fma_f32 v38, v38, v52, v60
    v_mfma_f32_16x16x32_bf16 v[216:219], a[228:231], a[108:111], v[216:219]
    s_waitcnt vmcnt(7) lgkmcnt(3)
    ds_read_b64_tr_b16 a[152:153], v249 offset:6144
    v_mfma_f32_16x16x32_bf16 v[220:223], a[228:231], a[132:135], v[220:223]
    ds_read_b64_tr_b16 a[154:155], v250 offset:6144
    ds_read_b64_tr_b16 a[176:177], v249 offset:6176
    v_mfma_f32_16x16x32_bf16 v[224:227], a[232:235], a[84:87], v[224:227]
    ds_read_b64_tr_b16 a[178:179], v250 offset:6176
    ds_read_b64_tr_b16 a[200:201], v249 offset:6208
    v_mfma_f32_16x16x32_bf16 v[228:231], a[232:235], a[108:111], v[228:231]
    ds_read_b64_tr_b16 a[202:203], v250 offset:6208
    ds_read_b128 a[228:231], v240 offset:4864
    v_mfma_f32_16x16x32_bf16 v[232:235], a[232:235], a[132:135], v[232:235]
    ds_read_b128 a[232:235], v240 offset:30976
    v_lshlrev_b32 v39, 16, v39
    v_mfma_f32_16x16x32_bf16 v[236:239], a[236:239], a[84:87], v[236:239]
    ds_write_b64 v62, v[36:37] offset:0
    v_mfma_f32_16x16x32_bf16 v[138:141], a[236:239], a[108:111], v[138:141]
    buffer_load_dwordx4 v173, s[8:11], s61 offen offset:1024 lds
    v_add_u32 v62, s49, v62
    v_mfma_f32_16x16x32_bf16 v[142:145], a[236:239], a[132:135], v[142:145]
    ds_read_b128 a[236:239], v240 offset:32512
    v_fma_f32 v39, v39, v53, v61
    v_mfma_f32_16x16x32_bf16 v[146:149], a[240:243], a[84:87], v[146:149]
    ds_write_b64 v62, v[38:39] offset:0
    v_mfma_f32_16x16x32_bf16 v[150:153], a[240:243], a[108:111], v[150:153]
    s_waitcnt lgkmcnt(8)
    v_add_u32 v62, s49, v62
    v_lshlrev_b32 v40, 16, v40
    v_mfma_f32_16x16x32_bf16 v[154:157], a[240:243], a[132:135], v[154:157]
    ds_read_b128 a[240:243], v240 offset:34048
    v_fma_f32 v40, v40, v52, v60
    v_mfma_f32_16x16x32_bf16 v[158:161], a[244:247], a[84:87], v[158:161]
    v_lshlrev_b32 v41, 16, v41
    v_fma_f32 v41, v41, v53, v61
    v_mfma_f32_16x16x32_bf16 v[162:165], a[244:247], a[108:111], v[162:165]
    ds_write_b64 v62, v[40:41] offset:0
    v_mfma_f32_16x16x32_bf16 v[24:27], a[244:247], a[132:135], v[24:27]
    buffer_load_dwordx4 v174, s[8:11], s61 offen offset:2048 lds
    s_add_u32 m0, s46, 0x1800
    v_mfma_f32_16x16x32_bf16 v[84:87], a[216:219], a[88:91], v[84:87]
    s_lshl_b32 s61, s28, 5
    s_add_u32 s61, s61, 0x6000
    v_add_u32 v62, s49, v62
    v_mfma_f32_16x16x32_bf16 v[180:183], a[216:219], a[112:115], v[180:183]
    ds_read_b128 a[244:247], v240 offset:35584
    v_lshlrev_b32 v42, 16, v42
    v_mfma_f32_16x16x32_bf16 v[184:187], a[216:219], a[136:139], v[184:187]
    ds_read_b128 a[216:219], v241 offset:256
    v_fma_f32 v42, v42, v52, v60
    v_mfma_f32_16x16x32_bf16 v[188:191], a[220:223], a[88:91], v[188:191]
    s_waitcnt lgkmcnt(4)
    v_lshlrev_b32 v43, 16, v43
    v_fma_f32 v43, v43, v53, v61
    v_mfma_f32_16x16x32_bf16 v[192:195], a[220:223], a[112:115], v[192:195]
    ds_write_b64 v62, v[42:43] offset:0
    v_mfma_f32_16x16x32_bf16 v[196:199], a[220:223], a[136:139], v[196:199]
    ds_read_b128 a[220:223], v241 offset:1792
    buffer_load_dwordx4 v168, s[4:7], s58 offen lds
    v_mfma_f32_16x16x32_bf16 v[200:203], a[224:227], a[88:91], v[200:203]
    s_waitcnt vmcnt(7) lgkmcnt(4)
    ds_read_b64_tr_b16 a[156:157], v249 offset:9216
    v_mfma_f32_16x16x32_bf16 v[204:207], a[224:227], a[112:115], v[204:207]
    ds_read_b64_tr_b16 a[158:159], v250 offset:9216
    ds_read_b64_tr_b16 a[180:181], v249 offset:9248
    v_mfma_f32_16x16x32_bf16 v[208:211], a[224:227], a[136:139], v[208:211]
    ds_read_b64_tr_b16 a[182:183], v250 offset:9248
    ds_read_b64_tr_b16 a[204:205], v249 offset:9280
    v_mfma_f32_16x16x32_bf16 v[212:215], a[228:231], a[88:91], v[212:215]
    ds_read_b64_tr_b16 a[206:207], v250 offset:9280
    buffer_load_dwordx4 v171, s[4:7], s58 offen offset:512 lds
    v_mfma_f32_16x16x32_bf16 v[216:219], a[228:231], a[112:115], v[216:219]
    s_lshl1_add_u32 s58, s45, s41
    s_add_u32 m0, s46, 0x9000
    v_add_u32 v62, s49, v62
    v_mfma_f32_16x16x32_bf16 v[220:223], a[228:231], a[136:139], v[220:223]
    ds_read_b128 a[224:227], v241 offset:3328
    ds_read_b128 a[228:231], v241 offset:4864
    v_mfma_f32_16x16x32_bf16 v[224:227], a[232:235], a[88:91], v[224:227]
    s_waitcnt lgkmcnt(9)
    v_lshlrev_b32 v44, 16, v44
    v_fma_f32 v44, v44, v52, v60
    v_mfma_f32_16x16x32_bf16 v[228:231], a[232:235], a[112:115], v[228:231]
    s_waitcnt lgkmcnt(8)
    buffer_load_dwordx4 v168, s[4:7], s58 offen lds
    v_mfma_f32_16x16x32_bf16 v[232:235], a[232:235], a[136:139], v[232:235]
    ds_read_b128 a[232:235], v241 offset:30976
    v_lshlrev_b32 v45, 16, v45
    v_mfma_f32_16x16x32_bf16 v[236:239], a[236:239], a[88:91], v[236:239]
    v_fma_f32 v45, v45, v53, v61
    v_lshlrev_b32 v46, 16, v46
    v_mfma_f32_16x16x32_bf16 v[138:141], a[236:239], a[112:115], v[138:141]
    ds_write_b64 v62, v[44:45] offset:0
    v_mfma_f32_16x16x32_bf16 v[142:145], a[236:239], a[136:139], v[142:145]
    buffer_load_dwordx4 v171, s[4:7], s58 offen offset:512 lds
    s_lshl1_add_u32 s58, s45, s42
    v_mfma_f32_16x16x32_bf16 v[146:149], a[240:243], a[88:91], v[146:149]
    s_add_u32 m0, s46, 0x10800
    ds_read_b128 a[236:239], v241 offset:32512
    v_mfma_f32_16x16x32_bf16 v[150:153], a[240:243], a[112:115], v[150:153]
    s_waitcnt lgkmcnt(4)
    v_add_u32 v62, s49, v62
    v_fma_f32 v46, v46, v52, v60
    v_mfma_f32_16x16x32_bf16 v[154:157], a[240:243], a[136:139], v[154:157]
    ds_read_b128 a[240:243], v241 offset:34048
    v_lshlrev_b32 v47, 16, v47
    v_mfma_f32_16x16x32_bf16 v[158:161], a[244:247], a[88:91], v[158:161]
    buffer_load_dwordx4 v168, s[4:7], s58 offen lds
    v_fma_f32 v47, v47, v53, v61
    v_mfma_f32_16x16x32_bf16 v[162:165], a[244:247], a[112:115], v[162:165]
    ds_write_b64 v62, v[46:47] offset:0
    v_mfma_f32_16x16x32_bf16 v[24:27], a[244:247], a[136:139], v[24:27]
    ds_read_b128 a[244:247], v241 offset:35584
    v_add_u32 v62, s49, v62
    v_mfma_f32_16x16x32_bf16 v[84:87], a[216:219], a[92:95], v[84:87]
    s_waitcnt lgkmcnt(4)
    v_lshlrev_b32 v48, 16, v48
    v_fma_f32 v48, v48, v52, v60
    v_mfma_f32_16x16x32_bf16 v[180:183], a[216:219], a[116:119], v[180:183]
    buffer_load_dwordx4 v171, s[4:7], s58 offen offset:512 lds
    s_add_u32 m0, s46, 0x16800
    v_mfma_f32_16x16x32_bf16 v[184:187], a[216:219], a[140:143], v[184:187]
    s_waitcnt vmcnt(9)
    ds_read_b64_tr_b16 a[160:161], v249 offset:0
    v_mfma_f32_16x16x32_bf16 v[188:191], a[220:223], a[92:95], v[188:191]
    ds_read_b64_tr_b16 a[162:163], v250 offset:0
    ds_read_b64_tr_b16 a[184:185], v249 offset:32
    v_mfma_f32_16x16x32_bf16 v[192:195], a[220:223], a[116:119], v[192:195]
    ds_read_b64_tr_b16 a[186:187], v250 offset:32
    ds_read_b64_tr_b16 a[208:209], v249 offset:64
    v_mfma_f32_16x16x32_bf16 v[196:199], a[220:223], a[140:143], v[196:199]
    ds_read_b64_tr_b16 a[210:211], v250 offset:64
    v_cvt_pk_bf16_f32 v0, v84, v85
    v_mfma_f32_16x16x32_bf16 v[200:203], a[224:227], a[92:95], v[200:203]
    s_lshl1_add_u32 s58, s45, s43
    v_cvt_pk_bf16_f32 v3, v86, v87
    v_cvt_pk_bf16_f32 v30, v180, v181
    v_mfma_f32_16x16x32_bf16 v[204:207], a[224:227], a[116:119], v[204:207]
    s_waitcnt lgkmcnt(6)
    v_cvt_pk_bf16_f32 v33, v182, v183
    v_cvt_pk_bf16_f32 v60, v184, v185
    v_mfma_f32_16x16x32_bf16 v[208:211], a[224:227], a[140:143], v[208:211]
    v_cvt_pk_bf16_f32 v6, v188, v189
    v_cvt_pk_bf16_f32 v9, v190, v191
    v_mfma_f32_16x16x32_bf16 v[212:215], a[228:231], a[92:95], v[212:215]
    v_cvt_pk_bf16_f32 v36, v192, v193
    v_cvt_pk_bf16_f32 v39, v194, v195
    v_mfma_f32_16x16x32_bf16 v[216:219], a[228:231], a[116:119], v[216:219]
    v_cvt_pk_bf16_f32 v66, v196, v197
    v_cvt_pk_bf16_f32 v69, v198, v199
    v_mfma_f32_16x16x32_bf16 v[220:223], a[228:231], a[140:143], v[220:223]
    v_cvt_pk_bf16_f32 v12, v200, v201
    v_cvt_pk_bf16_f32 v15, v202, v203
    v_mfma_f32_16x16x32_bf16 v[224:227], a[232:235], a[92:95], v[224:227]
    v_cvt_pk_bf16_f32 v42, v204, v205
    v_cvt_pk_bf16_f32 v45, v206, v207
    v_mfma_f32_16x16x32_bf16 v[228:231], a[232:235], a[116:119], v[228:231]
    v_cvt_pk_bf16_f32 v72, v208, v209
    v_cvt_pk_bf16_f32 v75, v210, v211
    v_mfma_f32_16x16x32_bf16 v[232:235], a[232:235], a[140:143], v[232:235]
    v_cvt_pk_bf16_f32 v18, v212, v213
    v_cvt_pk_bf16_f32 v21, v214, v215
    v_mfma_f32_16x16x32_bf16 v[236:239], a[236:239], a[92:95], v[236:239]
    v_cvt_pk_bf16_f32 v51, v218, v219
    v_cvt_pk_bf16_f32 v78, v220, v221
    v_mfma_f32_16x16x32_bf16 v[138:141], a[236:239], a[116:119], v[138:141]
    v_cvt_pk_bf16_f32 v81, v222, v223
    v_cvt_pk_bf16_f32 v4, v226, v227
    v_mfma_f32_16x16x32_bf16 v[142:145], a[236:239], a[140:143], v[142:145]
    v_cvt_pk_bf16_f32 v31, v228, v229
    v_cvt_pk_bf16_f32 v34, v230, v231
    v_mfma_f32_16x16x32_bf16 v[146:149], a[240:243], a[92:95], v[146:149]
    v_cvt_pk_bf16_f32 v7, v236, v237
    v_cvt_pk_bf16_f32 v10, v238, v239
    v_mfma_f32_16x16x32_bf16 v[150:153], a[240:243], a[116:119], v[150:153]
    v_cvt_pk_bf16_f32 v37, v138, v139
    v_cvt_pk_bf16_f32 v40, v140, v141
    v_mfma_f32_16x16x32_bf16 v[154:157], a[240:243], a[140:143], v[154:157]
    v_cvt_pk_bf16_f32 v67, v142, v143
    v_cvt_pk_bf16_f32 v70, v144, v145
    v_mfma_f32_16x16x32_bf16 v[158:161], a[244:247], a[92:95], v[158:161]
    v_cvt_pk_bf16_f32 v13, v146, v147
    v_cvt_pk_bf16_f32 v16, v148, v149
    v_mfma_f32_16x16x32_bf16 v[162:165], a[244:247], a[116:119], v[162:165]
    v_cvt_pk_bf16_f32 v43, v150, v151
    v_cvt_pk_bf16_f32 v46, v152, v153
    v_mfma_f32_16x16x32_bf16 v[24:27], a[244:247], a[140:143], v[24:27]
    v_cvt_pk_bf16_f32 v73, v154, v155
    v_cvt_pk_bf16_f32 v76, v156, v157
    v_cvt_pk_bf16_f32 v19, v158, v159
    s_waitcnt vmcnt(6)
    ds_read_b64_tr_b16 a[164:165], v249 offset:3072
    ds_read_b64_tr_b16 a[166:167], v250 offset:3072
    ds_read_b64_tr_b16 a[188:189], v249 offset:3104
    ds_read_b64_tr_b16 a[190:191], v250 offset:3104
    ds_read_b64_tr_b16 a[212:213], v249 offset:3136
    ds_read_b64_tr_b16 a[214:215], v250 offset:3136
    v_cvt_pk_bf16_f32 v22, v160, v161
    v_cvt_pk_bf16_f32 v52, v164, v165
    v_cvt_pk_bf16_f32 v79, v24, v25
    v_cvt_pk_bf16_f32 v82, v26, v27
    ds_read_b128 a[216:219], v240 offset:61440
    ds_read_b128 a[220:223], v241 offset:61440
    ds_read_b128 a[224:227], v240 offset:61568
    ds_read_b128 a[228:231], v241 offset:61568
    ds_read_b128 a[232:235], v240 offset:61696
    ds_read_b128 a[236:239], v241 offset:61696
    ds_read_b128 a[240:243], v240 offset:62976
    ds_read_b128 a[244:247], v241 offset:62976
    v_add_u32 v249, s66, v249
    v_add_u32 v250, s66, v250
    s_lshl_b32 s66, s28, 1
    v_mov_b32 v195, 0
    v_lshlrev_b32 v49, 16, v49
    v_fma_f32 v49, v49, v53, v61
    v_cvt_pk_bf16_f32 v61, v232, v233
    v_mov_b32 v64, 0xf149f2ca
    v_mov_b32 v65, 0xf149f2ca
    ds_write_b64 v62, v[48:49] offset:0
    v_cvt_pk_bf16_f32 v48, v216, v217
    v_cvt_pk_bf16_f32 v49, v162, v163
    v_add_u32 v62, s49, v62
    v_lshlrev_b32 v63, 3, v1
    v_cvt_pk_bf16_f32 v1, v224, v225
    v_add_u32 v63, 0x237c0, v63
    ds_write_b64 v63, v[64:65] offset:0
    s_waitcnt lgkmcnt(9)
    v_mfma_f32_16x16x32_bf16 v[228:231], a[0:3], a[216:219], 0
    s_waitcnt lgkmcnt(8)
    v_cvt_pk_bf16_f32 v63, v186, v187
    v_cvt_pk_bf16_f32 v64, v234, v235
    v_mfma_f32_16x16x32_bf16 v[228:231], a[4:7], a[220:223], v[228:231]
    ds_read_b128 v[196:199], v244 offset:192
    ds_read_b128 v[200:203], v245 offset:192
    v_mfma_f32_16x16x32_bf16 v[232:235], a[24:27], a[216:219], 0
    ds_read_b128 v[204:207], v246 offset:192
    ds_read_b128 v[208:211], v244 offset:256
    v_mfma_f32_16x16x32_bf16 v[232:235], a[28:31], a[220:223], v[232:235]
    s_waitcnt lgkmcnt(9)
    v_mfma_f32_16x16x32_bf16 v[228:231], a[8:11], a[224:227], v[228:231]
    v_mfma_f32_16x16x32_bf16 v[228:231], a[12:15], a[228:231], v[228:231]
    v_mfma_f32_16x16x32_bf16 v[228:231], a[16:19], a[232:235], v[228:231]
    s_waitcnt lgkmcnt(6)
    v_mfma_f32_16x16x32_bf16 v[228:231], a[20:23], a[236:239], v[228:231]
    v_mfma_f32_16x16x32_bf16 v[232:235], a[32:35], a[224:227], v[232:235]
    v_mfma_f32_16x16x32_bf16 v[232:235], a[36:39], a[228:231], v[232:235]
    v_mfma_f32_16x16x32_bf16 v[232:235], a[40:43], a[232:235], v[232:235]
    v_mfma_f32_16x16x32_bf16 v[232:235], a[44:47], a[236:239], v[232:235]
    v_mfma_f32_16x16x32_bf16 v[236:239], a[48:51], a[216:219], 0
    v_mfma_f32_16x16x32_bf16 v[236:239], a[52:55], a[220:223], v[236:239]
    v_mfma_f32_16x16x32_bf16 v[236:239], a[56:59], a[224:227], v[236:239]
    v_mfma_f32_16x16x32_bf16 v[236:239], a[60:63], a[228:231], v[236:239]
    v_cvt_pk_bf16_f32 v138, v228, v229
    v_cvt_pk_bf16_f32 v139, v230, v231
    v_mfma_f32_16x16x32_bf16 v[236:239], a[64:67], a[232:235], v[236:239]
    s_waitcnt vmcnt(0)
    v_cvt_pk_bf16_f32 v140, v232, v233
    v_cvt_pk_bf16_f32 v141, v234, v235
    v_mfma_f32_16x16x32_bf16 v[236:239], a[68:71], a[236:239], v[236:239]
    s_barrier
    buffer_load_dwordx4 v254, s[4:7], s43 offen lds
    v_mfma_f32_16x16x32_bf16 v[228:231], a[216:219], a[72:75], 0
    v_accvgpr_read_b32 v254, a254
    v_mfma_f32_16x16x32_bf16 v[228:231], a[220:223], a[76:79], v[228:231]
    v_mfma_f32_16x16x32_bf16 v[228:231], a[224:227], a[80:83], v[228:231]
    v_mfma_f32_16x16x32_bf16 v[228:231], a[228:231], a[84:87], v[228:231]
    buffer_load_dwordx4 v255, s[4:7], s43 offen offset:1024 lds
    v_cvt_pk_bf16_f32 v142, v236, v237
    v_mfma_f32_16x16x32_bf16 v[228:231], a[232:235], a[88:91], v[228:231]
    v_cvt_pk_bf16_f32 v143, v238, v239
    v_accvgpr_read_b32 v255, a252
    v_mfma_f32_16x16x32_bf16 v[228:231], a[236:239], a[92:95], v[228:231]
    v_mfma_f32_16x16x32_bf16 v[232:235], a[216:219], a[96:99], 0
    v_mfma_f32_16x16x32_bf16 v[232:235], a[220:223], a[100:103], v[232:235]
    buffer_load_dwordx4 v254, s[4:7], s43 offen offset:2048 lds
    s_add_u32 m0, s46, 0x17400
    v_mfma_f32_16x16x32_bf16 v[232:235], a[224:227], a[104:107], v[232:235]
    v_accvgpr_read_b32 v254, a253
    v_mfma_f32_16x16x32_bf16 v[232:235], a[228:231], a[108:111], v[232:235]
    v_mfma_f32_16x16x32_bf16 v[232:235], a[232:235], a[112:115], v[232:235]
    v_cvt_pk_bf16_f32 v2, v228, v229
    v_cvt_pk_bf16_f32 v5, v230, v231
    v_mfma_f32_16x16x32_bf16 v[232:235], a[236:239], a[116:119], v[232:235]
    buffer_load_dwordx4 v255, s[4:7], s59 offen lds
    v_accvgpr_read_b32 v255, a254
    v_mfma_f32_16x16x32_bf16 v[236:239], a[216:219], a[120:123], 0
    ds_read_b128 a[216:219], v240 offset:63104
    v_mfma_f32_16x16x32_bf16 v[236:239], a[220:223], a[124:127], v[236:239]
    ds_read_b128 a[220:223], v241 offset:63104
    v_mfma_f32_16x16x32_bf16 v[236:239], a[224:227], a[128:131], v[236:239]
    ds_read_b128 a[224:227], v240 offset:63232
    v_cvt_pk_bf16_f32 v32, v232, v233
    v_mfma_f32_16x16x32_bf16 v[236:239], a[228:231], a[132:135], v[236:239]
    ds_read_b128 a[228:231], v241 offset:63232
    v_cvt_pk_bf16_f32 v35, v234, v235
    v_mfma_f32_16x16x32_bf16 v[236:239], a[232:235], a[136:139], v[236:239]
    ds_read_b128 a[232:235], v240 offset:64512
    buffer_load_dwordx4 v254, s[4:7], s59 offen offset:1024 lds
    v_mfma_f32_16x16x32_bf16 v[236:239], a[236:239], a[140:143], v[236:239]
    ds_read_b128 a[236:239], v241 offset:64512
    v_accvgpr_read_b32 v254, a252
    v_mfma_f32_16x16x32_bf16 v[228:231], a[0:3], a[240:243], 0
    v_mfma_f32_16x16x32_bf16 v[228:231], a[4:7], a[244:247], v[228:231]
    v_mfma_f32_16x16x32_bf16 v[232:235], a[24:27], a[240:243], 0
    buffer_load_dwordx4 v255, s[4:7], s59 offen offset:2048 lds
    s_add_u32 m0, s46, 0x18000
    v_mfma_f32_16x16x32_bf16 v[232:235], a[28:31], a[244:247], v[232:235]
    s_waitcnt lgkmcnt(5)
    v_cvt_pk_bf16_f32 v62, v236, v237
    v_cvt_pk_bf16_f32 v65, v238, v239
    v_mfma_f32_16x16x32_bf16 v[228:231], a[8:11], a[216:219], v[228:231]
    s_add_u32 s59, s44, s45
    v_accvgpr_read_b32 v255, a255
    s_waitcnt lgkmcnt(3)
    v_mfma_f32_16x16x32_bf16 v[228:231], a[12:15], a[220:223], v[228:231]
    v_mfma_f32_16x16x32_bf16 v[228:231], a[16:19], a[224:227], v[228:231]
    buffer_load_dwordx4 v254, s[4:7], s58 offen lds
    v_mbcnt_lo_u32_b32 v254, -1, 0
    v_mfma_f32_16x16x32_bf16 v[232:235], a[32:35], a[216:219], v[232:235]
    s_waitcnt lgkmcnt(1)
    v_mbcnt_hi_u32_b32 v254, -1, v254
    v_bfe_u32 v254, v254, 1, 1
    v_mfma_f32_16x16x32_bf16 v[228:231], a[20:23], a[228:231], v[228:231]
    v_mfma_f32_16x16x32_bf16 v[232:235], a[36:39], a[220:223], v[232:235]
    v_mfma_f32_16x16x32_bf16 v[232:235], a[40:43], a[224:227], v[232:235]
    buffer_load_dwordx4 v255, s[4:7], s58 offen offset:512 lds
    v_lshlrev_b32 v255, 4, v254
    v_mfma_f32_16x16x32_bf16 v[232:235], a[44:47], a[228:231], v[232:235]
    s_add_u32 m0, s46, 0
    v_xor_b32 v255, v255, v242
    v_mul_u32_u24 v254, 0x7500, v254
    v_mfma_f32_16x16x32_bf16 v[236:239], a[48:51], a[240:243], 0
    s_lshl1_add_u32 s58, s45, s44
    v_cvt_pk_bf16_f32 v144, v228, v229
    v_cvt_pk_bf16_f32 v145, v230, v231
    v_mfma_f32_16x16x32_bf16 v[236:239], a[52:55], a[244:247], v[236:239]
    v_cvt_pk_bf16_f32 v146, v232, v233
    v_cvt_pk_bf16_f32 v147, v234, v235
    v_mfma_f32_16x16x32_bf16 v[236:239], a[56:59], a[216:219], v[236:239]
    v_add_u32 v254, v254, v255
    v_xor_b32 v255, 64, v254
    v_mfma_f32_16x16x32_bf16 v[236:239], a[60:63], a[220:223], v[236:239]
    v_mfma_f32_16x16x32_bf16 v[236:239], a[64:67], a[224:227], v[236:239]
    v_mfma_f32_16x16x32_bf16 v[236:239], a[68:71], a[228:231], v[236:239]
    v_mfma_f32_16x16x32_bf16 v[228:231], a[240:243], a[72:75], 0
    v_mfma_f32_16x16x32_bf16 v[228:231], a[244:247], a[76:79], v[228:231]
    v_mfma_f32_16x16x32_bf16 v[228:231], a[216:219], a[80:83], v[228:231]
    v_mfma_f32_16x16x32_bf16 v[228:231], a[220:223], a[84:87], v[228:231]
    v_mfma_f32_16x16x32_bf16 v[228:231], a[224:227], a[88:91], v[228:231]
    v_mfma_f32_16x16x32_bf16 v[228:231], a[228:231], a[92:95], v[228:231]
    v_mfma_f32_16x16x32_bf16 v[232:235], a[240:243], a[96:99], 0
    v_mfma_f32_16x16x32_bf16 v[232:235], a[244:247], a[100:103], v[232:235]
    v_cvt_pk_bf16_f32 v148, v236, v237
    v_cvt_pk_bf16_f32 v149, v238, v239
    v_mfma_f32_16x16x32_bf16 v[232:235], a[216:219], a[104:107], v[232:235]
    v_mfma_f32_16x16x32_bf16 v[232:235], a[220:223], a[108:111], v[232:235]
    v_mfma_f32_16x16x32_bf16 v[232:235], a[224:227], a[112:115], v[232:235]
    v_mfma_f32_16x16x32_bf16 v[232:235], a[228:231], a[116:119], v[232:235]
    v_cvt_pk_bf16_f32 v8, v228, v229
    v_cvt_pk_bf16_f32 v11, v230, v231
    v_mfma_f32_16x16x32_bf16 v[236:239], a[240:243], a[120:123], 0
    ds_read_b128 a[240:243], v240 offset:64640
    v_mfma_f32_16x16x32_bf16 v[236:239], a[244:247], a[124:127], v[236:239]
    ds_read_b128 a[244:247], v241 offset:64640
    v_mfma_f32_16x16x32_bf16 v[236:239], a[216:219], a[128:131], v[236:239]
    ds_read_b128 a[216:219], v240 offset:64768
    v_cvt_pk_bf16_f32 v38, v232, v233
    v_mfma_f32_16x16x32_bf16 v[236:239], a[220:223], a[132:135], v[236:239]
    ds_read_b128 a[220:223], v241 offset:64768
    v_cvt_pk_bf16_f32 v41, v234, v235
    v_mfma_f32_16x16x32_bf16 v[236:239], a[224:227], a[136:139], v[236:239]
    ds_read_b128 a[224:227], v242 offset:0
    v_add_u32 v240, 0xf000, v240
    v_mfma_f32_16x16x32_bf16 v[236:239], a[228:231], a[140:143], v[236:239]
    ds_read_b128 a[228:231], v243 offset:0
    v_add_u32 v241, 0xf000, v241
    v_mfma_f32_16x16x32_bf16 v[228:231], a[0:3], a[232:235], 0
    s_waitcnt lgkmcnt(6)
    v_mfma_f32_16x16x32_bf16 v[228:231], a[4:7], a[236:239], v[228:231]
    v_mfma_f32_16x16x32_bf16 v[232:235], a[24:27], a[232:235], 0
    v_mfma_f32_16x16x32_bf16 v[232:235], a[28:31], a[236:239], v[232:235]
    s_waitcnt lgkmcnt(5)
    v_cvt_pk_bf16_f32 v68, v236, v237
    v_cvt_pk_bf16_f32 v71, v238, v239
    v_mfma_f32_16x16x32_bf16 v[228:231], a[8:11], a[240:243], v[228:231]
    s_waitcnt lgkmcnt(4)
    v_mfma_f32_16x16x32_bf16 v[228:231], a[12:15], a[244:247], v[228:231]
    s_waitcnt lgkmcnt(3)
    v_mfma_f32_16x16x32_bf16 v[228:231], a[16:19], a[216:219], v[228:231]
    s_waitcnt lgkmcnt(2)
    v_mfma_f32_16x16x32_bf16 v[228:231], a[20:23], a[220:223], v[228:231]
    v_mfma_f32_16x16x32_bf16 v[232:235], a[32:35], a[240:243], v[232:235]
    v_mfma_f32_16x16x32_bf16 v[232:235], a[36:39], a[244:247], v[232:235]
    v_mfma_f32_16x16x32_bf16 v[232:235], a[40:43], a[216:219], v[232:235]
    v_mfma_f32_16x16x32_bf16 v[232:235], a[44:47], a[220:223], v[232:235]
    v_mfma_f32_16x16x32_bf16 v[236:239], a[48:51], a[232:235], 0
    v_mfma_f32_16x16x32_bf16 v[236:239], a[52:55], a[236:239], v[236:239]
    v_mfma_f32_16x16x32_bf16 v[236:239], a[56:59], a[240:243], v[236:239]
    v_mfma_f32_16x16x32_bf16 v[236:239], a[60:63], a[244:247], v[236:239]
    v_cvt_pk_bf16_f32 v150, v228, v229
    v_cvt_pk_bf16_f32 v151, v230, v231
    v_mfma_f32_16x16x32_bf16 v[236:239], a[64:67], a[216:219], v[236:239]
    v_mfma_f32_16x16x32_bf16 v[236:239], a[68:71], a[220:223], v[236:239]
    v_cvt_pk_bf16_f32 v152, v232, v233
    v_cvt_pk_bf16_f32 v153, v234, v235
    v_mfma_f32_16x16x32_bf16 v[228:231], a[232:235], a[72:75], 0
    v_mfma_f32_16x16x32_bf16 v[228:231], a[236:239], a[76:79], v[228:231]
    v_mfma_f32_16x16x32_bf16 v[228:231], a[240:243], a[80:83], v[228:231]
    v_mfma_f32_16x16x32_bf16 v[228:231], a[244:247], a[84:87], v[228:231]
    v_mfma_f32_16x16x32_bf16 v[228:231], a[216:219], a[88:91], v[228:231]
    v_mfma_f32_16x16x32_bf16 v[228:231], a[220:223], a[92:95], v[228:231]
    v_cvt_pk_bf16_f32 v154, v236, v237
    v_cvt_pk_bf16_f32 v155, v238, v239
    v_mfma_f32_16x16x32_bf16 v[232:235], a[232:235], a[96:99], 0
    v_mfma_f32_16x16x32_bf16 v[232:235], a[236:239], a[100:103], v[232:235]
    v_mfma_f32_16x16x32_bf16 v[232:235], a[240:243], a[104:107], v[232:235]
    v_mfma_f32_16x16x32_bf16 v[232:235], a[244:247], a[108:111], v[232:235]
    v_mfma_f32_16x16x32_bf16 v[232:235], a[216:219], a[112:115], v[232:235]
    v_mfma_f32_16x16x32_bf16 v[232:235], a[220:223], a[116:119], v[232:235]
    v_cvt_pk_bf16_f32 v14, v228, v229
    v_cvt_pk_bf16_f32 v17, v230, v231
    v_mfma_f32_16x16x32_bf16 v[236:239], a[232:235], a[120:123], 0
    ds_read_b128 a[232:235], v242 offset:128
    s_waitcnt lgkmcnt(1)
    v_mfma_f32_16x16x32_bf16 v[236:239], a[236:239], a[124:127], v[236:239]
    ds_read_b128 a[236:239], v243 offset:128
    v_mfma_f32_16x16x32_bf16 v[236:239], a[240:243], a[128:131], v[236:239]
    v_cvt_pk_bf16_f32 v44, v232, v233
    v_cvt_pk_bf16_f32 v47, v234, v235
    v_mfma_f32_16x16x32_bf16 v[236:239], a[244:247], a[132:135], v[236:239]
    ds_read_b128 a[240:243], v242 offset:256
    ds_read_b128 a[244:247], v243 offset:256
    v_mfma_f32_16x16x32_bf16 v[236:239], a[216:219], a[136:139], v[236:239]
    ds_read_b128 a[216:219], v240 offset:4608
    v_mfma_f32_16x16x32_bf16 v[236:239], a[220:223], a[140:143], v[236:239]
    ds_read_b128 a[220:223], v241 offset:4608
    v_mfma_f32_16x16x32_bf16 v[228:231], a[144:147], a[224:227], 0
    v_mfma_f32_16x16x32_bf16 v[228:231], a[148:151], a[228:231], v[228:231]
    v_mfma_f32_16x16x32_bf16 v[232:235], a[168:171], a[224:227], 0
    v_mfma_f32_16x16x32_bf16 v[232:235], a[172:175], a[228:231], v[232:235]
    s_waitcnt lgkmcnt(5)
    v_mfma_f32_16x16x32_bf16 v[228:231], a[152:155], a[232:235], v[228:231]
    s_waitcnt lgkmcnt(4)
    v_cvt_pk_bf16_f32 v74, v236, v237
    v_cvt_pk_bf16_f32 v77, v238, v239
    v_mfma_f32_16x16x32_bf16 v[228:231], a[156:159], a[236:239], v[228:231]
    v_mfma_f32_16x16x32_bf16 v[232:235], a[176:179], a[232:235], v[232:235]
    s_waitcnt lgkmcnt(3)
    v_mfma_f32_16x16x32_bf16 v[228:231], a[160:163], a[240:243], v[228:231]
    s_waitcnt lgkmcnt(2)
    v_mfma_f32_16x16x32_bf16 v[228:231], a[164:167], a[244:247], v[228:231]
    v_mfma_f32_16x16x32_bf16 v[232:235], a[180:183], a[236:239], v[232:235]
    v_mfma_f32_16x16x32_bf16 v[232:235], a[184:187], a[240:243], v[232:235]
    v_mfma_f32_16x16x32_bf16 v[232:235], a[188:191], a[244:247], v[232:235]
    v_mfma_f32_16x16x32_bf16 v[236:239], a[192:195], a[224:227], 0
    ds_read_b128 a[224:227], v240 offset:4736
    v_mfma_f32_16x16x32_bf16 v[236:239], a[196:199], a[228:231], v[236:239]
    ds_read_b128 a[228:231], v241 offset:4736
    v_mfma_f32_16x16x32_bf16 v[236:239], a[200:203], a[232:235], v[236:239]
    v_mul_f32 v228, s38, v228
    v_mul_f32 v229, s38, v229
    v_mfma_f32_16x16x32_bf16 v[236:239], a[204:207], a[236:239], v[236:239]
    v_mul_f32 v230, s38, v230
    v_mul_f32 v231, s38, v231
    v_mfma_f32_16x16x32_bf16 v[236:239], a[208:211], a[240:243], v[236:239]
    v_cvt_pk_bf16_f32 v168, v228, v229
    v_cvt_pk_bf16_f32 v169, v230, v231
    v_mfma_f32_16x16x32_bf16 v[236:239], a[212:215], a[244:247], v[236:239]
    s_waitcnt lgkmcnt(2)
    v_mul_f32 v232, s3, v232
    v_mul_f32 v233, s3, v233
    v_mfma_f32_16x16x32_bf16 v[228:231], a[0:3], a[216:219], 0
    v_mul_f32 v234, s3, v234
    v_mul_f32 v235, s3, v235
    v_mfma_f32_16x16x32_bf16 v[228:231], a[4:7], a[220:223], v[228:231]
    v_cvt_pk_bf16_f32 v170, v232, v233
    v_cvt_pk_bf16_f32 v171, v234, v235
    v_mfma_f32_16x16x32_bf16 v[232:235], a[24:27], a[216:219], 0
    v_mul_f32 v236, s38, v236
    v_mul_f32 v237, s38, v237
    v_mfma_f32_16x16x32_bf16 v[196:199], v[90:93], v[168:171], v[196:199]
    s_waitcnt lgkmcnt(1)
    v_mul_f32 v238, s38, v238
    v_mul_f32 v239, s38, v239
    v_mfma_f32_16x16x32_bf16 v[200:203], v[114:117], v[168:171], v[200:203]
    v_cvt_pk_bf16_f32 v172, v236, v237
    v_cvt_pk_bf16_f32 v173, v238, v239
    v_mfma_f32_16x16x32_bf16 v[204:207], v[138:141], v[168:171], v[204:207]
    ds_read_b128 a[232:235], v240 offset:4864
    ds_read_b128 a[236:239], v241 offset:4864
    v_mfma_f32_16x16x32_bf16 v[196:199], v[92:95], v[170:173], v[196:199]
    ds_read_b128 a[240:243], v242 offset:1536
    ds_read_b128 a[244:247], v243 offset:1536
    v_mfma_f32_16x16x32_bf16 v[200:203], v[116:119], v[170:173], v[200:203]
    v_add_u32 v240, 0xffff1000, v240
    v_add_u32 v241, 0xffff1000, v241
    v_mfma_f32_16x16x32_bf16 v[204:207], v[140:143], v[170:173], v[204:207]
    v_mfma_f32_16x16x32_bf16 v[208:211], v[96:99], v[168:171], v[208:211]
    v_mfma_f32_16x16x32_bf16 v[208:211], v[98:101], v[170:173], v[208:211]
    v_max_f32 v248, v196, v197
    v_max3_f32 v248, v248, v198, v199
    v_mfma_f32_16x16x32_bf16 v[228:231], a[8:11], a[224:227], v[228:231]
    ds_read_b128 v[196:199], v245 offset:256
    v_max3_f32 v248, v248, v200, v201
    v_mfma_f32_16x16x32_bf16 v[232:235], a[28:31], a[220:223], v[232:235]
    s_waitcnt lgkmcnt(5)
    v_max3_f32 v248, v248, v202, v203
    v_max3_f32 v248, v248, v204, v205
    v_mfma_f32_16x16x32_bf16 v[228:231], a[12:15], a[228:231], v[228:231]
    ds_read_b128 v[200:203], v246 offset:256
    v_max3_f32 v248, v248, v206, v207
    v_mfma_f32_16x16x32_bf16 v[232:235], a[32:35], a[224:227], v[232:235]
    ds_read_b128 v[204:207], v244 offset:320
    v_max3_f32 v248, v248, v208, v209
    v_mfma_f32_16x16x32_bf16 v[232:235], a[36:39], a[228:231], v[232:235]
    s_waitcnt lgkmcnt(4)
    v_max3_f32 v248, v248, v210, v211
    v_mfma_f32_16x16x32_bf16 v[228:231], a[16:19], a[232:235], v[228:231]
    ds_read_b128 v[208:211], v245 offset:320
    v_mfma_f32_16x16x32_bf16 v[228:231], a[20:23], a[236:239], v[228:231]
    v_mfma_f32_16x16x32_bf16 v[232:235], a[40:43], a[232:235], v[232:235]
    v_mfma_f32_16x16x32_bf16 v[232:235], a[44:47], a[236:239], v[232:235]
    v_mfma_f32_16x16x32_bf16 v[236:239], a[48:51], a[216:219], 0
    s_waitcnt lgkmcnt(3)
    v_mfma_f32_16x16x32_bf16 v[196:199], v[120:123], v[168:171], v[196:199]
    v_mfma_f32_16x16x32_bf16 v[196:199], v[122:125], v[170:173], v[196:199]
    s_waitcnt lgkmcnt(2)
    s_waitcnt lgkmcnt(1)
    v_cvt_pk_bf16_f32 v156, v228, v229
    v_mfma_f32_16x16x32_bf16 v[200:203], v[144:147], v[168:171], v[200:203]
    v_cvt_pk_bf16_f32 v157, v230, v231
    v_cvt_pk_bf16_f32 v158, v232, v233
    v_mfma_f32_16x16x32_bf16 v[200:203], v[146:149], v[170:173], v[200:203]
    v_cvt_pk_bf16_f32 v159, v234, v235
    v_max3_f32 v248, v248, v196, v197
    v_mfma_f32_16x16x32_bf16 v[204:207], v[102:105], v[168:171], v[204:207]
    s_waitcnt lgkmcnt(0)
    v_max3_f32 v248, v248, v198, v199
    v_mfma_f32_16x16x32_bf16 v[204:207], v[104:107], v[170:173], v[204:207]
    ds_read_b128 v[196:199], v246 offset:320
    v_mfma_f32_16x16x32_bf16 v[208:211], v[126:129], v[168:171], v[208:211]
    v_max3_f32 v248, v248, v200, v201
    v_max3_f32 v248, v248, v202, v203
    v_mfma_f32_16x16x32_bf16 v[208:211], v[128:131], v[170:173], v[208:211]
    ds_read_b128 v[200:203], v244 offset:192
    v_mfma_f32_16x16x32_bf16 v[236:239], a[52:55], a[220:223], v[236:239]
    v_mfma_f32_16x16x32_bf16 v[236:239], a[56:59], a[224:227], v[236:239]
    v_max3_f32 v248, v248, v204, v205
    v_mfma_f32_16x16x32_bf16 v[236:239], a[60:63], a[228:231], v[236:239]
    ds_read_b128 v[204:207], v245 offset:192
    v_mfma_f32_16x16x32_bf16 v[236:239], a[64:67], a[232:235], v[236:239]
    v_mfma_f32_16x16x32_bf16 v[236:239], a[68:71], a[236:239], v[236:239]
    v_max3_f32 v248, v248, v208, v209
    v_mfma_f32_16x16x32_bf16 v[228:231], a[216:219], a[72:75], 0
    ds_read_b128 v[208:211], v246 offset:192
    s_waitcnt lgkmcnt(3)
    v_mfma_f32_16x16x32_bf16 v[196:199], v[150:153], v[168:171], v[196:199]
    v_mfma_f32_16x16x32_bf16 v[196:199], v[152:155], v[170:173], v[196:199]
    v_mfma_f32_16x16x32_bf16 v[228:231], a[220:223], a[76:79], v[228:231]
    s_waitcnt lgkmcnt(2)
    v_cvt_pk_bf16_f32 v160, v236, v237
    v_cvt_pk_bf16_f32 v161, v238, v239
    v_mfma_f32_16x16x32_bf16 v[200:203], v[90:93], v[168:171], v[200:203]
    v_mfma_f32_16x16x32_bf16 v[200:203], v[92:95], v[170:173], v[200:203]
    v_mfma_f32_16x16x32_bf16 v[228:231], a[224:227], a[80:83], v[228:231]
    s_waitcnt lgkmcnt(1)
    v_max3_f32 v248, v248, v196, v197
    v_mov_b32 v225, v248
    v_mfma_f32_16x16x32_bf16 v[204:207], v[114:117], v[168:171], v[204:207]
    ds_read_b128 v[196:199], v244 offset:256
    v_permlane16_swap_b32 v248, v225
    v_mfma_f32_16x16x32_bf16 v[204:207], v[116:119], v[170:173], v[204:207]
    v_max_f32 v248, v248, v225
    v_mov_b32 v225, v248
    v_mfma_f32_16x16x32_bf16 v[228:231], a[228:231], a[84:87], v[228:231]
    s_waitcnt lgkmcnt(1)
    v_permlane32_swap_b32 v248, v225
    v_max_f32 v248, v248, v225
    v_mfma_f32_16x16x32_bf16 v[208:211], v[138:141], v[168:171], v[208:211]
    v_sub_f32 v200, v200, v248
    v_sub_f32 v201, v201, v248
    v_mfma_f32_16x16x32_bf16 v[208:211], v[140:143], v[170:173], v[208:211]
    v_exp_f32 v200, v200
    v_mfma_f32_16x16x32_bf16 v[228:231], a[232:235], a[88:91], v[228:231]
    v_exp_f32 v201, v201
    v_mfma_f32_16x16x32_bf16 v[228:231], a[236:239], a[92:95], v[228:231]
    v_sub_f32 v202, v202, v248
    v_sub_f32 v203, v203, v248
    v_mfma_f32_16x16x32_bf16 v[232:235], a[216:219], a[96:99], 0
    v_exp_f32 v202, v202
    v_mfma_f32_16x16x32_bf16 v[232:235], a[220:223], a[100:103], v[232:235]
    v_exp_f32 v203, v203
    v_mfma_f32_16x16x32_bf16 v[232:235], a[224:227], a[104:107], v[232:235]
    s_waitcnt lgkmcnt(0)
    v_cvt_pk_bf16_f32 v20, v228, v229
    v_cvt_pk_bf16_f32 v23, v230, v231
    v_mfma_f32_16x16x32_bf16 v[196:199], v[96:99], v[168:171], v[196:199]
    v_cvt_pk_bf16_f32 v180, v200, v201
    v_cvt_pk_bf16_f32 v183, v202, v203
    v_mfma_f32_16x16x32_bf16 v[196:199], v[98:101], v[170:173], v[196:199]
    ds_read_b128 v[200:203], v245 offset:256
    v_sub_f32 v204, v204, v248
    v_mfma_f32_16x16x32_bf16 v[232:235], a[228:231], a[108:111], v[232:235]
    v_exp_f32 v204, v204
    v_mfma_f32_16x16x32_bf16 v[232:235], a[232:235], a[112:115], v[232:235]
    v_sub_f32 v205, v205, v248
    v_sub_f32 v206, v206, v248
    v_mfma_f32_16x16x32_bf16 v[232:235], a[236:239], a[116:119], v[232:235]
    v_exp_f32 v205, v205
    v_mfma_f32_16x16x32_bf16 v[236:239], a[216:219], a[120:123], 0
    ds_read_b128 a[216:219], v242 offset:1664
    v_sub_f32 v207, v207, v248
    v_mfma_f32_16x16x32_bf16 v[236:239], a[220:223], a[124:127], v[236:239]
    ds_read_b128 a[220:223], v243 offset:1664
    v_cvt_pk_bf16_f32 v181, v204, v205
    v_mfma_f32_16x16x32_bf16 v[236:239], a[224:227], a[128:131], v[236:239]
    v_cvt_pk_bf16_f32 v50, v232, v233
    v_cvt_pk_bf16_f32 v53, v234, v235
    v_mfma_f32_16x16x32_bf16 v[236:239], a[228:231], a[132:135], v[236:239]
    ds_read_b128 a[224:227], v242 offset:1792
    ds_read_b128 a[228:231], v243 offset:1792
    v_mfma_f32_16x16x32_bf16 v[236:239], a[232:235], a[136:139], v[236:239]
    ds_read_b128 a[232:235], v240 offset:6144
    v_sub_f32 v208, v208, v248
    v_mfma_f32_16x16x32_bf16 v[236:239], a[236:239], a[140:143], v[236:239]
    ds_read_b128 a[236:239], v241 offset:6144
    v_sub_f32 v209, v209, v248
    v_mfma_f32_16x16x32_bf16 v[228:231], a[144:147], a[240:243], 0
    s_waitcnt lgkmcnt(6)
    v_exp_f32 v206, v206
    v_mfma_f32_16x16x32_bf16 v[200:203], v[120:123], v[168:171], v[200:203]
    v_exp_f32 v207, v207
    v_mfma_f32_16x16x32_bf16 v[200:203], v[122:125], v[170:173], v[200:203]
    v_cvt_pk_bf16_f32 v80, v236, v237
    v_cvt_pk_bf16_f32 v83, v238, v239
    v_mfma_f32_16x16x32_bf16 v[228:231], a[148:151], a[244:247], v[228:231]
    s_waitcnt lgkmcnt(5)
    v_cvt_pk_bf16_f32 v184, v206, v207
    v_sub_f32 v210, v210, v248
    v_mfma_f32_16x16x32_bf16 v[228:231], a[152:155], a[216:219], v[228:231]
    ds_read_b128 v[204:207], v246 offset:256
    v_sub_f32 v211, v211, v248
    v_mfma_f32_16x16x32_bf16 v[232:235], a[168:171], a[240:243], 0
    s_waitcnt lgkmcnt(5)
    v_exp_f32 v208, v208
    v_mfma_f32_16x16x32_bf16 v[228:231], a[156:159], a[220:223], v[228:231]
    s_waitcnt lgkmcnt(4)
    v_exp_f32 v209, v209
    v_mfma_f32_16x16x32_bf16 v[228:231], a[160:163], a[224:227], v[228:231]
    s_waitcnt lgkmcnt(3)
    v_exp_f32 v210, v210
    v_mfma_f32_16x16x32_bf16 v[228:231], a[164:167], a[228:231], v[228:231]
    v_exp_f32 v211, v211
    v_mfma_f32_16x16x32_bf16 v[232:235], a[172:175], a[244:247], v[232:235]
    v_cvt_pk_bf16_f32 v182, v208, v209
    v_cvt_pk_bf16_f32 v185, v210, v211
    v_mfma_f32_16x16x32_bf16 v[232:235], a[176:179], a[216:219], v[232:235]
    ds_read_b128 v[208:211], v244 offset:320
    v_sub_f32 v196, v196, v248
    v_mfma_f32_16x16x32_bf16 v[212:215], v[0:3], v[180:183], 0
    v_mul_f32 v228, s38, v228
    v_mul_f32 v229, s38, v229
    v_mfma_f32_16x16x32_bf16 v[216:219], v[30:33], v[180:183], 0
    v_mul_f32 v230, s38, v230
    v_mul_f32 v231, s38, v231
    v_mfma_f32_16x16x32_bf16 v[220:223], v[60:63], v[180:183], 0
    s_waitcnt lgkmcnt(1)
    v_cvt_pk_bf16_f32 v174, v228, v229
    v_cvt_pk_bf16_f32 v175, v230, v231
    v_mfma_f32_16x16x32_bf16 v[224:227], a[248:251], v[180:183], 0
    v_exp_f32 v196, v196
    v_mfma_f32_16x16x32_bf16 v[204:207], v[144:147], v[168:171], v[204:207]
    v_sub_f32 v197, v197, v248
    v_sub_f32 v198, v198, v248
    v_mfma_f32_16x16x32_bf16 v[204:207], v[146:149], v[170:173], v[204:207]
    v_exp_f32 v197, v197
    v_mfma_f32_16x16x32_bf16 v[232:235], a[180:183], a[220:223], v[232:235]
    v_exp_f32 v198, v198
    v_mfma_f32_16x16x32_bf16 v[232:235], a[184:187], a[224:227], v[232:235]
    v_sub_f32 v199, v199, v248
    v_cvt_pk_bf16_f32 v186, v196, v197
    v_mfma_f32_16x16x32_bf16 v[232:235], a[188:191], a[228:231], v[232:235]
    s_waitcnt lgkmcnt(0)
    v_exp_f32 v199, v199
    v_mfma_f32_16x16x32_bf16 v[208:211], v[102:105], v[168:171], v[208:211]
    v_cvt_pk_bf16_f32 v189, v198, v199
    v_sub_f32 v200, v200, v248
    v_mfma_f32_16x16x32_bf16 v[208:211], v[104:107], v[170:173], v[208:211]
    ds_read_b128 v[196:199], v245 offset:320
    v_sub_f32 v201, v201, v248
    v_mfma_f32_16x16x32_bf16 v[236:239], a[192:195], a[240:243], 0
    v_mul_f32 v232, s3, v232
    v_mul_f32 v233, s3, v233
    v_mfma_f32_16x16x32_bf16 v[236:239], a[196:199], a[244:247], v[236:239]
    v_mul_f32 v234, s3, v234
    v_mul_f32 v235, s3, v235
    v_mfma_f32_16x16x32_bf16 v[236:239], a[200:203], a[216:219], v[236:239]
    v_cvt_pk_bf16_f32 v176, v232, v233
    v_cvt_pk_bf16_f32 v177, v234, v235
    v_mfma_f32_16x16x32_bf16 v[236:239], a[204:207], a[220:223], v[236:239]
    ds_read_b128 a[240:243], v240 offset:6272
    ds_read_b128 a[244:247], v241 offset:6272
    v_mfma_f32_16x16x32_bf16 v[236:239], a[208:211], a[224:227], v[236:239]
    ds_read_b128 a[216:219], v240 offset:6400
    ds_read_b128 a[220:223], v241 offset:6400
    v_mfma_f32_16x16x32_bf16 v[236:239], a[212:215], a[228:231], v[236:239]
    ds_read_b128 a[224:227], v240 offset:6144
    ds_read_b128 a[228:231], v241 offset:6144
    v_mfma_f32_16x16x32_bf16 v[228:231], a[0:3], a[232:235], 0
    v_exp_f32 v200, v200
    v_mfma_f32_16x16x32_bf16 v[228:231], a[4:7], a[236:239], v[228:231]
    s_waitcnt lgkmcnt(6)
    v_exp_f32 v201, v201
    v_mfma_f32_16x16x32_bf16 v[196:199], v[126:129], v[168:171], v[196:199]
    v_mul_f32 v236, s38, v236
    v_mul_f32 v237, s38, v237
    v_mfma_f32_16x16x32_bf16 v[196:199], v[128:131], v[170:173], v[196:199]
    v_mul_f32 v238, s38, v238
    v_mul_f32 v239, s38, v239
    v_mfma_f32_16x16x32_bf16 v[232:235], a[24:27], a[232:235], 0
    v_cvt_pk_bf16_f32 v178, v236, v237
    v_cvt_pk_bf16_f32 v179, v238, v239
    v_mfma_f32_16x16x32_bf16 v[232:235], a[28:31], a[236:239], v[232:235]
    s_waitcnt lgkmcnt(5)
    v_sub_f32 v202, v202, v248
    v_sub_f32 v203, v203, v248
    v_mfma_f32_16x16x32_bf16 v[228:231], a[8:11], a[240:243], v[228:231]
    s_waitcnt lgkmcnt(4)
    v_exp_f32 v202, v202
    v_mfma_f32_16x16x32_bf16 v[228:231], a[12:15], a[244:247], v[228:231]
    s_waitcnt lgkmcnt(3)
    v_exp_f32 v203, v203
    v_mfma_f32_16x16x32_bf16 v[228:231], a[16:19], a[216:219], v[228:231]
    s_waitcnt lgkmcnt(2)
    v_cvt_pk_bf16_f32 v187, v200, v201
    v_cvt_pk_bf16_f32 v190, v202, v203
    v_mfma_f32_16x16x32_bf16 v[228:231], a[20:23], a[220:223], v[228:231]
    ds_read_b128 v[200:203], v246 offset:320
    v_sub_f32 v204, v204, v248
    v_mfma_f32_16x16x32_bf16 v[212:215], v[4:7], v[184:187], v[212:215]
    v_exp_f32 v204, v204
    v_mfma_f32_16x16x32_bf16 v[216:219], v[34:37], v[184:187], v[216:219]
    v_sub_f32 v205, v205, v248
    v_sub_f32 v206, v206, v248
    v_mfma_f32_16x16x32_bf16 v[220:223], v[64:67], v[184:187], v[220:223]
    v_cvt_pk_bf16_f32 v162, v228, v229
    v_cvt_pk_bf16_f32 v163, v230, v231
    v_mfma_f32_16x16x32_bf16 v[224:227], a[248:251], v[184:187], v[224:227]
    s_waitcnt lgkmcnt(1)
    v_exp_f32 v205, v205
    v_mfma_f32_16x16x32_bf16 v[232:235], a[32:35], a[240:243], v[232:235]
    v_exp_f32 v206, v206
    v_mfma_f32_16x16x32_bf16 v[232:235], a[36:39], a[244:247], v[232:235]
    v_sub_f32 v207, v207, v248
    v_cvt_pk_bf16_f32 v188, v204, v205
    v_mfma_f32_16x16x32_bf16 v[232:235], a[40:43], a[216:219], v[232:235]
    v_exp_f32 v207, v207
    v_mfma_f32_16x16x32_bf16 v[232:235], a[44:47], a[220:223], v[232:235]
    v_cvt_pk_bf16_f32 v191, v206, v207
    v_sub_f32 v208, v208, v248
    v_mfma_f32_16x16x32_bf16 v[236:239], a[48:51], a[232:235], 0
    ds_read_b128 a[232:235], v240 offset:6272
    ds_read_b128 v[204:207], v244 offset:0
    v_mfma_f32_16x16x32_bf16 v[212:215], v[8:11], v[188:191], v[212:215]
    s_waitcnt lgkmcnt(2)
    v_exp_f32 v208, v208
    v_mfma_f32_16x16x32_bf16 v[216:219], v[38:41], v[188:191], v[216:219]
    v_cvt_pk_bf16_f32 v164, v232, v233
    v_cvt_pk_bf16_f32 v165, v234, v235
    v_mfma_f32_16x16x32_bf16 v[220:223], v[68:71], v[188:191], v[220:223]
    v_sub_f32 v209, v209, v248
    v_sub_f32 v196, v196, v248
    v_mfma_f32_16x16x32_bf16 v[224:227], a[248:251], v[188:191], v[224:227]
    v_exp_f32 v209, v209
    v_mfma_f32_16x16x32_bf16 v[200:203], v[150:153], v[168:171], v[200:203]
    v_cvt_pk_bf16_f32 v192, v208, v209
    v_sub_f32 v197, v197, v248
    v_mfma_f32_16x16x32_bf16 v[200:203], v[152:155], v[170:173], v[200:203]
    ds_read_b128 v[208:211], v245 offset:0
    v_mfma_f32_16x16x32_bf16 v[236:239], a[52:55], a[236:239], v[236:239]
    ds_read_b128 a[236:239], v241 offset:6272
    v_mfma_f32_16x16x32_bf16 v[236:239], a[56:59], a[240:243], v[236:239]
    ds_read_b128 a[240:243], v240 offset:6400
    v_mfma_f32_16x16x32_bf16 v[236:239], a[60:63], a[244:247], v[236:239]
    ds_read_b128 a[244:247], v241 offset:6400
    s_waitcnt lgkmcnt(4)
    v_mfma_f32_16x16x32_bf16 v[204:207], v[96:99], v[174:177], v[204:207]
    v_exp_f32 v196, v196
    v_mfma_f32_16x16x32_bf16 v[204:207], v[98:101], v[176:179], v[204:207]
    v_exp_f32 v197, v197
    v_mfma_f32_16x16x32_bf16 v[236:239], a[64:67], a[216:219], v[236:239]
    ds_read_b128 a[216:219], v240 offset:36864
    v_cvt_pk_bf16_f32 v193, v196, v197
    v_mfma_f32_16x16x32_bf16 v[236:239], a[68:71], a[220:223], v[236:239]
    ds_read_b128 a[220:223], v241 offset:36864
    ds_read_b128 v[196:199], v246 offset:0
    v_mfma_f32_16x16x32_bf16 v[228:231], a[224:227], a[72:75], 0
    v_sub_f32 v200, v200, v248
    v_sub_f32 v201, v201, v248
    v_mfma_f32_16x16x32_bf16 v[228:231], a[228:231], a[76:79], v[228:231]
    s_waitcnt lgkmcnt(6)
    v_exp_f32 v200, v200
    v_mfma_f32_16x16x32_bf16 v[208:211], v[120:123], v[174:177], v[208:211]
    v_cvt_pk_bf16_f32 v166, v236, v237
    v_cvt_pk_bf16_f32 v167, v238, v239
    v_mfma_f32_16x16x32_bf16 v[208:211], v[122:125], v[176:179], v[208:211]
    v_exp_f32 v201, v201
    v_mfma_f32_16x16x32_bf16 v[228:231], a[232:235], a[80:83], v[228:231]
    s_waitcnt lgkmcnt(3)
    v_cvt_pk_bf16_f32 v194, v200, v201
    v_max_f32 v248, v204, v205
    v_mfma_f32_16x16x32_bf16 v[228:231], a[236:239], a[84:87], v[228:231]
    ds_read_b128 v[200:203], v244 offset:64
    v_max3_f32 v248, v248, v206, v207
    v_mfma_f32_16x16x32_bf16 v[212:215], v[12:15], v[192:195], v[212:215]
    ds_read_b128 v[204:207], v245 offset:64
    v_max3_f32 v248, v248, v208, v209
    v_mfma_f32_16x16x32_bf16 v[216:219], v[42:45], v[192:195], v[216:219]
    v_max3_f32 v248, v248, v210, v211
    v_mfma_f32_16x16x32_bf16 v[220:223], v[72:75], v[192:195], v[220:223]
    ds_read_b128 v[208:211], v246 offset:64
    s_waitcnt lgkmcnt(3)
    v_mfma_f32_16x16x32_bf16 v[224:227], a[248:251], v[192:195], v[224:227]
    v_mfma_f32_16x16x32_bf16 v[196:199], v[144:147], v[174:177], v[196:199]
    v_mfma_f32_16x16x32_bf16 v[196:199], v[146:149], v[176:179], v[196:199]
    v_mfma_f32_16x16x32_bf16 v[228:231], a[240:243], a[88:91], v[228:231]
    v_mfma_f32_16x16x32_bf16 v[228:231], a[244:247], a[92:95], v[228:231]
    v_mfma_f32_16x16x32_bf16 v[232:235], a[224:227], a[96:99], 0
    s_waitcnt lgkmcnt(2)
    s_waitcnt lgkmcnt(1)
    v_mfma_f32_16x16x32_bf16 v[200:203], v[102:105], v[174:177], v[200:203]
    v_rcp_f32 v225, v224
    v_mfma_f32_16x16x32_bf16 v[200:203], v[104:107], v[176:179], v[200:203]
    v_mul_f32 v212, v212, v225
    v_mul_f32 v213, v213, v225
    v_mfma_f32_16x16x32_bf16 v[204:207], v[126:129], v[174:177], v[204:207]
    s_waitcnt lgkmcnt(0)
    v_cvt_pk_bf16_f32 v24, v228, v229
    v_cvt_pk_bf16_f32 v27, v230, v231
    v_mfma_f32_16x16x32_bf16 v[204:207], v[128:131], v[176:179], v[204:207]
    v_mul_f32 v214, v214, v225
    v_mul_f32 v215, v215, v225
    v_mfma_f32_16x16x32_bf16 v[208:211], v[150:153], v[174:177], v[208:211]
    v_cvt_pk_bf16_f32 v212, v212, v213
    v_cvt_pk_bf16_f32 v213, v214, v215
    v_mfma_f32_16x16x32_bf16 v[208:211], v[152:155], v[176:179], v[208:211]
    ds_write_b64 v251, v[212:213] offset:0
    v_mfma_f32_16x16x32_bf16 v[232:235], a[228:231], a[100:103], v[232:235]
    v_mul_f32 v216, v216, v225
    v_mul_f32 v217, v217, v225
    v_mfma_f32_16x16x32_bf16 v[232:235], a[232:235], a[104:107], v[232:235]
    v_mul_f32 v218, v218, v225
    v_mul_f32 v219, v219, v225
    v_mfma_f32_16x16x32_bf16 v[232:235], a[236:239], a[108:111], v[232:235]
    v_cvt_pk_bf16_f32 v216, v216, v217
    v_cvt_pk_bf16_f32 v217, v218, v219
    v_mfma_f32_16x16x32_bf16 v[232:235], a[240:243], a[112:115], v[232:235]
    ds_write_b64 v251, v[216:217] offset:128
    v_mfma_f32_16x16x32_bf16 v[232:235], a[244:247], a[116:119], v[232:235]
    v_mul_f32 v220, v220, v225
    v_mul_f32 v221, v221, v225
    v_mfma_f32_16x16x32_bf16 v[236:239], a[224:227], a[120:123], 0
    ds_read_b128 a[224:227], v240 offset:36992
    v_mul_f32 v222, v222, v225
    v_mfma_f32_16x16x32_bf16 v[236:239], a[228:231], a[124:127], v[236:239]
    ds_read_b128 a[228:231], v241 offset:36992
    v_mul_f32 v223, v223, v225
    v_mfma_f32_16x16x32_bf16 v[236:239], a[232:235], a[128:131], v[236:239]
    v_cvt_pk_bf16_f32 v54, v232, v233
    v_cvt_pk_bf16_f32 v57, v234, v235
    v_mfma_f32_16x16x32_bf16 v[236:239], a[236:239], a[132:135], v[236:239]
    ds_read_b128 a[232:235], v240 offset:37120
    ds_read_b128 a[236:239], v241 offset:37120
    v_mfma_f32_16x16x32_bf16 v[236:239], a[240:243], a[136:139], v[236:239]
    ds_read_b128 a[240:243], v242 offset:3072
    v_add_u32 v240, 0xf000, v240
    v_mfma_f32_16x16x32_bf16 v[236:239], a[244:247], a[140:143], v[236:239]
    ds_read_b128 a[244:247], v243 offset:3072
    v_add_u32 v241, 0xf000, v241
    v_mfma_f32_16x16x32_bf16 v[228:231], a[0:3], a[216:219], 0
    v_cvt_pk_bf16_f32 v220, v220, v221
    v_cvt_pk_bf16_f32 v221, v222, v223
    v_mfma_f32_16x16x32_bf16 v[228:231], a[4:7], a[220:223], v[228:231]
    ds_write_b64 v251, v[220:221] offset:256
    v_mfma_f32_16x16x32_bf16 v[232:235], a[24:27], a[216:219], 0
    s_waitcnt lgkmcnt(6)
    v_cvt_pk_bf16_f32 v84, v236, v237
    v_cvt_pk_bf16_f32 v87, v238, v239
    v_mfma_f32_16x16x32_bf16 v[228:231], a[8:11], a[224:227], v[228:231]
    s_waitcnt lgkmcnt(5)
    v_max3_f32 v248, v248, v196, v197
    v_max3_f32 v248, v248, v198, v199
    v_mfma_f32_16x16x32_bf16 v[228:231], a[12:15], a[228:231], v[228:231]
    ds_read_b128 v[196:199], v244 offset:128
    v_max3_f32 v248, v248, v200, v201
    v_mfma_f32_16x16x32_bf16 v[232:235], a[28:31], a[220:223], v[232:235]
    s_waitcnt lgkmcnt(5)
    v_max3_f32 v248, v248, v202, v203
    v_max3_f32 v248, v248, v204, v205
    v_mfma_f32_16x16x32_bf16 v[228:231], a[16:19], a[232:235], v[228:231]
    ds_read_b128 v[200:203], v245 offset:128
    v_max3_f32 v248, v248, v206, v207
    v_mfma_f32_16x16x32_bf16 v[232:235], a[32:35], a[224:227], v[232:235]
    ds_read_b128 v[204:207], v246 offset:128
    v_max3_f32 v248, v248, v208, v209
    v_mfma_f32_16x16x32_bf16 v[232:235], a[36:39], a[228:231], v[232:235]
    s_waitcnt lgkmcnt(4)
    v_max3_f32 v248, v248, v210, v211
    v_mfma_f32_16x16x32_bf16 v[228:231], a[20:23], a[236:239], v[228:231]
    ds_read_b128 v[208:211], v244 offset:0
    v_mfma_f32_16x16x32_bf16 v[232:235], a[40:43], a[232:235], v[232:235]
    v_mfma_f32_16x16x32_bf16 v[232:235], a[44:47], a[236:239], v[232:235]
    v_mfma_f32_16x16x32_bf16 v[236:239], a[48:51], a[216:219], 0
    v_mfma_f32_16x16x32_bf16 v[236:239], a[52:55], a[220:223], v[236:239]
    s_waitcnt lgkmcnt(3)
    v_mfma_f32_16x16x32_bf16 v[196:199], v[108:111], v[174:177], v[196:199]
    v_mfma_f32_16x16x32_bf16 v[196:199], v[110:113], v[176:179], v[196:199]
    s_waitcnt lgkmcnt(2)
    v_cvt_pk_bf16_f32 v90, v228, v229
    v_cvt_pk_bf16_f32 v91, v230, v231
    v_mfma_f32_16x16x32_bf16 v[200:203], v[132:135], v[174:177], v[200:203]
    s_waitcnt lgkmcnt(1)
    v_cvt_pk_bf16_f32 v92, v232, v233
    v_cvt_pk_bf16_f32 v93, v234, v235
    v_mfma_f32_16x16x32_bf16 v[200:203], v[134:137], v[176:179], v[200:203]
    v_max3_f32 v248, v248, v196, v197
    s_waitcnt lgkmcnt(0)
    v_mfma_f32_16x16x32_bf16 v[204:207], v[156:159], v[174:177], v[204:207]
    ds_read_b128 v[196:199], v245 offset:0
    v_mfma_f32_16x16x32_bf16 v[204:207], v[158:161], v[176:179], v[204:207]
    v_mfma_f32_16x16x32_bf16 v[208:211], v[96:99], v[174:177], v[208:211]
    v_mfma_f32_16x16x32_bf16 v[208:211], v[98:101], v[176:179], v[208:211]
    v_mfma_f32_16x16x32_bf16 v[236:239], a[56:59], a[224:227], v[236:239]
    v_max3_f32 v248, v248, v200, v201
    v_mfma_f32_16x16x32_bf16 v[236:239], a[60:63], a[228:231], v[236:239]
    ds_read_b128 v[200:203], v246 offset:0
    v_mfma_f32_16x16x32_bf16 v[236:239], a[64:67], a[232:235], v[236:239]
    v_mfma_f32_16x16x32_bf16 v[236:239], a[68:71], a[236:239], v[236:239]
    v_max3_f32 v248, v248, v204, v205
    v_mov_b32 v225, v248
    v_mfma_f32_16x16x32_bf16 v[228:231], a[216:219], a[72:75], 0
    ds_read_b128 v[204:207], v244 offset:64
    v_permlane16_swap_b32 v248, v225
    v_mfma_f32_16x16x32_bf16 v[228:231], a[220:223], a[76:79], v[228:231]
    s_waitcnt lgkmcnt(2)
    v_max_f32 v248, v248, v225
    v_cvt_pk_bf16_f32 v94, v236, v237
    v_mfma_f32_16x16x32_bf16 v[196:199], v[120:123], v[174:177], v[196:199]
    v_cvt_pk_bf16_f32 v95, v238, v239
    v_mov_b32 v225, v248
    v_mfma_f32_16x16x32_bf16 v[196:199], v[122:125], v[176:179], v[196:199]
    v_mfma_f32_16x16x32_bf16 v[228:231], a[224:227], a[80:83], v[228:231]
    v_permlane32_swap_b32 v248, v225
    v_max_f32 v248, v248, v225
    v_mfma_f32_16x16x32_bf16 v[228:231], a[228:231], a[84:87], v[228:231]
    v_sub_f32 v208, v208, v248
    v_sub_f32 v209, v209, v248
    v_mfma_f32_16x16x32_bf16 v[228:231], a[232:235], a[88:91], v[228:231]
    s_waitcnt lgkmcnt(1)
    v_exp_f32 v208, v208
    v_mfma_f32_16x16x32_bf16 v[200:203], v[144:147], v[174:177], v[200:203]
    v_exp_f32 v209, v209
    v_mfma_f32_16x16x32_bf16 v[200:203], v[146:149], v[176:179], v[200:203]
    v_sub_f32 v210, v210, v248
    v_sub_f32 v211, v211, v248
    v_mfma_f32_16x16x32_bf16 v[228:231], a[236:239], a[92:95], v[228:231]
    s_waitcnt lgkmcnt(0)
    v_exp_f32 v210, v210
    v_mfma_f32_16x16x32_bf16 v[204:207], v[102:105], v[174:177], v[204:207]
    v_exp_f32 v211, v211
    v_mfma_f32_16x16x32_bf16 v[204:207], v[104:107], v[176:179], v[204:207]
    v_cvt_pk_bf16_f32 v180, v208, v209
    v_cvt_pk_bf16_f32 v183, v210, v211
    v_mfma_f32_16x16x32_bf16 v[232:235], a[216:219], a[96:99], 0
    v_cvt_pk_bf16_f32 v25, v228, v229
    v_cvt_pk_bf16_f32 v28, v230, v231
    v_mfma_f32_16x16x32_bf16 v[232:235], a[220:223], a[100:103], v[232:235]
    ds_read_b128 v[208:211], v245 offset:64
    v_sub_f32 v196, v196, v248
    v_mfma_f32_16x16x32_bf16 v[232:235], a[224:227], a[104:107], v[232:235]
    v_exp_f32 v196, v196
    v_mfma_f32_16x16x32_bf16 v[232:235], a[228:231], a[108:111], v[232:235]
    v_sub_f32 v197, v197, v248
    v_sub_f32 v198, v198, v248
    v_mfma_f32_16x16x32_bf16 v[232:235], a[232:235], a[112:115], v[232:235]
    v_exp_f32 v197, v197
    v_mfma_f32_16x16x32_bf16 v[232:235], a[236:239], a[116:119], v[232:235]
    v_exp_f32 v198, v198
    v_mfma_f32_16x16x32_bf16 v[236:239], a[216:219], a[120:123], 0
    ds_read_b128 a[216:219], v242 offset:3200
    v_sub_f32 v199, v199, v248
    v_mfma_f32_16x16x32_bf16 v[236:239], a[220:223], a[124:127], v[236:239]
    ds_read_b128 a[220:223], v243 offset:3200
    v_cvt_pk_bf16_f32 v181, v196, v197
    v_mfma_f32_16x16x32_bf16 v[236:239], a[224:227], a[128:131], v[236:239]
    v_cvt_pk_bf16_f32 v55, v232, v233
    v_cvt_pk_bf16_f32 v58, v234, v235
    v_mfma_f32_16x16x32_bf16 v[236:239], a[228:231], a[132:135], v[236:239]
    ds_read_b128 a[224:227], v242 offset:3328
    ds_read_b128 a[228:231], v243 offset:3328
    v_mfma_f32_16x16x32_bf16 v[236:239], a[232:235], a[136:139], v[236:239]
    ds_read_b128 a[232:235], v240 offset:6144
    v_sub_f32 v200, v200, v248
    v_mfma_f32_16x16x32_bf16 v[236:239], a[236:239], a[140:143], v[236:239]
    ds_read_b128 a[236:239], v241 offset:6144
    v_sub_f32 v201, v201, v248
    v_mfma_f32_16x16x32_bf16 v[228:231], a[144:147], a[240:243], 0
    s_waitcnt lgkmcnt(6)
    v_exp_f32 v199, v199
    v_mfma_f32_16x16x32_bf16 v[208:211], v[126:129], v[174:177], v[208:211]
    v_cvt_pk_bf16_f32 v184, v198, v199
    v_sub_f32 v202, v202, v248
    v_mfma_f32_16x16x32_bf16 v[208:211], v[128:131], v[176:179], v[208:211]
    v_cvt_pk_bf16_f32 v85, v236, v237
    v_cvt_pk_bf16_f32 v88, v238, v239
    v_mfma_f32_16x16x32_bf16 v[228:231], a[148:151], a[244:247], v[228:231]
    ds_read_b128 v[196:199], v246 offset:64
    v_sub_f32 v203, v203, v248
    v_mfma_f32_16x16x32_bf16 v[232:235], a[168:171], a[240:243], 0
    s_waitcnt lgkmcnt(5)
    v_exp_f32 v200, v200
    v_mfma_f32_16x16x32_bf16 v[228:231], a[152:155], a[216:219], v[228:231]
    v_exp_f32 v201, v201
    v_mfma_f32_16x16x32_bf16 v[228:231], a[156:159], a[220:223], v[228:231]
    s_waitcnt lgkmcnt(4)
    v_exp_f32 v202, v202
    v_mfma_f32_16x16x32_bf16 v[228:231], a[160:163], a[224:227], v[228:231]
    s_waitcnt lgkmcnt(3)
    v_exp_f32 v203, v203
    v_mfma_f32_16x16x32_bf16 v[228:231], a[164:167], a[228:231], v[228:231]
    v_cvt_pk_bf16_f32 v182, v200, v201
    v_cvt_pk_bf16_f32 v185, v202, v203
    v_mfma_f32_16x16x32_bf16 v[232:235], a[172:175], a[244:247], v[232:235]
    ds_read_b128 v[200:203], v244 offset:128
    v_sub_f32 v204, v204, v248
    v_mfma_f32_16x16x32_bf16 v[212:215], v[6:9], v[180:183], 0
    v_exp_f32 v204, v204
    v_mfma_f32_16x16x32_bf16 v[216:219], v[36:39], v[180:183], 0
    v_mul_f32 v228, s38, v228
    v_mul_f32 v229, s38, v229
    v_mfma_f32_16x16x32_bf16 v[220:223], v[66:69], v[180:183], 0
    s_waitcnt lgkmcnt(1)
    v_mul_f32 v230, s38, v230
    v_mul_f32 v231, s38, v231
    v_mfma_f32_16x16x32_bf16 v[224:227], a[248:251], v[180:183], 0
    v_cvt_pk_bf16_f32 v168, v228, v229
    v_cvt_pk_bf16_f32 v169, v230, v231
    v_mfma_f32_16x16x32_bf16 v[196:199], v[150:153], v[174:177], v[196:199]
    v_sub_f32 v205, v205, v248
    v_sub_f32 v206, v206, v248
    v_mfma_f32_16x16x32_bf16 v[196:199], v[152:155], v[176:179], v[196:199]
    v_exp_f32 v205, v205
    v_mfma_f32_16x16x32_bf16 v[232:235], a[176:179], a[216:219], v[232:235]
    v_exp_f32 v206, v206
    v_mfma_f32_16x16x32_bf16 v[232:235], a[180:183], a[220:223], v[232:235]
    v_sub_f32 v207, v207, v248
    v_cvt_pk_bf16_f32 v186, v204, v205
    v_mfma_f32_16x16x32_bf16 v[232:235], a[184:187], a[224:227], v[232:235]
    s_waitcnt lgkmcnt(0)
    v_exp_f32 v207, v207
    v_mfma_f32_16x16x32_bf16 v[200:203], v[108:111], v[174:177], v[200:203]
    v_cvt_pk_bf16_f32 v189, v206, v207
    v_sub_f32 v208, v208, v248
    v_mfma_f32_16x16x32_bf16 v[200:203], v[110:113], v[176:179], v[200:203]
    ds_read_b128 v[204:207], v245 offset:128
    v_sub_f32 v209, v209, v248
    v_mfma_f32_16x16x32_bf16 v[232:235], a[188:191], a[228:231], v[232:235]
    v_exp_f32 v208, v208
    v_mfma_f32_16x16x32_bf16 v[236:239], a[192:195], a[240:243], 0
    ds_read_b128 a[240:243], v240 offset:6272
    v_sub_f32 v210, v210, v248
    v_mfma_f32_16x16x32_bf16 v[236:239], a[196:199], a[244:247], v[236:239]
    ds_read_b128 a[244:247], v241 offset:6272
    v_sub_f32 v211, v211, v248
    v_mfma_f32_16x16x32_bf16 v[236:239], a[200:203], a[216:219], v[236:239]
    v_mul_f32 v232, s3, v232
    v_mul_f32 v233, s3, v233
    v_mfma_f32_16x16x32_bf16 v[236:239], a[204:207], a[220:223], v[236:239]
    v_mul_f32 v234, s3, v234
    v_mul_f32 v235, s3, v235
    v_mfma_f32_16x16x32_bf16 v[236:239], a[208:211], a[224:227], v[236:239]
    v_cvt_pk_bf16_f32 v170, v232, v233
    v_cvt_pk_bf16_f32 v171, v234, v235
    v_mfma_f32_16x16x32_bf16 v[236:239], a[212:215], a[228:231], v[236:239]
    ds_read_b128 a[216:219], v240 offset:6400
    ds_read_b128 a[220:223], v241 offset:6400
    v_mfma_f32_16x16x32_bf16 v[228:231], a[0:3], a[232:235], 0
    ds_read_b128 a[224:227], v254 offset:4608
    ds_read_b128 a[228:231], v255 offset:4608
    v_mfma_f32_16x16x32_bf16 v[228:231], a[4:7], a[236:239], v[228:231]
    s_waitcnt lgkmcnt(6)
    v_exp_f32 v209, v209
    v_mfma_f32_16x16x32_bf16 v[204:207], v[132:135], v[174:177], v[204:207]
    s_waitcnt lgkmcnt(5)
    v_mul_f32 v236, s38, v236
    v_mul_f32 v237, s38, v237
    v_mfma_f32_16x16x32_bf16 v[204:207], v[134:137], v[176:179], v[204:207]
    v_mul_f32 v238, s38, v238
    v_mul_f32 v239, s38, v239
    v_mfma_f32_16x16x32_bf16 v[228:231], a[8:11], a[240:243], v[228:231]
    s_waitcnt lgkmcnt(4)
    v_cvt_pk_bf16_f32 v172, v236, v237
    v_cvt_pk_bf16_f32 v173, v238, v239
    v_mfma_f32_16x16x32_bf16 v[228:231], a[12:15], a[244:247], v[228:231]
    v_exp_f32 v210, v210
    v_mfma_f32_16x16x32_bf16 v[232:235], a[24:27], a[232:235], 0
    v_exp_f32 v211, v211
    v_mfma_f32_16x16x32_bf16 v[232:235], a[28:31], a[236:239], v[232:235]
    s_waitcnt lgkmcnt(3)
    v_cvt_pk_bf16_f32 v187, v208, v209
    v_cvt_pk_bf16_f32 v190, v210, v211
    v_mfma_f32_16x16x32_bf16 v[228:231], a[16:19], a[216:219], v[228:231]
    ds_read_b128 v[208:211], v246 offset:128
    v_sub_f32 v196, v196, v248
    v_mfma_f32_16x16x32_bf16 v[212:215], v[10:13], v[184:187], v[212:215]
    s_waitcnt lgkmcnt(2)
    v_exp_f32 v196, v196
    v_mfma_f32_16x16x32_bf16 v[216:219], v[40:43], v[184:187], v[216:219]
    v_sub_f32 v197, v197, v248
    v_sub_f32 v198, v198, v248
    v_mfma_f32_16x16x32_bf16 v[220:223], v[70:73], v[184:187], v[220:223]
    v_exp_f32 v197, v197
    v_mfma_f32_16x16x32_bf16 v[224:227], a[248:251], v[184:187], v[224:227]
    v_exp_f32 v198, v198
    v_mfma_f32_16x16x32_bf16 v[228:231], a[20:23], a[220:223], v[228:231]
    v_sub_f32 v199, v199, v248
    v_cvt_pk_bf16_f32 v188, v196, v197
    v_mfma_f32_16x16x32_bf16 v[232:235], a[32:35], a[240:243], v[232:235]
    v_exp_f32 v199, v199
    v_mfma_f32_16x16x32_bf16 v[232:235], a[36:39], a[244:247], v[232:235]
    v_cvt_pk_bf16_f32 v191, v198, v199
    v_sub_f32 v200, v200, v248
    v_mfma_f32_16x16x32_bf16 v[232:235], a[40:43], a[216:219], v[232:235]
    v_cvt_pk_bf16_f32 v96, v228, v229
    v_cvt_pk_bf16_f32 v97, v230, v231
    v_mfma_f32_16x16x32_bf16 v[212:215], v[14:17], v[188:191], v[212:215]
    ds_read_b128 v[196:199], v244 offset:0
    v_sub_f32 v201, v201, v248
    v_mfma_f32_16x16x32_bf16 v[216:219], v[44:47], v[188:191], v[216:219]
    s_waitcnt lgkmcnt(1)
    v_exp_f32 v200, v200
    v_mfma_f32_16x16x32_bf16 v[220:223], v[74:77], v[188:191], v[220:223]
    v_exp_f32 v201, v201
    v_mfma_f32_16x16x32_bf16 v[224:227], a[248:251], v[188:191], v[224:227]
    v_cvt_pk_bf16_f32 v192, v200, v201
    v_sub_f32 v204, v204, v248
    v_mfma_f32_16x16x32_bf16 v[208:211], v[156:159], v[174:177], v[208:211]
    ds_read_b128 v[200:203], v245 offset:0
    v_sub_f32 v205, v205, v248
    v_mfma_f32_16x16x32_bf16 v[208:211], v[158:161], v[176:179], v[208:211]
    v_exp_f32 v204, v204
    v_mfma_f32_16x16x32_bf16 v[232:235], a[44:47], a[220:223], v[232:235]
    v_exp_f32 v205, v205
    v_mfma_f32_16x16x32_bf16 v[236:239], a[48:51], a[232:235], 0
    v_cvt_pk_bf16_f32 v193, v204, v205
    v_mfma_f32_16x16x32_bf16 v[236:239], a[52:55], a[236:239], v[236:239]
    ds_read_b128 v[204:207], v246 offset:0
    s_waitcnt lgkmcnt(2)
    v_mfma_f32_16x16x32_bf16 v[196:199], v[102:105], v[168:171], v[196:199]
    v_sub_f32 v208, v208, v248
    v_cvt_pk_bf16_f32 v98, v232, v233
    v_mfma_f32_16x16x32_bf16 v[196:199], v[104:107], v[170:173], v[196:199]
    v_cvt_pk_bf16_f32 v99, v234, v235
    v_sub_f32 v209, v209, v248
    v_mfma_f32_16x16x32_bf16 v[236:239], a[56:59], a[240:243], v[236:239]
    v_exp_f32 v208, v208
    v_mfma_f32_16x16x32_bf16 v[236:239], a[60:63], a[244:247], v[236:239]
    v_exp_f32 v209, v209
    v_mfma_f32_16x16x32_bf16 v[236:239], a[64:67], a[216:219], v[236:239]
    s_waitcnt lgkmcnt(1)
    v_cvt_pk_bf16_f32 v194, v208, v209
    v_max_f32 v248, v196, v197
    v_mfma_f32_16x16x32_bf16 v[200:203], v[126:129], v[168:171], v[200:203]
    ds_read_b128 v[208:211], v244 offset:64
    v_max3_f32 v248, v248, v198, v199
    v_mfma_f32_16x16x32_bf16 v[212:215], v[18:21], v[192:195], v[212:215]
    ds_read_b128 v[196:199], v245 offset:64
    v_mfma_f32_16x16x32_bf16 v[216:219], v[48:51], v[192:195], v[216:219]
    v_mfma_f32_16x16x32_bf16 v[220:223], v[78:81], v[192:195], v[220:223]
    s_waitcnt lgkmcnt(2)
    v_mfma_f32_16x16x32_bf16 v[224:227], a[248:251], v[192:195], v[224:227]
    v_mfma_f32_16x16x32_bf16 v[200:203], v[128:131], v[170:173], v[200:203]
    v_mfma_f32_16x16x32_bf16 v[204:207], v[150:153], v[168:171], v[204:207]
    v_mfma_f32_16x16x32_bf16 v[204:207], v[152:155], v[170:173], v[204:207]
    v_mfma_f32_16x16x32_bf16 v[236:239], a[68:71], a[220:223], v[236:239]
    v_mfma_f32_16x16x32_bf16 v[228:231], a[232:235], a[72:75], 0
    s_waitcnt lgkmcnt(1)
    s_waitcnt lgkmcnt(0)
    v_mfma_f32_16x16x32_bf16 v[208:211], v[108:111], v[168:171], v[208:211]
    v_rcp_f32 v225, v224
    v_mfma_f32_16x16x32_bf16 v[208:211], v[110:113], v[170:173], v[208:211]
    v_mul_f32 v212, v212, v225
    v_mul_f32 v213, v213, v225
    v_mfma_f32_16x16x32_bf16 v[196:199], v[132:135], v[168:171], v[196:199]
    v_cvt_pk_bf16_f32 v100, v236, v237
    v_cvt_pk_bf16_f32 v101, v238, v239
    v_mfma_f32_16x16x32_bf16 v[196:199], v[134:137], v[170:173], v[196:199]
    v_mul_f32 v214, v214, v225
    v_mul_f32 v215, v215, v225
    v_mfma_f32_16x16x32_bf16 v[228:231], a[236:239], a[76:79], v[228:231]
    v_cvt_pk_bf16_f32 v212, v212, v213
    v_cvt_pk_bf16_f32 v213, v214, v215
    v_mfma_f32_16x16x32_bf16 v[228:231], a[240:243], a[80:83], v[228:231]
    ds_write_b64 v251, v[212:213] offset:6144
    v_mfma_f32_16x16x32_bf16 v[228:231], a[244:247], a[84:87], v[228:231]
    v_mul_f32 v216, v216, v225
    v_mul_f32 v217, v217, v225
    v_mfma_f32_16x16x32_bf16 v[228:231], a[216:219], a[88:91], v[228:231]
    v_mul_f32 v218, v218, v225
    v_mul_f32 v219, v219, v225
    v_mfma_f32_16x16x32_bf16 v[228:231], a[220:223], a[92:95], v[228:231]
    v_cvt_pk_bf16_f32 v216, v216, v217
    v_cvt_pk_bf16_f32 v217, v218, v219
    v_mfma_f32_16x16x32_bf16 v[232:235], a[232:235], a[96:99], 0
    ds_write_b64 v251, v[216:217] offset:6272
    v_mfma_f32_16x16x32_bf16 v[232:235], a[236:239], a[100:103], v[232:235]
    v_mul_f32 v220, v220, v225
    v_mul_f32 v221, v221, v225
    v_mfma_f32_16x16x32_bf16 v[232:235], a[240:243], a[104:107], v[232:235]
    v_cvt_pk_bf16_f32 v26, v228, v229
    v_cvt_pk_bf16_f32 v29, v230, v231
    v_mfma_f32_16x16x32_bf16 v[232:235], a[244:247], a[108:111], v[232:235]
    v_mul_f32 v222, v222, v225
    v_mul_f32 v223, v223, v225
    v_mfma_f32_16x16x32_bf16 v[232:235], a[216:219], a[112:115], v[232:235]
    v_cvt_pk_bf16_f32 v220, v220, v221
    v_cvt_pk_bf16_f32 v221, v222, v223
    v_mfma_f32_16x16x32_bf16 v[232:235], a[220:223], a[116:119], v[232:235]
    ds_write_b64 v251, v[220:221] offset:6400
    v_mfma_f32_16x16x32_bf16 v[236:239], a[232:235], a[120:123], 0
    ds_read_b128 a[232:235], v254 offset:4736
    v_max3_f32 v248, v248, v200, v201
    v_mfma_f32_16x16x32_bf16 v[236:239], a[236:239], a[124:127], v[236:239]
    ds_read_b128 a[236:239], v255 offset:4736
    v_max3_f32 v248, v248, v202, v203
    v_mfma_f32_16x16x32_bf16 v[236:239], a[240:243], a[128:131], v[236:239]
    v_cvt_pk_bf16_f32 v56, v232, v233
    v_cvt_pk_bf16_f32 v59, v234, v235
    v_mfma_f32_16x16x32_bf16 v[236:239], a[244:247], a[132:135], v[236:239]
    ds_read_b128 a[240:243], v254 offset:4864
    ds_read_b128 a[244:247], v255 offset:4864
    v_mfma_f32_16x16x32_bf16 v[236:239], a[216:219], a[136:139], v[236:239]
    ds_read_b128 v[200:203], v246 offset:64
    v_accvgpr_read_b32 v254, a252
    v_mfma_f32_16x16x32_bf16 v[236:239], a[220:223], a[140:143], v[236:239]
    buffer_load_dwordx4 v254, s[4:7], s44 offen lds
    v_accvgpr_read_b32 v255, a253
    v_mfma_f32_16x16x32_bf16 v[228:231], a[144:147], a[224:227], 0
    v_accvgpr_read_b32 v254, a254
    v_max3_f32 v248, v248, v204, v205
    v_mfma_f32_16x16x32_bf16 v[228:231], a[148:151], a[228:231], v[228:231]
    v_max3_f32 v248, v248, v206, v207
    v_max3_f32 v248, v248, v208, v209
    v_mfma_f32_16x16x32_bf16 v[232:235], a[168:171], a[224:227], 0
    v_cvt_pk_bf16_f32 v86, v236, v237
    v_cvt_pk_bf16_f32 v89, v238, v239
    v_mfma_f32_16x16x32_bf16 v[232:235], a[172:175], a[228:231], v[232:235]
    ds_read_b128 v[204:207], v244 offset:128
    v_max3_f32 v248, v248, v210, v211
    v_mfma_f32_16x16x32_bf16 v[236:239], a[192:195], a[224:227], 0
    ds_read_b128 v[208:211], v245 offset:128
    v_max3_f32 v248, v248, v196, v197
    v_mfma_f32_16x16x32_bf16 v[236:239], a[196:199], a[228:231], v[236:239]
    s_waitcnt lgkmcnt(5)
    v_max3_f32 v248, v248, v198, v199
    v_mfma_f32_16x16x32_bf16 v[228:231], a[152:155], a[232:235], v[228:231]
    ds_read_b128 v[196:199], v246 offset:128
    s_waitcnt vmcnt(6) lgkmcnt(4)
    v_mfma_f32_16x16x32_bf16 v[228:231], a[156:159], a[236:239], v[228:231]
    s_barrier
    ds_read_b128 a[216:219], v240 offset:30720
    v_mfma_f32_16x16x32_bf16 v[228:231], a[160:163], a[240:243], v[228:231]
    ds_read_b128 a[220:223], v241 offset:30720
    ds_read_b128 a[224:227], v240 offset:30848
    v_mfma_f32_16x16x32_bf16 v[228:231], a[164:167], a[244:247], v[228:231]
    ds_read_b128 a[228:231], v241 offset:30848
    buffer_load_dwordx4 v255, s[4:7], s44 offen offset:1024 lds
    v_mfma_f32_16x16x32_bf16 v[232:235], a[176:179], a[232:235], v[232:235]
    s_waitcnt lgkmcnt(7)
    v_accvgpr_read_b32 v255, a252
    v_mfma_f32_16x16x32_bf16 v[200:203], v[156:159], v[168:171], v[200:203]
    s_waitcnt lgkmcnt(6)
    v_mfma_f32_16x16x32_bf16 v[200:203], v[158:161], v[170:173], v[200:203]
    s_waitcnt lgkmcnt(5)
    v_mul_f32 v228, s38, v228
    v_mul_f32 v229, s38, v229
    v_mfma_f32_16x16x32_bf16 v[204:207], v[162:165], v[168:171], v[204:207]
    v_mul_f32 v230, s38, v230
    v_mul_f32 v231, s38, v231
    v_mfma_f32_16x16x32_bf16 v[204:207], v[164:167], v[170:173], v[204:207]
    s_waitcnt lgkmcnt(4)
    v_cvt_pk_bf16_f32 v174, v228, v229
    v_cvt_pk_bf16_f32 v175, v230, v231
    v_mfma_f32_16x16x32_bf16 v[208:211], v[90:93], v[168:171], v[208:211]
    ds_write_b64 v247, v[174:175] offset:0
    v_mfma_f32_16x16x32_bf16 v[208:211], v[92:95], v[170:173], v[208:211]
    buffer_load_dwordx4 v254, s[4:7], s44 offen offset:2048 lds
    s_add_u32 m0, s46, 0xc00
    v_mfma_f32_16x16x32_bf16 v[196:199], v[96:99], v[168:171], v[196:199]
    s_waitcnt lgkmcnt(2)
    v_accvgpr_read_b32 v254, a253
    v_max3_f32 v248, v248, v200, v201
    v_mfma_f32_16x16x32_bf16 v[196:199], v[98:101], v[170:173], v[196:199]
    v_max3_f32 v248, v248, v202, v203
    v_max3_f32 v248, v248, v204, v205
    v_mfma_f32_16x16x32_bf16 v[232:235], a[180:183], a[236:239], v[232:235]
    ds_read_b128 v[200:203], v244 offset:0
    ds_read_b128 v[204:207], v245 offset:0
    v_mfma_f32_16x16x32_bf16 v[232:235], a[184:187], a[240:243], v[232:235]
    buffer_load_dwordx4 v255, s[4:7], s59 offen lds
    v_accvgpr_read_b32 v255, a254
    v_mfma_f32_16x16x32_bf16 v[232:235], a[188:191], a[244:247], v[232:235]
    v_max3_f32 v248, v248, v208, v209
    v_max3_f32 v248, v248, v196, v197
    v_mfma_f32_16x16x32_bf16 v[236:239], a[200:203], a[232:235], v[236:239]
    ds_read_b128 a[232:235], v240 offset:30976
    ds_read_b128 v[208:211], v246 offset:0
    v_mfma_f32_16x16x32_bf16 v[236:239], a[204:207], a[236:239], v[236:239]
    ds_read_b128 a[236:239], v241 offset:30976
    ds_read_b128 v[196:199], v244 offset:64
    v_mfma_f32_16x16x32_bf16 v[236:239], a[208:211], a[240:243], v[236:239]
    v_mul_f32 v232, s3, v232
    v_mul_f32 v233, s3, v233
    v_mfma_f32_16x16x32_bf16 v[236:239], a[212:215], a[244:247], v[236:239]
    v_mul_f32 v234, s3, v234
    v_mul_f32 v235, s3, v235
    v_mfma_f32_16x16x32_bf16 v[228:231], a[0:3], a[216:219], 0
    v_cvt_pk_bf16_f32 v176, v232, v233
    v_cvt_pk_bf16_f32 v177, v234, v235
    v_mfma_f32_16x16x32_bf16 v[228:231], a[4:7], a[220:223], v[228:231]
    ds_write_b64 v247, v[176:177] offset:128
    v_mfma_f32_16x16x32_bf16 v[228:231], a[8:11], a[224:227], v[228:231]
    s_waitcnt lgkmcnt(5)
    v_mul_f32 v236, s38, v236
    v_mul_f32 v237, s38, v237
    v_mfma_f32_16x16x32_bf16 v[200:203], v[102:105], v[168:171], v[200:203]
    v_mul_f32 v238, s38, v238
    v_mul_f32 v239, s38, v239
    v_mfma_f32_16x16x32_bf16 v[200:203], v[104:107], v[170:173], v[200:203]
    v_cvt_pk_bf16_f32 v178, v236, v237
    v_cvt_pk_bf16_f32 v179, v238, v239
    v_mfma_f32_16x16x32_bf16 v[204:207], v[126:129], v[168:171], v[204:207]
    ds_write_b64 v247, v[178:179] offset:256
    v_mfma_f32_16x16x32_bf16 v[204:207], v[128:131], v[170:173], v[204:207]
    ds_read_b128 a[240:243], v242 offset:30720
    ds_read_b128 a[244:247], v243 offset:30720
    v_mfma_f32_16x16x32_bf16 v[228:231], a[12:15], a[228:231], v[228:231]
    buffer_load_dwordx4 v254, s[4:7], s59 offen offset:1024 lds
    v_accvgpr_read_b32 v254, a252
    v_mfma_f32_16x16x32_bf16 v[232:235], a[24:27], a[216:219], 0
    s_waitcnt lgkmcnt(4)
    v_mov_b32 v225, v248
    v_mfma_f32_16x16x32_bf16 v[208:211], v[150:153], v[168:171], v[208:211]
    v_mfma_f32_16x16x32_bf16 v[208:211], v[152:155], v[170:173], v[208:211]
    v_permlane16_swap_b32 v248, v225
    v_max_f32 v248, v248, v225
    v_mfma_f32_16x16x32_bf16 v[196:199], v[108:111], v[168:171], v[196:199]
    buffer_load_dwordx4 v255, s[4:7], s59 offen offset:2048 lds
    s_add_u32 m0, s46, 0x1800
    v_mfma_f32_16x16x32_bf16 v[196:199], v[110:113], v[170:173], v[196:199]
    v_accvgpr_read_b32 v255, a255
    v_mov_b32 v225, v248
    v_mfma_f32_16x16x32_bf16 v[228:231], a[16:19], a[232:235], v[228:231]
    v_mfma_f32_16x16x32_bf16 v[228:231], a[20:23], a[236:239], v[228:231]
    v_permlane32_swap_b32 v248, v225
    v_max_f32 v248, v248, v225
    v_mfma_f32_16x16x32_bf16 v[232:235], a[28:31], a[220:223], v[232:235]
    buffer_load_dwordx4 v254, s[4:7], s58 offen lds
    v_mbcnt_lo_u32_b32 v254, -1, 0
    v_mfma_f32_16x16x32_bf16 v[232:235], a[32:35], a[224:227], v[232:235]
    v_mbcnt_hi_u32_b32 v254, -1, v254
    v_sub_f32 v200, v200, v248
    v_mfma_f32_16x16x32_bf16 v[232:235], a[36:39], a[228:231], v[232:235]
    v_cvt_pk_bf16_f32 v102, v228, v229
    v_cvt_pk_bf16_f32 v103, v230, v231
    v_mfma_f32_16x16x32_bf16 v[232:235], a[40:43], a[232:235], v[232:235]
    v_exp_f32 v200, v200
    v_mfma_f32_16x16x32_bf16 v[232:235], a[44:47], a[236:239], v[232:235]
    buffer_load_dwordx4 v255, s[4:7], s58 offen offset:512 lds
    s_add_u32 m0, s46, 0x16800
    v_mfma_f32_16x16x32_bf16 v[236:239], a[48:51], a[216:219], 0
    v_lshrrev_b32 v255, 4, v254
    v_and_b32 v254, 15, v254
    v_mfma_f32_16x16x32_bf16 v[236:239], a[52:55], a[220:223], v[236:239]
    v_sub_f32 v201, v201, v248
    v_sub_f32 v202, v202, v248
    v_mfma_f32_16x16x32_bf16 v[236:239], a[56:59], a[224:227], v[236:239]
    v_cvt_pk_bf16_f32 v104, v232, v233
    v_cvt_pk_bf16_f32 v105, v234, v235
    v_mfma_f32_16x16x32_bf16 v[236:239], a[60:63], a[228:231], v[236:239]
    v_exp_f32 v201, v201
    v_mfma_f32_16x16x32_bf16 v[236:239], a[64:67], a[232:235], v[236:239]
    v_exp_f32 v202, v202
    v_mfma_f32_16x16x32_bf16 v[236:239], a[68:71], a[236:239], v[236:239]
    v_sub_f32 v203, v203, v248
    v_cvt_pk_bf16_f32 v180, v200, v201
    v_mfma_f32_16x16x32_bf16 v[228:231], a[216:219], a[72:75], 0
    v_exp_f32 v203, v203
    v_mfma_f32_16x16x32_bf16 v[228:231], a[220:223], a[76:79], v[228:231]
    v_cvt_pk_bf16_f32 v183, v202, v203
    v_sub_f32 v204, v204, v248
    v_mfma_f32_16x16x32_bf16 v[228:231], a[224:227], a[80:83], v[228:231]
    v_cvt_pk_bf16_f32 v106, v236, v237
    v_cvt_pk_bf16_f32 v107, v238, v239
    v_mfma_f32_16x16x32_bf16 v[228:231], a[228:231], a[84:87], v[228:231]
    ds_read_b128 v[200:203], v245 offset:64
    v_sub_f32 v205, v205, v248
    v_mfma_f32_16x16x32_bf16 v[228:231], a[232:235], a[88:91], v[228:231]
    v_exp_f32 v204, v204
    v_mfma_f32_16x16x32_bf16 v[228:231], a[236:239], a[92:95], v[228:231]
    v_exp_f32 v205, v205
    v_mfma_f32_16x16x32_bf16 v[232:235], a[216:219], a[96:99], 0
    v_sub_f32 v206, v206, v248
    v_sub_f32 v207, v207, v248
    v_mfma_f32_16x16x32_bf16 v[232:235], a[220:223], a[100:103], v[232:235]
    v_exp_f32 v206, v206
    v_mfma_f32_16x16x32_bf16 v[232:235], a[224:227], a[104:107], v[232:235]
    v_exp_f32 v207, v207
    v_mfma_f32_16x16x32_bf16 v[232:235], a[228:231], a[108:111], v[232:235]
    v_cvt_pk_bf16_f32 v0, v228, v229
    v_cvt_pk_bf16_f32 v3, v230, v231
    v_mfma_f32_16x16x32_bf16 v[232:235], a[232:235], a[112:115], v[232:235]
    s_waitcnt lgkmcnt(1)
    v_cvt_pk_bf16_f32 v181, v204, v205
    v_cvt_pk_bf16_f32 v184, v206, v207
    v_mfma_f32_16x16x32_bf16 v[232:235], a[236:239], a[116:119], v[232:235]
    ds_read_b128 v[204:207], v246 offset:64
    v_sub_f32 v208, v208, v248
    v_mfma_f32_16x16x32_bf16 v[236:239], a[216:219], a[120:123], 0
    ds_read_b128 a[216:219], v242 offset:30848
    v_sub_f32 v209, v209, v248
    v_mfma_f32_16x16x32_bf16 v[236:239], a[220:223], a[124:127], v[236:239]
    ds_read_b128 a[220:223], v243 offset:30848
    v_sub_f32 v210, v210, v248
    v_mfma_f32_16x16x32_bf16 v[236:239], a[224:227], a[128:131], v[236:239]
    s_waitcnt lgkmcnt(3)
    v_cvt_pk_bf16_f32 v30, v232, v233
    v_cvt_pk_bf16_f32 v33, v234, v235
    v_mfma_f32_16x16x32_bf16 v[200:203], v[132:135], v[168:171], v[200:203]
    ds_read_b128 a[224:227], v242 offset:30976
    v_sub_f32 v211, v211, v248
    v_mfma_f32_16x16x32_bf16 v[200:203], v[134:137], v[170:173], v[200:203]
    v_exp_f32 v208, v208
    v_mfma_f32_16x16x32_bf16 v[236:239], a[228:231], a[132:135], v[236:239]
    ds_read_b128 a[228:231], v243 offset:30976
    v_sub_f32 v196, v196, v248
    v_mfma_f32_16x16x32_bf16 v[236:239], a[232:235], a[136:139], v[236:239]
    ds_read_b128 a[232:235], v240 offset:32256
    v_sub_f32 v197, v197, v248
    v_mfma_f32_16x16x32_bf16 v[236:239], a[236:239], a[140:143], v[236:239]
    ds_read_b128 a[236:239], v241 offset:32256
    v_sub_f32 v198, v198, v248
    v_mfma_f32_16x16x32_bf16 v[228:231], a[144:147], a[240:243], 0
    s_waitcnt lgkmcnt(6)
    v_exp_f32 v209, v209
    v_mfma_f32_16x16x32_bf16 v[204:207], v[156:159], v[168:171], v[204:207]
    v_exp_f32 v210, v210
    v_mfma_f32_16x16x32_bf16 v[204:207], v[158:161], v[170:173], v[204:207]
    v_cvt_pk_bf16_f32 v60, v236, v237
    v_cvt_pk_bf16_f32 v63, v238, v239
    v_mfma_f32_16x16x32_bf16 v[228:231], a[148:151], a[244:247], v[228:231]
    s_waitcnt lgkmcnt(4)
    v_exp_f32 v211, v211
    v_mfma_f32_16x16x32_bf16 v[228:231], a[152:155], a[216:219], v[228:231]
    v_cvt_pk_bf16_f32 v182, v208, v209
    v_cvt_pk_bf16_f32 v185, v210, v211
    v_mfma_f32_16x16x32_bf16 v[228:231], a[156:159], a[220:223], v[228:231]
    ds_read_b128 v[208:211], v244 offset:128
    v_sub_f32 v199, v199, v248
    v_mfma_f32_16x16x32_bf16 v[212:215], v[12:15], v[180:183], 0
    s_waitcnt lgkmcnt(3)
    v_exp_f32 v196, v196
    v_mfma_f32_16x16x32_bf16 v[216:219], v[42:45], v[180:183], 0
    v_exp_f32 v197, v197
    v_mfma_f32_16x16x32_bf16 v[220:223], v[72:75], v[180:183], 0
    v_exp_f32 v198, v198
    v_mfma_f32_16x16x32_bf16 v[224:227], a[248:251], v[180:183], 0
    v_exp_f32 v199, v199
    v_mfma_f32_16x16x32_bf16 v[228:231], a[160:163], a[224:227], v[228:231]
    v_cvt_pk_bf16_f32 v186, v196, v197
    v_cvt_pk_bf16_f32 v189, v198, v199
    v_mfma_f32_16x16x32_bf16 v[228:231], a[164:167], a[228:231], v[228:231]
    ds_read_b128 v[196:199], v245 offset:128
    v_sub_f32 v200, v200, v248
    v_mfma_f32_16x16x32_bf16 v[232:235], a[168:171], a[240:243], 0
    v_exp_f32 v200, v200
    v_mfma_f32_16x16x32_bf16 v[232:235], a[172:175], a[244:247], v[232:235]
    v_sub_f32 v201, v201, v248
    v_sub_f32 v202, v202, v248
    v_mfma_f32_16x16x32_bf16 v[232:235], a[176:179], a[216:219], v[232:235]
    s_waitcnt lgkmcnt(1)
    v_mul_f32 v228, s38, v228
    v_mul_f32 v229, s38, v229
    v_mfma_f32_16x16x32_bf16 v[208:211], v[162:165], v[168:171], v[208:211]
    v_mul_f32 v230, s38, v230
    v_mul_f32 v231, s38, v231
    v_mfma_f32_16x16x32_bf16 v[208:211], v[164:167], v[170:173], v[208:211]
    v_exp_f32 v201, v201
    v_mfma_f32_16x16x32_bf16 v[232:235], a[180:183], a[220:223], v[232:235]
    v_exp_f32 v202, v202
    v_mfma_f32_16x16x32_bf16 v[232:235], a[184:187], a[224:227], v[232:235]
    v_sub_f32 v203, v203, v248
    v_cvt_pk_bf16_f32 v187, v200, v201
    v_mfma_f32_16x16x32_bf16 v[232:235], a[188:191], a[228:231], v[232:235]
    v_exp_f32 v203, v203
    v_mfma_f32_16x16x32_bf16 v[212:215], v[16:19], v[184:187], v[212:215]
    s_waitcnt lgkmcnt(0)
    v_cvt_pk_bf16_f32 v190, v202, v203
    v_sub_f32 v204, v204, v248
    v_mfma_f32_16x16x32_bf16 v[216:219], v[46:49], v[184:187], v[216:219]
    ds_read_b128 v[200:203], v246 offset:128
    v_sub_f32 v205, v205, v248
    v_mfma_f32_16x16x32_bf16 v[220:223], v[76:79], v[184:187], v[220:223]
    v_mul_f32 v232, s3, v232
    v_mul_f32 v233, s3, v233
    v_mfma_f32_16x16x32_bf16 v[224:227], a[248:251], v[184:187], v[224:227]
    v_mul_f32 v234, s3, v234
    v_mul_f32 v235, s3, v235
    v_mfma_f32_16x16x32_bf16 v[196:199], v[90:93], v[168:171], v[196:199]
    v_exp_f32 v204, v204
    v_mfma_f32_16x16x32_bf16 v[196:199], v[92:95], v[170:173], v[196:199]
    v_exp_f32 v205, v205
    v_mfma_f32_16x16x32_bf16 v[236:239], a[192:195], a[240:243], 0
    ds_read_b128 a[240:243], v240 offset:32384
    v_sub_f32 v206, v206, v248
    v_mfma_f32_16x16x32_bf16 v[236:239], a[196:199], a[244:247], v[236:239]
    ds_read_b128 a[244:247], v241 offset:32384
    v_sub_f32 v207, v207, v248
    v_mfma_f32_16x16x32_bf16 v[236:239], a[200:203], a[216:219], v[236:239]
    ds_read_b128 a[216:219], v240 offset:32512
    v_cvt_pk_bf16_f32 v188, v204, v205
    v_mfma_f32_16x16x32_bf16 v[236:239], a[204:207], a[220:223], v[236:239]
    ds_read_b128 a[220:223], v241 offset:32512
    v_sub_f32 v208, v208, v248
    v_mfma_f32_16x16x32_bf16 v[236:239], a[208:211], a[224:227], v[236:239]
    ds_read_b128 a[224:227], v242 offset:32256
    v_sub_f32 v209, v209, v248
    v_mfma_f32_16x16x32_bf16 v[236:239], a[212:215], a[228:231], v[236:239]
    s_waitcnt lgkmcnt(5)
    ds_read_b128 a[228:231], v243 offset:32256
    v_mfma_f32_16x16x32_bf16 v[200:203], v[96:99], v[168:171], v[200:203]
    v_cvt_pk_bf16_f32 v168, v228, v229
    v_cvt_pk_bf16_f32 v169, v230, v231
    v_mfma_f32_16x16x32_bf16 v[200:203], v[98:101], v[170:173], v[200:203]
    v_cvt_pk_bf16_f32 v170, v232, v233
    v_cvt_pk_bf16_f32 v171, v234, v235
    v_mfma_f32_16x16x32_bf16 v[228:231], a[0:3], a[232:235], 0
    v_mul_f32 v236, s38, v236
    v_mul_f32 v237, s38, v237
    v_mfma_f32_16x16x32_bf16 v[228:231], a[4:7], a[236:239], v[228:231]
    s_waitcnt lgkmcnt(5)
    v_mul_f32 v238, s38, v238
    v_mul_f32 v239, s38, v239
    v_mfma_f32_16x16x32_bf16 v[228:231], a[8:11], a[240:243], v[228:231]
    s_waitcnt lgkmcnt(4)
    v_cvt_pk_bf16_f32 v172, v236, v237
    v_cvt_pk_bf16_f32 v173, v238, v239
    v_mfma_f32_16x16x32_bf16 v[228:231], a[12:15], a[244:247], v[228:231]
    s_waitcnt lgkmcnt(3)
    v_exp_f32 v206, v206
    v_mfma_f32_16x16x32_bf16 v[228:231], a[16:19], a[216:219], v[228:231]
    s_waitcnt lgkmcnt(2)
    v_exp_f32 v207, v207
    v_mfma_f32_16x16x32_bf16 v[228:231], a[20:23], a[220:223], v[228:231]
    v_cvt_pk_bf16_f32 v191, v206, v207
    v_sub_f32 v196, v196, v248
    v_mfma_f32_16x16x32_bf16 v[232:235], a[24:27], a[232:235], 0
    ds_read_b128 v[204:207], v244 offset:0
    v_sub_f32 v197, v197, v248
    v_mfma_f32_16x16x32_bf16 v[212:215], v[20:23], v[188:191], v[212:215]
    v_exp_f32 v208, v208
    v_mfma_f32_16x16x32_bf16 v[216:219], v[50:53], v[188:191], v[216:219]
    v_exp_f32 v209, v209
    v_mfma_f32_16x16x32_bf16 v[220:223], v[80:83], v[188:191], v[220:223]
    v_cvt_pk_bf16_f32 v192, v208, v209
    v_sub_f32 v200, v200, v248
    v_mfma_f32_16x16x32_bf16 v[224:227], a[248:251], v[188:191], v[224:227]
    ds_read_b128 v[208:211], v245 offset:0
    v_sub_f32 v201, v201, v248
    v_mfma_f32_16x16x32_bf16 v[232:235], a[28:31], a[236:239], v[232:235]
    v_exp_f32 v196, v196
    v_mfma_f32_16x16x32_bf16 v[232:235], a[32:35], a[240:243], v[232:235]
    v_exp_f32 v197, v197
    v_mfma_f32_16x16x32_bf16 v[232:235], a[36:39], a[244:247], v[232:235]
    v_exp_f32 v200, v200
    v_mfma_f32_16x16x32_bf16 v[232:235], a[40:43], a[216:219], v[232:235]
    v_exp_f32 v201, v201
    v_mfma_f32_16x16x32_bf16 v[232:235], a[44:47], a[220:223], v[232:235]
    s_waitcnt lgkmcnt(1)
    v_cvt_pk_bf16_f32 v193, v196, v197
    v_cvt_pk_bf16_f32 v194, v200, v201
    v_mfma_f32_16x16x32_bf16 v[204:207], v[108:111], v[174:177], v[204:207]
    ds_read_b128 v[196:199], v246 offset:0
    ds_read_b128 v[200:203], v244 offset:64
    v_mfma_f32_16x16x32_bf16 v[212:215], v[24:27], v[192:195], v[212:215]
    v_mfma_f32_16x16x32_bf16 v[216:219], v[54:57], v[192:195], v[216:219]
    v_mfma_f32_16x16x32_bf16 v[220:223], v[84:87], v[192:195], v[220:223]
    s_waitcnt lgkmcnt(2)
    v_mfma_f32_16x16x32_bf16 v[224:227], a[248:251], v[192:195], v[224:227]
    v_mfma_f32_16x16x32_bf16 v[204:207], v[110:113], v[176:179], v[204:207]
    v_mfma_f32_16x16x32_bf16 v[208:211], v[132:135], v[174:177], v[208:211]
    v_mfma_f32_16x16x32_bf16 v[208:211], v[134:137], v[176:179], v[208:211]
    v_mfma_f32_16x16x32_bf16 v[236:239], a[48:51], a[232:235], 0
    v_mfma_f32_16x16x32_bf16 v[236:239], a[52:55], a[236:239], v[236:239]
    s_waitcnt lgkmcnt(1)
    s_waitcnt lgkmcnt(0)
    v_mfma_f32_16x16x32_bf16 v[196:199], v[156:159], v[174:177], v[196:199]
    v_rcp_f32 v225, v224
    v_mfma_f32_16x16x32_bf16 v[196:199], v[158:161], v[176:179], v[196:199]
    v_mul_f32 v212, v212, v225
    v_mul_f32 v213, v213, v225
    v_mfma_f32_16x16x32_bf16 v[200:203], v[162:165], v[174:177], v[200:203]
    v_mul_f32 v214, v214, v225
    v_mul_f32 v215, v215, v225
    v_mfma_f32_16x16x32_bf16 v[200:203], v[164:167], v[176:179], v[200:203]
    v_cvt_pk_bf16_f32 v212, v212, v213
    v_cvt_pk_bf16_f32 v213, v214, v215
    v_mfma_f32_16x16x32_bf16 v[236:239], a[56:59], a[240:243], v[236:239]
    ds_write_b64 v251, v[212:213] offset:12288
    v_mfma_f32_16x16x32_bf16 v[236:239], a[60:63], a[244:247], v[236:239]
    v_mul_f32 v216, v216, v225
    v_mul_f32 v217, v217, v225
    v_mfma_f32_16x16x32_bf16 v[236:239], a[64:67], a[216:219], v[236:239]
    v_mul_f32 v218, v218, v225
    v_mul_f32 v219, v219, v225
    v_mfma_f32_16x16x32_bf16 v[236:239], a[68:71], a[220:223], v[236:239]
    v_cvt_pk_bf16_f32 v216, v216, v217
    v_cvt_pk_bf16_f32 v217, v218, v219
    ds_write_b64 v251, v[216:217] offset:12416
    v_mul_f32 v220, v220, v225
    v_mul_f32 v221, v221, v225
    v_mul_f32 v222, v222, v225
    v_mul_f32 v223, v223, v225
    v_cvt_pk_bf16_f32 v220, v220, v221
    v_cvt_pk_bf16_f32 v221, v222, v223
    ds_write_b64 v251, v[220:221] offset:12544
    v_max_f32 v248, v204, v205
    v_max3_f32 v248, v248, v206, v207
    ds_read_b128 v[204:207], v245 offset:64
    v_max3_f32 v248, v248, v208, v209
    v_max3_f32 v248, v248, v210, v211
    ds_read_b128 v[208:211], v246 offset:64
    v_max3_f32 v248, v248, v196, v197
    v_max3_f32 v248, v248, v198, v199
    ds_read_b128 v[196:199], v244 offset:0
    v_max3_f32 v248, v248, v200, v201
    v_max3_f32 v248, v248, v202, v203
    ds_read_b128 v[200:203], v245 offset:0
    s_waitcnt lgkmcnt(3)
    v_mfma_f32_16x16x32_bf16 v[204:207], v[90:93], v[174:177], v[204:207]
    v_mfma_f32_16x16x32_bf16 v[204:207], v[92:95], v[176:179], v[204:207]
    s_waitcnt lgkmcnt(2)
    v_mfma_f32_16x16x32_bf16 v[208:211], v[96:99], v[174:177], v[208:211]
    s_waitcnt lgkmcnt(1)
    v_mfma_f32_16x16x32_bf16 v[208:211], v[98:101], v[176:179], v[208:211]
    v_mfma_f32_16x16x32_bf16 v[196:199], v[108:111], v[174:177], v[196:199]
    s_waitcnt lgkmcnt(0)
    v_cvt_pk_bf16_f32 v108, v228, v229
    v_cvt_pk_bf16_f32 v109, v230, v231
    v_mfma_f32_16x16x32_bf16 v[196:199], v[110:113], v[176:179], v[196:199]
    v_cvt_pk_bf16_f32 v110, v232, v233
    v_cvt_pk_bf16_f32 v111, v234, v235
    v_mfma_f32_16x16x32_bf16 v[200:203], v[132:135], v[174:177], v[200:203]
    v_cvt_pk_bf16_f32 v112, v236, v237
    v_cvt_pk_bf16_f32 v113, v238, v239
    v_mfma_f32_16x16x32_bf16 v[200:203], v[134:137], v[176:179], v[200:203]
    v_max3_f32 v248, v248, v204, v205
    v_max3_f32 v248, v248, v206, v207
    v_mfma_f32_16x16x32_bf16 v[228:231], a[232:235], a[72:75], 0
    ds_read_b128 v[204:207], v246 offset:0
    v_max3_f32 v248, v248, v208, v209
    v_mfma_f32_16x16x32_bf16 v[228:231], a[236:239], a[76:79], v[228:231]
    v_max3_f32 v248, v248, v210, v211
    v_mov_b32 v225, v248
    v_mfma_f32_16x16x32_bf16 v[228:231], a[240:243], a[80:83], v[228:231]
    ds_read_b128 v[208:211], v244 offset:64
    v_permlane16_swap_b32 v248, v225
    v_mfma_f32_16x16x32_bf16 v[228:231], a[244:247], a[84:87], v[228:231]
    v_max_f32 v248, v248, v225
    v_mov_b32 v225, v248
    v_mfma_f32_16x16x32_bf16 v[228:231], a[216:219], a[88:91], v[228:231]
    v_mfma_f32_16x16x32_bf16 v[228:231], a[220:223], a[92:95], v[228:231]
    v_permlane32_swap_b32 v248, v225
    v_max_f32 v248, v248, v225
    v_mfma_f32_16x16x32_bf16 v[232:235], a[232:235], a[96:99], 0
    v_sub_f32 v196, v196, v248
    v_sub_f32 v197, v197, v248
    v_mfma_f32_16x16x32_bf16 v[232:235], a[236:239], a[100:103], v[232:235]
    v_exp_f32 v196, v196
    v_mfma_f32_16x16x32_bf16 v[232:235], a[240:243], a[104:107], v[232:235]
    v_cvt_pk_bf16_f32 v6, v228, v229
    v_cvt_pk_bf16_f32 v9, v230, v231
    v_mfma_f32_16x16x32_bf16 v[232:235], a[244:247], a[108:111], v[232:235]
    s_waitcnt lgkmcnt(1)
    v_exp_f32 v197, v197
    v_mfma_f32_16x16x32_bf16 v[204:207], v[156:159], v[174:177], v[204:207]
    v_sub_f32 v198, v198, v248
    v_sub_f32 v199, v199, v248
    v_mfma_f32_16x16x32_bf16 v[204:207], v[158:161], v[176:179], v[204:207]
    s_waitcnt lgkmcnt(0)
    v_exp_f32 v198, v198
    v_mfma_f32_16x16x32_bf16 v[208:211], v[162:165], v[174:177], v[208:211]
    v_exp_f32 v199, v199
    v_mfma_f32_16x16x32_bf16 v[208:211], v[164:167], v[176:179], v[208:211]
    v_cvt_pk_bf16_f32 v180, v196, v197
    v_cvt_pk_bf16_f32 v183, v198, v199
    v_mfma_f32_16x16x32_bf16 v[232:235], a[216:219], a[112:115], v[232:235]
    ds_read_b128 v[196:199], v245 offset:64
    v_sub_f32 v200, v200, v248
    v_mfma_f32_16x16x32_bf16 v[232:235], a[220:223], a[116:119], v[232:235]
    v_exp_f32 v200, v200
    v_mfma_f32_16x16x32_bf16 v[236:239], a[232:235], a[120:123], 0
    ds_read_b128 a[232:235], v242 offset:32384
    v_sub_f32 v201, v201, v248
    v_mfma_f32_16x16x32_bf16 v[236:239], a[236:239], a[124:127], v[236:239]
    ds_read_b128 a[236:239], v243 offset:32384
    v_sub_f32 v202, v202, v248
    v_mfma_f32_16x16x32_bf16 v[236:239], a[240:243], a[128:131], v[236:239]
    v_cvt_pk_bf16_f32 v36, v232, v233
    v_cvt_pk_bf16_f32 v39, v234, v235
    v_mfma_f32_16x16x32_bf16 v[236:239], a[244:247], a[132:135], v[236:239]
    ds_read_b128 a[240:243], v242 offset:32512
    ds_read_b128 a[244:247], v243 offset:32512
    v_mfma_f32_16x16x32_bf16 v[236:239], a[216:219], a[136:139], v[236:239]
    ds_read_b128 a[216:219], v242 offset:33792
    v_sub_f32 v203, v203, v248
    v_mfma_f32_16x16x32_bf16 v[236:239], a[220:223], a[140:143], v[236:239]
    ds_read_b128 a[220:223], v243 offset:33792
    v_sub_f32 v204, v204, v248
    v_mfma_f32_16x16x32_bf16 v[228:231], a[144:147], a[224:227], 0
    v_exp_f32 v201, v201
    v_mfma_f32_16x16x32_bf16 v[228:231], a[148:151], a[228:231], v[228:231]
    s_waitcnt lgkmcnt(6)
    v_exp_f32 v202, v202
    v_mfma_f32_16x16x32_bf16 v[196:199], v[90:93], v[174:177], v[196:199]
    v_cvt_pk_bf16_f32 v66, v236, v237
    v_cvt_pk_bf16_f32 v69, v238, v239
    v_mfma_f32_16x16x32_bf16 v[196:199], v[92:95], v[176:179], v[196:199]
    s_waitcnt lgkmcnt(5)
    v_exp_f32 v203, v203
    v_mfma_f32_16x16x32_bf16 v[228:231], a[152:155], a[232:235], v[228:231]
    s_waitcnt lgkmcnt(4)
    v_cvt_pk_bf16_f32 v181, v200, v201
    v_cvt_pk_bf16_f32 v184, v202, v203
    v_mfma_f32_16x16x32_bf16 v[228:231], a[156:159], a[236:239], v[228:231]
    ds_read_b128 v[200:203], v246 offset:64
    v_sub_f32 v205, v205, v248
    v_mfma_f32_16x16x32_bf16 v[232:235], a[168:171], a[224:227], 0
    s_waitcnt lgkmcnt(4)
    v_exp_f32 v204, v204
    v_mfma_f32_16x16x32_bf16 v[228:231], a[160:163], a[240:243], v[228:231]
    s_waitcnt lgkmcnt(3)
    v_exp_f32 v205, v205
    v_mfma_f32_16x16x32_bf16 v[228:231], a[164:167], a[244:247], v[228:231]
    v_sub_f32 v206, v206, v248
    v_sub_f32 v207, v207, v248
    v_mfma_f32_16x16x32_bf16 v[232:235], a[172:175], a[228:231], v[232:235]
    v_exp_f32 v206, v206
    v_mfma_f32_16x16x32_bf16 v[232:235], a[176:179], a[232:235], v[232:235]
    v_exp_f32 v207, v207
    v_mfma_f32_16x16x32_bf16 v[232:235], a[180:183], a[236:239], v[232:235]
    v_cvt_pk_bf16_f32 v182, v204, v205
    v_mul_f32 v228, s38, v228
    v_mfma_f32_16x16x32_bf16 v[232:235], a[184:187], a[240:243], v[232:235]
    v_mul_f32 v229, s38, v229
    v_mul_f32 v230, s38, v230
    v_mfma_f32_16x16x32_bf16 v[212:215], v[18:21], v[180:183], 0
    v_mul_f32 v231, s38, v231
    v_cvt_pk_bf16_f32 v185, v206, v207
    v_mfma_f32_16x16x32_bf16 v[216:219], v[48:51], v[180:183], 0
    s_waitcnt lgkmcnt(0)
    v_sub_f32 v208, v208, v248
    v_sub_f32 v209, v209, v248
    v_mfma_f32_16x16x32_bf16 v[220:223], v[78:81], v[180:183], 0
    v_exp_f32 v208, v208
    v_mfma_f32_16x16x32_bf16 v[224:227], a[248:251], v[180:183], 0
    v_exp_f32 v209, v209
    v_mfma_f32_16x16x32_bf16 v[200:203], v[96:99], v[174:177], v[200:203]
    v_cvt_pk_bf16_f32 v174, v228, v229
    v_cvt_pk_bf16_f32 v175, v230, v231
    v_mfma_f32_16x16x32_bf16 v[200:203], v[98:101], v[176:179], v[200:203]
    v_sub_f32 v210, v210, v248
    v_sub_f32 v211, v211, v248
    v_mfma_f32_16x16x32_bf16 v[232:235], a[188:191], a[244:247], v[232:235]
    v_exp_f32 v210, v210
    v_mfma_f32_16x16x32_bf16 v[236:239], a[192:195], a[224:227], 0
    ds_read_b128 a[224:227], v242 offset:33920
    v_cvt_pk_bf16_f32 v186, v208, v209
    v_mfma_f32_16x16x32_bf16 v[236:239], a[196:199], a[228:231], v[236:239]
    ds_read_b128 a[228:231], v243 offset:33920
    v_sub_f32 v196, v196, v248
    v_mfma_f32_16x16x32_bf16 v[236:239], a[200:203], a[232:235], v[236:239]
    v_mul_f32 v232, s3, v232
    v_mul_f32 v233, s3, v233
    v_mfma_f32_16x16x32_bf16 v[236:239], a[204:207], a[236:239], v[236:239]
    v_mul_f32 v234, s3, v234
    v_mul_f32 v235, s3, v235
    v_mfma_f32_16x16x32_bf16 v[236:239], a[208:211], a[240:243], v[236:239]
    v_cvt_pk_bf16_f32 v176, v232, v233
    v_cvt_pk_bf16_f32 v177, v234, v235
    v_mfma_f32_16x16x32_bf16 v[236:239], a[212:215], a[244:247], v[236:239]
    ds_read_b128 a[232:235], v242 offset:34048
    ds_read_b128 a[236:239], v243 offset:34048
    v_mfma_f32_16x16x32_bf16 v[228:231], a[144:147], a[216:219], 0
    v_exp_f32 v211, v211
    v_mfma_f32_16x16x32_bf16 v[228:231], a[148:151], a[220:223], v[228:231]
    v_cvt_pk_bf16_f32 v189, v210, v211
    v_sub_f32 v197, v197, v248
    v_mfma_f32_16x16x32_bf16 v[232:235], a[168:171], a[216:219], 0
    v_mul_f32 v236, s38, v236
    v_mul_f32 v237, s38, v237
    v_mfma_f32_16x16x32_bf16 v[232:235], a[172:175], a[220:223], v[232:235]
    s_waitcnt lgkmcnt(3)
    v_mul_f32 v238, s38, v238
    v_mul_f32 v239, s38, v239
    v_mfma_f32_16x16x32_bf16 v[228:231], a[152:155], a[224:227], v[228:231]
    s_waitcnt lgkmcnt(2)
    v_cvt_pk_bf16_f32 v178, v236, v237
    v_cvt_pk_bf16_f32 v179, v238, v239
    v_mfma_f32_16x16x32_bf16 v[228:231], a[156:159], a[228:231], v[228:231]
    v_exp_f32 v196, v196
    v_mfma_f32_16x16x32_bf16 v[232:235], a[176:179], a[224:227], v[232:235]
    v_exp_f32 v197, v197
    v_mfma_f32_16x16x32_bf16 v[232:235], a[180:183], a[228:231], v[232:235]
    v_sub_f32 v198, v198, v248
    v_sub_f32 v199, v199, v248
    v_mfma_f32_16x16x32_bf16 v[236:239], a[192:195], a[216:219], 0
    s_waitcnt lgkmcnt(1)
    s_waitcnt vmcnt(8) lgkmcnt(0)
    s_barrier
    v_mfma_f32_16x16x32_bf16 v[228:231], a[160:163], a[232:235], v[228:231]
    ds_read_b128 a[240:243], v240 offset:33792
    ds_read_b128 a[244:247], v241 offset:33792
    v_mfma_f32_16x16x32_bf16 v[228:231], a[164:167], a[236:239], v[228:231]
    ds_read_b128 a[216:219], v240 offset:33920
    v_cvt_pk_bf16_f32 v187, v196, v197
    v_mfma_f32_16x16x32_bf16 v[232:235], a[184:187], a[232:235], v[232:235]
    v_exp_f32 v198, v198
    v_mfma_f32_16x16x32_bf16 v[212:215], v[22:25], v[184:187], v[212:215]
    v_exp_f32 v199, v199
    v_mfma_f32_16x16x32_bf16 v[216:219], v[52:55], v[184:187], v[216:219]
    v_cvt_pk_bf16_f32 v190, v198, v199
    v_mul_f32 v228, s38, v228
    v_mfma_f32_16x16x32_bf16 v[220:223], v[82:85], v[184:187], v[220:223]
    v_mul_f32 v229, s38, v229
    v_mul_f32 v230, s38, v230
    v_mfma_f32_16x16x32_bf16 v[224:227], a[248:251], v[184:187], v[224:227]
    v_mul_f32 v231, s38, v231
    v_cvt_pk_bf16_f32 v228, v228, v229
    v_mfma_f32_16x16x32_bf16 v[232:235], a[188:191], a[236:239], v[232:235]
    v_cvt_pk_bf16_f32 v229, v230, v231
    v_sub_f32 v200, v200, v248
    v_mfma_f32_16x16x32_bf16 v[236:239], a[196:199], a[220:223], v[236:239]
    ds_write_b64 v247, v[228:229] offset:18432
    v_mfma_f32_16x16x32_bf16 v[236:239], a[200:203], a[224:227], v[236:239]
    ds_read_b128 a[220:223], v241 offset:33920
    ds_read_b128 a[224:227], v240 offset:34048
    v_mfma_f32_16x16x32_bf16 v[236:239], a[204:207], a[228:231], v[236:239]
    s_waitcnt lgkmcnt(3)
    v_mul_f32 v232, s3, v232
    v_mul_f32 v233, s3, v233
    v_mfma_f32_16x16x32_bf16 v[236:239], a[208:211], a[232:235], v[236:239]
    v_mul_f32 v234, s3, v234
    v_mul_f32 v235, s3, v235
    v_mfma_f32_16x16x32_bf16 v[236:239], a[212:215], a[236:239], v[236:239]
    ds_read_b128 a[228:231], v241 offset:34048
    v_cvt_pk_bf16_f32 v232, v232, v233
    v_mfma_f32_16x16x32_bf16 v[228:231], a[0:3], a[240:243], 0
    ds_read_b128 a[232:235], v242 offset:61440
    v_cvt_pk_bf16_f32 v233, v234, v235
    v_mfma_f32_16x16x32_bf16 v[228:231], a[4:7], a[244:247], v[228:231]
    ds_write_b64 v247, v[232:233] offset:18560
    v_mfma_f32_16x16x32_bf16 v[228:231], a[8:11], a[216:219], v[228:231]
    v_mul_f32 v236, s38, v236
    v_mul_f32 v237, s38, v237
    v_mfma_f32_16x16x32_bf16 v[232:235], a[24:27], a[240:243], 0
    v_mul_f32 v238, s38, v238
    v_mul_f32 v239, s38, v239
    v_mfma_f32_16x16x32_bf16 v[232:235], a[28:31], a[244:247], v[232:235]
    ds_read_b128 a[236:239], v243 offset:61440
    v_cvt_pk_bf16_f32 v236, v236, v237
    v_mfma_f32_16x16x32_bf16 v[232:235], a[32:35], a[216:219], v[232:235]
    s_waitcnt lgkmcnt(4)
    v_cvt_pk_bf16_f32 v237, v238, v239
    v_sub_f32 v201, v201, v248
    v_mfma_f32_16x16x32_bf16 v[228:231], a[12:15], a[220:223], v[228:231]
    ds_write_b64 v247, v[236:237] offset:18688
    v_mfma_f32_16x16x32_bf16 v[228:231], a[16:19], a[224:227], v[228:231]
    s_waitcnt lgkmcnt(4)
    v_exp_f32 v200, v200
    v_mfma_f32_16x16x32_bf16 v[228:231], a[20:23], a[228:231], v[228:231]
    v_exp_f32 v201, v201
    v_mfma_f32_16x16x32_bf16 v[232:235], a[36:39], a[220:223], v[232:235]
    v_sub_f32 v202, v202, v248
    v_sub_f32 v203, v203, v248
    v_mfma_f32_16x16x32_bf16 v[232:235], a[40:43], a[224:227], v[232:235]
    v_exp_f32 v202, v202
    v_mfma_f32_16x16x32_bf16 v[232:235], a[44:47], a[228:231], v[232:235]
    v_exp_f32 v203, v203
    v_mfma_f32_16x16x32_bf16 v[236:239], a[48:51], a[240:243], 0
    v_cvt_pk_bf16_f32 v162, v228, v229
    v_cvt_pk_bf16_f32 v163, v230, v231
    v_mfma_f32_16x16x32_bf16 v[236:239], a[52:55], a[244:247], v[236:239]
    v_cvt_pk_bf16_f32 v188, v200, v201
    v_cvt_pk_bf16_f32 v191, v202, v203
    v_mfma_f32_16x16x32_bf16 v[236:239], a[56:59], a[216:219], v[236:239]
    v_cvt_pk_bf16_f32 v164, v232, v233
    v_cvt_pk_bf16_f32 v165, v234, v235
    v_mfma_f32_16x16x32_bf16 v[212:215], v[26:29], v[188:191], v[212:215]
    v_mbcnt_lo_u32_b32 v208, -1, 0
    v_mbcnt_hi_u32_b32 v208, -1, v208
    v_mfma_f32_16x16x32_bf16 v[216:219], v[56:59], v[188:191], v[216:219]
    v_bfe_u32 v204, v208, 2, 2
    v_and_b32 v205, 3, v208
    v_mfma_f32_16x16x32_bf16 v[220:223], v[86:89], v[188:191], v[220:223]
    v_lshrrev_b32 v208, 4, v208
    v_sub_u32 v206, v208, v204
    v_mfma_f32_16x16x32_bf16 v[224:227], a[248:251], v[188:191], v[224:227]
    v_mul_i32_i24 v206, 0x1c0, v206
    v_lshlrev_b32 v207, 4, v205
    v_mfma_f32_16x16x32_bf16 v[236:239], a[60:63], a[220:223], v[236:239]
    v_sub_u32 v206, v206, v207
    v_add_u32 v206, s37, v206
    v_mfma_f32_16x16x32_bf16 v[236:239], a[64:67], a[224:227], v[236:239]
    v_sub_u32 v207, v208, v204
    v_add_u32 v244, 0, v207
    v_mfma_f32_16x16x32_bf16 v[236:239], a[68:71], a[228:231], v[236:239]
    v_rcp_f32 v225, v224
    v_mfma_f32_16x16x32_bf16 v[228:231], a[240:243], a[72:75], 0
    v_mbcnt_lo_u32_b32 v226, -1, 0
    v_mbcnt_hi_u32_b32 v226, -1, v226
    v_mfma_f32_16x16x32_bf16 v[228:231], a[244:247], a[76:79], v[228:231]
    v_and_b32 v226, 2, v226
    v_cmp_eq_u32 vcc, 0, v226
    v_mfma_f32_16x16x32_bf16 v[228:231], a[216:219], a[80:83], v[228:231]
    v_cvt_pk_bf16_f32 v166, v236, v237
    v_cvt_pk_bf16_f32 v167, v238, v239
    v_mfma_f32_16x16x32_bf16 v[228:231], a[220:223], a[84:87], v[228:231]
    v_add_u32 v226, 0xfffdd200, v247
    v_cndmask_b32 v226, 0, v226, vcc
    v_mfma_f32_16x16x32_bf16 v[228:231], a[224:227], a[88:91], v[228:231]
    v_add_u32 v226, 0x22e00, v226
    v_mul_f32 v212, v212, v225
    v_mfma_f32_16x16x32_bf16 v[228:231], a[228:231], a[92:95], v[228:231]
    v_mul_f32 v213, v213, v225
    v_mul_f32 v214, v214, v225
    v_mfma_f32_16x16x32_bf16 v[232:235], a[240:243], a[96:99], 0
    v_mul_f32 v215, v215, v225
    v_cvt_pk_bf16_f32 v212, v212, v213
    v_mfma_f32_16x16x32_bf16 v[232:235], a[244:247], a[100:103], v[232:235]
    v_cvt_pk_bf16_f32 v213, v214, v215
    v_mul_f32 v216, v216, v225
    v_mfma_f32_16x16x32_bf16 v[232:235], a[216:219], a[104:107], v[232:235]
    v_cvt_pk_bf16_f32 v12, v228, v229
    v_cvt_pk_bf16_f32 v15, v230, v231
    v_mfma_f32_16x16x32_bf16 v[232:235], a[220:223], a[108:111], v[232:235]
    ds_write_b64 v226, v[212:213] offset:0
    v_mfma_f32_16x16x32_bf16 v[232:235], a[224:227], a[112:115], v[232:235]
    s_waitcnt lgkmcnt(1)
    v_mul_f32 v217, v217, v225
    v_mul_f32 v218, v218, v225
    v_mfma_f32_16x16x32_bf16 v[232:235], a[228:231], a[116:119], v[232:235]
    v_mul_f32 v219, v219, v225
    v_cvt_pk_bf16_f32 v216, v216, v217
    v_mfma_f32_16x16x32_bf16 v[236:239], a[240:243], a[120:123], 0
    ds_read_b128 a[240:243], v242 offset:61568
    v_cvt_pk_bf16_f32 v217, v218, v219
    v_mfma_f32_16x16x32_bf16 v[236:239], a[244:247], a[124:127], v[236:239]
    ds_read_b128 a[244:247], v243 offset:61568
    v_mul_f32 v220, v220, v225
    v_mfma_f32_16x16x32_bf16 v[236:239], a[216:219], a[128:131], v[236:239]
    v_cvt_pk_bf16_f32 v42, v232, v233
    v_cvt_pk_bf16_f32 v45, v234, v235
    v_mfma_f32_16x16x32_bf16 v[236:239], a[220:223], a[132:135], v[236:239]
    ds_read_b128 a[216:219], v242 offset:61696
    ds_read_b128 a[220:223], v243 offset:61696
    v_mfma_f32_16x16x32_bf16 v[236:239], a[224:227], a[136:139], v[236:239]
    ds_read_b128 a[224:227], v242 offset:62976
    v_mul_f32 v221, v221, v225
    v_mfma_f32_16x16x32_bf16 v[236:239], a[228:231], a[140:143], v[236:239]
    ds_read_b128 a[228:231], v243 offset:62976
    v_mul_f32 v222, v222, v225
    v_mfma_f32_16x16x32_bf16 v[228:231], a[144:147], a[232:235], 0
    ds_write_b64 v226, v[216:217] offset:128
    v_mfma_f32_16x16x32_bf16 v[228:231], a[148:151], a[236:239], v[228:231]
    v_mul_f32 v223, v223, v225
    v_cvt_pk_bf16_f32 v220, v220, v221
    v_mfma_f32_16x16x32_bf16 v[232:235], a[168:171], a[232:235], 0
    s_waitcnt lgkmcnt(6)
    v_cvt_pk_bf16_f32 v72, v236, v237
    v_cvt_pk_bf16_f32 v75, v238, v239
    v_mfma_f32_16x16x32_bf16 v[228:231], a[152:155], a[240:243], v[228:231]
    s_waitcnt lgkmcnt(5)
    v_cvt_pk_bf16_f32 v221, v222, v223
    v_cmp_gt_u32 vcc, 7, v244
    v_mfma_f32_16x16x32_bf16 v[228:231], a[156:159], a[244:247], v[228:231]
    ds_write_b64 v226, v[220:221] offset:256
    v_mfma_f32_16x16x32_bf16 v[232:235], a[172:175], a[236:239], v[232:235]
    s_waitcnt lgkmcnt(5)
    v_add_u32 v244, 0xfffdc870, v206
    v_cndmask_b32 v244, 0, v244, vcc
    v_mfma_f32_16x16x32_bf16 v[228:231], a[160:163], a[216:219], v[228:231]
    s_waitcnt vmcnt(0) lgkmcnt(4)
    s_barrier
    v_add_u32 v244, 0x237c0, v244
    v_mfma_f32_16x16x32_bf16 v[228:231], a[164:167], a[220:223], v[228:231]
    ds_read_b128 v[200:203], v244 offset:256
    v_add_u32 v245, 4, v207
    v_mfma_f32_16x16x32_bf16 v[232:235], a[176:179], a[240:243], v[232:235]
    v_cmp_gt_u32 vcc, 7, v245
    v_add_u32 v245, 0xfffdcf70, v206
    v_mfma_f32_16x16x32_bf16 v[232:235], a[180:183], a[244:247], v[232:235]
    v_cndmask_b32 v245, 0, v245, vcc
    v_add_u32 v245, 0x237c0, v245
    v_mfma_f32_16x16x32_bf16 v[232:235], a[184:187], a[216:219], v[232:235]
    v_mul_f32 v228, s38, v228
    v_mul_f32 v229, s38, v229
    v_mfma_f32_16x16x32_bf16 v[232:235], a[188:191], a[220:223], v[232:235]
    v_mul_f32 v230, s38, v230
    v_mul_f32 v231, s38, v231
    v_mfma_f32_16x16x32_bf16 v[236:239], a[192:195], a[232:235], 0
    ds_read_b128 a[232:235], v242 offset:63104
    v_cvt_pk_bf16_f32 v228, v228, v229
    v_mfma_f32_16x16x32_bf16 v[236:239], a[196:199], a[236:239], v[236:239]
    ds_read_b128 a[236:239], v243 offset:63104
    v_cvt_pk_bf16_f32 v229, v230, v231
    v_mfma_f32_16x16x32_bf16 v[236:239], a[200:203], a[240:243], v[236:239]
    ds_write_b64 v247, v[228:229] offset:24576
    v_mfma_f32_16x16x32_bf16 v[236:239], a[204:207], a[244:247], v[236:239]
    s_waitcnt lgkmcnt(3)
    v_mul_f32 v232, s3, v232
    v_mul_f32 v233, s3, v233
    v_mfma_f32_16x16x32_bf16 v[200:203], v[120:123], v[168:171], v[200:203]
    v_mul_f32 v234, s3, v234
    v_mul_f32 v235, s3, v235
    v_mfma_f32_16x16x32_bf16 v[200:203], v[122:125], v[170:173], v[200:203]
    ds_read_b128 a[240:243], v242 offset:63232
    v_cvt_pk_bf16_f32 v232, v232, v233
    v_mfma_f32_16x16x32_bf16 v[236:239], a[208:211], a[216:219], v[236:239]
    ds_read_b128 a[244:247], v243 offset:63232
    v_cvt_pk_bf16_f32 v233, v234, v235
    v_mfma_f32_16x16x32_bf16 v[236:239], a[212:215], a[220:223], v[236:239]
    ds_write_b64 v247, v[232:233] offset:24704
    v_mfma_f32_16x16x32_bf16 v[228:231], a[144:147], a[224:227], 0
    ds_read_b128 a[216:219], v240 offset:35328
    ds_read_b128 a[220:223], v241 offset:35328
    v_mfma_f32_16x16x32_bf16 v[228:231], a[148:151], a[228:231], v[228:231]
    ds_read_b128 v[208:211], v245 offset:192
    v_add_u32 v246, 8, v207
    v_mfma_f32_16x16x32_bf16 v[232:235], a[168:171], a[224:227], 0
    s_waitcnt lgkmcnt(7)
    v_mul_f32 v236, s38, v236
    v_mul_f32 v237, s38, v237
    v_mfma_f32_16x16x32_bf16 v[228:231], a[152:155], a[232:235], v[228:231]
    v_mul_f32 v238, s38, v238
    v_mul_f32 v239, s38, v239
    v_mfma_f32_16x16x32_bf16 v[228:231], a[156:159], a[236:239], v[228:231]
    v_cvt_pk_bf16_f32 v236, v236, v237
    v_cvt_pk_bf16_f32 v237, v238, v239
    v_mfma_f32_16x16x32_bf16 v[232:235], a[172:175], a[228:231], v[232:235]
    ds_write_b64 v247, v[236:237] offset:24832
    v_mfma_f32_16x16x32_bf16 v[232:235], a[176:179], a[232:235], v[232:235]
    s_waitcnt lgkmcnt(5)
    v_cmp_gt_u32 vcc, 7, v246
    v_add_u32 v246, 0xfffdd670, v206
    v_mfma_f32_16x16x32_bf16 v[228:231], a[160:163], a[240:243], v[228:231]
    ds_read_b128 v[204:207], v244 offset:192
    v_cndmask_b32 v246, 0, v246, vcc
    v_mfma_f32_16x16x32_bf16 v[228:231], a[164:167], a[244:247], v[228:231]
    v_add_u32 v246, 0x237c0, v246
    v_mov_b32 v191, 0
    v_mfma_f32_16x16x32_bf16 v[232:235], a[180:183], a[236:239], v[232:235]
    ds_read_b128 v[196:199], v246 offset:192
    v_mfma_f32_16x16x32_bf16 v[232:235], a[184:187], a[240:243], v[232:235]
    v_mfma_f32_16x16x32_bf16 v[232:235], a[188:191], a[244:247], v[232:235]
    s_waitcnt lgkmcnt(3)
    v_mfma_f32_16x16x32_bf16 v[208:211], v[138:141], v[168:171], v[208:211]
    v_mul_f32 v228, s38, v228
    v_mul_f32 v229, s38, v229
    v_mfma_f32_16x16x32_bf16 v[208:211], v[140:143], v[170:173], v[208:211]
    v_mul_f32 v230, s38, v230
    v_mul_f32 v231, s38, v231
    v_mfma_f32_16x16x32_bf16 v[236:239], a[192:195], a[224:227], 0
    v_cvt_pk_bf16_f32 v228, v228, v229
    v_cvt_pk_bf16_f32 v229, v230, v231
    v_mfma_f32_16x16x32_bf16 v[236:239], a[196:199], a[228:231], v[236:239]
    ds_write_b64 v247, v[228:229] offset:30720
    v_mfma_f32_16x16x32_bf16 v[236:239], a[200:203], a[232:235], v[236:239]
    s_waitcnt lgkmcnt(2)
    v_mul_f32 v232, s3, v232
    v_mul_f32 v233, s3, v233
    v_mfma_f32_16x16x32_bf16 v[204:207], v[114:117], v[168:171], v[204:207]
    s_waitcnt lgkmcnt(1)
    v_mul_f32 v234, s3, v234
    v_mul_f32 v235, s3, v235
    v_mfma_f32_16x16x32_bf16 v[204:207], v[116:119], v[170:173], v[204:207]
    ds_read_b128 a[224:227], v240 offset:35456
    v_cvt_pk_bf16_f32 v232, v232, v233
    v_mfma_f32_16x16x32_bf16 v[196:199], v[102:105], v[168:171], v[196:199]
    ds_read_b128 a[228:231], v241 offset:35456
    v_cvt_pk_bf16_f32 v233, v234, v235
    v_mfma_f32_16x16x32_bf16 v[196:199], v[104:107], v[170:173], v[196:199]
    ds_write_b64 v247, v[232:233] offset:30848
    v_mfma_f32_16x16x32_bf16 v[236:239], a[204:207], a[236:239], v[236:239]
    ds_read_b128 a[232:235], v240 offset:35584
    ds_read_b128 a[236:239], v241 offset:35584
    v_mfma_f32_16x16x32_bf16 v[236:239], a[208:211], a[240:243], v[236:239]
    ds_read_b128 a[240:243], v242 offset:64512
    v_max_f32 v248, v204, v205
    v_mfma_f32_16x16x32_bf16 v[236:239], a[212:215], a[244:247], v[236:239]
    ds_read_b128 a[244:247], v243 offset:64512
    v_max3_f32 v248, v248, v206, v207
    v_mfma_f32_16x16x32_bf16 v[228:231], a[0:3], a[216:219], 0
    ds_read_b128 v[204:207], v245 offset:256
    v_max3_f32 v248, v248, v208, v209
    v_mfma_f32_16x16x32_bf16 v[228:231], a[4:7], a[220:223], v[228:231]
    v_max3_f32 v248, v248, v210, v211
    v_max3_f32 v248, v248, v196, v197
    v_mfma_f32_16x16x32_bf16 v[232:235], a[24:27], a[216:219], 0
    s_waitcnt lgkmcnt(7)
    v_mul_f32 v236, s38, v236
    v_mul_f32 v237, s38, v237
    v_mfma_f32_16x16x32_bf16 v[228:231], a[8:11], a[224:227], v[228:231]
    s_waitcnt lgkmcnt(6)
    v_mul_f32 v238, s38, v238
    v_mul_f32 v239, s38, v239
    v_mfma_f32_16x16x32_bf16 v[228:231], a[12:15], a[228:231], v[228:231]
    ds_read_b128 v[208:211], v246 offset:256
    v_cvt_pk_bf16_f32 v236, v236, v237
    v_mfma_f32_16x16x32_bf16 v[232:235], a[28:31], a[220:223], v[232:235]
    v_cvt_pk_bf16_f32 v237, v238, v239
    v_max3_f32 v248, v248, v198, v199
    v_mfma_f32_16x16x32_bf16 v[232:235], a[32:35], a[224:227], v[232:235]
    ds_write_b64 v247, v[236:237] offset:30976
    v_mfma_f32_16x16x32_bf16 v[232:235], a[36:39], a[228:231], v[232:235]
    ds_read_b128 v[196:199], v244 offset:320
    v_max3_f32 v248, v248, v200, v201
    v_mfma_f32_16x16x32_bf16 v[236:239], a[48:51], a[216:219], 0
    s_waitcnt lgkmcnt(5)
    v_max3_f32 v248, v248, v202, v203
    v_mfma_f32_16x16x32_bf16 v[228:231], a[16:19], a[232:235], v[228:231]
    ds_read_b128 v[200:203], v245 offset:320
    s_waitcnt lgkmcnt(4)
    v_mfma_f32_16x16x32_bf16 v[204:207], v[144:147], v[168:171], v[204:207]
    v_mfma_f32_16x16x32_bf16 v[204:207], v[146:149], v[170:173], v[204:207]
    v_mfma_f32_16x16x32_bf16 v[228:231], a[20:23], a[236:239], v[228:231]
    s_waitcnt lgkmcnt(3)
    v_mfma_f32_16x16x32_bf16 v[208:211], v[108:111], v[168:171], v[208:211]
    v_mfma_f32_16x16x32_bf16 v[208:211], v[110:113], v[170:173], v[208:211]
    v_mfma_f32_16x16x32_bf16 v[232:235], a[40:43], a[232:235], v[232:235]
    v_mfma_f32_16x16x32_bf16 v[232:235], a[44:47], a[236:239], v[232:235]
    s_waitcnt lgkmcnt(1)
    v_mfma_f32_16x16x32_bf16 v[196:199], v[126:129], v[168:171], v[196:199]
    v_max3_f32 v248, v248, v204, v205
    v_max3_f32 v248, v248, v206, v207
    v_mfma_f32_16x16x32_bf16 v[196:199], v[128:131], v[170:173], v[196:199]
    ds_read_b128 v[204:207], v246 offset:320
    v_max3_f32 v248, v248, v208, v209
    v_mfma_f32_16x16x32_bf16 v[236:239], a[52:55], a[220:223], v[236:239]
    s_waitcnt lgkmcnt(1)
    v_max3_f32 v248, v248, v210, v211
    v_mfma_f32_16x16x32_bf16 v[200:203], v[150:153], v[168:171], v[200:203]
    ds_read_b128 v[208:211], v244 offset:192
    v_mfma_f32_16x16x32_bf16 v[200:203], v[152:155], v[170:173], v[200:203]
    v_max3_f32 v248, v248, v196, v197
    v_mfma_f32_16x16x32_bf16 v[236:239], a[56:59], a[224:227], v[236:239]
    ds_read_b128 v[196:199], v245 offset:192
    v_mfma_f32_16x16x32_bf16 v[236:239], a[60:63], a[228:231], v[236:239]
    v_mfma_f32_16x16x32_bf16 v[236:239], a[64:67], a[232:235], v[236:239]
    v_mfma_f32_16x16x32_bf16 v[236:239], a[68:71], a[236:239], v[236:239]
    s_nop 1
    v_max3_f32 v248, v248, v200, v201
    ds_read_b128 v[200:203], v246 offset:192
    s_waitcnt lgkmcnt(3)
    v_mfma_f32_16x16x32_bf16 v[204:207], v[162:165], v[168:171], v[204:207]
    v_mfma_f32_16x16x32_bf16 v[204:207], v[164:167], v[170:173], v[204:207]
    s_nop 7
    s_waitcnt lgkmcnt(2)
    v_mfma_f32_16x16x32_bf16 v[208:211], v[114:117], v[168:171], v[208:211]
    s_waitcnt lgkmcnt(1)
    v_cvt_pk_bf16_f32 v114, v228, v229
    v_cvt_pk_bf16_f32 v115, v230, v231
    v_mfma_f32_16x16x32_bf16 v[208:211], v[116:119], v[170:173], v[208:211]
    v_cvt_pk_bf16_f32 v116, v232, v233
    v_cvt_pk_bf16_f32 v117, v234, v235
    v_mfma_f32_16x16x32_bf16 v[196:199], v[138:141], v[168:171], v[196:199]
    v_cvt_pk_bf16_f32 v118, v236, v237
    v_cvt_pk_bf16_f32 v119, v238, v239
    v_mfma_f32_16x16x32_bf16 v[196:199], v[140:143], v[170:173], v[196:199]
    v_max3_f32 v248, v248, v204, v205
    v_mov_b32 v225, v248
    v_mfma_f32_16x16x32_bf16 v[228:231], a[216:219], a[72:75], 0
    ds_read_b128 v[204:207], v244 offset:256
    v_permlane16_swap_b32 v248, v225
    v_mfma_f32_16x16x32_bf16 v[228:231], a[220:223], a[76:79], v[228:231]
    s_waitcnt lgkmcnt(1)
    v_max_f32 v248, v248, v225
    v_mov_b32 v225, v248
    v_mfma_f32_16x16x32_bf16 v[200:203], v[102:105], v[168:171], v[200:203]
    v_mfma_f32_16x16x32_bf16 v[200:203], v[104:107], v[170:173], v[200:203]
    v_permlane32_swap_b32 v248, v225
    v_max_f32 v248, v248, v225
    v_mfma_f32_16x16x32_bf16 v[228:231], a[224:227], a[80:83], v[228:231]
    v_sub_f32 v208, v208, v248
    v_sub_f32 v209, v209, v248
    v_mfma_f32_16x16x32_bf16 v[228:231], a[228:231], a[84:87], v[228:231]
    v_exp_f32 v208, v208
    v_mfma_f32_16x16x32_bf16 v[228:231], a[232:235], a[88:91], v[228:231]
    v_exp_f32 v209, v209
    v_mfma_f32_16x16x32_bf16 v[228:231], a[236:239], a[92:95], v[228:231]
    v_sub_f32 v210, v210, v248
    v_sub_f32 v211, v211, v248
    v_mfma_f32_16x16x32_bf16 v[232:235], a[216:219], a[96:99], 0
    v_exp_f32 v210, v210
    v_mfma_f32_16x16x32_bf16 v[232:235], a[220:223], a[100:103], v[232:235]
    s_waitcnt lgkmcnt(0)
    v_exp_f32 v211, v211
    v_mfma_f32_16x16x32_bf16 v[204:207], v[120:123], v[168:171], v[204:207]
    v_cvt_pk_bf16_f32 v18, v228, v229
    v_cvt_pk_bf16_f32 v21, v230, v231
    v_mfma_f32_16x16x32_bf16 v[204:207], v[122:125], v[170:173], v[204:207]
    v_cvt_pk_bf16_f32 v193, v208, v209
    v_cvt_pk_bf16_f32 v180, v210, v211
    v_mfma_f32_16x16x32_bf16 v[232:235], a[224:227], a[104:107], v[232:235]
    ds_read_b128 v[208:211], v245 offset:256
    v_sub_f32 v196, v196, v248
    v_mfma_f32_16x16x32_bf16 v[232:235], a[228:231], a[108:111], v[232:235]
    v_exp_f32 v196, v196
    v_mfma_f32_16x16x32_bf16 v[232:235], a[232:235], a[112:115], v[232:235]
    v_sub_f32 v197, v197, v248
    v_sub_f32 v198, v198, v248
    v_mfma_f32_16x16x32_bf16 v[232:235], a[236:239], a[116:119], v[232:235]
    v_exp_f32 v197, v197
    v_mfma_f32_16x16x32_bf16 v[236:239], a[216:219], a[120:123], 0
    ds_read_b128 a[216:219], v242 offset:64640
    v_sub_f32 v199, v199, v248
    v_mfma_f32_16x16x32_bf16 v[236:239], a[220:223], a[124:127], v[236:239]
    ds_read_b128 a[220:223], v243 offset:64640
    v_cvt_pk_bf16_f32 v194, v196, v197
    v_mfma_f32_16x16x32_bf16 v[236:239], a[224:227], a[128:131], v[236:239]
    v_cvt_pk_bf16_f32 v48, v232, v233
    v_cvt_pk_bf16_f32 v51, v234, v235
    v_mfma_f32_16x16x32_bf16 v[236:239], a[228:231], a[132:135], v[236:239]
    ds_read_b128 a[224:227], v242 offset:64768
    ds_read_b128 a[228:231], v243 offset:64768
    v_mfma_f32_16x16x32_bf16 v[236:239], a[232:235], a[136:139], v[236:239]
    v_add_u32 v242, 0xf000, v242
    v_add_u32 v243, 0xf000, v243
    v_mfma_f32_16x16x32_bf16 v[236:239], a[236:239], a[140:143], v[236:239]
    ds_read_b128 a[232:235], v242 offset:4608
    ds_read_b128 a[236:239], v243 offset:4608
    v_mfma_f32_16x16x32_bf16 v[228:231], a[144:147], a[240:243], 0
    s_waitcnt lgkmcnt(6)
    v_exp_f32 v198, v198
    v_mfma_f32_16x16x32_bf16 v[208:211], v[144:147], v[168:171], v[208:211]
    v_exp_f32 v199, v199
    v_mfma_f32_16x16x32_bf16 v[208:211], v[146:149], v[170:173], v[208:211]
    v_cvt_pk_bf16_f32 v78, v236, v237
    v_cvt_pk_bf16_f32 v81, v238, v239
    v_mfma_f32_16x16x32_bf16 v[228:231], a[148:151], a[244:247], v[228:231]
    s_waitcnt lgkmcnt(4)
    v_cvt_pk_bf16_f32 v181, v198, v199
    v_sub_f32 v200, v200, v248
    v_mfma_f32_16x16x32_bf16 v[228:231], a[152:155], a[216:219], v[228:231]
    ds_read_b128 v[196:199], v246 offset:256
    v_sub_f32 v201, v201, v248
    v_mfma_f32_16x16x32_bf16 v[228:231], a[156:159], a[220:223], v[228:231]
    s_waitcnt lgkmcnt(4)
    v_exp_f32 v200, v200
    v_mfma_f32_16x16x32_bf16 v[228:231], a[160:163], a[224:227], v[228:231]
    s_waitcnt lgkmcnt(3)
    v_exp_f32 v201, v201
    v_mfma_f32_16x16x32_bf16 v[228:231], a[164:167], a[228:231], v[228:231]
    v_sub_f32 v202, v202, v248
    v_sub_f32 v203, v203, v248
    v_mfma_f32_16x16x32_bf16 v[232:235], a[168:171], a[240:243], 0
    v_exp_f32 v202, v202
    v_mfma_f32_16x16x32_bf16 v[232:235], a[172:175], a[244:247], v[232:235]
    v_exp_f32 v203, v203
    v_mfma_f32_16x16x32_bf16 v[232:235], a[176:179], a[216:219], v[232:235]
    v_cvt_pk_bf16_f32 v192, v200, v201
    v_mul_f32 v228, s38, v228
    v_mfma_f32_16x16x32_bf16 v[232:235], a[180:183], a[220:223], v[232:235]
    v_mul_f32 v229, s38, v229
    v_mul_f32 v230, s38, v230
    v_mfma_f32_16x16x32_bf16 v[232:235], a[184:187], a[224:227], v[232:235]
    v_mul_f32 v231, s38, v231
    v_cvt_pk_bf16_f32 v228, v228, v229
    v_mfma_f32_16x16x32_bf16 v[232:235], a[188:191], a[228:231], v[232:235]
    s_waitcnt lgkmcnt(0)
    v_cvt_pk_bf16_f32 v229, v230, v231
    v_cvt_pk_bf16_f32 v195, v202, v203
    v_mfma_f32_16x16x32_bf16 v[196:199], v[108:111], v[168:171], v[196:199]
    ds_write_b64 v247, v[228:229] offset:36864
    v_mfma_f32_16x16x32_bf16 v[212:215], v[0:3], v[192:195], 0
    ds_read_b128 v[200:203], v244 offset:320
    v_sub_f32 v204, v204, v248
    v_mfma_f32_16x16x32_bf16 v[216:219], v[30:33], v[192:195], 0
    v_mul_f32 v232, s3, v232
    v_mul_f32 v233, s3, v233
    v_mfma_f32_16x16x32_bf16 v[220:223], v[60:63], v[192:195], 0
    v_mul_f32 v234, s3, v234
    v_mul_f32 v235, s3, v235
    v_mfma_f32_16x16x32_bf16 v[224:227], a[248:251], v[192:195], 0
    v_cvt_pk_bf16_f32 v232, v232, v233
    v_cvt_pk_bf16_f32 v233, v234, v235
    v_mfma_f32_16x16x32_bf16 v[196:199], v[110:113], v[170:173], v[196:199]
    ds_write_b64 v247, v[232:233] offset:36992
    v_mfma_f32_16x16x32_bf16 v[236:239], a[192:195], a[240:243], 0
    ds_read_b128 a[240:243], v242 offset:4736
    v_sub_f32 v205, v205, v248
    v_mfma_f32_16x16x32_bf16 v[236:239], a[196:199], a[244:247], v[236:239]
    ds_read_b128 a[244:247], v243 offset:4736
    v_sub_f32 v206, v206, v248
    v_mfma_f32_16x16x32_bf16 v[236:239], a[200:203], a[216:219], v[236:239]
    ds_read_b128 a[216:219], v242 offset:4864
    v_sub_f32 v207, v207, v248
    v_mfma_f32_16x16x32_bf16 v[236:239], a[204:207], a[220:223], v[236:239]
    ds_read_b128 a[220:223], v243 offset:4864
    v_sub_f32 v208, v208, v248
    v_mfma_f32_16x16x32_bf16 v[236:239], a[208:211], a[224:227], v[236:239]
    s_waitcnt lgkmcnt(5)
    v_exp_f32 v204, v204
    v_mfma_f32_16x16x32_bf16 v[200:203], v[126:129], v[168:171], v[200:203]
    v_exp_f32 v205, v205
    v_mfma_f32_16x16x32_bf16 v[200:203], v[128:131], v[170:173], v[200:203]
    v_exp_f32 v206, v206
    v_mfma_f32_16x16x32_bf16 v[236:239], a[212:215], a[228:231], v[236:239]
    v_exp_f32 v207, v207
    v_mfma_f32_16x16x32_bf16 v[228:231], a[144:147], a[232:235], 0
    v_cvt_pk_bf16_f32 v183, v204, v205
    v_cvt_pk_bf16_f32 v186, v206, v207
    v_mfma_f32_16x16x32_bf16 v[228:231], a[148:151], a[236:239], v[228:231]
    ds_read_b128 v[204:207], v245 offset:320
    v_sub_f32 v209, v209, v248
    v_mfma_f32_16x16x32_bf16 v[232:235], a[168:171], a[232:235], 0
    s_waitcnt lgkmcnt(3)
    v_mul_f32 v236, s38, v236
    v_mul_f32 v237, s38, v237
    v_mfma_f32_16x16x32_bf16 v[228:231], a[152:155], a[240:243], v[228:231]
    v_mul_f32 v238, s38, v238
    v_mul_f32 v239, s38, v239
    v_mfma_f32_16x16x32_bf16 v[228:231], a[156:159], a[244:247], v[228:231]
    s_waitcnt lgkmcnt(1)
    v_cvt_pk_bf16_f32 v236, v236, v237
    v_cvt_pk_bf16_f32 v237, v238, v239
    v_mfma_f32_16x16x32_bf16 v[228:231], a[160:163], a[216:219], v[228:231]
    ds_write_b64 v247, v[236:237] offset:37120
    v_mfma_f32_16x16x32_bf16 v[228:231], a[164:167], a[220:223], v[228:231]
    v_exp_f32 v208, v208
    v_mfma_f32_16x16x32_bf16 v[232:235], a[172:175], a[236:239], v[232:235]
    v_exp_f32 v209, v209
    v_mfma_f32_16x16x32_bf16 v[232:235], a[176:179], a[240:243], v[232:235]
    v_sub_f32 v210, v210, v248
    v_sub_f32 v211, v211, v248
    v_mfma_f32_16x16x32_bf16 v[232:235], a[180:183], a[244:247], v[232:235]
    s_waitcnt lgkmcnt(1)
    v_mul_f32 v228, s38, v228
    v_mul_f32 v229, s38, v229
    v_mfma_f32_16x16x32_bf16 v[204:207], v[150:153], v[168:171], v[204:207]
    v_mul_f32 v230, s38, v230
    v_mul_f32 v231, s38, v231
    v_mfma_f32_16x16x32_bf16 v[204:207], v[152:155], v[170:173], v[204:207]
    v_cvt_pk_bf16_f32 v228, v228, v229
    v_cvt_pk_bf16_f32 v229, v230, v231
    v_mfma_f32_16x16x32_bf16 v[232:235], a[184:187], a[216:219], v[232:235]
    ds_write_b64 v247, v[228:229] offset:43008
    v_mfma_f32_16x16x32_bf16 v[232:235], a[188:191], a[220:223], v[232:235]
    v_mbcnt_lo_u32_b32 v228, -1, 0
    v_mbcnt_hi_u32_b32 v228, -1, v228
    v_mfma_f32_16x16x32_bf16 v[236:239], a[192:195], a[232:235], 0
    v_lshrrev_b32 v229, 4, v228
    v_bfe_u32 v230, v228, 2, 1
    v_mfma_f32_16x16x32_bf16 v[236:239], a[196:199], a[236:239], v[236:239]
    v_add_u32 v230, 15, v230
    v_and_b32 v230, 15, v230
    v_mfma_f32_16x16x32_bf16 v[236:239], a[200:203], a[240:243], v[236:239]
    v_mul_f32 v232, s3, v232
    v_mul_f32 v233, s3, v233
    v_mfma_f32_16x16x32_bf16 v[236:239], a[204:207], a[244:247], v[236:239]
    v_mul_f32 v234, s3, v234
    v_mul_f32 v235, s3, v235
    v_mfma_f32_16x16x32_bf16 v[236:239], a[208:211], a[216:219], v[236:239]
    ds_read_b128 a[216:219], v240 offset:36864
    v_cvt_pk_bf16_f32 v232, v232, v233
    v_mfma_f32_16x16x32_bf16 v[236:239], a[212:215], a[220:223], v[236:239]
    v_cvt_pk_bf16_f32 v233, v234, v235
    ds_write_b64 v247, v[232:233] offset:43136
    ds_read_b128 a[220:223], v241 offset:36864
    v_bfe_u32 v231, v228, 3, 1
    v_and_b32 v228, 3, v228
    v_lshl_add_u32 v228, v231, 2, v228
    v_add_u32 v228, 3, v228
    v_and_b32 v231, 3, v230
    v_mul_f32 v236, s38, v236
    v_mul_f32 v237, s38, v237
    v_mul_f32 v238, s38, v238
    v_mul_f32 v239, s38, v239
    v_cvt_pk_bf16_f32 v236, v236, v237
    v_cvt_pk_bf16_f32 v237, v238, v239
    ds_write_b64 v247, v[236:237] offset:43264
    v_mul_u32_u24 v230, 0x1e00, v230
    v_lshlrev_b32 v231, 1, v231
    v_bfe_u32 v243, v228, 1, 1
    v_or_b32 v231, v231, v243
    v_xor_b32 v231, v231, v229
    v_lshl_add_u32 v230, v231, 4, v230
    v_mul_u32_u24 v231, 0x180, v228
    v_add_u32 v242, v230, v231
    ds_read_b128 a[224:227], v242 offset:0
    ds_read_b128 a[232:235], v242 offset:128
    ds_read_b128 a[240:243], v242 offset:256
    v_xor_b32 v243, 64, v242
    ds_read_b128 a[228:231], v243 offset:0
    ds_read_b128 a[236:239], v243 offset:128
    ds_read_b128 a[244:247], v243 offset:256
    v_exp_f32 v210, v210
    v_exp_f32 v211, v211
    v_cvt_pk_bf16_f32 v184, v208, v209
    v_cvt_pk_bf16_f32 v187, v210, v211
    ds_read_b128 v[208:211], v246 offset:320
    v_sub_f32 v196, v196, v248
    v_exp_f32 v196, v196
    v_sub_f32 v197, v197, v248
    v_exp_f32 v197, v197
    v_sub_f32 v198, v198, v248
    v_exp_f32 v198, v198
    v_sub_f32 v199, v199, v248
    v_exp_f32 v199, v199
    v_cvt_pk_bf16_f32 v182, v196, v197
    s_waitcnt lgkmcnt(6)
    v_mfma_f32_16x16x32_bf16 v[232:235], a[144:147], a[224:227], 0
    v_cvt_pk_bf16_f32 v185, v198, v199
    v_sub_f32 v200, v200, v248
    v_mfma_f32_16x16x32_bf16 v[212:215], v[4:7], v[180:183], v[212:215]
    ds_read_b128 v[196:199], v244 offset:0
    v_sub_f32 v201, v201, v248
    v_mfma_f32_16x16x32_bf16 v[216:219], v[34:37], v[180:183], v[216:219]
    v_exp_f32 v200, v200
    v_mfma_f32_16x16x32_bf16 v[220:223], v[64:67], v[180:183], v[220:223]
    s_waitcnt lgkmcnt(4)
    v_exp_f32 v201, v201
    v_mfma_f32_16x16x32_bf16 v[224:227], a[248:251], v[180:183], v[224:227]
    v_cvt_pk_bf16_f32 v189, v200, v201
    v_sub_f32 v204, v204, v248
    v_mfma_f32_16x16x32_bf16 v[212:215], v[8:11], v[184:187], v[212:215]
    ds_read_b128 v[200:203], v245 offset:0
    v_sub_f32 v205, v205, v248
    v_mfma_f32_16x16x32_bf16 v[216:219], v[38:41], v[184:187], v[216:219]
    s_waitcnt lgkmcnt(2)
    v_exp_f32 v204, v204
    v_mfma_f32_16x16x32_bf16 v[220:223], v[68:71], v[184:187], v[220:223]
    v_exp_f32 v205, v205
    v_mfma_f32_16x16x32_bf16 v[224:227], a[248:251], v[184:187], v[224:227]
    v_cvt_pk_bf16_f32 v190, v204, v205
    v_mfma_f32_16x16x32_bf16 v[208:211], v[162:165], v[168:171], v[208:211]
    ds_read_b128 v[204:207], v246 offset:0
    ds_read_b64 v[168:169], v247 offset:18432
    v_mfma_f32_16x16x32_bf16 v[208:211], v[164:167], v[170:173], v[208:211]
    ds_read_b64 v[170:171], v247 offset:18560
    ds_read_b64 v[172:173], v247 offset:18688
    v_mfma_f32_16x16x32_bf16 v[232:235], a[148:151], a[228:231], v[232:235]
    s_waitcnt lgkmcnt(5)
    v_mfma_f32_16x16x32_bf16 v[196:199], v[120:123], v[174:177], v[196:199]
    v_mfma_f32_16x16x32_bf16 v[196:199], v[122:125], v[176:179], v[196:199]
    s_waitcnt lgkmcnt(4)
    v_mfma_f32_16x16x32_bf16 v[200:203], v[144:147], v[174:177], v[200:203]
    v_sub_f32 v208, v208, v248
    v_sub_f32 v209, v209, v248
    v_mfma_f32_16x16x32_bf16 v[200:203], v[146:149], v[176:179], v[200:203]
    v_exp_f32 v208, v208
    v_mfma_f32_16x16x32_bf16 v[232:235], a[152:155], a[232:235], v[232:235]
    v_exp_f32 v209, v209
    v_mfma_f32_16x16x32_bf16 v[232:235], a[156:159], a[236:239], v[232:235]
    s_waitcnt lgkmcnt(3)
    v_cvt_pk_bf16_f32 v188, v208, v209
    v_max_f32 v248, v196, v197
    v_mfma_f32_16x16x32_bf16 v[204:207], v[108:111], v[174:177], v[204:207]
    ds_read_b128 v[208:211], v244 offset:64
    v_max3_f32 v248, v248, v198, v199
    v_mfma_f32_16x16x32_bf16 v[212:215], v[12:15], v[188:191], v[212:215]
    ds_read_b128 v[196:199], v245 offset:64
    v_max3_f32 v248, v248, v200, v201
    v_mfma_f32_16x16x32_bf16 v[216:219], v[42:45], v[188:191], v[216:219]
    v_max3_f32 v248, v248, v202, v203
    v_mfma_f32_16x16x32_bf16 v[220:223], v[72:75], v[188:191], v[220:223]
    ds_read_b128 v[200:203], v246 offset:64
    v_mfma_f32_16x16x32_bf16 v[224:227], a[248:251], v[188:191], v[224:227]
    v_mfma_f32_16x16x32_bf16 v[204:207], v[110:113], v[176:179], v[204:207]
    v_mfma_f32_16x16x32_bf16 v[232:235], a[160:163], a[240:243], v[232:235]
    v_mfma_f32_16x16x32_bf16 v[232:235], a[164:167], a[244:247], v[232:235]
    v_mfma_f32_16x16x32_bf16 v[236:239], a[168:171], a[224:227], 0
    v_mfma_f32_16x16x32_bf16 v[236:239], a[172:175], a[228:231], v[236:239]
    s_waitcnt lgkmcnt(2)
    s_waitcnt lgkmcnt(1)
    v_mfma_f32_16x16x32_bf16 v[208:211], v[126:129], v[174:177], v[208:211]
    v_rcp_f32 v225, v224
    v_mfma_f32_16x16x32_bf16 v[208:211], v[128:131], v[176:179], v[208:211]
    v_mul_f32 v212, v212, v225
    v_mul_f32 v232, s38, v232
    v_mfma_f32_16x16x32_bf16 v[196:199], v[150:153], v[174:177], v[196:199]
    s_waitcnt lgkmcnt(0)
    v_mul_f32 v233, s38, v233
    v_mul_f32 v234, s38, v234
    v_mfma_f32_16x16x32_bf16 v[196:199], v[152:155], v[176:179], v[196:199]
    v_mul_f32 v235, s38, v235
    v_cvt_pk_bf16_f32 v232, v232, v233
    v_mfma_f32_16x16x32_bf16 v[200:203], v[162:165], v[174:177], v[200:203]
    v_cvt_pk_bf16_f32 v233, v234, v235
    v_mul_f32 v213, v213, v225
    v_mfma_f32_16x16x32_bf16 v[200:203], v[164:167], v[176:179], v[200:203]
    ds_write_b64 v247, v[232:233] offset:49152
    v_mfma_f32_16x16x32_bf16 v[236:239], a[176:179], a[232:235], v[236:239]
    v_mul_f32 v214, v214, v225
    v_mul_f32 v215, v215, v225
    v_mfma_f32_16x16x32_bf16 v[236:239], a[180:183], a[236:239], v[236:239]
    v_cvt_pk_bf16_f32 v212, v212, v213
    v_cvt_pk_bf16_f32 v213, v214, v215
    v_mfma_f32_16x16x32_bf16 v[236:239], a[184:187], a[240:243], v[236:239]
    ds_write_b64 v247, v[212:213] offset:6144
    v_mfma_f32_16x16x32_bf16 v[236:239], a[188:191], a[244:247], v[236:239]
    v_mul_f32 v216, v216, v225
    v_mul_f32 v217, v217, v225
    v_mfma_f32_16x16x32_bf16 v[228:231], a[192:195], a[224:227], 0
    ds_read_b128 a[224:227], v240 offset:36992
    v_mul_f32 v218, v218, v225
    v_mfma_f32_16x16x32_bf16 v[228:231], a[196:199], a[228:231], v[228:231]
    ds_read_b128 a[228:231], v241 offset:36992
    v_mul_f32 v219, v219, v225
    v_mfma_f32_16x16x32_bf16 v[228:231], a[200:203], a[232:235], v[228:231]
    v_mul_f32 v236, s3, v236
    v_mul_f32 v237, s3, v237
    v_mfma_f32_16x16x32_bf16 v[228:231], a[204:207], a[236:239], v[228:231]
    v_mul_f32 v238, s3, v238
    v_mul_f32 v239, s3, v239
    v_mfma_f32_16x16x32_bf16 v[228:231], a[208:211], a[240:243], v[228:231]
    ds_read_b128 a[232:235], v240 offset:37120
    v_cvt_pk_bf16_f32 v236, v236, v237
    v_mfma_f32_16x16x32_bf16 v[228:231], a[212:215], a[244:247], v[228:231]
    ds_read_b128 a[236:239], v241 offset:37120
    v_cvt_pk_bf16_f32 v237, v238, v239
    v_mfma_f32_16x16x32_bf16 v[232:235], a[0:3], a[216:219], 0
    ds_write_b64 v247, v[236:237] offset:49280
    v_mfma_f32_16x16x32_bf16 v[232:235], a[4:7], a[220:223], v[232:235]
    ds_read_b128 a[240:243], v242 offset:3072
    ds_read_b128 a[244:247], v243 offset:3072
    v_mfma_f32_16x16x32_bf16 v[236:239], a[24:27], a[216:219], 0
    s_waitcnt lgkmcnt(6)
    v_mul_f32 v228, s38, v228
    v_mul_f32 v229, s38, v229
    v_mfma_f32_16x16x32_bf16 v[232:235], a[8:11], a[224:227], v[232:235]
    s_waitcnt lgkmcnt(5)
    v_mul_f32 v230, s38, v230
    v_mul_f32 v231, s38, v231
    v_mfma_f32_16x16x32_bf16 v[232:235], a[12:15], a[228:231], v[232:235]
    v_cvt_pk_bf16_f32 v228, v228, v229
    v_cvt_pk_bf16_f32 v229, v230, v231
    v_mfma_f32_16x16x32_bf16 v[236:239], a[28:31], a[220:223], v[236:239]
    ds_write_b64 v247, v[228:229] offset:49408
    v_mfma_f32_16x16x32_bf16 v[236:239], a[32:35], a[224:227], v[236:239]
    s_waitcnt lgkmcnt(5)
    v_add_u32 v240, 0xffff1000, v240
    v_add_u32 v241, 0xffff1000, v241
    v_mfma_f32_16x16x32_bf16 v[232:235], a[16:19], a[232:235], v[232:235]
    s_waitcnt lgkmcnt(4)
    v_cvt_pk_bf16_f32 v216, v216, v217
    v_cvt_pk_bf16_f32 v217, v218, v219
    v_mfma_f32_16x16x32_bf16 v[232:235], a[20:23], a[236:239], v[232:235]
    ds_write_b64 v247, v[216:217] offset:6272
    v_mfma_f32_16x16x32_bf16 v[236:239], a[36:39], a[228:231], v[236:239]
    v_mul_f32 v220, v220, v225
    v_mul_f32 v221, v221, v225
    v_mfma_f32_16x16x32_bf16 v[236:239], a[40:43], a[232:235], v[236:239]
    v_mul_f32 v222, v222, v225
    v_mul_f32 v223, v223, v225
    v_mfma_f32_16x16x32_bf16 v[236:239], a[44:47], a[236:239], v[236:239]
    v_cvt_pk_bf16_f32 v220, v220, v221
    v_cvt_pk_bf16_f32 v221, v222, v223
    v_mfma_f32_16x16x32_bf16 v[228:231], a[48:51], a[216:219], 0
    ds_write_b64 v247, v[220:221] offset:6400
    v_mfma_f32_16x16x32_bf16 v[228:231], a[52:55], a[220:223], v[228:231]
    v_max3_f32 v248, v248, v204, v205
    v_max3_f32 v248, v248, v206, v207
    v_mfma_f32_16x16x32_bf16 v[228:231], a[56:59], a[224:227], v[228:231]
    ds_read_b128 v[204:207], v244 offset:128
    v_max3_f32 v248, v248, v208, v209
    v_mfma_f32_16x16x32_bf16 v[228:231], a[60:63], a[228:231], v[228:231]
    v_max3_f32 v248, v248, v210, v211
    v_max3_f32 v248, v248, v196, v197
    v_mfma_f32_16x16x32_bf16 v[228:231], a[64:67], a[232:235], v[228:231]
    ds_read_b128 v[208:211], v245 offset:128
    v_max3_f32 v248, v248, v198, v199
    v_mfma_f32_16x16x32_bf16 v[228:231], a[68:71], a[236:239], v[228:231]
    ds_read_b128 v[196:199], v246 offset:128
    v_max3_f32 v248, v248, v200, v201
    v_max3_f32 v248, v248, v202, v203
    ds_read_b128 v[200:203], v244 offset:0
    s_waitcnt lgkmcnt(3)
    v_mfma_f32_16x16x32_bf16 v[204:207], v[132:135], v[174:177], v[204:207]
    v_mfma_f32_16x16x32_bf16 v[204:207], v[134:137], v[176:179], v[204:207]
    s_nop 7
    s_waitcnt lgkmcnt(1)
    v_mfma_f32_16x16x32_bf16 v[208:211], v[156:159], v[174:177], v[208:211]
    v_max3_f32 v248, v248, v204, v205
    s_waitcnt lgkmcnt(0)
    v_mfma_f32_16x16x32_bf16 v[208:211], v[158:161], v[176:179], v[208:211]
    ds_read_b128 v[204:207], v245 offset:0
    v_mfma_f32_16x16x32_bf16 v[196:199], v[114:117], v[174:177], v[196:199]
    v_mfma_f32_16x16x32_bf16 v[196:199], v[116:119], v[176:179], v[196:199]
    v_mfma_f32_16x16x32_bf16 v[200:203], v[120:123], v[174:177], v[200:203]
    v_cvt_pk_bf16_f32 v120, v232, v233
    v_cvt_pk_bf16_f32 v121, v234, v235
    v_mfma_f32_16x16x32_bf16 v[200:203], v[122:125], v[176:179], v[200:203]
    v_cvt_pk_bf16_f32 v122, v236, v237
    v_cvt_pk_bf16_f32 v123, v238, v239
    v_mfma_f32_16x16x32_bf16 v[232:235], a[216:219], a[72:75], 0
    v_cvt_pk_bf16_f32 v124, v228, v229
    v_cvt_pk_bf16_f32 v125, v230, v231
    v_mfma_f32_16x16x32_bf16 v[232:235], a[220:223], a[76:79], v[232:235]
    v_max3_f32 v248, v248, v208, v209
    v_max3_f32 v248, v248, v196, v197
    v_mfma_f32_16x16x32_bf16 v[232:235], a[224:227], a[80:83], v[232:235]
    ds_read_b128 v[208:211], v246 offset:0
    ds_read_b128 v[196:199], v244 offset:64
    v_mfma_f32_16x16x32_bf16 v[232:235], a[228:231], a[84:87], v[232:235]
    v_mov_b32 v225, v248
    s_waitcnt lgkmcnt(2)
    v_mfma_f32_16x16x32_bf16 v[204:207], v[144:147], v[174:177], v[204:207]
    v_permlane16_swap_b32 v248, v225
    v_max_f32 v248, v248, v225
    v_mfma_f32_16x16x32_bf16 v[204:207], v[146:149], v[176:179], v[204:207]
    v_mov_b32 v225, v248
    v_mfma_f32_16x16x32_bf16 v[232:235], a[232:235], a[88:91], v[232:235]
    v_mfma_f32_16x16x32_bf16 v[232:235], a[236:239], a[92:95], v[232:235]
    v_permlane32_swap_b32 v248, v225
    v_max_f32 v248, v248, v225
    v_mfma_f32_16x16x32_bf16 v[236:239], a[216:219], a[96:99], 0
    v_sub_f32 v200, v200, v248
    v_sub_f32 v201, v201, v248
    v_mfma_f32_16x16x32_bf16 v[236:239], a[220:223], a[100:103], v[236:239]
    v_exp_f32 v200, v200
    v_mfma_f32_16x16x32_bf16 v[236:239], a[224:227], a[104:107], v[236:239]
    v_cvt_pk_bf16_f32 v24, v232, v233
    v_cvt_pk_bf16_f32 v27, v234, v235
    v_mfma_f32_16x16x32_bf16 v[236:239], a[228:231], a[108:111], v[236:239]
    s_waitcnt lgkmcnt(1)
    v_mbcnt_lo_u32_b32 v232, -1, 0
    v_mbcnt_hi_u32_b32 v232, -1, v232
    v_mfma_f32_16x16x32_bf16 v[208:211], v[108:111], v[174:177], v[208:211]
    s_waitcnt lgkmcnt(0)
    v_lshrrev_b32 v233, 1, v232
    v_add_u32 v233, 64, v233
    v_mfma_f32_16x16x32_bf16 v[208:211], v[110:113], v[176:179], v[208:211]
    v_mul_u32_u24 v234, 43, v233
    v_lshrrev_b32 v235, 8, v234
    v_mfma_f32_16x16x32_bf16 v[196:199], v[126:129], v[174:177], v[196:199]
    v_lshrrev_b32 v234, 7, v234
    v_mad_i32_i24 v233, v234, -3, v233
    v_mfma_f32_16x16x32_bf16 v[196:199], v[128:131], v[176:179], v[196:199]
    v_and_b32 v235, 4, v235
    v_xor_b32 v234, v234, v235
    v_mfma_f32_16x16x32_bf16 v[236:239], a[232:235], a[112:115], v[236:239]
    v_and_b32 v235, 4, v234
    v_mul_u32_u24 v251, 24, v235
    v_mfma_f32_16x16x32_bf16 v[236:239], a[236:239], a[116:119], v[236:239]
    v_lshrrev_b32 v235, 3, v234
    v_lshl_add_u32 v251, v235, 2, v251
    v_mfma_f32_16x16x32_bf16 v[228:231], a[216:219], a[120:123], 0
    ds_read_b128 a[216:219], v242 offset:3200
    v_and_or_b32 v251, v234, 3, v251
    v_mfma_f32_16x16x32_bf16 v[228:231], a[220:223], a[124:127], v[228:231]
    ds_read_b128 a[220:223], v243 offset:3200
    v_mad_u32_u24 v251, v251, 3, v233
    v_mfma_f32_16x16x32_bf16 v[228:231], a[224:227], a[128:131], v[228:231]
    v_cvt_pk_bf16_f32 v54, v236, v237
    v_cvt_pk_bf16_f32 v57, v238, v239
    v_mfma_f32_16x16x32_bf16 v[228:231], a[228:231], a[132:135], v[228:231]
    ds_read_b128 a[224:227], v242 offset:3328
    ds_read_b128 a[228:231], v243 offset:3328
    v_mfma_f32_16x16x32_bf16 v[228:231], a[232:235], a[136:139], v[228:231]
    ds_read_b128 a[232:235], v240 offset:0
    v_and_b32 v235, 1, v232
    v_mfma_f32_16x16x32_bf16 v[228:231], a[236:239], a[140:143], v[228:231]
    ds_read_b128 a[236:239], v241 offset:0
    v_lshl_add_u32 v251, v251, 3, v235
    v_mfma_f32_16x16x32_bf16 v[236:239], a[144:147], a[240:243], 0
    v_lshlrev_b32 v251, 4, v251
    v_add_u32 v251, 0xfffff800, v251
    v_mfma_f32_16x16x32_bf16 v[236:239], a[148:151], a[244:247], v[236:239]
    v_exp_f32 v201, v201
    v_mfma_f32_16x16x32_bf16 v[232:235], a[192:195], a[240:243], 0
    v_cvt_pk_bf16_f32 v84, v228, v229
    v_cvt_pk_bf16_f32 v87, v230, v231
    v_mfma_f32_16x16x32_bf16 v[228:231], a[168:171], a[240:243], 0
    ds_read_b128 a[240:243], v240 offset:128
    v_sub_f32 v202, v202, v248
    v_mfma_f32_16x16x32_bf16 v[228:231], a[172:175], a[244:247], v[228:231]
    s_waitcnt lgkmcnt(5)
    v_exp_f32 v202, v202
    v_mfma_f32_16x16x32_bf16 v[236:239], a[152:155], a[216:219], v[236:239]
    v_sub_f32 v203, v203, v248
    v_cvt_pk_bf16_f32 v193, v200, v201
    v_mfma_f32_16x16x32_bf16 v[236:239], a[156:159], a[220:223], v[236:239]
    s_waitcnt lgkmcnt(4)
    s_waitcnt lgkmcnt(3)
    s_barrier
    v_mfma_f32_16x16x32_bf16 v[236:239], a[160:163], a[224:227], v[236:239]
    buffer_load_dwordx4 v252, s[12:15], s62 offen lds
    v_sub_f32 v204, v204, v248
    v_mfma_f32_16x16x32_bf16 v[236:239], a[164:167], a[228:231], v[236:239]
    v_exp_f32 v203, v203
    v_mfma_f32_16x16x32_bf16 v[228:231], a[176:179], a[216:219], v[228:231]
    v_cvt_pk_bf16_f32 v180, v202, v203
    v_sub_f32 v205, v205, v248
    v_mfma_f32_16x16x32_bf16 v[228:231], a[180:183], a[220:223], v[228:231]
    ds_read_b128 v[200:203], v245 offset:64
    v_sub_f32 v206, v206, v248
    v_mfma_f32_16x16x32_bf16 v[228:231], a[184:187], a[224:227], v[228:231]
    buffer_load_dwordx4 v253, s[12:15], s62 offen offset:1024 lds
    v_mul_f32 v236, s38, v236
    v_mfma_f32_16x16x32_bf16 v[228:231], a[188:191], a[228:231], v[228:231]
    v_mul_f32 v237, s38, v237
    v_mul_f32 v238, s38, v238
    v_mfma_f32_16x16x32_bf16 v[232:235], a[196:199], a[244:247], v[232:235]
    v_mul_f32 v239, s38, v239
    v_cvt_pk_bf16_f32 v236, v236, v237
    v_mfma_f32_16x16x32_bf16 v[232:235], a[200:203], a[216:219], v[232:235]
    ds_read_b128 a[244:247], v241 offset:128
    v_cvt_pk_bf16_f32 v237, v238, v239
    v_mfma_f32_16x16x32_bf16 v[232:235], a[204:207], a[220:223], v[232:235]
    buffer_load_dwordx4 v251, s[12:15], s62 offen offset:2048 lds
    s_add_u32 m0, s46, 0x17400
    v_mfma_f32_16x16x32_bf16 v[232:235], a[208:211], a[224:227], v[232:235]
    s_lshl_b32 s62, s28, 5
    s_add_u32 s62, s62, 0x3000
    v_mul_f32 v228, s3, v228
    v_mfma_f32_16x16x32_bf16 v[232:235], a[212:215], a[228:231], v[232:235]
    ds_write_b64 v247, v[236:237] offset:55296
    s_waitcnt lgkmcnt(3)
    v_mfma_f32_16x16x32_bf16 v[236:239], a[0:3], a[232:235], 0
    s_waitcnt lgkmcnt(2)
    buffer_load_dwordx4 v252, s[12:15], s63 offen lds
    v_mfma_f32_16x16x32_bf16 v[200:203], v[150:153], v[174:177], v[200:203]
    v_mul_f32 v229, s3, v229
    v_mul_f32 v230, s3, v230
    v_mfma_f32_16x16x32_bf16 v[200:203], v[152:155], v[176:179], v[200:203]
    v_mul_f32 v231, s3, v231
    v_cvt_pk_bf16_f32 v228, v228, v229
    v_mfma_f32_16x16x32_bf16 v[236:239], a[4:7], a[236:239], v[236:239]
    v_cvt_pk_bf16_f32 v229, v230, v231
    v_mul_f32 v232, s38, v232
    v_mfma_f32_16x16x32_bf16 v[236:239], a[8:11], a[240:243], v[236:239]
    s_waitcnt lgkmcnt(1)
    buffer_load_dwordx4 v253, s[12:15], s63 offen offset:1024 lds
    v_mfma_f32_16x16x32_bf16 v[236:239], a[12:15], a[244:247], v[236:239]
    ds_write_b64 v247, v[228:229] offset:55424
    v_mfma_f32_16x16x32_bf16 v[228:231], a[24:27], a[232:235], 0
    v_mul_f32 v233, s38, v233
    v_mul_f32 v234, s38, v234
    v_mfma_f32_16x16x32_bf16 v[228:231], a[28:31], a[236:239], v[228:231]
    v_mul_f32 v235, s38, v235
    v_cvt_pk_bf16_f32 v232, v232, v233
    v_mfma_f32_16x16x32_bf16 v[228:231], a[32:35], a[240:243], v[228:231]
    buffer_load_dwordx4 v251, s[12:15], s63 offen offset:2048 lds
    s_add_u32 m0, s46, 0x16800
    v_mfma_f32_16x16x32_bf16 v[228:231], a[36:39], a[244:247], v[228:231]
    s_lshl_b32 s63, s28, 5
    s_add_u32 s63, s63, 0x7800
    v_cvt_pk_bf16_f32 v233, v234, v235
    ds_write_b64 v247, v[232:233] offset:55552
    v_mfma_f32_16x16x32_bf16 v[232:235], a[48:51], a[232:235], 0
    ds_read_b128 a[216:219], v240 offset:256
    ds_read_b128 a[220:223], v241 offset:256
    v_mfma_f32_16x16x32_bf16 v[232:235], a[52:55], a[236:239], v[232:235]
    ds_read_b128 a[224:227], v240 offset:1536
    ds_read_b128 a[228:231], v241 offset:1536
    v_mfma_f32_16x16x32_bf16 v[232:235], a[56:59], a[240:243], v[232:235]
    v_exp_f32 v204, v204
    v_mfma_f32_16x16x32_bf16 v[232:235], a[60:63], a[244:247], v[232:235]
    v_exp_f32 v205, v205
    v_exp_f32 v206, v206
    v_sub_f32 v207, v207, v248
    v_exp_f32 v207, v207
    v_cvt_pk_bf16_f32 v194, v204, v205
    v_cvt_pk_bf16_f32 v181, v206, v207
    ds_read_b128 v[204:207], v246 offset:64
    v_sub_f32 v208, v208, v248
    v_exp_f32 v208, v208
    v_sub_f32 v209, v209, v248
    v_exp_f32 v209, v209
    v_sub_f32 v210, v210, v248
    s_waitcnt lgkmcnt(4)
    v_mfma_f32_16x16x32_bf16 v[236:239], a[16:19], a[216:219], v[236:239]
    v_exp_f32 v210, v210
    v_mfma_f32_16x16x32_bf16 v[228:231], a[40:43], a[216:219], v[228:231]
    s_waitcnt lgkmcnt(3)
    v_sub_f32 v211, v211, v248
    v_cvt_pk_bf16_f32 v192, v208, v209
    v_mfma_f32_16x16x32_bf16 v[236:239], a[20:23], a[220:223], v[236:239]
    v_exp_f32 v211, v211
    v_mfma_f32_16x16x32_bf16 v[228:231], a[44:47], a[220:223], v[228:231]
    v_cvt_pk_bf16_f32 v195, v210, v211
    v_sub_f32 v196, v196, v248
    v_mfma_f32_16x16x32_bf16 v[232:235], a[64:67], a[216:219], v[232:235]
    ds_read_b128 v[208:211], v244 offset:128
    v_sub_f32 v197, v197, v248
    v_mfma_f32_16x16x32_bf16 v[212:215], v[6:9], v[192:195], 0
    v_exp_f32 v196, v196
    v_mfma_f32_16x16x32_bf16 v[216:219], v[36:39], v[192:195], 0
    s_waitcnt lgkmcnt(1)
    v_exp_f32 v197, v197
    v_mfma_f32_16x16x32_bf16 v[220:223], v[66:69], v[192:195], 0
    v_sub_f32 v198, v198, v248
    v_sub_f32 v199, v199, v248
    v_mfma_f32_16x16x32_bf16 v[224:227], a[248:251], v[192:195], 0
    v_exp_f32 v198, v198
    v_mfma_f32_16x16x32_bf16 v[204:207], v[162:165], v[174:177], v[204:207]
    v_exp_f32 v199, v199
    v_mfma_f32_16x16x32_bf16 v[204:207], v[164:167], v[176:179], v[204:207]
    v_cvt_pk_bf16_f32 v183, v196, v197
    v_cvt_pk_bf16_f32 v186, v198, v199
    v_mfma_f32_16x16x32_bf16 v[232:235], a[68:71], a[220:223], v[232:235]
    ds_read_b128 v[196:199], v245 offset:128
    v_sub_f32 v200, v200, v248
    v_exp_f32 v200, v200
    s_waitcnt lgkmcnt(1)
    v_mfma_f32_16x16x32_bf16 v[208:211], v[132:135], v[174:177], v[208:211]
    v_sub_f32 v201, v201, v248
    v_sub_f32 v202, v202, v248
    v_mfma_f32_16x16x32_bf16 v[208:211], v[134:137], v[176:179], v[208:211]
    v_exp_f32 v201, v201
    v_exp_f32 v202, v202
    v_sub_f32 v203, v203, v248
    v_exp_f32 v203, v203
    v_cvt_pk_bf16_f32 v184, v200, v201
    v_cvt_pk_bf16_f32 v187, v202, v203
    ds_read_b128 v[200:203], v246 offset:128
    v_sub_f32 v204, v204, v248
    v_exp_f32 v204, v204
    v_sub_f32 v205, v205, v248
    v_exp_f32 v205, v205
    v_sub_f32 v206, v206, v248
    v_exp_f32 v206, v206
    s_waitcnt lgkmcnt(1)
    v_mfma_f32_16x16x32_bf16 v[196:199], v[156:159], v[174:177], v[196:199]
    v_sub_f32 v207, v207, v248
    v_cvt_pk_bf16_f32 v182, v204, v205
    v_mfma_f32_16x16x32_bf16 v[196:199], v[158:161], v[176:179], v[196:199]
    v_exp_f32 v207, v207
    v_mfma_f32_16x16x32_bf16 v[212:215], v[10:13], v[180:183], v[212:215]
    v_cvt_pk_bf16_f32 v185, v206, v207
    v_sub_f32 v208, v208, v248
    v_mfma_f32_16x16x32_bf16 v[216:219], v[40:43], v[180:183], v[216:219]
    ds_read_b128 v[204:207], v244 offset:0
    v_sub_f32 v209, v209, v248
    v_mfma_f32_16x16x32_bf16 v[220:223], v[70:73], v[180:183], v[220:223]
    v_exp_f32 v208, v208
    v_mfma_f32_16x16x32_bf16 v[224:227], a[248:251], v[180:183], v[224:227]
    s_waitcnt lgkmcnt(1)
    v_exp_f32 v209, v209
    v_mfma_f32_16x16x32_bf16 v[212:215], v[14:17], v[184:187], v[212:215]
    v_cvt_pk_bf16_f32 v189, v208, v209
    v_sub_f32 v196, v196, v248
    v_mfma_f32_16x16x32_bf16 v[216:219], v[44:47], v[184:187], v[216:219]
    ds_read_b128 v[208:211], v245 offset:0
    s_waitcnt vmcnt(3)
    v_mfma_f32_16x16x32_bf16 v[220:223], v[74:77], v[184:187], v[220:223]
    ds_read_b64_tr_b16 a[144:145], v249 offset:0
    ds_read_b64_tr_b16 a[146:147], v250 offset:0
    v_mfma_f32_16x16x32_bf16 v[224:227], a[248:251], v[184:187], v[224:227]
    ds_read_b64_tr_b16 a[168:169], v249 offset:32
    ds_read_b64_tr_b16 a[170:171], v250 offset:32
    v_mfma_f32_16x16x32_bf16 v[200:203], v[114:117], v[174:177], v[200:203]
    ds_read_b64_tr_b16 a[192:193], v249 offset:64
    ds_read_b64_tr_b16 a[194:195], v250 offset:64
    v_mfma_f32_16x16x32_bf16 v[200:203], v[116:119], v[176:179], v[200:203]
    s_waitcnt lgkmcnt(7)
    ds_read_b64 v[174:175], v247 offset:0
    v_mfma_f32_16x16x32_bf16 v[204:207], v[126:129], v[168:171], v[204:207]
    ds_read_b64 v[176:177], v247 offset:128
    ds_read_b64 v[178:179], v247 offset:256
    v_mfma_f32_16x16x32_bf16 v[204:207], v[128:131], v[170:173], v[204:207]
    v_exp_f32 v196, v196
    v_sub_f32 v197, v197, v248
    v_exp_f32 v197, v197
    v_sub_f32 v200, v200, v248
    v_cvt_pk_bf16_f32 v190, v196, v197
    s_waitcnt lgkmcnt(9)
    v_mfma_f32_16x16x32_bf16 v[208:211], v[150:153], v[168:171], v[208:211]
    ds_read_b128 v[196:199], v246 offset:0
    v_sub_f32 v201, v201, v248
    v_mfma_f32_16x16x32_bf16 v[208:211], v[152:155], v[170:173], v[208:211]
    v_exp_f32 v200, v200
    v_exp_f32 v201, v201
    v_max_f32 v248, v204, v205
    v_cvt_pk_bf16_f32 v188, v200, v201
    ds_read_b128 v[200:203], v244 offset:64
    s_waitcnt lgkmcnt(5)
    v_mfma_f32_16x16x32_bf16 v[212:215], v[18:21], v[188:191], v[212:215]
    buffer_load_dwordx4 v252, s[12:15], s60 offen lds
    v_max3_f32 v248, v248, v206, v207
    v_mfma_f32_16x16x32_bf16 v[216:219], v[48:51], v[188:191], v[216:219]
    s_waitcnt vmcnt(1)
    ds_read_b64_tr_b16 a[148:149], v249 offset:3072
    v_mfma_f32_16x16x32_bf16 v[220:223], v[78:81], v[188:191], v[220:223]
    ds_read_b64_tr_b16 a[150:151], v250 offset:3072
    ds_read_b64_tr_b16 a[172:173], v249 offset:3104
    v_mfma_f32_16x16x32_bf16 v[224:227], a[248:251], v[188:191], v[224:227]
    ds_read_b64_tr_b16 a[174:175], v250 offset:3104
    ds_read_b64_tr_b16 a[196:197], v249 offset:3136
    buffer_load_dwordx4 v253, s[12:15], s60 offen offset:1024 lds
    s_waitcnt lgkmcnt(6)
    v_mfma_f32_16x16x32_bf16 v[196:199], v[162:165], v[168:171], v[196:199]
    ds_read_b64_tr_b16 a[198:199], v250 offset:3136
    ds_read_b128 v[204:207], v245 offset:64
    v_mfma_f32_16x16x32_bf16 v[196:199], v[164:167], v[170:173], v[196:199]
    v_rcp_f32 v225, v224
    v_max3_f32 v248, v248, v208, v209
    v_mul_f32 v212, v212, v225
    v_mul_f32 v213, v213, v225
    s_waitcnt lgkmcnt(7)
    v_mfma_f32_16x16x32_bf16 v[200:203], v[132:135], v[168:171], v[200:203]
    buffer_load_dwordx4 v251, s[12:15], s60 offen offset:2048 lds
    s_add_u32 m0, s46, 0x17400
    v_mfma_f32_16x16x32_bf16 v[200:203], v[134:137], v[170:173], v[200:203]
    v_mul_f32 v214, v214, v225
    v_mul_f32 v215, v215, v225
    v_cvt_pk_bf16_f32 v212, v212, v213
    v_cvt_pk_bf16_f32 v213, v214, v215
    ds_write_b64 v247, v[212:213] offset:12288
    v_mul_f32 v216, v216, v225
    v_mul_f32 v217, v217, v225
    v_mul_f32 v218, v218, v225
    v_mul_f32 v219, v219, v225
    v_cvt_pk_bf16_f32 v216, v216, v217
    v_cvt_pk_bf16_f32 v217, v218, v219
    ds_write_b64 v247, v[216:217] offset:12416
    s_waitcnt lgkmcnt(2)
    v_mfma_f32_16x16x32_bf16 v[204:207], v[156:159], v[168:171], v[204:207]
    buffer_load_dwordx4 v252, s[12:15], s61 offen lds
    v_mul_f32 v220, v220, v225
    v_mfma_f32_16x16x32_bf16 v[204:207], v[158:161], v[170:173], v[204:207]
    v_mul_f32 v221, v221, v225
    v_mul_f32 v222, v222, v225
    v_mul_f32 v223, v223, v225
    v_cvt_pk_bf16_f32 v220, v220, v221
    v_cvt_pk_bf16_f32 v221, v222, v223
    ds_write_b64 v247, v[220:221] offset:12544
    buffer_load_dwordx4 v253, s[12:15], s61 offen offset:1024 lds
    v_max3_f32 v248, v248, v210, v211
    ds_read_b128 v[208:211], v246 offset:64
    v_max3_f32 v248, v248, v196, v197
    v_max3_f32 v248, v248, v198, v199
    ds_read_b128 v[196:199], v244 offset:128
    v_max3_f32 v248, v248, v200, v201
    v_max3_f32 v248, v248, v202, v203
    ds_read_b128 v[200:203], v245 offset:128
    buffer_load_dwordx4 v251, s[12:15], s61 offen offset:2048 lds
    s_add_u32 m0, s46, 0x16800
    v_max3_f32 v248, v248, v204, v205
    v_max3_f32 v248, v248, v206, v207
    ds_read_b128 v[204:207], v246 offset:128
    s_waitcnt lgkmcnt(3)
    v_mfma_f32_16x16x32_bf16 v[208:211], v[114:117], v[168:171], v[208:211]
    v_mfma_f32_16x16x32_bf16 v[208:211], v[116:119], v[170:173], v[208:211]
    s_waitcnt lgkmcnt(2)
    v_mfma_f32_16x16x32_bf16 v[196:199], v[90:93], v[168:171], v[196:199]
    s_waitcnt lgkmcnt(1)
    v_mfma_f32_16x16x32_bf16 v[196:199], v[92:95], v[170:173], v[196:199]
    v_mfma_f32_16x16x32_bf16 v[200:203], v[96:99], v[168:171], v[200:203]
    s_waitcnt lgkmcnt(0)
    v_mfma_f32_16x16x32_bf16 v[200:203], v[98:101], v[170:173], v[200:203]
    v_mfma_f32_16x16x32_bf16 v[204:207], v[120:123], v[168:171], v[204:207]
    v_max3_f32 v248, v248, v208, v209
    v_max3_f32 v248, v248, v210, v211
    v_mfma_f32_16x16x32_bf16 v[204:207], v[122:125], v[170:173], v[204:207]
    ds_read_b128 v[208:211], v244 offset:0
    v_max3_f32 v248, v248, v196, v197
    ds_read_b128 v[196:199], v245 offset:0
    s_nop 0
    v_max3_f32 v248, v248, v200, v201
    ds_read_b128 v[200:203], v246 offset:0
    s_nop 1
    v_max3_f32 v248, v248, v204, v205
    ds_read_b128 v[204:207], v244 offset:64
    v_mov_b32 v225, v248
    s_nop 1
    v_permlane16_swap_b32 v248, v225
    v_max_f32 v248, v248, v225
    v_mov_b32 v225, v248
    s_nop 1
    v_permlane32_swap_b32 v248, v225
    v_max_f32 v248, v248, v225
    s_waitcnt lgkmcnt(3)
    v_mfma_f32_16x16x32_bf16 v[208:211], v[126:129], v[168:171], v[208:211]
    v_cvt_pk_bf16_f32 v126, v236, v237
    v_cvt_pk_bf16_f32 v127, v238, v239
    v_mfma_f32_16x16x32_bf16 v[208:211], v[128:131], v[170:173], v[208:211]
    s_waitcnt lgkmcnt(2)
    v_cvt_pk_bf16_f32 v128, v228, v229
    v_cvt_pk_bf16_f32 v129, v230, v231
    v_mfma_f32_16x16x32_bf16 v[196:199], v[150:153], v[168:171], v[196:199]
    s_waitcnt lgkmcnt(1)
    v_cvt_pk_bf16_f32 v130, v232, v233
    v_cvt_pk_bf16_f32 v131, v234, v235
    v_mfma_f32_16x16x32_bf16 v[196:199], v[152:155], v[170:173], v[196:199]
    v_sub_f32 v208, v208, v248
    v_sub_f32 v209, v209, v248
    v_mfma_f32_16x16x32_bf16 v[200:203], v[162:165], v[168:171], v[200:203]
    s_waitcnt lgkmcnt(0)
    v_exp_f32 v208, v208
    v_mfma_f32_16x16x32_bf16 v[200:203], v[164:167], v[170:173], v[200:203]
    v_exp_f32 v209, v209
    v_mfma_f32_16x16x32_bf16 v[204:207], v[132:135], v[168:171], v[204:207]
    v_sub_f32 v210, v210, v248
    v_sub_f32 v211, v211, v248
    v_mfma_f32_16x16x32_bf16 v[204:207], v[134:137], v[170:173], v[204:207]
    v_exp_f32 v210, v210
    v_mfma_f32_16x16x32_bf16 v[236:239], a[232:235], a[72:75], 0
    v_exp_f32 v211, v211
    v_mfma_f32_16x16x32_bf16 v[236:239], a[236:239], a[76:79], v[236:239]
    v_cvt_pk_bf16_f32 v193, v208, v209
    v_cvt_pk_bf16_f32 v180, v210, v211
    v_mfma_f32_16x16x32_bf16 v[236:239], a[240:243], a[80:83], v[236:239]
    ds_read_b128 v[208:211], v245 offset:64
    v_sub_f32 v196, v196, v248
    v_mfma_f32_16x16x32_bf16 v[236:239], a[244:247], a[84:87], v[236:239]
    v_exp_f32 v196, v196
    v_mfma_f32_16x16x32_bf16 v[236:239], a[216:219], a[88:91], v[236:239]
    v_sub_f32 v197, v197, v248
    v_sub_f32 v198, v198, v248
    v_mfma_f32_16x16x32_bf16 v[236:239], a[220:223], a[92:95], v[236:239]
    v_exp_f32 v197, v197
    v_mfma_f32_16x16x32_bf16 v[228:231], a[232:235], a[96:99], 0
    v_exp_f32 v198, v198
    v_mfma_f32_16x16x32_bf16 v[228:231], a[236:239], a[100:103], v[228:231]
    v_sub_f32 v199, v199, v248
    s_waitcnt vmcnt(3)
    v_mfma_f32_16x16x32_bf16 v[228:231], a[240:243], a[104:107], v[228:231]
    ds_read_b64_tr_b16 a[152:153], v249 offset:0
    ds_read_b64_tr_b16 a[154:155], v250 offset:0
    v_mfma_f32_16x16x32_bf16 v[228:231], a[244:247], a[108:111], v[228:231]
    ds_read_b64_tr_b16 a[176:177], v249 offset:32
    ds_read_b64_tr_b16 a[178:179], v250 offset:32
    v_mfma_f32_16x16x32_bf16 v[228:231], a[216:219], a[112:115], v[228:231]
    ds_read_b64_tr_b16 a[200:201], v249 offset:64
    ds_read_b64_tr_b16 a[202:203], v250 offset:64
    v_mfma_f32_16x16x32_bf16 v[228:231], a[220:223], a[116:119], v[228:231]
    s_waitcnt lgkmcnt(6)
    v_cvt_pk_bf16_f32 v1, v236, v237
    v_cvt_pk_bf16_f32 v4, v238, v239
    v_mfma_f32_16x16x32_bf16 v[208:211], v[156:159], v[168:171], v[208:211]
    v_exp_f32 v199, v199
    v_mfma_f32_16x16x32_bf16 v[208:211], v[158:161], v[170:173], v[208:211]
    v_cvt_pk_bf16_f32 v194, v196, v197
    v_cvt_pk_bf16_f32 v181, v198, v199
    v_mfma_f32_16x16x32_bf16 v[232:235], a[232:235], a[120:123], 0
    v_cvt_pk_bf16_f32 v31, v228, v229
    v_cvt_pk_bf16_f32 v34, v230, v231
    v_mfma_f32_16x16x32_bf16 v[232:235], a[236:239], a[124:127], v[232:235]
    ds_read_b128 a[232:235], v240 offset:1664
    ds_read_b128 a[236:239], v241 offset:1664
    v_mfma_f32_16x16x32_bf16 v[232:235], a[240:243], a[128:131], v[232:235]
    ds_read_b128 a[240:243], v240 offset:1792
    ds_read_b128 v[196:199], v246 offset:64
    v_mfma_f32_16x16x32_bf16 v[232:235], a[244:247], a[132:135], v[232:235]
    ds_read_b128 a[244:247], v241 offset:1792
    v_sub_f32 v200, v200, v248
    v_mfma_f32_16x16x32_bf16 v[232:235], a[216:219], a[136:139], v[232:235]
    ds_read_b128 a[216:219], v240 offset:3072
    s_waitcnt lgkmcnt(6)
    v_mfma_f32_16x16x32_bf16 v[232:235], a[220:223], a[140:143], v[232:235]
    buffer_load_dwordx4 v252, s[12:15], s62 offen lds
    ds_read_b128 a[220:223], v241 offset:3072
    v_mfma_f32_16x16x32_bf16 v[236:239], a[0:3], a[224:227], 0
    v_exp_f32 v200, v200
    v_mfma_f32_16x16x32_bf16 v[236:239], a[4:7], a[228:231], v[236:239]
    v_sub_f32 v201, v201, v248
    s_waitcnt vmcnt(1)
    v_mfma_f32_16x16x32_bf16 v[228:231], a[24:27], a[224:227], 0
    ds_read_b64_tr_b16 a[156:157], v249 offset:3072
    ds_read_b64_tr_b16 a[158:159], v250 offset:3072
    v_mfma_f32_16x16x32_bf16 v[228:231], a[28:31], a[228:231], v[228:231]
    s_waitcnt lgkmcnt(8)
    buffer_load_dwordx4 v253, s[12:15], s62 offen offset:1024 lds
    v_mfma_f32_16x16x32_bf16 v[236:239], a[8:11], a[232:235], v[236:239]
    ds_read_b64_tr_b16 a[180:181], v249 offset:3104
    ds_read_b64_tr_b16 a[182:183], v250 offset:3104
    v_mfma_f32_16x16x32_bf16 v[228:231], a[32:35], a[232:235], v[228:231]
    s_waitcnt lgkmcnt(8)
    ds_read_b64_tr_b16 a[204:205], v249 offset:3136
    v_mfma_f32_16x16x32_bf16 v[236:239], a[12:15], a[236:239], v[236:239]
    ds_read_b64_tr_b16 a[206:207], v250 offset:3136
    v_cvt_pk_bf16_f32 v61, v232, v233
    v_mfma_f32_16x16x32_bf16 v[236:239], a[16:19], a[240:243], v[236:239]
    buffer_load_dwordx4 v251, s[12:15], s62 offen offset:2048 lds
    s_add_u32 m0, s46, 0x17400
    v_mfma_f32_16x16x32_bf16 v[228:231], a[36:39], a[236:239], v[228:231]
    s_waitcnt lgkmcnt(7)
    v_cvt_pk_bf16_f32 v64, v234, v235
    v_sub_f32 v202, v202, v248
    v_mfma_f32_16x16x32_bf16 v[196:199], v[114:117], v[168:171], v[196:199]
    v_exp_f32 v201, v201
    v_mfma_f32_16x16x32_bf16 v[196:199], v[116:119], v[170:173], v[196:199]
    v_exp_f32 v202, v202
    v_mfma_f32_16x16x32_bf16 v[236:239], a[20:23], a[244:247], v[236:239]
    v_sub_f32 v203, v203, v248
    v_cvt_pk_bf16_f32 v192, v200, v201
    v_mfma_f32_16x16x32_bf16 v[228:231], a[40:43], a[240:243], v[228:231]
    v_exp_f32 v203, v203
    v_mfma_f32_16x16x32_bf16 v[228:231], a[44:47], a[244:247], v[228:231]
    v_cvt_pk_bf16_f32 v195, v202, v203
    v_sub_f32 v204, v204, v248
    v_mfma_f32_16x16x32_bf16 v[232:235], a[48:51], a[224:227], 0
    ds_read_b128 v[200:203], v244 offset:128
    s_waitcnt lgkmcnt(1)
    v_mfma_f32_16x16x32_bf16 v[212:215], v[12:15], v[192:195], 0
    buffer_load_dwordx4 v252, s[12:15], s63 offen lds
    v_sub_f32 v205, v205, v248
    v_mfma_f32_16x16x32_bf16 v[216:219], v[42:45], v[192:195], 0
    v_exp_f32 v204, v204
    v_mfma_f32_16x16x32_bf16 v[220:223], v[72:75], v[192:195], 0
    v_exp_f32 v205, v205
    v_mfma_f32_16x16x32_bf16 v[224:227], a[248:251], v[192:195], 0
    v_sub_f32 v206, v206, v248
    v_sub_f32 v207, v207, v248
    v_mfma_f32_16x16x32_bf16 v[232:235], a[52:55], a[228:231], v[232:235]
    buffer_load_dwordx4 v253, s[12:15], s63 offen offset:1024 lds
    v_cvt_pk_bf16_f32 v183, v204, v205
    v_mfma_f32_16x16x32_bf16 v[232:235], a[56:59], a[232:235], v[232:235]
    v_exp_f32 v206, v206
    v_mfma_f32_16x16x32_bf16 v[232:235], a[60:63], a[236:239], v[232:235]
    v_exp_f32 v207, v207
    v_mfma_f32_16x16x32_bf16 v[232:235], a[64:67], a[240:243], v[232:235]
    v_cvt_pk_bf16_f32 v186, v206, v207
    v_sub_f32 v208, v208, v248
    v_mfma_f32_16x16x32_bf16 v[232:235], a[68:71], a[244:247], v[232:235]
    s_waitcnt lgkmcnt(0)
    buffer_load_dwordx4 v251, s[12:15], s63 offen offset:2048 lds
    v_mfma_f32_16x16x32_bf16 v[200:203], v[90:93], v[168:171], v[200:203]
    ds_read_b128 v[204:207], v245 offset:128
    v_sub_f32 v209, v209, v248
    v_mfma_f32_16x16x32_bf16 v[200:203], v[92:95], v[170:173], v[200:203]
    v_exp_f32 v208, v208
    v_exp_f32 v209, v209
    v_sub_f32 v210, v210, v248
    v_exp_f32 v210, v210
    v_sub_f32 v211, v211, v248
    v_exp_f32 v211, v211
    v_cvt_pk_bf16_f32 v184, v208, v209
    v_cvt_pk_bf16_f32 v187, v210, v211
    ds_read_b128 v[208:211], v246 offset:128
    v_sub_f32 v196, v196, v248
    v_exp_f32 v196, v196
    v_sub_f32 v197, v197, v248
    v_exp_f32 v197, v197
    v_sub_f32 v198, v198, v248
    v_exp_f32 v198, v198
    v_sub_f32 v199, v199, v248
    v_exp_f32 v199, v199
    v_cvt_pk_bf16_f32 v182, v196, v197
    s_waitcnt lgkmcnt(1)
    v_mfma_f32_16x16x32_bf16 v[204:207], v[96:99], v[168:171], v[204:207]
    v_cvt_pk_bf16_f32 v185, v198, v199
    v_sub_f32 v200, v200, v248
    v_mfma_f32_16x16x32_bf16 v[212:215], v[16:19], v[180:183], v[212:215]
    ds_read_b128 v[196:199], v244 offset:32
    v_sub_f32 v201, v201, v248
    v_mfma_f32_16x16x32_bf16 v[216:219], v[46:49], v[180:183], v[216:219]
    v_exp_f32 v200, v200
    v_mfma_f32_16x16x32_bf16 v[220:223], v[76:79], v[180:183], v[220:223]
    v_exp_f32 v201, v201
    v_mfma_f32_16x16x32_bf16 v[224:227], a[248:251], v[180:183], v[224:227]
    s_waitcnt lgkmcnt(1)
    v_cvt_pk_bf16_f32 v189, v200, v201
    v_mfma_f32_16x16x32_bf16 v[212:215], v[20:23], v[184:187], v[212:215]
    ds_read_b128 v[200:203], v245 offset:32
    v_mfma_f32_16x16x32_bf16 v[216:219], v[50:53], v[184:187], v[216:219]
    v_mfma_f32_16x16x32_bf16 v[220:223], v[80:83], v[184:187], v[220:223]
    v_mfma_f32_16x16x32_bf16 v[224:227], a[248:251], v[184:187], v[224:227]
    v_mfma_f32_16x16x32_bf16 v[204:207], v[98:101], v[170:173], v[204:207]
    v_mfma_f32_16x16x32_bf16 v[208:211], v[120:123], v[168:171], v[208:211]
    ds_read_b64 v[168:169], v247 offset:24576
    s_waitcnt lgkmcnt(2)
    v_mfma_f32_16x16x32_bf16 v[208:211], v[122:125], v[170:173], v[208:211]
    ds_read_b64 v[170:171], v247 offset:24704
    ds_read_b64 v[172:173], v247 offset:24832
    v_mfma_f32_16x16x32_bf16 v[196:199], v[132:135], v[174:177], v[196:199]
    v_mfma_f32_16x16x32_bf16 v[196:199], v[134:137], v[176:179], v[196:199]
    v_sub_f32 v204, v204, v248
    s_waitcnt lgkmcnt(3)
    v_mfma_f32_16x16x32_bf16 v[200:203], v[156:159], v[174:177], v[200:203]
    v_exp_f32 v204, v204
    v_mfma_f32_16x16x32_bf16 v[200:203], v[158:161], v[176:179], v[200:203]
    v_sub_f32 v205, v205, v248
    v_exp_f32 v205, v205
    v_sub_f32 v208, v208, v248
    v_cvt_pk_bf16_f32 v190, v204, v205
    ds_read_b128 v[204:207], v246 offset:32
    v_exp_f32 v208, v208
    v_sub_f32 v209, v209, v248
    v_exp_f32 v209, v209
    v_max_f32 v248, v196, v197
    v_cvt_pk_bf16_f32 v188, v208, v209
    ds_read_b128 v[208:211], v244 offset:96
    v_max3_f32 v248, v248, v198, v199
    v_mfma_f32_16x16x32_bf16 v[212:215], v[24:27], v[188:191], v[212:215]
    ds_read_b128 v[196:199], v245 offset:96
    v_max3_f32 v248, v248, v200, v201
    v_mfma_f32_16x16x32_bf16 v[216:219], v[54:57], v[188:191], v[216:219]
    v_max3_f32 v248, v248, v202, v203
    v_mfma_f32_16x16x32_bf16 v[220:223], v[84:87], v[188:191], v[220:223]
    ds_read_b128 v[200:203], v246 offset:96
    v_mfma_f32_16x16x32_bf16 v[224:227], a[248:251], v[188:191], v[224:227]
    s_nop 7
    s_waitcnt vmcnt(3) lgkmcnt(3)
    v_mfma_f32_16x16x32_bf16 v[204:207], v[114:117], v[174:177], v[204:207]
    ds_read_b64_tr_b16 a[160:161], v249 offset:0
    ds_read_b64_tr_b16 a[162:163], v250 offset:0
    v_mfma_f32_16x16x32_bf16 v[204:207], v[116:119], v[176:179], v[204:207]
    ds_read_b64_tr_b16 a[184:185], v249 offset:32
    ds_read_b64_tr_b16 a[186:187], v250 offset:32
    s_waitcnt lgkmcnt(6)
    v_mfma_f32_16x16x32_bf16 v[208:211], v[90:93], v[174:177], v[208:211]
    ds_read_b64_tr_b16 a[208:209], v249 offset:64
    ds_read_b64_tr_b16 a[210:211], v250 offset:64
    v_mfma_f32_16x16x32_bf16 v[208:211], v[92:95], v[176:179], v[208:211]
    s_waitcnt lgkmcnt(7)
    v_rcp_f32 v225, v224
    v_mfma_f32_16x16x32_bf16 v[196:199], v[96:99], v[174:177], v[196:199]
    v_mul_f32 v212, v212, v225
    v_mul_f32 v213, v213, v225
    v_mfma_f32_16x16x32_bf16 v[196:199], v[98:101], v[176:179], v[196:199]
    s_waitcnt lgkmcnt(6)
    v_mul_f32 v214, v214, v225
    v_mul_f32 v215, v215, v225
    v_mfma_f32_16x16x32_bf16 v[200:203], v[120:123], v[174:177], v[200:203]
    v_cvt_pk_bf16_f32 v212, v212, v213
    v_cvt_pk_bf16_f32 v213, v214, v215
    v_mfma_f32_16x16x32_bf16 v[200:203], v[122:125], v[176:179], v[200:203]
    ds_write_b64 v247, v[212:213] offset:18432
    v_mul_f32 v216, v216, v225
    v_mul_f32 v217, v217, v225
    v_mul_f32 v218, v218, v225
    v_mul_f32 v219, v219, v225
    v_cvt_pk_bf16_f32 v216, v216, v217
    v_cvt_pk_bf16_f32 v217, v218, v219
    ds_write_b64 v247, v[216:217] offset:18560
    v_mul_f32 v220, v220, v225
    v_mul_f32 v221, v221, v225
    v_mul_f32 v222, v222, v225
    v_mul_f32 v223, v223, v225
    v_cvt_pk_bf16_f32 v220, v220, v221
    v_cvt_pk_bf16_f32 v221, v222, v223
    ds_write_b64 v247, v[220:221] offset:18688
    v_max3_f32 v248, v248, v204, v205
    v_max3_f32 v248, v248, v206, v207
    ds_read_b128 v[204:207], v244 offset:32
    s_waitcnt vmcnt(0)
    ds_read_b64_tr_b16 a[164:165], v249 offset:3072
    ds_read_b64_tr_b16 a[166:167], v250 offset:3072
    ds_read_b64_tr_b16 a[188:189], v249 offset:3104
    ds_read_b64_tr_b16 a[190:191], v250 offset:3104
    ds_read_b64_tr_b16 a[212:213], v249 offset:3136
    ds_read_b64_tr_b16 a[214:215], v250 offset:3136
    v_mul_i32_i24 v250, s31, v255
    v_add_u32 v250, s55, v250
    v_lshl_add_u32 v251, v254, 3, v250
    v_lshlrev_b32 v255, 3, v255
    v_and_b32 v255, 8, v255
    v_xor_b32 v254, v254, v255
    v_lshl_add_u32 v250, v254, 4, v250
    s_mul_i32 s55, s31, -8
    s_add_u32 s54, s54, s55
    s_add_u32 s55, s28, 11
    s_mul_i32 s55, s55, s30
    v_max3_f32 v248, v248, v208, v209
    v_max3_f32 v248, v248, v210, v211
    ds_read_b128 v[208:211], v245 offset:32
    v_max3_f32 v248, v248, v196, v197
    v_max3_f32 v248, v248, v198, v199
    ds_read_b128 v[196:199], v246 offset:32
    v_max3_f32 v248, v248, v200, v201
    s_waitcnt lgkmcnt(8)
    v_mfma_f32_16x16x32_bf16 v[204:207], v[132:135], v[174:177], v[204:207]
    v_cvt_pk_bf16_f32 v132, v236, v237
    v_cvt_pk_bf16_f32 v133, v238, v239
    v_mfma_f32_16x16x32_bf16 v[204:207], v[134:137], v[176:179], v[204:207]
    v_cvt_pk_bf16_f32 v134, v228, v229
    v_cvt_pk_bf16_f32 v135, v230, v231
    v_mfma_f32_16x16x32_bf16 v[236:239], a[224:227], a[72:75], 0
    v_cvt_pk_bf16_f32 v136, v232, v233
    v_cvt_pk_bf16_f32 v137, v234, v235
    v_mfma_f32_16x16x32_bf16 v[236:239], a[228:231], a[76:79], v[236:239]
    s_waitcnt lgkmcnt(2)
    s_barrier
    v_max3_f32 v248, v248, v202, v203
    v_mfma_f32_16x16x32_bf16 v[236:239], a[232:235], a[80:83], v[236:239]
    ds_read_b128 v[200:203], v244 offset:96
    v_mov_b32 v225, v248
    v_mfma_f32_16x16x32_bf16 v[236:239], a[236:239], a[84:87], v[236:239]
    v_mfma_f32_16x16x32_bf16 v[236:239], a[240:243], a[88:91], v[236:239]
    s_waitcnt lgkmcnt(2)
    v_permlane16_swap_b32 v248, v225
    v_max_f32 v248, v248, v225
    v_mfma_f32_16x16x32_bf16 v[208:211], v[156:159], v[174:177], v[208:211]
    s_waitcnt lgkmcnt(1)
    v_mov_b32 v225, v248
    v_mfma_f32_16x16x32_bf16 v[208:211], v[158:161], v[176:179], v[208:211]
    v_mfma_f32_16x16x32_bf16 v[196:199], v[114:117], v[174:177], v[196:199]
    v_permlane32_swap_b32 v248, v225
    v_max_f32 v248, v248, v225
    v_mfma_f32_16x16x32_bf16 v[196:199], v[116:119], v[176:179], v[196:199]
    v_sub_f32 v204, v204, v248
    v_sub_f32 v205, v205, v248
    v_mfma_f32_16x16x32_bf16 v[236:239], a[244:247], a[92:95], v[236:239]
    v_exp_f32 v204, v204
    v_mfma_f32_16x16x32_bf16 v[228:231], a[224:227], a[96:99], 0
    v_exp_f32 v205, v205
    v_mfma_f32_16x16x32_bf16 v[228:231], a[228:231], a[100:103], v[228:231]
    s_waitcnt lgkmcnt(0)
    v_sub_f32 v206, v206, v248
    v_sub_f32 v207, v207, v248
    v_mfma_f32_16x16x32_bf16 v[200:203], v[90:93], v[174:177], v[200:203]
    v_cvt_pk_bf16_f32 v7, v236, v237
    v_cvt_pk_bf16_f32 v10, v238, v239
    v_mfma_f32_16x16x32_bf16 v[200:203], v[92:95], v[176:179], v[200:203]
    v_exp_f32 v206, v206
    v_mfma_f32_16x16x32_bf16 v[228:231], a[232:235], a[104:107], v[228:231]
    v_exp_f32 v207, v207
    v_mfma_f32_16x16x32_bf16 v[228:231], a[236:239], a[108:111], v[228:231]
    v_cvt_pk_bf16_f32 v193, v204, v205
    v_cvt_pk_bf16_f32 v180, v206, v207
    v_mfma_f32_16x16x32_bf16 v[228:231], a[240:243], a[112:115], v[228:231]
    ds_read_b128 v[204:207], v245 offset:96
    v_sub_f32 v208, v208, v248
    v_mfma_f32_16x16x32_bf16 v[228:231], a[244:247], a[116:119], v[228:231]
    v_exp_f32 v208, v208
    v_mfma_f32_16x16x32_bf16 v[232:235], a[224:227], a[120:123], 0
    ds_read_b128 a[224:227], v240 offset:3200
    v_sub_f32 v209, v209, v248
    v_mfma_f32_16x16x32_bf16 v[232:235], a[228:231], a[124:127], v[232:235]
    ds_read_b128 a[228:231], v241 offset:3200
    v_sub_f32 v210, v210, v248
    v_mfma_f32_16x16x32_bf16 v[232:235], a[232:235], a[128:131], v[232:235]
    v_cvt_pk_bf16_f32 v37, v228, v229
    v_cvt_pk_bf16_f32 v40, v230, v231
    v_mfma_f32_16x16x32_bf16 v[232:235], a[236:239], a[132:135], v[232:235]
    ds_read_b128 a[232:235], v240 offset:3328
    ds_read_b128 a[236:239], v241 offset:3328
    v_mfma_f32_16x16x32_bf16 v[232:235], a[240:243], a[136:139], v[232:235]
    ds_read_b128 a[240:243], v240 offset:4608
    v_sub_f32 v211, v211, v248
    v_mfma_f32_16x16x32_bf16 v[232:235], a[244:247], a[140:143], v[232:235]
    ds_read_b128 a[244:247], v241 offset:4608
    v_sub_f32 v196, v196, v248
    v_mfma_f32_16x16x32_bf16 v[236:239], a[0:3], a[216:219], 0
    v_exp_f32 v209, v209
    v_mfma_f32_16x16x32_bf16 v[236:239], a[4:7], a[220:223], v[236:239]
    s_waitcnt lgkmcnt(6)
    v_exp_f32 v210, v210
    v_mfma_f32_16x16x32_bf16 v[204:207], v[96:99], v[174:177], v[204:207]
    v_cvt_pk_bf16_f32 v67, v232, v233
    v_cvt_pk_bf16_f32 v70, v234, v235
    v_mfma_f32_16x16x32_bf16 v[204:207], v[98:101], v[176:179], v[204:207]
    s_waitcnt lgkmcnt(5)
    v_exp_f32 v211, v211
    v_mfma_f32_16x16x32_bf16 v[236:239], a[8:11], a[224:227], v[236:239]
    s_waitcnt lgkmcnt(4)
    v_cvt_pk_bf16_f32 v194, v208, v209
    v_cvt_pk_bf16_f32 v181, v210, v211
    v_mfma_f32_16x16x32_bf16 v[236:239], a[12:15], a[228:231], v[236:239]
    ds_read_b128 v[208:211], v246 offset:96
    v_sub_f32 v197, v197, v248
    v_mfma_f32_16x16x32_bf16 v[228:231], a[24:27], a[216:219], 0
    s_waitcnt lgkmcnt(4)
    v_exp_f32 v196, v196
    v_mfma_f32_16x16x32_bf16 v[236:239], a[16:19], a[232:235], v[236:239]
    s_waitcnt lgkmcnt(3)
    v_exp_f32 v197, v197
    v_mfma_f32_16x16x32_bf16 v[236:239], a[20:23], a[236:239], v[236:239]
    v_sub_f32 v198, v198, v248
    v_sub_f32 v199, v199, v248
    v_mfma_f32_16x16x32_bf16 v[228:231], a[28:31], a[220:223], v[228:231]
    v_exp_f32 v198, v198
    v_mfma_f32_16x16x32_bf16 v[228:231], a[32:35], a[224:227], v[228:231]
    v_exp_f32 v199, v199
    v_mfma_f32_16x16x32_bf16 v[228:231], a[36:39], a[228:231], v[228:231]
    v_cvt_pk_bf16_f32 v192, v196, v197
    v_cvt_pk_bf16_f32 v90, v236, v237
    v_mfma_f32_16x16x32_bf16 v[228:231], a[40:43], a[232:235], v[228:231]
    v_cvt_pk_bf16_f32 v91, v238, v239
    v_cvt_pk_bf16_f32 v195, v198, v199
    v_mfma_f32_16x16x32_bf16 v[228:231], a[44:47], a[236:239], v[228:231]
    ds_read_b128 v[196:199], v244 offset:192
    v_sub_f32 v200, v200, v248
    v_mfma_f32_16x16x32_bf16 v[212:215], v[18:21], v[192:195], 0
    s_waitcnt lgkmcnt(1)
    v_exp_f32 v200, v200
    v_mfma_f32_16x16x32_bf16 v[216:219], v[48:51], v[192:195], 0
    v_sub_f32 v201, v201, v248
    v_sub_f32 v202, v202, v248
    v_mfma_f32_16x16x32_bf16 v[220:223], v[78:81], v[192:195], 0
    v_cvt_pk_bf16_f32 v92, v228, v229
    v_cvt_pk_bf16_f32 v93, v230, v231
    v_mfma_f32_16x16x32_bf16 v[224:227], a[248:251], v[192:195], 0
    v_exp_f32 v201, v201
    v_mfma_f32_16x16x32_bf16 v[208:211], v[120:123], v[174:177], v[208:211]
    ds_read_b64 v[174:175], v247 offset:30720
    v_sub_f32 v203, v203, v248
    v_mfma_f32_16x16x32_bf16 v[208:211], v[122:125], v[176:179], v[208:211]
    ds_read_b64 v[176:177], v247 offset:30848
    ds_read_b64 v[178:179], v247 offset:30976
    v_mfma_f32_16x16x32_bf16 v[232:235], a[48:51], a[216:219], 0
    v_exp_f32 v202, v202
    v_mfma_f32_16x16x32_bf16 v[232:235], a[52:55], a[220:223], v[232:235]
    v_exp_f32 v203, v203
    v_mfma_f32_16x16x32_bf16 v[232:235], a[56:59], a[224:227], v[232:235]
    s_waitcnt lgkmcnt(3)
    v_cvt_pk_bf16_f32 v183, v200, v201
    v_cvt_pk_bf16_f32 v186, v202, v203
    v_mfma_f32_16x16x32_bf16 v[196:199], v[138:141], v[168:171], v[196:199]
    ds_read_b128 v[200:203], v245 offset:192
    v_sub_f32 v204, v204, v248
    v_mfma_f32_16x16x32_bf16 v[196:199], v[140:143], v[170:173], v[196:199]
    v_exp_f32 v204, v204
    v_mfma_f32_16x16x32_bf16 v[232:235], a[60:63], a[228:231], v[232:235]
    v_sub_f32 v205, v205, v248
    v_sub_f32 v206, v206, v248
    v_mfma_f32_16x16x32_bf16 v[232:235], a[64:67], a[232:235], v[232:235]
    v_exp_f32 v205, v205
    v_mfma_f32_16x16x32_bf16 v[232:235], a[68:71], a[236:239], v[232:235]
    v_exp_f32 v206, v206
    v_mfma_f32_16x16x32_bf16 v[236:239], a[216:219], a[72:75], 0
    v_sub_f32 v207, v207, v248
    v_cvt_pk_bf16_f32 v184, v204, v205
    v_mfma_f32_16x16x32_bf16 v[236:239], a[220:223], a[76:79], v[236:239]
    v_exp_f32 v207, v207
    v_mfma_f32_16x16x32_bf16 v[236:239], a[224:227], a[80:83], v[236:239]
    v_cvt_pk_bf16_f32 v187, v206, v207
    v_cvt_pk_bf16_f32 v94, v232, v233
    v_mfma_f32_16x16x32_bf16 v[236:239], a[228:231], a[84:87], v[236:239]
    ds_read_b128 v[204:207], v246 offset:192
    v_cvt_pk_bf16_f32 v95, v234, v235
    v_mfma_f32_16x16x32_bf16 v[236:239], a[232:235], a[88:91], v[236:239]
    s_waitcnt lgkmcnt(1)
    v_sub_f32 v208, v208, v248
    v_sub_f32 v209, v209, v248
    v_mfma_f32_16x16x32_bf16 v[200:203], v[102:105], v[168:171], v[200:203]
    v_exp_f32 v208, v208
    v_mfma_f32_16x16x32_bf16 v[200:203], v[104:107], v[170:173], v[200:203]
    v_exp_f32 v209, v209
    v_mfma_f32_16x16x32_bf16 v[236:239], a[236:239], a[92:95], v[236:239]
    v_sub_f32 v210, v210, v248
    v_sub_f32 v211, v211, v248
    v_mfma_f32_16x16x32_bf16 v[228:231], a[216:219], a[96:99], 0
    v_exp_f32 v210, v210
    v_mfma_f32_16x16x32_bf16 v[228:231], a[220:223], a[100:103], v[228:231]
    v_exp_f32 v211, v211
    v_mfma_f32_16x16x32_bf16 v[228:231], a[224:227], a[104:107], v[228:231]
    v_cvt_pk_bf16_f32 v182, v208, v209
    v_cvt_pk_bf16_f32 v13, v236, v237
    v_mfma_f32_16x16x32_bf16 v[228:231], a[228:231], a[108:111], v[228:231]
    v_cvt_pk_bf16_f32 v16, v238, v239
    v_cvt_pk_bf16_f32 v185, v210, v211
    v_mfma_f32_16x16x32_bf16 v[212:215], v[22:25], v[180:183], v[212:215]
    ds_read_b128 v[208:211], v244 offset:256
    v_max_f32 v248, v196, v197
    v_mfma_f32_16x16x32_bf16 v[216:219], v[52:55], v[180:183], v[216:219]
    s_waitcnt lgkmcnt(1)
    v_max3_f32 v248, v248, v198, v199
    v_max3_f32 v248, v248, v200, v201
    v_mfma_f32_16x16x32_bf16 v[220:223], v[82:85], v[180:183], v[220:223]
    ds_read_b128 v[196:199], v245 offset:256
    v_max3_f32 v248, v248, v202, v203
    v_mfma_f32_16x16x32_bf16 v[224:227], a[248:251], v[180:183], v[224:227]
    ds_read_b128 v[200:203], v246 offset:256
    v_mfma_f32_16x16x32_bf16 v[212:215], v[26:29], v[184:187], v[212:215]
    v_mfma_f32_16x16x32_bf16 v[216:219], v[56:59], v[184:187], v[216:219]
    v_mfma_f32_16x16x32_bf16 v[220:223], v[86:89], v[184:187], v[220:223]
    v_mfma_f32_16x16x32_bf16 v[224:227], a[248:251], v[184:187], v[224:227]
    v_mov_b32 v187, 0
    v_mfma_f32_16x16x32_bf16 v[204:207], v[126:129], v[168:171], v[204:207]
    v_mfma_f32_16x16x32_bf16 v[204:207], v[128:131], v[170:173], v[204:207]
    s_waitcnt lgkmcnt(2)
    v_mfma_f32_16x16x32_bf16 v[208:211], v[144:147], v[168:171], v[208:211]
    v_mfma_f32_16x16x32_bf16 v[208:211], v[146:149], v[170:173], v[208:211]
    s_waitcnt lgkmcnt(1)
    s_waitcnt lgkmcnt(0)
    v_mbcnt_lo_u32_b32 v226, -1, 0
    v_mfma_f32_16x16x32_bf16 v[196:199], v[108:111], v[168:171], v[196:199]
    v_rcp_f32 v225, v224
    v_mfma_f32_16x16x32_bf16 v[196:199], v[110:113], v[170:173], v[196:199]
    v_mbcnt_hi_u32_b32 v226, -1, v226
    v_and_b32 v226, 2, v226
    v_mfma_f32_16x16x32_bf16 v[200:203], v[132:135], v[168:171], v[200:203]
    v_cmp_eq_u32 vcc, 2, v226
    v_add_u32 v226, 0xfffdd200, v247
    v_mfma_f32_16x16x32_bf16 v[200:203], v[134:137], v[170:173], v[200:203]
    v_cndmask_b32 v226, 0, v226, vcc
    v_add_u32 v226, 0x22e00, v226
    v_mfma_f32_16x16x32_bf16 v[228:231], a[232:235], a[112:115], v[228:231]
    v_mul_f32 v212, v212, v225
    v_mul_f32 v213, v213, v225
    v_mfma_f32_16x16x32_bf16 v[228:231], a[236:239], a[116:119], v[228:231]
    v_mul_f32 v214, v214, v225
    v_mul_f32 v215, v215, v225
    v_mfma_f32_16x16x32_bf16 v[232:235], a[216:219], a[120:123], 0
    ds_read_b128 a[216:219], v240 offset:4736
    v_cvt_pk_bf16_f32 v212, v212, v213
    v_mfma_f32_16x16x32_bf16 v[232:235], a[220:223], a[124:127], v[232:235]
    ds_read_b128 a[220:223], v241 offset:4736
    v_cvt_pk_bf16_f32 v213, v214, v215
    v_mfma_f32_16x16x32_bf16 v[232:235], a[224:227], a[128:131], v[232:235]
    v_cvt_pk_bf16_f32 v43, v228, v229
    v_cvt_pk_bf16_f32 v46, v230, v231
    v_mfma_f32_16x16x32_bf16 v[232:235], a[228:231], a[132:135], v[232:235]
    ds_read_b128 a[224:227], v240 offset:4864
    ds_read_b128 a[228:231], v241 offset:4864
    v_mfma_f32_16x16x32_bf16 v[232:235], a[232:235], a[136:139], v[232:235]
    ds_write_b64 v226, v[212:213] offset:0
    v_mfma_f32_16x16x32_bf16 v[232:235], a[236:239], a[140:143], v[232:235]
    v_mul_f32 v216, v216, v225
    v_mul_f32 v217, v217, v225
    v_mfma_f32_16x16x32_bf16 v[236:239], a[0:3], a[240:243], 0
    v_mul_f32 v218, v218, v225
    v_mul_f32 v219, v219, v225
    v_mfma_f32_16x16x32_bf16 v[236:239], a[4:7], a[244:247], v[236:239]
    v_cvt_pk_bf16_f32 v216, v216, v217
    v_cvt_pk_bf16_f32 v217, v218, v219
    v_mfma_f32_16x16x32_bf16 v[228:231], a[24:27], a[240:243], 0
    s_waitcnt lgkmcnt(4)
    v_cvt_pk_bf16_f32 v73, v232, v233
    v_cvt_pk_bf16_f32 v76, v234, v235
    v_mfma_f32_16x16x32_bf16 v[236:239], a[8:11], a[216:219], v[236:239]
    ds_write_b64 v226, v[216:217] offset:128
    v_mfma_f32_16x16x32_bf16 v[228:231], a[28:31], a[244:247], v[228:231]
    s_waitcnt lgkmcnt(4)
    v_mul_f32 v220, v220, v225
    v_mul_f32 v221, v221, v225
    v_mfma_f32_16x16x32_bf16 v[236:239], a[12:15], a[220:223], v[236:239]
    s_waitcnt lgkmcnt(3)
    v_mul_f32 v222, v222, v225
    v_mul_f32 v223, v223, v225
    v_mfma_f32_16x16x32_bf16 v[236:239], a[16:19], a[224:227], v[236:239]
    s_waitcnt lgkmcnt(2)
    v_cvt_pk_bf16_f32 v220, v220, v221
    v_cvt_pk_bf16_f32 v221, v222, v223
    v_mfma_f32_16x16x32_bf16 v[236:239], a[20:23], a[228:231], v[236:239]
    ds_write_b64 v226, v[220:221] offset:256
    v_mfma_f32_16x16x32_bf16 v[228:231], a[32:35], a[216:219], v[228:231]
    v_max3_f32 v248, v248, v204, v205
    v_max3_f32 v248, v248, v206, v207
    v_mfma_f32_16x16x32_bf16 v[228:231], a[36:39], a[220:223], v[228:231]
    ds_read_b128 v[204:207], v244 offset:320
    v_max3_f32 v248, v248, v208, v209
    v_mfma_f32_16x16x32_bf16 v[228:231], a[40:43], a[224:227], v[228:231]
    v_max3_f32 v248, v248, v210, v211
    v_max3_f32 v248, v248, v196, v197
    v_mfma_f32_16x16x32_bf16 v[228:231], a[44:47], a[228:231], v[228:231]
    ds_read_b128 v[208:211], v245 offset:320
    v_max3_f32 v248, v248, v198, v199
    v_mfma_f32_16x16x32_bf16 v[232:235], a[48:51], a[240:243], 0
    ds_read_b128 v[196:199], v246 offset:320
    v_max3_f32 v248, v248, v200, v201
    v_mfma_f32_16x16x32_bf16 v[232:235], a[52:55], a[244:247], v[232:235]
    v_max3_f32 v248, v248, v202, v203
    v_mfma_f32_16x16x32_bf16 v[232:235], a[56:59], a[216:219], v[232:235]
    ds_read_b128 v[200:203], v244 offset:192
    v_mfma_f32_16x16x32_bf16 v[232:235], a[60:63], a[220:223], v[232:235]
    v_mfma_f32_16x16x32_bf16 v[232:235], a[64:67], a[224:227], v[232:235]
    v_mfma_f32_16x16x32_bf16 v[232:235], a[68:71], a[228:231], v[232:235]
    s_waitcnt lgkmcnt(3)
    v_mfma_f32_16x16x32_bf16 v[204:207], v[150:153], v[168:171], v[204:207]
    v_mfma_f32_16x16x32_bf16 v[204:207], v[152:155], v[170:173], v[204:207]
    s_nop 7
    s_waitcnt lgkmcnt(1)
    v_mfma_f32_16x16x32_bf16 v[208:211], v[162:165], v[168:171], v[208:211]
    v_max3_f32 v248, v248, v204, v205
    v_mfma_f32_16x16x32_bf16 v[208:211], v[164:167], v[170:173], v[208:211]
    ds_read_b128 v[204:207], v245 offset:192
    s_waitcnt lgkmcnt(1)
    v_mfma_f32_16x16x32_bf16 v[196:199], v[90:93], v[168:171], v[196:199]
    v_mfma_f32_16x16x32_bf16 v[196:199], v[92:95], v[170:173], v[196:199]
    v_mfma_f32_16x16x32_bf16 v[200:203], v[138:141], v[168:171], v[200:203]
    v_cvt_pk_bf16_f32 v138, v236, v237
    v_cvt_pk_bf16_f32 v139, v238, v239
    v_mfma_f32_16x16x32_bf16 v[200:203], v[140:143], v[170:173], v[200:203]
    v_cvt_pk_bf16_f32 v140, v228, v229
    v_cvt_pk_bf16_f32 v141, v230, v231
    v_mfma_f32_16x16x32_bf16 v[236:239], a[240:243], a[72:75], 0
    v_cvt_pk_bf16_f32 v142, v232, v233
    v_cvt_pk_bf16_f32 v143, v234, v235
    v_mfma_f32_16x16x32_bf16 v[236:239], a[244:247], a[76:79], v[236:239]
    v_max3_f32 v248, v248, v208, v209
    v_max3_f32 v248, v248, v196, v197
    v_mfma_f32_16x16x32_bf16 v[236:239], a[216:219], a[80:83], v[236:239]
    ds_read_b128 v[208:211], v246 offset:192
    ds_read_b128 v[196:199], v244 offset:256
    v_mfma_f32_16x16x32_bf16 v[236:239], a[220:223], a[84:87], v[236:239]
    v_mov_b32 v225, v248
    s_waitcnt lgkmcnt(2)
    v_mfma_f32_16x16x32_bf16 v[204:207], v[102:105], v[168:171], v[204:207]
    v_permlane16_swap_b32 v248, v225
    v_max_f32 v248, v248, v225
    v_mfma_f32_16x16x32_bf16 v[204:207], v[104:107], v[170:173], v[204:207]
    v_mov_b32 v225, v248
    v_mfma_f32_16x16x32_bf16 v[236:239], a[224:227], a[88:91], v[236:239]
    v_mfma_f32_16x16x32_bf16 v[236:239], a[228:231], a[92:95], v[236:239]
    v_permlane32_swap_b32 v248, v225
    v_max_f32 v248, v248, v225
    v_mfma_f32_16x16x32_bf16 v[228:231], a[240:243], a[96:99], 0
    v_sub_f32 v200, v200, v248
    v_sub_f32 v201, v201, v248
    v_mfma_f32_16x16x32_bf16 v[228:231], a[244:247], a[100:103], v[228:231]
    v_exp_f32 v200, v200
    v_mfma_f32_16x16x32_bf16 v[228:231], a[216:219], a[104:107], v[228:231]
    v_cvt_pk_bf16_f32 v19, v236, v237
    v_cvt_pk_bf16_f32 v22, v238, v239
    v_mfma_f32_16x16x32_bf16 v[228:231], a[220:223], a[108:111], v[228:231]
    s_waitcnt lgkmcnt(1)
    v_mbcnt_lo_u32_b32 v236, -1, 0
    v_mbcnt_hi_u32_b32 v236, -1, v236
    v_mfma_f32_16x16x32_bf16 v[208:211], v[126:129], v[168:171], v[208:211]
    s_waitcnt lgkmcnt(0)
    v_and_b32 v237, 15, v236
    v_lshrrev_b32 v236, 4, v236
    v_mfma_f32_16x16x32_bf16 v[208:211], v[128:131], v[170:173], v[208:211]
    v_lshrrev_b32 v238, 1, v237
    v_mul_u32_u24 v239, 0x180, v237
    v_mfma_f32_16x16x32_bf16 v[196:199], v[144:147], v[168:171], v[196:199]
    v_xor_b32 v243, v236, v238
    v_lshl_add_u32 v242, v243, 4, v239
    v_mfma_f32_16x16x32_bf16 v[196:199], v[146:149], v[170:173], v[196:199]
    v_xor_b32 v243, 64, v242
    v_add_u32 v242, 0x1e000, v242
    v_mfma_f32_16x16x32_bf16 v[228:231], a[224:227], a[112:115], v[228:231]
    ds_read_b128 a[232:235], v242 offset:0
    v_add_u32 v243, 0x1e000, v243
    v_mfma_f32_16x16x32_bf16 v[228:231], a[228:231], a[116:119], v[228:231]
    ds_read_b128 a[236:239], v243 offset:0
    v_lshrrev_b32 v249, 1, v236
    v_mfma_f32_16x16x32_bf16 v[232:235], a[240:243], a[120:123], 0
    ds_read_b128 a[240:243], v242 offset:128
    v_or_b32 v249, s66, v249
    v_mfma_f32_16x16x32_bf16 v[232:235], a[244:247], a[124:127], v[232:235]
    ds_read_b128 a[244:247], v243 offset:128
    v_mov_b32 v253, v249
    v_mfma_f32_16x16x32_bf16 v[232:235], a[216:219], a[128:131], v[232:235]
    v_cvt_pk_bf16_f32 v49, v228, v229
    v_cvt_pk_bf16_f32 v52, v230, v231
    v_mfma_f32_16x16x32_bf16 v[232:235], a[220:223], a[132:135], v[232:235]
    ds_read_b128 a[216:219], v242 offset:256
    ds_read_b128 a[220:223], v243 offset:256
    v_mfma_f32_16x16x32_bf16 v[232:235], a[224:227], a[136:139], v[232:235]
    ds_read_b128 a[224:227], v242 offset:6144
    v_xor_b32 v249, v249, v238
    v_mfma_f32_16x16x32_bf16 v[232:235], a[228:231], a[140:143], v[232:235]
    ds_read_b128 a[228:231], v243 offset:6144
    v_lshl_add_u32 v249, v249, 4, v239
    v_and_b32 v239, 1, v236
    v_lshl_add_u32 v249, v239, 3, v249
    s_waitcnt lgkmcnt(7)
    v_mfma_f32_16x16x32_bf16 v[228:231], a[144:147], a[232:235], 0
    v_add_u32 v249, 0x16800, v249
    s_waitcnt lgkmcnt(6)
    v_mfma_f32_16x16x32_bf16 v[228:231], a[148:151], a[236:239], v[228:231]
    v_cvt_pk_bf16_f32 v79, v232, v233
    s_waitcnt lgkmcnt(5)
    v_mfma_f32_16x16x32_bf16 v[228:231], a[152:155], a[240:243], v[228:231]
    v_cvt_pk_bf16_f32 v82, v234, v235
    v_mul_u32_u24 v236, 0x180, v236
    v_mfma_f32_16x16x32_bf16 v[232:235], a[168:171], a[232:235], 0
    s_waitcnt lgkmcnt(4)
    v_add_u32 v236, s67, v236
    v_lshlrev_b32 v239, 3, v239
    v_mfma_f32_16x16x32_bf16 v[228:231], a[156:159], a[244:247], v[228:231]
    v_xor_b32 v252, v237, v239
    v_xor_b32 v252, v252, v253
    v_mfma_f32_16x16x32_bf16 v[232:235], a[172:175], a[236:239], v[232:235]
    s_waitcnt lgkmcnt(3)
    v_lshl_add_u32 v252, v252, 4, v236
    v_add_u32 v252, 0x16800, v252
    v_mfma_f32_16x16x32_bf16 v[228:231], a[160:163], a[216:219], v[228:231]
    s_waitcnt lgkmcnt(2)
    v_xor_b32 v253, v253, v238
    v_lshl_add_u32 v253, v253, 4, v236
    v_mfma_f32_16x16x32_bf16 v[228:231], a[164:167], a[220:223], v[228:231]
    v_and_b32 v237, 1, v237
    v_lshl_add_u32 v253, v237, 3, v253
    v_mfma_f32_16x16x32_bf16 v[232:235], a[176:179], a[240:243], v[232:235]
    v_add_u32 v253, 0x16800, v253
    v_sub_f32 v202, v202, v248
    v_mfma_f32_16x16x32_bf16 v[232:235], a[180:183], a[244:247], v[232:235]
    v_exp_f32 v201, v201
    v_mfma_f32_16x16x32_bf16 v[232:235], a[184:187], a[216:219], v[232:235]
    v_cvt_pk_bf16_f32 v228, v228, v229
    v_cvt_pk_bf16_f32 v229, v230, v231
    v_mfma_f32_16x16x32_bf16 v[232:235], a[188:191], a[220:223], v[232:235]
    ds_write_b64 v249, v[228:229] offset:0
    v_mfma_f32_16x16x32_bf16 v[236:239], a[192:195], a[232:235], 0
    ds_read_b128 a[232:235], v242 offset:6272
    v_sub_f32 v203, v203, v248
    v_mfma_f32_16x16x32_bf16 v[236:239], a[196:199], a[236:239], v[236:239]
    ds_read_b128 a[236:239], v243 offset:6272
    v_cvt_pk_bf16_f32 v190, v200, v201
    v_mfma_f32_16x16x32_bf16 v[236:239], a[200:203], a[240:243], v[236:239]
    ds_read_b128 a[240:243], v242 offset:6400
    v_cvt_pk_bf16_f32 v232, v232, v233
    v_mfma_f32_16x16x32_bf16 v[236:239], a[204:207], a[244:247], v[236:239]
    ds_read_b128 a[244:247], v243 offset:6400
    v_cvt_pk_bf16_f32 v233, v234, v235
    v_mfma_f32_16x16x32_bf16 v[236:239], a[208:211], a[216:219], v[236:239]
    ds_write_b64 v249, v[232:233] offset:128
    v_mfma_f32_16x16x32_bf16 v[236:239], a[212:215], a[220:223], v[236:239]
    s_waitcnt lgkmcnt(6)
    ds_read_b128 a[216:219], v242 offset:12288
    v_mfma_f32_16x16x32_bf16 v[228:231], a[144:147], a[224:227], 0
    ds_read_b128 a[220:223], v243 offset:12288
    v_sub_f32 v204, v204, v248
    v_mfma_f32_16x16x32_bf16 v[228:231], a[148:151], a[228:231], v[228:231]
    v_exp_f32 v202, v202
    v_mfma_f32_16x16x32_bf16 v[232:235], a[168:171], a[224:227], 0
    s_waitcnt lgkmcnt(6)
    v_cvt_pk_bf16_f32 v236, v236, v237
    v_cvt_pk_bf16_f32 v237, v238, v239
    v_mfma_f32_16x16x32_bf16 v[228:231], a[152:155], a[232:235], v[228:231]
    ds_write_b64 v249, v[236:237] offset:256
    v_mfma_f32_16x16x32_bf16 v[232:235], a[172:175], a[228:231], v[232:235]
    s_waitcnt lgkmcnt(5)
    v_exp_f32 v203, v203
    v_mfma_f32_16x16x32_bf16 v[228:231], a[156:159], a[236:239], v[228:231]
    v_cvt_pk_bf16_f32 v193, v202, v203
    v_sub_f32 v205, v205, v248
    v_mfma_f32_16x16x32_bf16 v[228:231], a[160:163], a[240:243], v[228:231]
    ds_read_b128 v[200:203], v245 offset:256
    v_sub_f32 v206, v206, v248
    v_mfma_f32_16x16x32_bf16 v[232:235], a[176:179], a[232:235], v[232:235]
    s_waitcnt lgkmcnt(4)
    v_exp_f32 v204, v204
    v_mfma_f32_16x16x32_bf16 v[228:231], a[164:167], a[244:247], v[228:231]
    v_exp_f32 v205, v205
    v_mfma_f32_16x16x32_bf16 v[232:235], a[180:183], a[236:239], v[232:235]
    v_exp_f32 v206, v206
    v_mfma_f32_16x16x32_bf16 v[232:235], a[184:187], a[240:243], v[232:235]
    v_sub_f32 v207, v207, v248
    v_cvt_pk_bf16_f32 v188, v204, v205
    v_mfma_f32_16x16x32_bf16 v[232:235], a[188:191], a[244:247], v[232:235]
    v_exp_f32 v207, v207
    v_mfma_f32_16x16x32_bf16 v[236:239], a[192:195], a[224:227], 0
    ds_read_b128 a[224:227], v242 offset:12416
    v_cvt_pk_bf16_f32 v228, v228, v229
    v_mfma_f32_16x16x32_bf16 v[236:239], a[196:199], a[228:231], v[236:239]
    ds_read_b128 a[228:231], v243 offset:12416
    v_cvt_pk_bf16_f32 v229, v230, v231
    v_mfma_f32_16x16x32_bf16 v[236:239], a[200:203], a[232:235], v[236:239]
    ds_write_b64 v249, v[228:229] offset:6144
    v_mfma_f32_16x16x32_bf16 v[236:239], a[204:207], a[236:239], v[236:239]
    ds_read_b128 a[232:235], v242 offset:12544
    v_cvt_pk_bf16_f32 v232, v232, v233
    v_mfma_f32_16x16x32_bf16 v[236:239], a[208:211], a[240:243], v[236:239]
    ds_read_b128 a[236:239], v243 offset:12544
    v_cvt_pk_bf16_f32 v233, v234, v235
    v_mfma_f32_16x16x32_bf16 v[236:239], a[212:215], a[244:247], v[236:239]
    s_waitcnt lgkmcnt(5)
    v_add_u32 v242, 0xfffe9800, v242
    v_add_u32 v243, 0xfffe9800, v243
    v_mfma_f32_16x16x32_bf16 v[200:203], v[108:111], v[168:171], v[200:203]
    ds_write_b64 v249, v[232:233] offset:6272
    v_mfma_f32_16x16x32_bf16 v[200:203], v[110:113], v[170:173], v[200:203]
    ds_read_b128 a[240:243], v242 offset:6144
    ds_read_b128 a[244:247], v243 offset:6144
    v_mfma_f32_16x16x32_bf16 v[228:231], a[144:147], a[216:219], 0
    v_cvt_pk_bf16_f32 v236, v236, v237
    v_cvt_pk_bf16_f32 v237, v238, v239
    v_mfma_f32_16x16x32_bf16 v[228:231], a[148:151], a[220:223], v[228:231]
    ds_write_b64 v249, v[236:237] offset:6400
    v_mfma_f32_16x16x32_bf16 v[232:235], a[168:171], a[216:219], 0
    s_waitcnt lgkmcnt(6)
    v_cvt_pk_bf16_f32 v191, v206, v207
    v_sub_f32 v208, v208, v248
    v_mfma_f32_16x16x32_bf16 v[228:231], a[152:155], a[224:227], v[228:231]
    ds_read_b128 v[204:207], v246 offset:256
    v_sub_f32 v209, v209, v248
    v_mfma_f32_16x16x32_bf16 v[228:231], a[156:159], a[228:231], v[228:231]
    s_waitcnt lgkmcnt(5)
    v_exp_f32 v208, v208
    v_mfma_f32_16x16x32_bf16 v[228:231], a[160:163], a[232:235], v[228:231]
    v_exp_f32 v209, v209
    v_mfma_f32_16x16x32_bf16 v[228:231], a[164:167], a[236:239], v[228:231]
    v_sub_f32 v210, v210, v248
    v_sub_f32 v211, v211, v248
    v_mfma_f32_16x16x32_bf16 v[232:235], a[172:175], a[220:223], v[232:235]
    v_exp_f32 v210, v210
    v_mfma_f32_16x16x32_bf16 v[232:235], a[176:179], a[224:227], v[232:235]
    v_exp_f32 v211, v211
    v_mfma_f32_16x16x32_bf16 v[232:235], a[180:183], a[228:231], v[232:235]
    v_cvt_pk_bf16_f32 v189, v208, v209
    v_cvt_pk_bf16_f32 v228, v228, v229
    v_mfma_f32_16x16x32_bf16 v[232:235], a[184:187], a[232:235], v[232:235]
    v_cvt_pk_bf16_f32 v229, v230, v231
    v_cvt_pk_bf16_f32 v192, v210, v211
    v_mfma_f32_16x16x32_bf16 v[212:215], v[0:3], v[188:191], 0
    ds_write_b64 v249, v[228:229] offset:12288
    v_mfma_f32_16x16x32_bf16 v[216:219], v[30:33], v[188:191], 0
    ds_read_b128 v[208:211], v244 offset:320
    v_sub_f32 v196, v196, v248
    v_mfma_f32_16x16x32_bf16 v[220:223], v[60:63], v[188:191], 0
    s_waitcnt lgkmcnt(2)
    v_exp_f32 v196, v196
    v_mfma_f32_16x16x32_bf16 v[224:227], a[248:251], v[188:191], 0
    v_sub_f32 v197, v197, v248
    v_sub_f32 v198, v198, v248
    v_mfma_f32_16x16x32_bf16 v[204:207], v[132:135], v[168:171], v[204:207]
    v_exp_f32 v197, v197
    v_mfma_f32_16x16x32_bf16 v[204:207], v[134:137], v[170:173], v[204:207]
    v_exp_f32 v198, v198
    v_mfma_f32_16x16x32_bf16 v[232:235], a[188:191], a[236:239], v[232:235]
    v_sub_f32 v199, v199, v248
    v_cvt_pk_bf16_f32 v180, v196, v197
    v_mfma_f32_16x16x32_bf16 v[236:239], a[192:195], a[216:219], 0
    ds_read_b128 a[216:219], v242 offset:6272
    v_sub_f32 v200, v200, v248
    v_mfma_f32_16x16x32_bf16 v[236:239], a[196:199], a[220:223], v[236:239]
    ds_read_b128 a[220:223], v243 offset:6272
    v_sub_f32 v201, v201, v248
    v_mfma_f32_16x16x32_bf16 v[236:239], a[200:203], a[224:227], v[236:239]
    ds_read_b128 a[224:227], v242 offset:6400
    v_cvt_pk_bf16_f32 v232, v232, v233
    v_mfma_f32_16x16x32_bf16 v[236:239], a[204:207], a[228:231], v[236:239]
    ds_read_b128 a[228:231], v243 offset:6400
    v_cvt_pk_bf16_f32 v233, v234, v235
    v_mfma_f32_16x16x32_bf16 v[236:239], a[208:211], a[232:235], v[236:239]
    ds_write_b64 v249, v[232:233] offset:12416
    v_mfma_f32_16x16x32_bf16 v[236:239], a[212:215], a[236:239], v[236:239]
    ds_read_b128 a[232:235], v240 offset:6144
    ds_read_b128 a[236:239], v241 offset:6144
    v_mfma_f32_16x16x32_bf16 v[228:231], a[144:147], a[240:243], 0
    s_waitcnt lgkmcnt(7)
    v_exp_f32 v199, v199
    v_mfma_f32_16x16x32_bf16 v[208:211], v[150:153], v[168:171], v[208:211]
    v_cvt_pk_bf16_f32 v183, v198, v199
    v_sub_f32 v202, v202, v248
    v_mfma_f32_16x16x32_bf16 v[208:211], v[152:155], v[170:173], v[208:211]
    ds_read_b128 v[196:199], v245 offset:320
    v_cvt_pk_bf16_f32 v236, v236, v237
    v_mfma_f32_16x16x32_bf16 v[228:231], a[148:151], a[244:247], v[228:231]
    s_waitcnt lgkmcnt(6)
    v_cvt_pk_bf16_f32 v237, v238, v239
    v_sub_f32 v203, v203, v248
    v_mfma_f32_16x16x32_bf16 v[228:231], a[152:155], a[216:219], v[228:231]
    ds_write_b64 v249, v[236:237] offset:12544
    v_mfma_f32_16x16x32_bf16 v[228:231], a[156:159], a[220:223], v[228:231]
    s_waitcnt lgkmcnt(5)
    v_exp_f32 v200, v200
    v_mfma_f32_16x16x32_bf16 v[228:231], a[160:163], a[224:227], v[228:231]
    v_exp_f32 v201, v201
    v_mfma_f32_16x16x32_bf16 v[228:231], a[164:167], a[228:231], v[228:231]
    v_exp_f32 v202, v202
    v_mfma_f32_16x16x32_bf16 v[232:235], a[168:171], a[240:243], 0
    v_exp_f32 v203, v203
    v_mfma_f32_16x16x32_bf16 v[232:235], a[172:175], a[244:247], v[232:235]
    v_cvt_pk_bf16_f32 v194, v200, v201
    v_cvt_pk_bf16_f32 v181, v202, v203
    v_mfma_f32_16x16x32_bf16 v[232:235], a[176:179], a[216:219], v[232:235]
    ds_read_b128 v[200:203], v246 offset:320
    v_cvt_pk_bf16_f32 v228, v228, v229
    v_mfma_f32_16x16x32_bf16 v[232:235], a[180:183], a[220:223], v[232:235]
    s_waitcnt lgkmcnt(2)
    v_cvt_pk_bf16_f32 v229, v230, v231
    v_sub_f32 v204, v204, v248
    v_mfma_f32_16x16x32_bf16 v[196:199], v[162:165], v[168:171], v[196:199]
    ds_write_b64 v249, v[228:229] offset:18432
    v_mfma_f32_16x16x32_bf16 v[196:199], v[164:167], v[170:173], v[196:199]
    s_waitcnt lgkmcnt(2)
    s_barrier
    v_sub_f32 v205, v205, v248
    v_mfma_f32_16x16x32_bf16 v[232:235], a[184:187], a[224:227], v[232:235]
    ds_read_b128 a[252:255], v252 offset:0
    ds_read_b64 v[254:255], v253 offset:256
    v_mfma_f32_16x16x32_bf16 v[232:235], a[188:191], a[228:231], v[232:235]
    v_exp_f32 v204, v204
    v_mfma_f32_16x16x32_bf16 v[236:239], a[192:195], a[240:243], 0
    ds_read_b128 a[240:243], v240 offset:6272
    v_sub_f32 v206, v206, v248
    v_mfma_f32_16x16x32_bf16 v[236:239], a[196:199], a[244:247], v[236:239]
    ds_read_b128 a[244:247], v241 offset:6272
    v_sub_f32 v207, v207, v248
    v_mfma_f32_16x16x32_bf16 v[236:239], a[200:203], a[216:219], v[236:239]
    ds_read_b128 a[216:219], v240 offset:6400
    v_cvt_pk_bf16_f32 v232, v232, v233
    v_mfma_f32_16x16x32_bf16 v[236:239], a[204:207], a[220:223], v[236:239]
    ds_read_b128 a[220:223], v241 offset:6400
    v_cvt_pk_bf16_f32 v233, v234, v235
    v_mfma_f32_16x16x32_bf16 v[236:239], a[208:211], a[224:227], v[236:239]
    ds_write_b64 v249, v[232:233] offset:18560
    v_mfma_f32_16x16x32_bf16 v[236:239], a[212:215], a[228:231], v[236:239]
    ds_read_b128 a[224:227], v242 offset:12288
    ds_read_b128 a[228:231], v243 offset:12288
    v_mfma_f32_16x16x32_bf16 v[228:231], a[0:3], a[232:235], 0
    s_waitcnt lgkmcnt(8)
    s_waitcnt lgkmcnt(7)
    v_sub_f32 v208, v208, v248
    v_mfma_f32_16x16x32_bf16 v[200:203], v[90:93], v[168:171], v[200:203]
    buffer_store_dwordx4 a[252:255], v250, s[20:23], 0 offen nt
    v_mfma_f32_16x16x32_bf16 v[200:203], v[92:95], v[170:173], v[200:203]
    ds_read_b64 v[168:169], v247 offset:36864
    v_cvt_pk_bf16_f32 v236, v236, v237
    v_mfma_f32_16x16x32_bf16 v[228:231], a[4:7], a[236:239], v[228:231]
    s_waitcnt lgkmcnt(6)
    v_cvt_pk_bf16_f32 v237, v238, v239
    v_add_u32 v250, s57, v250
    v_mfma_f32_16x16x32_bf16 v[228:231], a[8:11], a[240:243], v[228:231]
    ds_write_b64 v249, v[236:237] offset:18688
    v_mfma_f32_16x16x32_bf16 v[228:231], a[12:15], a[244:247], v[228:231]
    buffer_store_dwordx2 v[254:255], v251, s[20:23], 0 offen offset:256 nt
    v_mfma_f32_16x16x32_bf16 v[232:235], a[24:27], a[232:235], 0
    ds_read_b128 a[252:255], v252 offset:6144
    v_add_u32 v251, s57, v251
    v_mfma_f32_16x16x32_bf16 v[232:235], a[28:31], a[236:239], v[232:235]
    ds_read_b64 v[254:255], v253 offset:6400
    s_mul_i32 s57, s31, 4
    v_mfma_f32_16x16x32_bf16 v[232:235], a[32:35], a[240:243], v[232:235]
    s_add_u32 s56, s56, s57
    ds_read_b64 v[170:171], v247 offset:36992
    v_mfma_f32_16x16x32_bf16 v[232:235], a[36:39], a[244:247], v[232:235]
    ds_read_b64 v[172:173], v247 offset:37120
    s_mul_i32 s57, s30, 0
    v_mfma_f32_16x16x32_bf16 v[236:239], a[48:51], a[232:235], 0
    s_waitcnt lgkmcnt(5)
    v_exp_f32 v205, v205
    v_mfma_f32_16x16x32_bf16 v[228:231], a[16:19], a[216:219], v[228:231]
    v_exp_f32 v206, v206
    v_mfma_f32_16x16x32_bf16 v[228:231], a[20:23], a[220:223], v[228:231]
    v_exp_f32 v207, v207
    v_mfma_f32_16x16x32_bf16 v[232:235], a[40:43], a[216:219], v[232:235]
    v_cvt_pk_bf16_f32 v195, v204, v205
    v_cvt_pk_bf16_f32 v182, v206, v207
    v_mfma_f32_16x16x32_bf16 v[232:235], a[44:47], a[220:223], v[232:235]
    ds_read_b128 v[204:207], v244 offset:0
    s_waitcnt lgkmcnt(4)
    v_mfma_f32_16x16x32_bf16 v[212:215], v[4:7], v[192:195], v[212:215]
    buffer_store_dwordx4 a[252:255], v250, s[20:23], 0 offen nt
    v_mfma_f32_16x16x32_bf16 v[216:219], v[34:37], v[192:195], v[216:219]
    s_waitcnt lgkmcnt(2)
    v_add_u32 v250, s52, v250
    v_sub_f32 v209, v209, v248
    v_mfma_f32_16x16x32_bf16 v[220:223], v[64:67], v[192:195], v[220:223]
    ds_read_b128 a[252:255], v252 offset:12288
    v_sub_f32 v196, v196, v248
    v_mfma_f32_16x16x32_bf16 v[224:227], a[248:251], v[192:195], v[224:227]
    buffer_store_dwordx2 v[254:255], v251, s[20:23], 0 offen offset:256 nt
    v_mfma_f32_16x16x32_bf16 v[212:215], v[8:11], v[180:183], v[212:215]
    ds_read_b64 v[254:255], v253 offset:12544
    v_add_u32 v251, s52, v251
    v_mfma_f32_16x16x32_bf16 v[216:219], v[38:41], v[180:183], v[216:219]
    s_mul_i32 s52, s31, 4
    s_add_u32 s51, s51, s52
    s_mul_i32 s52, s30, 0
    v_mfma_f32_16x16x32_bf16 v[220:223], v[68:71], v[180:183], v[220:223]
    v_exp_f32 v208, v208
    v_mfma_f32_16x16x32_bf16 v[224:227], a[248:251], v[180:183], v[224:227]
    s_waitcnt lgkmcnt(2)
    v_exp_f32 v209, v209
    v_mfma_f32_16x16x32_bf16 v[204:207], v[144:147], v[174:177], v[204:207]
    v_cvt_pk_bf16_f32 v186, v208, v209
    v_sub_f32 v197, v197, v248
    v_mfma_f32_16x16x32_bf16 v[204:207], v[146:149], v[176:179], v[204:207]
    ds_read_b128 v[208:211], v245 offset:0
    v_sub_f32 v200, v200, v248
    v_mfma_f32_16x16x32_bf16 v[236:239], a[52:55], a[236:239], v[236:239]
    s_waitcnt lgkmcnt(2)
    v_exp_f32 v196, v196
    v_mfma_f32_16x16x32_bf16 v[236:239], a[56:59], a[240:243], v[236:239]
    buffer_store_dwordx4 a[252:255], v250, s[20:23], 0 offen nt
    v_mfma_f32_16x16x32_bf16 v[236:239], a[60:63], a[244:247], v[236:239]
    s_waitcnt lgkmcnt(1)
    v_add_u32 v250, s54, v250
    v_sub_f32 v201, v201, v248
    v_mfma_f32_16x16x32_bf16 v[236:239], a[64:67], a[216:219], v[236:239]
    v_exp_f32 v197, v197
    v_mfma_f32_16x16x32_bf16 v[236:239], a[68:71], a[220:223], v[236:239]
    buffer_store_dwordx2 v[254:255], v251, s[20:23], 0 offen offset:256 nt
    v_add_u32 v251, s54, v251
    s_mov_b32 s54, 15
    s_mul_i32 s54, s54, s31
    s_add_u32 s53, s53, s54
    s_add_u32 s53, s53, s32
    s_add_u32 s54, s28, 11
    s_waitcnt lgkmcnt(0)
    v_mfma_f32_16x16x32_bf16 v[208:211], v[108:111], v[174:177], v[208:211]
    s_mul_i32 s54, s54, s30
    v_cvt_pk_bf16_f32 v184, v196, v197
    v_max_f32 v248, v204, v205
    v_mfma_f32_16x16x32_bf16 v[208:211], v[110:113], v[176:179], v[208:211]
    ds_read_b128 v[196:199], v246 offset:0
    v_exp_f32 v200, v200
    v_exp_f32 v201, v201
    v_max3_f32 v248, v248, v206, v207
    ds_read_b128 v[204:207], v245 offset:64
    v_cvt_pk_bf16_f32 v185, v200, v201
    ds_read_b128 v[200:203], v244 offset:64
    s_nop 0
    v_mfma_f32_16x16x32_bf16 v[212:215], v[12:15], v[184:187], v[212:215]
    v_max3_f32 v248, v248, v208, v209
    v_max3_f32 v248, v248, v210, v211
    v_mfma_f32_16x16x32_bf16 v[216:219], v[42:45], v[184:187], v[216:219]
    ds_read_b128 v[208:211], v246 offset:64
    v_mfma_f32_16x16x32_bf16 v[220:223], v[72:75], v[184:187], v[220:223]
    v_mfma_f32_16x16x32_bf16 v[224:227], a[248:251], v[184:187], v[224:227]
    s_nop 7
    s_waitcnt lgkmcnt(3)
    v_mfma_f32_16x16x32_bf16 v[196:199], v[132:135], v[174:177], v[196:199]
    v_rcp_f32 v225, v224
    v_mfma_f32_16x16x32_bf16 v[196:199], v[134:137], v[176:179], v[196:199]
    s_waitcnt lgkmcnt(2)
    v_mul_f32 v212, v212, v225
    v_mul_f32 v213, v213, v225
    v_mfma_f32_16x16x32_bf16 v[204:207], v[162:165], v[174:177], v[204:207]
    s_waitcnt lgkmcnt(1)
    v_mul_f32 v214, v214, v225
    v_mul_f32 v215, v215, v225
    v_mfma_f32_16x16x32_bf16 v[200:203], v[150:153], v[174:177], v[200:203]
    v_cvt_pk_bf16_f32 v212, v212, v213
    v_cvt_pk_bf16_f32 v213, v214, v215
    v_mfma_f32_16x16x32_bf16 v[200:203], v[152:155], v[176:179], v[200:203]
    ds_write_b64 v247, v[212:213] offset:24576
    v_mfma_f32_16x16x32_bf16 v[204:207], v[164:167], v[176:179], v[204:207]
    s_waitcnt lgkmcnt(1)
    v_mul_f32 v216, v216, v225
    v_mul_f32 v217, v217, v225
    v_mfma_f32_16x16x32_bf16 v[208:211], v[90:93], v[174:177], v[208:211]
    v_mul_f32 v218, v218, v225
    v_mul_f32 v219, v219, v225
    v_mfma_f32_16x16x32_bf16 v[208:211], v[92:95], v[176:179], v[208:211]
    v_cvt_pk_bf16_f32 v216, v216, v217
    v_cvt_pk_bf16_f32 v217, v218, v219
    ds_write_b64 v247, v[216:217] offset:24704
    v_mul_f32 v220, v220, v225
    v_mul_f32 v221, v221, v225
    v_mul_f32 v222, v222, v225
    v_mul_f32 v223, v223, v225
    v_cvt_pk_bf16_f32 v220, v220, v221
    v_cvt_pk_bf16_f32 v221, v222, v223
    ds_write_b64 v247, v[220:221] offset:24832
    v_max3_f32 v248, v248, v196, v197
    v_max3_f32 v248, v248, v198, v199
    ds_read_b128 v[196:199], v244 offset:128
    v_max3_f32 v248, v248, v200, v201
    v_max3_f32 v248, v248, v202, v203
    ds_read_b128 v[200:203], v245 offset:128
    v_max3_f32 v248, v248, v204, v205
    v_max3_f32 v248, v248, v206, v207
    ds_read_b128 v[204:207], v246 offset:128
    v_max3_f32 v248, v248, v208, v209
    v_max3_f32 v248, v248, v210, v211
    ds_read_b128 v[208:211], v244 offset:0
    s_waitcnt lgkmcnt(3)
    v_mfma_f32_16x16x32_bf16 v[196:199], v[156:159], v[174:177], v[196:199]
    v_mfma_f32_16x16x32_bf16 v[196:199], v[158:161], v[176:179], v[196:199]
    s_waitcnt lgkmcnt(2)
    v_mfma_f32_16x16x32_bf16 v[200:203], v[114:117], v[174:177], v[200:203]
    s_waitcnt lgkmcnt(1)
    v_mfma_f32_16x16x32_bf16 v[200:203], v[116:119], v[176:179], v[200:203]
    v_mfma_f32_16x16x32_bf16 v[204:207], v[138:141], v[174:177], v[204:207]
    s_waitcnt lgkmcnt(0)
    v_mfma_f32_16x16x32_bf16 v[204:207], v[140:143], v[176:179], v[204:207]
    v_mfma_f32_16x16x32_bf16 v[208:211], v[144:147], v[174:177], v[208:211]
    v_cvt_pk_bf16_f32 v144, v228, v229
    v_cvt_pk_bf16_f32 v145, v230, v231
    v_mfma_f32_16x16x32_bf16 v[208:211], v[146:149], v[176:179], v[208:211]
    v_cvt_pk_bf16_f32 v146, v232, v233
    v_cvt_pk_bf16_f32 v147, v234, v235
    v_mfma_f32_16x16x32_bf16 v[228:231], a[232:235], a[72:75], 0
    v_cvt_pk_bf16_f32 v148, v236, v237
    v_cvt_pk_bf16_f32 v149, v238, v239
    v_mfma_f32_16x16x32_bf16 v[228:231], a[236:239], a[76:79], v[228:231]
    v_max3_f32 v248, v248, v196, v197
    v_max3_f32 v248, v248, v200, v201
    v_mfma_f32_16x16x32_bf16 v[228:231], a[240:243], a[80:83], v[228:231]
    ds_read_b128 v[196:199], v245 offset:0
    ds_read_b128 v[200:203], v246 offset:0
    v_mfma_f32_16x16x32_bf16 v[228:231], a[244:247], a[84:87], v[228:231]
    v_max3_f32 v248, v248, v204, v205
    v_mov_b32 v225, v248
    v_mfma_f32_16x16x32_bf16 v[228:231], a[216:219], a[88:91], v[228:231]
    ds_read_b128 v[204:207], v244 offset:64
    v_permlane16_swap_b32 v248, v225
    v_mfma_f32_16x16x32_bf16 v[228:231], a[220:223], a[92:95], v[228:231]
    v_max_f32 v248, v248, v225
    v_mov_b32 v225, v248
    v_mfma_f32_16x16x32_bf16 v[232:235], a[232:235], a[96:99], 0
    v_mfma_f32_16x16x32_bf16 v[232:235], a[236:239], a[100:103], v[232:235]
    v_permlane32_swap_b32 v248, v225
    v_max_f32 v248, v248, v225
    v_mfma_f32_16x16x32_bf16 v[232:235], a[240:243], a[104:107], v[232:235]
    v_sub_f32 v208, v208, v248
    v_cvt_pk_bf16_f32 v25, v228, v229
    v_mfma_f32_16x16x32_bf16 v[232:235], a[244:247], a[108:111], v[232:235]
    v_cvt_pk_bf16_f32 v28, v230, v231
    v_sub_f32 v209, v209, v248
    v_mfma_f32_16x16x32_bf16 v[232:235], a[216:219], a[112:115], v[232:235]
    v_exp_f32 v208, v208
    v_mfma_f32_16x16x32_bf16 v[232:235], a[220:223], a[116:119], v[232:235]
    s_waitcnt lgkmcnt(2)
    v_exp_f32 v209, v209
    v_mfma_f32_16x16x32_bf16 v[196:199], v[108:111], v[174:177], v[196:199]
    s_waitcnt lgkmcnt(1)
    v_sub_f32 v210, v210, v248
    v_sub_f32 v211, v211, v248
    v_mfma_f32_16x16x32_bf16 v[196:199], v[110:113], v[176:179], v[196:199]
    s_waitcnt lgkmcnt(0)
    v_cvt_pk_bf16_f32 v55, v232, v233
    v_cvt_pk_bf16_f32 v58, v234, v235
    v_mfma_f32_16x16x32_bf16 v[200:203], v[132:135], v[174:177], v[200:203]
    v_exp_f32 v210, v210
    v_mfma_f32_16x16x32_bf16 v[200:203], v[134:137], v[176:179], v[200:203]
    v_exp_f32 v211, v211
    v_mfma_f32_16x16x32_bf16 v[204:207], v[150:153], v[174:177], v[204:207]
    v_cvt_pk_bf16_f32 v190, v208, v209
    v_cvt_pk_bf16_f32 v193, v210, v211
    v_mfma_f32_16x16x32_bf16 v[204:207], v[152:155], v[176:179], v[204:207]
    ds_read_b128 v[208:211], v245 offset:64
    v_sub_f32 v196, v196, v248
    v_mfma_f32_16x16x32_bf16 v[236:239], a[232:235], a[120:123], 0
    ds_read_b128 a[232:235], v242 offset:12416
    v_sub_f32 v197, v197, v248
    v_mfma_f32_16x16x32_bf16 v[236:239], a[236:239], a[124:127], v[236:239]
    ds_read_b128 a[236:239], v243 offset:12416
    v_sub_f32 v198, v198, v248
    v_mfma_f32_16x16x32_bf16 v[236:239], a[240:243], a[128:131], v[236:239]
    ds_read_b128 a[240:243], v242 offset:12544
    v_sub_f32 v199, v199, v248
    v_mfma_f32_16x16x32_bf16 v[236:239], a[244:247], a[132:135], v[236:239]
    ds_read_b128 a[244:247], v243 offset:12544
    v_sub_f32 v200, v200, v248
    v_mfma_f32_16x16x32_bf16 v[236:239], a[216:219], a[136:139], v[236:239]
    ds_read_b128 a[216:219], v242 offset:18432
    v_sub_f32 v201, v201, v248
    v_mfma_f32_16x16x32_bf16 v[236:239], a[220:223], a[140:143], v[236:239]
    ds_read_b128 a[220:223], v243 offset:18432
    v_sub_f32 v202, v202, v248
    v_mfma_f32_16x16x32_bf16 v[228:231], a[144:147], a[224:227], 0
    v_exp_f32 v196, v196
    v_mfma_f32_16x16x32_bf16 v[228:231], a[148:151], a[228:231], v[228:231]
    v_exp_f32 v197, v197
    v_mfma_f32_16x16x32_bf16 v[232:235], a[168:171], a[224:227], 0
    s_waitcnt lgkmcnt(6)
    v_cvt_pk_bf16_f32 v85, v236, v237
    v_cvt_pk_bf16_f32 v88, v238, v239
    v_mfma_f32_16x16x32_bf16 v[208:211], v[162:165], v[174:177], v[208:211]
    s_waitcnt lgkmcnt(5)
    v_exp_f32 v198, v198
    v_mfma_f32_16x16x32_bf16 v[208:211], v[164:167], v[176:179], v[208:211]
    v_exp_f32 v199, v199
    v_mfma_f32_16x16x32_bf16 v[228:231], a[152:155], a[232:235], v[228:231]
    s_waitcnt lgkmcnt(3)
    v_cvt_pk_bf16_f32 v188, v196, v197
    v_cvt_pk_bf16_f32 v191, v198, v199
    v_mfma_f32_16x16x32_bf16 v[228:231], a[156:159], a[236:239], v[228:231]
    ds_read_b128 v[196:199], v246 offset:64
    v_sub_f32 v203, v203, v248
    v_mfma_f32_16x16x32_bf16 v[228:231], a[160:163], a[240:243], v[228:231]
    s_waitcnt lgkmcnt(2)
    v_exp_f32 v200, v200
    v_mfma_f32_16x16x32_bf16 v[228:231], a[164:167], a[244:247], v[228:231]
    v_exp_f32 v201, v201
    v_mfma_f32_16x16x32_bf16 v[232:235], a[172:175], a[228:231], v[232:235]
    v_exp_f32 v202, v202
    v_mfma_f32_16x16x32_bf16 v[232:235], a[176:179], a[232:235], v[232:235]
    v_exp_f32 v203, v203
    v_mfma_f32_16x16x32_bf16 v[232:235], a[180:183], a[236:239], v[232:235]
    v_cvt_pk_bf16_f32 v189, v200, v201
    v_cvt_pk_bf16_f32 v192, v202, v203
    v_mfma_f32_16x16x32_bf16 v[232:235], a[184:187], a[240:243], v[232:235]
    ds_read_b128 v[200:203], v244 offset:128
    v_cvt_pk_bf16_f32 v228, v228, v229
    v_mfma_f32_16x16x32_bf16 v[212:215], v[6:9], v[188:191], 0
    v_cvt_pk_bf16_f32 v229, v230, v231
    v_sub_f32 v204, v204, v248
    v_mfma_f32_16x16x32_bf16 v[216:219], v[36:39], v[188:191], 0
    ds_write_b64 v249, v[228:229] offset:24576
    v_mfma_f32_16x16x32_bf16 v[220:223], v[66:69], v[188:191], 0
    s_waitcnt lgkmcnt(2)
    v_exp_f32 v204, v204
    v_mfma_f32_16x16x32_bf16 v[224:227], a[248:251], v[188:191], 0
    v_sub_f32 v205, v205, v248
    v_sub_f32 v206, v206, v248
    v_mfma_f32_16x16x32_bf16 v[196:199], v[90:93], v[174:177], v[196:199]
    v_exp_f32 v205, v205
    v_mfma_f32_16x16x32_bf16 v[196:199], v[92:95], v[176:179], v[196:199]
    v_exp_f32 v206, v206
    v_mfma_f32_16x16x32_bf16 v[232:235], a[188:191], a[244:247], v[232:235]
    v_sub_f32 v207, v207, v248
    v_cvt_pk_bf16_f32 v180, v204, v205
    v_mfma_f32_16x16x32_bf16 v[236:239], a[192:195], a[224:227], 0
    ds_read_b128 a[224:227], v242 offset:18560
    v_sub_f32 v208, v208, v248
    v_mfma_f32_16x16x32_bf16 v[236:239], a[196:199], a[228:231], v[236:239]
    ds_read_b128 a[228:231], v243 offset:18560
    v_sub_f32 v209, v209, v248
    v_mfma_f32_16x16x32_bf16 v[236:239], a[200:203], a[232:235], v[236:239]
    ds_read_b128 a[232:235], v242 offset:18688
    v_cvt_pk_bf16_f32 v232, v232, v233
    v_mfma_f32_16x16x32_bf16 v[236:239], a[204:207], a[236:239], v[236:239]
    ds_read_b128 a[236:239], v243 offset:18688
    v_cvt_pk_bf16_f32 v233, v234, v235
    v_mfma_f32_16x16x32_bf16 v[236:239], a[208:211], a[240:243], v[236:239]
    ds_write_b64 v249, v[232:233] offset:24704
    v_mfma_f32_16x16x32_bf16 v[236:239], a[212:215], a[244:247], v[236:239]
    ds_read_b128 a[240:243], v242 offset:0
    ds_read_b128 a[244:247], v243 offset:0
    v_mfma_f32_16x16x32_bf16 v[228:231], a[144:147], a[216:219], 0
    s_waitcnt lgkmcnt(7)
    v_exp_f32 v207, v207
    v_mfma_f32_16x16x32_bf16 v[200:203], v[156:159], v[174:177], v[200:203]
    v_cvt_pk_bf16_f32 v183, v206, v207
    v_sub_f32 v210, v210, v248
    v_mfma_f32_16x16x32_bf16 v[200:203], v[158:161], v[176:179], v[200:203]
    ds_read_b128 v[204:207], v245 offset:128
    v_cvt_pk_bf16_f32 v236, v236, v237
    v_mfma_f32_16x16x32_bf16 v[228:231], a[148:151], a[220:223], v[228:231]
    s_waitcnt lgkmcnt(6)
    v_cvt_pk_bf16_f32 v237, v238, v239
    v_sub_f32 v211, v211, v248
    v_mfma_f32_16x16x32_bf16 v[228:231], a[152:155], a[224:227], v[228:231]
    ds_write_b64 v249, v[236:237] offset:24832
    v_mfma_f32_16x16x32_bf16 v[228:231], a[156:159], a[228:231], v[228:231]
    s_waitcnt lgkmcnt(5)
    v_exp_f32 v208, v208
    v_mfma_f32_16x16x32_bf16 v[228:231], a[160:163], a[232:235], v[228:231]
    v_exp_f32 v209, v209
    v_mfma_f32_16x16x32_bf16 v[228:231], a[164:167], a[236:239], v[228:231]
    v_exp_f32 v210, v210
    v_mfma_f32_16x16x32_bf16 v[232:235], a[168:171], a[216:219], 0
    v_exp_f32 v211, v211
    v_mfma_f32_16x16x32_bf16 v[232:235], a[172:175], a[220:223], v[232:235]
    v_cvt_pk_bf16_f32 v194, v208, v209
    v_cvt_pk_bf16_f32 v181, v210, v211
    v_mfma_f32_16x16x32_bf16 v[232:235], a[176:179], a[224:227], v[232:235]
    ds_read_b128 v[208:211], v246 offset:128
    v_cvt_pk_bf16_f32 v228, v228, v229
    v_mfma_f32_16x16x32_bf16 v[232:235], a[180:183], a[228:231], v[232:235]
    s_waitcnt lgkmcnt(2)
    v_cvt_pk_bf16_f32 v229, v230, v231
    v_sub_f32 v196, v196, v248
    v_mfma_f32_16x16x32_bf16 v[204:207], v[114:117], v[174:177], v[204:207]
    s_waitcnt lgkmcnt(1)
    s_barrier
    v_sub_f32 v197, v197, v248
    v_mfma_f32_16x16x32_bf16 v[204:207], v[116:119], v[176:179], v[204:207]
    ds_write_b64 v249, v[228:229] offset:0
    v_mfma_f32_16x16x32_bf16 v[232:235], a[184:187], a[232:235], v[232:235]
    ds_read_b128 a[252:255], v252 offset:18432
    ds_read_b64 v[254:255], v253 offset:18688
    v_mfma_f32_16x16x32_bf16 v[232:235], a[188:191], a[236:239], v[232:235]
    v_exp_f32 v196, v196
    v_mfma_f32_16x16x32_bf16 v[236:239], a[192:195], a[216:219], 0
    ds_read_b128 a[216:219], v242 offset:128
    v_sub_f32 v198, v198, v248
    v_mfma_f32_16x16x32_bf16 v[236:239], a[196:199], a[220:223], v[236:239]
    ds_read_b128 a[220:223], v243 offset:128
    v_sub_f32 v199, v199, v248
    v_mfma_f32_16x16x32_bf16 v[236:239], a[200:203], a[224:227], v[236:239]
    ds_read_b128 a[224:227], v242 offset:256
    v_cvt_pk_bf16_f32 v232, v232, v233
    v_mfma_f32_16x16x32_bf16 v[236:239], a[204:207], a[228:231], v[236:239]
    ds_read_b128 a[228:231], v243 offset:256
    v_cvt_pk_bf16_f32 v233, v234, v235
    v_mfma_f32_16x16x32_bf16 v[236:239], a[208:211], a[232:235], v[236:239]
    ds_write_b64 v249, v[232:233] offset:128
    v_mfma_f32_16x16x32_bf16 v[236:239], a[212:215], a[236:239], v[236:239]
    ds_read_b128 a[232:235], v242 offset:24576
    ds_read_b128 a[236:239], v243 offset:24576
    v_mfma_f32_16x16x32_bf16 v[228:231], a[144:147], a[240:243], 0
    s_waitcnt lgkmcnt(8)
    s_waitcnt lgkmcnt(7)
    v_sub_f32 v200, v200, v248
    v_mfma_f32_16x16x32_bf16 v[208:211], v[138:141], v[174:177], v[208:211]
    buffer_store_dwordx4 a[252:255], v250, s[20:23], 0 offen nt
    v_mfma_f32_16x16x32_bf16 v[208:211], v[140:143], v[176:179], v[208:211]
    ds_read_b64 v[174:175], v247 offset:43008
    v_cvt_pk_bf16_f32 v236, v236, v237
    v_mfma_f32_16x16x32_bf16 v[228:231], a[148:151], a[244:247], v[228:231]
    s_waitcnt lgkmcnt(6)
    v_cvt_pk_bf16_f32 v237, v238, v239
    v_add_u32 v250, s56, v250
    v_mfma_f32_16x16x32_bf16 v[228:231], a[152:155], a[216:219], v[228:231]
    ds_write_b64 v249, v[236:237] offset:256
    v_mfma_f32_16x16x32_bf16 v[228:231], a[156:159], a[220:223], v[228:231]
    buffer_store_dwordx2 v[254:255], v251, s[20:23], 0 offen offset:256 nt
    v_mfma_f32_16x16x32_bf16 v[232:235], a[168:171], a[240:243], 0
    ds_read_b128 a[252:255], v252 offset:24576
    v_add_u32 v251, s56, v251
    v_mfma_f32_16x16x32_bf16 v[232:235], a[172:175], a[244:247], v[232:235]
    ds_read_b64 v[254:255], v253 offset:24832
    ds_read_b64 v[176:177], v247 offset:43136
    v_mfma_f32_16x16x32_bf16 v[232:235], a[176:179], a[216:219], v[232:235]
    ds_read_b64 v[178:179], v247 offset:43264
    s_mov_b32 s56, 3
    v_mfma_f32_16x16x32_bf16 v[232:235], a[180:183], a[220:223], v[232:235]
    s_mul_i32 s56, s56, s31
    s_add_u32 s55, s55, s56
    s_add_u32 s55, s55, s32
    v_mfma_f32_16x16x32_bf16 v[236:239], a[192:195], a[240:243], 0
    ds_read_b128 a[240:243], v242 offset:24704
    s_and_b32 s56, s28, 1
    v_mfma_f32_16x16x32_bf16 v[236:239], a[196:199], a[244:247], v[236:239]
    ds_read_b128 a[244:247], v243 offset:24704
    s_add_u32 s56, s56, 15
    v_mfma_f32_16x16x32_bf16 v[236:239], a[200:203], a[216:219], v[236:239]
    ds_read_b128 a[216:219], v242 offset:24832
    s_mul_i32 s56, s56, s30
    v_mfma_f32_16x16x32_bf16 v[236:239], a[204:207], a[220:223], v[236:239]
    s_waitcnt lgkmcnt(7)
    ds_read_b128 a[220:223], v243 offset:24832
    v_mfma_f32_16x16x32_bf16 v[228:231], a[160:163], a[224:227], v[228:231]
    v_exp_f32 v197, v197
    v_mfma_f32_16x16x32_bf16 v[228:231], a[164:167], a[228:231], v[228:231]
    s_waitcnt lgkmcnt(7)
    s_waitcnt lgkmcnt(6)
    v_cvt_pk_bf16_f32 v195, v196, v197
    v_mfma_f32_16x16x32_bf16 v[232:235], a[184:187], a[224:227], v[232:235]
    buffer_store_dwordx4 a[252:255], v250, s[20:23], 0 offen nt
    v_mfma_f32_16x16x32_bf16 v[212:215], v[10:13], v[192:195], v[212:215]
    v_exp_f32 v198, v198
    v_mfma_f32_16x16x32_bf16 v[216:219], v[40:43], v[192:195], v[216:219]
    v_cvt_pk_bf16_f32 v228, v228, v229
    v_cvt_pk_bf16_f32 v229, v230, v231
    v_mfma_f32_16x16x32_bf16 v[220:223], v[70:73], v[192:195], v[220:223]
    ds_write_b64 v249, v[228:229] offset:6144
    v_mfma_f32_16x16x32_bf16 v[224:227], a[248:251], v[192:195], v[224:227]
    buffer_store_dwordx2 v[254:255], v251, s[20:23], 0 offen offset:256 nt
    v_mfma_f32_16x16x32_bf16 v[232:235], a[188:191], a[228:231], v[232:235]
    v_add_u32 v250, s51, v250
    v_add_u32 v251, s51, v251
    v_mfma_f32_16x16x32_bf16 v[236:239], a[208:211], a[224:227], v[236:239]
    s_mul_i32 s51, s31, 4
    s_add_u32 s57, s57, s51
    s_and_b32 s51, s28, 1
    v_mfma_f32_16x16x32_bf16 v[236:239], a[212:215], a[228:231], v[236:239]
    s_add_u32 s51, s51, 15
    v_cvt_pk_bf16_f32 v232, v232, v233
    v_cvt_pk_bf16_f32 v233, v234, v235
    ds_write_b64 v249, v[232:233] offset:6272
    s_mul_i32 s51, s51, s30
    v_exp_f32 v199, v199
    v_exp_f32 v200, v200
    v_cvt_pk_bf16_f32 v182, v198, v199
    v_cvt_pk_bf16_f32 v236, v236, v237
    v_cvt_pk_bf16_f32 v237, v238, v239
    v_mfma_f32_16x16x32_bf16 v[212:215], v[14:17], v[180:183], v[212:215]
    ds_write_b64 v249, v[236:237] offset:6400
    v_mfma_f32_16x16x32_bf16 v[216:219], v[44:47], v[180:183], v[216:219]
    ds_read_b128 v[196:199], v244 offset:0
    v_sub_f32 v201, v201, v248
    v_mfma_f32_16x16x32_bf16 v[220:223], v[74:77], v[180:183], v[220:223]
    v_exp_f32 v201, v201
    v_mfma_f32_16x16x32_bf16 v[224:227], a[248:251], v[180:183], v[224:227]
    v_cvt_pk_bf16_f32 v186, v200, v201
    ds_read_b128 v[200:203], v245 offset:0
    v_sub_f32 v204, v204, v248
    v_exp_f32 v204, v204
    v_sub_f32 v205, v205, v248
    v_exp_f32 v205, v205
    v_sub_f32 v208, v208, v248
    v_cvt_pk_bf16_f32 v184, v204, v205
    ds_read_b128 v[204:207], v246 offset:0
    v_exp_f32 v208, v208
    v_sub_f32 v209, v209, v248
    v_exp_f32 v209, v209
    s_nop 0
    v_cvt_pk_bf16_f32 v185, v208, v209
    ds_read_b128 v[208:211], v244 offset:64
    s_waitcnt lgkmcnt(3)
    v_mfma_f32_16x16x32_bf16 v[212:215], v[18:21], v[184:187], v[212:215]
    v_mfma_f32_16x16x32_bf16 v[216:219], v[48:51], v[184:187], v[216:219]
    v_mfma_f32_16x16x32_bf16 v[220:223], v[78:81], v[184:187], v[220:223]
    s_waitcnt lgkmcnt(2)
    v_mfma_f32_16x16x32_bf16 v[224:227], a[248:251], v[184:187], v[224:227]
    v_mfma_f32_16x16x32_bf16 v[196:199], v[150:153], v[168:171], v[196:199]
    v_mfma_f32_16x16x32_bf16 v[196:199], v[152:155], v[170:173], v[196:199]
    s_waitcnt lgkmcnt(1)
    v_mfma_f32_16x16x32_bf16 v[200:203], v[162:165], v[168:171], v[200:203]
    v_mfma_f32_16x16x32_bf16 v[200:203], v[164:167], v[170:173], v[200:203]
    v_mfma_f32_16x16x32_bf16 v[204:207], v[90:93], v[168:171], v[204:207]
    s_waitcnt lgkmcnt(0)
    v_mfma_f32_16x16x32_bf16 v[204:207], v[92:95], v[170:173], v[204:207]
    v_rcp_f32 v225, v224
    v_mfma_f32_16x16x32_bf16 v[208:211], v[156:159], v[168:171], v[208:211]
    v_mul_f32 v212, v212, v225
    v_mul_f32 v213, v213, v225
    v_mfma_f32_16x16x32_bf16 v[208:211], v[158:161], v[170:173], v[208:211]
    v_mul_f32 v214, v214, v225
    v_mul_f32 v215, v215, v225
    v_cvt_pk_bf16_f32 v212, v212, v213
    v_cvt_pk_bf16_f32 v213, v214, v215
    ds_write_b64 v247, v[212:213] offset:30720
    v_mul_f32 v216, v216, v225
    v_mul_f32 v217, v217, v225
    v_mul_f32 v218, v218, v225
    v_mul_f32 v219, v219, v225
    v_cvt_pk_bf16_f32 v216, v216, v217
    v_cvt_pk_bf16_f32 v217, v218, v219
    ds_write_b64 v247, v[216:217] offset:30848
    v_mul_f32 v220, v220, v225
    v_mul_f32 v221, v221, v225
    v_mul_f32 v222, v222, v225
    v_mul_f32 v223, v223, v225
    v_cvt_pk_bf16_f32 v220, v220, v221
    v_cvt_pk_bf16_f32 v221, v222, v223
    ds_write_b64 v247, v[220:221] offset:30976
    v_max_f32 v248, v196, v197
    v_max3_f32 v248, v248, v198, v199
    ds_read_b128 v[196:199], v245 offset:64
    v_max3_f32 v248, v248, v200, v201
    v_max3_f32 v248, v248, v202, v203
    ds_read_b128 v[200:203], v246 offset:64
    v_max3_f32 v248, v248, v204, v205
    v_max3_f32 v248, v248, v206, v207
    ds_read_b128 v[204:207], v244 offset:128
    v_max3_f32 v248, v248, v208, v209
    v_max3_f32 v248, v248, v210, v211
    ds_read_b128 v[208:211], v245 offset:128
    s_waitcnt lgkmcnt(3)
    v_mfma_f32_16x16x32_bf16 v[196:199], v[114:117], v[168:171], v[196:199]
    v_mfma_f32_16x16x32_bf16 v[196:199], v[116:119], v[170:173], v[196:199]
    s_waitcnt lgkmcnt(2)
    v_mfma_f32_16x16x32_bf16 v[200:203], v[138:141], v[168:171], v[200:203]
    s_waitcnt lgkmcnt(1)
    v_mfma_f32_16x16x32_bf16 v[200:203], v[140:143], v[170:173], v[200:203]
    v_mfma_f32_16x16x32_bf16 v[204:207], v[96:99], v[168:171], v[204:207]
    s_waitcnt lgkmcnt(0)
    v_mfma_f32_16x16x32_bf16 v[204:207], v[98:101], v[170:173], v[204:207]
    v_mfma_f32_16x16x32_bf16 v[208:211], v[120:123], v[168:171], v[208:211]
    v_max3_f32 v248, v248, v196, v197
    v_max3_f32 v248, v248, v198, v199
    v_mfma_f32_16x16x32_bf16 v[208:211], v[122:125], v[170:173], v[208:211]
    ds_read_b128 v[196:199], v246 offset:128
    v_max3_f32 v248, v248, v200, v201
    v_max3_f32 v248, v248, v202, v203
    ds_read_b128 v[200:203], v244 offset:0
    v_max3_f32 v248, v248, v204, v205
    ds_read_b128 v[204:207], v245 offset:0
    s_nop 1
    v_max3_f32 v248, v248, v208, v209
    ds_read_b128 v[208:211], v246 offset:0
    s_waitcnt lgkmcnt(3)
    v_mfma_f32_16x16x32_bf16 v[196:199], v[144:147], v[168:171], v[196:199]
    v_mfma_f32_16x16x32_bf16 v[196:199], v[146:149], v[170:173], v[196:199]
    s_waitcnt lgkmcnt(2)
    v_mfma_f32_16x16x32_bf16 v[200:203], v[150:153], v[168:171], v[200:203]
    s_waitcnt lgkmcnt(1)
    v_mfma_f32_16x16x32_bf16 v[200:203], v[152:155], v[170:173], v[200:203]
    v_mfma_f32_16x16x32_bf16 v[204:207], v[162:165], v[168:171], v[204:207]
    s_waitcnt lgkmcnt(0)
    v_mfma_f32_16x16x32_bf16 v[204:207], v[164:167], v[170:173], v[204:207]
    v_mfma_f32_16x16x32_bf16 v[208:211], v[90:93], v[168:171], v[208:211]
    v_max3_f32 v248, v248, v196, v197
    v_mov_b32 v225, v248
    v_mfma_f32_16x16x32_bf16 v[208:211], v[92:95], v[170:173], v[208:211]
    ds_read_b128 v[196:199], v244 offset:64
    v_permlane16_swap_b32 v248, v225
    v_max_f32 v248, v248, v225
    v_mov_b32 v225, v248
    s_nop 1
    v_permlane32_swap_b32 v248, v225
    v_max_f32 v248, v248, v225
    v_sub_f32 v200, v200, v248
    v_exp_f32 v200, v200
    v_sub_f32 v201, v201, v248
    v_exp_f32 v201, v201
    v_sub_f32 v202, v202, v248
    v_exp_f32 v202, v202
    v_sub_f32 v203, v203, v248
    v_exp_f32 v203, v203
    v_cvt_pk_bf16_f32 v190, v200, v201
    v_cvt_pk_bf16_f32 v193, v202, v203
    ds_read_b128 v[200:203], v245 offset:64
    v_sub_f32 v204, v204, v248
    v_exp_f32 v204, v204
    v_sub_f32 v205, v205, v248
    v_exp_f32 v205, v205
    v_sub_f32 v206, v206, v248
    s_waitcnt lgkmcnt(1)
    v_mfma_f32_16x16x32_bf16 v[196:199], v[156:159], v[168:171], v[196:199]
    v_exp_f32 v206, v206
    v_mfma_f32_16x16x32_bf16 v[196:199], v[158:161], v[170:173], v[196:199]
    v_sub_f32 v207, v207, v248
    v_exp_f32 v207, v207
    v_cvt_pk_bf16_f32 v188, v204, v205
    v_cvt_pk_bf16_f32 v191, v206, v207
    ds_read_b128 v[204:207], v246 offset:64
    v_sub_f32 v208, v208, v248
    v_exp_f32 v208, v208
    v_sub_f32 v209, v209, v248
    v_exp_f32 v209, v209
    v_sub_f32 v210, v210, v248
    v_exp_f32 v210, v210
    s_waitcnt lgkmcnt(1)
    v_mfma_f32_16x16x32_bf16 v[200:203], v[114:117], v[168:171], v[200:203]
    v_sub_f32 v211, v211, v248
    v_cvt_pk_bf16_f32 v189, v208, v209
    v_mfma_f32_16x16x32_bf16 v[200:203], v[116:119], v[170:173], v[200:203]
    v_exp_f32 v211, v211
    v_mfma_f32_16x16x32_bf16 v[212:215], v[12:15], v[188:191], 0
    v_cvt_pk_bf16_f32 v192, v210, v211
    v_sub_f32 v196, v196, v248
    v_mfma_f32_16x16x32_bf16 v[216:219], v[42:45], v[188:191], 0
    ds_read_b128 v[208:211], v244 offset:128
    v_sub_f32 v197, v197, v248
    v_mfma_f32_16x16x32_bf16 v[220:223], v[72:75], v[188:191], 0
    v_exp_f32 v196, v196
    v_mfma_f32_16x16x32_bf16 v[224:227], a[248:251], v[188:191], 0
    s_waitcnt lgkmcnt(1)
    v_exp_f32 v197, v197
    v_mfma_f32_16x16x32_bf16 v[204:207], v[138:141], v[168:171], v[204:207]
    v_sub_f32 v198, v198, v248
    v_sub_f32 v199, v199, v248
    v_mfma_f32_16x16x32_bf16 v[204:207], v[140:143], v[170:173], v[204:207]
    v_exp_f32 v198, v198
    v_exp_f32 v199, v199
    v_cvt_pk_bf16_f32 v180, v196, v197
    v_cvt_pk_bf16_f32 v183, v198, v199
    ds_read_b128 v[196:199], v245 offset:128
    v_sub_f32 v200, v200, v248
    v_exp_f32 v200, v200
    v_sub_f32 v201, v201, v248
    v_exp_f32 v201, v201
    v_sub_f32 v202, v202, v248
    s_waitcnt lgkmcnt(1)
    v_mfma_f32_16x16x32_bf16 v[208:211], v[96:99], v[168:171], v[208:211]
    v_exp_f32 v202, v202
    v_mfma_f32_16x16x32_bf16 v[208:211], v[98:101], v[170:173], v[208:211]
    v_sub_f32 v203, v203, v248
    v_exp_f32 v203, v203
    v_cvt_pk_bf16_f32 v194, v200, v201
    v_cvt_pk_bf16_f32 v181, v202, v203
    ds_read_b128 v[200:203], v246 offset:128
    v_sub_f32 v204, v204, v248
    v_exp_f32 v204, v204
    v_sub_f32 v205, v205, v248
    v_exp_f32 v205, v205
    v_sub_f32 v206, v206, v248
    v_exp_f32 v206, v206
    s_waitcnt lgkmcnt(1)
    v_mfma_f32_16x16x32_bf16 v[196:199], v[120:123], v[168:171], v[196:199]
    v_sub_f32 v207, v207, v248
    v_cvt_pk_bf16_f32 v195, v204, v205
    v_mfma_f32_16x16x32_bf16 v[196:199], v[122:125], v[170:173], v[196:199]
    v_exp_f32 v207, v207
    v_mfma_f32_16x16x32_bf16 v[212:215], v[16:19], v[192:195], v[212:215]
    v_cvt_pk_bf16_f32 v182, v206, v207
    v_sub_f32 v208, v208, v248
    v_mfma_f32_16x16x32_bf16 v[216:219], v[46:49], v[192:195], v[216:219]
    ds_read_b128 v[204:207], v244 offset:0
    v_sub_f32 v209, v209, v248
    v_mfma_f32_16x16x32_bf16 v[220:223], v[76:79], v[192:195], v[220:223]
    v_exp_f32 v208, v208
    v_mfma_f32_16x16x32_bf16 v[224:227], a[248:251], v[192:195], v[224:227]
    s_waitcnt lgkmcnt(1)
    v_exp_f32 v209, v209
    v_mfma_f32_16x16x32_bf16 v[212:215], v[20:23], v[180:183], v[212:215]
    v_cvt_pk_bf16_f32 v186, v208, v209
    v_sub_f32 v196, v196, v248
    v_mfma_f32_16x16x32_bf16 v[216:219], v[50:53], v[180:183], v[216:219]
    ds_read_b128 v[208:211], v245 offset:0
    v_sub_f32 v197, v197, v248
    v_mfma_f32_16x16x32_bf16 v[220:223], v[80:83], v[180:183], v[220:223]
    v_exp_f32 v196, v196
    v_mfma_f32_16x16x32_bf16 v[224:227], a[248:251], v[180:183], v[224:227]
    v_exp_f32 v197, v197
    v_mfma_f32_16x16x32_bf16 v[200:203], v[144:147], v[168:171], v[200:203]
    ds_read_b64 v[168:169], v247 offset:49152
    v_cvt_pk_bf16_f32 v184, v196, v197
    v_mfma_f32_16x16x32_bf16 v[200:203], v[146:149], v[170:173], v[200:203]
    ds_read_b128 v[196:199], v246 offset:0
    s_waitcnt lgkmcnt(3)
    v_mfma_f32_16x16x32_bf16 v[204:207], v[156:159], v[174:177], v[204:207]
    ds_read_b64 v[170:171], v247 offset:49280
    ds_read_b64 v[172:173], v247 offset:49408
    v_mfma_f32_16x16x32_bf16 v[204:207], v[158:161], v[176:179], v[204:207]
    s_nop 1
    v_sub_f32 v200, v200, v248
    v_exp_f32 v200, v200
    v_sub_f32 v201, v201, v248
    v_exp_f32 v201, v201
    s_nop 0
    s_waitcnt lgkmcnt(4)
    v_mfma_f32_16x16x32_bf16 v[208:211], v[114:117], v[174:177], v[208:211]
    v_cvt_pk_bf16_f32 v185, v200, v201
    v_max_f32 v248, v204, v205
    v_mfma_f32_16x16x32_bf16 v[208:211], v[116:119], v[176:179], v[208:211]
    ds_read_b128 v[200:203], v244 offset:64
    v_max3_f32 v248, v248, v206, v207
    v_mfma_f32_16x16x32_bf16 v[212:215], v[24:27], v[184:187], v[212:215]
    ds_read_b128 v[204:207], v245 offset:64
    v_mfma_f32_16x16x32_bf16 v[216:219], v[54:57], v[184:187], v[216:219]
    v_mfma_f32_16x16x32_bf16 v[220:223], v[84:87], v[184:187], v[220:223]
    s_waitcnt lgkmcnt(4)
    v_mfma_f32_16x16x32_bf16 v[224:227], a[248:251], v[184:187], v[224:227]
    v_max3_f32 v248, v248, v208, v209
    v_max3_f32 v248, v248, v210, v211
    v_mfma_f32_16x16x32_bf16 v[196:199], v[138:141], v[174:177], v[196:199]
    ds_read_b128 v[208:211], v246 offset:64
    v_mov_b32 v186, 0
    v_mfma_f32_16x16x32_bf16 v[196:199], v[140:143], v[176:179], v[196:199]
    s_nop 1
    v_rcp_f32 v225, v224
    s_nop 0
    v_mul_f32 v212, v212, v225
    v_mul_f32 v213, v213, v225
    v_mul_f32 v214, v214, v225
    v_mul_f32 v215, v215, v225
    s_waitcnt lgkmcnt(2)
    v_mfma_f32_16x16x32_bf16 v[200:203], v[96:99], v[174:177], v[200:203]
    v_cvt_pk_bf16_f32 v212, v212, v213
    v_cvt_pk_bf16_f32 v213, v214, v215
    v_mfma_f32_16x16x32_bf16 v[200:203], v[98:101], v[176:179], v[200:203]
    s_waitcnt lgkmcnt(1)
    v_mul_f32 v216, v216, v225
    v_mul_f32 v217, v217, v225
    v_mfma_f32_16x16x32_bf16 v[204:207], v[120:123], v[174:177], v[204:207]
    ds_write_b64 v247, v[212:213] offset:36864
    v_mfma_f32_16x16x32_bf16 v[204:207], v[122:125], v[176:179], v[204:207]
    v_mul_f32 v218, v218, v225
    v_mul_f32 v219, v219, v225
    v_cvt_pk_bf16_f32 v216, v216, v217
    v_cvt_pk_bf16_f32 v217, v218, v219
    s_waitcnt lgkmcnt(1)
    v_mfma_f32_16x16x32_bf16 v[208:211], v[144:147], v[174:177], v[208:211]
    ds_write_b64 v247, v[216:217] offset:36992
    v_mfma_f32_16x16x32_bf16 v[208:211], v[146:149], v[176:179], v[208:211]
    v_mul_f32 v220, v220, v225
    v_mul_f32 v221, v221, v225
    v_mul_f32 v222, v222, v225
    v_mul_f32 v223, v223, v225
    v_cvt_pk_bf16_f32 v220, v220, v221
    v_cvt_pk_bf16_f32 v221, v222, v223
    ds_write_b64 v247, v[220:221] offset:37120
    v_max3_f32 v248, v248, v196, v197
    v_max3_f32 v248, v248, v198, v199
    ds_read_b128 v[196:199], v244 offset:0
    v_max3_f32 v248, v248, v200, v201
    v_max3_f32 v248, v248, v202, v203
    ds_read_b128 v[200:203], v245 offset:0
    v_max3_f32 v248, v248, v204, v205
    v_max3_f32 v248, v248, v206, v207
    ds_read_b128 v[204:207], v246 offset:0
    v_max3_f32 v248, v248, v208, v209
    v_max3_f32 v248, v248, v210, v211
    ds_read_b128 v[208:211], v244 offset:64
    v_mov_b32 v225, v248
    s_nop 1
    v_permlane16_swap_b32 v248, v225
    v_max_f32 v248, v248, v225
    v_mov_b32 v225, v248
    s_nop 1
    v_permlane32_swap_b32 v248, v225
    v_max_f32 v248, v248, v225
    s_waitcnt lgkmcnt(3)
    v_mfma_f32_16x16x32_bf16 v[196:199], v[156:159], v[174:177], v[196:199]
    v_mfma_f32_16x16x32_bf16 v[196:199], v[158:161], v[176:179], v[196:199]
    s_waitcnt lgkmcnt(2)
    v_mfma_f32_16x16x32_bf16 v[200:203], v[114:117], v[174:177], v[200:203]
    s_waitcnt lgkmcnt(1)
    v_mfma_f32_16x16x32_bf16 v[200:203], v[116:119], v[176:179], v[200:203]
    v_mfma_f32_16x16x32_bf16 v[204:207], v[138:141], v[174:177], v[204:207]
    s_waitcnt lgkmcnt(0)
    v_mfma_f32_16x16x32_bf16 v[204:207], v[140:143], v[176:179], v[204:207]
    v_mfma_f32_16x16x32_bf16 v[208:211], v[96:99], v[174:177], v[208:211]
    v_sub_f32 v196, v196, v248
    v_sub_f32 v197, v197, v248
    v_mfma_f32_16x16x32_bf16 v[208:211], v[98:101], v[176:179], v[208:211]
    v_exp_f32 v196, v196
    v_exp_f32 v197, v197
    v_sub_f32 v198, v198, v248
    v_exp_f32 v198, v198
    v_sub_f32 v199, v199, v248
    v_exp_f32 v199, v199
    v_cvt_pk_bf16_f32 v190, v196, v197
    v_cvt_pk_bf16_f32 v193, v198, v199
    ds_read_b128 v[196:199], v245 offset:64
    v_sub_f32 v200, v200, v248
    v_exp_f32 v200, v200
    v_sub_f32 v201, v201, v248
    v_exp_f32 v201, v201
    v_sub_f32 v202, v202, v248
    v_exp_f32 v202, v202
    v_sub_f32 v203, v203, v248
    v_exp_f32 v203, v203
    v_cvt_pk_bf16_f32 v188, v200, v201
    v_cvt_pk_bf16_f32 v191, v202, v203
    ds_read_b128 v[200:203], v246 offset:64
    v_sub_f32 v204, v204, v248
    v_exp_f32 v204, v204
    v_sub_f32 v205, v205, v248
    v_exp_f32 v205, v205
    v_sub_f32 v206, v206, v248
    v_exp_f32 v206, v206
    v_sub_f32 v207, v207, v248
    v_exp_f32 v207, v207
    v_cvt_pk_bf16_f32 v189, v204, v205
    v_cvt_pk_bf16_f32 v192, v206, v207
    s_waitcnt lgkmcnt(1)
    v_mfma_f32_16x16x32_bf16 v[212:215], v[18:21], v[188:191], 0
    v_sub_f32 v208, v208, v248
    v_sub_f32 v209, v209, v248
    v_mfma_f32_16x16x32_bf16 v[216:219], v[48:51], v[188:191], 0
    v_exp_f32 v208, v208
    v_mfma_f32_16x16x32_bf16 v[220:223], v[78:81], v[188:191], 0
    v_exp_f32 v209, v209
    v_mfma_f32_16x16x32_bf16 v[224:227], a[248:251], v[188:191], 0
    v_sub_f32 v210, v210, v248
    v_sub_f32 v211, v211, v248
    v_mfma_f32_16x16x32_bf16 v[196:199], v[120:123], v[174:177], v[196:199]
    s_waitcnt lgkmcnt(0)
    v_exp_f32 v210, v210
    v_mfma_f32_16x16x32_bf16 v[196:199], v[122:125], v[176:179], v[196:199]
    v_exp_f32 v211, v211
    v_mfma_f32_16x16x32_bf16 v[200:203], v[144:147], v[174:177], v[200:203]
    ds_read_b64 v[174:175], v247 offset:55296
    v_cvt_pk_bf16_f32 v180, v208, v209
    v_mfma_f32_16x16x32_bf16 v[200:203], v[146:149], v[176:179], v[200:203]
    ds_read_b64 v[176:177], v247 offset:55424
    ds_read_b64 v[178:179], v247 offset:55552
    v_cvt_pk_bf16_f32 v183, v210, v211
    v_sub_f32 v196, v196, v248
    v_exp_f32 v196, v196
    v_sub_f32 v197, v197, v248
    v_exp_f32 v197, v197
    v_sub_f32 v198, v198, v248
    v_exp_f32 v198, v198
    v_sub_f32 v199, v199, v248
    v_exp_f32 v199, v199
    v_cvt_pk_bf16_f32 v194, v196, v197
    v_cvt_pk_bf16_f32 v181, v198, v199
    v_sub_f32 v200, v200, v248
    v_exp_f32 v200, v200
    v_sub_f32 v201, v201, v248
    v_exp_f32 v201, v201
    v_sub_f32 v202, v202, v248
    v_exp_f32 v202, v202
    v_sub_f32 v203, v203, v248
    v_exp_f32 v203, v203
    v_cvt_pk_bf16_f32 v195, v200, v201
    v_cvt_pk_bf16_f32 v182, v202, v203
    v_mbcnt_lo_u32_b32 v208, -1, 0
    v_mfma_f32_16x16x32_bf16 v[212:215], v[22:25], v[192:195], v[212:215]
    v_mbcnt_hi_u32_b32 v208, -1, v208
    v_bfe_u32 v204, v208, 2, 1
    v_mfma_f32_16x16x32_bf16 v[216:219], v[52:55], v[192:195], v[216:219]
    v_lshrrev_b32 v205, 1, v208
    v_and_b32 v205, 4, v205
    v_mfma_f32_16x16x32_bf16 v[220:223], v[82:85], v[192:195], v[220:223]
    v_and_or_b32 v205, v208, 3, v205
    v_bfe_u32 v209, v208, 3, 1
    v_mfma_f32_16x16x32_bf16 v[224:227], a[248:251], v[192:195], v[224:227]
    v_lshrrev_b32 v208, 4, v208
    v_sub_u32 v206, v208, v204
    v_mfma_f32_16x16x32_bf16 v[212:215], v[26:29], v[180:183], v[212:215]
    v_mul_i32_i24 v206, 0x1c0, v206
    v_lshlrev_b32 v207, 4, v205
    v_mfma_f32_16x16x32_bf16 v[216:219], v[56:59], v[180:183], v[216:219]
    v_sub_u32 v206, v206, v207
    v_add_u32 v206, s37, v206
    v_mfma_f32_16x16x32_bf16 v[220:223], v[86:89], v[180:183], v[220:223]
    v_sub_u32 v207, v208, v204
    v_add_u32 v244, 0, v207
    v_mfma_f32_16x16x32_bf16 v[224:227], a[248:251], v[180:183], v[224:227]
    v_cmp_gt_u32 vcc, 7, v244
    v_add_u32 v244, 0xfffdc870, v206
    v_add_u32 v245, 4, v207
    v_cndmask_b32 v244, 0, v244, vcc
    v_add_u32 v244, 0x237c0, v244
    v_cmp_gt_u32 vcc, 7, v245
    v_add_u32 v245, 0xfffdcf70, v206
    v_add_u32 v246, 8, v207
    v_rcp_f32 v225, v224
    v_cndmask_b32 v245, 0, v245, vcc
    v_mul_f32 v212, v212, v225
    v_mul_f32 v213, v213, v225
    v_mul_f32 v214, v214, v225
    v_mul_f32 v215, v215, v225
    v_cvt_pk_bf16_f32 v212, v212, v213
    v_cvt_pk_bf16_f32 v213, v214, v215
    ds_write_b64 v247, v[212:213] offset:43008
    v_mul_f32 v216, v216, v225
    v_mul_f32 v217, v217, v225
    v_mul_f32 v218, v218, v225
    v_mul_f32 v219, v219, v225
    v_cvt_pk_bf16_f32 v216, v216, v217
    v_cvt_pk_bf16_f32 v217, v218, v219
    ds_write_b64 v247, v[216:217] offset:43136
    v_mul_f32 v220, v220, v225
    v_mul_f32 v221, v221, v225
    v_mul_f32 v222, v222, v225
    v_mul_f32 v223, v223, v225
    v_cvt_pk_bf16_f32 v220, v220, v221
    v_cvt_pk_bf16_f32 v221, v222, v223
    ds_write_b64 v247, v[220:221] offset:43264
    v_add_u32 v245, 0x237c0, v245
    v_cmp_gt_u32 vcc, 7, v246
    v_add_u32 v246, 0xfffdd670, v206
    v_xor_b32 v209, 1, v209
    v_cndmask_b32 v246, 0, v246, vcc
    v_add_u32 v246, 0x237c0, v246
    v_mul_u32_u24 v246, 0xc0, v209
    v_add_u32 v244, v244, v246
    ds_read_b128 v[204:207], v244 offset:0
    ds_read_b128 v[196:199], v244 offset:64
    v_add_u32 v245, v245, v246
    ds_read_b128 v[208:211], v245 offset:0
    ds_read_b128 v[200:203], v245 offset:64
    v_mov_b32 v189, 0
    v_mov_b32 v192, 0
    v_mov_b32 v195, 0
    v_mov_b32 v182, 0
    s_waitcnt lgkmcnt(3)
    v_mfma_f32_16x16x32_bf16 v[204:207], v[102:105], v[168:171], v[204:207]
    v_mfma_f32_16x16x32_bf16 v[204:207], v[104:107], v[170:173], v[204:207]
    s_waitcnt lgkmcnt(2)
    v_mfma_f32_16x16x32_bf16 v[196:199], v[108:111], v[168:171], v[196:199]
    s_waitcnt lgkmcnt(1)
    v_mfma_f32_16x16x32_bf16 v[208:211], v[126:129], v[168:171], v[208:211]
    s_waitcnt lgkmcnt(0)
    v_mfma_f32_16x16x32_bf16 v[208:211], v[128:131], v[170:173], v[208:211]
    v_mfma_f32_16x16x32_bf16 v[196:199], v[110:113], v[170:173], v[196:199]
    v_mfma_f32_16x16x32_bf16 v[200:203], v[132:135], v[168:171], v[200:203]
    v_max_f32 v248, v204, v205
    v_max3_f32 v248, v248, v206, v207
    v_mfma_f32_16x16x32_bf16 v[200:203], v[134:137], v[170:173], v[200:203]
    ds_read_b128 v[204:207], v244 offset:128
    v_mfma_f32_16x16x32_bf16 v[228:231], a[144:147], a[232:235], 0
    v_mfma_f32_16x16x32_bf16 v[228:231], a[148:151], a[236:239], v[228:231]
    v_max3_f32 v248, v248, v208, v209
    v_max3_f32 v248, v248, v210, v211
    v_mfma_f32_16x16x32_bf16 v[228:231], a[152:155], a[240:243], v[228:231]
    ds_read_b128 v[208:211], v245 offset:128
    v_max3_f32 v248, v248, v196, v197
    v_mfma_f32_16x16x32_bf16 v[228:231], a[156:159], a[244:247], v[228:231]
    v_max3_f32 v248, v248, v198, v199
    v_max3_f32 v248, v248, v200, v201
    v_mfma_f32_16x16x32_bf16 v[228:231], a[160:163], a[216:219], v[228:231]
    ds_read_b128 v[196:199], v244 offset:192
    v_max3_f32 v248, v248, v202, v203
    v_mfma_f32_16x16x32_bf16 v[228:231], a[164:167], a[220:223], v[228:231]
    ds_read_b128 v[200:203], v245 offset:192
    v_mfma_f32_16x16x32_bf16 v[232:235], a[168:171], a[232:235], 0
    v_mfma_f32_16x16x32_bf16 v[232:235], a[172:175], a[236:239], v[232:235]
    v_mfma_f32_16x16x32_bf16 v[232:235], a[176:179], a[240:243], v[232:235]
    s_waitcnt lgkmcnt(3)
    v_mfma_f32_16x16x32_bf16 v[204:207], v[162:165], v[168:171], v[204:207]
    v_mfma_f32_16x16x32_bf16 v[204:207], v[164:167], v[170:173], v[204:207]
    v_mfma_f32_16x16x32_bf16 v[232:235], a[180:183], a[244:247], v[232:235]
    s_waitcnt lgkmcnt(2)
    v_cvt_pk_bf16_f32 v228, v228, v229
    v_cvt_pk_bf16_f32 v229, v230, v231
    v_mfma_f32_16x16x32_bf16 v[208:211], v[90:93], v[168:171], v[208:211]
    ds_write_b64 v249, v[228:229] offset:12288
    v_mfma_f32_16x16x32_bf16 v[208:211], v[92:95], v[170:173], v[208:211]
    s_waitcnt lgkmcnt(1)
    v_max3_f32 v248, v248, v204, v205
    v_max3_f32 v248, v248, v206, v207
    v_mfma_f32_16x16x32_bf16 v[196:199], v[114:117], v[168:171], v[196:199]
    ds_read_b128 v[204:207], v244 offset:0
    v_mfma_f32_16x16x32_bf16 v[196:199], v[116:119], v[170:173], v[196:199]
    v_mfma_f32_16x16x32_bf16 v[200:203], v[138:141], v[168:171], v[200:203]
    v_mfma_f32_16x16x32_bf16 v[200:203], v[140:143], v[170:173], v[200:203]
    v_max3_f32 v248, v248, v208, v209
    v_max3_f32 v248, v248, v210, v211
    v_mfma_f32_16x16x32_bf16 v[232:235], a[184:187], a[216:219], v[232:235]
    ds_read_b128 v[208:211], v245 offset:0
    v_mfma_f32_16x16x32_bf16 v[232:235], a[188:191], a[220:223], v[232:235]
    v_mfma_f32_16x16x32_bf16 v[236:239], a[192:195], a[232:235], 0
    v_max3_f32 v248, v248, v196, v197
    v_mfma_f32_16x16x32_bf16 v[236:239], a[196:199], a[236:239], v[236:239]
    ds_read_b128 v[196:199], v244 offset:64
    v_max3_f32 v248, v248, v200, v201
    v_mfma_f32_16x16x32_bf16 v[236:239], a[200:203], a[240:243], v[236:239]
    ds_read_b128 v[200:203], v245 offset:64
    v_mov_b32 v225, v248
    v_mfma_f32_16x16x32_bf16 v[236:239], a[204:207], a[244:247], v[236:239]
    s_waitcnt lgkmcnt(3)
    v_cvt_pk_bf16_f32 v232, v232, v233
    v_cvt_pk_bf16_f32 v233, v234, v235
    v_mfma_f32_16x16x32_bf16 v[204:207], v[102:105], v[168:171], v[204:207]
    ds_write_b64 v249, v[232:233] offset:12416
    v_mfma_f32_16x16x32_bf16 v[204:207], v[104:107], v[170:173], v[204:207]
    v_permlane16_swap_b32 v248, v225
    v_max_f32 v248, v248, v225
    v_mfma_f32_16x16x32_bf16 v[236:239], a[208:211], a[216:219], v[236:239]
    s_waitcnt lgkmcnt(3)
    v_mov_b32 v225, v248
    v_mfma_f32_16x16x32_bf16 v[208:211], v[126:129], v[168:171], v[208:211]
    v_mfma_f32_16x16x32_bf16 v[208:211], v[128:131], v[170:173], v[208:211]
    v_permlane32_swap_b32 v248, v225
    v_max_f32 v248, v248, v225
    v_mfma_f32_16x16x32_bf16 v[236:239], a[212:215], a[220:223], v[236:239]
    s_waitcnt lgkmcnt(2)
    v_sub_f32 v204, v204, v248
    v_sub_f32 v205, v205, v248
    v_mfma_f32_16x16x32_bf16 v[196:199], v[108:111], v[168:171], v[196:199]
    s_waitcnt lgkmcnt(1)
    v_exp_f32 v204, v204
    v_mfma_f32_16x16x32_bf16 v[196:199], v[110:113], v[170:173], v[196:199]
    v_exp_f32 v205, v205
    v_mfma_f32_16x16x32_bf16 v[200:203], v[132:135], v[168:171], v[200:203]
    v_cvt_pk_bf16_f32 v236, v236, v237
    v_cvt_pk_bf16_f32 v237, v238, v239
    v_mfma_f32_16x16x32_bf16 v[200:203], v[134:137], v[170:173], v[200:203]
    ds_write_b64 v249, v[236:237] offset:12544
    v_sub_f32 v206, v206, v248
    v_exp_f32 v206, v206
    v_sub_f32 v207, v207, v248
    v_exp_f32 v207, v207
    v_cvt_pk_bf16_f32 v184, v204, v205
    v_cvt_pk_bf16_f32 v187, v206, v207
    ds_read_b128 v[204:207], v244 offset:128
    v_sub_f32 v208, v208, v248
    v_exp_f32 v208, v208
    v_sub_f32 v209, v209, v248
    v_exp_f32 v209, v209
    v_sub_f32 v210, v210, v248
    v_exp_f32 v210, v210
    v_sub_f32 v211, v211, v248
    v_exp_f32 v211, v211
    v_cvt_pk_bf16_f32 v185, v208, v209
    v_cvt_pk_bf16_f32 v188, v210, v211
    ds_read_b128 v[208:211], v245 offset:128
    v_mfma_f32_16x16x32_bf16 v[212:215], v[0:3], v[184:187], 0
    s_waitcnt lgkmcnt(2)
    s_barrier
    v_sub_f32 v196, v196, v248
    v_mfma_f32_16x16x32_bf16 v[216:219], v[30:33], v[184:187], 0
    ds_read_b128 a[224:227], v242 offset:30720
    ds_read_b128 a[228:231], v243 offset:30720
    v_mfma_f32_16x16x32_bf16 v[220:223], v[60:63], v[184:187], 0
    ds_read_b128 a[232:235], v242 offset:30848
    ds_read_b128 a[236:239], v243 offset:30848
    v_mfma_f32_16x16x32_bf16 v[224:227], a[248:251], v[184:187], 0
    s_waitcnt lgkmcnt(5)
    ds_read_b128 a[240:243], v242 offset:30976
    v_mfma_f32_16x16x32_bf16 v[204:207], v[162:165], v[168:171], v[204:207]
    ds_read_b128 a[244:247], v243 offset:30976
    ds_read_b128 a[216:219], v242 offset:36864
    v_mfma_f32_16x16x32_bf16 v[204:207], v[164:167], v[170:173], v[204:207]
    ds_read_b128 a[220:223], v243 offset:36864
    ds_read_b128 a[252:255], v252 offset:0
    ds_read_b64 v[254:255], v253 offset:256
    v_exp_f32 v196, v196
    v_sub_f32 v197, v197, v248
    v_exp_f32 v197, v197
    s_waitcnt lgkmcnt(10)
    v_mfma_f32_16x16x32_bf16 v[208:211], v[90:93], v[168:171], v[208:211]
    v_sub_f32 v198, v198, v248
    v_sub_f32 v199, v199, v248
    v_mfma_f32_16x16x32_bf16 v[208:211], v[92:95], v[170:173], v[208:211]
    v_exp_f32 v198, v198
    s_waitcnt lgkmcnt(9)
    v_mfma_f32_16x16x32_bf16 v[228:231], a[144:147], a[224:227], 0
    s_waitcnt lgkmcnt(8)
    v_exp_f32 v199, v199
    v_mfma_f32_16x16x32_bf16 v[228:231], a[148:151], a[228:231], v[228:231]
    s_waitcnt lgkmcnt(7)
    v_cvt_pk_bf16_f32 v190, v196, v197
    v_cvt_pk_bf16_f32 v193, v198, v199
    v_mfma_f32_16x16x32_bf16 v[228:231], a[152:155], a[232:235], v[228:231]
    ds_read_b128 v[196:199], v244 offset:192
    v_sub_f32 v200, v200, v248
    v_mfma_f32_16x16x32_bf16 v[232:235], a[168:171], a[224:227], 0
    s_waitcnt lgkmcnt(6)
    v_exp_f32 v200, v200
    v_mfma_f32_16x16x32_bf16 v[228:231], a[156:159], a[236:239], v[228:231]
    v_sub_f32 v201, v201, v248
    v_sub_f32 v202, v202, v248
    v_mfma_f32_16x16x32_bf16 v[228:231], a[160:163], a[240:243], v[228:231]
    s_waitcnt lgkmcnt(4)
    v_exp_f32 v201, v201
    v_mfma_f32_16x16x32_bf16 v[228:231], a[164:167], a[244:247], v[228:231]
    v_exp_f32 v202, v202
    v_mfma_f32_16x16x32_bf16 v[232:235], a[172:175], a[228:231], v[232:235]
    s_waitcnt lgkmcnt(2)
    v_sub_f32 v203, v203, v248
    s_waitcnt lgkmcnt(1)
    v_mfma_f32_16x16x32_bf16 v[232:235], a[176:179], a[232:235], v[232:235]
    buffer_store_dwordx4 a[252:255], v250, s[20:23], 0 offen nt
    v_mfma_f32_16x16x32_bf16 v[232:235], a[180:183], a[236:239], v[232:235]
    v_cvt_pk_bf16_f32 v228, v228, v229
    v_cvt_pk_bf16_f32 v229, v230, v231
    v_mfma_f32_16x16x32_bf16 v[232:235], a[184:187], a[240:243], v[232:235]
    ds_write_b64 v249, v[228:229] offset:18432
    v_mfma_f32_16x16x32_bf16 v[232:235], a[188:191], a[244:247], v[232:235]
    buffer_store_dwordx2 v[254:255], v251, s[20:23], 0 offen offset:256 nt
    v_mfma_f32_16x16x32_bf16 v[236:239], a[192:195], a[224:227], 0
    ds_read_b128 a[224:227], v242 offset:36992
    v_mbcnt_lo_u32_b32 v254, -1, 0
    v_mfma_f32_16x16x32_bf16 v[236:239], a[196:199], a[228:231], v[236:239]
    ds_read_b128 a[228:231], v243 offset:36992
    v_mbcnt_hi_u32_b32 v254, -1, v254
    v_mfma_f32_16x16x32_bf16 v[236:239], a[200:203], a[232:235], v[236:239]
    ds_read_b128 a[232:235], v242 offset:37120
    v_cvt_pk_bf16_f32 v232, v232, v233
    v_mfma_f32_16x16x32_bf16 v[236:239], a[204:207], a[236:239], v[236:239]
    ds_read_b128 a[236:239], v243 offset:37120
    v_cvt_pk_bf16_f32 v233, v234, v235
    v_mfma_f32_16x16x32_bf16 v[236:239], a[208:211], a[240:243], v[236:239]
    ds_write_b64 v249, v[232:233] offset:18560
    v_mfma_f32_16x16x32_bf16 v[236:239], a[212:215], a[244:247], v[236:239]
    s_waitcnt lgkmcnt(6)
    ds_read_b128 a[240:243], v242 offset:43008
    v_mfma_f32_16x16x32_bf16 v[196:199], v[114:117], v[168:171], v[196:199]
    ds_read_b128 a[244:247], v243 offset:43008
    v_lshrrev_b32 v255, 4, v254
    v_mfma_f32_16x16x32_bf16 v[196:199], v[116:119], v[170:173], v[196:199]
    v_and_b32 v251, 2, v255
    v_lshlrev_b32 v251, 1, v251
    v_cvt_pk_bf16_f32 v236, v236, v237
    v_cvt_pk_bf16_f32 v237, v238, v239
    ds_write_b64 v249, v[236:237] offset:18688
    v_mul_i32_i24 v251, s30, v251
    v_and_b32 v250, 1, v255
    v_mad_i32_i24 v250, v250, s31, v251
    v_add_u32 v250, s53, v250
    v_and_b32 v254, 15, v254
    v_lshl_add_u32 v251, v254, 3, v250
    v_lshlrev_b32 v255, 3, v255
    v_and_b32 v255, 8, v255
    v_xor_b32 v254, v254, v255
    v_lshl_add_u32 v250, v254, 4, v250
    ds_read_b128 a[252:255], v252 offset:6144
    ds_read_b64 v[254:255], v253 offset:6400
    s_mul_i32 s53, s31, 4
    s_add_u32 s52, s52, s53
    v_exp_f32 v203, v203
    v_cvt_pk_bf16_f32 v191, v200, v201
    v_cvt_pk_bf16_f32 v194, v202, v203
    ds_read_b128 v[200:203], v245 offset:192
    v_mfma_f32_16x16x32_bf16 v[212:215], v[4:7], v[188:191], v[212:215]
    v_sub_f32 v204, v204, v248
    v_sub_f32 v205, v205, v248
    v_mfma_f32_16x16x32_bf16 v[216:219], v[34:37], v[188:191], v[216:219]
    v_exp_f32 v204, v204
    v_mfma_f32_16x16x32_bf16 v[220:223], v[64:67], v[188:191], v[220:223]
    v_exp_f32 v205, v205
    v_mfma_f32_16x16x32_bf16 v[224:227], a[248:251], v[188:191], v[224:227]
    v_sub_f32 v206, v206, v248
    v_sub_f32 v207, v207, v248
    v_mfma_f32_16x16x32_bf16 v[212:215], v[8:11], v[192:195], v[212:215]
    v_exp_f32 v206, v206
    v_mfma_f32_16x16x32_bf16 v[216:219], v[38:41], v[192:195], v[216:219]
    s_waitcnt lgkmcnt(2)
    v_exp_f32 v207, v207
    v_mfma_f32_16x16x32_bf16 v[220:223], v[68:71], v[192:195], v[220:223]
    buffer_store_dwordx4 a[252:255], v250, s[20:23], 0 offen nt
    v_mfma_f32_16x16x32_bf16 v[224:227], a[248:251], v[192:195], v[224:227]
    s_waitcnt lgkmcnt(0)
    ds_read_b128 a[252:255], v252 offset:12288
    v_mfma_f32_16x16x32_bf16 v[200:203], v[138:141], v[168:171], v[200:203]
    v_cvt_pk_bf16_f32 v180, v204, v205
    v_cvt_pk_bf16_f32 v183, v206, v207
    v_mfma_f32_16x16x32_bf16 v[200:203], v[140:143], v[170:173], v[200:203]
    buffer_store_dwordx2 v[254:255], v251, s[20:23], 0 offen offset:256 nt
    v_mbcnt_lo_u32_b32 v254, -1, 0
    v_mbcnt_hi_u32_b32 v254, -1, v254
    v_lshrrev_b32 v255, 4, v254
    v_mul_i32_i24 v250, s31, v255
    v_add_u32 v250, s55, v250
    v_and_b32 v254, 15, v254
    v_lshl_add_u32 v251, v254, 3, v250
    v_lshlrev_b32 v255, 3, v255
    v_and_b32 v255, 8, v255
    v_xor_b32 v254, v254, v255
    v_lshl_add_u32 v250, v254, 4, v250
    ds_read_b64 v[254:255], v253 offset:12544
    s_mov_b32 s55, 15
    v_sub_f32 v208, v208, v248
    v_exp_f32 v208, v208
    v_sub_f32 v209, v209, v248
    v_exp_f32 v209, v209
    v_sub_f32 v210, v210, v248
    s_waitcnt lgkmcnt(1)
    buffer_store_dwordx4 a[252:255], v250, s[20:23], 0 offen nt
    v_exp_f32 v210, v210
    v_sub_f32 v211, v211, v248
    v_add_u32 v250, s57, v250
    v_exp_f32 v211, v211
    v_cvt_pk_bf16_f32 v181, v208, v209
    v_cvt_pk_bf16_f32 v184, v210, v211
    v_sub_f32 v196, v196, v248
    v_mfma_f32_16x16x32_bf16 v[212:215], v[12:15], v[180:183], v[212:215]
    v_exp_f32 v196, v196
    v_mfma_f32_16x16x32_bf16 v[216:219], v[42:45], v[180:183], v[216:219]
    v_sub_f32 v197, v197, v248
    s_waitcnt lgkmcnt(0)
    v_mfma_f32_16x16x32_bf16 v[220:223], v[72:75], v[180:183], v[220:223]
    buffer_store_dwordx2 v[254:255], v251, s[20:23], 0 offen offset:256 nt
    v_mfma_f32_16x16x32_bf16 v[224:227], a[248:251], v[180:183], v[224:227]
    v_add_u32 v251, s57, v251
    s_lshr_b32 s57, s28, 1
    s_lshl2_add_u32 s57, s57, 3
    s_mul_i32 s57, s57, s31
    s_add_u32 s56, s56, s57
    s_add_u32 s56, s56, s32
    v_exp_f32 v197, v197
    v_sub_f32 v200, v200, v248
    v_cvt_pk_bf16_f32 v186, v196, v197
    v_exp_f32 v200, v200
    v_sub_f32 v201, v201, v248
    v_exp_f32 v201, v201
    v_mov_b32 v185, 0
    v_cvt_pk_bf16_f32 v187, v200, v201
    v_sub_u32 v244, v244, v246
    ds_read_b128 v[204:207], v244 offset:0
    v_mfma_f32_16x16x32_bf16 v[212:215], v[16:19], v[184:187], v[212:215]
    ds_read_b128 v[196:199], v244 offset:64
    v_sub_u32 v245, v245, v246
    v_mfma_f32_16x16x32_bf16 v[216:219], v[46:49], v[184:187], v[216:219]
    ds_read_b128 v[208:211], v245 offset:0
    ds_read_b128 v[200:203], v245 offset:64
    v_mfma_f32_16x16x32_bf16 v[220:223], v[76:79], v[184:187], v[220:223]
    v_mov_b32 v190, 0
    v_mov_b32 v193, 0
    v_mfma_f32_16x16x32_bf16 v[224:227], a[248:251], v[184:187], v[224:227]
    v_mov_b32 v180, 0
    v_mov_b32 v183, 0
    v_mov_b32 v186, 0
    s_nop 4
    v_rcp_f32 v225, v224
    s_nop 0
    v_mul_f32 v212, v212, v225
    v_mul_f32 v213, v213, v225
    v_mul_f32 v214, v214, v225
    v_mul_f32 v215, v215, v225
    v_cvt_pk_bf16_f32 v212, v212, v213
    v_cvt_pk_bf16_f32 v213, v214, v215
    s_waitcnt lgkmcnt(3)
    v_mfma_f32_16x16x32_bf16 v[204:207], v[162:165], v[174:177], v[204:207]
    ds_write_b64 v247, v[212:213] offset:49152
    v_mfma_f32_16x16x32_bf16 v[204:207], v[164:167], v[176:179], v[204:207]
    s_waitcnt lgkmcnt(3)
    v_mul_f32 v216, v216, v225
    v_mul_f32 v217, v217, v225
    v_mfma_f32_16x16x32_bf16 v[196:199], v[114:117], v[174:177], v[196:199]
    s_waitcnt lgkmcnt(2)
    v_mul_f32 v218, v218, v225
    v_mul_f32 v219, v219, v225
    v_mfma_f32_16x16x32_bf16 v[208:211], v[90:93], v[174:177], v[208:211]
    s_waitcnt lgkmcnt(1)
    v_cvt_pk_bf16_f32 v216, v216, v217
    v_cvt_pk_bf16_f32 v217, v218, v219
    v_mfma_f32_16x16x32_bf16 v[208:211], v[92:95], v[176:179], v[208:211]
    ds_write_b64 v247, v[216:217] offset:49280
    v_mfma_f32_16x16x32_bf16 v[196:199], v[116:119], v[176:179], v[196:199]
    v_mul_f32 v220, v220, v225
    v_mul_f32 v221, v221, v225
    v_mfma_f32_16x16x32_bf16 v[200:203], v[138:141], v[174:177], v[200:203]
    v_mul_f32 v222, v222, v225
    v_mul_f32 v223, v223, v225
    v_mfma_f32_16x16x32_bf16 v[200:203], v[140:143], v[176:179], v[200:203]
    v_cvt_pk_bf16_f32 v220, v220, v221
    v_cvt_pk_bf16_f32 v221, v222, v223
    v_mfma_f32_16x16x32_bf16 v[228:231], a[144:147], a[216:219], 0
    ds_write_b64 v247, v[220:221] offset:49408
    v_mfma_f32_16x16x32_bf16 v[228:231], a[148:151], a[220:223], v[228:231]
    v_max_f32 v248, v204, v205
    v_max3_f32 v248, v248, v206, v207
    v_mfma_f32_16x16x32_bf16 v[228:231], a[152:155], a[224:227], v[228:231]
    ds_read_b128 v[204:207], v244 offset:128
    v_max3_f32 v248, v248, v208, v209
    v_mfma_f32_16x16x32_bf16 v[228:231], a[156:159], a[228:231], v[228:231]
    v_max3_f32 v248, v248, v210, v211
    v_max3_f32 v248, v248, v196, v197
    v_mfma_f32_16x16x32_bf16 v[228:231], a[160:163], a[232:235], v[228:231]
    ds_read_b128 v[208:211], v245 offset:128
    v_max3_f32 v248, v248, v198, v199
    v_mfma_f32_16x16x32_bf16 v[228:231], a[164:167], a[236:239], v[228:231]
    ds_read_b128 v[196:199], v244 offset:0
    v_max3_f32 v248, v248, v200, v201
    v_mfma_f32_16x16x32_bf16 v[232:235], a[168:171], a[216:219], 0
    v_max3_f32 v248, v248, v202, v203
    v_mfma_f32_16x16x32_bf16 v[232:235], a[172:175], a[220:223], v[232:235]
    ds_read_b128 v[200:203], v245 offset:0
    v_mfma_f32_16x16x32_bf16 v[232:235], a[176:179], a[224:227], v[232:235]
    v_mfma_f32_16x16x32_bf16 v[232:235], a[180:183], a[228:231], v[232:235]
    v_cvt_pk_bf16_f32 v228, v228, v229
    v_cvt_pk_bf16_f32 v229, v230, v231
    v_mfma_f32_16x16x32_bf16 v[232:235], a[184:187], a[232:235], v[232:235]
    ds_write_b64 v249, v[228:229] offset:24576
    v_mfma_f32_16x16x32_bf16 v[232:235], a[188:191], a[236:239], v[232:235]
    s_waitcnt lgkmcnt(4)
    v_mfma_f32_16x16x32_bf16 v[204:207], v[120:123], v[174:177], v[204:207]
    s_waitcnt lgkmcnt(3)
    v_mfma_f32_16x16x32_bf16 v[204:207], v[122:125], v[176:179], v[204:207]
    s_waitcnt lgkmcnt(2)
    v_mfma_f32_16x16x32_bf16 v[208:211], v[144:147], v[174:177], v[208:211]
    v_mfma_f32_16x16x32_bf16 v[208:211], v[146:149], v[176:179], v[208:211]
    s_waitcnt lgkmcnt(1)
    v_cvt_pk_bf16_f32 v232, v232, v233
    v_cvt_pk_bf16_f32 v233, v234, v235
    v_mfma_f32_16x16x32_bf16 v[196:199], v[162:165], v[174:177], v[196:199]
    ds_write_b64 v249, v[232:233] offset:24704
    v_mfma_f32_16x16x32_bf16 v[196:199], v[164:167], v[176:179], v[196:199]
    v_max3_f32 v248, v248, v204, v205
    v_max3_f32 v248, v248, v206, v207
    v_mfma_f32_16x16x32_bf16 v[200:203], v[90:93], v[174:177], v[200:203]
    ds_read_b128 v[204:207], v244 offset:64
    v_max3_f32 v248, v248, v208, v209
    v_mfma_f32_16x16x32_bf16 v[200:203], v[92:95], v[176:179], v[200:203]
    v_max3_f32 v248, v248, v210, v211
    v_mov_b32 v225, v248
    v_mfma_f32_16x16x32_bf16 v[236:239], a[192:195], a[216:219], 0
    ds_read_b128 a[216:219], v242 offset:43136
    ds_read_b128 v[208:211], v245 offset:64
    v_mfma_f32_16x16x32_bf16 v[236:239], a[196:199], a[220:223], v[236:239]
    ds_read_b128 a[220:223], v243 offset:43136
    v_permlane16_swap_b32 v248, v225
    v_mfma_f32_16x16x32_bf16 v[236:239], a[200:203], a[224:227], v[236:239]
    ds_read_b128 a[224:227], v242 offset:43264
    v_max_f32 v248, v248, v225
    v_mfma_f32_16x16x32_bf16 v[236:239], a[204:207], a[228:231], v[236:239]
    ds_read_b128 a[228:231], v243 offset:43264
    v_mov_b32 v225, v248
    v_mfma_f32_16x16x32_bf16 v[236:239], a[208:211], a[232:235], v[236:239]
    v_mfma_f32_16x16x32_bf16 v[236:239], a[212:215], a[236:239], v[236:239]
    v_permlane32_swap_b32 v248, v225
    v_max_f32 v248, v248, v225
    v_mfma_f32_16x16x32_bf16 v[228:231], a[144:147], a[240:243], 0
    v_sub_f32 v196, v196, v248
    v_sub_f32 v197, v197, v248
    v_mfma_f32_16x16x32_bf16 v[228:231], a[148:151], a[244:247], v[228:231]
    s_waitcnt lgkmcnt(5)
    v_exp_f32 v196, v196
    v_mfma_f32_16x16x32_bf16 v[204:207], v[114:117], v[174:177], v[204:207]
    v_cvt_pk_bf16_f32 v236, v236, v237
    v_cvt_pk_bf16_f32 v237, v238, v239
    v_mfma_f32_16x16x32_bf16 v[204:207], v[116:119], v[176:179], v[204:207]
    ds_write_b64 v249, v[236:237] offset:24832
    v_mfma_f32_16x16x32_bf16 v[232:235], a[168:171], a[240:243], 0
    s_waitcnt lgkmcnt(3)
    v_exp_f32 v197, v197
    v_mfma_f32_16x16x32_bf16 v[208:211], v[138:141], v[174:177], v[208:211]
    v_sub_f32 v198, v198, v248
    v_sub_f32 v199, v199, v248
    v_mfma_f32_16x16x32_bf16 v[208:211], v[140:143], v[176:179], v[208:211]
    v_exp_f32 v198, v198
    v_mfma_f32_16x16x32_bf16 v[228:231], a[152:155], a[216:219], v[228:231]
    v_exp_f32 v199, v199
    v_mfma_f32_16x16x32_bf16 v[228:231], a[156:159], a[220:223], v[228:231]
    s_waitcnt lgkmcnt(1)
    v_cvt_pk_bf16_f32 v188, v196, v197
    v_cvt_pk_bf16_f32 v191, v198, v199
    v_mfma_f32_16x16x32_bf16 v[228:231], a[160:163], a[224:227], v[228:231]
    ds_read_b128 v[196:199], v244 offset:128
    v_sub_f32 v200, v200, v248
    v_mfma_f32_16x16x32_bf16 v[228:231], a[164:167], a[228:231], v[228:231]
    v_exp_f32 v200, v200
    v_mfma_f32_16x16x32_bf16 v[232:235], a[172:175], a[244:247], v[232:235]
    s_waitcnt lgkmcnt(1)
    s_barrier
    v_sub_f32 v201, v201, v248
    v_mfma_f32_16x16x32_bf16 v[232:235], a[176:179], a[216:219], v[232:235]
    ds_read_b128 a[232:235], v242 offset:49152
    ds_read_b128 a[236:239], v243 offset:49152
    v_mfma_f32_16x16x32_bf16 v[232:235], a[180:183], a[220:223], v[232:235]
    ds_read_b128 a[252:255], v252 offset:18432
    v_cvt_pk_bf16_f32 v228, v228, v229
    v_mfma_f32_16x16x32_bf16 v[232:235], a[184:187], a[224:227], v[232:235]
    ds_read_b64 v[254:255], v253 offset:18688
    v_cvt_pk_bf16_f32 v229, v230, v231
    v_mfma_f32_16x16x32_bf16 v[232:235], a[188:191], a[228:231], v[232:235]
    ds_write_b64 v249, v[228:229] offset:0
    v_mfma_f32_16x16x32_bf16 v[236:239], a[192:195], a[240:243], 0
    ds_read_b128 a[240:243], v242 offset:49280
    v_sub_f32 v202, v202, v248
    v_mfma_f32_16x16x32_bf16 v[236:239], a[196:199], a[244:247], v[236:239]
    ds_read_b128 a[244:247], v243 offset:49280
    v_sub_f32 v203, v203, v248
    v_mfma_f32_16x16x32_bf16 v[236:239], a[200:203], a[216:219], v[236:239]
    ds_read_b128 a[216:219], v242 offset:49408
    v_cvt_pk_bf16_f32 v232, v232, v233
    v_mfma_f32_16x16x32_bf16 v[236:239], a[204:207], a[220:223], v[236:239]
    ds_read_b128 a[220:223], v243 offset:49408
    v_cvt_pk_bf16_f32 v233, v234, v235
    v_mfma_f32_16x16x32_bf16 v[236:239], a[208:211], a[224:227], v[236:239]
    ds_write_b64 v249, v[232:233] offset:128
    v_mfma_f32_16x16x32_bf16 v[236:239], a[212:215], a[228:231], v[236:239]
    s_waitcnt lgkmcnt(8)
    v_exp_f32 v201, v201
    v_mfma_f32_16x16x32_bf16 v[196:199], v[120:123], v[174:177], v[196:199]
    s_waitcnt lgkmcnt(7)
    s_waitcnt lgkmcnt(6)
    v_cvt_pk_bf16_f32 v189, v200, v201
    v_mfma_f32_16x16x32_bf16 v[196:199], v[122:125], v[176:179], v[196:199]
    buffer_store_dwordx4 a[252:255], v250, s[20:23], 0 offen nt
    v_mfma_f32_16x16x32_bf16 v[212:215], v[12:15], v[188:191], 0
    v_cvt_pk_bf16_f32 v236, v236, v237
    v_cvt_pk_bf16_f32 v237, v238, v239
    v_mfma_f32_16x16x32_bf16 v[216:219], v[42:45], v[188:191], 0
    ds_write_b64 v249, v[236:237] offset:256
    v_mfma_f32_16x16x32_bf16 v[220:223], v[72:75], v[188:191], 0
    buffer_store_dwordx2 v[254:255], v251, s[20:23], 0 offen offset:256 nt
    v_mfma_f32_16x16x32_bf16 v[224:227], a[248:251], v[188:191], 0
    v_add_u32 v250, s52, v250
    v_add_u32 v251, s52, v251
    v_mfma_f32_16x16x32_bf16 v[228:231], a[144:147], a[232:235], 0
    ds_read_b128 a[252:255], v252 offset:24576
    ds_read_b64 v[254:255], v253 offset:24832
    v_mfma_f32_16x16x32_bf16 v[228:231], a[148:151], a[236:239], v[228:231]
    s_lshr_b32 s52, s28, 1
    s_lshl2_add_u32 s52, s52, 11
    v_sub_f32 v204, v204, v248
    v_mfma_f32_16x16x32_bf16 v[232:235], a[168:171], a[232:235], 0
    s_waitcnt lgkmcnt(3)
    v_exp_f32 v202, v202
    v_mfma_f32_16x16x32_bf16 v[228:231], a[152:155], a[240:243], v[228:231]
    v_exp_f32 v203, v203
    v_mfma_f32_16x16x32_bf16 v[228:231], a[156:159], a[244:247], v[228:231]
    v_cvt_pk_bf16_f32 v192, v202, v203
    v_sub_f32 v205, v205, v248
    v_mfma_f32_16x16x32_bf16 v[228:231], a[160:163], a[216:219], v[228:231]
    ds_read_b128 v[200:203], v245 offset:128
    v_sub_f32 v206, v206, v248
    v_mfma_f32_16x16x32_bf16 v[228:231], a[164:167], a[220:223], v[228:231]
    v_exp_f32 v204, v204
    v_mfma_f32_16x16x32_bf16 v[232:235], a[172:175], a[236:239], v[232:235]
    v_exp_f32 v205, v205
    v_mfma_f32_16x16x32_bf16 v[232:235], a[176:179], a[240:243], v[232:235]
    v_exp_f32 v206, v206
    v_mfma_f32_16x16x32_bf16 v[232:235], a[180:183], a[244:247], v[232:235]
    s_waitcnt lgkmcnt(1)
    v_sub_f32 v207, v207, v248
    v_cvt_pk_bf16_f32 v228, v228, v229
    v_mfma_f32_16x16x32_bf16 v[232:235], a[184:187], a[216:219], v[232:235]
    v_cvt_pk_bf16_f32 v229, v230, v231
    v_cvt_pk_bf16_f32 v194, v204, v205
    v_mfma_f32_16x16x32_bf16 v[232:235], a[188:191], a[220:223], v[232:235]
    ds_write_b64 v249, v[228:229] offset:6144
    v_mfma_f32_16x16x32_bf16 v[236:239], a[192:195], a[232:235], 0
    buffer_store_dwordx4 a[252:255], v250, s[20:23], 0 offen nt
    v_mfma_f32_16x16x32_bf16 v[236:239], a[196:199], a[236:239], v[236:239]
    s_waitcnt lgkmcnt(1)
    v_exp_f32 v207, v207
    v_mfma_f32_16x16x32_bf16 v[200:203], v[144:147], v[174:177], v[200:203]
    v_cvt_pk_bf16_f32 v181, v206, v207
    v_cvt_pk_bf16_f32 v232, v232, v233
    v_mfma_f32_16x16x32_bf16 v[200:203], v[146:149], v[176:179], v[200:203]
    v_cvt_pk_bf16_f32 v233, v234, v235
    v_sub_f32 v208, v208, v248
    v_mfma_f32_16x16x32_bf16 v[236:239], a[200:203], a[240:243], v[236:239]
    ds_write_b64 v249, v[232:233] offset:6272
    v_mfma_f32_16x16x32_bf16 v[236:239], a[204:207], a[244:247], v[236:239]
    buffer_store_dwordx2 v[254:255], v251, s[20:23], 0 offen offset:256 nt
    v_mfma_f32_16x16x32_bf16 v[236:239], a[208:211], a[216:219], v[236:239]
    v_mbcnt_lo_u32_b32 v254, -1, 0
    v_mbcnt_hi_u32_b32 v254, -1, v254
    v_mfma_f32_16x16x32_bf16 v[236:239], a[212:215], a[220:223], v[236:239]
    v_lshrrev_b32 v255, 4, v254
    v_add_u32 v251, s55, v255
    v_cmp_gt_u32 vcc, 17, v251
    s_mul_i32 s55, s55, s31
    s_add_u32 s54, s54, s55
    s_add_u32 s54, s54, s32
    v_mul_i32_i24 v250, s31, v255
    v_add_u32 v250, s54, v250
    v_cvt_pk_bf16_f32 v236, v236, v237
    v_cvt_pk_bf16_f32 v237, v238, v239
    ds_write_b64 v249, v[236:237] offset:6400
    v_add_u32 v250, 0x80000000, v250
    v_cndmask_b32 v250, 0, v250, vcc
    v_add_u32 v250, 0x80000000, v250
    v_and_b32 v254, 15, v254
    v_lshl_add_u32 v251, v254, 3, v250
    v_lshlrev_b32 v255, 3, v255
    v_and_b32 v255, 8, v255
    v_xor_b32 v254, v254, v255
    v_lshl_add_u32 v250, v254, 4, v250
    v_exp_f32 v208, v208
    v_sub_f32 v209, v209, v248
    v_exp_f32 v209, v209
    v_sub_f32 v210, v210, v248
    v_exp_f32 v210, v210
    v_sub_f32 v211, v211, v248
    v_exp_f32 v211, v211
    v_cvt_pk_bf16_f32 v195, v208, v209
    v_cvt_pk_bf16_f32 v182, v210, v211
    v_sub_f32 v196, v196, v248
    v_mfma_f32_16x16x32_bf16 v[212:215], v[16:19], v[192:195], v[212:215]
    v_exp_f32 v196, v196
    v_mfma_f32_16x16x32_bf16 v[216:219], v[46:49], v[192:195], v[216:219]
    v_sub_f32 v197, v197, v248
    v_sub_f32 v198, v198, v248
    v_mfma_f32_16x16x32_bf16 v[220:223], v[76:79], v[192:195], v[220:223]
    v_exp_f32 v197, v197
    v_mfma_f32_16x16x32_bf16 v[224:227], a[248:251], v[192:195], v[224:227]
    v_exp_f32 v198, v198
    v_mfma_f32_16x16x32_bf16 v[212:215], v[20:23], v[180:183], v[212:215]
    v_sub_f32 v199, v199, v248
    v_cvt_pk_bf16_f32 v184, v196, v197
    v_mfma_f32_16x16x32_bf16 v[216:219], v[50:53], v[180:183], v[216:219]
    v_exp_f32 v199, v199
    v_mfma_f32_16x16x32_bf16 v[220:223], v[80:83], v[180:183], v[220:223]
    v_cvt_pk_bf16_f32 v187, v198, v199
    v_sub_f32 v200, v200, v248
    v_mfma_f32_16x16x32_bf16 v[224:227], a[248:251], v[180:183], v[224:227]
    v_exp_f32 v200, v200
    v_sub_f32 v201, v201, v248
    v_exp_f32 v201, v201
    v_sub_f32 v202, v202, v248
    v_exp_f32 v202, v202
    v_sub_f32 v203, v203, v248
    v_exp_f32 v203, v203
    v_cvt_pk_bf16_f32 v185, v200, v201
    v_cvt_pk_bf16_f32 v188, v202, v203
    v_mov_b32 v189, 0
    v_mfma_f32_16x16x32_bf16 v[212:215], v[24:27], v[184:187], v[212:215]
    v_mov_b32 v191, 0
    v_mfma_f32_16x16x32_bf16 v[216:219], v[54:57], v[184:187], v[216:219]
    v_mfma_f32_16x16x32_bf16 v[220:223], v[84:87], v[184:187], v[220:223]
    v_mfma_f32_16x16x32_bf16 v[224:227], a[248:251], v[184:187], v[224:227]
    v_mfma_f32_16x16x32_bf16 v[212:215], v[28:31], v[188:191], v[212:215]
    v_mfma_f32_16x16x32_bf16 v[216:219], v[58:61], v[188:191], v[216:219]
    v_mfma_f32_16x16x32_bf16 v[220:223], v[88:91], v[188:191], v[220:223]
    v_mfma_f32_16x16x32_bf16 v[224:227], a[248:251], v[188:191], v[224:227]
    s_nop 7
    v_rcp_f32 v225, v224
    s_nop 0
    v_mul_f32 v212, v212, v225
    v_mul_f32 v213, v213, v225
    v_mul_f32 v214, v214, v225
    v_mul_f32 v215, v215, v225
    v_cvt_pk_bf16_f32 v212, v212, v213
    v_cvt_pk_bf16_f32 v213, v214, v215
    ds_write_b64 v247, v[212:213] offset:55296
    v_mul_f32 v216, v216, v225
    v_mul_f32 v217, v217, v225
    v_mul_f32 v218, v218, v225
    v_mul_f32 v219, v219, v225
    v_cvt_pk_bf16_f32 v216, v216, v217
    v_cvt_pk_bf16_f32 v217, v218, v219
    ds_write_b64 v247, v[216:217] offset:55424
    v_mul_f32 v220, v220, v225
    v_mul_f32 v221, v221, v225
    v_mul_f32 v222, v222, v225
    v_mul_f32 v223, v223, v225
    v_cvt_pk_bf16_f32 v220, v220, v221
    v_cvt_pk_bf16_f32 v221, v222, v223
    ds_write_b64 v247, v[220:221] offset:55552
    s_waitcnt lgkmcnt(0)
    s_barrier
    ds_read_b128 a[224:227], v242 offset:55296
    ds_read_b128 a[228:231], v243 offset:55296
    ds_read_b128 a[232:235], v242 offset:55424
    ds_read_b128 a[236:239], v243 offset:55424
    ds_read_b128 a[240:243], v242 offset:55552
    ds_read_b128 a[244:247], v243 offset:55552
    ds_read_b128 a[252:255], v252 offset:0
    ds_read_b64 v[254:255], v253 offset:256
    s_waitcnt lgkmcnt(7)
    v_mfma_f32_16x16x32_bf16 v[228:231], a[144:147], a[224:227], 0
    v_mfma_f32_16x16x32_bf16 v[232:235], a[168:171], a[224:227], 0
    s_waitcnt lgkmcnt(6)
    v_mfma_f32_16x16x32_bf16 v[228:231], a[148:151], a[228:231], v[228:231]
    s_waitcnt lgkmcnt(5)
    v_mfma_f32_16x16x32_bf16 v[228:231], a[152:155], a[232:235], v[228:231]
    s_waitcnt lgkmcnt(4)
    v_mfma_f32_16x16x32_bf16 v[228:231], a[156:159], a[236:239], v[228:231]
    s_waitcnt lgkmcnt(3)
    v_mfma_f32_16x16x32_bf16 v[228:231], a[160:163], a[240:243], v[228:231]
    s_waitcnt lgkmcnt(2)
    v_mfma_f32_16x16x32_bf16 v[228:231], a[164:167], a[244:247], v[228:231]
    s_waitcnt lgkmcnt(0)
    v_mfma_f32_16x16x32_bf16 v[232:235], a[172:175], a[228:231], v[232:235]
    buffer_store_dwordx4 a[252:255], v250, s[20:23], 0 offen nt
    v_mfma_f32_16x16x32_bf16 v[232:235], a[176:179], a[232:235], v[232:235]
    v_mfma_f32_16x16x32_bf16 v[232:235], a[180:183], a[236:239], v[232:235]
    ds_read_b128 a[252:255], v252 offset:6144
    v_mfma_f32_16x16x32_bf16 v[232:235], a[184:187], a[240:243], v[232:235]
    buffer_store_dwordx2 v[254:255], v251, s[20:23], 0 offen offset:256 nt
    v_mfma_f32_16x16x32_bf16 v[232:235], a[188:191], a[244:247], v[232:235]
    v_cvt_pk_bf16_f32 v228, v228, v229
    v_cvt_pk_bf16_f32 v229, v230, v231
    v_mfma_f32_16x16x32_bf16 v[236:239], a[192:195], a[224:227], 0
    ds_write_b64 v249, v[228:229] offset:12288
    v_mfma_f32_16x16x32_bf16 v[236:239], a[196:199], a[228:231], v[236:239]
    v_mbcnt_lo_u32_b32 v254, -1, 0
    v_mbcnt_hi_u32_b32 v254, -1, v254
    v_mfma_f32_16x16x32_bf16 v[236:239], a[200:203], a[232:235], v[236:239]
    v_cvt_pk_bf16_f32 v232, v232, v233
    v_cvt_pk_bf16_f32 v233, v234, v235
    v_mfma_f32_16x16x32_bf16 v[236:239], a[204:207], a[236:239], v[236:239]
    ds_write_b64 v249, v[232:233] offset:12416
    v_mfma_f32_16x16x32_bf16 v[236:239], a[208:211], a[240:243], v[236:239]
    v_lshrrev_b32 v255, 4, v254
    v_mul_i32_i24 v250, s31, v255
    v_mfma_f32_16x16x32_bf16 v[236:239], a[212:215], a[244:247], v[236:239]
    v_add_u32 v250, s56, v250
    v_and_b32 v254, 15, v254
    v_lshl_add_u32 v251, v254, 3, v250
    v_lshlrev_b32 v255, 3, v255
    v_and_b32 v255, 8, v255
    v_xor_b32 v254, v254, v255
    v_lshl_add_u32 v250, v254, 4, v250
    ds_read_b64 v[254:255], v253 offset:6400
    v_cvt_pk_bf16_f32 v236, v236, v237
    v_cvt_pk_bf16_f32 v237, v238, v239
    ds_write_b64 v249, v[236:237] offset:12544
    s_waitcnt lgkmcnt(3)
    buffer_store_dwordx4 a[252:255], v250, s[20:23], 0 offen nt
    s_waitcnt lgkmcnt(1)
    buffer_store_dwordx2 v[254:255], v251, s[20:23], 0 offen offset:256 nt
    v_mbcnt_lo_u32_b32 v254, -1, 0
    s_waitcnt lgkmcnt(0)
    s_barrier
    v_mbcnt_hi_u32_b32 v254, -1, v254
    v_lshrrev_b32 v255, 4, v254
    v_add_u32 v251, s52, v255
    v_cmp_gt_u32 vcc, 17, v251
    s_mul_i32 s52, s52, s31
    s_add_u32 s51, s51, s52
    s_add_u32 s51, s51, s32
    v_mul_i32_i24 v250, s31, v255
    v_add_u32 v250, s51, v250
    v_add_u32 v250, 0x80000000, v250
    v_cndmask_b32 v250, 0, v250, vcc
    v_add_u32 v250, 0x80000000, v250
    v_and_b32 v254, 15, v254
    v_lshl_add_u32 v251, v254, 3, v250
    v_lshlrev_b32 v255, 3, v255
    v_and_b32 v255, 8, v255
    v_xor_b32 v254, v254, v255
    v_lshl_add_u32 v250, v254, 4, v250
    ds_read_b128 a[252:255], v252 offset:12288
    ds_read_b64 v[254:255], v253 offset:12544
    s_waitcnt lgkmcnt(1)
    buffer_store_dwordx4 a[252:255], v250, s[20:23], 0 offen nt
    s_waitcnt lgkmcnt(0)
    buffer_store_dwordx2 v[254:255], v251, s[20:23], 0 offen offset:256 nt
    s_endpgm
.section .rodata,"a"
.p2align 6
.amdhsa_kernel standalone__neighborhood_dinat__vision_kernel
  .amdhsa_next_free_vgpr 512
  .amdhsa_next_free_sgpr 102
  .amdhsa_accum_offset 256
  .amdhsa_group_segment_fixed_size 0
  .amdhsa_kernarg_size 56
  .amdhsa_user_sgpr_count 2
  .amdhsa_user_sgpr_kernarg_segment_ptr 1
  .amdhsa_system_sgpr_workgroup_id_x 1
.end_amdhsa_kernel
```

```asm
; @launch grid=(256,1,1) block=(256,1,1) lds=163840
.amdgcn_target "amdgcn-amd-amdhsa--gfx950"
.text
.globl standalone__neighborhood_dinat__vision_kernel
.p2align 12
.p2align 8
.type standalone__neighborhood_dinat__vision_kernel,@function
standalone__neighborhood_dinat__vision_kernel:
    s_cmpk_ge_u32 s2, 0x100
    s_cbranch_scc1 L_exit
    s_load_dwordx2 s[4:5], s[0:1], 0
    s_load_dwordx2 s[8:9], s[0:1], 8
    s_load_dwordx2 s[12:13], s[0:1], 16
    s_load_dwordx2 s[16:17], s[0:1], 24
    s_load_dwordx2 s[20:21], s[0:1], 32
    s_getpc_b64 s[68:69]
    v_lshrrev_b32 v4, 6, v0
    s_bfe_u32 s65, s2, 0x30003
    v_readfirstlane_b32 s28, v4
    s_lshl_b32 s66, s65, 13
    v_lshl_add_u32 v12, v0, 5, s66
    global_load_dword v11, v12, s[68:69]
    s_lshr_b32 s66, s2, 6
    s_and_b32 s67, s2, 1
    s_lshl2_add_u32 s64, s67, s66
    s_mov_b32 s30, 0x2a000
    s_mul_i32 s66, s64, 14
    s_bitcmp1_b32 s64, 0
    s_cselect_b32 s67, 16, -3
    s_cselect_b32 s35, -1, 1
    s_add_u32 s66, s66, s67
    s_mul_i32 s32, s66, s30
    s_mul_i32 s40, s30, 0x6f
    s_mul_i32 s30, s30, s35
    s_mul_i32 s66, s65, 28
    s_cmp_eq_u32 s65, 7
    s_cselect_b32 s36, 1, 0
    s_cselect_b32 s67, 18, -6
    s_cselect_b32 s31, -3, 3
    s_add_u32 s66, s66, s67
    s_bfe_u32 s67, s2, 0x10001
    s_add_u32 s66, s66, s67
    s_bfe_u32 s67, s2, 0x10002
    s_mulk_i32 s67, 0xe0
    s_add_u32 s66, s66, s67
    s_mulk_i32 s66, 0x180
    s_lshl_b32 s67, s36, 11
    s_sub_u32 s66, s66, s67
    s_lshl_b32 s45, s31, 11
    s_lshl_b32 s31, s31, 8
    s_mul_i32 s67, s30, s28
    s_add_u32 s67, s67, s32
    s_add_u32 s32, s32, s66
    s_min_i32 s40, s40, s67
    s_max_i32 s40, s40, 0
    s_add_u32 s40, s40, s66
    s_add_u32 s67, s67, s66
    s_lshl2_add_u32 s41, s30, s67
    s_mul_i32 s46, s28, 0x1e00
    s_mul_i32 s29, s28, 0x3000
    s_add_u32 s29, s29, 0x16800
    s_mul_i32 s39, s28, 0x60
    s_mov_b32 s6, 0x1260000
    s_mov_b32 s7, 0x20000
    s_mov_b32 s10, 0x36000
    s_mov_b32 s11, 0x20000
    v_mbcnt_lo_u32_b32 v1, -1, 0
    v_mbcnt_hi_u32_b32 v1, -1, v1
    s_lshl_b32 s51, s28, 1
    s_add_u32 s50, s31, 0xfffffe80
    s_mul_i32 s52, s36, 0x1d00
    v_lshrrev_b32 v2, 3, v1
    v_and_b32 v3, 7, v1
    v_xor_b32 v3, s51, v3
    v_lshl_add_u32 v4, v2, 7, s52
    v_mul_u32_u24 v8, 11, v2
    v_bfe_u32 v9, v8, 6, 1
    v_lshrrev_b32 v8, 5, v8
    v_xor_b32 v9, v3, v9
    v_mad_i32_i24 v8, v8, s50, v4
    v_lshl_add_u32 v168, v9, 4, v8
    v_add_u32 v8, 8, v2
    v_mul_u32_u24 v8, 11, v8
    v_bfe_u32 v9, v8, 6, 1
    v_lshrrev_b32 v8, 5, v8
    v_xor_b32 v9, v3, v9
    v_mad_i32_i24 v8, v8, s50, v4
    v_lshl_add_u32 v169, v9, 4, v8
    v_add_u32 v8, 16, v2
    v_mul_u32_u24 v8, 11, v8
    v_bfe_u32 v9, v8, 6, 1
    v_lshrrev_b32 v8, 5, v8
    v_xor_b32 v9, v3, v9
    v_mad_i32_i24 v8, v8, s50, v4
    v_lshl_add_u32 v170, v9, 4, v8
    s_movk_i32 s53, 0x480
    s_movk_i32 s54, -96
    v_lshrrev_b32 v10, 1, v1
    v_lshlrev_b32 v12, 4, v1
    v_mul_u32_u24 v8, 43, v10
    v_lshrrev_b32 v9, 8, v8
    v_lshrrev_b32 v8, 7, v8
    v_and_b32 v9, 4, v9
    v_xor_b32 v9, v8, v9
    v_mad_i32_i24 v8, v8, s54, v12
    v_mad_u32_u24 v172, v9, s53, v8
    v_add_u32 v8, 32, v10
    v_mul_u32_u24 v8, 43, v8
    v_lshrrev_b32 v9, 8, v8
    v_lshrrev_b32 v8, 7, v8
    v_and_b32 v9, 4, v9
    v_xor_b32 v9, v8, v9
    v_mad_i32_i24 v8, v8, s54, v12
    v_mad_u32_u24 v173, v9, s53, v8
    v_add_u32 v8, 64, v10
    v_mul_u32_u24 v8, 43, v8
    v_lshrrev_b32 v9, 8, v8
    v_lshrrev_b32 v8, 7, v8
    v_and_b32 v9, 4, v9
    v_xor_b32 v9, v8, v9
    v_mad_i32_i24 v8, v8, s54, v12
    v_mad_u32_u24 v174, v9, s53, v8
    s_waitcnt lgkmcnt(0)
    s_add_u32 m0, s46, 0xc00
    s_add_u32 s59, s40, s45
    buffer_load_dwordx4 v168, s[4:7], s59 offen lds
    s_add_u32 m0, s29, 0
    s_add_u32 s60, s39, 0x180
    buffer_load_dwordx4 v172, s[8:11], s60 offen lds
    s_add_u32 m0, s46, 0xc00
    s_add_u32 s52, s40, 0
    buffer_load_dwordx4 v169, s[4:7], s59 offen offset:1024 lds
    s_add_u32 m0, s29, 0
    v_add_u32 v5, s52, v168
    buffer_load_dwordx4 v173, s[8:11], s60 offen offset:1024 lds
    s_add_u32 m0, s46, 0xc00
    v_max_i32 v5, 0, v5
    buffer_load_dwordx4 v170, s[4:7], s59 offen offset:2048 lds
    s_add_u32 m0, s29, 0
    s_add_u32 s61, s39, 0x9180
    buffer_load_dwordx4 v174, s[8:11], s60 offen offset:2048 lds
    s_add_u32 m0, s46, 0
    s_add_u32 s53, s40, 0x400
    buffer_load_dwordx4 v5, s[4:7], 0 offen lds
    s_add_u32 m0, s29, 0xc00
    v_add_u32 v6, s53, v169
    buffer_load_dwordx4 v172, s[8:11], s61 offen lds
    s_add_u32 m0, s46, 0x400
    v_max_i32 v6, 0, v6
    buffer_load_dwordx4 v6, s[4:7], 0 offen lds
    s_add_u32 m0, s29, 0xc00
    s_add_u32 s54, s40, 0x800
    buffer_load_dwordx4 v173, s[8:11], s61 offen offset:1024 lds
    s_add_u32 m0, s46, 0x800
    v_add_u32 v7, s54, v170
    v_max_i32 v7, 0, v7
    buffer_load_dwordx4 v7, s[4:7], 0 offen lds
    s_add_u32 m0, s29, 0xc00
    s_add_u32 s62, s39, 0x12180
    buffer_load_dwordx4 v174, s[8:11], s61 offen offset:2048 lds
    s_add_u32 m0, s46, 0x7800
    s_mov_b32 s33, 0
    s_add_u32 s66, s64, 1
    s_and_b32 s66, s66, 6
    s_cselect_b32 s33, 0, 3
    s_add_u32 s66, s65, 1
    s_and_b32 s66, s66, 6
    s_cselect_b32 s34, 0, 1
    s_cmp_lt_i32 s30, 0
    s_cselect_b32 s35, 1, 0
    s_cselect_b32 s49, -1, 1
    s_mul_i32 s49, s49, 0x1c0
    s_cselect_b32 s48, 0, 0x4e
    s_mul_i32 s66, s28, 0x152
    s_add_u32 s48, s48, s66
    s_lshl2_add_u32 s42, s30, s41
    s_lshl2_add_u32 s43, s30, s42
    s_lshl2_add_u32 s44, s30, s43
    s_mul_i32 s66, s36, 0x1400
    s_add_u32 s32, s32, s66
    s_mul_i32 s37, s28, 0x1180
    s_add_u32 s37, s37, 0x239c0
    s_mov_b32 s38, 0x3e553b95
    s_mov_b32 s3, 0x3dd53b95
    s_mov_b32 s14, 0x12000
    s_mov_b32 s15, 0x20000
    s_mov_b32 s18, 0x548
    s_mov_b32 s19, 0x20000
    s_mov_b32 s22, 0x1260000
    s_mov_b32 s23, 0x20000
    s_mov_b32 s26, 0x1000000
    s_mov_b32 s27, 0x20000
    s_add_u32 s59, s41, s45
    s_add_u32 s63, s39, 0x1b180
    v_and_b32 v13, 15, v1
    v_lshrrev_b32 v14, 4, v1
    v_lshrrev_b32 v15, 2, v13
    v_and_b32 v17, 1, v14
    v_lshl_add_u32 v18, v14, 3, v15
    v_xor_b32 v19, 0, v17
    v_lshl_add_u32 v19, v19, 2, v18
    v_and_b32 v16, 3, v13
    v_mul_u32_u24 v19, 0x60, v19
    v_lshl_add_u32 v19, v16, 3, v19
    v_add_u32 v249, s29, v19
    v_xor_b32 v19, 1, v17
    v_lshl_add_u32 v19, v19, 2, v18
    v_mov_b32 v17, v15
    v_and_b32 v18, 3, v17
    v_lshlrev_b32 v18, 1, v18
    v_bfe_u32 v241, v16, 1, 1
    v_or_b32 v18, v18, v241
    v_mul_u32_u24 v17, 0x1e00, v17
    v_xor_b32 v18, v18, v14
    v_mul_u32_u24 v19, 0x60, v19
    v_lshl_add_u32 v17, v18, 4, v17
    v_lshl_add_u32 v19, v16, 3, v19
    v_mul_u32_u24 v18, 0x180, v16
    v_add_u32 v250, s29, v19
    v_add_u32 v240, v17, v18
    v_xor_b32 v241, 64, v240
    s_add_u32 s60, s39, 0x24180
    s_add_u32 s61, s39, 0x2d180
    s_and_b32 s65, s48, 0xfff0
    s_lshl1_add_u32 s58, s45, s40
    s_add_u32 s55, s28, 3
    s_mul_i32 s56, s31, 3
    s_mul_i32 s55, s55, s30
    s_add_u32 s55, s55, s56
    s_add_u32 s55, s55, s32
    s_add_u32 s57, s28, 3
    s_mul_i32 s51, s31, 7
    s_mul_i32 s57, s57, s30
    s_add_u32 s57, s57, s51
    s_add_u32 s57, s57, s32
    s_add_u32 s52, s28, 3
    s_mul_i32 s53, s31, 11
    s_mul_i32 s52, s52, s30
    s_add_u32 s52, s52, s53
    s_add_u32 s52, s52, s32
    s_add_u32 s54, s28, 7
    s_mul_i32 s54, s54, s30
    s_add_u32 s56, s28, 7
    s_mul_i32 s56, s56, s30
    s_add_u32 s51, s28, 7
    s_mul_i32 s51, s51, s30
    s_add_u32 s53, s28, 3
    s_mul_i32 s53, s53, s30
    buffer_load_dwordx4 v168, s[4:7], s41 offen lds
    s_add_u32 m0, s29, 0x1800
    s_nop 0
    buffer_load_dwordx4 v172, s[8:11], s62 offen lds
    s_add_u32 m0, s46, 0x7800
    s_nop 0
    buffer_load_dwordx4 v169, s[4:7], s41 offen offset:1024 lds
    s_add_u32 m0, s29, 0x1800
    s_nop 0
    buffer_load_dwordx4 v173, s[8:11], s62 offen offset:1024 lds
    s_add_u32 m0, s46, 0x7800
    s_nop 0
    buffer_load_dwordx4 v170, s[4:7], s41 offen offset:2048 lds
    s_add_u32 m0, s29, 0x1800
    s_nop 0
    buffer_load_dwordx4 v174, s[8:11], s62 offen offset:2048 lds
    s_add_u32 m0, s46, 0x8400
    s_waitcnt vmcnt(12)
    ds_read_b64_tr_b16 a[0:1], v249 offset:0
    ds_read_b64_tr_b16 a[2:3], v250 offset:0
    ds_read_b64_tr_b16 a[24:25], v249 offset:32
    ds_read_b64_tr_b16 a[26:27], v250 offset:32
    ds_read_b64_tr_b16 a[48:49], v249 offset:64
    ds_read_b64_tr_b16 a[50:51], v250 offset:64
    s_add_u32 s62, s39, 0x300
    buffer_load_dwordx4 v168, s[4:7], s59 offen lds
    s_add_u32 m0, s29, 0x2400
    s_nop 0
    buffer_load_dwordx4 v172, s[8:11], s63 offen lds
    s_add_u32 m0, s46, 0x8400
    s_nop 0
    buffer_load_dwordx4 v169, s[4:7], s59 offen offset:1024 lds
    s_add_u32 m0, s29, 0x2400
    s_nop 0
    s_mov_b64 exec, 0
    s_cmp_eq_u32 s28, 0
    s_cbranch_scc1 L_h1
    s_cmp_eq_u32 s28, 1
    s_cbranch_scc1 L_h2
    s_cmp_eq_u32 s28, 2
    s_cbranch_scc1 L_h3
    s_branch L_h4
    L_hback:
    s_mov_b64 exec, -1
    buffer_load_dwordx4 v173, s[8:11], s63 offen offset:1024 lds
    s_add_u32 m0, s46, 0x8400
    s_nop 0
    buffer_load_dwordx4 v170, s[4:7], s59 offen offset:2048 lds
    s_waitcnt vmcnt(12)
    s_barrier
    ds_read_b128 a[216:219], v240 offset:0
    ds_read_b128 a[220:223], v240 offset:1536
    ds_read_b128 a[224:227], v240 offset:3072
    ds_read_b128 a[228:231], v240 offset:4608
    ds_read_b128 a[232:235], v241 offset:0
    ds_read_b128 a[236:239], v241 offset:1536
    s_add_u32 m0, s29, 0x2400
    ds_read_b128 a[240:243], v241 offset:3072
    ds_read_b128 a[244:247], v241 offset:4608
    s_add_u32 s59, s42, s45
    s_waitcnt vmcnt(11)
    ds_read_b64_tr_b16 a[4:5], v249 offset:3072
    ds_read_b64_tr_b16 a[6:7], v250 offset:3072
    ds_read_b64_tr_b16 a[28:29], v249 offset:3104
    ds_read_b64_tr_b16 a[30:31], v250 offset:3104
    ds_read_b64_tr_b16 a[52:53], v249 offset:3136
    ds_read_b64_tr_b16 a[54:55], v250 offset:3136
    buffer_load_dwordx4 v174, s[8:11], s63 offen offset:2048 lds
    s_add_u32 m0, s29, 0
    s_waitcnt lgkmcnt(14)
    s_add_u32 s63, s39, 0x9300
    s_waitcnt lgkmcnt(13)
    v_mfma_f32_16x16x32_bf16 v[180:183], a[0:3], a[216:219], 0
    v_mfma_f32_16x16x32_bf16 v[184:187], a[24:27], a[216:219], 0
    s_waitcnt lgkmcnt(12)
    buffer_load_dwordx4 v172, s[8:11], s60 offen lds
    v_mfma_f32_16x16x32_bf16 v[188:191], a[48:51], a[216:219], 0
    ds_read_b128 a[216:219], v240 offset:128
    v_mfma_f32_16x16x32_bf16 v[192:195], a[0:3], a[220:223], 0
    s_waitcnt lgkmcnt(12)
    v_mfma_f32_16x16x32_bf16 v[196:199], a[24:27], a[220:223], 0
    v_mfma_f32_16x16x32_bf16 v[200:203], a[48:51], a[220:223], 0
    ds_read_b128 a[220:223], v240 offset:1664
    buffer_load_dwordx4 v173, s[8:11], s60 offen offset:1024 lds
    v_mfma_f32_16x16x32_bf16 v[204:207], a[0:3], a[224:227], 0
    s_waitcnt lgkmcnt(12)
    v_mfma_f32_16x16x32_bf16 v[208:211], a[24:27], a[224:227], 0
    v_mfma_f32_16x16x32_bf16 v[212:215], a[48:51], a[224:227], 0
    ds_read_b128 a[224:227], v240 offset:3200
    v_mfma_f32_16x16x32_bf16 v[216:219], a[0:3], a[228:231], 0
    s_waitcnt lgkmcnt(7)
    buffer_load_dwordx4 v174, s[8:11], s60 offen offset:2048 lds
    v_mfma_f32_16x16x32_bf16 v[220:223], a[24:27], a[228:231], 0
    s_waitcnt lgkmcnt(5)
    s_add_u32 m0, s29, 0xc00
    s_add_u32 s60, s39, 0x12300
    v_mfma_f32_16x16x32_bf16 v[224:227], a[48:51], a[228:231], 0
    s_waitcnt lgkmcnt(3)
    ds_read_b128 a[228:231], v240 offset:4736
    v_mfma_f32_16x16x32_bf16 v[180:183], a[4:7], a[232:235], v[180:183]
    v_mfma_f32_16x16x32_bf16 v[184:187], a[28:31], a[232:235], v[184:187]
    buffer_load_dwordx4 v172, s[8:11], s61 offen lds
    v_mfma_f32_16x16x32_bf16 v[188:191], a[52:55], a[232:235], v[188:191]
    v_mfma_f32_16x16x32_bf16 v[192:195], a[4:7], a[236:239], v[192:195]
    v_mfma_f32_16x16x32_bf16 v[196:199], a[28:31], a[236:239], v[196:199]
    v_mfma_f32_16x16x32_bf16 v[200:203], a[52:55], a[236:239], v[200:203]
    buffer_load_dwordx4 v173, s[8:11], s61 offen offset:1024 lds
    v_mfma_f32_16x16x32_bf16 v[204:207], a[4:7], a[240:243], v[204:207]
    v_mfma_f32_16x16x32_bf16 v[208:211], a[28:31], a[240:243], v[208:211]
    v_mfma_f32_16x16x32_bf16 v[212:215], a[52:55], a[240:243], v[212:215]
    v_mfma_f32_16x16x32_bf16 v[216:219], a[4:7], a[244:247], v[216:219]
    s_waitcnt vmcnt(11)
    ds_read_b64_tr_b16 a[8:9], v249 offset:6144
    v_mfma_f32_16x16x32_bf16 v[220:223], a[28:31], a[244:247], v[220:223]
    ds_read_b64_tr_b16 a[10:11], v250 offset:6144
    ds_read_b64_tr_b16 a[32:33], v249 offset:6176
    v_mfma_f32_16x16x32_bf16 v[224:227], a[52:55], a[244:247], v[224:227]
    ds_read_b64_tr_b16 a[34:35], v250 offset:6176
    ds_read_b64_tr_b16 a[56:57], v249 offset:6208
    ds_read_b64_tr_b16 a[58:59], v250 offset:6208
    buffer_load_dwordx4 v174, s[8:11], s61 offen offset:2048 lds
    s_add_u32 m0, s37, 0xd80
    s_add_u32 s61, s39, 0x1b300
    v_add_u32 v17, 3, v15
    v_add_u32 v19, 3, v16
    v_and_b32 v18, 3, v17
    v_lshlrev_b32 v18, 1, v18
    v_bfe_u32 v243, v19, 1, 1
    v_or_b32 v18, v18, v243
    v_mul_u32_u24 v17, 0x1e00, v17
    v_xor_b32 v18, v18, v14
    v_lshl_add_u32 v17, v18, 4, v17
    buffer_load_dwordx4 v12, s[16:19], s65 offen lds
    s_add_u32 m0, s29, 0x1800
    v_mul_u32_u24 v18, 0x180, v19
    v_add_u32 v242, v17, v18
    v_mov_b32 v17, 0x3f803f80
    s_and_b32 s66, s28, 1
    v_lshrrev_b32 v18, 1, v13
    v_accvgpr_write_b32 a248, v17
    s_waitcnt lgkmcnt(4)
    v_mfma_f32_16x16x32_bf16 v[180:183], a[8:11], a[216:219], v[180:183]
    s_lshl_b32 s66, s66, 2
    v_accvgpr_write_b32 a249, v17
    s_waitcnt lgkmcnt(2)
    v_mfma_f32_16x16x32_bf16 v[184:187], a[32:35], a[216:219], v[184:187]
    s_lshr_b32 s67, s28, 1
    v_accvgpr_write_b32 a250, v17
    s_waitcnt lgkmcnt(0)
    v_mfma_f32_16x16x32_bf16 v[188:191], a[56:59], a[216:219], v[188:191]
    buffer_load_dwordx4 v172, s[8:11], s62 offen lds
    v_accvgpr_write_b32 a251, v17
    v_mfma_f32_16x16x32_bf16 v[192:195], a[8:11], a[220:223], v[192:195]
    s_lshl_b32 s67, s67, 3
    v_xor_b32 v18, v14, v18
    v_xor_b32 v18, s66, v18
    v_mfma_f32_16x16x32_bf16 v[196:199], a[32:35], a[220:223], v[196:199]
    s_lshl_b32 s66, s36, 1
    v_mul_u32_u24 v17, 0x180, v13
    v_lshl_add_u32 v17, v18, 4, v17
    v_mfma_f32_16x16x32_bf16 v[200:203], a[56:59], a[220:223], v[200:203]
    s_sub_u32 s66, 1, s66
    v_add_u32 v17, s67, v17
    v_add_u32 v247, 0x7800, v17
    v_mfma_f32_16x16x32_bf16 v[204:207], a[8:11], a[224:227], v[204:207]
    buffer_load_dwordx4 v173, s[8:11], s62 offen offset:1024 lds
    v_add_u32 v251, 0x1e000, v17
    v_mfma_f32_16x16x32_bf16 v[208:211], a[32:35], a[224:227], v[208:211]
    s_mul_i32 s64, s35, 0xfc0
    v_sub_u32 v17, v14, v15
    v_mul_i32_i24 v17, 0x1c0, v17
    v_mfma_f32_16x16x32_bf16 v[212:215], a[56:59], a[224:227], v[212:215]
    s_add_u32 s64, s64, s37
    v_lshlrev_b32 v18, 4, v16
    v_sub_u32 v17, v17, v18
    v_mfma_f32_16x16x32_bf16 v[216:219], a[8:11], a[228:231], v[216:219]
    s_add_u32 s50, s31, 0xfffffe80
    v_max_u32 v18, s33, v15
    v_sub_u32 v18, v14, v18
    v_mfma_f32_16x16x32_bf16 v[220:223], a[32:35], a[228:231], v[220:223]
    buffer_load_dwordx4 v174, s[8:11], s62 offen offset:2048 lds
    v_add_u32 v244, 0, v18
    v_mfma_f32_16x16x32_bf16 v[224:227], a[56:59], a[228:231], v[224:227]
    s_add_u32 m0, s46, 0xf000
    s_add_u32 s62, s39, 0x24300
    v_cmp_gt_u32 vcc, 7, v244
    v_add_u32 v17, s37, v17
    s_waitcnt vmcnt(11)
    s_barrier
    ds_read_b128 a[232:235], v240 offset:30720
    ds_read_b128 a[236:239], v240 offset:32256
    ds_read_b128 a[240:243], v240 offset:33792
    ds_read_b128 a[244:247], v240 offset:35328
    ds_read_b128 a[216:219], v241 offset:30720
    ds_read_b128 a[220:223], v241 offset:32256
    ds_read_b128 a[224:227], v241 offset:33792
    ds_read_b128 a[228:231], v241 offset:35328
    buffer_load_dwordx4 v168, s[4:7], s42 offen lds
    s_add_u32 m0, s29, 0x2400
    v_add_u32 v244, 0xfffdc870, v17
    v_cndmask_b32 v244, 0, v244, vcc
    v_add_u32 v245, 4, v18
    s_waitcnt vmcnt(11)
    ds_read_b64_tr_b16 a[12:13], v249 offset:9216
    ds_read_b64_tr_b16 a[14:15], v250 offset:9216
    ds_read_b64_tr_b16 a[36:37], v249 offset:9248
    ds_read_b64_tr_b16 a[38:39], v250 offset:9248
    ds_read_b64_tr_b16 a[60:61], v249 offset:9280
    ds_read_b64_tr_b16 a[62:63], v250 offset:9280
    v_cmp_gt_u32 vcc, 7, v245
    v_add_u32 v245, 0xfffdcf70, v17
    v_add_u32 v246, 8, v18
    v_cndmask_b32 v245, 0, v245, vcc
    v_cmp_gt_u32 vcc, 7, v246
    v_add_u32 v246, 0xfffdd670, v17
    v_min_u32 v20, 55, v1
    v_cndmask_b32 v246, 0, v246, vcc
    s_waitcnt lgkmcnt(13)
    v_mfma_f32_16x16x32_bf16 v[228:231], a[0:3], a[232:235], 0
    s_mul_i32 s67, s36, 3
    v_lshrrev_b32 v21, 1, v20
    s_waitcnt lgkmcnt(12)
    v_mfma_f32_16x16x32_bf16 v[232:235], a[24:27], a[232:235], 0
    v_cmp_lt_u32 vcc, 11, v21
    v_lshlrev_b32 v62, 3, v20
    v_mfma_f32_16x16x32_bf16 v[236:239], a[48:51], a[232:235], 0
    ds_read_b128 a[232:235], v240 offset:30848
    v_add_u32 v22, -12, v21
    v_mfma_f32_16x16x32_bf16 v[138:141], a[0:3], a[236:239], 0
    s_waitcnt lgkmcnt(12)
    v_mov_b32 v23, s34
    v_and_b32 v20, 1, v20
    v_mfma_f32_16x16x32_bf16 v[142:145], a[24:27], a[236:239], 0
    v_cndmask_b32 v22, v21, v22, vcc
    v_cndmask_b32 v23, 0, v23, vcc
    v_mfma_f32_16x16x32_bf16 v[146:149], a[48:51], a[236:239], 0
    ds_read_b128 a[236:239], v240 offset:32384
    v_lshlrev_b32 v20, 1, v20
    v_mfma_f32_16x16x32_bf16 v[150:153], a[0:3], a[240:243], 0
    s_waitcnt lgkmcnt(12)
    v_cmp_ne_u32 vcc, 0, v23
    v_add_u32 v63, 0, v20
    v_mfma_f32_16x16x32_bf16 v[154:157], a[24:27], a[240:243], 0
    v_add3_u32 v64, v22, v63, -6
    v_and_b32 v66, 12, v22
    v_mfma_f32_16x16x32_bf16 v[158:161], a[48:51], a[240:243], 0
    ds_read_b128 a[240:243], v240 offset:33920
    s_waitcnt lgkmcnt(12)
    v_mfma_f32_16x16x32_bf16 v[162:165], a[0:3], a[244:247], 0
    v_add_u32 v65, 3, v64
    s_waitcnt lgkmcnt(11)
    v_mfma_f32_16x16x32_bf16 v[24:27], a[24:27], a[244:247], 0
    v_add3_u32 v66, v66, v63, -3
    v_cndmask_b32 v65, v65, v66, vcc
    v_mfma_f32_16x16x32_bf16 v[54:57], a[48:51], a[244:247], 0
    s_waitcnt lgkmcnt(10)
    v_cmp_gt_u32 vcc, 7, v65
    v_mul_i32_i24 v64, s66, v64
    v_mfma_f32_16x16x32_bf16 v[228:231], a[4:7], a[216:219], v[228:231]
    s_waitcnt lgkmcnt(8)
    v_add_lshl_u32 v64, v64, 6, 1
    v_cndmask_b32 v50, 0, v64, vcc
    v_mfma_f32_16x16x32_bf16 v[232:235], a[28:31], a[216:219], v[232:235]
    ds_read_b128 a[244:247], v240 offset:35456
    v_mov_b32 v64, 0x3fb8aa3b
    v_mfma_f32_16x16x32_bf16 v[236:239], a[52:55], a[216:219], v[236:239]
    ds_read_b128 a[216:219], v241 offset:128
    v_cndmask_b32 v52, 0, v64, vcc
    v_mfma_f32_16x16x32_bf16 v[138:141], a[4:7], a[220:223], v[138:141]
    s_waitcnt lgkmcnt(5)
    v_mov_b32 v64, 0
    v_mov_b32 v65, 0xf149f2ca
    v_mfma_f32_16x16x32_bf16 v[142:145], a[28:31], a[220:223], v[142:145]
    s_waitcnt lgkmcnt(4)
    v_cndmask_b32 v60, v65, v64, vcc
    v_cmp_ne_u32 vcc, 0, v23
    v_mfma_f32_16x16x32_bf16 v[146:149], a[52:55], a[220:223], v[146:149]
    ds_read_b128 a[220:223], v241 offset:1664
    v_add_u32 v63, 1, v20
    v_mfma_f32_16x16x32_bf16 v[150:153], a[4:7], a[224:227], v[150:153]
    buffer_load_dwordx4 v172, s[8:11], s63 offen lds
    v_add3_u32 v64, v22, v63, -6
    v_mfma_f32_16x16x32_bf16 v[154:157], a[28:31], a[224:227], v[154:157]
    s_waitcnt lgkmcnt(4)
    v_and_b32 v66, 12, v22
    v_add_u32 v65, 3, v64
    v_mfma_f32_16x16x32_bf16 v[158:161], a[52:55], a[224:227], v[158:161]
    ds_read_b128 a[224:227], v241 offset:3200
    v_add3_u32 v66, v66, v63, -3
    v_mfma_f32_16x16x32_bf16 v[162:165], a[4:7], a[228:231], v[162:165]
    s_add_u32 m0, s46, 0xf000
    v_cndmask_b32 v65, v65, v66, vcc
    v_cmp_gt_u32 vcc, 7, v65
    v_mfma_f32_16x16x32_bf16 v[24:27], a[28:31], a[228:231], v[24:27]
    s_waitcnt lgkmcnt(4)
    v_add_u32 v62, s64, v62
    v_mul_i32_i24 v64, s66, v64
    v_mfma_f32_16x16x32_bf16 v[54:57], a[52:55], a[228:231], v[54:57]
    ds_read_b128 a[228:231], v241 offset:4736
    v_add_lshl_u32 v64, v64, 6, 1
    v_mfma_f32_16x16x32_bf16 v[228:231], a[8:11], a[232:235], v[228:231]
    buffer_load_dwordx4 v169, s[4:7], s42 offen offset:1024 lds
    v_cndmask_b32 v51, 0, v64, vcc
    v_mfma_f32_16x16x32_bf16 v[232:235], a[32:35], a[232:235], v[232:235]
    s_add_u32 m0, s29, 0x2400
    v_mov_b32 v64, 0x3fb8aa3b
L_h1:
    s_cbranch_execz L_h5
    v_cndmask_b32 v53, 0, v64, vcc
    v_mfma_f32_16x16x32_bf16 v[236:239], a[56:59], a[232:235], v[236:239]
    ds_read_b128 a[232:235], v241 offset:30848
    v_mov_b32 v64, 0
    v_mfma_f32_16x16x32_bf16 v[138:141], a[8:11], a[236:239], v[138:141]
    s_waitcnt lgkmcnt(5)
    v_mov_b32 v65, 0xf149f2ca
    v_cndmask_b32 v61, v65, v64, vcc
    v_mfma_f32_16x16x32_bf16 v[142:145], a[32:35], a[236:239], v[142:145]
    s_waitcnt lgkmcnt(4)
    v_lshlrev_b32 v63, 3, v1
    v_mov_b32 v64, 0xf149f2ca
    v_mfma_f32_16x16x32_bf16 v[146:149], a[56:59], a[236:239], v[146:149]
    ds_read_b128 a[236:239], v241 offset:32384
    v_mov_b32 v65, 0xf149f2ca
    v_mfma_f32_16x16x32_bf16 v[150:153], a[8:11], a[240:243], v[150:153]
    buffer_load_dwordx4 v173, s[8:11], s63 offen offset:1024 lds
    v_add_u32 v63, 0x237c0, v63
    v_mfma_f32_16x16x32_bf16 v[154:157], a[32:35], a[240:243], v[154:157]
    s_waitcnt lgkmcnt(4)
    v_mbcnt_lo_u32_b32 v67, -1, 0
    v_mbcnt_hi_u32_b32 v67, -1, v67
    v_mfma_f32_16x16x32_bf16 v[158:161], a[56:59], a[240:243], v[158:161]
    ds_read_b128 a[240:243], v241 offset:33920
    v_lshrrev_b32 v68, 1, v67
    v_mfma_f32_16x16x32_bf16 v[162:165], a[8:11], a[244:247], v[162:165]
    s_add_u32 m0, s46, 0xf000
    v_add_u32 v68, 0, v68
    v_mul_u32_u24 v69, 43, v68
    v_mfma_f32_16x16x32_bf16 v[24:27], a[32:35], a[244:247], v[24:27]
    s_waitcnt lgkmcnt(4)
    v_lshrrev_b32 v70, 8, v69
    v_lshrrev_b32 v69, 7, v69
    v_mfma_f32_16x16x32_bf16 v[54:57], a[56:59], a[244:247], v[54:57]
    ds_read_b128 a[244:247], v241 offset:35456
    v_mad_i32_i24 v68, v69, -3, v68
    v_mfma_f32_16x16x32_bf16 v[180:183], a[12:15], a[216:219], v[180:183]
    buffer_load_dwordx4 v170, s[4:7], s42 offen offset:2048 lds
    v_and_b32 v70, 4, v70
    v_mfma_f32_16x16x32_bf16 v[184:187], a[36:39], a[216:219], v[184:187]
    s_waitcnt lgkmcnt(4)
    v_xor_b32 v69, v69, v70
    v_and_b32 v70, 4, v69
    v_mfma_f32_16x16x32_bf16 v[188:191], a[60:63], a[216:219], v[188:191]
    ds_read_b128 a[216:219], v240 offset:256
    v_mul_u32_u24 v252, 24, v70
    v_mfma_f32_16x16x32_bf16 v[192:195], a[12:15], a[220:223], v[192:195]
    s_add_u32 m0, s29, 0x2400
    v_lshrrev_b32 v70, 3, v69
    v_lshl_add_u32 v252, v70, 2, v252
    v_mfma_f32_16x16x32_bf16 v[196:199], a[36:39], a[220:223], v[196:199]
    s_waitcnt lgkmcnt(4)
    v_and_or_b32 v252, v69, 3, v252
    v_mad_u32_u24 v252, v252, 3, v68
    v_mfma_f32_16x16x32_bf16 v[200:203], a[60:63], a[220:223], v[200:203]
    ds_read_b128 a[220:223], v240 offset:1792
    v_lshrrev_b32 v68, 1, v67
    v_mfma_f32_16x16x32_bf16 v[204:207], a[12:15], a[224:227], v[204:207]
    buffer_load_dwordx4 v174, s[8:11], s63 offen offset:2048 lds
    v_and_b32 v70, 1, v67
    v_mfma_f32_16x16x32_bf16 v[208:211], a[36:39], a[224:227], v[208:211]
    s_waitcnt lgkmcnt(4)
    v_add_u32 v68, 32, v68
    v_lshl_add_u32 v252, v252, 3, v70
    v_mfma_f32_16x16x32_bf16 v[212:215], a[60:63], a[224:227], v[212:215]
    ds_read_b128 a[224:227], v240 offset:3328
    v_mul_u32_u24 v69, 43, v68
    v_mfma_f32_16x16x32_bf16 v[216:219], a[12:15], a[228:231], v[216:219]
    s_add_u32 m0, s46, 0xfc00
    v_lshrrev_b32 v70, 8, v69
    v_lshrrev_b32 v69, 7, v69
    v_mfma_f32_16x16x32_bf16 v[220:223], a[36:39], a[228:231], v[220:223]
    s_waitcnt lgkmcnt(4)
    v_mad_i32_i24 v68, v69, -3, v68
    v_and_b32 v70, 4, v70
    v_mfma_f32_16x16x32_bf16 v[224:227], a[60:63], a[228:231], v[224:227]
    ds_read_b128 a[228:231], v240 offset:4864
    v_xor_b32 v69, v69, v70
    v_mfma_f32_16x16x32_bf16 v[228:231], a[12:15], a[232:235], v[228:231]
    s_waitcnt vmcnt(13)
    ds_read_b64_tr_b16 a[16:17], v249 offset:0
    v_mfma_f32_16x16x32_bf16 v[232:235], a[36:39], a[232:235], v[232:235]
    ds_read_b64_tr_b16 a[18:19], v250 offset:0
    ds_read_b64_tr_b16 a[40:41], v249 offset:32
    v_mfma_f32_16x16x32_bf16 v[236:239], a[60:63], a[232:235], v[236:239]
    ds_read_b64_tr_b16 a[42:43], v250 offset:32
    ds_read_b64_tr_b16 a[64:65], v249 offset:64
    v_mfma_f32_16x16x32_bf16 v[138:141], a[12:15], a[236:239], v[138:141]
    ds_read_b64_tr_b16 a[66:67], v250 offset:64
    s_waitcnt lgkmcnt(9)
    v_mfma_f32_16x16x32_bf16 v[142:145], a[36:39], a[236:239], v[142:145]
    ds_read_b128 a[232:235], v240 offset:30976
    v_and_b32 v70, 4, v69
    v_mfma_f32_16x16x32_bf16 v[146:149], a[60:63], a[236:239], v[146:149]
    ds_read_b128 a[236:239], v240 offset:32512
    v_mul_u32_u24 v253, 24, v70
    v_mfma_f32_16x16x32_bf16 v[150:153], a[12:15], a[240:243], v[150:153]
    buffer_load_dwordx4 v168, s[4:7], s59 offen lds
    v_lshrrev_b32 v70, 3, v69
    v_mfma_f32_16x16x32_bf16 v[154:157], a[36:39], a[240:243], v[154:157]
    s_add_u32 m0, s29, 0
    v_lshl_add_u32 v253, v70, 2, v253
    v_and_b32 v70, 1, v67
    v_mfma_f32_16x16x32_bf16 v[158:161], a[60:63], a[240:243], v[158:161]
    ds_read_b128 a[240:243], v240 offset:34048
    v_add_u32 v8, 4, v2
    v_mfma_f32_16x16x32_bf16 v[162:165], a[12:15], a[244:247], v[162:165]
    s_waitcnt lgkmcnt(7)
    v_and_or_b32 v253, v69, 3, v253
    v_mad_u32_u24 v253, v253, 3, v68
    v_mfma_f32_16x16x32_bf16 v[24:27], a[36:39], a[244:247], v[24:27]
    s_add_u32 s63, s39, 0x2d300
    s_waitcnt lgkmcnt(5)
    v_lshl_add_u32 v253, v253, 3, v70
    v_mfma_f32_16x16x32_bf16 v[54:57], a[60:63], a[244:247], v[54:57]
    ds_read_b128 a[244:247], v240 offset:35584
    s_waitcnt lgkmcnt(4)
    v_mfma_f32_16x16x32_bf16 v[180:183], a[16:19], a[216:219], v[180:183]
    buffer_load_dwordx4 v172, s[8:11], s60 offen lds
    v_mul_u32_u24 v8, 11, v8
    v_mfma_f32_16x16x32_bf16 v[184:187], a[40:43], a[216:219], v[184:187]
    s_add_u32 m0, s46, 0xfc00
    v_bfe_u32 v9, v8, 6, 1
    v_lshrrev_b32 v8, 5, v8
    v_mfma_f32_16x16x32_bf16 v[188:191], a[64:67], a[216:219], v[188:191]
    ds_read_b128 a[216:219], v241 offset:256
    v_xor_b32 v9, v3, v9
    v_mfma_f32_16x16x32_bf16 v[192:195], a[16:19], a[220:223], v[192:195]
    s_and_b32 s64, s48, 15
    v_mad_i32_i24 v8, v8, s50, v4
    v_lshl_add_u32 v171, v9, 4, v8
    v_mfma_f32_16x16x32_bf16 v[196:199], a[40:43], a[220:223], v[196:199]
    buffer_load_dwordx4 v169, s[4:7], s59 offen offset:1024 lds
    v_xor_b32 v243, 64, v242
    v_mfma_f32_16x16x32_bf16 v[200:203], a[64:67], a[220:223], v[200:203]
    ds_read_b128 a[220:223], v241 offset:1792
    v_add_u32 v244, 0x237c0, v244
    v_mfma_f32_16x16x32_bf16 v[204:207], a[16:19], a[224:227], v[204:207]
    s_waitcnt lgkmcnt(5)
    v_add_u32 v245, 0x237c0, v245
    v_add_u32 v246, 0x237c0, v246
    v_mfma_f32_16x16x32_bf16 v[208:211], a[40:43], a[224:227], v[208:211]
    s_waitcnt lgkmcnt(4)
    v_accvgpr_write_b32 a252, v168
    v_accvgpr_write_b32 a253, v169
    v_mfma_f32_16x16x32_bf16 v[212:215], a[64:67], a[224:227], v[212:215]
    ds_read_b128 a[224:227], v241 offset:3328
    v_accvgpr_write_b32 a254, v170
    v_mfma_f32_16x16x32_bf16 v[216:219], a[16:19], a[228:231], v[216:219]
    s_add_u32 m0, s29, 0
    v_accvgpr_write_b32 a255, v171
    v_mov_b32 v248, 0
    v_mfma_f32_16x16x32_bf16 v[220:223], a[40:43], a[228:231], v[220:223]
    s_waitcnt lgkmcnt(4)
    v_accvgpr_read_b32 v254, a252
    v_accvgpr_read_b32 v255, a253
    v_mfma_f32_16x16x32_bf16 v[224:227], a[64:67], a[228:231], v[224:227]
    buffer_load_dwordx4 v173, s[8:11], s60 offen offset:1024 lds
    v_lshlrev_b32 v252, 4, v252
    v_mfma_f32_16x16x32_bf16 v[228:231], a[16:19], a[232:235], v[228:231]
    s_waitcnt vmcnt(14)
    ds_read_b64_tr_b16 a[20:21], v249 offset:3072
    v_mfma_f32_16x16x32_bf16 v[232:235], a[40:43], a[232:235], v[232:235]
    ds_read_b64_tr_b16 a[22:23], v250 offset:3072
    ds_read_b64_tr_b16 a[44:45], v249 offset:3104
    v_mfma_f32_16x16x32_bf16 v[236:239], a[64:67], a[232:235], v[236:239]
    ds_read_b64_tr_b16 a[46:47], v250 offset:3104
    ds_read_b64_tr_b16 a[68:69], v249 offset:3136
    v_mfma_f32_16x16x32_bf16 v[138:141], a[16:19], a[236:239], v[138:141]
    ds_read_b64_tr_b16 a[70:71], v250 offset:3136
    s_waitcnt lgkmcnt(8)
    v_mfma_f32_16x16x32_bf16 v[142:145], a[40:43], a[236:239], v[142:145]
    ds_read_b128 a[228:231], v241 offset:4864
    v_lshlrev_b32 v253, 4, v253
    v_mfma_f32_16x16x32_bf16 v[146:149], a[64:67], a[236:239], v[146:149]
    s_add_u32 m0, s46, 0xfc00
    v_add_u32 v253, 0xfffffc00, v253
    s_add_u32 s64, s64, s37
    v_mfma_f32_16x16x32_bf16 v[150:153], a[16:19], a[240:243], v[150:153]
    buffer_load_dwordx4 v170, s[4:7], s59 offen offset:2048 lds
    v_add_u32 v50, s64, v50
    v_mfma_f32_16x16x32_bf16 v[154:157], a[40:43], a[240:243], v[154:157]
    ds_read_b128 a[232:235], v241 offset:30976
    v_add_u32 v51, s64, v51
    v_mfma_f32_16x16x32_bf16 v[158:161], a[64:67], a[240:243], v[158:161]
    ds_read_b128 a[236:239], v241 offset:32512
    s_add_u32 m0, s29, 0
    v_mfma_f32_16x16x32_bf16 v[162:165], a[16:19], a[244:247], v[162:165]
    s_waitcnt vmcnt(14) lgkmcnt(7)
    ds_read_b128 a[240:243], v241 offset:34048
    v_mfma_f32_16x16x32_bf16 v[24:27], a[40:43], a[244:247], v[24:27]
    buffer_load_dwordx4 v174, s[8:11], s60 offen offset:2048 lds
    s_waitcnt lgkmcnt(6)
    v_mfma_f32_16x16x32_bf16 v[54:57], a[64:67], a[244:247], v[54:57]
    ds_read_b128 a[244:247], v241 offset:35584
    s_waitcnt lgkmcnt(5)
    v_mfma_f32_16x16x32_bf16 v[180:183], a[20:23], a[216:219], v[180:183]
    s_add_u32 m0, s29, 0xc00
    s_add_u32 s60, s39, 0
    s_add_u32 s59, s43, s45
    v_mfma_f32_16x16x32_bf16 v[184:187], a[44:47], a[216:219], v[184:187]
    ds_read_u16 v30, v50 offset:3456
    ds_read_u16 v31, v51 offset:3456
    v_mfma_f32_16x16x32_bf16 v[188:191], a[68:71], a[216:219], v[188:191]
    ds_read_b128 a[216:219], v240 offset:0
    v_cvt_pk_bf16_f32 v90, v180, v181
    v_mfma_f32_16x16x32_bf16 v[192:195], a[20:23], a[220:223], v[192:195]
    buffer_load_dwordx4 v172, s[8:11], s61 offen lds
    v_cvt_pk_bf16_f32 v91, v182, v183
    v_mfma_f32_16x16x32_bf16 v[196:199], a[44:47], a[220:223], v[196:199]
    s_mov_b32 vcc_lo, 0xcccccccc
    v_cvt_pk_bf16_f32 v92, v184, v185
    v_cvt_pk_bf16_f32 v93, v186, v187
    v_mfma_f32_16x16x32_bf16 v[200:203], a[68:71], a[220:223], v[200:203]
    ds_read_b128 a[220:223], v240 offset:1536
    s_waitcnt vmcnt(13) lgkmcnt(8)
    v_mfma_f32_16x16x32_bf16 v[204:207], a[20:23], a[224:227], v[204:207]
    ds_read_b64_tr_b16 a[72:73], v249 offset:6144
    v_cvt_pk_bf16_f32 v94, v188, v189
    v_mfma_f32_16x16x32_bf16 v[208:211], a[44:47], a[224:227], v[208:211]
    ds_read_b64_tr_b16 a[74:75], v250 offset:6144
    v_cvt_pk_bf16_f32 v95, v190, v191
    v_mfma_f32_16x16x32_bf16 v[212:215], a[68:71], a[224:227], v[212:215]
    ds_read_b64_tr_b16 a[96:97], v249 offset:6176
    s_waitcnt lgkmcnt(10)
    v_mfma_f32_16x16x32_bf16 v[216:219], a[20:23], a[228:231], v[216:219]
    ds_read_b64_tr_b16 a[98:99], v250 offset:6176
    s_waitcnt lgkmcnt(10)
    v_mfma_f32_16x16x32_bf16 v[220:223], a[44:47], a[228:231], v[220:223]
    ds_read_b64_tr_b16 a[120:121], v249 offset:6208
    v_cvt_pk_bf16_f32 v96, v192, v193
    v_mfma_f32_16x16x32_bf16 v[224:227], a[68:71], a[228:231], v[224:227]
    ds_read_b64_tr_b16 a[122:123], v250 offset:6208
    v_cvt_pk_bf16_f32 v97, v194, v195
    v_mfma_f32_16x16x32_bf16 v[228:231], a[20:23], a[232:235], v[228:231]
    s_waitcnt lgkmcnt(11)
    v_cvt_pk_bf16_f32 v98, v196, v197
    v_cvt_pk_bf16_f32 v99, v198, v199
    v_mfma_f32_16x16x32_bf16 v[232:235], a[44:47], a[232:235], v[232:235]
    s_waitcnt lgkmcnt(10)
    v_cvt_pk_bf16_f32 v100, v200, v201
    v_cvt_pk_bf16_f32 v101, v202, v203
    v_mfma_f32_16x16x32_bf16 v[236:239], a[68:71], a[232:235], v[236:239]
    ds_read_b128 a[224:227], v240 offset:3072
    v_cvt_pk_bf16_f32 v102, v204, v205
    v_mfma_f32_16x16x32_bf16 v[138:141], a[20:23], a[236:239], v[138:141]
    ds_read_b128 a[228:231], v240 offset:4608
    v_cvt_pk_bf16_f32 v103, v206, v207
    v_mfma_f32_16x16x32_bf16 v[142:145], a[44:47], a[236:239], v[142:145]
    buffer_load_dwordx4 v173, s[8:11], s61 offen offset:1024 lds
    v_cvt_pk_bf16_f32 v104, v208, v209
    v_mfma_f32_16x16x32_bf16 v[146:149], a[68:71], a[236:239], v[146:149]
    ds_read_b128 a[232:235], v240 offset:30720
    v_cvt_pk_bf16_f32 v105, v210, v211
    v_mfma_f32_16x16x32_bf16 v[150:153], a[20:23], a[240:243], v[150:153]
    ds_read_b128 a[236:239], v240 offset:32256
    v_cvt_pk_bf16_f32 v106, v212, v213
    v_mfma_f32_16x16x32_bf16 v[154:157], a[44:47], a[240:243], v[154:157]
    s_waitcnt lgkmcnt(10)
    v_cvt_pk_bf16_f32 v107, v214, v215
    v_cvt_pk_bf16_f32 v108, v216, v217
    v_mfma_f32_16x16x32_bf16 v[158:161], a[68:71], a[240:243], v[158:161]
    buffer_load_dwordx4 v174, s[8:11], s61 offen offset:2048 lds
    s_waitcnt lgkmcnt(8)
    v_mfma_f32_16x16x32_bf16 v[162:165], a[20:23], a[244:247], v[162:165]
    ds_read_b128 a[240:243], v240 offset:33792
    v_cvt_pk_bf16_f32 v109, v218, v219
    v_mfma_f32_16x16x32_bf16 v[24:27], a[44:47], a[244:247], v[24:27]
    s_waitcnt lgkmcnt(7)
    v_cvt_pk_bf16_f32 v110, v220, v221
    v_cvt_pk_bf16_f32 v111, v222, v223
    v_mfma_f32_16x16x32_bf16 v[54:57], a[68:71], a[244:247], v[54:57]
    s_waitcnt lgkmcnt(5)
    v_cvt_pk_bf16_f32 v112, v224, v225
    v_cvt_pk_bf16_f32 v113, v226, v227
    v_mfma_f32_16x16x32_bf16 v[84:87], a[216:219], a[72:75], 0
    ds_read_b128 a[244:247], v240 offset:35328
    v_cvt_pk_bf16_f32 v114, v228, v229
    v_mfma_f32_16x16x32_bf16 v[180:183], a[216:219], a[96:99], 0
    s_add_u32 m0, s29, 0x1800
    v_cvt_pk_bf16_f32 v115, v230, v231
    v_cvt_pk_bf16_f32 v116, v232, v233
    v_mfma_f32_16x16x32_bf16 v[184:187], a[216:219], a[120:123], 0
    ds_read_b128 a[216:219], v241 offset:0
    v_cvt_pk_bf16_f32 v117, v234, v235
    v_mfma_f32_16x16x32_bf16 v[188:191], a[220:223], a[72:75], 0
    s_waitcnt lgkmcnt(6)
    v_cvt_pk_bf16_f32 v118, v236, v237
    v_cvt_pk_bf16_f32 v119, v238, v239
    v_mfma_f32_16x16x32_bf16 v[192:195], a[220:223], a[96:99], 0
    s_add_u32 s61, s39, 0x9000
    s_waitcnt lgkmcnt(5)
    v_cvt_pk_bf16_f32 v120, v138, v139
    v_mfma_f32_16x16x32_bf16 v[196:199], a[220:223], a[120:123], 0
    s_mov_b32 vcc_hi, 0xcccccccc
    v_cvt_pk_bf16_f32 v121, v140, v141
    v_cvt_pk_bf16_f32 v122, v142, v143
    v_mfma_f32_16x16x32_bf16 v[200:203], a[224:227], a[72:75], 0
    ds_read_b128 a[220:223], v241 offset:1536
    s_waitcnt lgkmcnt(5)
    v_mfma_f32_16x16x32_bf16 v[204:207], a[224:227], a[96:99], 0
    s_mul_i32 s66, s28, 0xffffee00
    v_cvt_pk_bf16_f32 v123, v144, v145
    v_cvt_pk_bf16_f32 v124, v146, v147
    v_mfma_f32_16x16x32_bf16 v[208:211], a[224:227], a[120:123], 0
    s_waitcnt lgkmcnt(4)
    v_cvt_pk_bf16_f32 v125, v148, v149
    v_cvt_pk_bf16_f32 v126, v150, v151
    v_mfma_f32_16x16x32_bf16 v[212:215], a[228:231], a[72:75], 0
    v_cvt_pk_bf16_f32 v127, v152, v153
    v_cvt_pk_bf16_f32 v128, v154, v155
    v_mfma_f32_16x16x32_bf16 v[216:219], a[228:231], a[96:99], 0
    ds_read_b128 a[224:227], v241 offset:3072
    v_cvt_pk_bf16_f32 v129, v156, v157
    v_mfma_f32_16x16x32_bf16 v[220:223], a[228:231], a[120:123], 0
    s_waitcnt lgkmcnt(4)
    v_cvt_pk_bf16_f32 v130, v158, v159
    v_cvt_pk_bf16_f32 v131, v160, v161
    v_mfma_f32_16x16x32_bf16 v[224:227], a[232:235], a[72:75], 0
    s_waitcnt vmcnt(9)
    ds_read_b64_tr_b16 a[76:77], v249 offset:9216
    v_mfma_f32_16x16x32_bf16 v[228:231], a[232:235], a[96:99], 0
    ds_read_b64_tr_b16 a[78:79], v250 offset:9216
    ds_read_b64_tr_b16 a[100:101], v249 offset:9248
    v_mfma_f32_16x16x32_bf16 v[232:235], a[232:235], a[120:123], 0
    ds_read_b64_tr_b16 a[102:103], v250 offset:9248
    ds_read_b64_tr_b16 a[124:125], v249 offset:9280
    v_mfma_f32_16x16x32_bf16 v[236:239], a[236:239], a[72:75], 0
    ds_read_b64_tr_b16 a[126:127], v250 offset:9280
    s_waitcnt lgkmcnt(8)
    v_mfma_f32_16x16x32_bf16 v[138:141], a[236:239], a[96:99], 0
    buffer_load_dwordx4 v172, s[8:11], s62 offen lds
    v_cvt_pk_bf16_f32 v132, v162, v163
    v_mfma_f32_16x16x32_bf16 v[142:145], a[236:239], a[120:123], 0
    v_cvt_pk_bf16_f32 v133, v164, v165
    v_cvt_pk_bf16_f32 v134, v24, v25
    v_mfma_f32_16x16x32_bf16 v[146:149], a[240:243], a[72:75], 0
    ds_read_b128 a[228:231], v241 offset:4608
    v_cvt_pk_bf16_f32 v135, v26, v27
    v_mfma_f32_16x16x32_bf16 v[150:153], a[240:243], a[96:99], 0
    ds_read_b128 a[232:235], v241 offset:30720
    v_lshlrev_b32 v30, 16, v30
    v_mfma_f32_16x16x32_bf16 v[154:157], a[240:243], a[120:123], 0
    buffer_load_dwordx4 v173, s[8:11], s62 offen offset:1024 lds
    v_lshlrev_b32 v31, 16, v31
    v_mfma_f32_16x16x32_bf16 v[158:161], a[244:247], a[72:75], 0
    s_waitcnt lgkmcnt(6)
    v_fma_f32 v30, v30, v52, v60
    v_fma_f32 v31, v31, v53, v61
    v_mfma_f32_16x16x32_bf16 v[162:165], a[244:247], a[96:99], 0
    ds_read_b128 a[236:239], v241 offset:32256
    s_waitcnt lgkmcnt(5)
    v_mfma_f32_16x16x32_bf16 v[24:27], a[244:247], a[120:123], 0
    ds_read_b128 a[240:243], v241 offset:33792
    s_waitcnt lgkmcnt(4)
    v_mfma_f32_16x16x32_bf16 v[84:87], a[216:219], a[76:79], v[84:87]
    buffer_load_dwordx4 v174, s[8:11], s62 offen offset:2048 lds
    v_cvt_pk_bf16_f32 v136, v54, v55
    v_mfma_f32_16x16x32_bf16 v[180:183], a[216:219], a[100:103], v[180:183]
    ds_read_b128 a[244:247], v241 offset:35328
    v_cvt_pk_bf16_f32 v137, v56, v57
    v_mfma_f32_16x16x32_bf16 v[184:187], a[216:219], a[124:127], v[184:187]
    ds_read_b128 a[216:219], v240 offset:128
    s_add_u32 m0, s29, 0x2400
    v_mfma_f32_16x16x32_bf16 v[188:191], a[220:223], a[76:79], v[188:191]
    s_add_u32 s62, s39, 0x12000
    ds_read_u16 v32, v50 offset:3482
    v_mfma_f32_16x16x32_bf16 v[192:195], a[220:223], a[100:103], v[192:195]
    buffer_load_dwordx4 v172, s[8:11], s63 offen lds
    ds_read_u16 v33, v51 offset:3482
    v_mfma_f32_16x16x32_bf16 v[196:199], a[220:223], a[124:127], v[196:199]
    ds_read_b128 a[220:223], v240 offset:1664
    ds_read_u16 v34, v50 offset:3508
    v_mfma_f32_16x16x32_bf16 v[200:203], a[224:227], a[76:79], v[200:203]
    s_waitcnt lgkmcnt(9)
    ds_read_u16 v35, v51 offset:3508
    v_mfma_f32_16x16x32_bf16 v[204:207], a[224:227], a[100:103], v[204:207]
    ds_read_u16 v37, v51 offset:3534
    ds_read_u16 v39, v51 offset:3560
    v_mfma_f32_16x16x32_bf16 v[208:211], a[224:227], a[124:127], v[208:211]
    s_waitcnt lgkmcnt(11)
    ds_read_b128 a[224:227], v240 offset:3200
    v_mfma_f32_16x16x32_bf16 v[212:215], a[228:231], a[76:79], v[212:215]
    buffer_load_dwordx4 v173, s[8:11], s63 offen offset:1024 lds
    ds_read_u16 v41, v51 offset:3586
    v_mfma_f32_16x16x32_bf16 v[216:219], a[228:231], a[100:103], v[216:219]
    ds_read_u16 v43, v51 offset:3612
    ds_read_u16 v45, v51 offset:3638
    v_mfma_f32_16x16x32_bf16 v[220:223], a[228:231], a[124:127], v[220:223]
    s_waitcnt lgkmcnt(14)
    ds_read_b128 a[228:231], v240 offset:4736
    v_mfma_f32_16x16x32_bf16 v[224:227], a[232:235], a[76:79], v[224:227]
    s_waitcnt vmcnt(8) lgkmcnt(14)
    ds_read_b64_tr_b16 a[80:81], v249 offset:0
    v_mfma_f32_16x16x32_bf16 v[228:231], a[232:235], a[100:103], v[228:231]
    ds_read_b64_tr_b16 a[82:83], v250 offset:0
    ds_read_b64_tr_b16 a[104:105], v249 offset:32
    v_mfma_f32_16x16x32_bf16 v[232:235], a[232:235], a[124:127], v[232:235]
    ds_read_b64_tr_b16 a[106:107], v250 offset:32
    ds_read_b64_tr_b16 a[128:129], v249 offset:64
    v_mfma_f32_16x16x32_bf16 v[236:239], a[236:239], a[76:79], v[236:239]
    ds_read_b64_tr_b16 a[130:131], v250 offset:64
    ds_read_b128 a[232:235], v240 offset:30848
    v_mfma_f32_16x16x32_bf16 v[138:141], a[236:239], a[100:103], v[138:141]
    buffer_load_dwordx4 v174, s[8:11], s63 offen offset:2048 lds
    s_add_u32 m0, s29, 0
    v_mfma_f32_16x16x32_bf16 v[142:145], a[236:239], a[124:127], v[142:145]
    ds_read_b128 a[236:239], v240 offset:32384
    s_barrier
    v_mfma_f32_16x16x32_bf16 v[146:149], a[240:243], a[76:79], v[146:149]
    ds_read_u16 v47, v51 offset:3664
    ds_read_u16 v49, v51 offset:3690
    v_mfma_f32_16x16x32_bf16 v[150:153], a[240:243], a[100:103], v[150:153]
    s_add_u32 s63, s39, 0x1b000
    ds_read_u16 v36, v50 offset:3534
    v_mfma_f32_16x16x32_bf16 v[154:157], a[240:243], a[124:127], v[154:157]
    s_waitcnt lgkmcnt(12)
    v_lshlrev_b32 v32, 16, v32
    v_lshlrev_b32 v33, 16, v33
    v_mfma_f32_16x16x32_bf16 v[158:161], a[244:247], a[76:79], v[158:161]
    s_waitcnt lgkmcnt(9)
    v_fma_f32 v32, v32, v52, v60
    v_fma_f32 v33, v33, v53, v61
    v_mfma_f32_16x16x32_bf16 v[162:165], a[244:247], a[100:103], v[162:165]
    s_waitcnt lgkmcnt(7)
    v_lshlrev_b32 v34, 16, v34
    v_lshlrev_b32 v35, 16, v35
    v_mfma_f32_16x16x32_bf16 v[24:27], a[244:247], a[124:127], v[24:27]
    s_waitcnt lgkmcnt(5)
    v_fma_f32 v34, v34, v52, v60
    v_fma_f32 v35, v35, v53, v61
    v_mfma_f32_16x16x32_bf16 v[84:87], a[216:219], a[80:83], v[84:87]
    ds_read_b128 a[240:243], v240 offset:33920
    v_lshlrev_b32 v37, 16, v37
    v_mfma_f32_16x16x32_bf16 v[180:183], a[216:219], a[104:107], v[180:183]
    ds_read_b128 a[244:247], v240 offset:35456
    v_lshlrev_b32 v39, 16, v39
    v_mfma_f32_16x16x32_bf16 v[184:187], a[216:219], a[128:131], v[184:187]
    ds_read_b128 a[216:219], v241 offset:128
    v_lshlrev_b32 v41, 16, v41
    v_mfma_f32_16x16x32_bf16 v[188:191], a[220:223], a[80:83], v[188:191]
    buffer_load_dwordx4 v172, s[8:11], s60 offen lds
    v_lshlrev_b32 v43, 16, v43
    v_mfma_f32_16x16x32_bf16 v[192:195], a[220:223], a[104:107], v[192:195]
    ds_read_u16 v38, v50 offset:3560
    v_lshlrev_b32 v45, 16, v45
    v_mfma_f32_16x16x32_bf16 v[196:199], a[220:223], a[128:131], v[196:199]
    s_waitcnt lgkmcnt(8)
    v_fma_f32 v37, v37, v53, v61
    v_fma_f32 v39, v39, v53, v61
    v_mfma_f32_16x16x32_bf16 v[200:203], a[224:227], a[80:83], v[200:203]
    ds_read_b128 a[220:223], v241 offset:1664
    v_fma_f32 v41, v41, v53, v61
    v_mfma_f32_16x16x32_bf16 v[204:207], a[224:227], a[104:107], v[204:207]
    s_waitcnt lgkmcnt(8)
    v_fma_f32 v43, v43, v53, v61
    v_fma_f32 v45, v45, v53, v61
    v_mfma_f32_16x16x32_bf16 v[208:211], a[224:227], a[128:131], v[208:211]
    ds_read_b128 a[224:227], v241 offset:3200
    ds_read_u16 v40, v50 offset:3586
    v_mfma_f32_16x16x32_bf16 v[212:215], a[228:231], a[80:83], v[212:215]
    ds_read_u16 v42, v50 offset:3612
    ds_read_u16 v44, v50 offset:3638
    v_mfma_f32_16x16x32_bf16 v[216:219], a[228:231], a[104:107], v[216:219]
    buffer_load_dwordx4 v173, s[8:11], s60 offen offset:1024 lds
    ds_read_u16 v46, v50 offset:3664
    v_mfma_f32_16x16x32_bf16 v[220:223], a[228:231], a[128:131], v[220:223]
    ds_read_b128 a[228:231], v241 offset:4736
    ds_read_u16 v48, v50 offset:3690
    v_mfma_f32_16x16x32_bf16 v[224:227], a[232:235], a[80:83], v[224:227]
    s_waitcnt vmcnt(8) lgkmcnt(12)
    ds_read_b64_tr_b16 a[84:85], v249 offset:3072
    v_mfma_f32_16x16x32_bf16 v[228:231], a[232:235], a[104:107], v[228:231]
    ds_read_b64_tr_b16 a[86:87], v250 offset:3072
    ds_read_b64_tr_b16 a[108:109], v249 offset:3104
    v_mfma_f32_16x16x32_bf16 v[232:235], a[232:235], a[128:131], v[232:235]
    ds_read_b64_tr_b16 a[110:111], v250 offset:3104
    ds_read_b64_tr_b16 a[132:133], v249 offset:3136
    v_mfma_f32_16x16x32_bf16 v[236:239], a[236:239], a[80:83], v[236:239]
    ds_read_b64_tr_b16 a[134:135], v250 offset:3136
    s_waitcnt lgkmcnt(15)
    v_mfma_f32_16x16x32_bf16 v[138:141], a[236:239], a[104:107], v[138:141]
    ds_read_b128 a[232:235], v241 offset:30848
    v_lshlrev_b32 v47, 16, v47
    v_mfma_f32_16x16x32_bf16 v[142:145], a[236:239], a[128:131], v[142:145]
    ds_read_b128 a[236:239], v241 offset:32384
    v_lshlrev_b32 v49, 16, v49
    v_mfma_f32_16x16x32_bf16 v[146:149], a[240:243], a[80:83], v[146:149]
    buffer_load_dwordx4 v174, s[8:11], s60 offen offset:2048 lds
    v_fma_f32 v47, v47, v53, v61
    v_mfma_f32_16x16x32_bf16 v[150:153], a[240:243], a[104:107], v[150:153]
    s_add_u32 m0, s29, 0xc00
    v_fma_f32 v49, v49, v53, v61
    v_lshlrev_b32 v36, 16, v36
    v_mfma_f32_16x16x32_bf16 v[154:157], a[240:243], a[128:131], v[154:157]
    ds_read_b128 a[240:243], v241 offset:33920
    v_fma_f32 v36, v36, v52, v60
    v_mfma_f32_16x16x32_bf16 v[158:161], a[244:247], a[80:83], v[158:161]
    s_waitcnt lgkmcnt(7)
    v_lshlrev_b32 v38, 16, v38
    v_fma_f32 v38, v38, v52, v60
    v_mfma_f32_16x16x32_bf16 v[162:165], a[244:247], a[104:107], v[162:165]
    ds_write_b64 v62, v[30:31] offset:0
    v_mfma_f32_16x16x32_bf16 v[24:27], a[244:247], a[128:131], v[24:27]
    s_waitcnt lgkmcnt(4)
    v_add_u32 v62, s49, v62
    v_lshlrev_b32 v40, 16, v40
    v_mfma_f32_16x16x32_bf16 v[84:87], a[216:219], a[84:87], v[84:87]
    ds_read_b128 a[244:247], v241 offset:35456
    v_fma_f32 v40, v40, v52, v60
    v_mfma_f32_16x16x32_bf16 v[180:183], a[216:219], a[108:111], v[180:183]
    buffer_load_dwordx4 v172, s[8:11], s61 offen lds
    v_lshlrev_b32 v42, 16, v42
    v_mfma_f32_16x16x32_bf16 v[184:187], a[216:219], a[132:135], v[184:187]
    ds_read_b128 a[216:219], v240 offset:256
    v_fma_f32 v42, v42, v52, v60
    v_mfma_f32_16x16x32_bf16 v[188:191], a[220:223], a[84:87], v[188:191]
    ds_write_b64 v62, v[32:33] offset:0
    v_mfma_f32_16x16x32_bf16 v[192:195], a[220:223], a[108:111], v[192:195]
    s_add_u32 s60, s39, 0x24000
    v_add_u32 v62, s49, v62
    v_lshlrev_b32 v44, 16, v44
    v_mfma_f32_16x16x32_bf16 v[196:199], a[220:223], a[132:135], v[196:199]
    s_waitcnt lgkmcnt(6)
    v_fma_f32 v44, v44, v52, v60
    v_lshlrev_b32 v46, 16, v46
    v_mfma_f32_16x16x32_bf16 v[200:203], a[224:227], a[84:87], v[200:203]
    s_waitcnt lgkmcnt(5)
    v_fma_f32 v46, v46, v52, v60
    v_lshlrev_b32 v48, 16, v48
    v_mfma_f32_16x16x32_bf16 v[204:207], a[224:227], a[108:111], v[204:207]
    ds_read_b128 a[220:223], v240 offset:1792
    v_fma_f32 v48, v48, v52, v60
    v_mfma_f32_16x16x32_bf16 v[208:211], a[224:227], a[132:135], v[208:211]
    ds_read_b128 a[224:227], v240 offset:3328
    buffer_load_dwordx4 v173, s[8:11], s61 offen offset:1024 lds
    v_mfma_f32_16x16x32_bf16 v[212:215], a[228:231], a[84:87], v[212:215]
    s_waitcnt lgkmcnt(6)
    v_mfma_f32_16x16x32_bf16 v[216:219], a[228:231], a[108:111], v[216:219]
    ds_write_b64 v62, v[34:35] offset:0
    v_mfma_f32_16x16x32_bf16 v[220:223], a[228:231], a[132:135], v[220:223]
    ds_read_b128 a[228:231], v240 offset:4864
    v_add_u32 v62, s49, v62
    v_mfma_f32_16x16x32_bf16 v[224:227], a[232:235], a[84:87], v[224:227]
    s_waitcnt vmcnt(8)
    ds_read_b64_tr_b16 a[88:89], v249 offset:6144
    v_mfma_f32_16x16x32_bf16 v[228:231], a[232:235], a[108:111], v[228:231]
    ds_read_b64_tr_b16 a[90:91], v250 offset:6144
    ds_read_b64_tr_b16 a[112:113], v249 offset:6176
    v_mfma_f32_16x16x32_bf16 v[232:235], a[232:235], a[132:135], v[232:235]
    ds_read_b64_tr_b16 a[114:115], v250 offset:6176
    ds_read_b64_tr_b16 a[136:137], v249 offset:6208
    v_mfma_f32_16x16x32_bf16 v[236:239], a[236:239], a[84:87], v[236:239]
    ds_read_b64_tr_b16 a[138:139], v250 offset:6208
    s_waitcnt lgkmcnt(11)
    v_mfma_f32_16x16x32_bf16 v[138:141], a[236:239], a[108:111], v[138:141]
    ds_read_b128 a[232:235], v240 offset:30976
    buffer_load_dwordx4 v174, s[8:11], s61 offen offset:2048 lds
    v_mfma_f32_16x16x32_bf16 v[142:145], a[236:239], a[132:135], v[142:145]
    ds_read_b128 a[236:239], v240 offset:32512
    s_add_u32 m0, s29, 0x1800
    v_mfma_f32_16x16x32_bf16 v[146:149], a[240:243], a[84:87], v[146:149]
    ds_write_b64 v63, v[64:65] offset:0
    v_mfma_f32_16x16x32_bf16 v[150:153], a[240:243], a[108:111], v[150:153]
    ds_write_b64 v62, v[36:37] offset:0
    v_mfma_f32_16x16x32_bf16 v[154:157], a[240:243], a[132:135], v[154:157]
    ds_read_b128 a[240:243], v240 offset:34048
    v_add_u32 v62, s49, v62
    v_mfma_f32_16x16x32_bf16 v[158:161], a[244:247], a[84:87], v[158:161]
    s_waitcnt lgkmcnt(9)
    s_add_u32 s61, s39, 0x2d000
    v_mfma_f32_16x16x32_bf16 v[162:165], a[244:247], a[108:111], v[162:165]
    s_waitcnt lgkmcnt(7)
    v_mfma_f32_16x16x32_bf16 v[24:27], a[244:247], a[132:135], v[24:27]
    s_waitcnt lgkmcnt(5)
    ds_read_b128 a[244:247], v240 offset:35584
    v_mfma_f32_16x16x32_bf16 v[84:87], a[216:219], a[88:91], v[84:87]
L_h2:
    s_cbranch_execz L_h6
    buffer_load_dwordx4 v172, s[8:11], s62 offen lds
    v_mfma_f32_16x16x32_bf16 v[180:183], a[216:219], a[112:115], v[180:183]
    ds_write_b64 v62, v[38:39] offset:0
    v_mfma_f32_16x16x32_bf16 v[184:187], a[216:219], a[136:139], v[184:187]
    ds_read_b128 a[216:219], v241 offset:256
    v_add_u32 v62, s49, v62
    v_mfma_f32_16x16x32_bf16 v[188:191], a[220:223], a[88:91], v[188:191]
    ds_write_b64 v62, v[40:41] offset:0
    v_mfma_f32_16x16x32_bf16 v[192:195], a[220:223], a[112:115], v[192:195]
    v_add_u32 v62, s49, v62
    s_waitcnt lgkmcnt(8)
    v_mfma_f32_16x16x32_bf16 v[196:199], a[220:223], a[136:139], v[196:199]
    ds_read_b128 a[220:223], v241 offset:1792
    s_waitcnt lgkmcnt(8)
    v_mfma_f32_16x16x32_bf16 v[200:203], a[224:227], a[88:91], v[200:203]
    ds_write_b64 v62, v[42:43] offset:0
    v_mfma_f32_16x16x32_bf16 v[204:207], a[224:227], a[112:115], v[204:207]
    buffer_load_dwordx4 v173, s[8:11], s62 offen offset:1024 lds
    v_add_u32 v62, s49, v62
    v_mfma_f32_16x16x32_bf16 v[208:211], a[224:227], a[136:139], v[208:211]
    ds_read_b128 a[224:227], v241 offset:3328
    v_mfma_f32_16x16x32_bf16 v[212:215], a[228:231], a[88:91], v[212:215]
    s_waitcnt lgkmcnt(7)
    v_mfma_f32_16x16x32_bf16 v[216:219], a[228:231], a[112:115], v[216:219]
    ds_write_b64 v62, v[44:45] offset:0
    v_mfma_f32_16x16x32_bf16 v[220:223], a[228:231], a[136:139], v[220:223]
    ds_read_b128 a[228:231], v241 offset:4864
    v_add_u32 v62, s49, v62
    v_mfma_f32_16x16x32_bf16 v[224:227], a[232:235], a[88:91], v[224:227]
    s_waitcnt vmcnt(8) lgkmcnt(8)
    ds_read_b64_tr_b16 a[92:93], v249 offset:9216
    v_mfma_f32_16x16x32_bf16 v[228:231], a[232:235], a[112:115], v[228:231]
    ds_read_b64_tr_b16 a[94:95], v250 offset:9216
    ds_read_b64_tr_b16 a[116:117], v249 offset:9248
    v_mfma_f32_16x16x32_bf16 v[232:235], a[232:235], a[136:139], v[232:235]
    ds_read_b64_tr_b16 a[118:119], v250 offset:9248
    ds_read_b64_tr_b16 a[140:141], v249 offset:9280
    v_mfma_f32_16x16x32_bf16 v[236:239], a[236:239], a[88:91], v[236:239]
    ds_read_b64_tr_b16 a[142:143], v250 offset:9280
    ds_read_b128 a[232:235], v241 offset:30976
    v_mfma_f32_16x16x32_bf16 v[138:141], a[236:239], a[112:115], v[138:141]
    buffer_load_dwordx4 v174, s[8:11], s62 offen offset:2048 lds
    s_add_u32 m0, s29, 0x2400
    v_mfma_f32_16x16x32_bf16 v[142:145], a[236:239], a[136:139], v[142:145]
    ds_read_b128 a[236:239], v241 offset:32512
    s_lshl_b32 s62, s28, 5
    v_mfma_f32_16x16x32_bf16 v[146:149], a[240:243], a[88:91], v[146:149]
    ds_write_b64 v62, v[46:47] offset:0
    v_mfma_f32_16x16x32_bf16 v[150:153], a[240:243], a[112:115], v[150:153]
    s_add_u32 s62, s62, 0
    v_add_u32 v62, s49, v62
    v_mfma_f32_16x16x32_bf16 v[154:157], a[240:243], a[136:139], v[154:157]
    ds_read_b128 a[240:243], v241 offset:34048
    v_mfma_f32_16x16x32_bf16 v[158:161], a[244:247], a[88:91], v[158:161]
    s_waitcnt lgkmcnt(8)
    v_mfma_f32_16x16x32_bf16 v[162:165], a[244:247], a[112:115], v[162:165]
    s_waitcnt lgkmcnt(6)
    v_mfma_f32_16x16x32_bf16 v[24:27], a[244:247], a[136:139], v[24:27]
    s_waitcnt lgkmcnt(4)
    ds_read_b128 a[244:247], v241 offset:35584
    v_mfma_f32_16x16x32_bf16 v[84:87], a[216:219], a[92:95], v[84:87]
    buffer_load_dwordx4 v172, s[8:11], s63 offen lds
    v_mfma_f32_16x16x32_bf16 v[180:183], a[216:219], a[116:119], v[180:183]
    ds_write_b64 v62, v[48:49] offset:0
    v_mfma_f32_16x16x32_bf16 v[184:187], a[216:219], a[140:143], v[184:187]
    ds_read_b128 a[216:219], v240 offset:61440
    v_add_u32 v62, s49, v62
    v_mfma_f32_16x16x32_bf16 v[188:191], a[220:223], a[92:95], v[188:191]
    v_mfma_f32_16x16x32_bf16 v[192:195], a[220:223], a[116:119], v[192:195]
    v_cvt_pk_bf16_f32 v0, v84, v85
    v_cvt_pk_bf16_f32 v3, v86, v87
    v_mfma_f32_16x16x32_bf16 v[196:199], a[220:223], a[140:143], v[196:199]
    s_waitcnt lgkmcnt(6)
    v_cvt_pk_bf16_f32 v30, v180, v181
    v_cvt_pk_bf16_f32 v33, v182, v183
    v_mfma_f32_16x16x32_bf16 v[200:203], a[224:227], a[92:95], v[200:203]
    s_waitcnt lgkmcnt(5)
    v_cvt_pk_bf16_f32 v60, v184, v185
    v_cvt_pk_bf16_f32 v63, v186, v187
    v_mfma_f32_16x16x32_bf16 v[204:207], a[224:227], a[116:119], v[204:207]
    ds_read_b128 a[220:223], v241 offset:61440
    v_cvt_pk_bf16_f32 v66, v196, v197
    v_mfma_f32_16x16x32_bf16 v[208:211], a[224:227], a[140:143], v[208:211]
    ds_read_b128 a[224:227], v240 offset:61568
    v_cvt_pk_bf16_f32 v69, v198, v199
    v_mfma_f32_16x16x32_bf16 v[212:215], a[228:231], a[92:95], v[212:215]
    s_waitcnt lgkmcnt(5)
    v_cvt_pk_bf16_f32 v12, v200, v201
    v_cvt_pk_bf16_f32 v15, v202, v203
    v_mfma_f32_16x16x32_bf16 v[216:219], a[228:231], a[116:119], v[216:219]
    buffer_load_dwordx4 v173, s[8:11], s63 offen offset:1024 lds
    v_cvt_pk_bf16_f32 v42, v204, v205
    v_mfma_f32_16x16x32_bf16 v[220:223], a[228:231], a[140:143], v[220:223]
    ds_read_b128 a[228:231], v241 offset:61568
    v_cvt_pk_bf16_f32 v45, v206, v207
    v_mfma_f32_16x16x32_bf16 v[224:227], a[232:235], a[92:95], v[224:227]
    ds_read_b128 v[196:199], v244 offset:192
    v_cvt_pk_bf16_f32 v72, v208, v209
    v_mfma_f32_16x16x32_bf16 v[228:231], a[232:235], a[116:119], v[228:231]
    s_waitcnt lgkmcnt(6)
    v_cvt_pk_bf16_f32 v75, v210, v211
    v_cvt_pk_bf16_f32 v18, v212, v213
    v_mfma_f32_16x16x32_bf16 v[232:235], a[232:235], a[140:143], v[232:235]
    ds_read_b128 a[232:235], v240 offset:61696
    v_cvt_pk_bf16_f32 v1, v224, v225
    v_mfma_f32_16x16x32_bf16 v[236:239], a[236:239], a[92:95], v[236:239]
    ds_read_b128 v[200:203], v245 offset:192
    v_cvt_pk_bf16_f32 v31, v228, v229
    v_mfma_f32_16x16x32_bf16 v[138:141], a[236:239], a[116:119], v[138:141]
    ds_read_b128 v[204:207], v246 offset:192
    v_cvt_pk_bf16_f32 v34, v230, v231
    v_mfma_f32_16x16x32_bf16 v[142:145], a[236:239], a[140:143], v[142:145]
    ds_read_b128 a[236:239], v241 offset:61696
    v_cvt_pk_bf16_f32 v61, v232, v233
    v_mfma_f32_16x16x32_bf16 v[146:149], a[240:243], a[92:95], v[146:149]
    s_waitcnt lgkmcnt(8)
    v_cvt_pk_bf16_f32 v64, v234, v235
    v_cvt_pk_bf16_f32 v7, v236, v237
    v_mfma_f32_16x16x32_bf16 v[150:153], a[240:243], a[116:119], v[150:153]
    buffer_load_dwordx4 v174, s[8:11], s63 offen offset:2048 lds
    v_cvt_pk_bf16_f32 v10, v238, v239
    v_mfma_f32_16x16x32_bf16 v[154:157], a[240:243], a[140:143], v[154:157]
    s_add_u32 m0, s29, 0
    v_cvt_pk_bf16_f32 v37, v138, v139
    v_cvt_pk_bf16_f32 v40, v140, v141
    v_mfma_f32_16x16x32_bf16 v[158:161], a[244:247], a[92:95], v[158:161]
    ds_read_b128 a[240:243], v240 offset:62976
    v_cvt_pk_bf16_f32 v67, v142, v143
    v_mfma_f32_16x16x32_bf16 v[162:165], a[244:247], a[116:119], v[162:165]
    s_lshl_b32 s63, s28, 5
    v_cvt_pk_bf16_f32 v70, v144, v145
    v_cvt_pk_bf16_f32 v13, v146, v147
    v_mfma_f32_16x16x32_bf16 v[24:27], a[244:247], a[140:143], v[24:27]
    ds_read_b128 a[244:247], v241 offset:62976
    v_cvt_pk_bf16_f32 v16, v148, v149
    v_mfma_f32_16x16x32_bf16 v[228:231], a[0:3], a[216:219], 0
    s_waitcnt lgkmcnt(8)
    v_cvt_pk_bf16_f32 v43, v150, v151
    v_cvt_pk_bf16_f32 v46, v152, v153
    v_mfma_f32_16x16x32_bf16 v[228:231], a[4:7], a[220:223], v[228:231]
    ds_read_b128 v[208:211], v244 offset:256
    v_cvt_pk_bf16_f32 v73, v154, v155
    v_mfma_f32_16x16x32_bf16 v[228:231], a[8:11], a[224:227], v[228:231]
    s_waitcnt vmcnt(9) lgkmcnt(7)
    ds_read_b64_tr_b16 a[144:145], v249 offset:0
    v_mfma_f32_16x16x32_bf16 v[228:231], a[12:15], a[228:231], v[228:231]
    ds_read_b64_tr_b16 a[146:147], v250 offset:0
    ds_read_b64_tr_b16 a[168:169], v249 offset:32
    v_mfma_f32_16x16x32_bf16 v[232:235], a[24:27], a[216:219], 0
    ds_read_b64_tr_b16 a[170:171], v250 offset:32
    ds_read_b64_tr_b16 a[192:193], v249 offset:64
    v_mfma_f32_16x16x32_bf16 v[232:235], a[28:31], a[220:223], v[232:235]
    ds_read_b64_tr_b16 a[194:195], v250 offset:64
    s_waitcnt lgkmcnt(10)
    v_mfma_f32_16x16x32_bf16 v[228:231], a[16:19], a[232:235], v[228:231]
    s_waitcnt lgkmcnt(9)
    v_cvt_pk_bf16_f32 v76, v156, v157
    v_cvt_pk_bf16_f32 v21, v214, v215
    v_mfma_f32_16x16x32_bf16 v[228:231], a[20:23], a[236:239], v[228:231]
    s_add_u32 s63, s63, 0x4800
    v_cvt_pk_bf16_f32 v48, v216, v217
    v_cvt_pk_bf16_f32 v51, v218, v219
    v_mfma_f32_16x16x32_bf16 v[232:235], a[32:35], a[224:227], v[232:235]
    v_cvt_pk_bf16_f32 v78, v220, v221
    v_cvt_pk_bf16_f32 v81, v222, v223
    v_mfma_f32_16x16x32_bf16 v[232:235], a[36:39], a[228:231], v[232:235]
    v_cvt_pk_bf16_f32 v4, v226, v227
    v_cvt_pk_bf16_f32 v138, v228, v229
    v_mfma_f32_16x16x32_bf16 v[232:235], a[40:43], a[232:235], v[232:235]
    v_cvt_pk_bf16_f32 v139, v230, v231
    v_cvt_pk_bf16_f32 v6, v188, v189
    v_mfma_f32_16x16x32_bf16 v[232:235], a[44:47], a[236:239], v[232:235]
    v_cvt_pk_bf16_f32 v36, v192, v193
    v_cvt_pk_bf16_f32 v9, v190, v191
    v_mfma_f32_16x16x32_bf16 v[236:239], a[48:51], a[216:219], 0
    v_cvt_pk_bf16_f32 v39, v194, v195
    v_cvt_pk_bf16_f32 v19, v158, v159
    v_mfma_f32_16x16x32_bf16 v[236:239], a[52:55], a[220:223], v[236:239]
    v_mov_b32 v195, 0
    s_waitcnt lgkmcnt(0)
    v_mfma_f32_16x16x32_bf16 v[236:239], a[56:59], a[224:227], v[236:239]
    buffer_load_dwordx4 v172, s[8:11], s60 offen lds
    v_cvt_pk_bf16_f32 v140, v232, v233
    v_mfma_f32_16x16x32_bf16 v[236:239], a[60:63], a[228:231], v[236:239]
    v_cvt_pk_bf16_f32 v141, v234, v235
    v_cvt_pk_bf16_f32 v22, v160, v161
    v_mfma_f32_16x16x32_bf16 v[236:239], a[64:67], a[232:235], v[236:239]
    v_cvt_pk_bf16_f32 v49, v162, v163
    v_cvt_pk_bf16_f32 v52, v164, v165
    v_mfma_f32_16x16x32_bf16 v[236:239], a[68:71], a[236:239], v[236:239]
    v_cvt_pk_bf16_f32 v79, v24, v25
    v_cvt_pk_bf16_f32 v82, v26, v27
    v_mfma_f32_16x16x32_bf16 v[228:231], a[216:219], a[72:75], 0
    v_mfma_f32_16x16x32_bf16 v[228:231], a[220:223], a[76:79], v[228:231]
    v_mfma_f32_16x16x32_bf16 v[228:231], a[224:227], a[80:83], v[228:231]
    v_mfma_f32_16x16x32_bf16 v[228:231], a[228:231], a[84:87], v[228:231]
    buffer_load_dwordx4 v173, s[8:11], s60 offen offset:1024 lds
    v_mfma_f32_16x16x32_bf16 v[228:231], a[232:235], a[88:91], v[228:231]
    s_waitcnt vmcnt(8)
    ds_read_b64_tr_b16 a[148:149], v249 offset:3072
    v_mfma_f32_16x16x32_bf16 v[228:231], a[236:239], a[92:95], v[228:231]
    ds_read_b64_tr_b16 a[150:151], v250 offset:3072
    ds_read_b64_tr_b16 a[172:173], v249 offset:3104
    v_mfma_f32_16x16x32_bf16 v[232:235], a[216:219], a[96:99], 0
    ds_read_b64_tr_b16 a[174:175], v250 offset:3104
    ds_read_b64_tr_b16 a[196:197], v249 offset:3136
    v_mfma_f32_16x16x32_bf16 v[232:235], a[220:223], a[100:103], v[232:235]
    ds_read_b64_tr_b16 a[198:199], v250 offset:3136
    v_cvt_pk_bf16_f32 v142, v236, v237
    v_mfma_f32_16x16x32_bf16 v[232:235], a[224:227], a[104:107], v[232:235]
    v_cvt_pk_bf16_f32 v143, v238, v239
    v_cvt_pk_bf16_f32 v2, v228, v229
    v_mfma_f32_16x16x32_bf16 v[232:235], a[228:231], a[108:111], v[232:235]
    v_cvt_pk_bf16_f32 v5, v230, v231
    v_mfma_f32_16x16x32_bf16 v[232:235], a[232:235], a[112:115], v[232:235]
    buffer_load_dwordx4 v174, s[8:11], s60 offen offset:2048 lds
    s_add_u32 m0, s29, 0xc00
    v_mfma_f32_16x16x32_bf16 v[232:235], a[236:239], a[116:119], v[232:235]
    s_lshl_b32 s60, s28, 5
    s_add_u32 s60, s60, 0x1800
    v_mfma_f32_16x16x32_bf16 v[236:239], a[216:219], a[120:123], 0
    ds_read_b128 a[216:219], v240 offset:63104
    v_mfma_f32_16x16x32_bf16 v[236:239], a[220:223], a[124:127], v[236:239]
    ds_read_b128 a[220:223], v241 offset:63104
    v_mfma_f32_16x16x32_bf16 v[236:239], a[224:227], a[128:131], v[236:239]
    ds_read_b128 a[224:227], v240 offset:63232
    v_cvt_pk_bf16_f32 v32, v232, v233
    v_mfma_f32_16x16x32_bf16 v[236:239], a[228:231], a[132:135], v[236:239]
    ds_read_b128 a[228:231], v241 offset:63232
    s_waitcnt lgkmcnt(4)
    v_mfma_f32_16x16x32_bf16 v[236:239], a[232:235], a[136:139], v[236:239]
    ds_read_b128 a[232:235], v240 offset:64512
    v_cvt_pk_bf16_f32 v35, v234, v235
    v_mfma_f32_16x16x32_bf16 v[236:239], a[236:239], a[140:143], v[236:239]
    buffer_load_dwordx4 v172, s[8:11], s61 offen lds
    ds_read_b128 a[236:239], v241 offset:64512
    v_mfma_f32_16x16x32_bf16 v[228:231], a[0:3], a[240:243], 0
    v_mfma_f32_16x16x32_bf16 v[228:231], a[4:7], a[244:247], v[228:231]
    v_mfma_f32_16x16x32_bf16 v[232:235], a[24:27], a[240:243], 0
    v_mfma_f32_16x16x32_bf16 v[232:235], a[28:31], a[244:247], v[232:235]
    s_waitcnt vmcnt(7) lgkmcnt(5)
    ds_read_b64_tr_b16 a[152:153], v249 offset:6144
    v_mfma_f32_16x16x32_bf16 v[228:231], a[8:11], a[216:219], v[228:231]
    s_waitcnt lgkmcnt(5)
    v_cvt_pk_bf16_f32 v62, v236, v237
    v_cvt_pk_bf16_f32 v65, v238, v239
    v_mfma_f32_16x16x32_bf16 v[228:231], a[12:15], a[220:223], v[228:231]
    s_waitcnt lgkmcnt(4)
    ds_read_b64_tr_b16 a[154:155], v250 offset:6144
    v_mfma_f32_16x16x32_bf16 v[228:231], a[16:19], a[224:227], v[228:231]
    buffer_load_dwordx4 v173, s[8:11], s61 offen offset:1024 lds
    s_waitcnt lgkmcnt(4)
    v_mfma_f32_16x16x32_bf16 v[228:231], a[20:23], a[228:231], v[228:231]
    ds_read_b64_tr_b16 a[176:177], v249 offset:6176
    ds_read_b64_tr_b16 a[178:179], v250 offset:6176
    v_mfma_f32_16x16x32_bf16 v[232:235], a[32:35], a[216:219], v[232:235]
    ds_read_b64_tr_b16 a[200:201], v249 offset:6208
    ds_read_b64_tr_b16 a[202:203], v250 offset:6208
    v_mfma_f32_16x16x32_bf16 v[232:235], a[36:39], a[220:223], v[232:235]
    v_mfma_f32_16x16x32_bf16 v[232:235], a[40:43], a[224:227], v[232:235]
    v_mfma_f32_16x16x32_bf16 v[232:235], a[44:47], a[228:231], v[232:235]
    v_cvt_pk_bf16_f32 v144, v228, v229
    v_cvt_pk_bf16_f32 v145, v230, v231
    v_mfma_f32_16x16x32_bf16 v[236:239], a[48:51], a[240:243], 0
    v_mfma_f32_16x16x32_bf16 v[236:239], a[52:55], a[244:247], v[236:239]
    buffer_load_dwordx4 v174, s[8:11], s61 offen offset:2048 lds
    s_add_u32 m0, s46, 0x1800
    v_mfma_f32_16x16x32_bf16 v[236:239], a[56:59], a[216:219], v[236:239]
    s_lshl_b32 s61, s28, 5
    v_cvt_pk_bf16_f32 v146, v232, v233
    v_cvt_pk_bf16_f32 v147, v234, v235
    v_mfma_f32_16x16x32_bf16 v[236:239], a[60:63], a[220:223], v[236:239]
    s_add_u32 s61, s61, 0x6000
    v_mfma_f32_16x16x32_bf16 v[236:239], a[64:67], a[224:227], v[236:239]
    v_mfma_f32_16x16x32_bf16 v[236:239], a[68:71], a[228:231], v[236:239]
    v_mfma_f32_16x16x32_bf16 v[228:231], a[240:243], a[72:75], 0
    v_mfma_f32_16x16x32_bf16 v[228:231], a[244:247], a[76:79], v[228:231]
    v_mfma_f32_16x16x32_bf16 v[228:231], a[216:219], a[80:83], v[228:231]
    buffer_load_dwordx4 v168, s[4:7], s58 offen lds
    v_mfma_f32_16x16x32_bf16 v[228:231], a[220:223], a[84:87], v[228:231]
    v_mfma_f32_16x16x32_bf16 v[228:231], a[224:227], a[88:91], v[228:231]
    v_mfma_f32_16x16x32_bf16 v[228:231], a[228:231], a[92:95], v[228:231]
    v_mfma_f32_16x16x32_bf16 v[232:235], a[240:243], a[96:99], 0
    v_cvt_pk_bf16_f32 v148, v236, v237
    v_cvt_pk_bf16_f32 v149, v238, v239
    v_mfma_f32_16x16x32_bf16 v[232:235], a[244:247], a[100:103], v[232:235]
    buffer_load_dwordx4 v171, s[4:7], s58 offen offset:512 lds
    s_add_u32 m0, s46, 0x9000
    v_mfma_f32_16x16x32_bf16 v[232:235], a[216:219], a[104:107], v[232:235]
    s_lshl1_add_u32 s58, s45, s41
    v_cvt_pk_bf16_f32 v8, v228, v229
    v_cvt_pk_bf16_f32 v11, v230, v231
    v_mfma_f32_16x16x32_bf16 v[232:235], a[220:223], a[108:111], v[232:235]
    s_waitcnt lgkmcnt(0)
    v_mfma_f32_16x16x32_bf16 v[232:235], a[224:227], a[112:115], v[232:235]
    v_mfma_f32_16x16x32_bf16 v[232:235], a[228:231], a[116:119], v[232:235]
    buffer_load_dwordx4 v168, s[4:7], s58 offen lds
    v_mfma_f32_16x16x32_bf16 v[236:239], a[240:243], a[120:123], 0
    ds_read_b128 a[240:243], v240 offset:64640
    v_mfma_f32_16x16x32_bf16 v[236:239], a[244:247], a[124:127], v[236:239]
    ds_read_b128 a[244:247], v241 offset:64640
    v_mfma_f32_16x16x32_bf16 v[236:239], a[216:219], a[128:131], v[236:239]
    ds_read_b128 a[216:219], v240 offset:64768
    v_add_u32 v240, 0xf000, v240
    v_mfma_f32_16x16x32_bf16 v[236:239], a[220:223], a[132:135], v[236:239]
    ds_read_b128 a[220:223], v241 offset:64768
    v_cvt_pk_bf16_f32 v38, v232, v233
    v_mfma_f32_16x16x32_bf16 v[236:239], a[224:227], a[136:139], v[236:239]
    ds_read_b128 a[224:227], v242 offset:0
    v_cvt_pk_bf16_f32 v41, v234, v235
    v_mfma_f32_16x16x32_bf16 v[236:239], a[228:231], a[140:143], v[236:239]
    ds_read_b128 a[228:231], v243 offset:0
    v_add_u32 v241, 0xf000, v241
    v_mfma_f32_16x16x32_bf16 v[228:231], a[0:3], a[232:235], 0
    buffer_load_dwordx4 v171, s[4:7], s58 offen offset:512 lds
    s_add_u32 m0, s46, 0x10800
    v_mfma_f32_16x16x32_bf16 v[228:231], a[4:7], a[236:239], v[228:231]
    s_lshl1_add_u32 s58, s45, s42
    v_mfma_f32_16x16x32_bf16 v[232:235], a[24:27], a[232:235], 0
    v_cvt_pk_bf16_f32 v68, v236, v237
    s_waitcnt lgkmcnt(5)
    v_mfma_f32_16x16x32_bf16 v[228:231], a[8:11], a[240:243], v[228:231]
    v_cvt_pk_bf16_f32 v71, v238, v239
    s_waitcnt lgkmcnt(4)
    v_mfma_f32_16x16x32_bf16 v[228:231], a[12:15], a[244:247], v[228:231]
    buffer_load_dwordx4 v168, s[4:7], s58 offen lds
    s_waitcnt lgkmcnt(3)
    v_mfma_f32_16x16x32_bf16 v[228:231], a[16:19], a[216:219], v[228:231]
    v_mfma_f32_16x16x32_bf16 v[232:235], a[28:31], a[236:239], v[232:235]
    s_waitcnt lgkmcnt(2)
    v_mfma_f32_16x16x32_bf16 v[228:231], a[20:23], a[220:223], v[228:231]
    v_mfma_f32_16x16x32_bf16 v[232:235], a[32:35], a[240:243], v[232:235]
    buffer_load_dwordx4 v171, s[4:7], s58 offen offset:512 lds
    s_add_u32 m0, s46, 0x16800
    v_mfma_f32_16x16x32_bf16 v[232:235], a[36:39], a[244:247], v[232:235]
    s_lshl1_add_u32 s58, s45, s43
    v_mfma_f32_16x16x32_bf16 v[232:235], a[40:43], a[216:219], v[232:235]
    v_mfma_f32_16x16x32_bf16 v[232:235], a[44:47], a[220:223], v[232:235]
    v_mfma_f32_16x16x32_bf16 v[236:239], a[48:51], a[232:235], 0
    v_cvt_pk_bf16_f32 v150, v228, v229
    v_cvt_pk_bf16_f32 v151, v230, v231
    v_mfma_f32_16x16x32_bf16 v[236:239], a[52:55], a[236:239], v[236:239]
    v_mfma_f32_16x16x32_bf16 v[236:239], a[56:59], a[240:243], v[236:239]
    v_mfma_f32_16x16x32_bf16 v[236:239], a[60:63], a[244:247], v[236:239]
    v_mfma_f32_16x16x32_bf16 v[236:239], a[64:67], a[216:219], v[236:239]
    v_mfma_f32_16x16x32_bf16 v[236:239], a[68:71], a[220:223], v[236:239]
    v_cvt_pk_bf16_f32 v152, v232, v233
    v_cvt_pk_bf16_f32 v153, v234, v235
    v_mfma_f32_16x16x32_bf16 v[228:231], a[232:235], a[72:75], 0
    v_mfma_f32_16x16x32_bf16 v[228:231], a[236:239], a[76:79], v[228:231]
    v_mfma_f32_16x16x32_bf16 v[228:231], a[240:243], a[80:83], v[228:231]
    v_mfma_f32_16x16x32_bf16 v[228:231], a[244:247], a[84:87], v[228:231]
    v_mfma_f32_16x16x32_bf16 v[228:231], a[216:219], a[88:91], v[228:231]
    v_mfma_f32_16x16x32_bf16 v[228:231], a[220:223], a[92:95], v[228:231]
    s_waitcnt vmcnt(12)
    v_cvt_pk_bf16_f32 v154, v236, v237
    v_cvt_pk_bf16_f32 v155, v238, v239
    v_mfma_f32_16x16x32_bf16 v[232:235], a[232:235], a[96:99], 0
    ds_read_b64_tr_b16 a[156:157], v249 offset:9216
    ds_read_b64_tr_b16 a[158:159], v250 offset:9216
    v_mfma_f32_16x16x32_bf16 v[232:235], a[236:239], a[100:103], v[232:235]
    ds_read_b64_tr_b16 a[180:181], v249 offset:9248
    v_cvt_pk_bf16_f32 v14, v228, v229
    v_mfma_f32_16x16x32_bf16 v[232:235], a[240:243], a[104:107], v[232:235]
    ds_read_b64_tr_b16 a[182:183], v250 offset:9248
    v_cvt_pk_bf16_f32 v17, v230, v231
    v_mfma_f32_16x16x32_bf16 v[232:235], a[244:247], a[108:111], v[232:235]
    s_waitcnt lgkmcnt(4)
    ds_read_b64_tr_b16 a[204:205], v249 offset:9280
    v_mfma_f32_16x16x32_bf16 v[232:235], a[216:219], a[112:115], v[232:235]
    ds_read_b64_tr_b16 a[206:207], v250 offset:9280
    v_mfma_f32_16x16x32_bf16 v[232:235], a[220:223], a[116:119], v[232:235]
    s_waitcnt vmcnt(9)
    ds_read_b64_tr_b16 a[160:161], v249 offset:0
    v_mfma_f32_16x16x32_bf16 v[236:239], a[232:235], a[120:123], 0
    ds_read_b128 a[232:235], v242 offset:128
    ds_read_b64_tr_b16 a[162:163], v250 offset:0
    v_mfma_f32_16x16x32_bf16 v[236:239], a[236:239], a[124:127], v[236:239]
    ds_read_b128 a[236:239], v243 offset:128
    s_waitcnt vmcnt(6)
    v_mfma_f32_16x16x32_bf16 v[236:239], a[240:243], a[128:131], v[236:239]
    ds_read_b128 a[240:243], v242 offset:256
    ds_read_b64_tr_b16 a[164:165], v249 offset:3072
    v_mfma_f32_16x16x32_bf16 v[236:239], a[244:247], a[132:135], v[236:239]
    ds_read_b64_tr_b16 a[166:167], v250 offset:3072
    ds_read_b128 a[244:247], v243 offset:256
    v_mfma_f32_16x16x32_bf16 v[236:239], a[216:219], a[136:139], v[236:239]
    ds_read_b64_tr_b16 a[184:185], v249 offset:32
    ds_read_b64_tr_b16 a[186:187], v250 offset:32
    v_mfma_f32_16x16x32_bf16 v[236:239], a[220:223], a[140:143], v[236:239]
    ds_read_b64_tr_b16 a[188:189], v249 offset:3104
    ds_read_b64_tr_b16 a[190:191], v250 offset:3104
    v_mfma_f32_16x16x32_bf16 v[228:231], a[144:147], a[224:227], 0
    v_cvt_pk_bf16_f32 v44, v232, v233
    v_cvt_pk_bf16_f32 v47, v234, v235
    v_mfma_f32_16x16x32_bf16 v[228:231], a[148:151], a[228:231], v[228:231]
    ds_read_b64_tr_b16 a[208:209], v249 offset:64
    ds_read_b64_tr_b16 a[210:211], v250 offset:64
    v_mfma_f32_16x16x32_bf16 v[232:235], a[168:171], a[224:227], 0
    s_waitcnt lgkmcnt(12)
    v_cvt_pk_bf16_f32 v74, v236, v237
    v_cvt_pk_bf16_f32 v77, v238, v239
    v_mfma_f32_16x16x32_bf16 v[228:231], a[152:155], a[232:235], v[228:231]
    ds_read_b64_tr_b16 a[212:213], v249 offset:3136
    s_waitcnt lgkmcnt(11)
    v_mfma_f32_16x16x32_bf16 v[228:231], a[156:159], a[236:239], v[228:231]
    ds_read_b64_tr_b16 a[214:215], v250 offset:3136
    s_waitcnt lgkmcnt(11)
    v_mfma_f32_16x16x32_bf16 v[228:231], a[160:163], a[240:243], v[228:231]
    ds_read_b128 a[216:219], v240 offset:4608
    v_add_u32 v249, s66, v249
    v_mfma_f32_16x16x32_bf16 v[232:235], a[172:175], a[228:231], v[232:235]
    ds_read_b128 a[220:223], v241 offset:4608
    s_waitcnt lgkmcnt(10)
    v_mfma_f32_16x16x32_bf16 v[228:231], a[164:167], a[244:247], v[228:231]
    v_add_u32 v250, s66, v250
    s_lshl_b32 s66, s28, 1
    v_mfma_f32_16x16x32_bf16 v[232:235], a[176:179], a[232:235], v[232:235]
    v_mfma_f32_16x16x32_bf16 v[232:235], a[180:183], a[236:239], v[232:235]
    s_waitcnt lgkmcnt(8)
    v_mfma_f32_16x16x32_bf16 v[232:235], a[184:187], a[240:243], v[232:235]
    s_waitcnt lgkmcnt(6)
    v_mfma_f32_16x16x32_bf16 v[232:235], a[188:191], a[244:247], v[232:235]
    v_mul_f32 v228, s38, v228
    v_mul_f32 v229, s38, v229
    v_mfma_f32_16x16x32_bf16 v[236:239], a[192:195], a[224:227], 0
    v_mul_f32 v230, s38, v230
    v_mul_f32 v231, s38, v231
    v_mfma_f32_16x16x32_bf16 v[236:239], a[196:199], a[228:231], v[236:239]
    v_cvt_pk_bf16_f32 v168, v228, v229
    v_cvt_pk_bf16_f32 v169, v230, v231
    v_mfma_f32_16x16x32_bf16 v[236:239], a[200:203], a[232:235], v[236:239]
    v_mul_f32 v232, s3, v232
    v_mul_f32 v233, s3, v233
    v_mfma_f32_16x16x32_bf16 v[236:239], a[204:207], a[236:239], v[236:239]
    s_waitcnt lgkmcnt(1)
    v_mul_f32 v234, s3, v234
    v_mul_f32 v235, s3, v235
    v_mfma_f32_16x16x32_bf16 v[236:239], a[208:211], a[240:243], v[236:239]
    v_cvt_pk_bf16_f32 v170, v232, v233
    v_cvt_pk_bf16_f32 v171, v234, v235
    v_mfma_f32_16x16x32_bf16 v[236:239], a[212:215], a[244:247], v[236:239]
    ds_read_b128 a[224:227], v240 offset:4736
    ds_read_b128 a[228:231], v241 offset:4736
    v_mfma_f32_16x16x32_bf16 v[196:199], v[90:93], v[168:171], v[196:199]
    ds_read_b128 a[232:235], v240 offset:4864
    ds_read_b128 a[236:239], v241 offset:4864
    v_mfma_f32_16x16x32_bf16 v[200:203], v[114:117], v[168:171], v[200:203]
    ds_read_b128 a[240:243], v242 offset:1536
    v_add_u32 v240, 0xffff1000, v240
    v_mfma_f32_16x16x32_bf16 v[204:207], v[138:141], v[168:171], v[204:207]
    v_mul_f32 v236, s38, v236
    v_mul_f32 v237, s38, v237
    v_mfma_f32_16x16x32_bf16 v[208:211], v[96:99], v[168:171], v[208:211]
    v_mul_f32 v238, s38, v238
    v_mul_f32 v239, s38, v239
    v_mfma_f32_16x16x32_bf16 v[228:231], a[0:3], a[216:219], 0
    s_waitcnt lgkmcnt(5)
    v_cvt_pk_bf16_f32 v172, v236, v237
    v_cvt_pk_bf16_f32 v173, v238, v239
    v_mfma_f32_16x16x32_bf16 v[228:231], a[4:7], a[220:223], v[228:231]
    ds_read_b128 a[244:247], v243 offset:1536
    v_add_u32 v241, 0xffff1000, v241
    v_mfma_f32_16x16x32_bf16 v[196:199], v[92:95], v[170:173], v[196:199]
    v_mfma_f32_16x16x32_bf16 v[200:203], v[116:119], v[170:173], v[200:203]
    s_waitcnt lgkmcnt(5)
    v_mfma_f32_16x16x32_bf16 v[204:207], v[140:143], v[170:173], v[204:207]
    v_mfma_f32_16x16x32_bf16 v[208:211], v[98:101], v[170:173], v[208:211]
    v_mfma_f32_16x16x32_bf16 v[228:231], a[8:11], a[224:227], v[228:231]
    s_waitcnt lgkmcnt(4)
    v_mfma_f32_16x16x32_bf16 v[228:231], a[12:15], a[228:231], v[228:231]
    s_waitcnt lgkmcnt(3)
    v_exp_f32 v196, v196
    v_mfma_f32_16x16x32_bf16 v[228:231], a[16:19], a[232:235], v[228:231]
    s_waitcnt lgkmcnt(2)
    v_exp_f32 v197, v197
    v_mfma_f32_16x16x32_bf16 v[228:231], a[20:23], a[236:239], v[228:231]
    v_exp_f32 v198, v198
    v_mfma_f32_16x16x32_bf16 v[232:235], a[24:27], a[216:219], 0
    v_exp_f32 v199, v199
    v_mfma_f32_16x16x32_bf16 v[232:235], a[28:31], a[220:223], v[232:235]
    v_cvt_pk_bf16_f32 v180, v196, v197
    v_cvt_pk_bf16_f32 v183, v198, v199
    v_mfma_f32_16x16x32_bf16 v[232:235], a[32:35], a[224:227], v[232:235]
    ds_read_b128 v[196:199], v245 offset:256
    v_cvt_pk_bf16_f32 v156, v228, v229
    v_mfma_f32_16x16x32_bf16 v[232:235], a[36:39], a[228:231], v[232:235]
    v_exp_f32 v200, v200
    v_mfma_f32_16x16x32_bf16 v[232:235], a[40:43], a[232:235], v[232:235]
    v_exp_f32 v201, v201
    v_mfma_f32_16x16x32_bf16 v[232:235], a[44:47], a[236:239], v[232:235]
    v_exp_f32 v202, v202
    v_mfma_f32_16x16x32_bf16 v[236:239], a[48:51], a[216:219], 0
    v_exp_f32 v203, v203
    v_mfma_f32_16x16x32_bf16 v[236:239], a[52:55], a[220:223], v[236:239]
    v_cvt_pk_bf16_f32 v181, v200, v201
    v_cvt_pk_bf16_f32 v184, v202, v203
    v_mfma_f32_16x16x32_bf16 v[236:239], a[56:59], a[224:227], v[236:239]
    ds_read_b128 v[200:203], v246 offset:256
    v_cvt_pk_bf16_f32 v157, v230, v231
    v_mfma_f32_16x16x32_bf16 v[236:239], a[60:63], a[228:231], v[236:239]
    v_exp_f32 v204, v204
    v_mfma_f32_16x16x32_bf16 v[236:239], a[64:67], a[232:235], v[236:239]
    v_exp_f32 v205, v205
    v_mfma_f32_16x16x32_bf16 v[236:239], a[68:71], a[236:239], v[236:239]
    s_waitcnt lgkmcnt(1)
    v_exp_f32 v206, v206
    v_mfma_f32_16x16x32_bf16 v[196:199], v[120:123], v[168:171], v[196:199]
    v_exp_f32 v207, v207
    v_mfma_f32_16x16x32_bf16 v[196:199], v[122:125], v[170:173], v[196:199]
    v_cvt_pk_bf16_f32 v182, v204, v205
    v_cvt_pk_bf16_f32 v185, v206, v207
    v_mfma_f32_16x16x32_bf16 v[228:231], a[216:219], a[72:75], 0
    ds_read_b128 v[204:207], v244 offset:320
    v_cvt_pk_bf16_f32 v158, v232, v233
    v_mfma_f32_16x16x32_bf16 v[212:215], v[0:3], v[180:183], 0
    v_exp_f32 v208, v208
    v_mfma_f32_16x16x32_bf16 v[216:219], v[30:33], v[180:183], 0
    v_exp_f32 v209, v209
    v_mfma_f32_16x16x32_bf16 v[220:223], v[60:63], v[180:183], 0
    s_waitcnt lgkmcnt(1)
    v_exp_f32 v210, v210
    v_mfma_f32_16x16x32_bf16 v[224:227], a[248:251], v[180:183], 0
    v_exp_f32 v211, v211
    v_mfma_f32_16x16x32_bf16 v[200:203], v[144:147], v[168:171], v[200:203]
    v_cvt_pk_bf16_f32 v186, v208, v209
    v_cvt_pk_bf16_f32 v189, v210, v211
    v_mfma_f32_16x16x32_bf16 v[200:203], v[146:149], v[170:173], v[200:203]
    ds_read_b128 v[208:211], v245 offset:320
    v_cvt_pk_bf16_f32 v159, v234, v235
    v_mfma_f32_16x16x32_bf16 v[228:231], a[220:223], a[76:79], v[228:231]
    v_exp_f32 v196, v196
    v_mfma_f32_16x16x32_bf16 v[228:231], a[224:227], a[80:83], v[228:231]
    v_exp_f32 v197, v197
    v_mfma_f32_16x16x32_bf16 v[228:231], a[228:231], a[84:87], v[228:231]
    s_waitcnt lgkmcnt(1)
    v_cvt_pk_bf16_f32 v187, v196, v197
    v_cvt_pk_bf16_f32 v160, v236, v237
    v_mfma_f32_16x16x32_bf16 v[204:207], v[102:105], v[168:171], v[204:207]
    v_exp_f32 v198, v198
    v_mfma_f32_16x16x32_bf16 v[212:215], v[4:7], v[184:187], v[212:215]
    v_exp_f32 v199, v199
    v_mfma_f32_16x16x32_bf16 v[216:219], v[34:37], v[184:187], v[216:219]
    v_cvt_pk_bf16_f32 v190, v198, v199
    v_cvt_pk_bf16_f32 v161, v238, v239
    v_mfma_f32_16x16x32_bf16 v[220:223], v[64:67], v[184:187], v[220:223]
    ds_read_b128 v[196:199], v246 offset:320
    v_mfma_f32_16x16x32_bf16 v[224:227], a[248:251], v[184:187], v[224:227]
    v_exp_f32 v200, v200
    v_mfma_f32_16x16x32_bf16 v[204:207], v[104:107], v[170:173], v[204:207]
    s_waitcnt lgkmcnt(1)
    v_exp_f32 v201, v201
    v_mfma_f32_16x16x32_bf16 v[208:211], v[126:129], v[168:171], v[208:211]
    v_exp_f32 v202, v202
    v_mfma_f32_16x16x32_bf16 v[208:211], v[128:131], v[170:173], v[208:211]
    v_exp_f32 v203, v203
    v_mfma_f32_16x16x32_bf16 v[228:231], a[232:235], a[88:91], v[228:231]
    v_cvt_pk_bf16_f32 v188, v200, v201
    v_cvt_pk_bf16_f32 v191, v202, v203
    v_mfma_f32_16x16x32_bf16 v[228:231], a[236:239], a[92:95], v[228:231]
    v_exp_f32 v204, v204
    v_mfma_f32_16x16x32_bf16 v[212:215], v[8:11], v[188:191], v[212:215]
    v_exp_f32 v205, v205
    v_mfma_f32_16x16x32_bf16 v[216:219], v[38:41], v[188:191], v[216:219]
L_h3:
    s_cbranch_execz L_h7
    v_exp_f32 v208, v208
    v_mfma_f32_16x16x32_bf16 v[220:223], v[68:71], v[188:191], v[220:223]
    s_waitcnt lgkmcnt(0)
    v_exp_f32 v209, v209
    v_mfma_f32_16x16x32_bf16 v[224:227], a[248:251], v[188:191], v[224:227]
    v_cvt_pk_bf16_f32 v192, v204, v205
    v_cvt_pk_bf16_f32 v193, v208, v209
    v_mfma_f32_16x16x32_bf16 v[196:199], v[150:153], v[168:171], v[196:199]
    v_cvt_pk_bf16_f32 v20, v228, v229
    v_cvt_pk_bf16_f32 v23, v230, v231
    v_mfma_f32_16x16x32_bf16 v[196:199], v[152:155], v[170:173], v[196:199]
    ds_read_b128 v[200:203], v244 offset:0
    ds_read_b128 v[204:207], v245 offset:0
    v_mfma_f32_16x16x32_bf16 v[232:235], a[216:219], a[96:99], 0
    ds_read_b128 v[208:211], v246 offset:0
    s_waitcnt vmcnt(0)
    v_mfma_f32_16x16x32_bf16 v[232:235], a[220:223], a[100:103], v[232:235]
    s_barrier
    buffer_load_dwordx4 v254, s[4:7], s43 offen lds
    v_mfma_f32_16x16x32_bf16 v[232:235], a[224:227], a[104:107], v[232:235]
    v_exp_f32 v196, v196
    v_mfma_f32_16x16x32_bf16 v[232:235], a[228:231], a[108:111], v[232:235]
    v_exp_f32 v197, v197
    v_mfma_f32_16x16x32_bf16 v[232:235], a[232:235], a[112:115], v[232:235]
    v_cvt_pk_bf16_f32 v194, v196, v197
    v_accvgpr_read_b32 v254, a254
    v_mfma_f32_16x16x32_bf16 v[232:235], a[236:239], a[116:119], v[232:235]
    ds_read_b128 v[196:199], v244 offset:64
    buffer_load_dwordx4 v255, s[4:7], s43 offen offset:1024 lds
    v_mfma_f32_16x16x32_bf16 v[212:215], v[12:15], v[192:195], v[212:215]
    v_accvgpr_read_b32 v255, a252
    v_mfma_f32_16x16x32_bf16 v[216:219], v[42:45], v[192:195], v[216:219]
    v_mfma_f32_16x16x32_bf16 v[220:223], v[72:75], v[192:195], v[220:223]
    v_mfma_f32_16x16x32_bf16 v[224:227], a[248:251], v[192:195], v[224:227]
    buffer_load_dwordx4 v254, s[4:7], s43 offen offset:2048 lds
    v_cvt_pk_bf16_f32 v50, v232, v233
    v_mfma_f32_16x16x32_bf16 v[236:239], a[216:219], a[120:123], 0
    ds_read_b128 a[216:219], v242 offset:1664
    v_cvt_pk_bf16_f32 v53, v234, v235
    v_mfma_f32_16x16x32_bf16 v[236:239], a[220:223], a[124:127], v[236:239]
    ds_read_b128 a[220:223], v243 offset:1664
    v_accvgpr_read_b32 v254, a253
    v_mfma_f32_16x16x32_bf16 v[236:239], a[224:227], a[128:131], v[236:239]
    ds_read_b128 a[224:227], v242 offset:1792
    s_add_u32 m0, s46, 0x17400
    v_mfma_f32_16x16x32_bf16 v[236:239], a[228:231], a[132:135], v[236:239]
    ds_read_b128 a[228:231], v243 offset:1792
    buffer_load_dwordx4 v255, s[4:7], s59 offen lds
    v_mfma_f32_16x16x32_bf16 v[236:239], a[232:235], a[136:139], v[236:239]
    ds_read_b128 a[232:235], v240 offset:6144
    v_accvgpr_read_b32 v255, a254
    v_mfma_f32_16x16x32_bf16 v[236:239], a[236:239], a[140:143], v[236:239]
    ds_read_b128 a[236:239], v241 offset:6144
    v_mfma_f32_16x16x32_bf16 v[228:231], a[144:147], a[240:243], 0
    v_rcp_f32 v225, v224
    v_mfma_f32_16x16x32_bf16 v[228:231], a[148:151], a[244:247], v[228:231]
    v_mul_f32 v212, v212, v225
    v_mul_f32 v213, v213, v225
    v_mfma_f32_16x16x32_bf16 v[232:235], a[168:171], a[240:243], 0
    v_mul_f32 v214, v214, v225
    s_waitcnt lgkmcnt(5)
    v_mfma_f32_16x16x32_bf16 v[228:231], a[152:155], a[216:219], v[228:231]
    v_cvt_pk_bf16_f32 v80, v236, v237
    s_waitcnt lgkmcnt(4)
    v_mfma_f32_16x16x32_bf16 v[228:231], a[156:159], a[220:223], v[228:231]
    v_cvt_pk_bf16_f32 v83, v238, v239
    s_waitcnt lgkmcnt(3)
    v_mfma_f32_16x16x32_bf16 v[228:231], a[160:163], a[224:227], v[228:231]
    v_mul_f32 v215, v215, v225
    s_waitcnt lgkmcnt(2)
    v_mfma_f32_16x16x32_bf16 v[228:231], a[164:167], a[228:231], v[228:231]
    v_cvt_pk_bf16_f32 v212, v212, v213
    v_cvt_pk_bf16_f32 v213, v214, v215
    v_mfma_f32_16x16x32_bf16 v[232:235], a[172:175], a[244:247], v[232:235]
    ds_write_b64 v251, v[212:213] offset:0
    v_mfma_f32_16x16x32_bf16 v[232:235], a[176:179], a[216:219], v[232:235]
    v_mul_f32 v216, v216, v225
    v_mul_f32 v217, v217, v225
    v_mfma_f32_16x16x32_bf16 v[232:235], a[180:183], a[220:223], v[232:235]
    v_mul_f32 v228, s38, v228
    v_mul_f32 v229, s38, v229
    v_mfma_f32_16x16x32_bf16 v[232:235], a[184:187], a[224:227], v[232:235]
    v_mul_f32 v230, s38, v230
    v_mul_f32 v231, s38, v231
    v_mfma_f32_16x16x32_bf16 v[232:235], a[188:191], a[228:231], v[232:235]
    v_cvt_pk_bf16_f32 v174, v228, v229
    v_cvt_pk_bf16_f32 v175, v230, v231
    v_mfma_f32_16x16x32_bf16 v[236:239], a[192:195], a[240:243], 0
    ds_read_b128 a[240:243], v240 offset:6272
    v_mul_f32 v218, v218, v225
    v_mfma_f32_16x16x32_bf16 v[236:239], a[196:199], a[244:247], v[236:239]
    ds_read_b128 a[244:247], v241 offset:6272
    v_mul_f32 v219, v219, v225
    v_mfma_f32_16x16x32_bf16 v[236:239], a[200:203], a[216:219], v[236:239]
    s_waitcnt lgkmcnt(3)
    v_mul_f32 v232, s3, v232
    v_mul_f32 v233, s3, v233
    v_mfma_f32_16x16x32_bf16 v[236:239], a[204:207], a[220:223], v[236:239]
    v_mul_f32 v234, s3, v234
    v_mul_f32 v235, s3, v235
    v_mfma_f32_16x16x32_bf16 v[236:239], a[208:211], a[224:227], v[236:239]
    v_cvt_pk_bf16_f32 v176, v232, v233
    v_cvt_pk_bf16_f32 v177, v234, v235
    v_mfma_f32_16x16x32_bf16 v[236:239], a[212:215], a[228:231], v[236:239]
    ds_read_b128 a[216:219], v240 offset:6400
    ds_read_b128 a[220:223], v241 offset:6400
    v_mfma_f32_16x16x32_bf16 v[200:203], v[96:99], v[174:177], v[200:203]
    ds_read_b128 a[224:227], v240 offset:6144
    v_cvt_pk_bf16_f32 v216, v216, v217
    v_mfma_f32_16x16x32_bf16 v[204:207], v[120:123], v[174:177], v[204:207]
    ds_read_b128 a[228:231], v241 offset:6144
    v_cvt_pk_bf16_f32 v217, v218, v219
    v_mfma_f32_16x16x32_bf16 v[208:211], v[144:147], v[174:177], v[208:211]
    v_mul_f32 v236, s38, v236
    v_mul_f32 v237, s38, v237
    v_mfma_f32_16x16x32_bf16 v[196:199], v[102:105], v[174:177], v[196:199]
    v_mul_f32 v238, s38, v238
    v_mul_f32 v239, s38, v239
    v_mfma_f32_16x16x32_bf16 v[228:231], a[0:3], a[232:235], 0
    v_cvt_pk_bf16_f32 v178, v236, v237
    v_cvt_pk_bf16_f32 v179, v238, v239
    v_mfma_f32_16x16x32_bf16 v[228:231], a[4:7], a[236:239], v[228:231]
    ds_write_b64 v251, v[216:217] offset:128
    v_mfma_f32_16x16x32_bf16 v[200:203], v[98:101], v[176:179], v[200:203]
    v_max3_f32 v248, v248, v224, v225
    v_mul_f32 v220, v220, v225
    v_mfma_f32_16x16x32_bf16 v[204:207], v[122:125], v[176:179], v[204:207]
    s_waitcnt lgkmcnt(6)
    v_mul_f32 v221, v221, v225
    v_mul_f32 v222, v222, v225
    v_mfma_f32_16x16x32_bf16 v[208:211], v[146:149], v[176:179], v[208:211]
    v_mul_f32 v223, v223, v225
    v_cvt_pk_bf16_f32 v220, v220, v221
    v_mfma_f32_16x16x32_bf16 v[196:199], v[104:107], v[176:179], v[196:199]
    v_exp_f32 v200, v200
    v_mfma_f32_16x16x32_bf16 v[228:231], a[8:11], a[240:243], v[228:231]
    s_waitcnt lgkmcnt(5)
    v_exp_f32 v201, v201
    v_mfma_f32_16x16x32_bf16 v[228:231], a[12:15], a[244:247], v[228:231]
    s_waitcnt lgkmcnt(4)
    v_exp_f32 v202, v202
    v_mfma_f32_16x16x32_bf16 v[228:231], a[16:19], a[216:219], v[228:231]
    s_waitcnt lgkmcnt(3)
    v_exp_f32 v203, v203
    v_mfma_f32_16x16x32_bf16 v[228:231], a[20:23], a[220:223], v[228:231]
    v_cvt_pk_bf16_f32 v180, v200, v201
    v_cvt_pk_bf16_f32 v183, v202, v203
    v_mfma_f32_16x16x32_bf16 v[232:235], a[24:27], a[232:235], 0
    ds_read_b128 v[200:203], v245 offset:64
    v_cvt_pk_bf16_f32 v221, v222, v223
    v_mfma_f32_16x16x32_bf16 v[232:235], a[28:31], a[236:239], v[232:235]
    v_exp_f32 v204, v204
    v_mfma_f32_16x16x32_bf16 v[232:235], a[32:35], a[240:243], v[232:235]
    v_cvt_pk_bf16_f32 v162, v228, v229
    v_cvt_pk_bf16_f32 v163, v230, v231
    v_mfma_f32_16x16x32_bf16 v[232:235], a[36:39], a[244:247], v[232:235]
    s_waitcnt lgkmcnt(2)
    v_exp_f32 v205, v205
    v_mfma_f32_16x16x32_bf16 v[232:235], a[40:43], a[216:219], v[232:235]
    v_exp_f32 v208, v208
    v_mfma_f32_16x16x32_bf16 v[232:235], a[44:47], a[220:223], v[232:235]
    v_exp_f32 v209, v209
    v_mfma_f32_16x16x32_bf16 v[236:239], a[48:51], a[232:235], 0
    ds_read_b128 a[232:235], v240 offset:6272
    v_cvt_pk_bf16_f32 v181, v204, v205
    v_mfma_f32_16x16x32_bf16 v[236:239], a[52:55], a[236:239], v[236:239]
    ds_read_b128 a[236:239], v241 offset:6272
    v_cvt_pk_bf16_f32 v182, v208, v209
    v_mfma_f32_16x16x32_bf16 v[236:239], a[56:59], a[240:243], v[236:239]
    ds_read_b128 a[240:243], v240 offset:6400
    v_cvt_pk_bf16_f32 v164, v232, v233
    v_mfma_f32_16x16x32_bf16 v[212:215], v[6:9], v[180:183], 0
    buffer_load_dwordx4 v254, s[4:7], s59 offen offset:1024 lds
    v_cvt_pk_bf16_f32 v165, v234, v235
    v_mfma_f32_16x16x32_bf16 v[216:219], v[36:39], v[180:183], 0
    v_exp_f32 v206, v206
    v_mfma_f32_16x16x32_bf16 v[224:227], a[248:251], v[180:183], 0
    v_exp_f32 v207, v207
    v_mfma_f32_16x16x32_bf16 v[236:239], a[60:63], a[244:247], v[236:239]
    ds_read_b128 a[244:247], v241 offset:6400
    s_waitcnt lgkmcnt(4)
    v_mfma_f32_16x16x32_bf16 v[200:203], v[126:129], v[174:177], v[200:203]
    buffer_load_dwordx4 v255, s[4:7], s59 offen offset:2048 lds
    v_cvt_pk_bf16_f32 v184, v206, v207
    v_mfma_f32_16x16x32_bf16 v[200:203], v[128:131], v[176:179], v[200:203]
    ds_read_b128 v[204:207], v246 offset:64
    v_accvgpr_read_b32 v254, a252
    v_mfma_f32_16x16x32_bf16 v[236:239], a[64:67], a[216:219], v[236:239]
    ds_write_b64 v251, v[220:221] offset:256
    v_mfma_f32_16x16x32_bf16 v[220:223], v[66:69], v[180:183], 0
    s_add_u32 m0, s46, 0x18000
    v_exp_f32 v210, v210
    v_mfma_f32_16x16x32_bf16 v[236:239], a[68:71], a[220:223], v[236:239]
    s_add_u32 s59, s44, s45
    v_exp_f32 v211, v211
    v_mfma_f32_16x16x32_bf16 v[228:231], a[224:227], a[72:75], 0
    ds_read_b128 a[216:219], v240 offset:36864
    v_cvt_pk_bf16_f32 v185, v210, v211
    v_mfma_f32_16x16x32_bf16 v[228:231], a[228:231], a[76:79], v[228:231]
    s_waitcnt lgkmcnt(6)
    v_exp_f32 v196, v196
    v_mfma_f32_16x16x32_bf16 v[228:231], a[232:235], a[80:83], v[228:231]
    s_waitcnt lgkmcnt(5)
    v_exp_f32 v197, v197
    v_mfma_f32_16x16x32_bf16 v[228:231], a[236:239], a[84:87], v[228:231]
    s_waitcnt lgkmcnt(4)
    v_exp_f32 v200, v200
    v_mfma_f32_16x16x32_bf16 v[228:231], a[240:243], a[88:91], v[228:231]
    s_waitcnt lgkmcnt(3)
    v_exp_f32 v201, v201
    v_mfma_f32_16x16x32_bf16 v[228:231], a[244:247], a[92:95], v[228:231]
    s_waitcnt lgkmcnt(2)
    ds_read_b128 v[208:211], v244 offset:128
    v_mfma_f32_16x16x32_bf16 v[204:207], v[150:153], v[174:177], v[204:207]
    v_cvt_pk_bf16_f32 v166, v236, v237
    v_cvt_pk_bf16_f32 v167, v238, v239
    v_mfma_f32_16x16x32_bf16 v[204:207], v[152:155], v[176:179], v[204:207]
    v_cvt_pk_bf16_f32 v186, v196, v197
    v_cvt_pk_bf16_f32 v187, v200, v201
    v_mfma_f32_16x16x32_bf16 v[232:235], a[224:227], a[96:99], 0
    v_exp_f32 v198, v198
    v_mfma_f32_16x16x32_bf16 v[212:215], v[10:13], v[184:187], v[212:215]
    v_exp_f32 v199, v199
    v_mfma_f32_16x16x32_bf16 v[216:219], v[40:43], v[184:187], v[216:219]
    ds_read_b128 a[220:223], v241 offset:36864
    v_cvt_pk_bf16_f32 v189, v198, v199
    v_mfma_f32_16x16x32_bf16 v[220:223], v[70:73], v[184:187], v[220:223]
    ds_read_b128 v[196:199], v245 offset:128
    v_cvt_pk_bf16_f32 v24, v228, v229
    v_mfma_f32_16x16x32_bf16 v[224:227], a[248:251], v[184:187], v[224:227]
    v_exp_f32 v202, v202
    v_mfma_f32_16x16x32_bf16 v[232:235], a[228:231], a[100:103], v[232:235]
    v_exp_f32 v203, v203
    v_mfma_f32_16x16x32_bf16 v[232:235], a[232:235], a[104:107], v[232:235]
    v_exp_f32 v204, v204
    v_mfma_f32_16x16x32_bf16 v[232:235], a[236:239], a[108:111], v[232:235]
    v_exp_f32 v205, v205
    v_mfma_f32_16x16x32_bf16 v[232:235], a[240:243], a[112:115], v[232:235]
    s_waitcnt lgkmcnt(2)
    v_exp_f32 v206, v206
    v_mfma_f32_16x16x32_bf16 v[208:211], v[108:111], v[174:177], v[208:211]
    v_exp_f32 v207, v207
    v_mfma_f32_16x16x32_bf16 v[208:211], v[110:113], v[176:179], v[208:211]
    v_cvt_pk_bf16_f32 v190, v202, v203
    v_cvt_pk_bf16_f32 v188, v204, v205
    v_mfma_f32_16x16x32_bf16 v[232:235], a[244:247], a[116:119], v[232:235]
    ds_read_b128 v[200:203], v246 offset:128
    v_cvt_pk_bf16_f32 v191, v206, v207
    v_mfma_f32_16x16x32_bf16 v[236:239], a[224:227], a[120:123], 0
    ds_read_b128 a[224:227], v240 offset:36992
    v_cvt_pk_bf16_f32 v27, v230, v231
    v_mfma_f32_16x16x32_bf16 v[212:215], v[14:17], v[188:191], v[212:215]
    v_exp_f32 v208, v208
    v_mfma_f32_16x16x32_bf16 v[216:219], v[44:47], v[188:191], v[216:219]
    v_exp_f32 v209, v209
    v_mfma_f32_16x16x32_bf16 v[220:223], v[74:77], v[188:191], v[220:223]
    s_waitcnt lgkmcnt(2)
    v_cvt_pk_bf16_f32 v54, v232, v233
    v_cvt_pk_bf16_f32 v57, v234, v235
    v_mfma_f32_16x16x32_bf16 v[224:227], a[248:251], v[188:191], v[224:227]
    ds_read_b128 v[204:207], v244 offset:0
    v_cvt_pk_bf16_f32 v192, v208, v209
    v_mfma_f32_16x16x32_bf16 v[196:199], v[132:135], v[174:177], v[196:199]
    ds_read_b128 v[208:211], v245 offset:0
    v_accvgpr_read_b32 v255, a255
    v_mfma_f32_16x16x32_bf16 v[196:199], v[134:137], v[176:179], v[196:199]
    buffer_load_dwordx4 v254, s[4:7], s58 offen lds
    v_xor_b32 v254, 16, v242
    v_mfma_f32_16x16x32_bf16 v[236:239], a[228:231], a[124:127], v[236:239]
    ds_read_b128 a[228:231], v241 offset:36992
    v_add_u32 v254, 0x7500, v254
    v_mfma_f32_16x16x32_bf16 v[236:239], a[232:235], a[128:131], v[236:239]
    ds_read_b128 a[232:235], v240 offset:37120
    s_waitcnt lgkmcnt(5)
    v_mfma_f32_16x16x32_bf16 v[200:203], v[156:159], v[174:177], v[200:203]
    v_exp_f32 v196, v196
    v_mfma_f32_16x16x32_bf16 v[200:203], v[158:161], v[176:179], v[200:203]
    v_exp_f32 v197, v197
    v_mfma_f32_16x16x32_bf16 v[236:239], a[236:239], a[132:135], v[236:239]
    ds_read_b128 a[236:239], v241 offset:37120
    v_cvt_pk_bf16_f32 v193, v196, v197
    v_mfma_f32_16x16x32_bf16 v[236:239], a[240:243], a[136:139], v[236:239]
    ds_read_b128 a[240:243], v242 offset:3072
    v_add_u32 v240, 0xf000, v240
    v_mfma_f32_16x16x32_bf16 v[236:239], a[244:247], a[140:143], v[236:239]
    v_exp_f32 v200, v200
    v_mfma_f32_16x16x32_bf16 v[228:231], a[0:3], a[216:219], 0
    v_exp_f32 v201, v201
    v_mfma_f32_16x16x32_bf16 v[228:231], a[4:7], a[220:223], v[228:231]
    s_waitcnt lgkmcnt(6)
    v_cvt_pk_bf16_f32 v194, v200, v201
    v_add_u32 v241, 0xf000, v241
    v_mfma_f32_16x16x32_bf16 v[228:231], a[8:11], a[224:227], v[228:231]
    s_waitcnt lgkmcnt(3)
    v_cvt_pk_bf16_f32 v84, v236, v237
    v_cvt_pk_bf16_f32 v87, v238, v239
    v_mfma_f32_16x16x32_bf16 v[212:215], v[18:21], v[192:195], v[212:215]
    ds_read_b128 a[244:247], v243 offset:3072
    v_cndmask_b32 v254, v242, v254, vcc
    v_mfma_f32_16x16x32_bf16 v[216:219], v[48:51], v[192:195], v[216:219]
    ds_read_b128 v[196:199], v246 offset:0
    ds_read_b128 v[200:203], v244 offset:64
    v_mfma_f32_16x16x32_bf16 v[220:223], v[78:81], v[192:195], v[220:223]
    buffer_load_dwordx4 v255, s[4:7], s58 offen offset:512 lds
    v_xor_b32 v255, 64, v254
    v_mfma_f32_16x16x32_bf16 v[224:227], a[248:251], v[192:195], v[224:227]
    s_mov_b32 vcc_lo, 0x33333333
    s_mov_b32 vcc_hi, 0x33333333
    s_add_u32 m0, s46, 0
    v_mfma_f32_16x16x32_bf16 v[228:231], a[12:15], a[228:231], v[228:231]
    s_waitcnt lgkmcnt(5)
    s_lshl1_add_u32 s58, s45, s44
    v_mfma_f32_16x16x32_bf16 v[228:231], a[16:19], a[232:235], v[228:231]
    s_waitcnt lgkmcnt(4)
    v_rcp_f32 v225, v224
    v_mfma_f32_16x16x32_bf16 v[228:231], a[20:23], a[236:239], v[228:231]
    v_mul_f32 v212, v212, v225
    v_mul_f32 v213, v213, v225
    v_mfma_f32_16x16x32_bf16 v[232:235], a[24:27], a[216:219], 0
    v_mul_f32 v214, v214, v225
    v_mul_f32 v215, v215, v225
    v_mfma_f32_16x16x32_bf16 v[232:235], a[28:31], a[220:223], v[232:235]
    v_cvt_pk_bf16_f32 v212, v212, v213
    v_cvt_pk_bf16_f32 v213, v214, v215
    v_mfma_f32_16x16x32_bf16 v[232:235], a[32:35], a[224:227], v[232:235]
    v_cvt_pk_bf16_f32 v90, v228, v229
    v_cvt_pk_bf16_f32 v91, v230, v231
    v_mfma_f32_16x16x32_bf16 v[232:235], a[36:39], a[228:231], v[232:235]
    ds_write_b64 v251, v[212:213] offset:6144
    v_mfma_f32_16x16x32_bf16 v[232:235], a[40:43], a[232:235], v[232:235]
    v_mul_f32 v216, v216, v225
    v_mul_f32 v217, v217, v225
    v_mfma_f32_16x16x32_bf16 v[232:235], a[44:47], a[236:239], v[232:235]
    v_mul_f32 v218, v218, v225
    v_mul_f32 v219, v219, v225
    v_mfma_f32_16x16x32_bf16 v[236:239], a[48:51], a[216:219], 0
    v_cvt_pk_bf16_f32 v216, v216, v217
    v_cvt_pk_bf16_f32 v217, v218, v219
    v_mfma_f32_16x16x32_bf16 v[236:239], a[52:55], a[220:223], v[236:239]
    ds_write_b64 v251, v[216:217] offset:6272
    v_mfma_f32_16x16x32_bf16 v[236:239], a[56:59], a[224:227], v[236:239]
    v_cvt_pk_bf16_f32 v92, v232, v233
    v_cvt_pk_bf16_f32 v93, v234, v235
    v_mfma_f32_16x16x32_bf16 v[236:239], a[60:63], a[228:231], v[236:239]
    v_mul_f32 v220, v220, v225
    v_mul_f32 v221, v221, v225
    v_mfma_f32_16x16x32_bf16 v[236:239], a[64:67], a[232:235], v[236:239]
    v_mul_f32 v222, v222, v225
    v_mul_f32 v223, v223, v225
    v_mfma_f32_16x16x32_bf16 v[236:239], a[68:71], a[236:239], v[236:239]
    v_cvt_pk_bf16_f32 v220, v220, v221
    v_cvt_pk_bf16_f32 v221, v222, v223
    v_mfma_f32_16x16x32_bf16 v[228:231], a[216:219], a[72:75], 0
    ds_write_b64 v251, v[220:221] offset:6400
    v_mfma_f32_16x16x32_bf16 v[228:231], a[220:223], a[76:79], v[228:231]
    v_max3_f32 v248, v248, v224, v225
    v_mfma_f32_16x16x32_bf16 v[228:231], a[224:227], a[80:83], v[228:231]
    v_mfma_f32_16x16x32_bf16 v[228:231], a[228:231], a[84:87], v[228:231]
    v_cvt_pk_bf16_f32 v94, v236, v237
    v_cvt_pk_bf16_f32 v95, v238, v239
    v_mfma_f32_16x16x32_bf16 v[228:231], a[232:235], a[88:91], v[228:231]
    v_mfma_f32_16x16x32_bf16 v[228:231], a[236:239], a[92:95], v[228:231]
    v_mfma_f32_16x16x32_bf16 v[232:235], a[216:219], a[96:99], 0
    v_mfma_f32_16x16x32_bf16 v[232:235], a[220:223], a[100:103], v[232:235]
    v_mfma_f32_16x16x32_bf16 v[232:235], a[224:227], a[104:107], v[232:235]
    v_mfma_f32_16x16x32_bf16 v[232:235], a[228:231], a[108:111], v[232:235]
    v_mfma_f32_16x16x32_bf16 v[232:235], a[232:235], a[112:115], v[232:235]
    v_mfma_f32_16x16x32_bf16 v[232:235], a[236:239], a[116:119], v[232:235]
    v_mfma_f32_16x16x32_bf16 v[236:239], a[216:219], a[120:123], 0
    ds_read_b128 a[216:219], v242 offset:3200
    v_cvt_pk_bf16_f32 v25, v228, v229
    v_mfma_f32_16x16x32_bf16 v[236:239], a[220:223], a[124:127], v[236:239]
    ds_read_b128 a[220:223], v243 offset:3200
    v_cvt_pk_bf16_f32 v28, v230, v231
    v_mfma_f32_16x16x32_bf16 v[236:239], a[224:227], a[128:131], v[236:239]
    ds_read_b128 a[224:227], v242 offset:3328
    s_waitcnt lgkmcnt(3)
    v_mfma_f32_16x16x32_bf16 v[236:239], a[228:231], a[132:135], v[236:239]
    ds_read_b128 a[228:231], v243 offset:3328
    v_cvt_pk_bf16_f32 v55, v232, v233
    v_mfma_f32_16x16x32_bf16 v[236:239], a[232:235], a[136:139], v[236:239]
    ds_read_b128 a[232:235], v240 offset:6144
    v_cvt_pk_bf16_f32 v58, v234, v235
    v_mfma_f32_16x16x32_bf16 v[236:239], a[236:239], a[140:143], v[236:239]
    ds_read_b128 a[236:239], v241 offset:6144
    v_mfma_f32_16x16x32_bf16 v[228:231], a[144:147], a[240:243], 0
    v_mfma_f32_16x16x32_bf16 v[228:231], a[148:151], a[244:247], v[228:231]
    v_mfma_f32_16x16x32_bf16 v[232:235], a[168:171], a[240:243], 0
    v_mfma_f32_16x16x32_bf16 v[232:235], a[172:175], a[244:247], v[232:235]
    s_waitcnt lgkmcnt(5)
    v_mfma_f32_16x16x32_bf16 v[228:231], a[152:155], a[216:219], v[228:231]
    s_waitcnt lgkmcnt(4)
    v_cvt_pk_bf16_f32 v85, v236, v237
    v_cvt_pk_bf16_f32 v88, v238, v239
    v_mfma_f32_16x16x32_bf16 v[228:231], a[156:159], a[220:223], v[228:231]
    s_waitcnt lgkmcnt(3)
    v_mfma_f32_16x16x32_bf16 v[228:231], a[160:163], a[224:227], v[228:231]
    s_waitcnt lgkmcnt(2)
    v_mfma_f32_16x16x32_bf16 v[228:231], a[164:167], a[228:231], v[228:231]
    v_mfma_f32_16x16x32_bf16 v[232:235], a[176:179], a[216:219], v[232:235]
    v_mfma_f32_16x16x32_bf16 v[232:235], a[180:183], a[220:223], v[232:235]
    v_mfma_f32_16x16x32_bf16 v[232:235], a[184:187], a[224:227], v[232:235]
    v_mfma_f32_16x16x32_bf16 v[232:235], a[188:191], a[228:231], v[232:235]
    v_mfma_f32_16x16x32_bf16 v[236:239], a[192:195], a[240:243], 0
    ds_read_b128 a[240:243], v240 offset:6272
    v_mfma_f32_16x16x32_bf16 v[236:239], a[196:199], a[244:247], v[236:239]
    ds_read_b128 a[244:247], v241 offset:6272
    v_mul_f32 v228, s38, v228
    v_mfma_f32_16x16x32_bf16 v[236:239], a[200:203], a[216:219], v[236:239]
    v_mul_f32 v229, s38, v229
    v_mul_f32 v230, s38, v230
    v_mfma_f32_16x16x32_bf16 v[236:239], a[204:207], a[220:223], v[236:239]
    v_mul_f32 v231, s38, v231
    v_cvt_pk_bf16_f32 v168, v228, v229
    v_mfma_f32_16x16x32_bf16 v[236:239], a[208:211], a[224:227], v[236:239]
    v_cvt_pk_bf16_f32 v169, v230, v231
    s_waitcnt lgkmcnt(2)
    v_mfma_f32_16x16x32_bf16 v[236:239], a[212:215], a[228:231], v[236:239]
    v_mul_f32 v232, s3, v232
    v_mul_f32 v233, s3, v233
    v_mfma_f32_16x16x32_bf16 v[228:231], a[0:3], a[232:235], 0
    v_mul_f32 v234, s3, v234
    v_mul_f32 v235, s3, v235
    v_mfma_f32_16x16x32_bf16 v[228:231], a[4:7], a[236:239], v[228:231]
    v_cvt_pk_bf16_f32 v170, v232, v233
    v_cvt_pk_bf16_f32 v171, v234, v235
    v_mfma_f32_16x16x32_bf16 v[232:235], a[24:27], a[232:235], 0
    ds_read_b128 a[216:219], v240 offset:6400
    ds_read_b128 a[220:223], v241 offset:6400
    v_mfma_f32_16x16x32_bf16 v[204:207], v[102:105], v[168:171], v[204:207]
    v_mul_f32 v236, s38, v236
    v_mul_f32 v237, s38, v237
    v_mfma_f32_16x16x32_bf16 v[208:211], v[126:129], v[168:171], v[208:211]
    v_mul_f32 v238, s38, v238
    v_mul_f32 v239, s38, v239
    v_mfma_f32_16x16x32_bf16 v[196:199], v[150:153], v[168:171], v[196:199]
    v_cvt_pk_bf16_f32 v172, v236, v237
    v_cvt_pk_bf16_f32 v173, v238, v239
    v_mfma_f32_16x16x32_bf16 v[200:203], v[108:111], v[168:171], v[200:203]
    ds_read_b128 a[224:227], v254 offset:4608
    ds_read_b128 a[228:231], v255 offset:4608
    v_mfma_f32_16x16x32_bf16 v[204:207], v[104:107], v[170:173], v[204:207]
    s_waitcnt lgkmcnt(5)
    v_mfma_f32_16x16x32_bf16 v[208:211], v[128:131], v[170:173], v[208:211]
    v_mfma_f32_16x16x32_bf16 v[196:199], v[152:155], v[170:173], v[196:199]
    v_mfma_f32_16x16x32_bf16 v[200:203], v[110:113], v[170:173], v[200:203]
    v_mfma_f32_16x16x32_bf16 v[228:231], a[8:11], a[240:243], v[228:231]
    s_waitcnt lgkmcnt(4)
    v_mfma_f32_16x16x32_bf16 v[228:231], a[12:15], a[244:247], v[228:231]
    s_waitcnt lgkmcnt(3)
    v_exp_f32 v204, v204
    v_mfma_f32_16x16x32_bf16 v[228:231], a[16:19], a[216:219], v[228:231]
    s_waitcnt lgkmcnt(2)
    v_exp_f32 v205, v205
    v_mfma_f32_16x16x32_bf16 v[228:231], a[20:23], a[220:223], v[228:231]
    v_exp_f32 v206, v206
    v_mfma_f32_16x16x32_bf16 v[232:235], a[28:31], a[236:239], v[232:235]
    v_exp_f32 v207, v207
    v_mfma_f32_16x16x32_bf16 v[232:235], a[32:35], a[240:243], v[232:235]
    v_cvt_pk_bf16_f32 v180, v204, v205
    v_cvt_pk_bf16_f32 v183, v206, v207
    v_mfma_f32_16x16x32_bf16 v[232:235], a[36:39], a[244:247], v[232:235]
    ds_read_b128 v[204:207], v245 offset:64
    v_cvt_pk_bf16_f32 v96, v228, v229
    v_mfma_f32_16x16x32_bf16 v[232:235], a[40:43], a[216:219], v[232:235]
    v_exp_f32 v208, v208
    v_mfma_f32_16x16x32_bf16 v[232:235], a[44:47], a[220:223], v[232:235]
    v_exp_f32 v209, v209
    v_mfma_f32_16x16x32_bf16 v[236:239], a[48:51], a[232:235], 0
    v_exp_f32 v210, v210
    v_mfma_f32_16x16x32_bf16 v[236:239], a[52:55], a[236:239], v[236:239]
    v_exp_f32 v211, v211
    v_mfma_f32_16x16x32_bf16 v[236:239], a[56:59], a[240:243], v[236:239]
    v_cvt_pk_bf16_f32 v181, v208, v209
    v_cvt_pk_bf16_f32 v184, v210, v211
    v_mfma_f32_16x16x32_bf16 v[236:239], a[60:63], a[244:247], v[236:239]
    ds_read_b128 v[208:211], v246 offset:64
    v_cvt_pk_bf16_f32 v97, v230, v231
    v_mfma_f32_16x16x32_bf16 v[236:239], a[64:67], a[216:219], v[236:239]
    v_exp_f32 v196, v196
    v_mfma_f32_16x16x32_bf16 v[236:239], a[68:71], a[220:223], v[236:239]
    v_exp_f32 v197, v197
    v_mfma_f32_16x16x32_bf16 v[228:231], a[232:235], a[72:75], 0
    s_waitcnt lgkmcnt(1)
    v_exp_f32 v198, v198
    v_mfma_f32_16x16x32_bf16 v[204:207], v[132:135], v[168:171], v[204:207]
    v_exp_f32 v199, v199
    v_mfma_f32_16x16x32_bf16 v[204:207], v[134:137], v[170:173], v[204:207]
    v_cvt_pk_bf16_f32 v182, v196, v197
    v_cvt_pk_bf16_f32 v185, v198, v199
    v_mfma_f32_16x16x32_bf16 v[228:231], a[236:239], a[76:79], v[228:231]
    ds_read_b128 v[196:199], v244 offset:128
    v_cvt_pk_bf16_f32 v98, v232, v233
    v_mfma_f32_16x16x32_bf16 v[212:215], v[12:15], v[180:183], 0
    v_exp_f32 v200, v200
    v_mfma_f32_16x16x32_bf16 v[216:219], v[42:45], v[180:183], 0
    v_exp_f32 v201, v201
    v_mfma_f32_16x16x32_bf16 v[220:223], v[72:75], v[180:183], 0
    s_waitcnt lgkmcnt(1)
    v_exp_f32 v202, v202
    v_mfma_f32_16x16x32_bf16 v[224:227], a[248:251], v[180:183], 0
    v_exp_f32 v203, v203
    v_mfma_f32_16x16x32_bf16 v[208:211], v[156:159], v[168:171], v[208:211]
    v_cvt_pk_bf16_f32 v186, v200, v201
    v_cvt_pk_bf16_f32 v189, v202, v203
    v_mfma_f32_16x16x32_bf16 v[208:211], v[158:161], v[170:173], v[208:211]
    ds_read_b128 v[200:203], v245 offset:128
    v_cvt_pk_bf16_f32 v99, v234, v235
    v_mfma_f32_16x16x32_bf16 v[228:231], a[240:243], a[80:83], v[228:231]
    v_exp_f32 v204, v204
    v_mfma_f32_16x16x32_bf16 v[228:231], a[244:247], a[84:87], v[228:231]
    v_exp_f32 v205, v205
    v_mfma_f32_16x16x32_bf16 v[228:231], a[216:219], a[88:91], v[228:231]
    s_waitcnt lgkmcnt(1)
    v_cvt_pk_bf16_f32 v187, v204, v205
    v_cvt_pk_bf16_f32 v100, v236, v237
    v_mfma_f32_16x16x32_bf16 v[196:199], v[162:165], v[168:171], v[196:199]
    v_exp_f32 v206, v206
    v_mfma_f32_16x16x32_bf16 v[212:215], v[16:19], v[184:187], v[212:215]
    v_exp_f32 v207, v207
    v_mfma_f32_16x16x32_bf16 v[216:219], v[46:49], v[184:187], v[216:219]
    v_cvt_pk_bf16_f32 v190, v206, v207
    v_cvt_pk_bf16_f32 v101, v238, v239
    v_mfma_f32_16x16x32_bf16 v[220:223], v[76:79], v[184:187], v[220:223]
    ds_read_b128 v[204:207], v246 offset:128
    v_mfma_f32_16x16x32_bf16 v[224:227], a[248:251], v[184:187], v[224:227]
    v_exp_f32 v208, v208
    v_mfma_f32_16x16x32_bf16 v[196:199], v[164:167], v[170:173], v[196:199]
    v_exp_f32 v209, v209
    v_mfma_f32_16x16x32_bf16 v[228:231], a[220:223], a[92:95], v[228:231]
    s_waitcnt lgkmcnt(1)
    v_exp_f32 v210, v210
    v_mfma_f32_16x16x32_bf16 v[200:203], v[90:93], v[168:171], v[200:203]
    v_exp_f32 v211, v211
    v_mfma_f32_16x16x32_bf16 v[200:203], v[92:95], v[170:173], v[200:203]
    v_cvt_pk_bf16_f32 v188, v208, v209
    v_cvt_pk_bf16_f32 v191, v210, v211
    v_mfma_f32_16x16x32_bf16 v[232:235], a[232:235], a[96:99], 0
    v_cvt_pk_bf16_f32 v26, v228, v229
    v_cvt_pk_bf16_f32 v29, v230, v231
    v_mfma_f32_16x16x32_bf16 v[212:215], v[20:23], v[188:191], v[212:215]
    v_exp_f32 v196, v196
    v_mfma_f32_16x16x32_bf16 v[216:219], v[50:53], v[188:191], v[216:219]
    v_exp_f32 v197, v197
    v_mfma_f32_16x16x32_bf16 v[220:223], v[80:83], v[188:191], v[220:223]
    s_waitcnt lgkmcnt(0)
    v_exp_f32 v200, v200
    v_mfma_f32_16x16x32_bf16 v[224:227], a[248:251], v[188:191], v[224:227]
    v_exp_f32 v201, v201
    v_mfma_f32_16x16x32_bf16 v[204:207], v[96:99], v[168:171], v[204:207]
    v_cvt_pk_bf16_f32 v192, v196, v197
    v_cvt_pk_bf16_f32 v193, v200, v201
    v_mfma_f32_16x16x32_bf16 v[204:207], v[98:101], v[170:173], v[204:207]
    ds_read_b128 v[208:211], v244 offset:0
    ds_read_b128 v[196:199], v245 offset:0
    v_mfma_f32_16x16x32_bf16 v[232:235], a[236:239], a[100:103], v[232:235]
    ds_read_b128 v[200:203], v246 offset:0
    v_mfma_f32_16x16x32_bf16 v[232:235], a[240:243], a[104:107], v[232:235]
    v_mfma_f32_16x16x32_bf16 v[232:235], a[244:247], a[108:111], v[232:235]
    v_mfma_f32_16x16x32_bf16 v[232:235], a[216:219], a[112:115], v[232:235]
    v_mfma_f32_16x16x32_bf16 v[232:235], a[220:223], a[116:119], v[232:235]
    v_exp_f32 v204, v204
    v_mfma_f32_16x16x32_bf16 v[236:239], a[232:235], a[120:123], 0
    ds_read_b128 a[232:235], v254 offset:4736
    v_mfma_f32_16x16x32_bf16 v[236:239], a[236:239], a[124:127], v[236:239]
    ds_read_b128 a[236:239], v255 offset:4736
    v_mfma_f32_16x16x32_bf16 v[236:239], a[240:243], a[128:131], v[236:239]
    ds_read_b128 a[240:243], v254 offset:4864
    v_accvgpr_read_b32 v254, a252
    v_mfma_f32_16x16x32_bf16 v[236:239], a[244:247], a[132:135], v[236:239]
    ds_read_b128 a[244:247], v255 offset:4864
    v_cvt_pk_bf16_f32 v56, v232, v233
    v_mfma_f32_16x16x32_bf16 v[236:239], a[216:219], a[136:139], v[236:239]
    buffer_load_dwordx4 v254, s[4:7], s44 offen lds
    v_cvt_pk_bf16_f32 v59, v234, v235
    v_mfma_f32_16x16x32_bf16 v[236:239], a[220:223], a[140:143], v[236:239]
    v_exp_f32 v205, v205
    v_mfma_f32_16x16x32_bf16 v[228:231], a[144:147], a[224:227], 0
    v_cvt_pk_bf16_f32 v194, v204, v205
    v_accvgpr_read_b32 v255, a253
    v_mfma_f32_16x16x32_bf16 v[228:231], a[148:151], a[228:231], v[228:231]
    ds_read_b128 v[204:207], v244 offset:64
    v_accvgpr_read_b32 v254, a254
    v_mfma_f32_16x16x32_bf16 v[212:215], v[24:27], v[192:195], v[212:215]
    v_cvt_pk_bf16_f32 v86, v236, v237
    s_waitcnt lgkmcnt(4)
    v_mfma_f32_16x16x32_bf16 v[216:219], v[54:57], v[192:195], v[216:219]
    buffer_load_dwordx4 v255, s[4:7], s44 offen offset:1024 lds
    v_cvt_pk_bf16_f32 v89, v238, v239
    v_mfma_f32_16x16x32_bf16 v[220:223], v[84:87], v[192:195], v[220:223]
    v_accvgpr_read_b32 v255, a252
    v_mfma_f32_16x16x32_bf16 v[224:227], a[248:251], v[192:195], v[224:227]
    v_mfma_f32_16x16x32_bf16 v[228:231], a[152:155], a[232:235], v[228:231]
L_h4:
    s_cbranch_execz L_h8
    s_waitcnt lgkmcnt(3)
    v_mfma_f32_16x16x32_bf16 v[228:231], a[156:159], a[236:239], v[228:231]
    s_waitcnt lgkmcnt(2)
    v_mfma_f32_16x16x32_bf16 v[228:231], a[160:163], a[240:243], v[228:231]
    s_waitcnt lgkmcnt(1)
    s_waitcnt vmcnt(7)
    s_barrier
    v_mfma_f32_16x16x32_bf16 v[228:231], a[164:167], a[244:247], v[228:231]
    ds_read_b128 a[216:219], v240 offset:30720
    ds_read_b128 a[220:223], v241 offset:30720
    v_mfma_f32_16x16x32_bf16 v[232:235], a[168:171], a[224:227], 0
    v_rcp_f32 v225, v224
    v_mfma_f32_16x16x32_bf16 v[232:235], a[172:175], a[228:231], v[232:235]
    v_mul_f32 v212, v212, v225
    v_mul_f32 v213, v213, v225
    v_mfma_f32_16x16x32_bf16 v[232:235], a[176:179], a[232:235], v[232:235]
    v_mul_f32 v228, s38, v228
    v_mul_f32 v229, s38, v229
    v_mfma_f32_16x16x32_bf16 v[232:235], a[180:183], a[236:239], v[232:235]
    v_mul_f32 v230, s38, v230
    v_mul_f32 v231, s38, v231
    v_mfma_f32_16x16x32_bf16 v[232:235], a[184:187], a[240:243], v[232:235]
    v_cvt_pk_bf16_f32 v174, v228, v229
    v_cvt_pk_bf16_f32 v175, v230, v231
    v_mfma_f32_16x16x32_bf16 v[232:235], a[188:191], a[244:247], v[232:235]
    v_mul_f32 v214, v214, v225
    v_mul_f32 v215, v215, v225
    v_mfma_f32_16x16x32_bf16 v[236:239], a[192:195], a[224:227], 0
    ds_read_b128 a[224:227], v240 offset:30848
    v_cvt_pk_bf16_f32 v212, v212, v213
    v_mfma_f32_16x16x32_bf16 v[236:239], a[196:199], a[228:231], v[236:239]
    ds_read_b128 a[228:231], v241 offset:30848
    v_cvt_pk_bf16_f32 v213, v214, v215
    v_mfma_f32_16x16x32_bf16 v[236:239], a[200:203], a[232:235], v[236:239]
    v_mul_f32 v232, s3, v232
    v_mul_f32 v233, s3, v233
    v_mfma_f32_16x16x32_bf16 v[236:239], a[204:207], a[236:239], v[236:239]
    v_mul_f32 v234, s3, v234
    v_mul_f32 v235, s3, v235
    v_mfma_f32_16x16x32_bf16 v[236:239], a[208:211], a[240:243], v[236:239]
    v_cvt_pk_bf16_f32 v176, v232, v233
    v_cvt_pk_bf16_f32 v177, v234, v235
    v_mfma_f32_16x16x32_bf16 v[236:239], a[212:215], a[244:247], v[236:239]
    s_waitcnt lgkmcnt(3)
    ds_read_b128 a[232:235], v240 offset:30976
    v_mfma_f32_16x16x32_bf16 v[208:211], v[108:111], v[174:177], v[208:211]
    ds_read_b128 a[236:239], v241 offset:30976
    v_mul_f32 v216, v216, v225
    v_mfma_f32_16x16x32_bf16 v[196:199], v[132:135], v[174:177], v[196:199]
    ds_write_b64 v251, v[212:213] offset:12288
    v_mfma_f32_16x16x32_bf16 v[200:203], v[156:159], v[174:177], v[200:203]
    v_mul_f32 v236, s38, v236
    v_mul_f32 v237, s38, v237
    v_mfma_f32_16x16x32_bf16 v[204:207], v[162:165], v[174:177], v[204:207]
    v_mul_f32 v238, s38, v238
    v_mul_f32 v239, s38, v239
    v_mfma_f32_16x16x32_bf16 v[228:231], a[0:3], a[216:219], 0
    s_waitcnt lgkmcnt(5)
    v_cvt_pk_bf16_f32 v178, v236, v237
    v_cvt_pk_bf16_f32 v179, v238, v239
    v_mfma_f32_16x16x32_bf16 v[228:231], a[4:7], a[220:223], v[228:231]
    v_mul_f32 v217, v217, v225
    v_mul_f32 v218, v218, v225
    v_mfma_f32_16x16x32_bf16 v[208:211], v[110:113], v[176:179], v[208:211]
    v_mul_f32 v219, v219, v225
    v_cvt_pk_bf16_f32 v216, v216, v217
    v_mfma_f32_16x16x32_bf16 v[196:199], v[134:137], v[176:179], v[196:199]
    s_waitcnt lgkmcnt(4)
    v_cvt_pk_bf16_f32 v217, v218, v219
    v_mul_f32 v220, v220, v225
    v_mfma_f32_16x16x32_bf16 v[200:203], v[158:161], v[176:179], v[200:203]
    ds_write_b64 v251, v[216:217] offset:12416
    v_mfma_f32_16x16x32_bf16 v[204:207], v[164:167], v[176:179], v[204:207]
    v_exp_f32 v208, v208
    v_mfma_f32_16x16x32_bf16 v[228:231], a[8:11], a[224:227], v[228:231]
    s_waitcnt lgkmcnt(4)
    v_exp_f32 v209, v209
    v_mfma_f32_16x16x32_bf16 v[228:231], a[12:15], a[228:231], v[228:231]
    s_waitcnt lgkmcnt(3)
    v_exp_f32 v210, v210
    v_mfma_f32_16x16x32_bf16 v[228:231], a[16:19], a[232:235], v[228:231]
    s_waitcnt lgkmcnt(2)
    v_exp_f32 v211, v211
    v_mfma_f32_16x16x32_bf16 v[228:231], a[20:23], a[236:239], v[228:231]
    v_cvt_pk_bf16_f32 v180, v208, v209
    v_cvt_pk_bf16_f32 v183, v210, v211
    v_mfma_f32_16x16x32_bf16 v[232:235], a[24:27], a[216:219], 0
    ds_read_b128 v[208:211], v245 offset:64
    v_mul_f32 v221, v221, v225
    v_mfma_f32_16x16x32_bf16 v[232:235], a[28:31], a[220:223], v[232:235]
    v_exp_f32 v196, v196
    v_mfma_f32_16x16x32_bf16 v[232:235], a[32:35], a[224:227], v[232:235]
    v_exp_f32 v197, v197
    v_mfma_f32_16x16x32_bf16 v[232:235], a[36:39], a[228:231], v[232:235]
    v_exp_f32 v198, v198
    v_mfma_f32_16x16x32_bf16 v[232:235], a[40:43], a[232:235], v[232:235]
    v_exp_f32 v199, v199
    v_mfma_f32_16x16x32_bf16 v[232:235], a[44:47], a[236:239], v[232:235]
    v_cvt_pk_bf16_f32 v181, v196, v197
    v_cvt_pk_bf16_f32 v184, v198, v199
    v_mfma_f32_16x16x32_bf16 v[236:239], a[48:51], a[216:219], 0
    v_exp_f32 v200, v200
    v_mfma_f32_16x16x32_bf16 v[236:239], a[52:55], a[220:223], v[236:239]
    v_exp_f32 v201, v201
    v_mfma_f32_16x16x32_bf16 v[236:239], a[56:59], a[224:227], v[236:239]
    ds_read_b128 v[196:199], v246 offset:64
    v_cvt_pk_bf16_f32 v102, v228, v229
    v_mfma_f32_16x16x32_bf16 v[236:239], a[60:63], a[228:231], v[236:239]
    v_cvt_pk_bf16_f32 v103, v230, v231
    v_cvt_pk_bf16_f32 v182, v200, v201
    v_mfma_f32_16x16x32_bf16 v[236:239], a[64:67], a[232:235], v[236:239]
    v_mul_f32 v222, v222, v225
    v_mul_f32 v223, v223, v225
    v_mfma_f32_16x16x32_bf16 v[212:215], v[18:21], v[180:183], 0
    v_cvt_pk_bf16_f32 v220, v220, v221
    v_cvt_pk_bf16_f32 v221, v222, v223
    v_mfma_f32_16x16x32_bf16 v[216:219], v[48:51], v[180:183], 0
    s_waitcnt lgkmcnt(1)
    v_max3_f32 v248, v248, v224, v225
    v_cvt_pk_bf16_f32 v104, v232, v233
    v_mfma_f32_16x16x32_bf16 v[224:227], a[248:251], v[180:183], 0
    ds_write_b64 v251, v[220:221] offset:12544
    v_mfma_f32_16x16x32_bf16 v[220:223], v[78:81], v[180:183], 0
    ds_read_b128 a[240:243], v242 offset:30720
    v_cvt_pk_bf16_f32 v105, v234, v235
    v_mfma_f32_16x16x32_bf16 v[208:211], v[90:93], v[174:177], v[208:211]
    v_exp_f32 v202, v202
    v_mfma_f32_16x16x32_bf16 v[208:211], v[92:95], v[176:179], v[208:211]
    v_exp_f32 v203, v203
    v_mfma_f32_16x16x32_bf16 v[236:239], a[68:71], a[236:239], v[236:239]
    v_exp_f32 v204, v204
    v_mfma_f32_16x16x32_bf16 v[228:231], a[216:219], a[72:75], 0
    s_waitcnt lgkmcnt(2)
    v_exp_f32 v205, v205
    v_mfma_f32_16x16x32_bf16 v[196:199], v[96:99], v[174:177], v[196:199]
    v_cvt_pk_bf16_f32 v185, v202, v203
    v_cvt_pk_bf16_f32 v186, v204, v205
    v_mfma_f32_16x16x32_bf16 v[196:199], v[98:101], v[176:179], v[196:199]
    v_exp_f32 v208, v208
    v_mfma_f32_16x16x32_bf16 v[228:231], a[220:223], a[76:79], v[228:231]
    v_exp_f32 v209, v209
    v_mfma_f32_16x16x32_bf16 v[228:231], a[224:227], a[80:83], v[228:231]
    v_cvt_pk_bf16_f32 v187, v208, v209
    v_cvt_pk_bf16_f32 v106, v236, v237
    v_mfma_f32_16x16x32_bf16 v[228:231], a[228:231], a[84:87], v[228:231]
    ds_read_b128 a[244:247], v243 offset:30720
    v_cvt_pk_bf16_f32 v107, v238, v239
    v_mfma_f32_16x16x32_bf16 v[212:215], v[22:25], v[184:187], v[212:215]
    v_exp_f32 v206, v206
    v_mfma_f32_16x16x32_bf16 v[216:219], v[52:55], v[184:187], v[216:219]
    v_exp_f32 v207, v207
    v_mfma_f32_16x16x32_bf16 v[220:223], v[82:85], v[184:187], v[220:223]
    v_exp_f32 v210, v210
    v_mfma_f32_16x16x32_bf16 v[224:227], a[248:251], v[184:187], v[224:227]
    v_exp_f32 v211, v211
    v_mfma_f32_16x16x32_bf16 v[228:231], a[232:235], a[88:91], v[228:231]
    v_exp_f32 v196, v196
    v_mfma_f32_16x16x32_bf16 v[228:231], a[236:239], a[92:95], v[228:231]
    v_exp_f32 v197, v197
    v_mfma_f32_16x16x32_bf16 v[232:235], a[216:219], a[96:99], 0
    v_exp_f32 v198, v198
    v_mfma_f32_16x16x32_bf16 v[232:235], a[220:223], a[100:103], v[232:235]
    v_exp_f32 v199, v199
    v_mfma_f32_16x16x32_bf16 v[232:235], a[224:227], a[104:107], v[232:235]
    v_cvt_pk_bf16_f32 v189, v206, v207
    v_cvt_pk_bf16_f32 v190, v210, v211
    v_mfma_f32_16x16x32_bf16 v[232:235], a[228:231], a[108:111], v[232:235]
    v_cvt_pk_bf16_f32 v0, v228, v229
    v_cvt_pk_bf16_f32 v3, v230, v231
    v_mfma_f32_16x16x32_bf16 v[232:235], a[232:235], a[112:115], v[232:235]
    s_waitcnt lgkmcnt(1)
    v_cvt_pk_bf16_f32 v188, v196, v197
    v_cvt_pk_bf16_f32 v191, v198, v199
    v_mfma_f32_16x16x32_bf16 v[232:235], a[236:239], a[116:119], v[232:235]
    v_mov_b32 v200, 0x237c0
    v_add_u32 v201, 0xfffff900, v245
    v_mfma_f32_16x16x32_bf16 v[212:215], v[26:29], v[188:191], v[212:215]
    buffer_load_dwordx4 v254, s[4:7], s44 offen offset:2048 lds
    v_add_u32 v246, 0x700, v245
    v_mfma_f32_16x16x32_bf16 v[216:219], v[56:59], v[188:191], v[216:219]
    ds_write_b64 v247, v[174:175] offset:0
    v_mfma_f32_16x16x32_bf16 v[220:223], v[86:89], v[188:191], v[220:223]
    s_add_u32 m0, s46, 0xc00
    v_cvt_pk_bf16_f32 v30, v232, v233
    v_cvt_pk_bf16_f32 v33, v234, v235
    v_mfma_f32_16x16x32_bf16 v[224:227], a[248:251], v[188:191], v[224:227]
    ds_write_b64 v247, v[176:177] offset:128
    v_mfma_f32_16x16x32_bf16 v[236:239], a[216:219], a[120:123], 0
    ds_read_b128 a[216:219], v242 offset:30848
    v_mov_b32 v191, 0
    v_mfma_f32_16x16x32_bf16 v[236:239], a[220:223], a[124:127], v[236:239]
    ds_read_b128 a[220:223], v243 offset:30848
    v_accvgpr_read_b32 v254, a253
    v_mfma_f32_16x16x32_bf16 v[236:239], a[224:227], a[128:131], v[236:239]
    ds_read_b128 a[224:227], v242 offset:30976
    v_mov_b32 v226, 0x22e00
    v_mfma_f32_16x16x32_bf16 v[236:239], a[228:231], a[132:135], v[236:239]
    ds_read_b128 a[228:231], v243 offset:30976
    v_cndmask_b32 v226, v226, v247, vcc
    v_mfma_f32_16x16x32_bf16 v[236:239], a[232:235], a[136:139], v[236:239]
    ds_read_b128 a[232:235], v240 offset:32256
    s_mov_b32 vcc_lo, 0x0
    v_mfma_f32_16x16x32_bf16 v[236:239], a[236:239], a[140:143], v[236:239]
    ds_read_b128 a[236:239], v241 offset:32256
    s_mov_b32 vcc_hi, 0xf0000
    v_mfma_f32_16x16x32_bf16 v[228:231], a[144:147], a[240:243], 0
    s_waitcnt lgkmcnt(8)
    v_cndmask_b32 v245, v245, v200, vcc
    v_cndmask_b32 v244, v201, v244, vcc
    v_mfma_f32_16x16x32_bf16 v[228:231], a[148:151], a[244:247], v[228:231]
    ds_read_b128 v[204:207], v245 offset:192
    v_cvt_pk_bf16_f32 v60, v236, v237
    v_mfma_f32_16x16x32_bf16 v[232:235], a[168:171], a[240:243], 0
    s_mov_b32 vcc_lo, 0xff00fff0
    s_waitcnt lgkmcnt(6)
    v_cvt_pk_bf16_f32 v63, v238, v239
    v_mfma_f32_16x16x32_bf16 v[228:231], a[152:155], a[216:219], v[228:231]
    s_mov_b32 vcc_hi, 0xf000
    s_waitcnt lgkmcnt(5)
    v_cndmask_b32 v244, v244, v200, vcc
    v_mfma_f32_16x16x32_bf16 v[228:231], a[156:159], a[220:223], v[228:231]
    ds_read_b128 v[196:199], v244 offset:256
    s_waitcnt lgkmcnt(5)
    v_mfma_f32_16x16x32_bf16 v[228:231], a[160:163], a[224:227], v[228:231]
    s_mov_b32 vcc_lo, 0xfff00ff
    s_waitcnt lgkmcnt(4)
    s_mov_b32 vcc_hi, 0xffffffff
    v_mfma_f32_16x16x32_bf16 v[228:231], a[164:167], a[228:231], v[228:231]
    buffer_load_dwordx4 v255, s[4:7], s59 offen lds
    v_cndmask_b32 v246, v246, v200, vcc
    v_mfma_f32_16x16x32_bf16 v[232:235], a[172:175], a[244:247], v[232:235]
    ds_read_b128 v[200:203], v244 offset:192
    v_accvgpr_read_b32 v255, a254
    v_mfma_f32_16x16x32_bf16 v[232:235], a[176:179], a[216:219], v[232:235]
    ds_read_b128 v[208:211], v246 offset:192
    s_mov_b32 vcc_lo, 0xff00ff00
    v_mfma_f32_16x16x32_bf16 v[232:235], a[180:183], a[220:223], v[232:235]
    s_mov_b32 vcc_hi, 0xff00ff00
    v_mul_f32 v228, s38, v228
    v_mul_f32 v229, s38, v229
    v_mfma_f32_16x16x32_bf16 v[232:235], a[184:187], a[224:227], v[232:235]
    v_mul_f32 v230, s38, v230
    v_mul_f32 v231, s38, v231
    v_mfma_f32_16x16x32_bf16 v[232:235], a[188:191], a[228:231], v[232:235]
    v_cvt_pk_bf16_f32 v168, v228, v229
    v_cvt_pk_bf16_f32 v169, v230, v231
    v_mfma_f32_16x16x32_bf16 v[236:239], a[192:195], a[240:243], 0
    ds_read_b128 a[240:243], v240 offset:32384
    s_waitcnt lgkmcnt(5)
    v_mfma_f32_16x16x32_bf16 v[236:239], a[196:199], a[244:247], v[236:239]
    ds_read_b128 a[244:247], v241 offset:32384
    buffer_load_dwordx4 v254, s[4:7], s59 offen offset:1024 lds
    v_mfma_f32_16x16x32_bf16 v[236:239], a[200:203], a[216:219], v[236:239]
    ds_read_b128 a[216:219], v240 offset:32512
    v_mul_f32 v232, s3, v232
    v_mfma_f32_16x16x32_bf16 v[236:239], a[204:207], a[220:223], v[236:239]
    ds_read_b128 a[220:223], v241 offset:32512
    v_mul_f32 v233, s3, v233
    v_mfma_f32_16x16x32_bf16 v[236:239], a[208:211], a[224:227], v[236:239]
    v_mul_f32 v234, s3, v234
    v_mul_f32 v235, s3, v235
    v_mfma_f32_16x16x32_bf16 v[236:239], a[212:215], a[228:231], v[236:239]
    v_cvt_pk_bf16_f32 v170, v232, v233
    v_cvt_pk_bf16_f32 v171, v234, v235
    v_mfma_f32_16x16x32_bf16 v[228:231], a[0:3], a[232:235], 0
    s_waitcnt lgkmcnt(6)
    v_rcp_f32 v225, v224
    v_mfma_f32_16x16x32_bf16 v[204:207], v[138:141], v[168:171], v[204:207]
    v_mul_f32 v212, v212, v225
    v_mul_f32 v213, v213, v225
    v_mfma_f32_16x16x32_bf16 v[196:199], v[120:123], v[168:171], v[196:199]
    v_mul_f32 v236, s38, v236
    v_mul_f32 v237, s38, v237
    v_mfma_f32_16x16x32_bf16 v[228:231], a[4:7], a[236:239], v[228:231]
    s_waitcnt lgkmcnt(3)
    v_mul_f32 v238, s38, v238
    v_mul_f32 v239, s38, v239
    v_mfma_f32_16x16x32_bf16 v[200:203], v[114:117], v[168:171], v[200:203]
    v_cvt_pk_bf16_f32 v172, v236, v237
    v_cvt_pk_bf16_f32 v173, v238, v239
    v_mfma_f32_16x16x32_bf16 v[208:211], v[102:105], v[168:171], v[208:211]
    v_mul_f32 v214, v214, v225
    v_mul_f32 v215, v215, v225
    v_mfma_f32_16x16x32_bf16 v[200:203], v[116:119], v[170:173], v[200:203]
    v_cvt_pk_bf16_f32 v212, v212, v213
    v_cvt_pk_bf16_f32 v213, v214, v215
    v_mfma_f32_16x16x32_bf16 v[204:207], v[140:143], v[170:173], v[204:207]
    ds_write_b64 v247, v[178:179] offset:256
    v_mfma_f32_16x16x32_bf16 v[208:211], v[104:107], v[170:173], v[208:211]
    ds_write_b64 v226, v[212:213] offset:0
    v_mfma_f32_16x16x32_bf16 v[196:199], v[122:125], v[170:173], v[196:199]
    v_mul_f32 v216, v216, v225
    v_mul_f32 v217, v217, v225
    v_mfma_f32_16x16x32_bf16 v[228:231], a[8:11], a[240:243], v[228:231]
    s_waitcnt lgkmcnt(2)
    v_exp_f32 v204, v204
    v_mfma_f32_16x16x32_bf16 v[228:231], a[12:15], a[244:247], v[228:231]
    v_exp_f32 v205, v205
    v_mfma_f32_16x16x32_bf16 v[228:231], a[16:19], a[216:219], v[228:231]
    v_exp_f32 v206, v206
    v_mfma_f32_16x16x32_bf16 v[228:231], a[20:23], a[220:223], v[228:231]
    v_exp_f32 v207, v207
    v_mfma_f32_16x16x32_bf16 v[232:235], a[24:27], a[232:235], 0
    v_cvt_pk_bf16_f32 v194, v204, v205
    v_cvt_pk_bf16_f32 v181, v206, v207
    v_mfma_f32_16x16x32_bf16 v[232:235], a[28:31], a[236:239], v[232:235]
    ds_read_b128 v[204:207], v246 offset:256
    v_mul_f32 v218, v218, v225
    v_mfma_f32_16x16x32_bf16 v[232:235], a[32:35], a[240:243], v[232:235]
    v_cvt_pk_bf16_f32 v108, v228, v229
    v_cvt_pk_bf16_f32 v109, v230, v231
    v_mfma_f32_16x16x32_bf16 v[232:235], a[36:39], a[244:247], v[232:235]
    v_exp_f32 v200, v200
    v_mfma_f32_16x16x32_bf16 v[232:235], a[40:43], a[216:219], v[232:235]
    v_exp_f32 v201, v201
    v_mfma_f32_16x16x32_bf16 v[232:235], a[44:47], a[220:223], v[232:235]
    v_exp_f32 v202, v202
    v_mfma_f32_16x16x32_bf16 v[236:239], a[48:51], a[232:235], 0
    v_exp_f32 v203, v203
    v_mfma_f32_16x16x32_bf16 v[236:239], a[52:55], a[236:239], v[236:239]
    v_cvt_pk_bf16_f32 v193, v200, v201
    v_cvt_pk_bf16_f32 v180, v202, v203
    v_mfma_f32_16x16x32_bf16 v[236:239], a[56:59], a[240:243], v[236:239]
    ds_read_b128 v[200:203], v245 offset:256
    v_cvt_pk_bf16_f32 v110, v232, v233
    v_mfma_f32_16x16x32_bf16 v[236:239], a[60:63], a[244:247], v[236:239]
    v_cvt_pk_bf16_f32 v111, v234, v235
    v_mul_f32 v219, v219, v225
    v_mfma_f32_16x16x32_bf16 v[236:239], a[64:67], a[216:219], v[236:239]
    v_exp_f32 v208, v208
    v_mfma_f32_16x16x32_bf16 v[236:239], a[68:71], a[220:223], v[236:239]
    v_exp_f32 v209, v209
    v_mfma_f32_16x16x32_bf16 v[228:231], a[232:235], a[72:75], 0
    v_exp_f32 v210, v210
    v_mfma_f32_16x16x32_bf16 v[228:231], a[236:239], a[76:79], v[228:231]
    v_exp_f32 v211, v211
    v_mfma_f32_16x16x32_bf16 v[228:231], a[240:243], a[80:83], v[228:231]
    s_waitcnt lgkmcnt(1)
    v_cvt_pk_bf16_f32 v192, v208, v209
    v_cvt_pk_bf16_f32 v112, v236, v237
    v_mfma_f32_16x16x32_bf16 v[204:207], v[108:111], v[168:171], v[204:207]
    v_cvt_pk_bf16_f32 v113, v238, v239
    v_cvt_pk_bf16_f32 v195, v210, v211
    v_mfma_f32_16x16x32_bf16 v[228:231], a[244:247], a[84:87], v[228:231]
    v_cvt_pk_bf16_f32 v216, v216, v217
    v_cvt_pk_bf16_f32 v217, v218, v219
    v_mfma_f32_16x16x32_bf16 v[212:215], v[0:3], v[192:195], 0
    ds_write_b64 v226, v[216:217] offset:128
    v_mfma_f32_16x16x32_bf16 v[216:219], v[30:33], v[192:195], 0
    v_mul_f32 v220, v220, v225
    v_mul_f32 v221, v221, v225
    v_mfma_f32_16x16x32_bf16 v[204:207], v[110:113], v[170:173], v[204:207]
    v_mul_f32 v222, v222, v225
    v_mul_f32 v223, v223, v225
    v_mfma_f32_16x16x32_bf16 v[228:231], a[216:219], a[88:91], v[228:231]
    v_cvt_pk_bf16_f32 v220, v220, v221
    v_cvt_pk_bf16_f32 v221, v222, v223
    v_mfma_f32_16x16x32_bf16 v[228:231], a[220:223], a[92:95], v[228:231]
    ds_write_b64 v226, v[220:221] offset:256
    v_mfma_f32_16x16x32_bf16 v[220:223], v[60:63], v[192:195], 0
    ds_read_b128 v[208:211], v244 offset:320
    v_max3_f32 v248, v248, v224, v225
    v_mfma_f32_16x16x32_bf16 v[224:227], a[248:251], v[192:195], 0
    s_waitcnt lgkmcnt(3)
    v_exp_f32 v196, v196
    v_mfma_f32_16x16x32_bf16 v[200:203], v[144:147], v[168:171], v[200:203]
    v_exp_f32 v197, v197
    v_mfma_f32_16x16x32_bf16 v[200:203], v[146:149], v[170:173], v[200:203]
    v_exp_f32 v204, v204
    v_mfma_f32_16x16x32_bf16 v[232:235], a[232:235], a[96:99], 0
    v_exp_f32 v205, v205
    v_mfma_f32_16x16x32_bf16 v[232:235], a[236:239], a[100:103], v[232:235]
    v_cvt_pk_bf16_f32 v6, v228, v229
    v_cvt_pk_bf16_f32 v183, v196, v197
    v_mfma_f32_16x16x32_bf16 v[232:235], a[240:243], a[104:107], v[232:235]
    ds_read_b128 a[224:227], v242 offset:32256
    v_cvt_pk_bf16_f32 v182, v204, v205
    v_mfma_f32_16x16x32_bf16 v[232:235], a[244:247], a[108:111], v[232:235]
    v_exp_f32 v198, v198
    v_mfma_f32_16x16x32_bf16 v[212:215], v[4:7], v[180:183], v[212:215]
    v_exp_f32 v199, v199
    v_mfma_f32_16x16x32_bf16 v[224:227], a[248:251], v[180:183], v[224:227]
    s_waitcnt lgkmcnt(1)
    v_cvt_pk_bf16_f32 v186, v198, v199
    v_cvt_pk_bf16_f32 v9, v230, v231
    v_mfma_f32_16x16x32_bf16 v[208:211], v[126:129], v[168:171], v[208:211]
    ds_read_b128 v[196:199], v245 offset:320
    ds_read_b128 a[228:231], v243 offset:32256
    v_mfma_f32_16x16x32_bf16 v[208:211], v[128:131], v[170:173], v[208:211]
    v_exp_f32 v200, v200
    v_mfma_f32_16x16x32_bf16 v[232:235], a[216:219], a[112:115], v[232:235]
    v_exp_f32 v201, v201
    v_mfma_f32_16x16x32_bf16 v[232:235], a[220:223], a[116:119], v[232:235]
    v_exp_f32 v202, v202
    v_mfma_f32_16x16x32_bf16 v[236:239], a[232:235], a[120:123], 0
    ds_read_b128 a[232:235], v242 offset:32384
    v_cvt_pk_bf16_f32 v184, v200, v201
    v_mfma_f32_16x16x32_bf16 v[236:239], a[236:239], a[124:127], v[236:239]
    ds_read_b128 a[236:239], v243 offset:32384
    v_accvgpr_read_b32 v254, a252
    v_mfma_f32_16x16x32_bf16 v[236:239], a[240:243], a[128:131], v[236:239]
    ds_read_b128 a[240:243], v242 offset:32512
    v_cvt_pk_bf16_f32 v36, v232, v233
    v_mfma_f32_16x16x32_bf16 v[236:239], a[244:247], a[132:135], v[236:239]
    ds_read_b128 a[244:247], v243 offset:32512
    v_cvt_pk_bf16_f32 v39, v234, v235
    v_mfma_f32_16x16x32_bf16 v[216:219], v[34:37], v[180:183], v[216:219]
    v_exp_f32 v203, v203
    v_mfma_f32_16x16x32_bf16 v[236:239], a[216:219], a[136:139], v[236:239]
    s_waitcnt lgkmcnt(5)
    v_exp_f32 v206, v206
    v_mfma_f32_16x16x32_bf16 v[196:199], v[150:153], v[168:171], v[196:199]
    v_exp_f32 v207, v207
    v_mfma_f32_16x16x32_bf16 v[196:199], v[152:155], v[170:173], v[196:199]
    v_cvt_pk_bf16_f32 v187, v202, v203
    v_cvt_pk_bf16_f32 v185, v206, v207
    v_mfma_f32_16x16x32_bf16 v[236:239], a[220:223], a[140:143], v[236:239]
    ds_read_b128 a[216:219], v242 offset:33792
    ds_read_b128 a[220:223], v243 offset:33792
    v_mfma_f32_16x16x32_bf16 v[212:215], v[8:11], v[184:187], v[212:215]
    ds_read_b128 v[204:207], v244 offset:0
    ds_read_b128 v[200:203], v246 offset:320
    v_mfma_f32_16x16x32_bf16 v[216:219], v[38:41], v[184:187], v[216:219]
    v_exp_f32 v208, v208
    v_mfma_f32_16x16x32_bf16 v[224:227], a[248:251], v[184:187], v[224:227]
    v_cvt_pk_bf16_f32 v66, v236, v237
    v_cvt_pk_bf16_f32 v69, v238, v239
    v_mfma_f32_16x16x32_bf16 v[228:231], a[144:147], a[224:227], 0
    s_waitcnt lgkmcnt(8)
    v_exp_f32 v209, v209
    v_mfma_f32_16x16x32_bf16 v[220:223], v[64:67], v[180:183], v[220:223]
    buffer_load_dwordx4 v255, s[4:7], s59 offen offset:2048 lds
    v_cvt_pk_bf16_f32 v189, v208, v209
    v_mfma_f32_16x16x32_bf16 v[220:223], v[68:71], v[184:187], v[220:223]
    ds_read_b128 v[208:211], v245 offset:0
    v_accvgpr_read_b32 v255, a255
    v_mfma_f32_16x16x32_bf16 v[228:231], a[148:151], a[228:231], v[228:231]
    s_waitcnt lgkmcnt(6)
    v_exp_f32 v196, v196
    v_mfma_f32_16x16x32_bf16 v[228:231], a[152:155], a[232:235], v[228:231]
    s_add_u32 m0, s46, 0x1800
    v_exp_f32 v197, v197
    v_mfma_f32_16x16x32_bf16 v[228:231], a[156:159], a[236:239], v[228:231]
    buffer_load_dwordx4 v254, s[4:7], s58 offen lds
    v_cvt_pk_bf16_f32 v190, v196, v197
    v_mfma_f32_16x16x32_bf16 v[228:231], a[160:163], a[240:243], v[228:231]
    s_waitcnt lgkmcnt(5)
    ds_read_b128 v[196:199], v246 offset:0
    v_mfma_f32_16x16x32_bf16 v[228:231], a[164:167], a[244:247], v[228:231]
    v_mfma_f32_16x16x32_bf16 v[232:235], a[168:171], a[224:227], 0
    v_mfma_f32_16x16x32_bf16 v[232:235], a[172:175], a[228:231], v[232:235]
    buffer_load_dwordx4 v255, s[4:7], s58 offen offset:512 lds
    s_add_u32 m0, s46, 0x16800
    v_mfma_f32_16x16x32_bf16 v[232:235], a[176:179], a[232:235], v[232:235]
    v_mfma_f32_16x16x32_bf16 v[232:235], a[180:183], a[236:239], v[232:235]
    v_mfma_f32_16x16x32_bf16 v[232:235], a[184:187], a[240:243], v[232:235]
    v_mfma_f32_16x16x32_bf16 v[232:235], a[188:191], a[244:247], v[232:235]
    v_mul_f32 v228, s38, v228
    v_mul_f32 v229, s38, v229
    v_mfma_f32_16x16x32_bf16 v[236:239], a[192:195], a[224:227], 0
    ds_read_b128 a[224:227], v242 offset:33920
    v_mul_f32 v230, s38, v230
    v_mfma_f32_16x16x32_bf16 v[236:239], a[196:199], a[228:231], v[236:239]
    ds_read_b128 a[228:231], v243 offset:33920
    v_mul_f32 v231, s38, v231
    v_mfma_f32_16x16x32_bf16 v[236:239], a[200:203], a[232:235], v[236:239]
    ds_read_b128 a[232:235], v242 offset:34048
    v_cvt_pk_bf16_f32 v174, v228, v229
    v_mfma_f32_16x16x32_bf16 v[236:239], a[204:207], a[236:239], v[236:239]
    ds_read_b128 a[236:239], v243 offset:34048
    v_cvt_pk_bf16_f32 v175, v230, v231
    v_mfma_f32_16x16x32_bf16 v[236:239], a[208:211], a[240:243], v[236:239]
    s_waitcnt lgkmcnt(5)
    v_mul_f32 v232, s3, v232
    v_mul_f32 v233, s3, v233
    v_mfma_f32_16x16x32_bf16 v[236:239], a[212:215], a[244:247], v[236:239]
    v_mul_f32 v234, s3, v234
    v_mul_f32 v235, s3, v235
    v_mfma_f32_16x16x32_bf16 v[228:231], a[144:147], a[216:219], 0
    v_cvt_pk_bf16_f32 v176, v232, v233
    v_cvt_pk_bf16_f32 v177, v234, v235
    v_mfma_f32_16x16x32_bf16 v[228:231], a[148:151], a[220:223], v[228:231]
    s_waitcnt lgkmcnt(4)
    v_mfma_f32_16x16x32_bf16 v[204:207], v[120:123], v[174:177], v[204:207]
    v_mul_f32 v236, s38, v236
    s_waitcnt lgkmcnt(3)
    v_mfma_f32_16x16x32_bf16 v[208:211], v[144:147], v[174:177], v[208:211]
    v_mul_f32 v237, s38, v237
    v_mul_f32 v238, s38, v238
    v_mfma_f32_16x16x32_bf16 v[196:199], v[108:111], v[174:177], v[196:199]
    v_mul_f32 v239, s38, v239
    v_cvt_pk_bf16_f32 v178, v236, v237
    v_mfma_f32_16x16x32_bf16 v[228:231], a[152:155], a[224:227], v[228:231]
    s_waitcnt lgkmcnt(2)
    v_cvt_pk_bf16_f32 v179, v238, v239
    v_mfma_f32_16x16x32_bf16 v[228:231], a[156:159], a[228:231], v[228:231]
    s_waitcnt lgkmcnt(1)
    v_mfma_f32_16x16x32_bf16 v[204:207], v[122:125], v[176:179], v[204:207]
    v_mfma_f32_16x16x32_bf16 v[208:211], v[146:149], v[176:179], v[208:211]
    v_mfma_f32_16x16x32_bf16 v[196:199], v[110:113], v[176:179], v[196:199]
    v_mfma_f32_16x16x32_bf16 v[228:231], a[160:163], a[232:235], v[228:231]
    s_waitcnt lgkmcnt(0)
    s_waitcnt vmcnt(8)
    s_barrier
    v_mfma_f32_16x16x32_bf16 v[228:231], a[164:167], a[236:239], v[228:231]
    ds_read_b128 a[240:243], v240 offset:33792
    ds_read_b128 a[244:247], v241 offset:33792
    v_mfma_f32_16x16x32_bf16 v[232:235], a[168:171], a[216:219], 0
    v_exp_f32 v204, v204
    v_mfma_f32_16x16x32_bf16 v[232:235], a[172:175], a[220:223], v[232:235]
    v_exp_f32 v205, v205
    v_mfma_f32_16x16x32_bf16 v[232:235], a[176:179], a[224:227], v[232:235]
    v_exp_f32 v206, v206
    v_mfma_f32_16x16x32_bf16 v[232:235], a[180:183], a[228:231], v[232:235]
    v_mul_f32 v228, s38, v228
    v_mul_f32 v229, s38, v229
    v_mfma_f32_16x16x32_bf16 v[232:235], a[184:187], a[232:235], v[232:235]
    v_mul_f32 v230, s38, v230
    v_mul_f32 v231, s38, v231
    v_mfma_f32_16x16x32_bf16 v[232:235], a[188:191], a[236:239], v[232:235]
    v_cvt_pk_bf16_f32 v228, v228, v229
    v_cvt_pk_bf16_f32 v229, v230, v231
    v_mfma_f32_16x16x32_bf16 v[236:239], a[192:195], a[216:219], 0
    ds_read_b128 a[216:219], v240 offset:33920
    v_cvt_pk_bf16_f32 v193, v204, v205
    v_mfma_f32_16x16x32_bf16 v[236:239], a[196:199], a[220:223], v[236:239]
    ds_read_b128 a[220:223], v241 offset:33920
    v_mfma_f32_16x16x32_bf16 v[236:239], a[200:203], a[224:227], v[236:239]
    ds_read_b128 a[224:227], v240 offset:34048
    v_mul_f32 v232, s3, v232
    v_mfma_f32_16x16x32_bf16 v[236:239], a[204:207], a[228:231], v[236:239]
    ds_read_b128 a[228:231], v241 offset:34048
    v_mul_f32 v233, s3, v233
    v_mfma_f32_16x16x32_bf16 v[236:239], a[208:211], a[232:235], v[236:239]
    ds_write_b64 v247, v[228:229] offset:18432
    v_mfma_f32_16x16x32_bf16 v[236:239], a[212:215], a[236:239], v[236:239]
    s_waitcnt lgkmcnt(6)
    v_mul_f32 v234, s3, v234
    v_mul_f32 v235, s3, v235
    v_mfma_f32_16x16x32_bf16 v[228:231], a[0:3], a[240:243], 0
    s_waitcnt lgkmcnt(5)
    v_cvt_pk_bf16_f32 v232, v232, v233
    v_cvt_pk_bf16_f32 v233, v234, v235
    v_mfma_f32_16x16x32_bf16 v[228:231], a[4:7], a[244:247], v[228:231]
    ds_write_b64 v247, v[232:233] offset:18560
    v_mfma_f32_16x16x32_bf16 v[232:235], a[24:27], a[240:243], 0
    s_waitcnt lgkmcnt(5)
    v_mul_f32 v236, s38, v236
    v_mul_f32 v237, s38, v237
    v_mfma_f32_16x16x32_bf16 v[228:231], a[8:11], a[216:219], v[228:231]
    s_waitcnt lgkmcnt(4)
    v_mul_f32 v238, s38, v238
    v_mul_f32 v239, s38, v239
    v_mfma_f32_16x16x32_bf16 v[228:231], a[12:15], a[220:223], v[228:231]
    s_waitcnt lgkmcnt(3)
    v_cvt_pk_bf16_f32 v236, v236, v237
    v_cvt_pk_bf16_f32 v237, v238, v239
    v_mfma_f32_16x16x32_bf16 v[228:231], a[16:19], a[224:227], v[228:231]
    ds_write_b64 v247, v[236:237] offset:18688
    v_mfma_f32_16x16x32_bf16 v[232:235], a[28:31], a[244:247], v[232:235]
    s_waitcnt lgkmcnt(3)
    v_exp_f32 v207, v207
    v_mfma_f32_16x16x32_bf16 v[228:231], a[20:23], a[228:231], v[228:231]
    ds_read_b128 a[232:235], v242 offset:61440
    v_cvt_pk_bf16_f32 v180, v206, v207
    v_mfma_f32_16x16x32_bf16 v[232:235], a[32:35], a[216:219], v[232:235]
    ds_read_b128 v[204:207], v245 offset:64
    ds_read_b128 a[236:239], v243 offset:61440
    v_mfma_f32_16x16x32_bf16 v[232:235], a[36:39], a[220:223], v[232:235]
    v_exp_f32 v208, v208
    v_mfma_f32_16x16x32_bf16 v[232:235], a[40:43], a[224:227], v[232:235]
    v_cvt_pk_bf16_f32 v162, v228, v229
    v_cvt_pk_bf16_f32 v163, v230, v231
    v_mfma_f32_16x16x32_bf16 v[232:235], a[44:47], a[228:231], v[232:235]
    v_exp_f32 v209, v209
    v_mfma_f32_16x16x32_bf16 v[236:239], a[48:51], a[240:243], 0
    v_exp_f32 v210, v210
    v_mfma_f32_16x16x32_bf16 v[236:239], a[52:55], a[244:247], v[236:239]
    v_exp_f32 v211, v211
    v_mfma_f32_16x16x32_bf16 v[236:239], a[56:59], a[216:219], v[236:239]
    v_cvt_pk_bf16_f32 v194, v208, v209
    v_cvt_pk_bf16_f32 v181, v210, v211
    v_mfma_f32_16x16x32_bf16 v[236:239], a[60:63], a[220:223], v[236:239]
    v_cvt_pk_bf16_f32 v164, v232, v233
    v_cvt_pk_bf16_f32 v165, v234, v235
    v_mfma_f32_16x16x32_bf16 v[236:239], a[64:67], a[224:227], v[236:239]
    ds_read_b128 v[208:211], v246 offset:64
    v_mfma_f32_16x16x32_bf16 v[200:203], v[162:165], v[168:171], v[200:203]
    v_exp_f32 v196, v196
    v_mfma_f32_16x16x32_bf16 v[236:239], a[68:71], a[228:231], v[236:239]
    v_exp_f32 v197, v197
    v_mfma_f32_16x16x32_bf16 v[228:231], a[240:243], a[72:75], 0
    v_exp_f32 v198, v198
    v_mfma_f32_16x16x32_bf16 v[228:231], a[244:247], a[76:79], v[228:231]
    v_exp_f32 v199, v199
    v_mfma_f32_16x16x32_bf16 v[228:231], a[216:219], a[80:83], v[228:231]
    v_cvt_pk_bf16_f32 v192, v196, v197
    s_waitcnt lgkmcnt(2)
    v_mfma_f32_16x16x32_bf16 v[204:207], v[150:153], v[174:177], v[204:207]
    v_cvt_pk_bf16_f32 v166, v236, v237
    v_cvt_pk_bf16_f32 v167, v238, v239
    v_mfma_f32_16x16x32_bf16 v[204:207], v[152:155], v[176:179], v[204:207]
    ds_read_b64 v[168:169], v247 offset:18432
    v_cvt_pk_bf16_f32 v195, v198, v199
    v_mfma_f32_16x16x32_bf16 v[200:203], v[164:167], v[170:173], v[200:203]
    ds_read_b128 v[196:199], v244 offset:128
    ds_read_b64 v[170:171], v247 offset:18560
    v_mfma_f32_16x16x32_bf16 v[228:231], a[220:223], a[84:87], v[228:231]
    ds_read_b64 v[172:173], v247 offset:18688
    v_mfma_f32_16x16x32_bf16 v[228:231], a[224:227], a[88:91], v[228:231]
L_h5:
    s_cbranch_execz L_h9
    v_exp_f32 v204, v204
    v_mfma_f32_16x16x32_bf16 v[228:231], a[228:231], a[92:95], v[228:231]
    v_exp_f32 v205, v205
    v_mfma_f32_16x16x32_bf16 v[232:235], a[240:243], a[96:99], 0
    v_exp_f32 v200, v200
    v_mfma_f32_16x16x32_bf16 v[232:235], a[244:247], a[100:103], v[232:235]
    v_exp_f32 v201, v201
    v_mfma_f32_16x16x32_bf16 v[232:235], a[216:219], a[104:107], v[232:235]
    s_waitcnt lgkmcnt(4)
    v_cvt_pk_bf16_f32 v188, v200, v201
    v_cvt_pk_bf16_f32 v12, v228, v229
    v_mfma_f32_16x16x32_bf16 v[208:211], v[162:165], v[174:177], v[208:211]
    ds_read_b128 v[200:203], v244 offset:64
    v_cvt_pk_bf16_f32 v15, v230, v231
    v_mfma_f32_16x16x32_bf16 v[224:227], a[248:251], v[188:191], v[224:227]
    v_exp_f32 v206, v206
    v_mfma_f32_16x16x32_bf16 v[212:215], v[12:15], v[188:191], v[212:215]
    v_exp_f32 v207, v207
    v_mfma_f32_16x16x32_bf16 v[208:211], v[164:167], v[176:179], v[208:211]
    v_cvt_pk_bf16_f32 v184, v204, v205
    v_cvt_pk_bf16_f32 v187, v206, v207
    v_mfma_f32_16x16x32_bf16 v[232:235], a[220:223], a[108:111], v[232:235]
    ds_read_b128 v[204:207], v246 offset:128
    v_mfma_f32_16x16x32_bf16 v[232:235], a[224:227], a[112:115], v[232:235]
    v_rcp_f32 v225, v224
    v_mfma_f32_16x16x32_bf16 v[232:235], a[228:231], a[116:119], v[232:235]
    v_mul_f32 v212, v212, v225
    v_mul_f32 v213, v213, v225
    v_mfma_f32_16x16x32_bf16 v[236:239], a[240:243], a[120:123], 0
    s_waitcnt lgkmcnt(3)
    v_mul_f32 v214, v214, v225
    v_mul_f32 v215, v215, v225
    v_mfma_f32_16x16x32_bf16 v[196:199], v[132:135], v[174:177], v[196:199]
    ds_read_b128 a[240:243], v242 offset:61568
    s_waitcnt lgkmcnt(2)
    v_mfma_f32_16x16x32_bf16 v[200:203], v[126:129], v[174:177], v[200:203]
    v_cvt_pk_bf16_f32 v42, v232, v233
    v_cvt_pk_bf16_f32 v45, v234, v235
    v_mfma_f32_16x16x32_bf16 v[200:203], v[128:131], v[176:179], v[200:203]
    v_cvt_pk_bf16_f32 v212, v212, v213
    v_cvt_pk_bf16_f32 v213, v214, v215
    v_mfma_f32_16x16x32_bf16 v[216:219], v[42:45], v[188:191], v[216:219]
    ds_write_b64 v247, v[212:213] offset:6144
    v_mfma_f32_16x16x32_bf16 v[212:215], v[6:9], v[192:195], 0
    v_exp_f32 v208, v208
    v_mfma_f32_16x16x32_bf16 v[196:199], v[134:137], v[176:179], v[196:199]
    v_exp_f32 v209, v209
    v_mfma_f32_16x16x32_bf16 v[236:239], a[244:247], a[124:127], v[236:239]
    ds_read_b128 a[244:247], v243 offset:61568
    v_max3_f32 v248, v248, v224, v225
    v_mfma_f32_16x16x32_bf16 v[236:239], a[216:219], a[128:131], v[236:239]
    ds_read_b128 a[216:219], v242 offset:61696
    v_mul_f32 v216, v216, v225
    v_mfma_f32_16x16x32_bf16 v[236:239], a[220:223], a[132:135], v[236:239]
    ds_read_b128 a[220:223], v243 offset:61696
    v_mul_f32 v217, v217, v225
    v_mfma_f32_16x16x32_bf16 v[236:239], a[224:227], a[136:139], v[236:239]
    v_mul_f32 v218, v218, v225
    v_mul_f32 v219, v219, v225
    v_mfma_f32_16x16x32_bf16 v[236:239], a[228:231], a[140:143], v[236:239]
    v_cvt_pk_bf16_f32 v216, v216, v217
    v_cvt_pk_bf16_f32 v217, v218, v219
    v_mfma_f32_16x16x32_bf16 v[228:231], a[144:147], a[232:235], 0
    ds_write_b64 v247, v[216:217] offset:6272
    v_mfma_f32_16x16x32_bf16 v[216:219], v[36:39], v[192:195], 0
    v_exp_f32 v200, v200
    v_mfma_f32_16x16x32_bf16 v[228:231], a[148:151], a[236:239], v[228:231]
    s_waitcnt lgkmcnt(5)
    v_cvt_pk_bf16_f32 v72, v236, v237
    v_cvt_pk_bf16_f32 v75, v238, v239
    v_mfma_f32_16x16x32_bf16 v[228:231], a[152:155], a[240:243], v[228:231]
    s_waitcnt lgkmcnt(3)
    v_exp_f32 v201, v201
    v_mfma_f32_16x16x32_bf16 v[220:223], v[72:75], v[188:191], v[220:223]
    v_cvt_pk_bf16_f32 v183, v200, v201
    v_cvt_pk_bf16_f32 v182, v208, v209
    v_mfma_f32_16x16x32_bf16 v[228:231], a[156:159], a[244:247], v[228:231]
    s_waitcnt lgkmcnt(2)
    v_exp_f32 v202, v202
    v_mfma_f32_16x16x32_bf16 v[212:215], v[10:13], v[180:183], v[212:215]
    ds_read_b128 a[224:227], v242 offset:62976
    ds_read_b128 a[228:231], v243 offset:62976
    v_mfma_f32_16x16x32_bf16 v[216:219], v[40:43], v[180:183], v[216:219]
    v_mul_f32 v220, v220, v225
    v_mul_f32 v221, v221, v225
    v_mfma_f32_16x16x32_bf16 v[228:231], a[160:163], a[216:219], v[228:231]
    s_waitcnt lgkmcnt(3)
    v_mul_f32 v222, v222, v225
    v_mul_f32 v223, v223, v225
    v_mfma_f32_16x16x32_bf16 v[224:227], a[248:251], v[192:195], 0
    v_cvt_pk_bf16_f32 v220, v220, v221
    v_cvt_pk_bf16_f32 v221, v222, v223
    v_mfma_f32_16x16x32_bf16 v[224:227], a[248:251], v[180:183], v[224:227]
    ds_write_b64 v247, v[220:221] offset:6400
    v_mfma_f32_16x16x32_bf16 v[220:223], v[66:69], v[192:195], 0
    v_exp_f32 v203, v203
    v_mfma_f32_16x16x32_bf16 v[220:223], v[70:73], v[180:183], v[220:223]
    v_exp_f32 v210, v210
    v_mfma_f32_16x16x32_bf16 v[228:231], a[164:167], a[220:223], v[228:231]
    v_exp_f32 v211, v211
    v_mfma_f32_16x16x32_bf16 v[232:235], a[168:171], a[232:235], 0
    s_waitcnt vmcnt(0)
    v_cvt_pk_bf16_f32 v186, v202, v203
    v_cvt_pk_bf16_f32 v185, v210, v211
    v_mfma_f32_16x16x32_bf16 v[232:235], a[172:175], a[236:239], v[232:235]
    ds_read_b128 v[200:203], v245 offset:128
    ds_read_b128 v[208:211], v244 offset:0
    v_mfma_f32_16x16x32_bf16 v[212:215], v[14:17], v[184:187], v[212:215]
    s_barrier
    v_mul_f32 v228, s38, v228
    v_mul_f32 v229, s38, v229
    v_mfma_f32_16x16x32_bf16 v[216:219], v[44:47], v[184:187], v[216:219]
    v_mul_f32 v230, s38, v230
    v_mul_f32 v231, s38, v231
    v_mfma_f32_16x16x32_bf16 v[220:223], v[74:77], v[184:187], v[220:223]
    v_cvt_pk_bf16_f32 v228, v228, v229
    v_cvt_pk_bf16_f32 v229, v230, v231
    v_mfma_f32_16x16x32_bf16 v[224:227], a[248:251], v[184:187], v[224:227]
    ds_write_b64 v247, v[228:229] offset:24576
    v_mfma_f32_16x16x32_bf16 v[232:235], a[176:179], a[240:243], v[232:235]
    s_waitcnt lgkmcnt(4)
    v_exp_f32 v196, v196
    v_mfma_f32_16x16x32_bf16 v[232:235], a[180:183], a[244:247], v[232:235]
    v_exp_f32 v197, v197
    v_mfma_f32_16x16x32_bf16 v[232:235], a[184:187], a[216:219], v[232:235]
    v_cvt_pk_bf16_f32 v189, v196, v197
    v_mfma_f32_16x16x32_bf16 v[232:235], a[188:191], a[220:223], v[232:235]
    ds_read_b128 v[196:199], v245 offset:0
    v_mfma_f32_16x16x32_bf16 v[236:239], a[192:195], a[232:235], 0
    ds_read_b128 a[232:235], v242 offset:63104
    v_mfma_f32_16x16x32_bf16 v[236:239], a[196:199], a[236:239], v[236:239]
    ds_read_b128 a[236:239], v243 offset:63104
    v_mfma_f32_16x16x32_bf16 v[236:239], a[200:203], a[240:243], v[236:239]
    ds_read_b128 a[240:243], v242 offset:63232
    v_mfma_f32_16x16x32_bf16 v[236:239], a[204:207], a[244:247], v[236:239]
    ds_read_b128 a[244:247], v243 offset:63232
    v_mul_f32 v232, s3, v232
    v_mfma_f32_16x16x32_bf16 v[236:239], a[208:211], a[216:219], v[236:239]
    s_waitcnt lgkmcnt(7)
    v_mul_f32 v233, s3, v233
    v_mul_f32 v234, s3, v234
    v_mfma_f32_16x16x32_bf16 v[200:203], v[156:159], v[174:177], v[200:203]
    s_waitcnt lgkmcnt(6)
    v_mul_f32 v235, s3, v235
    v_cvt_pk_bf16_f32 v232, v232, v233
    v_mfma_f32_16x16x32_bf16 v[200:203], v[158:161], v[176:179], v[200:203]
    ds_read_b128 a[216:219], v240 offset:35328
    v_cvt_pk_bf16_f32 v233, v234, v235
    v_mfma_f32_16x16x32_bf16 v[208:211], v[126:129], v[168:171], v[208:211]
    ds_write_b64 v247, v[232:233] offset:24704
    v_mfma_f32_16x16x32_bf16 v[208:211], v[128:131], v[170:173], v[208:211]
    v_mfma_f32_16x16x32_bf16 v[236:239], a[212:215], a[220:223], v[236:239]
    ds_read_b128 a[220:223], v241 offset:35328
    v_mfma_f32_16x16x32_bf16 v[228:231], a[144:147], a[224:227], 0
    v_exp_f32 v200, v200
    v_mfma_f32_16x16x32_bf16 v[228:231], a[148:151], a[228:231], v[228:231]
    s_waitcnt lgkmcnt(6)
    v_exp_f32 v201, v201
    v_mfma_f32_16x16x32_bf16 v[196:199], v[150:153], v[168:171], v[196:199]
    v_exp_f32 v208, v208
    v_mfma_f32_16x16x32_bf16 v[196:199], v[152:155], v[170:173], v[196:199]
    v_cvt_pk_bf16_f32 v190, v200, v201
    v_mul_f32 v236, s38, v236
    v_mfma_f32_16x16x32_bf16 v[228:231], a[152:155], a[232:235], v[228:231]
    s_waitcnt lgkmcnt(5)
    v_mul_f32 v237, s38, v237
    v_mul_f32 v238, s38, v238
    v_mfma_f32_16x16x32_bf16 v[228:231], a[156:159], a[236:239], v[228:231]
    s_waitcnt lgkmcnt(4)
    ds_read_b128 v[200:203], v246 offset:0
    v_mfma_f32_16x16x32_bf16 v[228:231], a[160:163], a[240:243], v[228:231]
    s_waitcnt lgkmcnt(4)
    v_mul_f32 v239, s38, v239
    v_cvt_pk_bf16_f32 v236, v236, v237
    v_mfma_f32_16x16x32_bf16 v[228:231], a[164:167], a[244:247], v[228:231]
    v_exp_f32 v209, v209
    v_mfma_f32_16x16x32_bf16 v[232:235], a[168:171], a[224:227], 0
    v_cvt_pk_bf16_f32 v237, v238, v239
    v_cvt_pk_bf16_f32 v193, v208, v209
    v_mfma_f32_16x16x32_bf16 v[232:235], a[172:175], a[228:231], v[232:235]
    ds_write_b64 v247, v[236:237] offset:24832
    v_mfma_f32_16x16x32_bf16 v[232:235], a[176:179], a[232:235], v[232:235]
    v_exp_f32 v210, v210
    v_mfma_f32_16x16x32_bf16 v[232:235], a[180:183], a[236:239], v[232:235]
    v_mul_f32 v228, s38, v228
    v_mul_f32 v229, s38, v229
    v_mfma_f32_16x16x32_bf16 v[232:235], a[184:187], a[240:243], v[232:235]
    v_mul_f32 v230, s38, v230
    v_mul_f32 v231, s38, v231
    v_mfma_f32_16x16x32_bf16 v[232:235], a[188:191], a[244:247], v[232:235]
    v_cvt_pk_bf16_f32 v228, v228, v229
    v_cvt_pk_bf16_f32 v229, v230, v231
    v_mfma_f32_16x16x32_bf16 v[236:239], a[192:195], a[224:227], 0
    ds_read_b128 a[224:227], v240 offset:35456
    v_mfma_f32_16x16x32_bf16 v[236:239], a[196:199], a[228:231], v[236:239]
    ds_read_b128 a[228:231], v241 offset:35456
    v_mfma_f32_16x16x32_bf16 v[236:239], a[200:203], a[232:235], v[236:239]
    ds_read_b128 a[232:235], v240 offset:35584
    s_waitcnt lgkmcnt(4)
    v_mfma_f32_16x16x32_bf16 v[200:203], v[162:165], v[168:171], v[200:203]
    ds_write_b64 v247, v[228:229] offset:30720
    v_mfma_f32_16x16x32_bf16 v[200:203], v[164:167], v[170:173], v[200:203]
    v_mul_f32 v232, s3, v232
    v_mul_f32 v233, s3, v233
    v_mfma_f32_16x16x32_bf16 v[236:239], a[204:207], a[236:239], v[236:239]
    ds_read_b128 a[236:239], v241 offset:35584
    v_mul_f32 v234, s3, v234
    v_mfma_f32_16x16x32_bf16 v[236:239], a[208:211], a[240:243], v[236:239]
    v_mul_f32 v235, s3, v235
    v_cvt_pk_bf16_f32 v232, v232, v233
    v_mfma_f32_16x16x32_bf16 v[236:239], a[212:215], a[244:247], v[236:239]
    ds_read_b128 a[240:243], v242 offset:64512
    v_cvt_pk_bf16_f32 v233, v234, v235
    v_mfma_f32_16x16x32_bf16 v[228:231], a[0:3], a[216:219], 0
    ds_write_b64 v247, v[232:233] offset:30848
    v_mfma_f32_16x16x32_bf16 v[228:231], a[4:7], a[220:223], v[228:231]
    s_waitcnt lgkmcnt(6)
    v_exp_f32 v211, v211
    v_mfma_f32_16x16x32_bf16 v[228:231], a[8:11], a[224:227], v[228:231]
    s_waitcnt lgkmcnt(5)
    v_mul_f32 v236, s38, v236
    v_mul_f32 v237, s38, v237
    v_mfma_f32_16x16x32_bf16 v[228:231], a[12:15], a[228:231], v[228:231]
    s_waitcnt lgkmcnt(4)
    v_mul_f32 v238, s38, v238
    v_mul_f32 v239, s38, v239
    v_mfma_f32_16x16x32_bf16 v[228:231], a[16:19], a[232:235], v[228:231]
    v_cvt_pk_bf16_f32 v236, v236, v237
    v_cvt_pk_bf16_f32 v237, v238, v239
    v_mfma_f32_16x16x32_bf16 v[232:235], a[24:27], a[216:219], 0
    s_waitcnt lgkmcnt(2)
    v_exp_f32 v196, v196
    v_mfma_f32_16x16x32_bf16 v[228:231], a[20:23], a[236:239], v[228:231]
    ds_write_b64 v247, v[236:237] offset:30976
    v_mfma_f32_16x16x32_bf16 v[232:235], a[28:31], a[220:223], v[232:235]
    ds_read_b128 a[244:247], v243 offset:64512
    v_cvt_pk_bf16_f32 v180, v210, v211
    v_mfma_f32_16x16x32_bf16 v[232:235], a[32:35], a[224:227], v[232:235]
    ds_read_b128 v[208:211], v245 offset:64
    v_mfma_f32_16x16x32_bf16 v[232:235], a[36:39], a[228:231], v[232:235]
    v_exp_f32 v197, v197
    v_mfma_f32_16x16x32_bf16 v[232:235], a[40:43], a[232:235], v[232:235]
    v_cvt_pk_bf16_f32 v114, v228, v229
    v_cvt_pk_bf16_f32 v115, v230, v231
    v_mfma_f32_16x16x32_bf16 v[232:235], a[44:47], a[236:239], v[232:235]
    v_exp_f32 v198, v198
    v_mfma_f32_16x16x32_bf16 v[236:239], a[48:51], a[216:219], 0
    v_exp_f32 v199, v199
    v_mfma_f32_16x16x32_bf16 v[236:239], a[52:55], a[220:223], v[236:239]
    v_cvt_pk_bf16_f32 v194, v196, v197
    v_cvt_pk_bf16_f32 v181, v198, v199
    v_mfma_f32_16x16x32_bf16 v[236:239], a[56:59], a[224:227], v[236:239]
    ds_read_b128 v[196:199], v246 offset:64
    v_cvt_pk_bf16_f32 v116, v232, v233
    v_mfma_f32_16x16x32_bf16 v[236:239], a[60:63], a[228:231], v[236:239]
    v_cvt_pk_bf16_f32 v117, v234, v235
    v_mfma_f32_16x16x32_bf16 v[236:239], a[64:67], a[232:235], v[236:239]
    v_exp_f32 v200, v200
    v_mfma_f32_16x16x32_bf16 v[204:207], v[114:117], v[174:177], v[204:207]
    v_exp_f32 v201, v201
    v_mfma_f32_16x16x32_bf16 v[236:239], a[68:71], a[236:239], v[236:239]
    v_exp_f32 v202, v202
    v_mfma_f32_16x16x32_bf16 v[228:231], a[216:219], a[72:75], 0
    v_exp_f32 v203, v203
    v_mfma_f32_16x16x32_bf16 v[228:231], a[220:223], a[76:79], v[228:231]
    v_cvt_pk_bf16_f32 v192, v200, v201
    v_cvt_pk_bf16_f32 v195, v202, v203
    v_mfma_f32_16x16x32_bf16 v[228:231], a[224:227], a[80:83], v[228:231]
    ds_read_b128 v[200:203], v244 offset:128
    v_cvt_pk_bf16_f32 v118, v236, v237
    v_mfma_f32_16x16x32_bf16 v[228:231], a[228:231], a[84:87], v[228:231]
    s_waitcnt lgkmcnt(2)
    v_cvt_pk_bf16_f32 v119, v238, v239
    v_mfma_f32_16x16x32_bf16 v[208:211], v[156:159], v[168:171], v[208:211]
    ds_read_b64 v[174:175], v247 offset:0
    v_mfma_f32_16x16x32_bf16 v[204:207], v[116:119], v[176:179], v[204:207]
    ds_read_b64 v[176:177], v247 offset:128
    ds_read_b64 v[178:179], v247 offset:256
    v_mfma_f32_16x16x32_bf16 v[208:211], v[158:161], v[170:173], v[208:211]
    v_mfma_f32_16x16x32_bf16 v[228:231], a[232:235], a[88:91], v[228:231]
    v_mfma_f32_16x16x32_bf16 v[228:231], a[236:239], a[92:95], v[228:231]
    v_mfma_f32_16x16x32_bf16 v[232:235], a[216:219], a[96:99], 0
    s_waitcnt lgkmcnt(4)
    v_mfma_f32_16x16x32_bf16 v[196:199], v[114:117], v[168:171], v[196:199]
    v_exp_f32 v204, v204
    v_mfma_f32_16x16x32_bf16 v[196:199], v[116:119], v[170:173], v[196:199]
    v_exp_f32 v205, v205
    v_mfma_f32_16x16x32_bf16 v[232:235], a[220:223], a[100:103], v[232:235]
    v_cvt_pk_bf16_f32 v188, v204, v205
    v_cvt_pk_bf16_f32 v18, v228, v229
    v_mfma_f32_16x16x32_bf16 v[232:235], a[224:227], a[104:107], v[232:235]
    ds_read_b128 v[204:207], v244 offset:64
    v_cvt_pk_bf16_f32 v21, v230, v231
    v_mfma_f32_16x16x32_bf16 v[224:227], a[248:251], v[188:191], v[224:227]
    s_waitcnt lgkmcnt(4)
    v_exp_f32 v196, v196
    v_mfma_f32_16x16x32_bf16 v[212:215], v[18:21], v[188:191], v[212:215]
    v_exp_f32 v197, v197
    v_mfma_f32_16x16x32_bf16 v[200:203], v[90:93], v[168:171], v[200:203]
    v_exp_f32 v208, v208
    v_mfma_f32_16x16x32_bf16 v[200:203], v[92:95], v[170:173], v[200:203]
    v_exp_f32 v209, v209
    v_mfma_f32_16x16x32_bf16 v[232:235], a[228:231], a[108:111], v[232:235]
    v_rcp_f32 v225, v224
    v_mfma_f32_16x16x32_bf16 v[232:235], a[232:235], a[112:115], v[232:235]
    v_mul_f32 v212, v212, v225
    v_mul_f32 v213, v213, v225
    v_mfma_f32_16x16x32_bf16 v[232:235], a[236:239], a[116:119], v[232:235]
    v_mul_f32 v214, v214, v225
    v_mul_f32 v215, v215, v225
    v_mfma_f32_16x16x32_bf16 v[236:239], a[216:219], a[120:123], 0
    ds_read_b128 a[216:219], v242 offset:64640
    s_waitcnt lgkmcnt(1)
    v_mfma_f32_16x16x32_bf16 v[204:207], v[132:135], v[168:171], v[204:207]
    v_cvt_pk_bf16_f32 v212, v212, v213
    v_cvt_pk_bf16_f32 v213, v214, v215
    v_mfma_f32_16x16x32_bf16 v[204:207], v[134:137], v[170:173], v[204:207]
    v_cvt_pk_bf16_f32 v48, v232, v233
    v_cvt_pk_bf16_f32 v51, v234, v235
    v_mfma_f32_16x16x32_bf16 v[236:239], a[220:223], a[124:127], v[236:239]
    ds_read_b128 a[220:223], v243 offset:64640
    v_max3_f32 v248, v248, v224, v225
    v_mfma_f32_16x16x32_bf16 v[216:219], v[48:51], v[188:191], v[216:219]
    ds_write_b64 v247, v[212:213] offset:12288
    v_mfma_f32_16x16x32_bf16 v[212:215], v[12:15], v[192:195], 0
    v_exp_f32 v204, v204
    v_mfma_f32_16x16x32_bf16 v[236:239], a[224:227], a[128:131], v[236:239]
    ds_read_b128 a[224:227], v242 offset:64768
    v_add_u32 v242, 0xf000, v242
    v_mfma_f32_16x16x32_bf16 v[236:239], a[228:231], a[132:135], v[236:239]
    ds_read_b128 a[228:231], v243 offset:64768
    v_mul_f32 v216, v216, v225
    v_mfma_f32_16x16x32_bf16 v[236:239], a[232:235], a[136:139], v[236:239]
    v_mul_f32 v217, v217, v225
    v_mul_f32 v218, v218, v225
    v_mfma_f32_16x16x32_bf16 v[236:239], a[236:239], a[140:143], v[236:239]
    v_mul_f32 v219, v219, v225
    v_cvt_pk_bf16_f32 v216, v216, v217
    v_mfma_f32_16x16x32_bf16 v[228:231], a[144:147], a[240:243], 0
    ds_read_b128 a[232:235], v242 offset:4608
    v_cvt_pk_bf16_f32 v217, v218, v219
    v_mfma_f32_16x16x32_bf16 v[228:231], a[148:151], a[244:247], v[228:231]
    s_waitcnt lgkmcnt(5)
    v_add_u32 v243, 0xf000, v243
    v_cvt_pk_bf16_f32 v78, v236, v237
    v_mfma_f32_16x16x32_bf16 v[228:231], a[152:155], a[216:219], v[228:231]
    s_waitcnt lgkmcnt(4)
    v_cvt_pk_bf16_f32 v81, v238, v239
    v_cvt_pk_bf16_f32 v182, v196, v197
    v_mfma_f32_16x16x32_bf16 v[228:231], a[156:159], a[220:223], v[228:231]
    ds_write_b64 v247, v[216:217] offset:12416
    v_mfma_f32_16x16x32_bf16 v[220:223], v[78:81], v[188:191], v[220:223]
    s_waitcnt lgkmcnt(3)
    v_exp_f32 v205, v205
    v_mfma_f32_16x16x32_bf16 v[216:219], v[42:45], v[192:195], 0
    ds_read_b128 a[236:239], v243 offset:4608
    v_cvt_pk_bf16_f32 v183, v204, v205
    v_mfma_f32_16x16x32_bf16 v[228:231], a[160:163], a[224:227], v[228:231]
    s_waitcnt lgkmcnt(3)
    v_exp_f32 v206, v206
    v_mfma_f32_16x16x32_bf16 v[212:215], v[16:19], v[180:183], v[212:215]
    v_mul_f32 v220, v220, v225
    v_mul_f32 v221, v221, v225
    v_mfma_f32_16x16x32_bf16 v[216:219], v[46:49], v[180:183], v[216:219]
    v_mul_f32 v222, v222, v225
    v_mul_f32 v223, v223, v225
    v_mfma_f32_16x16x32_bf16 v[224:227], a[248:251], v[192:195], 0
    v_cvt_pk_bf16_f32 v220, v220, v221
    v_cvt_pk_bf16_f32 v221, v222, v223
    v_mfma_f32_16x16x32_bf16 v[224:227], a[248:251], v[180:183], v[224:227]
    ds_write_b64 v247, v[220:221] offset:12544
    v_mfma_f32_16x16x32_bf16 v[220:223], v[72:75], v[192:195], 0
    v_exp_f32 v207, v207
    v_mfma_f32_16x16x32_bf16 v[220:223], v[76:79], v[180:183], v[220:223]
    v_cvt_pk_bf16_f32 v186, v206, v207
    v_cvt_pk_bf16_f32 v184, v208, v209
    v_mfma_f32_16x16x32_bf16 v[228:231], a[164:167], a[228:231], v[228:231]
    ds_read_b128 v[204:207], v245 offset:128
    v_mfma_f32_16x16x32_bf16 v[232:235], a[168:171], a[240:243], 0
    v_exp_f32 v210, v210
    v_mfma_f32_16x16x32_bf16 v[232:235], a[172:175], a[244:247], v[232:235]
    v_exp_f32 v211, v211
    v_mfma_f32_16x16x32_bf16 v[232:235], a[176:179], a[216:219], v[232:235]
    v_exp_f32 v198, v198
    v_mfma_f32_16x16x32_bf16 v[232:235], a[180:183], a[220:223], v[232:235]
    v_mul_f32 v228, s38, v228
    v_mul_f32 v229, s38, v229
    v_mfma_f32_16x16x32_bf16 v[232:235], a[184:187], a[224:227], v[232:235]
    v_mul_f32 v230, s38, v230
    v_mul_f32 v231, s38, v231
    v_mfma_f32_16x16x32_bf16 v[232:235], a[188:191], a[228:231], v[232:235]
    v_cvt_pk_bf16_f32 v228, v228, v229
    v_cvt_pk_bf16_f32 v229, v230, v231
    v_mfma_f32_16x16x32_bf16 v[236:239], a[192:195], a[240:243], 0
    ds_read_b128 a[240:243], v242 offset:4736
    v_cvt_pk_bf16_f32 v187, v210, v211
    v_mfma_f32_16x16x32_bf16 v[236:239], a[196:199], a[244:247], v[236:239]
    ds_read_b128 a[244:247], v243 offset:4736
    ds_read_b128 v[208:211], v246 offset:128
    v_mfma_f32_16x16x32_bf16 v[236:239], a[200:203], a[216:219], v[236:239]
    ds_read_b128 a[216:219], v242 offset:4864
    v_mul_f32 v232, s3, v232
    v_mfma_f32_16x16x32_bf16 v[236:239], a[204:207], a[220:223], v[236:239]
    ds_read_b128 a[220:223], v243 offset:4864
    v_mul_f32 v233, s3, v233
    v_mfma_f32_16x16x32_bf16 v[236:239], a[208:211], a[224:227], v[236:239]
    ds_write_b64 v247, v[228:229] offset:36864
    v_mfma_f32_16x16x32_bf16 v[236:239], a[212:215], a[228:231], v[236:239]
    s_waitcnt lgkmcnt(6)
    v_mul_f32 v234, s3, v234
    v_mul_f32 v235, s3, v235
    v_mfma_f32_16x16x32_bf16 v[204:207], v[96:99], v[168:171], v[204:207]
    v_cvt_pk_bf16_f32 v232, v232, v233
    v_cvt_pk_bf16_f32 v233, v234, v235
    v_mfma_f32_16x16x32_bf16 v[204:207], v[98:101], v[170:173], v[204:207]
    ds_write_b64 v247, v[232:233] offset:36992
    v_mfma_f32_16x16x32_bf16 v[228:231], a[144:147], a[232:235], 0
    v_add_u32 v242, 0x7800, v242
    v_add_u32 v243, 0x4200, v243
    v_mfma_f32_16x16x32_bf16 v[228:231], a[148:151], a[236:239], v[228:231]
    s_waitcnt lgkmcnt(6)
    v_cndmask_b32 v242, v242, v243, vcc
    s_mov_b32 vcc_lo, 0xf0f0f0f0
    v_mfma_f32_16x16x32_bf16 v[228:231], a[152:155], a[240:243], v[228:231]
    s_waitcnt lgkmcnt(5)
    v_add_u32 v243, 0xfffe2000, v242
    s_mov_b32 vcc_hi, 0xf0f0f0f0
    v_mfma_f32_16x16x32_bf16 v[228:231], a[156:159], a[244:247], v[228:231]
    s_waitcnt lgkmcnt(3)
    v_cndmask_b32 v242, v242, v243, vcc
    v_mul_f32 v236, s38, v236
    v_mfma_f32_16x16x32_bf16 v[228:231], a[160:163], a[216:219], v[228:231]
    s_waitcnt lgkmcnt(2)
    ds_read_b128 a[224:227], v242 offset:0
    v_mfma_f32_16x16x32_bf16 v[228:231], a[164:167], a[220:223], v[228:231]
    s_mov_b32 vcc_lo, 0xcccccccc
    v_mul_f32 v237, s38, v237
    v_mul_f32 v238, s38, v238
    v_mfma_f32_16x16x32_bf16 v[232:235], a[168:171], a[232:235], 0
    s_mov_b32 vcc_hi, 0xcccccccc
    v_mul_f32 v239, s38, v239
    v_cvt_pk_bf16_f32 v236, v236, v237
    v_mfma_f32_16x16x32_bf16 v[232:235], a[172:175], a[236:239], v[232:235]
    v_xor_b32 v243, 64, v242
    v_cvt_pk_bf16_f32 v237, v238, v239
    v_mfma_f32_16x16x32_bf16 v[232:235], a[176:179], a[240:243], v[232:235]
    ds_read_b128 a[228:231], v243 offset:0
    v_mul_f32 v228, s38, v228
    v_mfma_f32_16x16x32_bf16 v[232:235], a[180:183], a[244:247], v[232:235]
    ds_write_b64 v247, v[236:237] offset:37120
    v_mfma_f32_16x16x32_bf16 v[232:235], a[184:187], a[216:219], v[232:235]
    v_mul_f32 v229, s38, v229
    v_mul_f32 v230, s38, v230
    v_mfma_f32_16x16x32_bf16 v[232:235], a[188:191], a[220:223], v[232:235]
    v_mul_f32 v231, s38, v231
    v_cvt_pk_bf16_f32 v228, v228, v229
    v_mfma_f32_16x16x32_bf16 v[236:239], a[192:195], a[232:235], 0
    ds_read_b128 a[232:235], v242 offset:128
    v_cvt_pk_bf16_f32 v229, v230, v231
    v_mfma_f32_16x16x32_bf16 v[236:239], a[196:199], a[236:239], v[236:239]
    ds_read_b128 a[236:239], v243 offset:128
    v_mfma_f32_16x16x32_bf16 v[236:239], a[200:203], a[240:243], v[236:239]
    ds_read_b128 a[240:243], v242 offset:256
    v_mul_f32 v232, s3, v232
    v_mfma_f32_16x16x32_bf16 v[236:239], a[204:207], a[244:247], v[236:239]
    ds_read_b128 a[244:247], v243 offset:256
    v_mul_f32 v233, s3, v233
    v_mfma_f32_16x16x32_bf16 v[236:239], a[208:211], a[216:219], v[236:239]
    ds_write_b64 v247, v[228:229] offset:43008
    v_mfma_f32_16x16x32_bf16 v[236:239], a[212:215], a[220:223], v[236:239]
    s_waitcnt lgkmcnt(7)
    v_mul_f32 v234, s3, v234
    v_mul_f32 v235, s3, v235
    v_mfma_f32_16x16x32_bf16 v[228:231], a[144:147], a[224:227], 0
    s_waitcnt lgkmcnt(6)
    v_cvt_pk_bf16_f32 v232, v232, v233
    v_cvt_pk_bf16_f32 v233, v234, v235
    v_mfma_f32_16x16x32_bf16 v[228:231], a[148:151], a[228:231], v[228:231]
    ds_write_b64 v247, v[232:233] offset:43136
    v_mfma_f32_16x16x32_bf16 v[232:235], a[168:171], a[224:227], 0
    s_waitcnt lgkmcnt(5)
    v_mul_f32 v236, s38, v236
    v_mul_f32 v237, s38, v237
    v_mfma_f32_16x16x32_bf16 v[228:231], a[152:155], a[232:235], v[228:231]
    s_waitcnt lgkmcnt(4)
    v_mul_f32 v238, s38, v238
    v_mul_f32 v239, s38, v239
    v_mfma_f32_16x16x32_bf16 v[228:231], a[156:159], a[236:239], v[228:231]
    s_waitcnt lgkmcnt(3)
    v_cvt_pk_bf16_f32 v236, v236, v237
    v_cvt_pk_bf16_f32 v237, v238, v239
    v_mfma_f32_16x16x32_bf16 v[228:231], a[160:163], a[240:243], v[228:231]
    s_waitcnt lgkmcnt(2)
    v_exp_f32 v199, v199
    v_mfma_f32_16x16x32_bf16 v[228:231], a[164:167], a[244:247], v[228:231]
    ds_write_b64 v247, v[236:237] offset:43264
    v_mfma_f32_16x16x32_bf16 v[232:235], a[172:175], a[228:231], v[232:235]
    ds_read_b128 a[216:219], v240 offset:36864
    v_cvt_pk_bf16_f32 v185, v198, v199
    v_mfma_f32_16x16x32_bf16 v[232:235], a[176:179], a[232:235], v[232:235]
    ds_read_b128 a[220:223], v241 offset:36864
    ds_read_b128 v[196:199], v244 offset:32
    v_mfma_f32_16x16x32_bf16 v[212:215], v[20:23], v[184:187], v[212:215]
    v_mul_f32 v228, s38, v228
    v_mul_f32 v229, s38, v229
    v_mfma_f32_16x16x32_bf16 v[216:219], v[50:53], v[184:187], v[216:219]
    v_mul_f32 v230, s38, v230
    v_mul_f32 v231, s38, v231
    v_mfma_f32_16x16x32_bf16 v[220:223], v[80:83], v[184:187], v[220:223]
    v_cvt_pk_bf16_f32 v228, v228, v229
    v_cvt_pk_bf16_f32 v229, v230, v231
    v_mfma_f32_16x16x32_bf16 v[224:227], a[248:251], v[184:187], v[224:227]
    ds_write_b64 v247, v[228:229] offset:49152
    v_mfma_f32_16x16x32_bf16 v[232:235], a[180:183], a[236:239], v[232:235]
    v_exp_f32 v200, v200
    v_mfma_f32_16x16x32_bf16 v[232:235], a[184:187], a[240:243], v[232:235]
    v_exp_f32 v201, v201
    v_mfma_f32_16x16x32_bf16 v[232:235], a[188:191], a[244:247], v[232:235]
    v_exp_f32 v204, v204
    v_mfma_f32_16x16x32_bf16 v[236:239], a[192:195], a[224:227], 0
    ds_read_b128 a[224:227], v240 offset:36992
    v_cvt_pk_bf16_f32 v189, v200, v201
    v_mfma_f32_16x16x32_bf16 v[236:239], a[196:199], a[228:231], v[236:239]
    ds_read_b128 a[228:231], v241 offset:36992
    ds_read_b128 v[200:203], v245 offset:32
    v_mfma_f32_16x16x32_bf16 v[236:239], a[200:203], a[232:235], v[236:239]
    ds_read_b128 a[232:235], v240 offset:37120
    v_mul_f32 v232, s3, v232
    v_mfma_f32_16x16x32_bf16 v[236:239], a[204:207], a[236:239], v[236:239]
    s_waitcnt lgkmcnt(7)
    ds_read_b128 a[236:239], v241 offset:37120
    v_mfma_f32_16x16x32_bf16 v[236:239], a[208:211], a[240:243], v[236:239]
    v_mul_f32 v233, s3, v233
    v_mul_f32 v234, s3, v234
    v_mfma_f32_16x16x32_bf16 v[236:239], a[212:215], a[244:247], v[236:239]
    v_mul_f32 v235, s3, v235
    v_cvt_pk_bf16_f32 v232, v232, v233
    v_mfma_f32_16x16x32_bf16 v[228:231], a[0:3], a[216:219], 0
    s_waitcnt lgkmcnt(6)
    v_cvt_pk_bf16_f32 v233, v234, v235
    v_add_u32 v240, 0xffff1000, v240
    v_mfma_f32_16x16x32_bf16 v[196:199], v[132:135], v[174:177], v[196:199]
    ds_write_b64 v247, v[232:233] offset:49280
    v_mfma_f32_16x16x32_bf16 v[196:199], v[134:137], v[176:179], v[196:199]
    v_exp_f32 v205, v205
    v_mfma_f32_16x16x32_bf16 v[228:231], a[4:7], a[220:223], v[228:231]
    s_waitcnt lgkmcnt(5)
    v_cvt_pk_bf16_f32 v190, v204, v205
    v_mul_f32 v236, s38, v236
    v_mfma_f32_16x16x32_bf16 v[228:231], a[8:11], a[224:227], v[228:231]
    s_waitcnt lgkmcnt(4)
    v_mul_f32 v237, s38, v237
    v_mul_f32 v238, s38, v238
    v_mfma_f32_16x16x32_bf16 v[228:231], a[12:15], a[228:231], v[228:231]
    s_waitcnt lgkmcnt(2)
    v_mul_f32 v239, s38, v239
    v_cvt_pk_bf16_f32 v236, v236, v237
    v_mfma_f32_16x16x32_bf16 v[200:203], v[156:159], v[174:177], v[200:203]
    ds_read_b128 v[204:207], v246 offset:32
    v_cvt_pk_bf16_f32 v237, v238, v239
    v_mfma_f32_16x16x32_bf16 v[200:203], v[158:161], v[176:179], v[200:203]
    ds_write_b64 v247, v[236:237] offset:49408
    v_mfma_f32_16x16x32_bf16 v[228:231], a[16:19], a[232:235], v[228:231]
    s_waitcnt lgkmcnt(3)
    v_exp_f32 v196, v196
    v_mfma_f32_16x16x32_bf16 v[228:231], a[20:23], a[236:239], v[228:231]
    v_exp_f32 v197, v197
    v_mfma_f32_16x16x32_bf16 v[232:235], a[24:27], a[216:219], 0
    v_exp_f32 v198, v198
    v_mfma_f32_16x16x32_bf16 v[232:235], a[28:31], a[220:223], v[232:235]
    v_exp_f32 v199, v199
    v_mfma_f32_16x16x32_bf16 v[232:235], a[32:35], a[224:227], v[232:235]
    v_cvt_pk_bf16_f32 v193, v196, v197
    v_cvt_pk_bf16_f32 v180, v198, v199
    v_mfma_f32_16x16x32_bf16 v[232:235], a[36:39], a[228:231], v[232:235]
    v_cvt_pk_bf16_f32 v120, v228, v229
    v_cvt_pk_bf16_f32 v121, v230, v231
    v_mfma_f32_16x16x32_bf16 v[232:235], a[40:43], a[232:235], v[232:235]
    ds_read_b128 v[196:199], v245 offset:96
    v_add_u32 v241, 0xffff1000, v241
    v_mfma_f32_16x16x32_bf16 v[232:235], a[44:47], a[236:239], v[232:235]
    ds_read_b128 a[240:243], v242 offset:3072
    ds_read_b128 a[244:247], v243 offset:3072
    v_mfma_f32_16x16x32_bf16 v[236:239], a[48:51], a[216:219], 0
    v_exp_f32 v200, v200
    v_mfma_f32_16x16x32_bf16 v[236:239], a[52:55], a[220:223], v[236:239]
    v_exp_f32 v201, v201
    v_mfma_f32_16x16x32_bf16 v[236:239], a[56:59], a[224:227], v[236:239]
    s_waitcnt lgkmcnt(4)
    v_cvt_pk_bf16_f32 v122, v232, v233
    v_cvt_pk_bf16_f32 v123, v234, v235
    v_mfma_f32_16x16x32_bf16 v[204:207], v[114:117], v[174:177], v[204:207]
    v_exp_f32 v202, v202
    v_mfma_f32_16x16x32_bf16 v[208:211], v[120:123], v[168:171], v[208:211]
    v_exp_f32 v203, v203
    v_mfma_f32_16x16x32_bf16 v[204:207], v[116:119], v[176:179], v[204:207]
    v_cvt_pk_bf16_f32 v194, v200, v201
    v_cvt_pk_bf16_f32 v181, v202, v203
    v_mfma_f32_16x16x32_bf16 v[236:239], a[60:63], a[228:231], v[236:239]
    ds_read_b128 v[200:203], v246 offset:96
    ds_read_b64 v[168:169], v247 offset:24576
    v_mfma_f32_16x16x32_bf16 v[236:239], a[64:67], a[232:235], v[236:239]
    v_mfma_f32_16x16x32_bf16 v[236:239], a[68:71], a[236:239], v[236:239]
    v_mfma_f32_16x16x32_bf16 v[228:231], a[216:219], a[72:75], 0
L_h6:
    s_cbranch_execz L_hback
    v_exp_f32 v204, v204
    v_mfma_f32_16x16x32_bf16 v[228:231], a[220:223], a[76:79], v[228:231]
    v_exp_f32 v205, v205
    v_mfma_f32_16x16x32_bf16 v[228:231], a[224:227], a[80:83], v[228:231]
    s_waitcnt lgkmcnt(4)
    v_exp_f32 v206, v206
    v_mfma_f32_16x16x32_bf16 v[196:199], v[96:99], v[174:177], v[196:199]
    v_cvt_pk_bf16_f32 v124, v236, v237
    v_cvt_pk_bf16_f32 v125, v238, v239
    v_mfma_f32_16x16x32_bf16 v[196:199], v[98:101], v[176:179], v[196:199]
    v_exp_f32 v207, v207
    v_mfma_f32_16x16x32_bf16 v[208:211], v[122:125], v[170:173], v[208:211]
    v_cvt_pk_bf16_f32 v192, v204, v205
    v_cvt_pk_bf16_f32 v195, v206, v207
    v_mfma_f32_16x16x32_bf16 v[228:231], a[228:231], a[84:87], v[228:231]
    ds_read_b64 v[170:171], v247 offset:24704
    ds_read_b128 v[204:207], v244 offset:192
    v_mfma_f32_16x16x32_bf16 v[228:231], a[232:235], a[88:91], v[228:231]
    ds_read_b64 v[172:173], v247 offset:24832
    v_mfma_f32_16x16x32_bf16 v[228:231], a[236:239], a[92:95], v[228:231]
    v_exp_f32 v208, v208
    v_mfma_f32_16x16x32_bf16 v[232:235], a[216:219], a[96:99], 0
    v_exp_f32 v209, v209
    v_mfma_f32_16x16x32_bf16 v[232:235], a[220:223], a[100:103], v[232:235]
    s_waitcnt lgkmcnt(4)
    v_exp_f32 v196, v196
    v_mfma_f32_16x16x32_bf16 v[200:203], v[120:123], v[174:177], v[200:203]
    v_exp_f32 v197, v197
    v_mfma_f32_16x16x32_bf16 v[200:203], v[122:125], v[176:179], v[200:203]
    v_cvt_pk_bf16_f32 v24, v228, v229
    v_cvt_pk_bf16_f32 v27, v230, v231
    v_mfma_f32_16x16x32_bf16 v[232:235], a[224:227], a[104:107], v[232:235]
    v_cvt_pk_bf16_f32 v188, v208, v209
    v_mbcnt_lo_u32_b32 v228, -1, 0
    v_mfma_f32_16x16x32_bf16 v[232:235], a[228:231], a[108:111], v[232:235]
    ds_read_b128 v[208:211], v244 offset:96
    v_mbcnt_hi_u32_b32 v228, -1, v228
    v_mfma_f32_16x16x32_bf16 v[212:215], v[24:27], v[188:191], v[212:215]
    v_lshrrev_b32 v229, 1, v228
    v_add_u32 v229, 64, v229
    v_mfma_f32_16x16x32_bf16 v[224:227], a[248:251], v[188:191], v[224:227]
    v_mul_u32_u24 v230, 43, v229
    v_lshrrev_b32 v231, 8, v230
    v_mfma_f32_16x16x32_bf16 v[232:235], a[232:235], a[112:115], v[232:235]
    v_lshrrev_b32 v230, 7, v230
    v_mad_i32_i24 v229, v230, -3, v229
    v_mfma_f32_16x16x32_bf16 v[232:235], a[236:239], a[116:119], v[232:235]
    v_and_b32 v231, 4, v231
    v_xor_b32 v230, v230, v231
    v_mfma_f32_16x16x32_bf16 v[236:239], a[216:219], a[120:123], 0
    ds_read_b128 a[216:219], v242 offset:3200
    v_and_b32 v231, 4, v230
    v_mfma_f32_16x16x32_bf16 v[236:239], a[220:223], a[124:127], v[236:239]
    ds_read_b128 a[220:223], v243 offset:3200
    v_mul_u32_u24 v251, 24, v231
    v_mfma_f32_16x16x32_bf16 v[236:239], a[224:227], a[128:131], v[236:239]
    ds_read_b128 a[224:227], v242 offset:3328
    v_cvt_pk_bf16_f32 v54, v232, v233
    v_mfma_f32_16x16x32_bf16 v[236:239], a[228:231], a[132:135], v[236:239]
    ds_read_b128 a[228:231], v243 offset:3328
    v_cvt_pk_bf16_f32 v57, v234, v235
    v_mfma_f32_16x16x32_bf16 v[236:239], a[232:235], a[136:139], v[236:239]
    s_waitcnt lgkmcnt(4)
    v_lshrrev_b32 v231, 3, v230
    v_lshl_add_u32 v251, v231, 2, v251
    v_mfma_f32_16x16x32_bf16 v[216:219], v[54:57], v[188:191], v[216:219]
    v_and_or_b32 v251, v230, 3, v251
    v_mad_u32_u24 v251, v251, 3, v229
    v_mfma_f32_16x16x32_bf16 v[208:211], v[90:93], v[174:177], v[208:211]
    ds_read_b128 a[232:235], v240 offset:0
    v_and_b32 v231, 1, v228
    v_mfma_f32_16x16x32_bf16 v[208:211], v[92:95], v[176:179], v[208:211]
    v_lshl_add_u32 v251, v251, 3, v231
    v_lshlrev_b32 v251, 4, v251
    v_mfma_f32_16x16x32_bf16 v[204:207], v[138:141], v[168:171], v[204:207]
    v_add_u32 v251, 0xfffff800, v251
    v_cvt_pk_bf16_f32 v184, v196, v197
    v_mfma_f32_16x16x32_bf16 v[204:207], v[140:143], v[170:173], v[204:207]
    v_rcp_f32 v225, v224
    v_mfma_f32_16x16x32_bf16 v[236:239], a[236:239], a[140:143], v[236:239]
    ds_read_b128 a[236:239], v241 offset:0
    v_mul_f32 v212, v212, v225
    v_mfma_f32_16x16x32_bf16 v[232:235], a[144:147], a[240:243], 0
    v_mul_f32 v213, v213, v225
    s_waitcnt lgkmcnt(2)
    v_mfma_f32_16x16x32_bf16 v[232:235], a[148:151], a[244:247], v[232:235]
    s_barrier
    buffer_load_dwordx4 v252, s[12:15], s62 offen lds
    v_mfma_f32_16x16x32_bf16 v[232:235], a[152:155], a[216:219], v[232:235]
    v_cvt_pk_bf16_f32 v84, v236, v237
    v_cvt_pk_bf16_f32 v87, v238, v239
    v_mfma_f32_16x16x32_bf16 v[232:235], a[156:159], a[220:223], v[232:235]
    v_mul_f32 v214, v214, v225
    v_mul_f32 v215, v215, v225
    v_mfma_f32_16x16x32_bf16 v[220:223], v[84:87], v[188:191], v[220:223]
    v_cvt_pk_bf16_f32 v212, v212, v213
    v_cvt_pk_bf16_f32 v213, v214, v215
    v_mfma_f32_16x16x32_bf16 v[232:235], a[160:163], a[224:227], v[232:235]
    buffer_load_dwordx4 v253, s[12:15], s62 offen offset:1024 lds
    v_mul_f32 v216, v216, v225
    v_mfma_f32_16x16x32_bf16 v[232:235], a[164:167], a[228:231], v[232:235]
    ds_write_b64 v247, v[212:213] offset:18432
    v_mfma_f32_16x16x32_bf16 v[212:215], v[18:21], v[192:195], 0
    v_mul_f32 v217, v217, v225
    v_mul_f32 v218, v218, v225
    v_mfma_f32_16x16x32_bf16 v[236:239], a[168:171], a[240:243], 0
    v_mul_f32 v219, v219, v225
    v_cvt_pk_bf16_f32 v216, v216, v217
    v_mfma_f32_16x16x32_bf16 v[236:239], a[172:175], a[244:247], v[236:239]
    buffer_load_dwordx4 v251, s[12:15], s62 offen offset:2048 lds
    s_add_u32 m0, s46, 0x17400
    v_mfma_f32_16x16x32_bf16 v[236:239], a[176:179], a[216:219], v[236:239]
    s_lshl_b32 s62, s28, 5
    v_mul_f32 v232, s38, v232
    v_mul_f32 v233, s38, v233
    v_mfma_f32_16x16x32_bf16 v[236:239], a[180:183], a[220:223], v[236:239]
    s_add_u32 s62, s62, 0x3000
    v_mul_f32 v234, s38, v234
    v_mul_f32 v235, s38, v235
    v_mfma_f32_16x16x32_bf16 v[236:239], a[184:187], a[224:227], v[236:239]
    v_cvt_pk_bf16_f32 v232, v232, v233
    v_cvt_pk_bf16_f32 v233, v234, v235
    v_mfma_f32_16x16x32_bf16 v[236:239], a[188:191], a[228:231], v[236:239]
    buffer_load_dwordx4 v252, s[12:15], s63 offen lds
    v_cvt_pk_bf16_f32 v217, v218, v219
    v_mfma_f32_16x16x32_bf16 v[228:231], a[192:195], a[240:243], 0
    ds_read_b128 a[240:243], v240 offset:128
    v_max3_f32 v248, v248, v224, v225
    v_mfma_f32_16x16x32_bf16 v[228:231], a[196:199], a[244:247], v[228:231]
    ds_read_b128 a[244:247], v241 offset:128
    v_mul_f32 v220, v220, v225
    v_mfma_f32_16x16x32_bf16 v[228:231], a[200:203], a[216:219], v[228:231]
    ds_read_b128 a[216:219], v240 offset:256
    v_mul_f32 v236, s3, v236
    v_mfma_f32_16x16x32_bf16 v[228:231], a[204:207], a[220:223], v[228:231]
    buffer_load_dwordx4 v253, s[12:15], s63 offen offset:1024 lds
    ds_read_b128 a[220:223], v241 offset:256
    v_mfma_f32_16x16x32_bf16 v[228:231], a[208:211], a[224:227], v[228:231]
    ds_write_b64 v247, v[232:233] offset:55296
    v_mfma_f32_16x16x32_bf16 v[228:231], a[212:215], a[228:231], v[228:231]
    s_waitcnt lgkmcnt(5)
    v_mul_f32 v237, s3, v237
    v_mul_f32 v238, s3, v238
    v_mfma_f32_16x16x32_bf16 v[232:235], a[0:3], a[232:235], 0
    v_mul_f32 v239, s3, v239
    v_cvt_pk_bf16_f32 v236, v236, v237
    v_mfma_f32_16x16x32_bf16 v[232:235], a[4:7], a[236:239], v[232:235]
    buffer_load_dwordx4 v251, s[12:15], s63 offen offset:2048 lds
    v_cvt_pk_bf16_f32 v237, v238, v239
    ds_write_b64 v247, v[236:237] offset:55424
    v_mfma_f32_16x16x32_bf16 v[236:239], a[24:27], a[232:235], 0
    s_waitcnt lgkmcnt(5)
    v_mul_f32 v228, s38, v228
    v_mul_f32 v229, s38, v229
    v_mfma_f32_16x16x32_bf16 v[232:235], a[8:11], a[240:243], v[232:235]
    s_waitcnt lgkmcnt(4)
    v_mul_f32 v230, s38, v230
    v_mul_f32 v231, s38, v231
    v_mfma_f32_16x16x32_bf16 v[232:235], a[12:15], a[244:247], v[232:235]
    s_waitcnt lgkmcnt(3)
    v_cvt_pk_bf16_f32 v228, v228, v229
    v_cvt_pk_bf16_f32 v229, v230, v231
    v_mfma_f32_16x16x32_bf16 v[232:235], a[16:19], a[216:219], v[232:235]
    s_waitcnt lgkmcnt(2)
    v_mul_f32 v221, v221, v225
    v_mul_f32 v222, v222, v225
    v_mfma_f32_16x16x32_bf16 v[232:235], a[20:23], a[220:223], v[232:235]
    ds_write_b64 v247, v[228:229] offset:55552
    v_mfma_f32_16x16x32_bf16 v[236:239], a[28:31], a[236:239], v[236:239]
    ds_write_b64 v247, v[216:217] offset:18560
    v_mfma_f32_16x16x32_bf16 v[216:219], v[48:51], v[192:195], 0
    s_add_u32 m0, s46, 0x16800
    v_mul_f32 v223, v223, v225
    v_cvt_pk_bf16_f32 v220, v220, v221
    v_mfma_f32_16x16x32_bf16 v[224:227], a[248:251], v[192:195], 0
    s_lshl_b32 s63, s28, 5
    v_cvt_pk_bf16_f32 v126, v232, v233
    v_cvt_pk_bf16_f32 v127, v234, v235
    v_mfma_f32_16x16x32_bf16 v[236:239], a[32:35], a[240:243], v[236:239]
    ds_read_b128 a[224:227], v240 offset:1536
    v_cvt_pk_bf16_f32 v221, v222, v223
    v_mfma_f32_16x16x32_bf16 v[236:239], a[36:39], a[244:247], v[236:239]
    ds_write_b64 v247, v[220:221] offset:18688
    v_mfma_f32_16x16x32_bf16 v[220:223], v[78:81], v[192:195], 0
    s_add_u32 s63, s63, 0x7800
    v_exp_f32 v208, v208
    v_mfma_f32_16x16x32_bf16 v[236:239], a[40:43], a[216:219], v[236:239]
    v_exp_f32 v209, v209
    v_mfma_f32_16x16x32_bf16 v[236:239], a[44:47], a[220:223], v[236:239]
    v_exp_f32 v210, v210
    v_mfma_f32_16x16x32_bf16 v[228:231], a[48:51], a[232:235], 0
    v_exp_f32 v211, v211
    v_mfma_f32_16x16x32_bf16 v[228:231], a[52:55], a[236:239], v[228:231]
    v_cvt_pk_bf16_f32 v183, v208, v209
    v_cvt_pk_bf16_f32 v186, v210, v211
    v_mfma_f32_16x16x32_bf16 v[228:231], a[56:59], a[240:243], v[228:231]
    ds_read_b128 v[208:211], v245 offset:192
    v_cvt_pk_bf16_f32 v128, v236, v237
    v_mfma_f32_16x16x32_bf16 v[228:231], a[60:63], a[244:247], v[228:231]
    ds_read_b128 a[228:231], v241 offset:1536
    v_cvt_pk_bf16_f32 v129, v238, v239
    v_mfma_f32_16x16x32_bf16 v[228:231], a[64:67], a[216:219], v[228:231]
    v_exp_f32 v200, v200
    v_mfma_f32_16x16x32_bf16 v[228:231], a[68:71], a[220:223], v[228:231]
    v_exp_f32 v201, v201
    v_mfma_f32_16x16x32_bf16 v[232:235], a[232:235], a[72:75], 0
    ds_read_b64 v[174:175], v247 offset:30720
    v_cvt_pk_bf16_f32 v182, v200, v201
    v_mfma_f32_16x16x32_bf16 v[232:235], a[236:239], a[76:79], v[232:235]
    v_exp_f32 v198, v198
    v_mfma_f32_16x16x32_bf16 v[212:215], v[22:25], v[180:183], v[212:215]
    v_exp_f32 v199, v199
    v_mfma_f32_16x16x32_bf16 v[216:219], v[52:55], v[180:183], v[216:219]
    v_cvt_pk_bf16_f32 v130, v228, v229
    v_cvt_pk_bf16_f32 v131, v230, v231
    v_mfma_f32_16x16x32_bf16 v[220:223], v[82:85], v[180:183], v[220:223]
    ds_read_b64 v[176:177], v247 offset:30848
    v_cvt_pk_bf16_f32 v187, v198, v199
    v_mfma_f32_16x16x32_bf16 v[224:227], a[248:251], v[180:183], v[224:227]
    ds_read_b128 v[196:199], v246 offset:192
    ds_read_b64 v[178:179], v247 offset:30976
    v_mfma_f32_16x16x32_bf16 v[232:235], a[240:243], a[80:83], v[232:235]
    v_exp_f32 v202, v202
    v_mfma_f32_16x16x32_bf16 v[232:235], a[244:247], a[84:87], v[232:235]
    v_exp_f32 v203, v203
    v_mfma_f32_16x16x32_bf16 v[232:235], a[216:219], a[88:91], v[232:235]
    v_exp_f32 v204, v204
    v_mfma_f32_16x16x32_bf16 v[232:235], a[220:223], a[92:95], v[232:235]
    v_exp_f32 v205, v205
    v_mfma_f32_16x16x32_bf16 v[236:239], a[232:235], a[96:99], 0
    s_waitcnt lgkmcnt(5)
    v_cvt_pk_bf16_f32 v185, v202, v203
    v_cvt_pk_bf16_f32 v190, v204, v205
    v_mfma_f32_16x16x32_bf16 v[208:211], v[102:105], v[168:171], v[208:211]
    ds_read_b128 v[200:203], v244 offset:256
    v_mfma_f32_16x16x32_bf16 v[212:215], v[26:29], v[184:187], v[212:215]
    v_cvt_pk_bf16_f32 v1, v232, v233
    v_cvt_pk_bf16_f32 v4, v234, v235
    v_mfma_f32_16x16x32_bf16 v[216:219], v[56:59], v[184:187], v[216:219]
    v_exp_f32 v206, v206
    v_mfma_f32_16x16x32_bf16 v[220:223], v[86:89], v[184:187], v[220:223]
    v_exp_f32 v207, v207
    v_mfma_f32_16x16x32_bf16 v[224:227], a[248:251], v[184:187], v[224:227]
    v_cvt_pk_bf16_f32 v193, v206, v207
    v_mov_b32 v187, 0
    v_mfma_f32_16x16x32_bf16 v[208:211], v[104:107], v[170:173], v[208:211]
    ds_read_b128 v[204:207], v245 offset:256
    s_waitcnt vmcnt(3)
    v_mfma_f32_16x16x32_bf16 v[236:239], a[236:239], a[100:103], v[236:239]
    ds_read_b64_tr_b16 a[144:145], v249 offset:0
    ds_read_b64_tr_b16 a[146:147], v250 offset:0
    v_mfma_f32_16x16x32_bf16 v[236:239], a[240:243], a[104:107], v[236:239]
    ds_read_b64_tr_b16 a[168:169], v249 offset:32
    ds_read_b64_tr_b16 a[170:171], v250 offset:32
    v_mfma_f32_16x16x32_bf16 v[236:239], a[244:247], a[108:111], v[236:239]
    ds_read_b64_tr_b16 a[192:193], v249 offset:64
    ds_read_b64_tr_b16 a[194:195], v250 offset:64
    v_mfma_f32_16x16x32_bf16 v[236:239], a[216:219], a[112:115], v[236:239]
    s_waitcnt lgkmcnt(8)
    v_exp_f32 v208, v208
    v_mfma_f32_16x16x32_bf16 v[196:199], v[126:129], v[168:171], v[196:199]
    v_exp_f32 v209, v209
    v_mfma_f32_16x16x32_bf16 v[196:199], v[128:131], v[170:173], v[196:199]
    v_exp_f32 v210, v210
    v_mfma_f32_16x16x32_bf16 v[236:239], a[220:223], a[116:119], v[236:239]
    v_exp_f32 v211, v211
    v_mfma_f32_16x16x32_bf16 v[228:231], a[232:235], a[120:123], 0
    ds_read_b128 a[232:235], v240 offset:1664
    v_cvt_pk_bf16_f32 v188, v208, v209
    v_mfma_f32_16x16x32_bf16 v[228:231], a[236:239], a[124:127], v[228:231]
    ds_read_b128 a[236:239], v241 offset:1664
    v_cvt_pk_bf16_f32 v191, v210, v211
    v_mfma_f32_16x16x32_bf16 v[228:231], a[240:243], a[128:131], v[228:231]
    ds_read_b128 a[240:243], v240 offset:1792
    v_cvt_pk_bf16_f32 v31, v236, v237
    v_mfma_f32_16x16x32_bf16 v[228:231], a[244:247], a[132:135], v[228:231]
    ds_read_b128 a[244:247], v241 offset:1792
    v_cvt_pk_bf16_f32 v34, v238, v239
    v_mfma_f32_16x16x32_bf16 v[228:231], a[216:219], a[136:139], v[228:231]
    s_waitcnt lgkmcnt(4)
    buffer_load_dwordx4 v252, s[12:15], s60 offen lds
    v_mfma_f32_16x16x32_bf16 v[200:203], v[144:147], v[168:171], v[200:203]
    v_rcp_f32 v225, v224
    v_mfma_f32_16x16x32_bf16 v[200:203], v[146:149], v[170:173], v[200:203]
    s_waitcnt vmcnt(1)
    ds_read_b64_tr_b16 a[148:149], v249 offset:3072
    v_mfma_f32_16x16x32_bf16 v[204:207], v[108:111], v[168:171], v[204:207]
    ds_read_b64_tr_b16 a[150:151], v250 offset:3072
    ds_read_b64_tr_b16 a[172:173], v249 offset:3104
    v_mfma_f32_16x16x32_bf16 v[204:207], v[110:113], v[170:173], v[204:207]
    ds_read_b64_tr_b16 a[174:175], v250 offset:3104
    ds_read_b64_tr_b16 a[196:197], v249 offset:3136
    v_mfma_f32_16x16x32_bf16 v[228:231], a[220:223], a[140:143], v[228:231]
    ds_read_b64_tr_b16 a[198:199], v250 offset:3136
    buffer_load_dwordx4 v253, s[12:15], s60 offen offset:1024 lds
    v_mfma_f32_16x16x32_bf16 v[232:235], a[0:3], a[224:227], 0
    v_exp_f32 v196, v196
    v_mfma_f32_16x16x32_bf16 v[232:235], a[4:7], a[228:231], v[232:235]
    s_waitcnt lgkmcnt(9)
    v_exp_f32 v197, v197
    v_mfma_f32_16x16x32_bf16 v[232:235], a[8:11], a[232:235], v[232:235]
    s_waitcnt lgkmcnt(8)
    v_cvt_pk_bf16_f32 v61, v228, v229
    v_cvt_pk_bf16_f32 v64, v230, v231
    v_mfma_f32_16x16x32_bf16 v[232:235], a[12:15], a[236:239], v[232:235]
    s_waitcnt lgkmcnt(7)
    buffer_load_dwordx4 v251, s[12:15], s60 offen offset:2048 lds
    v_mfma_f32_16x16x32_bf16 v[232:235], a[16:19], a[240:243], v[232:235]
    s_waitcnt lgkmcnt(6)
    s_add_u32 m0, s46, 0x17400
    v_mul_f32 v212, v212, v225
    v_mfma_f32_16x16x32_bf16 v[232:235], a[20:23], a[244:247], v[232:235]
    ds_read_b128 v[208:211], v246 offset:256
    v_mul_f32 v213, v213, v225
    v_mfma_f32_16x16x32_bf16 v[236:239], a[24:27], a[224:227], 0
    v_cvt_pk_bf16_f32 v189, v196, v197
    v_mov_b32 v226, 0x22e00
    v_mfma_f32_16x16x32_bf16 v[236:239], a[28:31], a[228:231], v[236:239]
    v_mul_f32 v214, v214, v225
    s_waitcnt lgkmcnt(1)
    v_mfma_f32_16x16x32_bf16 v[236:239], a[32:35], a[232:235], v[236:239]
    buffer_load_dwordx4 v252, s[12:15], s61 offen lds
    v_cvt_pk_bf16_f32 v132, v232, v233
    v_mfma_f32_16x16x32_bf16 v[236:239], a[36:39], a[236:239], v[236:239]
    v_cvt_pk_bf16_f32 v133, v234, v235
    v_mul_f32 v215, v215, v225
    v_mfma_f32_16x16x32_bf16 v[236:239], a[40:43], a[240:243], v[236:239]
    v_cvt_pk_bf16_f32 v212, v212, v213
    v_cndmask_b32 v226, v226, v247, vcc
    v_mfma_f32_16x16x32_bf16 v[236:239], a[44:47], a[244:247], v[236:239]
    ds_read_b128 a[216:219], v240 offset:3072
    v_cvt_pk_bf16_f32 v213, v214, v215
    v_mfma_f32_16x16x32_bf16 v[228:231], a[48:51], a[224:227], 0
    buffer_load_dwordx4 v253, s[12:15], s61 offen offset:1024 lds
    v_mul_f32 v216, v216, v225
    v_mfma_f32_16x16x32_bf16 v[228:231], a[52:55], a[228:231], v[228:231]
    ds_write_b64 v226, v[212:213] offset:0
    v_mfma_f32_16x16x32_bf16 v[212:215], v[0:3], v[188:191], 0
    s_mov_b32 vcc_lo, 0xff00fff0
    v_cvt_pk_bf16_f32 v134, v236, v237
    v_cvt_pk_bf16_f32 v135, v238, v239
    v_mfma_f32_16x16x32_bf16 v[228:231], a[56:59], a[232:235], v[228:231]
    ds_read_b128 a[220:223], v241 offset:3072
    buffer_load_dwordx4 v251, s[12:15], s61 offen offset:2048 lds
    v_mfma_f32_16x16x32_bf16 v[228:231], a[60:63], a[236:239], v[228:231]
    s_add_u32 m0, s46, 0x16800
    v_mul_f32 v217, v217, v225
    v_mul_f32 v218, v218, v225
    v_mfma_f32_16x16x32_bf16 v[228:231], a[64:67], a[240:243], v[228:231]
    s_mov_b32 vcc_hi, 0xf000
    v_mul_f32 v219, v219, v225
    v_cvt_pk_bf16_f32 v216, v216, v217
    v_mfma_f32_16x16x32_bf16 v[228:231], a[68:71], a[244:247], v[228:231]
    s_waitcnt lgkmcnt(3)
    v_cvt_pk_bf16_f32 v217, v218, v219
    v_mul_f32 v220, v220, v225
    v_mfma_f32_16x16x32_bf16 v[208:211], v[132:135], v[168:171], v[208:211]
    ds_write_b64 v226, v[216:217] offset:128
    v_mfma_f32_16x16x32_bf16 v[216:219], v[30:33], v[188:191], 0
    v_mul_f32 v221, v221, v225
    v_mul_f32 v222, v222, v225
    v_mfma_f32_16x16x32_bf16 v[232:235], a[224:227], a[72:75], 0
    v_cvt_pk_bf16_f32 v136, v228, v229
    v_cvt_pk_bf16_f32 v137, v230, v231
    v_mfma_f32_16x16x32_bf16 v[232:235], a[228:231], a[76:79], v[232:235]
    v_mul_f32 v223, v223, v225
    v_cvt_pk_bf16_f32 v220, v220, v221
    v_mfma_f32_16x16x32_bf16 v[208:211], v[134:137], v[170:173], v[208:211]
    v_cvt_pk_bf16_f32 v221, v222, v223
    v_max3_f32 v248, v248, v224, v225
    v_mfma_f32_16x16x32_bf16 v[232:235], a[232:235], a[80:83], v[232:235]
    ds_write_b64 v226, v[220:221] offset:256
    v_mfma_f32_16x16x32_bf16 v[220:223], v[60:63], v[188:191], 0
    v_exp_f32 v198, v198
    v_mfma_f32_16x16x32_bf16 v[224:227], a[248:251], v[188:191], 0
    v_exp_f32 v199, v199
    v_mfma_f32_16x16x32_bf16 v[232:235], a[236:239], a[84:87], v[232:235]
    v_exp_f32 v200, v200
    v_mfma_f32_16x16x32_bf16 v[232:235], a[240:243], a[88:91], v[232:235]
    v_exp_f32 v201, v201
    v_mfma_f32_16x16x32_bf16 v[232:235], a[244:247], a[92:95], v[232:235]
    v_cvt_pk_bf16_f32 v192, v198, v199
    v_cvt_pk_bf16_f32 v180, v200, v201
    v_mfma_f32_16x16x32_bf16 v[236:239], a[224:227], a[96:99], 0
    ds_read_b128 v[196:199], v244 offset:320
    v_mfma_f32_16x16x32_bf16 v[236:239], a[228:231], a[100:103], v[236:239]
    v_exp_f32 v202, v202
    v_mfma_f32_16x16x32_bf16 v[236:239], a[232:235], a[104:107], v[236:239]
    v_exp_f32 v203, v203
    v_mfma_f32_16x16x32_bf16 v[236:239], a[236:239], a[108:111], v[236:239]
    v_cvt_pk_bf16_f32 v7, v232, v233
    v_cvt_pk_bf16_f32 v10, v234, v235
    v_mfma_f32_16x16x32_bf16 v[236:239], a[240:243], a[112:115], v[236:239]
    s_waitcnt lgkmcnt(2)
    v_exp_f32 v204, v204
    v_mfma_f32_16x16x32_bf16 v[236:239], a[244:247], a[116:119], v[236:239]
    v_exp_f32 v205, v205
    v_mfma_f32_16x16x32_bf16 v[228:231], a[224:227], a[120:123], 0
    ds_read_b128 a[224:227], v240 offset:3200
    v_cvt_pk_bf16_f32 v183, v202, v203
    v_mfma_f32_16x16x32_bf16 v[228:231], a[228:231], a[124:127], v[228:231]
    ds_read_b128 a[228:231], v241 offset:3200
    v_cvt_pk_bf16_f32 v194, v204, v205
    v_mfma_f32_16x16x32_bf16 v[228:231], a[232:235], a[128:131], v[228:231]
    ds_read_b128 a[232:235], v240 offset:3328
    v_cvt_pk_bf16_f32 v37, v236, v237
    v_mfma_f32_16x16x32_bf16 v[228:231], a[236:239], a[132:135], v[228:231]
    ds_read_b128 a[236:239], v241 offset:3328
    v_cvt_pk_bf16_f32 v40, v238, v239
    v_mfma_f32_16x16x32_bf16 v[228:231], a[240:243], a[136:139], v[228:231]
    ds_read_b128 v[200:203], v245 offset:320
    ds_read_b128 a[240:243], v240 offset:4608
    v_mfma_f32_16x16x32_bf16 v[228:231], a[244:247], a[140:143], v[228:231]
    v_exp_f32 v208, v208
    v_mfma_f32_16x16x32_bf16 v[232:235], a[0:3], a[216:219], 0
    v_exp_f32 v209, v209
    v_mfma_f32_16x16x32_bf16 v[232:235], a[4:7], a[220:223], v[232:235]
    ds_read_b128 a[244:247], v241 offset:4608
    v_cvt_pk_bf16_f32 v195, v208, v209
    v_mfma_f32_16x16x32_bf16 v[236:239], a[24:27], a[216:219], 0
    s_waitcnt lgkmcnt(7)
    s_waitcnt lgkmcnt(6)
    v_cvt_pk_bf16_f32 v67, v228, v229
    v_mfma_f32_16x16x32_bf16 v[212:215], v[4:7], v[192:195], v[212:215]
    v_exp_f32 v206, v206
    v_mfma_f32_16x16x32_bf16 v[216:219], v[34:37], v[192:195], v[216:219]
    v_exp_f32 v207, v207
    v_mfma_f32_16x16x32_bf16 v[220:223], v[64:67], v[192:195], v[220:223]
    v_cvt_pk_bf16_f32 v70, v230, v231
    v_cvt_pk_bf16_f32 v181, v206, v207
    v_mfma_f32_16x16x32_bf16 v[224:227], a[248:251], v[192:195], v[224:227]
    ds_read_b128 v[204:207], v246 offset:320
    v_mfma_f32_16x16x32_bf16 v[196:199], v[150:153], v[168:171], v[196:199]
    v_exp_f32 v210, v210
    v_mfma_f32_16x16x32_bf16 v[196:199], v[152:155], v[170:173], v[196:199]
    v_exp_f32 v211, v211
    v_mfma_f32_16x16x32_bf16 v[232:235], a[8:11], a[224:227], v[232:235]
    s_waitcnt lgkmcnt(6)
    v_cvt_pk_bf16_f32 v182, v210, v211
    v_mfma_f32_16x16x32_bf16 v[232:235], a[12:15], a[228:231], v[232:235]
    s_waitcnt lgkmcnt(5)
    ds_read_b128 v[208:211], v244 offset:0
    v_mfma_f32_16x16x32_bf16 v[212:215], v[8:11], v[180:183], v[212:215]
    v_exp_f32 v196, v196
    v_mfma_f32_16x16x32_bf16 v[216:219], v[38:41], v[180:183], v[216:219]
    s_waitcnt lgkmcnt(4)
    v_exp_f32 v197, v197
    v_mfma_f32_16x16x32_bf16 v[220:223], v[68:71], v[180:183], v[220:223]
    s_waitcnt vmcnt(3)
    ds_read_b64_tr_b16 a[152:153], v249 offset:0
    v_mfma_f32_16x16x32_bf16 v[224:227], a[248:251], v[180:183], v[224:227]
    ds_read_b64_tr_b16 a[154:155], v250 offset:0
    ds_read_b64_tr_b16 a[176:177], v249 offset:32
    v_mfma_f32_16x16x32_bf16 v[200:203], v[162:165], v[168:171], v[200:203]
    ds_read_b64_tr_b16 a[178:179], v250 offset:32
    ds_read_b64_tr_b16 a[200:201], v249 offset:64
    v_mfma_f32_16x16x32_bf16 v[200:203], v[164:167], v[170:173], v[200:203]
    ds_read_b64_tr_b16 a[202:203], v250 offset:64
    v_cvt_pk_bf16_f32 v186, v196, v197
    v_mfma_f32_16x16x32_bf16 v[232:235], a[16:19], a[232:235], v[232:235]
    ds_read_b128 v[196:199], v245 offset:0
    v_mfma_f32_16x16x32_bf16 v[232:235], a[20:23], a[236:239], v[232:235]
    v_mfma_f32_16x16x32_bf16 v[236:239], a[28:31], a[220:223], v[236:239]
    v_mfma_f32_16x16x32_bf16 v[236:239], a[32:35], a[224:227], v[236:239]
    v_mfma_f32_16x16x32_bf16 v[236:239], a[36:39], a[228:231], v[236:239]
    v_exp_f32 v200, v200
    v_mfma_f32_16x16x32_bf16 v[236:239], a[40:43], a[232:235], v[236:239]
    v_exp_f32 v201, v201
    v_mfma_f32_16x16x32_bf16 v[236:239], a[44:47], a[236:239], v[236:239]
    v_cvt_pk_bf16_f32 v184, v200, v201
    v_cvt_pk_bf16_f32 v90, v232, v233
    v_mfma_f32_16x16x32_bf16 v[228:231], a[48:51], a[216:219], 0
    ds_read_b128 v[200:203], v246 offset:0
    v_cvt_pk_bf16_f32 v91, v234, v235
    v_mfma_f32_16x16x32_bf16 v[228:231], a[52:55], a[220:223], v[228:231]
    s_waitcnt lgkmcnt(2)
    buffer_load_dwordx4 v252, s[12:15], s62 offen lds
    v_mfma_f32_16x16x32_bf16 v[208:211], v[144:147], v[174:177], v[208:211]
    s_waitcnt vmcnt(1)
    ds_read_b64_tr_b16 a[156:157], v249 offset:3072
    v_mfma_f32_16x16x32_bf16 v[208:211], v[146:149], v[176:179], v[208:211]
    ds_read_b64_tr_b16 a[158:159], v250 offset:3072
    ds_read_b64_tr_b16 a[180:181], v249 offset:3104
    v_mfma_f32_16x16x32_bf16 v[228:231], a[56:59], a[224:227], v[228:231]
    ds_read_b64_tr_b16 a[182:183], v250 offset:3104
    ds_read_b64_tr_b16 a[204:205], v249 offset:3136
    v_mfma_f32_16x16x32_bf16 v[228:231], a[60:63], a[228:231], v[228:231]
    ds_read_b64_tr_b16 a[206:207], v250 offset:3136
    buffer_load_dwordx4 v253, s[12:15], s62 offen offset:1024 lds
    v_mfma_f32_16x16x32_bf16 v[228:231], a[64:67], a[232:235], v[228:231]
    s_waitcnt lgkmcnt(7)
    v_cvt_pk_bf16_f32 v92, v236, v237
    v_cvt_pk_bf16_f32 v93, v238, v239
    v_mfma_f32_16x16x32_bf16 v[196:199], v[108:111], v[174:177], v[196:199]
    v_exp_f32 v208, v208
    v_mfma_f32_16x16x32_bf16 v[204:207], v[90:93], v[168:171], v[204:207]
    v_exp_f32 v209, v209
    v_mfma_f32_16x16x32_bf16 v[196:199], v[110:113], v[176:179], v[196:199]
    buffer_load_dwordx4 v251, s[12:15], s62 offen offset:2048 lds
    v_cvt_pk_bf16_f32 v190, v208, v209
    v_mfma_f32_16x16x32_bf16 v[228:231], a[68:71], a[236:239], v[228:231]
    s_add_u32 m0, s46, 0x17400
    v_exp_f32 v210, v210
    v_mfma_f32_16x16x32_bf16 v[232:235], a[216:219], a[72:75], 0
    v_exp_f32 v211, v211
    v_mfma_f32_16x16x32_bf16 v[232:235], a[220:223], a[76:79], v[232:235]
    ds_read_b64 v[168:169], v247 offset:36864
    v_cvt_pk_bf16_f32 v193, v210, v211
    v_mfma_f32_16x16x32_bf16 v[232:235], a[224:227], a[80:83], v[232:235]
    s_waitcnt lgkmcnt(7)
    s_waitcnt lgkmcnt(1)
    v_cvt_pk_bf16_f32 v94, v228, v229
    v_mfma_f32_16x16x32_bf16 v[200:203], v[132:135], v[174:177], v[200:203]
    buffer_load_dwordx4 v252, s[12:15], s63 offen lds
    v_cvt_pk_bf16_f32 v95, v230, v231
    v_mfma_f32_16x16x32_bf16 v[200:203], v[134:137], v[176:179], v[200:203]
    ds_read_b128 v[208:211], v245 offset:64
    v_mfma_f32_16x16x32_bf16 v[204:207], v[92:95], v[170:173], v[204:207]
    v_exp_f32 v196, v196
    v_mfma_f32_16x16x32_bf16 v[232:235], a[228:231], a[84:87], v[232:235]
    v_exp_f32 v197, v197
    v_mfma_f32_16x16x32_bf16 v[232:235], a[232:235], a[88:91], v[232:235]
    buffer_load_dwordx4 v253, s[12:15], s63 offen offset:1024 lds
    v_cvt_pk_bf16_f32 v188, v196, v197
    v_mfma_f32_16x16x32_bf16 v[232:235], a[236:239], a[92:95], v[232:235]
    v_exp_f32 v198, v198
    v_mfma_f32_16x16x32_bf16 v[236:239], a[216:219], a[96:99], 0
    v_exp_f32 v204, v204
    v_mfma_f32_16x16x32_bf16 v[236:239], a[220:223], a[100:103], v[236:239]
    v_exp_f32 v205, v205
    v_mfma_f32_16x16x32_bf16 v[236:239], a[224:227], a[104:107], v[236:239]
    buffer_load_dwordx4 v251, s[12:15], s63 offen offset:2048 lds
    v_cvt_pk_bf16_f32 v185, v204, v205
    v_mfma_f32_16x16x32_bf16 v[236:239], a[228:231], a[108:111], v[236:239]
    ds_read_b128 v[204:207], v244 offset:64
    v_cvt_pk_bf16_f32 v13, v232, v233
    v_mfma_f32_16x16x32_bf16 v[224:227], a[248:251], v[184:187], v[224:227]
    ds_read_b64 v[170:171], v247 offset:36992
    v_cvt_pk_bf16_f32 v16, v234, v235
    v_mfma_f32_16x16x32_bf16 v[212:215], v[12:15], v[184:187], v[212:215]
    v_exp_f32 v199, v199
    v_mfma_f32_16x16x32_bf16 v[236:239], a[232:235], a[112:115], v[236:239]
    v_exp_f32 v200, v200
    v_mfma_f32_16x16x32_bf16 v[236:239], a[236:239], a[116:119], v[236:239]
    v_exp_f32 v201, v201
    v_mfma_f32_16x16x32_bf16 v[228:231], a[216:219], a[120:123], 0
    ds_read_b128 a[216:219], v240 offset:4736
    v_cvt_pk_bf16_f32 v191, v198, v199
    v_mfma_f32_16x16x32_bf16 v[228:231], a[220:223], a[124:127], v[228:231]
    ds_read_b128 a[220:223], v241 offset:4736
    v_cvt_pk_bf16_f32 v189, v200, v201
    v_mfma_f32_16x16x32_bf16 v[228:231], a[224:227], a[128:131], v[228:231]
    ds_read_b128 a[224:227], v240 offset:4864
    v_cvt_pk_bf16_f32 v43, v236, v237
    v_mfma_f32_16x16x32_bf16 v[228:231], a[228:231], a[132:135], v[228:231]
    ds_read_b128 a[228:231], v241 offset:4864
    v_cvt_pk_bf16_f32 v46, v238, v239
    v_mfma_f32_16x16x32_bf16 v[216:219], v[42:45], v[184:187], v[216:219]
    s_waitcnt lgkmcnt(6)
    v_rcp_f32 v225, v224
    v_mfma_f32_16x16x32_bf16 v[208:211], v[162:165], v[174:177], v[208:211]
    v_mul_f32 v212, v212, v225
    v_mul_f32 v213, v213, v225
    v_mfma_f32_16x16x32_bf16 v[208:211], v[164:167], v[176:179], v[208:211]
    v_mul_f32 v214, v214, v225
    v_mul_f32 v215, v215, v225
    v_mfma_f32_16x16x32_bf16 v[228:231], a[232:235], a[136:139], v[228:231]
    ds_read_b128 v[196:199], v246 offset:64
    v_cvt_pk_bf16_f32 v212, v212, v213
    v_mfma_f32_16x16x32_bf16 v[228:231], a[236:239], a[140:143], v[228:231]
    v_cvt_pk_bf16_f32 v213, v214, v215
    s_waitcnt lgkmcnt(6)
    v_mfma_f32_16x16x32_bf16 v[204:207], v[150:153], v[174:177], v[204:207]
    ds_write_b64 v247, v[212:213] offset:24576
    v_mfma_f32_16x16x32_bf16 v[212:215], v[6:9], v[188:191], 0
    v_mul_f32 v216, v216, v225
    v_mul_f32 v217, v217, v225
    v_mfma_f32_16x16x32_bf16 v[204:207], v[152:155], v[176:179], v[204:207]
    v_cvt_pk_bf16_f32 v73, v228, v229
    v_cvt_pk_bf16_f32 v76, v230, v231
    v_mfma_f32_16x16x32_bf16 v[232:235], a[0:3], a[240:243], 0
    v_mul_f32 v218, v218, v225
    v_mul_f32 v219, v219, v225
    v_mfma_f32_16x16x32_bf16 v[220:223], v[72:75], v[184:187], v[220:223]
    v_cvt_pk_bf16_f32 v216, v216, v217
    v_cvt_pk_bf16_f32 v217, v218, v219
    v_mfma_f32_16x16x32_bf16 v[232:235], a[4:7], a[244:247], v[232:235]
    s_waitcnt lgkmcnt(4)
    v_exp_f32 v202, v202
    v_mfma_f32_16x16x32_bf16 v[232:235], a[8:11], a[216:219], v[232:235]
    ds_write_b64 v247, v[216:217] offset:24704
    v_mfma_f32_16x16x32_bf16 v[216:219], v[36:39], v[188:191], 0
L_h7:
    s_cbranch_execz L_hback
    v_mul_f32 v220, v220, v225
    v_mul_f32 v221, v221, v225
    v_mfma_f32_16x16x32_bf16 v[232:235], a[12:15], a[220:223], v[232:235]
    s_waitcnt lgkmcnt(3)
    v_mul_f32 v222, v222, v225
    v_mul_f32 v223, v223, v225
    v_mfma_f32_16x16x32_bf16 v[232:235], a[16:19], a[224:227], v[232:235]
    v_cvt_pk_bf16_f32 v220, v220, v221
    v_cvt_pk_bf16_f32 v221, v222, v223
    v_mfma_f32_16x16x32_bf16 v[232:235], a[20:23], a[228:231], v[232:235]
    ds_write_b64 v247, v[220:221] offset:24832
    v_mfma_f32_16x16x32_bf16 v[220:223], v[66:69], v[188:191], 0
    s_waitcnt lgkmcnt(3)
    v_exp_f32 v203, v203
    v_mfma_f32_16x16x32_bf16 v[196:199], v[90:93], v[174:177], v[196:199]
    v_max3_f32 v248, v248, v224, v225
    v_cvt_pk_bf16_f32 v192, v202, v203
    v_mfma_f32_16x16x32_bf16 v[224:227], a[248:251], v[188:191], 0
    v_cvt_pk_bf16_f32 v138, v232, v233
    v_cvt_pk_bf16_f32 v139, v234, v235
    v_mfma_f32_16x16x32_bf16 v[196:199], v[92:95], v[176:179], v[196:199]
    ds_read_b128 v[200:203], v244 offset:128
    ds_read_b64 v[172:173], v247 offset:37120
    v_mfma_f32_16x16x32_bf16 v[236:239], a[24:27], a[240:243], 0
    v_exp_f32 v204, v204
    v_mfma_f32_16x16x32_bf16 v[236:239], a[28:31], a[244:247], v[236:239]
    v_exp_f32 v205, v205
    v_mfma_f32_16x16x32_bf16 v[236:239], a[32:35], a[216:219], v[236:239]
    v_exp_f32 v206, v206
    v_mfma_f32_16x16x32_bf16 v[236:239], a[36:39], a[220:223], v[236:239]
    v_exp_f32 v207, v207
    v_mfma_f32_16x16x32_bf16 v[236:239], a[40:43], a[224:227], v[236:239]
    v_cvt_pk_bf16_f32 v180, v204, v205
    v_cvt_pk_bf16_f32 v183, v206, v207
    v_mfma_f32_16x16x32_bf16 v[236:239], a[44:47], a[228:231], v[236:239]
    ds_read_b128 v[204:207], v245 offset:128
    v_mfma_f32_16x16x32_bf16 v[228:231], a[48:51], a[240:243], 0
    v_exp_f32 v208, v208
    v_mfma_f32_16x16x32_bf16 v[228:231], a[52:55], a[244:247], v[228:231]
    v_exp_f32 v209, v209
    v_mfma_f32_16x16x32_bf16 v[228:231], a[56:59], a[216:219], v[228:231]
    v_exp_f32 v196, v196
    v_mfma_f32_16x16x32_bf16 v[228:231], a[60:63], a[220:223], v[228:231]
    v_cvt_pk_bf16_f32 v140, v236, v237
    v_cvt_pk_bf16_f32 v141, v238, v239
    v_mfma_f32_16x16x32_bf16 v[228:231], a[64:67], a[224:227], v[228:231]
    v_exp_f32 v197, v197
    v_mfma_f32_16x16x32_bf16 v[228:231], a[68:71], a[228:231], v[228:231]
    v_cvt_pk_bf16_f32 v194, v208, v209
    v_cvt_pk_bf16_f32 v195, v196, v197
    v_mfma_f32_16x16x32_bf16 v[232:235], a[240:243], a[72:75], 0
    v_exp_f32 v210, v210
    v_mfma_f32_16x16x32_bf16 v[212:215], v[10:13], v[192:195], v[212:215]
    s_waitcnt lgkmcnt(1)
    v_exp_f32 v211, v211
    v_mfma_f32_16x16x32_bf16 v[216:219], v[40:43], v[192:195], v[216:219]
    v_cvt_pk_bf16_f32 v142, v228, v229
    v_cvt_pk_bf16_f32 v143, v230, v231
    v_mfma_f32_16x16x32_bf16 v[220:223], v[70:73], v[192:195], v[220:223]
    v_exp_f32 v198, v198
    v_mfma_f32_16x16x32_bf16 v[224:227], a[248:251], v[192:195], v[224:227]
    v_exp_f32 v199, v199
    v_mfma_f32_16x16x32_bf16 v[200:203], v[156:159], v[174:177], v[200:203]
    v_cvt_pk_bf16_f32 v181, v210, v211
    v_cvt_pk_bf16_f32 v182, v198, v199
    v_mfma_f32_16x16x32_bf16 v[200:203], v[158:161], v[176:179], v[200:203]
    ds_read_b128 v[208:211], v246 offset:128
    s_waitcnt lgkmcnt(1)
    v_mfma_f32_16x16x32_bf16 v[212:215], v[14:17], v[180:183], v[212:215]
    ds_read_b128 v[196:199], v244 offset:0
    v_mfma_f32_16x16x32_bf16 v[216:219], v[44:47], v[180:183], v[216:219]
    v_mfma_f32_16x16x32_bf16 v[220:223], v[74:77], v[180:183], v[220:223]
    v_mfma_f32_16x16x32_bf16 v[224:227], a[248:251], v[180:183], v[224:227]
    v_mfma_f32_16x16x32_bf16 v[204:207], v[114:117], v[174:177], v[204:207]
    v_exp_f32 v200, v200
    v_mfma_f32_16x16x32_bf16 v[204:207], v[116:119], v[176:179], v[204:207]
    s_waitcnt vmcnt(3)
    ds_read_b64_tr_b16 a[160:161], v249 offset:0
    v_mfma_f32_16x16x32_bf16 v[232:235], a[244:247], a[76:79], v[232:235]
    ds_read_b64_tr_b16 a[162:163], v250 offset:0
    s_waitcnt vmcnt(0)
    v_mfma_f32_16x16x32_bf16 v[232:235], a[216:219], a[80:83], v[232:235]
    ds_read_b64_tr_b16 a[164:165], v249 offset:3072
    ds_read_b64_tr_b16 a[166:167], v250 offset:3072
    v_mfma_f32_16x16x32_bf16 v[232:235], a[220:223], a[84:87], v[232:235]
    ds_read_b64_tr_b16 a[184:185], v249 offset:32
    ds_read_b64_tr_b16 a[186:187], v250 offset:32
    v_mfma_f32_16x16x32_bf16 v[232:235], a[224:227], a[88:91], v[232:235]
    ds_read_b64_tr_b16 a[188:189], v249 offset:3104
    ds_read_b64_tr_b16 a[190:191], v250 offset:3104
    v_mfma_f32_16x16x32_bf16 v[232:235], a[228:231], a[92:95], v[232:235]
    ds_read_b64_tr_b16 a[208:209], v249 offset:64
    ds_read_b64_tr_b16 a[210:211], v250 offset:64
    v_mfma_f32_16x16x32_bf16 v[236:239], a[240:243], a[96:99], 0
    ds_read_b64_tr_b16 a[212:213], v249 offset:3136
    ds_read_b64_tr_b16 a[214:215], v250 offset:3136
    v_mfma_f32_16x16x32_bf16 v[236:239], a[244:247], a[100:103], v[236:239]
    s_waitcnt lgkmcnt(13)
    v_exp_f32 v201, v201
    v_mfma_f32_16x16x32_bf16 v[208:211], v[138:141], v[174:177], v[208:211]
    s_waitcnt lgkmcnt(12)
    v_cvt_pk_bf16_f32 v19, v232, v233
    v_mbcnt_lo_u32_b32 v232, -1, 0
    v_mfma_f32_16x16x32_bf16 v[208:211], v[140:143], v[176:179], v[208:211]
    v_mbcnt_hi_u32_b32 v232, -1, v232
    v_cvt_pk_bf16_f32 v22, v234, v235
    v_mfma_f32_16x16x32_bf16 v[196:199], v[150:153], v[168:171], v[196:199]
    v_and_b32 v233, 15, v232
    v_lshrrev_b32 v232, 4, v232
    v_mfma_f32_16x16x32_bf16 v[196:199], v[152:155], v[170:173], v[196:199]
    v_lshrrev_b32 v234, 1, v233
    v_mul_u32_u24 v235, 0x180, v233
    v_mfma_f32_16x16x32_bf16 v[236:239], a[216:219], a[104:107], v[236:239]
    v_xor_b32 v243, v232, v234
    v_lshl_add_u32 v242, v243, 4, v235
    v_mfma_f32_16x16x32_bf16 v[236:239], a[220:223], a[108:111], v[236:239]
    v_xor_b32 v243, 64, v242
    v_add_u32 v242, 0x1e000, v242
    v_mfma_f32_16x16x32_bf16 v[236:239], a[224:227], a[112:115], v[236:239]
    ds_read_b128 a[232:235], v242 offset:0
    v_add_u32 v243, 0x1e000, v243
    v_mfma_f32_16x16x32_bf16 v[236:239], a[228:231], a[116:119], v[236:239]
    ds_read_b128 a[236:239], v243 offset:0
    v_lshrrev_b32 v249, 1, v232
    v_mfma_f32_16x16x32_bf16 v[228:231], a[240:243], a[120:123], 0
    ds_read_b128 a[240:243], v242 offset:128
    v_or_b32 v249, s66, v249
    v_mfma_f32_16x16x32_bf16 v[228:231], a[244:247], a[124:127], v[228:231]
    ds_read_b128 a[244:247], v243 offset:128
    v_mov_b32 v253, v249
    v_mfma_f32_16x16x32_bf16 v[228:231], a[216:219], a[128:131], v[228:231]
    ds_read_b128 a[216:219], v242 offset:256
    v_cvt_pk_bf16_f32 v49, v236, v237
    v_mfma_f32_16x16x32_bf16 v[228:231], a[220:223], a[132:135], v[228:231]
    ds_read_b128 a[220:223], v243 offset:256
    v_cvt_pk_bf16_f32 v52, v238, v239
    v_mfma_f32_16x16x32_bf16 v[228:231], a[224:227], a[136:139], v[228:231]
    ds_read_b128 a[224:227], v242 offset:6144
    v_xor_b32 v249, v249, v234
    v_mfma_f32_16x16x32_bf16 v[228:231], a[228:231], a[140:143], v[228:231]
    v_lshl_add_u32 v249, v249, 4, v235
    v_and_b32 v235, 1, v232
    v_lshl_add_u32 v249, v235, 3, v249
    v_lshlrev_b32 v235, 3, v235
    s_waitcnt lgkmcnt(6)
    v_mfma_f32_16x16x32_bf16 v[236:239], a[144:147], a[232:235], 0
    s_barrier
    v_xor_b32 v250, s67, v232
    s_waitcnt lgkmcnt(5)
    v_mfma_f32_16x16x32_bf16 v[236:239], a[148:151], a[236:239], v[236:239]
    s_mul_i32 s67, s28, 0x600
    v_cvt_pk_bf16_f32 v79, v228, v229
    s_waitcnt lgkmcnt(4)
    v_mfma_f32_16x16x32_bf16 v[236:239], a[152:155], a[240:243], v[236:239]
    s_add_u32 s67, s67, 0x16800
    v_cvt_pk_bf16_f32 v82, v230, v231
    s_waitcnt lgkmcnt(3)
    v_mfma_f32_16x16x32_bf16 v[236:239], a[156:159], a[244:247], v[236:239]
    v_xor_b32 v252, v233, v235
    s_waitcnt lgkmcnt(2)
    v_mfma_f32_16x16x32_bf16 v[236:239], a[160:163], a[216:219], v[236:239]
    v_xor_b32 v252, v252, v253
    s_waitcnt lgkmcnt(1)
    v_mfma_f32_16x16x32_bf16 v[236:239], a[164:167], a[220:223], v[236:239]
    v_mul_u32_u24 v250, 0x300, v250
    v_mul_u32_u24 v232, 0x180, v232
    v_mfma_f32_16x16x32_bf16 v[228:231], a[168:171], a[232:235], 0
    v_xor_b32 v253, v253, v234
    v_add_u32 v232, s67, v232
    v_mfma_f32_16x16x32_bf16 v[228:231], a[172:175], a[236:239], v[228:231]
    s_lshl2_add_u32 s67, s28, 0x23000
    v_and_b32 v234, 1, v233
    v_lshl_add_u32 v251, v233, 3, v250
    v_mfma_f32_16x16x32_bf16 v[228:231], a[176:179], a[240:243], v[228:231]
    ds_read_b128 a[228:231], v243 offset:6144
    v_lshl_add_u32 v253, v253, 4, v232
    v_mfma_f32_16x16x32_bf16 v[228:231], a[180:183], a[244:247], v[228:231]
    v_xor_b32 v233, v233, v235
    v_lshl_add_u32 v252, v252, 4, v232
    v_mfma_f32_16x16x32_bf16 v[228:231], a[184:187], a[216:219], v[228:231]
    v_lshl_add_u32 v253, v234, 3, v253
    v_lshl_add_u32 v250, v233, 4, v250
    v_mfma_f32_16x16x32_bf16 v[228:231], a[188:191], a[220:223], v[228:231]
    v_cvt_pk_bf16_f32 v236, v236, v237
    v_add_u32 v249, 0x16800, v249
    v_mfma_f32_16x16x32_bf16 v[232:235], a[192:195], a[232:235], 0
    ds_read_b128 a[232:235], v242 offset:6272
    v_cvt_pk_bf16_f32 v237, v238, v239
    v_mfma_f32_16x16x32_bf16 v[232:235], a[196:199], a[236:239], v[232:235]
    ds_read_b128 a[236:239], v243 offset:6272
    v_cvt_pk_bf16_f32 v186, v200, v201
    v_mfma_f32_16x16x32_bf16 v[232:235], a[200:203], a[240:243], v[232:235]
    ds_read_b128 a[240:243], v242 offset:6400
    v_cvt_pk_bf16_f32 v228, v228, v229
    v_mfma_f32_16x16x32_bf16 v[232:235], a[204:207], a[244:247], v[232:235]
    ds_read_b128 a[244:247], v243 offset:6400
    v_cvt_pk_bf16_f32 v229, v230, v231
    v_mfma_f32_16x16x32_bf16 v[232:235], a[208:211], a[216:219], v[232:235]
    ds_write_b64 v249, v[236:237] offset:0
    v_mfma_f32_16x16x32_bf16 v[232:235], a[212:215], a[220:223], v[232:235]
    s_waitcnt lgkmcnt(6)
    v_exp_f32 v204, v204
    v_mfma_f32_16x16x32_bf16 v[236:239], a[144:147], a[224:227], 0
    s_waitcnt lgkmcnt(5)
    v_exp_f32 v205, v205
    v_mfma_f32_16x16x32_bf16 v[236:239], a[148:151], a[228:231], v[236:239]
    ds_write_b64 v249, v[228:229] offset:128
    v_mfma_f32_16x16x32_bf16 v[228:231], a[168:171], a[224:227], 0
    s_waitcnt lgkmcnt(5)
    ds_read_b128 v[200:203], v245 offset:0
    v_mfma_f32_16x16x32_bf16 v[236:239], a[152:155], a[232:235], v[236:239]
    s_waitcnt lgkmcnt(5)
    v_cvt_pk_bf16_f32 v232, v232, v233
    v_cvt_pk_bf16_f32 v184, v204, v205
    v_mfma_f32_16x16x32_bf16 v[236:239], a[156:159], a[236:239], v[236:239]
    s_waitcnt lgkmcnt(4)
    v_exp_f32 v208, v208
    v_mfma_f32_16x16x32_bf16 v[236:239], a[160:163], a[240:243], v[236:239]
    s_waitcnt lgkmcnt(3)
    v_exp_f32 v209, v209
    v_mfma_f32_16x16x32_bf16 v[236:239], a[164:167], a[244:247], v[236:239]
    ds_read_b128 v[204:207], v246 offset:0
    v_cvt_pk_bf16_f32 v233, v234, v235
    v_mfma_f32_16x16x32_bf16 v[228:231], a[172:175], a[228:231], v[228:231]
    ds_write_b64 v249, v[232:233] offset:256
    v_mfma_f32_16x16x32_bf16 v[228:231], a[176:179], a[232:235], v[228:231]
    ds_read_b128 a[216:219], v242 offset:12288
    v_cvt_pk_bf16_f32 v185, v208, v209
    v_mfma_f32_16x16x32_bf16 v[228:231], a[180:183], a[236:239], v[228:231]
    ds_read_b128 a[220:223], v243 offset:12288
    v_cvt_pk_bf16_f32 v236, v236, v237
    v_mfma_f32_16x16x32_bf16 v[212:215], v[18:21], v[184:187], v[212:215]
    ds_read_b128 v[208:211], v244 offset:64
    v_cvt_pk_bf16_f32 v237, v238, v239
    v_mfma_f32_16x16x32_bf16 v[216:219], v[48:51], v[184:187], v[216:219]
    v_exp_f32 v196, v196
    v_mfma_f32_16x16x32_bf16 v[220:223], v[78:81], v[184:187], v[220:223]
    s_waitcnt lgkmcnt(5)
    v_exp_f32 v197, v197
    v_mfma_f32_16x16x32_bf16 v[224:227], a[248:251], v[184:187], v[224:227]
    v_exp_f32 v198, v198
    v_mfma_f32_16x16x32_bf16 v[200:203], v[162:165], v[168:171], v[200:203]
    v_exp_f32 v199, v199
    v_mfma_f32_16x16x32_bf16 v[200:203], v[164:167], v[170:173], v[200:203]
    v_cvt_pk_bf16_f32 v190, v196, v197
    v_cvt_pk_bf16_f32 v193, v198, v199
    v_mfma_f32_16x16x32_bf16 v[228:231], a[184:187], a[240:243], v[228:231]
    ds_read_b128 v[196:199], v245 offset:64
    ds_read_b64 v[174:175], v247 offset:43008
    v_mfma_f32_16x16x32_bf16 v[228:231], a[188:191], a[244:247], v[228:231]
    ds_write_b64 v249, v[236:237] offset:6144
    v_mfma_f32_16x16x32_bf16 v[232:235], a[192:195], a[224:227], 0
    ds_read_b128 a[224:227], v242 offset:12416
    s_waitcnt lgkmcnt(8)
    v_mfma_f32_16x16x32_bf16 v[204:207], v[90:93], v[168:171], v[204:207]
    v_exp_f32 v200, v200
    v_mfma_f32_16x16x32_bf16 v[204:207], v[92:95], v[170:173], v[204:207]
    v_exp_f32 v201, v201
    v_mfma_f32_16x16x32_bf16 v[232:235], a[196:199], a[228:231], v[232:235]
    ds_read_b128 a[228:231], v243 offset:12416
    s_waitcnt lgkmcnt(7)
    v_mfma_f32_16x16x32_bf16 v[232:235], a[200:203], a[232:235], v[232:235]
    ds_read_b128 a[232:235], v242 offset:12544
    v_cvt_pk_bf16_f32 v228, v228, v229
    v_mfma_f32_16x16x32_bf16 v[232:235], a[204:207], a[236:239], v[232:235]
    ds_read_b128 a[236:239], v243 offset:12544
    s_waitcnt lgkmcnt(7)
    v_mfma_f32_16x16x32_bf16 v[208:211], v[156:159], v[168:171], v[208:211]
    v_cvt_pk_bf16_f32 v229, v230, v231
    v_add_u32 v242, 0xfffe9800, v242
    v_mfma_f32_16x16x32_bf16 v[208:211], v[158:161], v[170:173], v[208:211]
    ds_write_b64 v249, v[228:229] offset:6272
    v_mfma_f32_16x16x32_bf16 v[232:235], a[208:211], a[240:243], v[232:235]
    ds_read_b128 a[240:243], v242 offset:6144
    v_add_u32 v243, 0xfffe9800, v243
    v_mfma_f32_16x16x32_bf16 v[232:235], a[212:215], a[244:247], v[232:235]
    ds_read_b128 a[244:247], v243 offset:6144
    v_cvt_pk_bf16_f32 v188, v200, v201
    v_mfma_f32_16x16x32_bf16 v[236:239], a[144:147], a[216:219], 0
    v_exp_f32 v202, v202
    v_mfma_f32_16x16x32_bf16 v[236:239], a[148:151], a[220:223], v[236:239]
    s_waitcnt lgkmcnt(6)
    v_exp_f32 v203, v203
    v_mfma_f32_16x16x32_bf16 v[196:199], v[114:117], v[168:171], v[196:199]
    v_cvt_pk_bf16_f32 v232, v232, v233
    v_cvt_pk_bf16_f32 v191, v202, v203
    v_mfma_f32_16x16x32_bf16 v[196:199], v[116:119], v[170:173], v[196:199]
    ds_read_b128 v[200:203], v246 offset:64
    v_cvt_pk_bf16_f32 v233, v234, v235
    v_mfma_f32_16x16x32_bf16 v[236:239], a[152:155], a[224:227], v[236:239]
    s_waitcnt lgkmcnt(6)
    v_rcp_f32 v225, v224
    v_mfma_f32_16x16x32_bf16 v[236:239], a[156:159], a[228:231], v[236:239]
    s_waitcnt lgkmcnt(5)
    v_exp_f32 v204, v204
    v_mfma_f32_16x16x32_bf16 v[236:239], a[160:163], a[232:235], v[236:239]
    s_waitcnt lgkmcnt(4)
    v_exp_f32 v205, v205
    v_mfma_f32_16x16x32_bf16 v[236:239], a[164:167], a[236:239], v[236:239]
    ds_write_b64 v249, v[232:233] offset:6400
    v_mfma_f32_16x16x32_bf16 v[228:231], a[168:171], a[216:219], 0
    v_mul_f32 v212, v212, v225
    v_mul_f32 v213, v213, v225
    v_mfma_f32_16x16x32_bf16 v[228:231], a[172:175], a[220:223], v[228:231]
    v_cvt_pk_bf16_f32 v189, v204, v205
    v_mul_f32 v214, v214, v225
    v_mfma_f32_16x16x32_bf16 v[228:231], a[176:179], a[224:227], v[228:231]
    v_cvt_pk_bf16_f32 v236, v236, v237
    v_cvt_pk_bf16_f32 v237, v238, v239
    v_mfma_f32_16x16x32_bf16 v[228:231], a[180:183], a[228:231], v[228:231]
    ds_write_b64 v249, v[236:237] offset:12288
    v_mfma_f32_16x16x32_bf16 v[228:231], a[184:187], a[232:235], v[228:231]
    s_waitcnt lgkmcnt(3)
    v_mul_f32 v215, v215, v225
    v_cvt_pk_bf16_f32 v212, v212, v213
    v_mfma_f32_16x16x32_bf16 v[228:231], a[188:191], a[236:239], v[228:231]
    v_cvt_pk_bf16_f32 v213, v214, v215
    v_mul_f32 v216, v216, v225
    v_mfma_f32_16x16x32_bf16 v[232:235], a[192:195], a[216:219], 0
    ds_read_b128 a[216:219], v242 offset:6272
    v_mul_f32 v217, v217, v225
    v_mfma_f32_16x16x32_bf16 v[232:235], a[196:199], a[220:223], v[232:235]
    ds_read_b128 a[220:223], v243 offset:6272
    v_mul_f32 v218, v218, v225
    v_mfma_f32_16x16x32_bf16 v[232:235], a[200:203], a[224:227], v[232:235]
    ds_read_b128 a[224:227], v242 offset:6400
    v_mul_f32 v219, v219, v225
    v_mfma_f32_16x16x32_bf16 v[232:235], a[204:207], a[228:231], v[232:235]
    ds_read_b128 a[228:231], v243 offset:6400
    s_waitcnt lgkmcnt(6)
    v_mfma_f32_16x16x32_bf16 v[200:203], v[138:141], v[168:171], v[200:203]
    ds_write_b64 v247, v[212:213] offset:30720
    v_mfma_f32_16x16x32_bf16 v[212:215], v[12:15], v[188:191], 0
    v_cvt_pk_bf16_f32 v216, v216, v217
    v_cvt_pk_bf16_f32 v217, v218, v219
    v_mfma_f32_16x16x32_bf16 v[200:203], v[140:143], v[170:173], v[200:203]
    ds_write_b64 v247, v[216:217] offset:30848
    v_mfma_f32_16x16x32_bf16 v[216:219], v[42:45], v[188:191], 0
    v_cvt_pk_bf16_f32 v228, v228, v229
    v_cvt_pk_bf16_f32 v229, v230, v231
    v_mfma_f32_16x16x32_bf16 v[232:235], a[208:211], a[232:235], v[232:235]
    ds_write_b64 v249, v[228:229] offset:12416
    v_mfma_f32_16x16x32_bf16 v[232:235], a[212:215], a[236:239], v[232:235]
    v_max3_f32 v248, v248, v224, v225
    v_mul_f32 v220, v220, v225
    v_mfma_f32_16x16x32_bf16 v[236:239], a[144:147], a[240:243], 0
    v_mul_f32 v221, v221, v225
    v_mul_f32 v222, v222, v225
    v_mfma_f32_16x16x32_bf16 v[236:239], a[148:151], a[244:247], v[236:239]
    s_waitcnt lgkmcnt(6)
    v_mul_f32 v223, v223, v225
    v_cvt_pk_bf16_f32 v220, v220, v221
    v_mfma_f32_16x16x32_bf16 v[224:227], a[248:251], v[188:191], 0
    ds_read_b128 a[232:235], v240 offset:6144
    v_cvt_pk_bf16_f32 v221, v222, v223
    v_mfma_f32_16x16x32_bf16 v[236:239], a[152:155], a[216:219], v[236:239]
    s_waitcnt lgkmcnt(6)
    v_cvt_pk_bf16_f32 v232, v232, v233
    v_cvt_pk_bf16_f32 v233, v234, v235
    v_mfma_f32_16x16x32_bf16 v[236:239], a[156:159], a[220:223], v[236:239]
    s_waitcnt lgkmcnt(5)
    v_exp_f32 v206, v206
    v_mfma_f32_16x16x32_bf16 v[236:239], a[160:163], a[224:227], v[236:239]
    s_waitcnt lgkmcnt(4)
    v_exp_f32 v207, v207
    v_mfma_f32_16x16x32_bf16 v[236:239], a[164:167], a[228:231], v[236:239]
    ds_write_b64 v247, v[220:221] offset:30976
    v_mfma_f32_16x16x32_bf16 v[220:223], v[72:75], v[188:191], 0
    ds_read_b128 a[236:239], v241 offset:6144
    v_cvt_pk_bf16_f32 v192, v206, v207
    v_mfma_f32_16x16x32_bf16 v[228:231], a[168:171], a[240:243], 0
    ds_write_b64 v249, v[232:233] offset:12544
    v_mfma_f32_16x16x32_bf16 v[228:231], a[172:175], a[244:247], v[228:231]
    ds_read_b128 v[204:207], v244 offset:128
    v_cvt_pk_bf16_f32 v236, v236, v237
    v_mfma_f32_16x16x32_bf16 v[228:231], a[176:179], a[216:219], v[228:231]
    ds_read_b64 v[176:177], v247 offset:43136
    v_cvt_pk_bf16_f32 v237, v238, v239
    v_mfma_f32_16x16x32_bf16 v[228:231], a[180:183], a[220:223], v[228:231]
    ds_write_b64 v249, v[236:237] offset:18432
    v_mfma_f32_16x16x32_bf16 v[228:231], a[184:187], a[224:227], v[228:231]
    v_exp_f32 v196, v196
    v_mfma_f32_16x16x32_bf16 v[228:231], a[188:191], a[228:231], v[228:231]
    v_exp_f32 v197, v197
    v_mfma_f32_16x16x32_bf16 v[232:235], a[192:195], a[240:243], 0
    ds_read_b128 a[240:243], v240 offset:6272
    s_waitcnt lgkmcnt(7)
    v_mfma_f32_16x16x32_bf16 v[232:235], a[196:199], a[244:247], v[232:235]
    ds_read_b128 a[244:247], v241 offset:6272
    v_cvt_pk_bf16_f32 v194, v196, v197
    v_mfma_f32_16x16x32_bf16 v[232:235], a[200:203], a[216:219], v[232:235]
    ds_read_b128 a[216:219], v240 offset:6400
    v_cvt_pk_bf16_f32 v228, v228, v229
    v_mfma_f32_16x16x32_bf16 v[232:235], a[204:207], a[220:223], v[232:235]
    ds_read_b128 a[220:223], v241 offset:6400
    v_cvt_pk_bf16_f32 v229, v230, v231
    v_mfma_f32_16x16x32_bf16 v[232:235], a[208:211], a[224:227], v[232:235]
    ds_write_b64 v249, v[228:229] offset:18560
    v_mfma_f32_16x16x32_bf16 v[232:235], a[212:215], a[228:231], v[232:235]
    v_exp_f32 v200, v200
    v_mfma_f32_16x16x32_bf16 v[236:239], a[0:3], a[232:235], 0
    s_waitcnt lgkmcnt(9)
    v_exp_f32 v201, v201
    v_mfma_f32_16x16x32_bf16 v[236:239], a[4:7], a[236:239], v[236:239]
    ds_read_b64 v[178:179], v247 offset:43264
    v_cvt_pk_bf16_f32 v195, v200, v201
    v_mfma_f32_16x16x32_bf16 v[228:231], a[24:27], a[232:235], 0
    s_waitcnt lgkmcnt(5)
    v_exp_f32 v208, v208
    v_mfma_f32_16x16x32_bf16 v[212:215], v[16:19], v[192:195], v[212:215]
    s_barrier
    v_exp_f32 v209, v209
    v_mfma_f32_16x16x32_bf16 v[216:219], v[46:49], v[192:195], v[216:219]
    v_exp_f32 v210, v210
    v_mfma_f32_16x16x32_bf16 v[220:223], v[76:79], v[192:195], v[220:223]
    v_exp_f32 v211, v211
    v_mfma_f32_16x16x32_bf16 v[224:227], a[248:251], v[192:195], v[224:227]
    v_cvt_pk_bf16_f32 v180, v208, v209
    v_cvt_pk_bf16_f32 v183, v210, v211
    v_mfma_f32_16x16x32_bf16 v[204:207], v[96:99], v[168:171], v[204:207]
    ds_read_b128 v[208:211], v245 offset:128
    v_cvt_pk_bf16_f32 v232, v232, v233
    v_mfma_f32_16x16x32_bf16 v[204:207], v[98:101], v[170:173], v[204:207]
    ds_read_b128 a[224:227], v242 offset:12288
    v_cvt_pk_bf16_f32 v233, v234, v235
    v_mfma_f32_16x16x32_bf16 v[236:239], a[8:11], a[240:243], v[236:239]
    s_waitcnt lgkmcnt(5)
    v_exp_f32 v198, v198
    v_mfma_f32_16x16x32_bf16 v[236:239], a[12:15], a[244:247], v[236:239]
    ds_write_b64 v249, v[232:233] offset:18688
    v_mfma_f32_16x16x32_bf16 v[236:239], a[16:19], a[216:219], v[236:239]
    s_waitcnt lgkmcnt(5)
    v_exp_f32 v199, v199
    v_mfma_f32_16x16x32_bf16 v[236:239], a[20:23], a[220:223], v[236:239]
    ds_read_b128 a[228:231], v243 offset:12288
    v_cvt_pk_bf16_f32 v181, v198, v199
    v_mfma_f32_16x16x32_bf16 v[228:231], a[28:31], a[236:239], v[228:231]
    ds_read_b128 v[196:199], v246 offset:128
    ds_read_b128 a[252:255], v252 offset:0
    v_mfma_f32_16x16x32_bf16 v[228:231], a[32:35], a[240:243], v[228:231]
    v_exp_f32 v202, v202
    v_mfma_f32_16x16x32_bf16 v[228:231], a[36:39], a[244:247], v[228:231]
    v_exp_f32 v203, v203
    v_mfma_f32_16x16x32_bf16 v[228:231], a[40:43], a[216:219], v[228:231]
    v_cvt_pk_bf16_f32 v182, v202, v203
    v_cvt_pk_bf16_f32 v144, v236, v237
    v_mfma_f32_16x16x32_bf16 v[228:231], a[44:47], a[220:223], v[228:231]
    ds_read_b128 v[200:203], v244 offset:0
    v_cvt_pk_bf16_f32 v145, v238, v239
    v_mfma_f32_16x16x32_bf16 v[212:215], v[20:23], v[180:183], v[212:215]
    v_exp_f32 v204, v204
    v_mfma_f32_16x16x32_bf16 v[216:219], v[50:53], v[180:183], v[216:219]
    v_exp_f32 v205, v205
    v_mfma_f32_16x16x32_bf16 v[220:223], v[80:83], v[180:183], v[220:223]
    s_waitcnt lgkmcnt(6)
    v_cvt_pk_bf16_f32 v146, v228, v229
    v_cvt_pk_bf16_f32 v147, v230, v231
    v_mfma_f32_16x16x32_bf16 v[224:227], a[248:251], v[180:183], v[224:227]
    ds_read_b64 v[254:255], v253 offset:256
    v_cvt_pk_bf16_f32 v186, v204, v205
    v_mfma_f32_16x16x32_bf16 v[208:211], v[120:123], v[168:171], v[208:211]
    ds_read_b128 v[204:207], v245 offset:0
    v_mfma_f32_16x16x32_bf16 v[208:211], v[122:125], v[170:173], v[208:211]
    v_mfma_f32_16x16x32_bf16 v[232:235], a[48:51], a[232:235], 0
    v_mfma_f32_16x16x32_bf16 v[232:235], a[52:55], a[236:239], v[232:235]
    v_mfma_f32_16x16x32_bf16 v[232:235], a[56:59], a[240:243], v[232:235]
    s_waitcnt lgkmcnt(4)
    v_mfma_f32_16x16x32_bf16 v[196:199], v[144:147], v[168:171], v[196:199]
    ds_read_b64 v[168:169], v247 offset:49152
    s_waitcnt lgkmcnt(4)
    v_mfma_f32_16x16x32_bf16 v[232:235], a[60:63], a[244:247], v[232:235]
    v_exp_f32 v208, v208
    v_mfma_f32_16x16x32_bf16 v[232:235], a[64:67], a[216:219], v[232:235]
    v_exp_f32 v209, v209
    v_mfma_f32_16x16x32_bf16 v[232:235], a[68:71], a[220:223], v[232:235]
    v_cvt_pk_bf16_f32 v184, v208, v209
    s_waitcnt lgkmcnt(3)
    v_mfma_f32_16x16x32_bf16 v[200:203], v[156:159], v[174:177], v[200:203]
    ds_read_b128 v[208:211], v246 offset:0
    v_mfma_f32_16x16x32_bf16 v[200:203], v[158:161], v[176:179], v[200:203]
    buffer_store_dwordx4 a[252:255], v250, s[20:23], s55 offen nt
    v_mfma_f32_16x16x32_bf16 v[236:239], a[232:235], a[72:75], 0
    v_mfma_f32_16x16x32_bf16 v[236:239], a[236:239], a[76:79], v[236:239]
    s_waitcnt lgkmcnt(3)
    v_cvt_pk_bf16_f32 v148, v232, v233
    v_cvt_pk_bf16_f32 v149, v234, v235
    v_mfma_f32_16x16x32_bf16 v[236:239], a[240:243], a[80:83], v[236:239]
    s_waitcnt lgkmcnt(2)
    v_exp_f32 v200, v200
    v_mfma_f32_16x16x32_bf16 v[196:199], v[146:149], v[170:173], v[196:199]
    v_exp_f32 v201, v201
    v_mfma_f32_16x16x32_bf16 v[204:207], v[114:117], v[174:177], v[204:207]
    v_exp_f32 v202, v202
    v_mfma_f32_16x16x32_bf16 v[204:207], v[116:119], v[176:179], v[204:207]
    v_exp_f32 v203, v203
    v_mfma_f32_16x16x32_bf16 v[236:239], a[244:247], a[84:87], v[236:239]
    v_cvt_pk_bf16_f32 v190, v200, v201
    v_cvt_pk_bf16_f32 v193, v202, v203
    v_mfma_f32_16x16x32_bf16 v[236:239], a[216:219], a[88:91], v[236:239]
    v_exp_f32 v196, v196
    v_mfma_f32_16x16x32_bf16 v[236:239], a[220:223], a[92:95], v[236:239]
    v_exp_f32 v197, v197
    v_mfma_f32_16x16x32_bf16 v[228:231], a[232:235], a[96:99], 0
    ds_read_b128 v[200:203], v245 offset:64
    v_cvt_pk_bf16_f32 v185, v196, v197
    v_mfma_f32_16x16x32_bf16 v[228:231], a[236:239], a[100:103], v[228:231]
    ds_read_b128 v[196:199], v244 offset:64
    s_waitcnt lgkmcnt(2)
    v_mfma_f32_16x16x32_bf16 v[224:227], a[248:251], v[184:187], v[224:227]
    v_cvt_pk_bf16_f32 v25, v236, v237
    v_cvt_pk_bf16_f32 v28, v238, v239
    v_mfma_f32_16x16x32_bf16 v[208:211], v[138:141], v[174:177], v[208:211]
    ds_read_b128 a[252:255], v252 offset:6144
    ds_read_b64 v[170:171], v247 offset:49280
    v_mfma_f32_16x16x32_bf16 v[212:215], v[24:27], v[184:187], v[212:215]
    buffer_store_dwordx2 v[254:255], v251, s[20:23], s55 offen offset:256 nt
    v_mfma_f32_16x16x32_bf16 v[208:211], v[140:143], v[176:179], v[208:211]
    ds_read_b64 v[254:255], v253 offset:6400
    ds_read_b64 v[172:173], v247 offset:49408
    v_mfma_f32_16x16x32_bf16 v[228:231], a[240:243], a[104:107], v[228:231]
    s_mul_i32 s55, s31, 3
    v_rcp_f32 v225, v224
    v_mfma_f32_16x16x32_bf16 v[228:231], a[244:247], a[108:111], v[228:231]
    s_add_u32 s54, s54, s55
    v_exp_f32 v204, v204
    v_mfma_f32_16x16x32_bf16 v[228:231], a[216:219], a[112:115], v[228:231]
    s_add_u32 s54, s54, s32
    v_exp_f32 v205, v205
    v_mfma_f32_16x16x32_bf16 v[228:231], a[220:223], a[116:119], v[228:231]
    s_add_u32 s55, s28, 7
    v_exp_f32 v206, v206
    v_mfma_f32_16x16x32_bf16 v[232:235], a[232:235], a[120:123], 0
    ds_read_b128 a[232:235], v242 offset:12416
    v_mul_f32 v212, v212, v225
    v_mfma_f32_16x16x32_bf16 v[232:235], a[236:239], a[124:127], v[232:235]
    ds_read_b128 a[236:239], v243 offset:12416
    v_mul_f32 v213, v213, v225
    v_mfma_f32_16x16x32_bf16 v[232:235], a[240:243], a[128:131], v[232:235]
    s_waitcnt lgkmcnt(6)
    v_cvt_pk_bf16_f32 v55, v228, v229
    v_cvt_pk_bf16_f32 v58, v230, v231
    v_mfma_f32_16x16x32_bf16 v[196:199], v[96:99], v[174:177], v[196:199]
    ds_read_b128 a[240:243], v242 offset:12544
    v_cvt_pk_bf16_f32 v188, v204, v205
    v_mfma_f32_16x16x32_bf16 v[216:219], v[54:57], v[184:187], v[216:219]
    s_mul_i32 s55, s55, s30
    v_exp_f32 v207, v207
    v_mfma_f32_16x16x32_bf16 v[196:199], v[98:101], v[176:179], v[196:199]
    v_exp_f32 v208, v208
    v_mfma_f32_16x16x32_bf16 v[200:203], v[120:123], v[174:177], v[200:203]
    s_waitcnt lgkmcnt(6)
    v_exp_f32 v209, v209
    v_mfma_f32_16x16x32_bf16 v[200:203], v[122:125], v[176:179], v[200:203]
    v_cvt_pk_bf16_f32 v191, v206, v207
    v_cvt_pk_bf16_f32 v189, v208, v209
    v_mfma_f32_16x16x32_bf16 v[232:235], a[244:247], a[132:135], v[232:235]
    ds_read_b128 a[244:247], v243 offset:12544
    v_mul_f32 v214, v214, v225
    v_mfma_f32_16x16x32_bf16 v[232:235], a[216:219], a[136:139], v[232:235]
    ds_read_b128 a[216:219], v242 offset:18432
    v_mul_f32 v215, v215, v225
    v_mfma_f32_16x16x32_bf16 v[232:235], a[220:223], a[140:143], v[232:235]
    ds_read_b128 a[220:223], v243 offset:18432
    v_cvt_pk_bf16_f32 v212, v212, v213
    v_mfma_f32_16x16x32_bf16 v[236:239], a[144:147], a[224:227], 0
    s_waitcnt lgkmcnt(6)
    v_cvt_pk_bf16_f32 v213, v214, v215
    v_mul_f32 v216, v216, v225
    v_mfma_f32_16x16x32_bf16 v[236:239], a[148:151], a[228:231], v[236:239]
    s_waitcnt lgkmcnt(5)
    v_cvt_pk_bf16_f32 v85, v232, v233
    v_cvt_pk_bf16_f32 v88, v234, v235
    v_mfma_f32_16x16x32_bf16 v[236:239], a[152:155], a[232:235], v[236:239]
    s_waitcnt lgkmcnt(4)
    v_mul_f32 v217, v217, v225
    v_mul_f32 v218, v218, v225
    v_mfma_f32_16x16x32_bf16 v[220:223], v[84:87], v[184:187], v[220:223]
    ds_write_b64 v247, v[212:213] offset:36864
    v_mfma_f32_16x16x32_bf16 v[212:215], v[18:21], v[188:191], 0
    v_mul_f32 v219, v219, v225
    v_cvt_pk_bf16_f32 v216, v216, v217
    v_mfma_f32_16x16x32_bf16 v[236:239], a[156:159], a[236:239], v[236:239]
    s_waitcnt lgkmcnt(4)
    v_cvt_pk_bf16_f32 v217, v218, v219
    v_max3_f32 v248, v248, v224, v225
    v_mfma_f32_16x16x32_bf16 v[236:239], a[160:163], a[240:243], v[236:239]
    s_waitcnt lgkmcnt(3)
    v_mul_f32 v220, v220, v225
    v_mul_f32 v221, v221, v225
    v_mfma_f32_16x16x32_bf16 v[236:239], a[164:167], a[244:247], v[236:239]
    ds_write_b64 v247, v[216:217] offset:36992
    v_mfma_f32_16x16x32_bf16 v[216:219], v[48:51], v[188:191], 0
    v_mul_f32 v222, v222, v225
    v_mul_f32 v223, v223, v225
    v_mfma_f32_16x16x32_bf16 v[224:227], a[248:251], v[188:191], 0
    ds_read_b128 v[204:207], v246 offset:64
    v_cvt_pk_bf16_f32 v220, v220, v221
    v_mfma_f32_16x16x32_bf16 v[228:231], a[168:171], a[224:227], 0
L_h8:
    s_cbranch_execz L_hback
    v_cvt_pk_bf16_f32 v236, v236, v237
    v_cvt_pk_bf16_f32 v237, v238, v239
    v_mfma_f32_16x16x32_bf16 v[228:231], a[172:175], a[228:231], v[228:231]
    ds_write_b64 v249, v[236:237] offset:24576
    v_mfma_f32_16x16x32_bf16 v[228:231], a[176:179], a[232:235], v[228:231]
    s_waitcnt lgkmcnt(4)
    v_cvt_pk_bf16_f32 v221, v222, v223
    v_add_u32 v209, 0xfffff900, v245
    v_mfma_f32_16x16x32_bf16 v[228:231], a[180:183], a[236:239], v[228:231]
    ds_write_b64 v247, v[220:221] offset:37120
    v_mfma_f32_16x16x32_bf16 v[220:223], v[78:81], v[188:191], 0
    buffer_store_dwordx4 a[252:255], v250, s[20:23], s57 offen nt
    v_mfma_f32_16x16x32_bf16 v[228:231], a[184:187], a[240:243], v[228:231]
    v_exp_f32 v210, v210
    v_mfma_f32_16x16x32_bf16 v[228:231], a[188:191], a[244:247], v[228:231]
    ds_read_b128 a[252:255], v252 offset:12288
    v_cndmask_b32 v209, v244, v209, vcc
    v_mfma_f32_16x16x32_bf16 v[232:235], a[192:195], a[224:227], 0
    ds_read_b128 a[224:227], v242 offset:18560
    v_mov_b32 v208, 0x237c0
    v_mfma_f32_16x16x32_bf16 v[232:235], a[196:199], a[228:231], v[232:235]
    ds_read_b128 a[228:231], v243 offset:18560
    v_mov_b32 v186, 0
    v_mfma_f32_16x16x32_bf16 v[232:235], a[200:203], a[232:235], v[232:235]
    ds_read_b128 a[232:235], v242 offset:18688
    v_cvt_pk_bf16_f32 v228, v228, v229
    v_mfma_f32_16x16x32_bf16 v[232:235], a[204:207], a[236:239], v[232:235]
    ds_read_b128 a[236:239], v243 offset:18688
    v_cvt_pk_bf16_f32 v229, v230, v231
    v_mfma_f32_16x16x32_bf16 v[232:235], a[208:211], a[240:243], v[232:235]
    ds_write_b64 v249, v[228:229] offset:24704
    v_mfma_f32_16x16x32_bf16 v[232:235], a[212:215], a[244:247], v[232:235]
    buffer_store_dwordx2 v[254:255], v251, s[20:23], s57 offen offset:256 nt
    v_mfma_f32_16x16x32_bf16 v[236:239], a[144:147], a[216:219], 0
    ds_read_b64 v[254:255], v253 offset:12544
    v_mov_b32 v189, 0
    v_mfma_f32_16x16x32_bf16 v[236:239], a[148:151], a[220:223], v[236:239]
    ds_read_b128 a[240:243], v242 offset:0
    ds_read_b128 a[244:247], v243 offset:0
    v_mfma_f32_16x16x32_bf16 v[228:231], a[168:171], a[216:219], 0
    s_waitcnt lgkmcnt(7)
    v_cvt_pk_bf16_f32 v232, v232, v233
    v_cvt_pk_bf16_f32 v233, v234, v235
    v_mfma_f32_16x16x32_bf16 v[204:207], v[144:147], v[174:177], v[204:207]
    ds_write_b64 v249, v[232:233] offset:24832
    v_mfma_f32_16x16x32_bf16 v[204:207], v[146:149], v[176:179], v[204:207]
    s_mov_b32 vcc_lo, 0xff00ff00
    v_exp_f32 v211, v211
    v_mfma_f32_16x16x32_bf16 v[236:239], a[152:155], a[224:227], v[236:239]
    s_waitcnt lgkmcnt(7)
    v_exp_f32 v200, v200
    v_mfma_f32_16x16x32_bf16 v[236:239], a[156:159], a[228:231], v[236:239]
    s_waitcnt lgkmcnt(6)
    v_exp_f32 v201, v201
    v_mfma_f32_16x16x32_bf16 v[236:239], a[160:163], a[232:235], v[236:239]
    s_waitcnt lgkmcnt(5)
    v_exp_f32 v204, v204
    v_mfma_f32_16x16x32_bf16 v[236:239], a[164:167], a[236:239], v[236:239]
    s_mov_b32 vcc_hi, 0xff00ff00
    v_exp_f32 v205, v205
    v_mfma_f32_16x16x32_bf16 v[228:231], a[172:175], a[220:223], v[228:231]
    s_mul_i32 s57, s31, 7
    v_cvt_pk_bf16_f32 v192, v210, v211
    v_cvt_pk_bf16_f32 v194, v200, v201
    v_mfma_f32_16x16x32_bf16 v[228:231], a[176:179], a[224:227], v[228:231]
    s_add_u32 s56, s56, s57
    v_cvt_pk_bf16_f32 v236, v236, v237
    v_cvt_pk_bf16_f32 v237, v238, v239
    v_mfma_f32_16x16x32_bf16 v[228:231], a[180:183], a[228:231], v[228:231]
    s_add_u32 s56, s56, s32
    v_cvt_pk_bf16_f32 v195, v204, v205
    v_add_u32 v210, 0xc0, v209
    v_mfma_f32_16x16x32_bf16 v[228:231], a[184:187], a[232:235], v[228:231]
    ds_read_b64 v[174:175], v247 offset:55296
    v_add_u32 v209, 0x340, v209
    v_mfma_f32_16x16x32_bf16 v[212:215], v[22:25], v[192:195], v[212:215]
    s_waitcnt lgkmcnt(4)
    v_cndmask_b32 v244, v210, v209, vcc
    v_add_u32 v245, 0x700, v244
    v_mfma_f32_16x16x32_bf16 v[216:219], v[52:55], v[192:195], v[216:219]
    s_mov_b32 vcc_lo, 0xf0f0
    v_exp_f32 v202, v202
    v_mfma_f32_16x16x32_bf16 v[220:223], v[82:85], v[192:195], v[220:223]
    s_mov_b32 vcc_hi, 0x0
    v_exp_f32 v203, v203
    v_mfma_f32_16x16x32_bf16 v[224:227], a[248:251], v[192:195], v[224:227]
    s_waitcnt lgkmcnt(1)
    s_barrier
    v_cndmask_b32 v244, v244, v208, vcc
    v_mfma_f32_16x16x32_bf16 v[228:231], a[188:191], a[236:239], v[228:231]
    ds_write_b64 v249, v[236:237] offset:0
    v_mfma_f32_16x16x32_bf16 v[232:235], a[192:195], a[216:219], 0
    ds_read_b128 a[216:219], v242 offset:128
    v_cvt_pk_bf16_f32 v181, v202, v203
    v_mfma_f32_16x16x32_bf16 v[232:235], a[196:199], a[220:223], v[232:235]
    ds_read_b128 a[220:223], v243 offset:128
    v_mov_b32 v192, 0
    v_mfma_f32_16x16x32_bf16 v[232:235], a[200:203], a[224:227], v[232:235]
    ds_read_b128 a[224:227], v242 offset:256
    v_cvt_pk_bf16_f32 v228, v228, v229
    v_mfma_f32_16x16x32_bf16 v[232:235], a[204:207], a[228:231], v[232:235]
    ds_read_b128 a[228:231], v243 offset:256
    v_cvt_pk_bf16_f32 v229, v230, v231
    v_mfma_f32_16x16x32_bf16 v[232:235], a[208:211], a[232:235], v[232:235]
    ds_write_b64 v249, v[228:229] offset:128
    v_mfma_f32_16x16x32_bf16 v[232:235], a[212:215], a[236:239], v[232:235]
    s_mov_b32 vcc_lo, 0x0
    v_exp_f32 v196, v196
    v_mfma_f32_16x16x32_bf16 v[236:239], a[144:147], a[240:243], 0
    s_mov_b32 vcc_hi, 0xf0f0000
    v_cndmask_b32 v245, v245, v208, vcc
    v_mov_b32 v195, 0
    v_mfma_f32_16x16x32_bf16 v[236:239], a[148:151], a[244:247], v[236:239]
    ds_read_b128 v[208:211], v244 offset:0
    v_cvt_pk_bf16_f32 v232, v232, v233
    v_mfma_f32_16x16x32_bf16 v[228:231], a[168:171], a[240:243], 0
    s_waitcnt lgkmcnt(5)
    v_exp_f32 v197, v197
    v_mfma_f32_16x16x32_bf16 v[236:239], a[152:155], a[216:219], v[236:239]
    s_waitcnt lgkmcnt(4)
    v_cvt_pk_bf16_f32 v233, v234, v235
    v_cvt_pk_bf16_f32 v180, v196, v197
    v_mfma_f32_16x16x32_bf16 v[236:239], a[156:159], a[220:223], v[236:239]
    s_waitcnt lgkmcnt(3)
    v_exp_f32 v198, v198
    v_mfma_f32_16x16x32_bf16 v[236:239], a[160:163], a[224:227], v[236:239]
    s_waitcnt lgkmcnt(2)
    v_exp_f32 v199, v199
    v_mfma_f32_16x16x32_bf16 v[236:239], a[164:167], a[228:231], v[236:239]
    ds_read_b128 v[200:203], v244 offset:64
    v_cvt_pk_bf16_f32 v183, v198, v199
    v_mfma_f32_16x16x32_bf16 v[228:231], a[172:175], a[244:247], v[228:231]
    ds_write_b64 v249, v[232:233] offset:256
    v_mfma_f32_16x16x32_bf16 v[228:231], a[176:179], a[216:219], v[228:231]
    s_mov_b32 vcc_lo, 0xff000f
    v_exp_f32 v206, v206
    v_mfma_f32_16x16x32_bf16 v[228:231], a[180:183], a[220:223], v[228:231]
    s_mov_b32 vcc_hi, 0xff00ff
    v_exp_f32 v207, v207
    v_mfma_f32_16x16x32_bf16 v[228:231], a[184:187], a[224:227], v[228:231]
    ds_read_b128 v[196:199], v245 offset:0
    v_cvt_pk_bf16_f32 v182, v206, v207
    v_mfma_f32_16x16x32_bf16 v[228:231], a[188:191], a[228:231], v[228:231]
    ds_read_b128 v[204:207], v245 offset:64
    v_cvt_pk_bf16_f32 v236, v236, v237
    v_mfma_f32_16x16x32_bf16 v[212:215], v[26:29], v[180:183], v[212:215]
    ds_read_b128 a[232:235], v242 offset:24576
    v_cvt_pk_bf16_f32 v237, v238, v239
    v_mfma_f32_16x16x32_bf16 v[216:219], v[56:59], v[180:183], v[216:219]
    ds_read_b128 a[236:239], v243 offset:24576
    ds_read_b64 v[176:177], v247 offset:55424
    v_mfma_f32_16x16x32_bf16 v[220:223], v[86:89], v[180:183], v[220:223]
    s_waitcnt lgkmcnt(7)
    v_cvt_pk_bf16_f32 v228, v228, v229
    v_cvt_pk_bf16_f32 v229, v230, v231
    v_mfma_f32_16x16x32_bf16 v[224:227], a[248:251], v[180:183], v[224:227]
    ds_write_b64 v249, v[236:237] offset:6144
    v_mfma_f32_16x16x32_bf16 v[208:211], v[102:105], v[168:171], v[208:211]
    ds_write_b64 v249, v[228:229] offset:6272
    v_mfma_f32_16x16x32_bf16 v[208:211], v[104:107], v[170:173], v[208:211]
    buffer_store_dwordx4 a[252:255], v250, s[20:23], s52 offen nt
    v_mfma_f32_16x16x32_bf16 v[232:235], a[192:195], a[240:243], 0
    s_waitcnt lgkmcnt(8)
    ds_read_b128 a[240:243], v242 offset:24704
    v_mfma_f32_16x16x32_bf16 v[200:203], v[108:111], v[168:171], v[200:203]
    s_add_u32 s57, s28, 11
    v_rcp_f32 v225, v224
    v_mfma_f32_16x16x32_bf16 v[200:203], v[110:113], v[170:173], v[200:203]
    s_mul_i32 s57, s57, s30
    v_exp_f32 v208, v208
    v_mfma_f32_16x16x32_bf16 v[232:235], a[196:199], a[244:247], v[232:235]
    s_waitcnt lgkmcnt(7)
    ds_read_b128 a[244:247], v243 offset:24704
    v_mfma_f32_16x16x32_bf16 v[196:199], v[126:129], v[168:171], v[196:199]
    v_exp_f32 v209, v209
    v_mfma_f32_16x16x32_bf16 v[196:199], v[128:131], v[170:173], v[196:199]
    s_waitcnt lgkmcnt(7)
    v_exp_f32 v210, v210
    v_mfma_f32_16x16x32_bf16 v[204:207], v[132:135], v[168:171], v[204:207]
    s_waitcnt lgkmcnt(6)
    v_exp_f32 v211, v211
    v_mfma_f32_16x16x32_bf16 v[204:207], v[134:137], v[170:173], v[204:207]
    v_cvt_pk_bf16_f32 v184, v208, v209
    v_cvt_pk_bf16_f32 v187, v210, v211
    v_mfma_f32_16x16x32_bf16 v[232:235], a[200:203], a[216:219], v[232:235]
    ds_read_b128 a[216:219], v242 offset:24832
    v_mul_f32 v212, v212, v225
    v_mfma_f32_16x16x32_bf16 v[232:235], a[204:207], a[220:223], v[232:235]
    ds_read_b128 a[220:223], v243 offset:24832
    v_mul_f32 v213, v213, v225
    v_mfma_f32_16x16x32_bf16 v[232:235], a[208:211], a[224:227], v[232:235]
    ds_read_b128 v[208:211], v244 offset:128
    v_mul_f32 v214, v214, v225
    v_mfma_f32_16x16x32_bf16 v[232:235], a[212:215], a[228:231], v[232:235]
    v_exp_f32 v196, v196
    v_mfma_f32_16x16x32_bf16 v[236:239], a[144:147], a[232:235], 0
    s_waitcnt lgkmcnt(5)
    v_exp_f32 v197, v197
    v_mfma_f32_16x16x32_bf16 v[236:239], a[148:151], a[236:239], v[236:239]
    s_waitcnt lgkmcnt(4)
    v_cvt_pk_bf16_f32 v185, v196, v197
    v_mul_f32 v215, v215, v225
    v_mfma_f32_16x16x32_bf16 v[236:239], a[152:155], a[240:243], v[236:239]
    s_waitcnt lgkmcnt(3)
    v_cvt_pk_bf16_f32 v212, v212, v213
    v_cvt_pk_bf16_f32 v213, v214, v215
    v_mfma_f32_16x16x32_bf16 v[236:239], a[156:159], a[244:247], v[236:239]
    ds_write_b64 v247, v[212:213] offset:43008
    v_mfma_f32_16x16x32_bf16 v[212:215], v[0:3], v[184:187], 0
    s_waitcnt lgkmcnt(3)
    v_mul_f32 v216, v216, v225
    v_mul_f32 v217, v217, v225
    v_mfma_f32_16x16x32_bf16 v[236:239], a[160:163], a[216:219], v[236:239]
    s_waitcnt lgkmcnt(2)
    v_mul_f32 v218, v218, v225
    v_mul_f32 v219, v219, v225
    v_mfma_f32_16x16x32_bf16 v[236:239], a[164:167], a[220:223], v[236:239]
    ds_read_b128 a[224:227], v242 offset:30720
    v_cvt_pk_bf16_f32 v216, v216, v217
    v_mfma_f32_16x16x32_bf16 v[228:231], a[168:171], a[232:235], 0
    v_cvt_pk_bf16_f32 v217, v218, v219
    v_cvt_pk_bf16_f32 v232, v232, v233
    v_mfma_f32_16x16x32_bf16 v[228:231], a[172:175], a[236:239], v[228:231]
    ds_write_b64 v247, v[216:217] offset:43136
    v_mfma_f32_16x16x32_bf16 v[216:219], v[30:33], v[184:187], 0
    ds_read_b128 a[228:231], v243 offset:30720
    v_cvt_pk_bf16_f32 v233, v234, v235
    v_mfma_f32_16x16x32_bf16 v[228:231], a[176:179], a[240:243], v[228:231]
    ds_write_b64 v249, v[232:233] offset:6400
    v_mfma_f32_16x16x32_bf16 v[228:231], a[180:183], a[244:247], v[228:231]
    s_waitcnt lgkmcnt(5)
    v_mul_f32 v220, v220, v225
    v_mul_f32 v221, v221, v225
    v_mfma_f32_16x16x32_bf16 v[208:211], v[162:165], v[168:171], v[208:211]
    v_mul_f32 v222, v222, v225
    v_mul_f32 v223, v223, v225
    v_mfma_f32_16x16x32_bf16 v[208:211], v[164:167], v[170:173], v[208:211]
    v_cvt_pk_bf16_f32 v220, v220, v221
    v_cvt_pk_bf16_f32 v221, v222, v223
    v_mfma_f32_16x16x32_bf16 v[228:231], a[184:187], a[216:219], v[228:231]
    ds_write_b64 v247, v[220:221] offset:43264
    v_mfma_f32_16x16x32_bf16 v[220:223], v[60:63], v[184:187], 0
    v_max3_f32 v248, v248, v224, v225
    v_cvt_pk_bf16_f32 v236, v236, v237
    v_mfma_f32_16x16x32_bf16 v[224:227], a[248:251], v[184:187], 0
    v_exp_f32 v198, v198
    v_mfma_f32_16x16x32_bf16 v[228:231], a[188:191], a[220:223], v[228:231]
    v_exp_f32 v199, v199
    v_mfma_f32_16x16x32_bf16 v[232:235], a[192:195], a[232:235], 0
    ds_read_b128 a[232:235], v242 offset:30848
    v_cvt_pk_bf16_f32 v188, v198, v199
    v_mfma_f32_16x16x32_bf16 v[232:235], a[196:199], a[236:239], v[232:235]
    ds_read_b128 a[236:239], v243 offset:30848
    ds_read_b128 v[196:199], v245 offset:128
    v_mfma_f32_16x16x32_bf16 v[232:235], a[200:203], a[240:243], v[232:235]
    ds_read_b128 a[240:243], v242 offset:30976
    v_cvt_pk_bf16_f32 v237, v238, v239
    v_mfma_f32_16x16x32_bf16 v[232:235], a[204:207], a[244:247], v[232:235]
    ds_read_b128 a[244:247], v243 offset:30976
    v_cvt_pk_bf16_f32 v228, v228, v229
    v_mfma_f32_16x16x32_bf16 v[232:235], a[208:211], a[216:219], v[232:235]
    ds_write_b64 v249, v[236:237] offset:12288
    v_mfma_f32_16x16x32_bf16 v[232:235], a[212:215], a[220:223], v[232:235]
    s_waitcnt lgkmcnt(7)
    v_cvt_pk_bf16_f32 v229, v230, v231
    v_mov_b32 v182, 0
    v_mfma_f32_16x16x32_bf16 v[236:239], a[144:147], a[224:227], 0
    ds_write_b64 v249, v[228:229] offset:12416
    v_mfma_f32_16x16x32_bf16 v[236:239], a[148:151], a[228:231], v[236:239]
    v_exp_f32 v200, v200
    v_mfma_f32_16x16x32_bf16 v[228:231], a[168:171], a[224:227], 0
    s_waitcnt lgkmcnt(6)
    v_exp_f32 v201, v201
    v_mfma_f32_16x16x32_bf16 v[236:239], a[152:155], a[232:235], v[236:239]
    s_waitcnt lgkmcnt(5)
    v_exp_f32 v204, v204
    v_mfma_f32_16x16x32_bf16 v[236:239], a[156:159], a[236:239], v[236:239]
    s_waitcnt lgkmcnt(4)
    v_exp_f32 v205, v205
    v_mfma_f32_16x16x32_bf16 v[196:199], v[90:93], v[168:171], v[196:199]
    s_waitcnt lgkmcnt(3)
    v_cvt_pk_bf16_f32 v190, v200, v201
    v_cvt_pk_bf16_f32 v191, v204, v205
    v_mfma_f32_16x16x32_bf16 v[196:199], v[92:95], v[170:173], v[196:199]
    v_exp_f32 v202, v202
    v_mfma_f32_16x16x32_bf16 v[212:215], v[4:7], v[188:191], v[212:215]
    v_exp_f32 v203, v203
    v_mfma_f32_16x16x32_bf16 v[216:219], v[34:37], v[188:191], v[216:219]
    v_cvt_pk_bf16_f32 v193, v202, v203
    v_cvt_pk_bf16_f32 v232, v232, v233
    v_mfma_f32_16x16x32_bf16 v[220:223], v[64:67], v[188:191], v[220:223]
    ds_read_b128 v[200:203], v244 offset:192
    v_cvt_pk_bf16_f32 v233, v234, v235
    v_mfma_f32_16x16x32_bf16 v[224:227], a[248:251], v[188:191], v[224:227]
    v_exp_f32 v206, v206
    v_mfma_f32_16x16x32_bf16 v[236:239], a[160:163], a[240:243], v[236:239]
    s_waitcnt lgkmcnt(3)
    v_exp_f32 v207, v207
    v_mfma_f32_16x16x32_bf16 v[236:239], a[164:167], a[244:247], v[236:239]
    ds_read_b128 a[252:255], v252 offset:18432
    v_cvt_pk_bf16_f32 v194, v206, v207
    v_mfma_f32_16x16x32_bf16 v[228:231], a[172:175], a[228:231], v[228:231]
    ds_read_b128 v[204:207], v245 offset:192
    v_mov_b32 v185, 0
    v_mfma_f32_16x16x32_bf16 v[212:215], v[8:11], v[192:195], v[212:215]
    ds_write_b64 v249, v[232:233] offset:12544
    v_mfma_f32_16x16x32_bf16 v[216:219], v[38:41], v[192:195], v[216:219]
    buffer_store_dwordx2 v[254:255], v251, s[20:23], s52 offen offset:256 nt
    v_mfma_f32_16x16x32_bf16 v[220:223], v[68:71], v[192:195], v[220:223]
    ds_read_b64 v[254:255], v253 offset:18688
    v_cvt_pk_bf16_f32 v236, v236, v237
    v_mfma_f32_16x16x32_bf16 v[224:227], a[248:251], v[192:195], v[224:227]
    s_mul_i32 s52, s31, 11
    v_exp_f32 v208, v208
    v_mfma_f32_16x16x32_bf16 v[228:231], a[176:179], a[232:235], v[228:231]
    s_add_u32 s51, s51, s52
    v_exp_f32 v209, v209
    v_mfma_f32_16x16x32_bf16 v[228:231], a[180:183], a[236:239], v[228:231]
    ds_read_b64 v[178:179], v247 offset:55552
    v_cvt_pk_bf16_f32 v180, v208, v209
    v_mfma_f32_16x16x32_bf16 v[228:231], a[184:187], a[240:243], v[228:231]
    s_waitcnt lgkmcnt(5)
    v_add_u32 v208, 0xffffff40, v244
    v_cndmask_b32 v244, v244, v208, vcc
    v_mfma_f32_16x16x32_bf16 v[200:203], v[114:117], v[168:171], v[200:203]
    s_mov_b32 vcc_lo, 0xff00ff
    v_exp_f32 v210, v210
    v_mfma_f32_16x16x32_bf16 v[200:203], v[116:119], v[170:173], v[200:203]
    s_mov_b32 vcc_hi, 0xf000ff
    v_exp_f32 v211, v211
    v_mfma_f32_16x16x32_bf16 v[228:231], a[188:191], a[244:247], v[228:231]
    s_add_u32 s51, s51, s32
    v_add_u32 v209, 0xffffff40, v245
    v_cvt_pk_bf16_f32 v183, v210, v211
    v_mfma_f32_16x16x32_bf16 v[232:235], a[192:195], a[224:227], 0
    ds_read_b128 a[216:219], v242 offset:36864
    v_cndmask_b32 v245, v245, v209, vcc
    v_mfma_f32_16x16x32_bf16 v[232:235], a[196:199], a[228:231], v[232:235]
    s_waitcnt lgkmcnt(4)
    v_exp_f32 v200, v200
    v_mfma_f32_16x16x32_bf16 v[204:207], v[138:141], v[168:171], v[204:207]
    s_add_u32 s52, s28, 11
    v_exp_f32 v201, v201
    v_mfma_f32_16x16x32_bf16 v[204:207], v[140:143], v[170:173], v[204:207]
    ds_read_b128 v[208:211], v244 offset:0
    v_cvt_pk_bf16_f32 v186, v200, v201
    v_mfma_f32_16x16x32_bf16 v[232:235], a[200:203], a[232:235], v[232:235]
    ds_read_b128 v[200:203], v244 offset:64
    v_cvt_pk_bf16_f32 v237, v238, v239
    v_mfma_f32_16x16x32_bf16 v[232:235], a[204:207], a[236:239], v[232:235]
    s_mul_i32 s52, s52, s30
    v_exp_f32 v196, v196
    v_mfma_f32_16x16x32_bf16 v[232:235], a[208:211], a[240:243], v[232:235]
    s_waitcnt lgkmcnt(4)
    v_exp_f32 v197, v197
    v_mfma_f32_16x16x32_bf16 v[232:235], a[212:215], a[244:247], v[232:235]
    v_cvt_pk_bf16_f32 v181, v196, v197
    v_cvt_pk_bf16_f32 v228, v228, v229
    buffer_store_dwordx4 a[252:255], v250, s[20:23], s54 offen nt
    v_mfma_f32_16x16x32_bf16 v[212:215], v[12:15], v[180:183], v[212:215]
    v_exp_f32 v198, v198
    v_mfma_f32_16x16x32_bf16 v[216:219], v[42:45], v[180:183], v[216:219]
    ds_read_b128 a[252:255], v252 offset:24576
    v_cvt_pk_bf16_f32 v229, v230, v231
    v_mfma_f32_16x16x32_bf16 v[220:223], v[72:75], v[180:183], v[220:223]
    buffer_store_dwordx2 v[254:255], v251, s[20:23], s54 offen offset:256 nt
    v_mfma_f32_16x16x32_bf16 v[224:227], a[248:251], v[180:183], v[224:227]
    s_waitcnt lgkmcnt(1)
    ds_read_b64 v[254:255], v253 offset:24832
    v_mfma_f32_16x16x32_bf16 v[208:211], v[162:165], v[174:177], v[208:211]
    s_mul_i32 s54, s31, 15
    v_exp_f32 v199, v199
    v_mfma_f32_16x16x32_bf16 v[208:211], v[164:167], v[176:179], v[208:211]
    ds_read_b128 a[220:223], v243 offset:36864
    v_cvt_pk_bf16_f32 v184, v198, v199
    v_mfma_f32_16x16x32_bf16 v[200:203], v[114:117], v[174:177], v[200:203]
    ds_read_b128 v[196:199], v245 offset:0
    ds_read_b128 a[224:227], v242 offset:36992
    v_mfma_f32_16x16x32_bf16 v[200:203], v[116:119], v[176:179], v[200:203]
    v_exp_f32 v204, v204
    v_exp_f32 v205, v205
    ds_read_b128 a[228:231], v243 offset:36992
    v_cvt_pk_bf16_f32 v187, v204, v205
    ds_read_b128 v[204:207], v245 offset:64
    ds_read_b128 a[232:235], v242 offset:37120
    v_mfma_f32_16x16x32_bf16 v[212:215], v[16:19], v[184:187], v[212:215]
    ds_read_b128 a[236:239], v243 offset:37120
    v_cvt_pk_bf16_f32 v232, v232, v233
    v_mfma_f32_16x16x32_bf16 v[216:219], v[46:49], v[184:187], v[216:219]
    s_waitcnt lgkmcnt(7)
    s_barrier
    v_cvt_pk_bf16_f32 v233, v234, v235
    v_mfma_f32_16x16x32_bf16 v[220:223], v[76:79], v[184:187], v[220:223]
    ds_write_b64 v249, v[236:237] offset:18432
    v_mfma_f32_16x16x32_bf16 v[224:227], a[248:251], v[184:187], v[224:227]
    ds_write_b64 v249, v[228:229] offset:18560
    v_mfma_f32_16x16x32_bf16 v[236:239], a[144:147], a[216:219], 0
    s_waitcnt lgkmcnt(7)
    v_exp_f32 v208, v208
    v_mfma_f32_16x16x32_bf16 v[196:199], v[90:93], v[174:177], v[196:199]
    s_add_u32 s53, s53, s54
    v_exp_f32 v209, v209
    v_mfma_f32_16x16x32_bf16 v[196:199], v[92:95], v[176:179], v[196:199]
    s_add_u32 s53, s53, s32
    v_exp_f32 v210, v210
    v_mfma_f32_16x16x32_bf16 v[236:239], a[148:151], a[220:223], v[236:239]
    s_waitcnt lgkmcnt(4)
    v_exp_f32 v211, v211
    v_mfma_f32_16x16x32_bf16 v[204:207], v[138:141], v[174:177], v[204:207]
    s_add_u32 s54, s28, 11
    v_cvt_pk_bf16_f32 v188, v208, v209
    v_cvt_pk_bf16_f32 v191, v210, v211
    v_mfma_f32_16x16x32_bf16 v[204:207], v[140:143], v[176:179], v[204:207]
    ds_read_b128 v[208:211], v244 offset:128
    v_mov_b32 v190, 0
    v_mfma_f32_16x16x32_bf16 v[236:239], a[152:155], a[224:227], v[236:239]
    buffer_store_dwordx4 a[252:255], v250, s[20:23], s56 offen nt
    v_mfma_f32_16x16x32_bf16 v[236:239], a[156:159], a[228:231], v[236:239]
    s_waitcnt lgkmcnt(4)
    v_exp_f32 v196, v196
    v_mfma_f32_16x16x32_bf16 v[236:239], a[160:163], a[232:235], v[236:239]
    s_waitcnt lgkmcnt(3)
    ds_read_b128 a[252:255], v252 offset:0
    v_mfma_f32_16x16x32_bf16 v[236:239], a[164:167], a[236:239], v[236:239]
    ds_write_b64 v249, v[232:233] offset:18688
    v_mfma_f32_16x16x32_bf16 v[228:231], a[168:171], a[216:219], 0
    s_mul_i32 s54, s54, s30
    v_exp_f32 v197, v197
    v_mfma_f32_16x16x32_bf16 v[228:231], a[172:175], a[220:223], v[228:231]
    v_exp_f32 v198, v198
    v_mfma_f32_16x16x32_bf16 v[228:231], a[176:179], a[224:227], v[228:231]
    v_exp_f32 v199, v199
    v_mfma_f32_16x16x32_bf16 v[228:231], a[180:183], a[228:231], v[228:231]
    v_cvt_pk_bf16_f32 v189, v196, v197
    v_cvt_pk_bf16_f32 v192, v198, v199
    v_mfma_f32_16x16x32_bf16 v[228:231], a[184:187], a[232:235], v[228:231]
    ds_read_b128 v[196:199], v245 offset:128
    v_cvt_pk_bf16_f32 v236, v236, v237
    v_mfma_f32_16x16x32_bf16 v[228:231], a[188:191], a[236:239], v[228:231]
    ds_read_b128 a[240:243], v242 offset:43008
    v_cvt_pk_bf16_f32 v237, v238, v239
    v_mfma_f32_16x16x32_bf16 v[232:235], a[192:195], a[216:219], 0
    ds_read_b128 a[244:247], v243 offset:43008
    v_mov_b32 v193, 0
    v_mfma_f32_16x16x32_bf16 v[232:235], a[196:199], a[220:223], v[232:235]
    s_waitcnt lgkmcnt(5)
    v_rcp_f32 v225, v224
    v_mfma_f32_16x16x32_bf16 v[208:211], v[120:123], v[174:177], v[208:211]
    buffer_store_dwordx2 v[254:255], v251, s[20:23], s56 offen offset:256 nt
    v_mfma_f32_16x16x32_bf16 v[208:211], v[122:125], v[176:179], v[208:211]
    s_waitcnt lgkmcnt(4)
    v_mul_f32 v212, v212, v225
    v_mul_f32 v213, v213, v225
    v_mfma_f32_16x16x32_bf16 v[232:235], a[200:203], a[224:227], v[232:235]
    s_mul_i32 s56, s31, 13
    v_mul_f32 v214, v214, v225
    v_mul_f32 v215, v215, v225
    v_mfma_f32_16x16x32_bf16 v[232:235], a[204:207], a[228:231], v[232:235]
    ds_read_b64 v[254:255], v253 offset:256
    v_cvt_pk_bf16_f32 v212, v212, v213
    v_mfma_f32_16x16x32_bf16 v[232:235], a[208:211], a[232:235], v[232:235]
    buffer_store_dwordx4 a[252:255], v250, s[20:23], s51 offen nt
    v_mfma_f32_16x16x32_bf16 v[232:235], a[212:215], a[236:239], v[232:235]
    s_waitcnt lgkmcnt(3)
    ds_read_b128 a[252:255], v252 offset:6144
    v_mfma_f32_16x16x32_bf16 v[196:199], v[144:147], v[174:177], v[196:199]
    s_add_u32 s55, s55, s56
    v_cvt_pk_bf16_f32 v213, v214, v215
    v_mul_f32 v216, v216, v225
    v_mfma_f32_16x16x32_bf16 v[196:199], v[146:149], v[176:179], v[196:199]
    ds_write_b64 v247, v[212:213] offset:49152
    v_mfma_f32_16x16x32_bf16 v[212:215], v[12:15], v[188:191], 0
    v_mul_f32 v217, v217, v225
    v_mul_f32 v218, v218, v225
    v_mul_f32 v219, v219, v225
    v_cvt_pk_bf16_f32 v216, v216, v217
    v_cvt_pk_bf16_f32 v217, v218, v219
    ds_write_b64 v247, v[216:217] offset:49280
    v_mfma_f32_16x16x32_bf16 v[216:219], v[42:45], v[188:191], 0
    v_mul_f32 v220, v220, v225
    v_mul_f32 v221, v221, v225
    v_mul_f32 v222, v222, v225
    v_mul_f32 v223, v223, v225
    v_cvt_pk_bf16_f32 v220, v220, v221
    v_cvt_pk_bf16_f32 v221, v222, v223
    ds_write_b64 v247, v[220:221] offset:49408
    v_mfma_f32_16x16x32_bf16 v[220:223], v[72:75], v[188:191], 0
    ds_read_b128 a[216:219], v242 offset:43136
    ds_read_b128 a[220:223], v243 offset:43136
    v_max3_f32 v248, v248, v224, v225
    v_mfma_f32_16x16x32_bf16 v[224:227], a[248:251], v[188:191], 0
    ds_write_b64 v249, v[236:237] offset:24576
    s_waitcnt lgkmcnt(6)
    v_mfma_f32_16x16x32_bf16 v[236:239], a[144:147], a[240:243], 0
    s_add_u32 s55, s55, s32
    v_exp_f32 v200, v200
    v_mfma_f32_16x16x32_bf16 v[236:239], a[148:151], a[244:247], v[236:239]
    v_exp_f32 v201, v201
    v_exp_f32 v204, v204
    v_exp_f32 v205, v205
    v_cvt_pk_bf16_f32 v194, v200, v201
    v_cvt_pk_bf16_f32 v195, v204, v205
    s_mov_b32 exec_hi, 0
    buffer_store_dwordx4 a[252:255], v250, s[20:23], s53 offen nt
    s_mov_b32 exec_hi, -1
    ds_read_b128 a[224:227], v242 offset:43264
    v_mfma_f32_16x16x32_bf16 v[212:215], v[16:19], v[192:195], v[212:215]
    s_add_u32 s56, s28, 11
    v_cvt_pk_bf16_f32 v228, v228, v229
    v_cvt_pk_bf16_f32 v232, v232, v233
    v_mfma_f32_16x16x32_bf16 v[216:219], v[46:49], v[192:195], v[216:219]
    s_waitcnt lgkmcnt(3)
    v_cvt_pk_bf16_f32 v229, v230, v231
    v_cvt_pk_bf16_f32 v233, v234, v235
    v_mfma_f32_16x16x32_bf16 v[220:223], v[76:79], v[192:195], v[220:223]
    s_mov_b32 exec_lo, 0
    buffer_store_dwordx4 a[252:255], v250, s[20:23], s55 offen nt
    s_mov_b32 exec_lo, -1
    v_mfma_f32_16x16x32_bf16 v[224:227], a[248:251], v[192:195], v[224:227]
    ds_write_b64 v249, v[228:229] offset:24704
    v_mfma_f32_16x16x32_bf16 v[236:239], a[152:155], a[216:219], v[236:239]
    ds_read_b128 a[252:255], v252 offset:12288
    s_waitcnt lgkmcnt(4)
    v_mfma_f32_16x16x32_bf16 v[236:239], a[156:159], a[220:223], v[236:239]
    buffer_store_dwordx2 v[254:255], v251, s[20:23], s51 offen offset:256 nt
    v_mfma_f32_16x16x32_bf16 v[228:231], a[168:171], a[240:243], 0
    ds_read_b64 v[254:255], v253 offset:6400
    ds_read_b128 a[228:231], v243 offset:43264
    v_mfma_f32_16x16x32_bf16 v[228:231], a[172:175], a[244:247], v[228:231]
    ds_write_b64 v249, v[232:233] offset:24832
    v_mfma_f32_16x16x32_bf16 v[228:231], a[176:179], a[216:219], v[228:231]
    s_waitcnt lgkmcnt(5)
    v_exp_f32 v202, v202
    v_mfma_f32_16x16x32_bf16 v[236:239], a[160:163], a[224:227], v[236:239]
    s_mul_i32 s51, s31, 3
    v_exp_f32 v203, v203
    v_mfma_f32_16x16x32_bf16 v[228:231], a[180:183], a[220:223], v[228:231]
    s_add_u32 s57, s57, s51
    v_exp_f32 v206, v206
    v_mfma_f32_16x16x32_bf16 v[228:231], a[184:187], a[224:227], v[228:231]
    s_add_u32 s57, s57, s32
    v_exp_f32 v207, v207
    v_mfma_f32_16x16x32_bf16 v[232:235], a[192:195], a[240:243], 0
    s_mul_i32 s56, s56, s30
    v_cvt_pk_bf16_f32 v181, v202, v203
    v_cvt_pk_bf16_f32 v182, v206, v207
    v_mfma_f32_16x16x32_bf16 v[232:235], a[196:199], a[244:247], v[232:235]
    s_and_b32 s51, s28, 1
    v_mov_b32 v180, 0
    v_mov_b32 v183, 0
    v_mfma_f32_16x16x32_bf16 v[232:235], a[200:203], a[216:219], v[232:235]
    s_waitcnt lgkmcnt(2)
    v_exp_f32 v208, v208
    v_mfma_f32_16x16x32_bf16 v[212:215], v[20:23], v[180:183], v[212:215]
    s_mov_b32 exec_hi, 0
    buffer_store_dwordx2 v[254:255], v251, s[20:23], s53 offen offset:256 nt
    s_mov_b32 exec_hi, -1
    v_mfma_f32_16x16x32_bf16 v[216:219], v[50:53], v[180:183], v[216:219]
    s_waitcnt lgkmcnt(1)
    s_waitcnt lgkmcnt(0)
    s_barrier
    v_mfma_f32_16x16x32_bf16 v[220:223], v[80:83], v[180:183], v[220:223]
    ds_read_b128 a[232:235], v242 offset:49152
    ds_read_b128 a[236:239], v243 offset:49152
    v_mfma_f32_16x16x32_bf16 v[224:227], a[248:251], v[180:183], v[224:227]
    ds_read_b128 a[240:243], v242 offset:49280
    ds_read_b128 a[244:247], v243 offset:49280
    v_mfma_f32_16x16x32_bf16 v[236:239], a[164:167], a[228:231], v[236:239]
    s_mov_b32 exec_lo, 0
    buffer_store_dwordx2 v[254:255], v251, s[20:23], s55 offen offset:256 nt
    s_mov_b32 exec_lo, -1
    v_mfma_f32_16x16x32_bf16 v[228:231], a[188:191], a[228:231], v[228:231]
    ds_read_b64 v[254:255], v253 offset:12544
    ds_read_b128 a[216:219], v242 offset:49408
    v_mfma_f32_16x16x32_bf16 v[232:235], a[204:207], a[220:223], v[232:235]
    ds_read_b128 a[220:223], v243 offset:49408
    v_mov_b32 v186, 0
    v_mfma_f32_16x16x32_bf16 v[232:235], a[208:211], a[224:227], v[232:235]
    s_mul_i32 s53, s31, 7
    v_exp_f32 v209, v209
    v_mfma_f32_16x16x32_bf16 v[232:235], a[212:215], a[228:231], v[232:235]
    buffer_store_dwordx4 a[252:255], v250, s[20:23], s57 offen nt
    v_exp_f32 v210, v210
    v_exp_f32 v211, v211
    ds_read_b128 a[252:255], v252 offset:18432
    v_exp_f32 v196, v196
    v_exp_f32 v197, v197
    v_exp_f32 v198, v198
    v_exp_f32 v199, v199
    v_cvt_pk_bf16_f32 v184, v208, v209
    v_cvt_pk_bf16_f32 v187, v210, v211
    v_cvt_pk_bf16_f32 v185, v196, v197
    v_cvt_pk_bf16_f32 v188, v198, v199
    v_mov_b32 v189, 0
    v_mfma_f32_16x16x32_bf16 v[212:215], v[24:27], v[184:187], v[212:215]
    s_waitcnt lgkmcnt(3)
    v_mov_b32 v191, 0
    v_cvt_pk_bf16_f32 v236, v236, v237
    v_mfma_f32_16x16x32_bf16 v[216:219], v[54:57], v[184:187], v[216:219]
    s_add_u32 s52, s52, s53
    v_cvt_pk_bf16_f32 v228, v228, v229
    v_cvt_pk_bf16_f32 v232, v232, v233
    v_mfma_f32_16x16x32_bf16 v[220:223], v[84:87], v[184:187], v[220:223]
    buffer_store_dwordx2 v[254:255], v251, s[20:23], s57 offen offset:256 nt
    v_mfma_f32_16x16x32_bf16 v[224:227], a[248:251], v[184:187], v[224:227]
    s_add_u32 s52, s52, s32
    v_cvt_pk_bf16_f32 v237, v238, v239
L_h9:
    s_cbranch_execz L_hback
    v_cvt_pk_bf16_f32 v229, v230, v231
    v_mfma_f32_16x16x32_bf16 v[212:215], v[28:31], v[188:191], v[212:215]
    ds_read_b64 v[254:255], v253 offset:18688
    v_cvt_pk_bf16_f32 v233, v234, v235
    v_mfma_f32_16x16x32_bf16 v[216:219], v[58:61], v[188:191], v[216:219]
    ds_write_b64 v249, v[236:237] offset:0
    v_mfma_f32_16x16x32_bf16 v[220:223], v[88:91], v[188:191], v[220:223]
    ds_write_b64 v249, v[228:229] offset:128
    v_mfma_f32_16x16x32_bf16 v[224:227], a[248:251], v[188:191], v[224:227]
    ds_write_b64 v249, v[232:233] offset:256
    v_mfma_f32_16x16x32_bf16 v[236:239], a[144:147], a[232:235], 0
    s_waitcnt lgkmcnt(4)
    s_mul_i32 s55, s31, 11
    s_add_u32 s54, s54, s55
    v_mfma_f32_16x16x32_bf16 v[236:239], a[148:151], a[236:239], v[236:239]
    buffer_store_dwordx4 a[252:255], v250, s[20:23], s52 offen nt
    v_mfma_f32_16x16x32_bf16 v[236:239], a[152:155], a[240:243], v[236:239]
    s_add_u32 s54, s54, s32
    v_rcp_f32 v225, v224
    v_mfma_f32_16x16x32_bf16 v[236:239], a[156:159], a[244:247], v[236:239]
    s_waitcnt lgkmcnt(3)
    v_max3_f32 v248, v248, v224, v225
    v_mov_b32 v226, 0x5d800000
    v_mfma_f32_16x16x32_bf16 v[236:239], a[160:163], a[216:219], v[236:239]
    s_mul_i32 s57, s31, 15
    v_cmp_gt_f32 vcc, v248, v226
    v_mul_f32 v212, v212, v225
    v_mfma_f32_16x16x32_bf16 v[236:239], a[164:167], a[220:223], v[236:239]
    s_cmp_lg_u64 vcc, 0
    s_cselect_b32 s66, 1, 0
    v_mul_f32 v213, v213, v225
    v_mul_f32 v214, v214, v225
    v_mfma_f32_16x16x32_bf16 v[228:231], a[168:171], a[232:235], 0
    s_add_u32 s56, s56, s57
    v_mul_f32 v215, v215, v225
    v_cvt_pk_bf16_f32 v212, v212, v213
    v_mfma_f32_16x16x32_bf16 v[228:231], a[172:175], a[236:239], v[228:231]
    s_add_u32 s56, s56, s32
    v_mul_f32 v216, v216, v225
    v_mul_f32 v217, v217, v225
    v_mfma_f32_16x16x32_bf16 v[228:231], a[176:179], a[240:243], v[228:231]
    s_add_u32 s51, s51, 15
    v_cvt_pk_bf16_f32 v213, v214, v215
    v_mul_f32 v218, v218, v225
    v_mfma_f32_16x16x32_bf16 v[228:231], a[180:183], a[244:247], v[228:231]
    s_mul_i32 s51, s51, s30
    v_mul_f32 v219, v219, v225
    v_cvt_pk_bf16_f32 v216, v216, v217
    v_mfma_f32_16x16x32_bf16 v[228:231], a[184:187], a[216:219], v[228:231]
    s_lshr_b32 s55, s28, 1
    v_mul_f32 v220, v220, v225
    v_mul_f32 v221, v221, v225
    v_mfma_f32_16x16x32_bf16 v[228:231], a[188:191], a[220:223], v[228:231]
    ds_write_b64 v247, v[212:213] offset:55296
    v_mfma_f32_16x16x32_bf16 v[232:235], a[192:195], a[232:235], 0
    s_lshl2_add_u32 s55, s55, 11
    v_cvt_pk_bf16_f32 v217, v218, v219
    v_mul_f32 v222, v222, v225
    v_mfma_f32_16x16x32_bf16 v[232:235], a[196:199], a[236:239], v[232:235]
    s_mul_i32 s55, s55, s31
    v_mul_f32 v223, v223, v225
    v_cvt_pk_bf16_f32 v220, v220, v221
    v_mfma_f32_16x16x32_bf16 v[232:235], a[200:203], a[240:243], v[232:235]
    s_lshr_b32 s53, s28, 1
    v_cvt_pk_bf16_f32 v236, v236, v237
    v_cvt_pk_bf16_f32 v228, v228, v229
    v_mfma_f32_16x16x32_bf16 v[232:235], a[204:207], a[244:247], v[232:235]
    ds_write_b64 v247, v[216:217] offset:55424
    v_mfma_f32_16x16x32_bf16 v[232:235], a[208:211], a[216:219], v[232:235]
    s_sub_u32 s53, s53, 1
    v_cvt_pk_bf16_f32 v221, v222, v223
    v_mov_b32 v225, s66
    v_mfma_f32_16x16x32_bf16 v[232:235], a[212:215], a[220:223], v[232:235]
    v_mov_b32 v226, s67
    v_cvt_pk_bf16_f32 v237, v238, v239
    v_cvt_pk_bf16_f32 v229, v230, v231
    ds_write_b64 v247, v[220:221] offset:55552
    ds_write_b32 v226, v225 offset:0
    ds_write_b64 v249, v[236:237] offset:6144
    ds_write_b64 v249, v[228:229] offset:6272
    ds_read_b128 a[252:255], v252 offset:24576
    v_cvt_pk_bf16_f32 v232, v232, v233
    v_cvt_pk_bf16_f32 v233, v234, v235
    ds_write_b64 v249, v[232:233] offset:6400
    buffer_store_dwordx2 v[254:255], v251, s[20:23], s52 offen offset:256 nt
    ds_read_b64 v[254:255], v253 offset:24832
    s_lshr_b32 s52, s28, 1
    s_lshl2_add_u32 s52, s52, 3
    s_mul_i32 s52, s52, s31
    s_add_u32 s51, s51, s52
    s_add_u32 s51, s51, s32
    v_mov_b32 v226, 0x23000
    s_waitcnt lgkmcnt(2)
    buffer_store_dwordx4 a[252:255], v250, s[20:23], s54 offen nt
    s_waitcnt lgkmcnt(1)
    s_barrier
    ds_read_b128 a[224:227], v242 offset:55296
    ds_read_b128 a[228:231], v243 offset:55296
    ds_read_b128 a[232:235], v242 offset:55424
    ds_read_b128 a[236:239], v243 offset:55424
    ds_read_b128 a[240:243], v242 offset:55552
    ds_read_b128 a[244:247], v243 offset:55552
    ds_read_b128 a[252:255], v252 offset:0
    s_waitcnt lgkmcnt(7)
    buffer_store_dwordx2 v[254:255], v251, s[20:23], s54 offen offset:256 nt
    ds_read_b64 v[254:255], v253 offset:256
    ds_read_b128 v[196:199], v226 offset:0
    s_and_b32 s54, s28, 1
    s_add_u32 s54, s54, 15
    s_mul_i32 s54, s54, s30
    s_add_u32 s54, s54, s55
    s_add_u32 s54, s54, s32
    s_waitcnt lgkmcnt(8)
    v_mfma_f32_16x16x32_bf16 v[236:239], a[144:147], a[224:227], 0
    v_mfma_f32_16x16x32_bf16 v[228:231], a[168:171], a[224:227], 0
    s_waitcnt lgkmcnt(7)
    v_mfma_f32_16x16x32_bf16 v[236:239], a[148:151], a[228:231], v[236:239]
    s_waitcnt lgkmcnt(6)
    v_mfma_f32_16x16x32_bf16 v[236:239], a[152:155], a[232:235], v[236:239]
    s_waitcnt lgkmcnt(5)
    v_mfma_f32_16x16x32_bf16 v[236:239], a[156:159], a[236:239], v[236:239]
    s_waitcnt lgkmcnt(4)
    v_mfma_f32_16x16x32_bf16 v[236:239], a[160:163], a[240:243], v[236:239]
    s_waitcnt lgkmcnt(3)
    v_mfma_f32_16x16x32_bf16 v[236:239], a[164:167], a[244:247], v[236:239]
    s_waitcnt lgkmcnt(1)
    v_mfma_f32_16x16x32_bf16 v[228:231], a[172:175], a[228:231], v[228:231]
    s_mov_b32 exec_hi, 0
    buffer_store_dwordx4 a[252:255], v250, s[20:23], s56 offen nt
    s_mov_b32 exec_hi, -1
    v_mfma_f32_16x16x32_bf16 v[228:231], a[176:179], a[232:235], v[228:231]
    v_mfma_f32_16x16x32_bf16 v[228:231], a[180:183], a[236:239], v[228:231]
    ds_read_b128 a[252:255], v252 offset:6144
    v_mfma_f32_16x16x32_bf16 v[228:231], a[184:187], a[240:243], v[228:231]
    s_mov_b32 exec_hi, 0
    buffer_store_dwordx2 v[254:255], v251, s[20:23], s56 offen offset:256 nt
    s_mov_b32 exec_hi, -1
    v_mfma_f32_16x16x32_bf16 v[228:231], a[188:191], a[244:247], v[228:231]
    ds_read_b64 v[254:255], v253 offset:6400
    v_cvt_pk_bf16_f32 v236, v236, v237
    v_mfma_f32_16x16x32_bf16 v[232:235], a[192:195], a[224:227], 0
    s_waitcnt lgkmcnt(2)
    v_cvt_pk_bf16_f32 v237, v238, v239
    v_or3_b32 v225, v196, v197, v198
    v_mfma_f32_16x16x32_bf16 v[232:235], a[196:199], a[228:231], v[232:235]
    ds_write_b64 v249, v[236:237] offset:12288
    v_mfma_f32_16x16x32_bf16 v[232:235], a[200:203], a[232:235], v[232:235]
    v_cvt_pk_bf16_f32 v228, v228, v229
    v_cvt_pk_bf16_f32 v229, v230, v231
    v_mfma_f32_16x16x32_bf16 v[232:235], a[204:207], a[236:239], v[232:235]
    ds_write_b64 v249, v[228:229] offset:12416
    v_mfma_f32_16x16x32_bf16 v[232:235], a[208:211], a[240:243], v[232:235]
    v_or_b32 v225, v225, v199
    s_waitcnt lgkmcnt(3)
    v_mfma_f32_16x16x32_bf16 v[232:235], a[212:215], a[244:247], v[232:235]
    buffer_store_dwordx4 a[252:255], v250, s[20:23], s51 offen nt
    v_readfirstlane_b32 s47, v225
    s_waitcnt lgkmcnt(2)
    s_nop 4
    v_cvt_pk_bf16_f32 v232, v232, v233
    v_cvt_pk_bf16_f32 v233, v234, v235
    ds_write_b64 v249, v[232:233] offset:12544
    buffer_store_dwordx2 v[254:255], v251, s[20:23], s51 offen offset:256 nt
    s_waitcnt lgkmcnt(0)
    s_barrier
    ds_read_b128 a[252:255], v252 offset:12288
    ds_read_b64 v[254:255], v253 offset:12544
    s_waitcnt lgkmcnt(1)
    s_mov_b32 exec_hi, s53
    buffer_store_dwordx4 a[252:255], v250, s[20:23], s54 offen nt
    s_mov_b32 exec_hi, -1
    s_waitcnt lgkmcnt(0)
    s_mov_b32 exec_hi, s53
    buffer_store_dwordx2 v[254:255], v251, s[20:23], s54 offen offset:256 nt
    s_mov_b32 exec_hi, -1
    s_nop 4
    s_cmp_lg_u32 s47, 0
    s_cbranch_scc1 L_safe
L_exit:
    s_endpgm
L_safe:
    s_waitcnt vmcnt(0) lgkmcnt(0)
    s_nop 7
    s_barrier
    v_mbcnt_lo_u32_b32 v1, -1, 0
    v_mbcnt_hi_u32_b32 v1, -1, v1
    s_lshl_b32 s51, s28, 1
    s_add_u32 s50, s31, 0xfffffe80
    s_mul_i32 s52, s36, 0x1d00
    v_lshrrev_b32 v2, 3, v1
    v_and_b32 v3, 7, v1
    v_xor_b32 v3, s51, v3
    v_lshl_add_u32 v4, v2, 7, s52
    v_mul_u32_u24 v8, 11, v2
    v_bfe_u32 v9, v8, 6, 1
    v_lshrrev_b32 v8, 5, v8
    v_xor_b32 v9, v3, v9
    v_mad_i32_i24 v8, v8, s50, v4
    v_lshl_add_u32 v168, v9, 4, v8
    v_add_u32 v8, 8, v2
    v_mul_u32_u24 v8, 11, v8
    v_bfe_u32 v9, v8, 6, 1
    v_lshrrev_b32 v8, 5, v8
    v_xor_b32 v9, v3, v9
    v_mad_i32_i24 v8, v8, s50, v4
    v_lshl_add_u32 v169, v9, 4, v8
    v_add_u32 v8, 16, v2
    v_mul_u32_u24 v8, 11, v8
    v_bfe_u32 v9, v8, 6, 1
    v_lshrrev_b32 v8, 5, v8
    v_xor_b32 v9, v3, v9
    v_mad_i32_i24 v8, v8, s50, v4
    v_lshl_add_u32 v170, v9, 4, v8
    s_movk_i32 s53, 0x480
    s_movk_i32 s54, -96
    v_lshrrev_b32 v10, 1, v1
    v_lshlrev_b32 v12, 4, v1
    v_mul_u32_u24 v8, 43, v10
    v_lshrrev_b32 v9, 8, v8
    v_lshrrev_b32 v8, 7, v8
    v_and_b32 v9, 4, v9
    v_xor_b32 v9, v8, v9
    v_mad_i32_i24 v8, v8, s54, v12
    v_mad_u32_u24 v172, v9, s53, v8
    v_add_u32 v8, 32, v10
    v_mul_u32_u24 v8, 43, v8
    v_lshrrev_b32 v9, 8, v8
    v_lshrrev_b32 v8, 7, v8
    v_and_b32 v9, 4, v9
    v_xor_b32 v9, v8, v9
    v_mad_i32_i24 v8, v8, s54, v12
    v_mad_u32_u24 v173, v9, s53, v8
    v_add_u32 v8, 64, v10
    v_mul_u32_u24 v8, 43, v8
    v_lshrrev_b32 v9, 8, v8
    v_lshrrev_b32 v8, 7, v8
    v_and_b32 v9, 4, v9
    v_xor_b32 v9, v8, v9
    v_mad_i32_i24 v8, v8, s54, v12
    v_mad_u32_u24 v174, v9, s53, v8
L_safe2:
    s_add_u32 s59, s40, s45
    s_add_u32 m0, s46, 0xc00
    s_add_u32 s60, s39, 0x180
    buffer_load_dwordx4 v168, s[4:7], s59 offen lds
    s_add_u32 m0, s29, 0
    s_add_u32 s52, s40, 0
    buffer_load_dwordx4 v172, s[8:11], s60 offen lds
    s_add_u32 m0, s46, 0xc00
    v_add_u32 v5, s52, v168
    buffer_load_dwordx4 v169, s[4:7], s59 offen offset:1024 lds
    s_add_u32 m0, s29, 0
    v_max_i32 v5, 0, v5
    buffer_load_dwordx4 v173, s[8:11], s60 offen offset:1024 lds
    s_add_u32 m0, s46, 0xc00
    s_add_u32 s61, s39, 0x9180
    buffer_load_dwordx4 v170, s[4:7], s59 offen offset:2048 lds
    s_add_u32 m0, s29, 0
    s_add_u32 s53, s40, 0x400
    buffer_load_dwordx4 v174, s[8:11], s60 offen offset:2048 lds
    s_add_u32 m0, s46, 0
    v_add_u32 v6, s53, v169
    buffer_load_dwordx4 v5, s[4:7], 0 offen lds
    s_add_u32 m0, s29, 0xc00
    v_max_i32 v6, 0, v6
    buffer_load_dwordx4 v172, s[8:11], s61 offen lds
    s_add_u32 m0, s46, 0x400
    s_add_u32 s54, s40, 0x800
    buffer_load_dwordx4 v6, s[4:7], 0 offen lds
    s_add_u32 m0, s29, 0xc00
    v_add_u32 v7, s54, v170
    buffer_load_dwordx4 v173, s[8:11], s61 offen offset:1024 lds
    v_max_i32 v7, 0, v7
    s_add_u32 m0, s46, 0x800
    s_add_u32 s62, s39, 0x12180
    buffer_load_dwordx4 v7, s[4:7], 0 offen lds
    s_add_u32 m0, s29, 0xc00
    s_add_u32 s59, s41, s45
    buffer_load_dwordx4 v174, s[8:11], s61 offen offset:2048 lds
    s_add_u32 m0, s46, 0x7800
    s_add_u32 s63, s39, 0x1b180
    s_add_u32 s60, s39, 0x24180
    s_add_u32 s61, s39, 0x2d180
    s_and_b32 s65, s48, 0xfff0
    s_lshl1_add_u32 s58, s45, s40
    v_and_b32 v13, 15, v1
    v_lshrrev_b32 v14, 4, v1
    v_lshrrev_b32 v15, 2, v13
    v_and_b32 v16, 3, v13
    v_and_b32 v17, 1, v14
    v_lshl_add_u32 v18, v14, 3, v15
    v_xor_b32 v19, 0, v17
    v_lshl_add_u32 v19, v19, 2, v18
    v_mul_u32_u24 v19, 0x60, v19
    v_lshl_add_u32 v19, v16, 3, v19
    v_add_u32 v249, s29, v19
    v_xor_b32 v19, 1, v17
    v_lshl_add_u32 v19, v19, 2, v18
    v_mul_u32_u24 v19, 0x60, v19
    v_lshl_add_u32 v19, v16, 3, v19
    v_add_u32 v250, s29, v19
    v_mov_b32 v17, v15
    v_and_b32 v18, 3, v17
    v_mul_u32_u24 v17, 0x1e00, v17
    v_lshlrev_b32 v18, 1, v18
    v_bfe_u32 v241, v16, 1, 1
    v_or_b32 v18, v18, v241
    v_xor_b32 v18, v18, v14
    v_lshl_add_u32 v17, v18, 4, v17
    v_mul_u32_u24 v18, 0x180, v16
    v_add_u32 v240, v17, v18
    v_xor_b32 v241, 64, v240
    s_add_u32 s55, s28, 3
    s_mul_i32 s56, s31, 3
    s_mul_i32 s55, s55, s30
    s_add_u32 s55, s55, s56
    s_add_u32 s55, s55, s32
    s_add_u32 s57, s28, 3
    s_mul_i32 s51, s31, 7
    s_mul_i32 s57, s57, s30
    s_add_u32 s57, s57, s51
    s_add_u32 s57, s57, s32
    s_add_u32 s52, s28, 3
    s_mul_i32 s53, s31, 11
    s_mul_i32 s52, s52, s30
    s_add_u32 s52, s52, s53
    s_add_u32 s52, s52, s32
    s_add_u32 s54, s28, 7
    s_mul_i32 s54, s54, s30
    s_add_u32 s56, s28, 7
    s_mul_i32 s56, s56, s30
    s_add_u32 s51, s28, 7
    s_mul_i32 s51, s51, s30
    s_add_u32 s53, s28, 3
    s_mul_i32 s53, s53, s30
    buffer_load_dwordx4 v168, s[4:7], s41 offen lds
    s_add_u32 m0, s29, 0x1800
    s_nop 0
    buffer_load_dwordx4 v172, s[8:11], s62 offen lds
    s_add_u32 m0, s46, 0x7800
    s_nop 0
    buffer_load_dwordx4 v169, s[4:7], s41 offen offset:1024 lds
    s_add_u32 m0, s29, 0x1800
    s_nop 0
    buffer_load_dwordx4 v173, s[8:11], s62 offen offset:1024 lds
    s_add_u32 m0, s46, 0x7800
    s_nop 0
    buffer_load_dwordx4 v170, s[4:7], s41 offen offset:2048 lds
    s_add_u32 m0, s29, 0x1800
    s_nop 0
    buffer_load_dwordx4 v174, s[8:11], s62 offen offset:2048 lds
    s_add_u32 m0, s46, 0x8400
    s_add_u32 s62, s39, 0x300
    s_waitcnt vmcnt(12)
    ds_read_b64_tr_b16 a[0:1], v249 offset:0
    ds_read_b64_tr_b16 a[2:3], v250 offset:0
    ds_read_b64_tr_b16 a[24:25], v249 offset:32
    ds_read_b64_tr_b16 a[26:27], v250 offset:32
    ds_read_b64_tr_b16 a[48:49], v249 offset:64
    ds_read_b64_tr_b16 a[50:51], v250 offset:64
    buffer_load_dwordx4 v168, s[4:7], s59 offen lds
    s_add_u32 m0, s29, 0x2400
    s_nop 0
    buffer_load_dwordx4 v172, s[8:11], s63 offen lds
    s_add_u32 m0, s46, 0x8400
    s_nop 0
    buffer_load_dwordx4 v169, s[4:7], s59 offen offset:1024 lds
    s_add_u32 m0, s29, 0x2400
    s_nop 0
    buffer_load_dwordx4 v173, s[8:11], s63 offen offset:1024 lds
    s_add_u32 m0, s46, 0x8400
    s_nop 0
    buffer_load_dwordx4 v170, s[4:7], s59 offen offset:2048 lds
    s_add_u32 m0, s29, 0x2400
    s_add_u32 s59, s42, s45
    s_waitcnt vmcnt(12)
    s_barrier
    ds_read_b128 a[216:219], v240 offset:0
    ds_read_b128 a[220:223], v240 offset:1536
    ds_read_b128 a[224:227], v240 offset:3072
    ds_read_b128 a[228:231], v240 offset:4608
    ds_read_b128 a[232:235], v241 offset:0
    ds_read_b128 a[236:239], v241 offset:1536
    ds_read_b128 a[240:243], v241 offset:3072
    ds_read_b128 a[244:247], v241 offset:4608
    buffer_load_dwordx4 v174, s[8:11], s63 offen offset:2048 lds
    s_add_u32 m0, s29, 0
    s_waitcnt vmcnt(12) lgkmcnt(8)
    s_add_u32 s63, s39, 0x9300
    ds_read_b64_tr_b16 a[4:5], v249 offset:3072
    ds_read_b64_tr_b16 a[6:7], v250 offset:3072
    ds_read_b64_tr_b16 a[28:29], v249 offset:3104
    ds_read_b64_tr_b16 a[30:31], v250 offset:3104
    ds_read_b64_tr_b16 a[52:53], v249 offset:3136
    ds_read_b64_tr_b16 a[54:55], v250 offset:3136
    buffer_load_dwordx4 v172, s[8:11], s60 offen lds
    s_waitcnt lgkmcnt(13)
    v_mfma_f32_16x16x32_bf16 v[180:183], a[0:3], a[216:219], 0
    v_mfma_f32_16x16x32_bf16 v[184:187], a[24:27], a[216:219], 0
    s_waitcnt lgkmcnt(12)
    v_mfma_f32_16x16x32_bf16 v[188:191], a[48:51], a[216:219], 0
    ds_read_b128 a[216:219], v240 offset:128
    s_waitcnt lgkmcnt(11)
    v_mfma_f32_16x16x32_bf16 v[192:195], a[0:3], a[220:223], 0
    buffer_load_dwordx4 v173, s[8:11], s60 offen offset:1024 lds
    v_mfma_f32_16x16x32_bf16 v[196:199], a[24:27], a[220:223], 0
    v_mfma_f32_16x16x32_bf16 v[200:203], a[48:51], a[220:223], 0
    ds_read_b128 a[220:223], v240 offset:1664
    v_mfma_f32_16x16x32_bf16 v[204:207], a[0:3], a[224:227], 0
    v_mfma_f32_16x16x32_bf16 v[208:211], a[24:27], a[224:227], 0
    v_mfma_f32_16x16x32_bf16 v[212:215], a[48:51], a[224:227], 0
    buffer_load_dwordx4 v174, s[8:11], s60 offen offset:2048 lds
    s_add_u32 m0, s29, 0xc00
    v_mfma_f32_16x16x32_bf16 v[216:219], a[0:3], a[228:231], 0
    s_add_u32 s60, s39, 0x12300
    ds_read_b128 a[224:227], v240 offset:3200
    v_mfma_f32_16x16x32_bf16 v[220:223], a[24:27], a[228:231], 0
    s_waitcnt lgkmcnt(3)
    v_mfma_f32_16x16x32_bf16 v[224:227], a[48:51], a[228:231], 0
    ds_read_b128 a[228:231], v240 offset:4736
    v_mfma_f32_16x16x32_bf16 v[180:183], a[4:7], a[232:235], v[180:183]
    buffer_load_dwordx4 v172, s[8:11], s61 offen lds
    v_mfma_f32_16x16x32_bf16 v[184:187], a[28:31], a[232:235], v[184:187]
    v_mfma_f32_16x16x32_bf16 v[188:191], a[52:55], a[232:235], v[188:191]
    v_mfma_f32_16x16x32_bf16 v[192:195], a[4:7], a[236:239], v[192:195]
    v_mfma_f32_16x16x32_bf16 v[196:199], a[28:31], a[236:239], v[196:199]
    v_mfma_f32_16x16x32_bf16 v[200:203], a[52:55], a[236:239], v[200:203]
    buffer_load_dwordx4 v173, s[8:11], s61 offen offset:1024 lds
    v_mfma_f32_16x16x32_bf16 v[204:207], a[4:7], a[240:243], v[204:207]
    v_mfma_f32_16x16x32_bf16 v[208:211], a[28:31], a[240:243], v[208:211]
    v_mfma_f32_16x16x32_bf16 v[212:215], a[52:55], a[240:243], v[212:215]
    v_mfma_f32_16x16x32_bf16 v[216:219], a[4:7], a[244:247], v[216:219]
    buffer_load_dwordx4 v174, s[8:11], s61 offen offset:2048 lds
    s_add_u32 m0, s37, 0xd80
    v_mfma_f32_16x16x32_bf16 v[220:223], a[28:31], a[244:247], v[220:223]
    s_add_u32 s61, s39, 0x1b300
    s_waitcnt vmcnt(12)
    v_mfma_f32_16x16x32_bf16 v[224:227], a[52:55], a[244:247], v[224:227]
    ds_read_b64_tr_b16 a[8:9], v249 offset:6144
    ds_read_b64_tr_b16 a[10:11], v250 offset:6144
    ds_read_b64_tr_b16 a[32:33], v249 offset:6176
    ds_read_b64_tr_b16 a[34:35], v250 offset:6176
    ds_read_b64_tr_b16 a[56:57], v249 offset:6208
    ds_read_b64_tr_b16 a[58:59], v250 offset:6208
    buffer_load_dwordx4 v12, s[16:19], s65 offen lds
    s_add_u32 m0, s29, 0x1800
    s_waitcnt lgkmcnt(4)
    v_mfma_f32_16x16x32_bf16 v[180:183], a[8:11], a[216:219], v[180:183]
    v_mfma_f32_16x16x32_bf16 v[192:195], a[8:11], a[220:223], v[192:195]
    s_waitcnt lgkmcnt(2)
    v_mfma_f32_16x16x32_bf16 v[184:187], a[32:35], a[216:219], v[184:187]
    s_waitcnt lgkmcnt(0)
    buffer_load_dwordx4 v172, s[8:11], s62 offen lds
    v_mfma_f32_16x16x32_bf16 v[188:191], a[56:59], a[216:219], v[188:191]
    v_mfma_f32_16x16x32_bf16 v[196:199], a[32:35], a[220:223], v[196:199]
    v_mfma_f32_16x16x32_bf16 v[200:203], a[56:59], a[220:223], v[200:203]
    v_mfma_f32_16x16x32_bf16 v[204:207], a[8:11], a[224:227], v[204:207]
    buffer_load_dwordx4 v173, s[8:11], s62 offen offset:1024 lds
    s_add_u32 s50, s31, 0xfffffe80
    v_mfma_f32_16x16x32_bf16 v[208:211], a[32:35], a[224:227], v[208:211]
    s_and_b32 s66, s28, 1
    v_add_u32 v8, 4, v2
    v_mul_u32_u24 v8, 11, v8
    v_mfma_f32_16x16x32_bf16 v[212:215], a[56:59], a[224:227], v[212:215]
    s_lshl_b32 s66, s66, 2
    v_bfe_u32 v9, v8, 6, 1
    v_lshrrev_b32 v8, 5, v8
    v_mfma_f32_16x16x32_bf16 v[216:219], a[8:11], a[228:231], v[216:219]
    s_lshr_b32 s67, s28, 1
    v_xor_b32 v9, v3, v9
    v_mad_i32_i24 v8, v8, s50, v4
    v_mfma_f32_16x16x32_bf16 v[220:223], a[32:35], a[228:231], v[220:223]
    buffer_load_dwordx4 v174, s[8:11], s62 offen offset:2048 lds
    s_add_u32 m0, s46, 0xf000
    v_mfma_f32_16x16x32_bf16 v[224:227], a[56:59], a[228:231], v[224:227]
    s_add_u32 s62, s39, 0x24300
    s_waitcnt vmcnt(11)
    s_barrier
    ds_read_b128 a[232:235], v240 offset:30720
    ds_read_b128 a[236:239], v240 offset:32256
    ds_read_b128 a[240:243], v240 offset:33792
    ds_read_b128 a[244:247], v240 offset:35328
    ds_read_b128 a[216:219], v241 offset:30720
    ds_read_b128 a[220:223], v241 offset:32256
    ds_read_b128 a[224:227], v241 offset:33792
    buffer_load_dwordx4 v168, s[4:7], s42 offen lds
    s_add_u32 m0, s29, 0x2400
    s_waitcnt vmcnt(11)
    ds_read_b64_tr_b16 a[12:13], v249 offset:9216
    ds_read_b64_tr_b16 a[14:15], v250 offset:9216
    ds_read_b64_tr_b16 a[36:37], v249 offset:9248
    ds_read_b64_tr_b16 a[38:39], v250 offset:9248
    ds_read_b64_tr_b16 a[60:61], v249 offset:9280
    ds_read_b64_tr_b16 a[62:63], v250 offset:9280
    ds_read_b128 a[228:231], v241 offset:35328
    v_lshl_add_u32 v171, v9, 4, v8
    v_mbcnt_lo_u32_b32 v67, -1, 0
    v_mbcnt_hi_u32_b32 v67, -1, v67
    v_lshrrev_b32 v68, 1, v67
    v_add_u32 v68, 0, v68
    v_mul_u32_u24 v69, 43, v68
    v_lshrrev_b32 v70, 8, v69
    v_lshrrev_b32 v69, 7, v69
    v_mad_i32_i24 v68, v69, -3, v68
    v_and_b32 v70, 4, v70
    v_xor_b32 v69, v69, v70
    s_waitcnt lgkmcnt(13)
    v_mfma_f32_16x16x32_bf16 v[228:231], a[0:3], a[232:235], 0
    s_lshl_b32 s67, s67, 3
    v_and_b32 v70, 4, v69
    v_mul_u32_u24 v252, 24, v70
    v_mfma_f32_16x16x32_bf16 v[232:235], a[24:27], a[232:235], 0
    s_mul_i32 s64, s35, 0xfc0
    v_lshrrev_b32 v70, 3, v69
    v_lshl_add_u32 v252, v70, 2, v252
    v_mfma_f32_16x16x32_bf16 v[236:239], a[48:51], a[232:235], 0
    s_waitcnt lgkmcnt(11)
    ds_read_b128 a[232:235], v240 offset:30848
    v_mfma_f32_16x16x32_bf16 v[138:141], a[0:3], a[236:239], 0
    s_add_u32 s64, s64, s37
    v_and_or_b32 v252, v69, 3, v252
    v_mad_u32_u24 v252, v252, 3, v68
    v_mfma_f32_16x16x32_bf16 v[142:145], a[24:27], a[236:239], 0
    s_waitcnt lgkmcnt(10)
    v_and_b32 v70, 1, v67
    v_lshl_add_u32 v252, v252, 3, v70
    v_mfma_f32_16x16x32_bf16 v[146:149], a[48:51], a[236:239], 0
    ds_read_b128 a[236:239], v240 offset:32384
    v_lshlrev_b32 v252, 4, v252
    v_mfma_f32_16x16x32_bf16 v[150:153], a[0:3], a[240:243], 0
    s_waitcnt lgkmcnt(9)
    v_lshrrev_b32 v68, 1, v67
    v_add_u32 v68, 32, v68
    v_mfma_f32_16x16x32_bf16 v[154:157], a[24:27], a[240:243], 0
    v_mul_u32_u24 v69, 43, v68
    s_waitcnt vmcnt(8)
    v_mfma_f32_16x16x32_bf16 v[158:161], a[48:51], a[240:243], 0
    ds_read_b64_tr_b16 a[16:17], v249 offset:0
    s_waitcnt lgkmcnt(4)
    v_mfma_f32_16x16x32_bf16 v[162:165], a[0:3], a[244:247], 0
    buffer_load_dwordx4 v172, s[8:11], s63 offen lds
    s_add_u32 m0, s46, 0xf000
    v_mfma_f32_16x16x32_bf16 v[24:27], a[24:27], a[244:247], 0
    ds_read_b64_tr_b16 a[18:19], v250 offset:0
    ds_read_b64_tr_b16 a[40:41], v249 offset:32
    v_mfma_f32_16x16x32_bf16 v[54:57], a[48:51], a[244:247], 0
    ds_read_b64_tr_b16 a[42:43], v250 offset:32
    ds_read_b64_tr_b16 a[64:65], v249 offset:64
    v_mfma_f32_16x16x32_bf16 v[228:231], a[4:7], a[216:219], v[228:231]
    ds_read_b64_tr_b16 a[66:67], v250 offset:64
    ds_read_b128 a[240:243], v240 offset:33920
    v_mfma_f32_16x16x32_bf16 v[232:235], a[28:31], a[216:219], v[232:235]
    buffer_load_dwordx4 v169, s[4:7], s42 offen offset:1024 lds
    s_add_u32 m0, s29, 0x2400
    v_mfma_f32_16x16x32_bf16 v[236:239], a[52:55], a[216:219], v[236:239]
    ds_read_b128 a[244:247], v240 offset:35456
    ds_read_b128 a[216:219], v241 offset:128
    v_mfma_f32_16x16x32_bf16 v[138:141], a[4:7], a[220:223], v[138:141]
    s_waitcnt lgkmcnt(9)
    v_lshrrev_b32 v70, 8, v69
    v_lshrrev_b32 v69, 7, v69
    v_mfma_f32_16x16x32_bf16 v[142:145], a[28:31], a[220:223], v[142:145]
    v_mad_i32_i24 v68, v69, -3, v68
    v_and_b32 v70, 4, v70
    v_mfma_f32_16x16x32_bf16 v[146:149], a[52:55], a[220:223], v[146:149]
    buffer_load_dwordx4 v173, s[8:11], s63 offen offset:1024 lds
    s_add_u32 m0, s46, 0xf000
    v_mfma_f32_16x16x32_bf16 v[150:153], a[4:7], a[224:227], v[150:153]
    ds_read_b128 a[220:223], v241 offset:1664
    v_xor_b32 v69, v69, v70
    v_mfma_f32_16x16x32_bf16 v[154:157], a[28:31], a[224:227], v[154:157]
    v_and_b32 v70, 4, v69
    v_mul_u32_u24 v253, 24, v70
    v_mfma_f32_16x16x32_bf16 v[158:161], a[52:55], a[224:227], v[158:161]
    ds_read_b128 a[224:227], v241 offset:3200
    s_waitcnt vmcnt(8)
    v_mfma_f32_16x16x32_bf16 v[162:165], a[4:7], a[228:231], v[162:165]
    buffer_load_dwordx4 v170, s[4:7], s42 offen offset:2048 lds
    s_add_u32 m0, s29, 0x2400
    v_mfma_f32_16x16x32_bf16 v[24:27], a[28:31], a[228:231], v[24:27]
    ds_read_b64_tr_b16 a[20:21], v249 offset:3072
    ds_read_b64_tr_b16 a[22:23], v250 offset:3072
    v_mfma_f32_16x16x32_bf16 v[54:57], a[52:55], a[228:231], v[54:57]
    ds_read_b64_tr_b16 a[44:45], v249 offset:3104
    ds_read_b64_tr_b16 a[46:47], v250 offset:3104
    v_mfma_f32_16x16x32_bf16 v[228:231], a[8:11], a[232:235], v[228:231]
    ds_read_b64_tr_b16 a[68:69], v249 offset:3136
    ds_read_b64_tr_b16 a[70:71], v250 offset:3136
    v_mfma_f32_16x16x32_bf16 v[232:235], a[32:35], a[232:235], v[232:235]
    buffer_load_dwordx4 v174, s[8:11], s63 offen offset:2048 lds
    s_add_u32 m0, s46, 0xfc00
    v_mfma_f32_16x16x32_bf16 v[236:239], a[56:59], a[232:235], v[236:239]
    s_add_u32 s63, s39, 0x2d300
    ds_read_b128 a[228:231], v241 offset:4736
    v_mfma_f32_16x16x32_bf16 v[138:141], a[8:11], a[236:239], v[138:141]
    ds_read_b128 a[232:235], v241 offset:30848
    v_lshrrev_b32 v70, 3, v69
    v_mfma_f32_16x16x32_bf16 v[142:145], a[32:35], a[236:239], v[142:145]
    s_waitcnt lgkmcnt(8)
    v_lshl_add_u32 v253, v70, 2, v253
    v_and_or_b32 v253, v69, 3, v253
    v_mfma_f32_16x16x32_bf16 v[146:149], a[56:59], a[236:239], v[146:149]
    buffer_load_dwordx4 v168, s[4:7], s59 offen lds
    s_add_u32 m0, s29, 0
    v_mfma_f32_16x16x32_bf16 v[150:153], a[8:11], a[240:243], v[150:153]
    ds_read_b128 a[236:239], v241 offset:32384
    v_mad_u32_u24 v253, v253, 3, v68
    v_mfma_f32_16x16x32_bf16 v[154:157], a[32:35], a[240:243], v[154:157]
    v_and_b32 v70, 1, v67
    v_lshl_add_u32 v253, v253, 3, v70
    v_mfma_f32_16x16x32_bf16 v[158:161], a[56:59], a[240:243], v[158:161]
    ds_read_b128 a[240:243], v241 offset:33920
    v_lshlrev_b32 v253, 4, v253
    v_mfma_f32_16x16x32_bf16 v[162:165], a[8:11], a[244:247], v[162:165]
    buffer_load_dwordx4 v172, s[8:11], s60 offen lds
    s_add_u32 m0, s46, 0xfc00
    v_mfma_f32_16x16x32_bf16 v[24:27], a[32:35], a[244:247], v[24:27]
    v_add_u32 v253, 0xfffffc00, v253
    v_add_u32 v17, 3, v15
    v_mfma_f32_16x16x32_bf16 v[54:57], a[56:59], a[244:247], v[54:57]
    ds_read_b128 a[244:247], v241 offset:35456
    v_add_u32 v19, 3, v16
    v_mfma_f32_16x16x32_bf16 v[180:183], a[12:15], a[216:219], v[180:183]
    s_waitcnt lgkmcnt(3)
    v_and_b32 v18, 3, v17
    v_mul_u32_u24 v17, 0x1e00, v17
    v_mfma_f32_16x16x32_bf16 v[184:187], a[36:39], a[216:219], v[184:187]
    buffer_load_dwordx4 v169, s[4:7], s59 offen offset:1024 lds
    s_add_u32 m0, s29, 0
    v_mfma_f32_16x16x32_bf16 v[188:191], a[60:63], a[216:219], v[188:191]
    ds_read_b128 a[216:219], v240 offset:256
    v_lshlrev_b32 v18, 1, v18
    v_mfma_f32_16x16x32_bf16 v[192:195], a[12:15], a[220:223], v[192:195]
    s_waitcnt lgkmcnt(3)
    v_bfe_u32 v243, v19, 1, 1
    v_or_b32 v18, v18, v243
    v_mfma_f32_16x16x32_bf16 v[196:199], a[36:39], a[220:223], v[196:199]
    s_waitcnt vmcnt(9)
    ds_read_b64_tr_b16 a[72:73], v249 offset:6144
    v_mfma_f32_16x16x32_bf16 v[200:203], a[60:63], a[220:223], v[200:203]
    buffer_load_dwordx4 v173, s[8:11], s60 offen offset:1024 lds
    s_add_u32 m0, s46, 0xfc00
    v_mfma_f32_16x16x32_bf16 v[204:207], a[12:15], a[224:227], v[204:207]
    ds_read_b64_tr_b16 a[74:75], v250 offset:6144
    ds_read_b64_tr_b16 a[96:97], v249 offset:6176
    v_mfma_f32_16x16x32_bf16 v[208:211], a[36:39], a[224:227], v[208:211]
    ds_read_b64_tr_b16 a[98:99], v250 offset:6176
    ds_read_b64_tr_b16 a[120:121], v249 offset:6208
    v_mfma_f32_16x16x32_bf16 v[212:215], a[60:63], a[224:227], v[212:215]
    ds_read_b64_tr_b16 a[122:123], v250 offset:6208
    ds_read_b128 a[220:223], v240 offset:1792
    v_mfma_f32_16x16x32_bf16 v[216:219], a[12:15], a[228:231], v[216:219]
    buffer_load_dwordx4 v170, s[4:7], s59 offen offset:2048 lds
    s_add_u32 m0, s29, 0
    v_mfma_f32_16x16x32_bf16 v[220:223], a[36:39], a[228:231], v[220:223]
    ds_read_b128 a[224:227], v240 offset:3328
    s_add_u32 s59, s43, s45
    v_mfma_f32_16x16x32_bf16 v[224:227], a[60:63], a[228:231], v[224:227]
    ds_read_b128 a[228:231], v240 offset:4864
    v_xor_b32 v18, v18, v14
    v_mfma_f32_16x16x32_bf16 v[228:231], a[12:15], a[232:235], v[228:231]
    s_waitcnt lgkmcnt(9)
    v_lshl_add_u32 v17, v18, 4, v17
    v_mul_u32_u24 v18, 0x180, v19
    v_mfma_f32_16x16x32_bf16 v[232:235], a[36:39], a[232:235], v[232:235]
    buffer_load_dwordx4 v174, s[8:11], s60 offen offset:2048 lds
    s_add_u32 m0, s29, 0xc00
    v_mfma_f32_16x16x32_bf16 v[236:239], a[60:63], a[232:235], v[236:239]
    s_add_u32 s60, s39, 0
    ds_read_b128 a[232:235], v240 offset:30976
    v_mfma_f32_16x16x32_bf16 v[138:141], a[12:15], a[236:239], v[138:141]
    v_add_u32 v242, v17, v18
    v_xor_b32 v243, 64, v242
    v_mfma_f32_16x16x32_bf16 v[142:145], a[36:39], a[236:239], v[142:145]
    v_accvgpr_write_b32 a252, v168
    v_accvgpr_read_b32 v254, a252
    v_mfma_f32_16x16x32_bf16 v[146:149], a[60:63], a[236:239], v[146:149]
    buffer_load_dwordx4 v172, s[8:11], s61 offen lds
    ds_read_b128 a[236:239], v240 offset:32512
    v_mfma_f32_16x16x32_bf16 v[150:153], a[12:15], a[240:243], v[150:153]
    s_waitcnt lgkmcnt(4)
    v_accvgpr_write_b32 a253, v169
    v_accvgpr_read_b32 v255, a253
    v_mfma_f32_16x16x32_bf16 v[154:157], a[36:39], a[240:243], v[154:157]
    s_waitcnt lgkmcnt(3)
    v_accvgpr_write_b32 a254, v170
    v_accvgpr_write_b32 a255, v171
    v_mfma_f32_16x16x32_bf16 v[158:161], a[60:63], a[240:243], v[158:161]
    ds_read_b128 a[240:243], v240 offset:34048
    v_mov_b32 v17, 0x3f803f80
    v_mfma_f32_16x16x32_bf16 v[162:165], a[12:15], a[244:247], v[162:165]
    s_waitcnt lgkmcnt(3)
    v_accvgpr_write_b32 a248, v17
    v_accvgpr_write_b32 a249, v17
    v_mfma_f32_16x16x32_bf16 v[24:27], a[36:39], a[244:247], v[24:27]
    v_accvgpr_write_b32 a250, v17
    v_accvgpr_write_b32 a251, v17
    v_mfma_f32_16x16x32_bf16 v[54:57], a[60:63], a[244:247], v[54:57]
    buffer_load_dwordx4 v173, s[8:11], s61 offen offset:1024 lds
    ds_read_b128 a[244:247], v240 offset:35584
    v_mfma_f32_16x16x32_bf16 v[180:183], a[16:19], a[216:219], v[180:183]
    s_waitcnt lgkmcnt(3)
    v_mov_b32 v248, 0
    v_lshrrev_b32 v18, 1, v13
    v_mfma_f32_16x16x32_bf16 v[184:187], a[40:43], a[216:219], v[184:187]
    v_xor_b32 v18, v14, v18
    v_xor_b32 v18, s66, v18
    v_mfma_f32_16x16x32_bf16 v[188:191], a[64:67], a[216:219], v[188:191]
    ds_read_b128 a[216:219], v241 offset:256
    v_mul_u32_u24 v17, 0x180, v13
    v_mfma_f32_16x16x32_bf16 v[192:195], a[16:19], a[220:223], v[192:195]
    buffer_load_dwordx4 v174, s[8:11], s61 offen offset:2048 lds
    s_add_u32 m0, s29, 0x1800
    v_mfma_f32_16x16x32_bf16 v[196:199], a[40:43], a[220:223], v[196:199]
    s_add_u32 s61, s39, 0x9000
    v_lshl_add_u32 v17, v18, 4, v17
    v_add_u32 v17, s67, v17
    v_mfma_f32_16x16x32_bf16 v[200:203], a[64:67], a[220:223], v[200:203]
    ds_read_b128 a[220:223], v241 offset:1792
    s_mul_i32 s67, s36, 3
    v_mfma_f32_16x16x32_bf16 v[204:207], a[16:19], a[224:227], v[204:207]
    s_lshl_b32 s66, s36, 1
    v_add_u32 v247, 0x7800, v17
    v_add_u32 v251, 0x1e000, v17
    v_mfma_f32_16x16x32_bf16 v[208:211], a[40:43], a[224:227], v[208:211]
    buffer_load_dwordx4 v172, s[8:11], s62 offen lds
    v_sub_u32 v17, v14, v15
    v_mfma_f32_16x16x32_bf16 v[212:215], a[64:67], a[224:227], v[212:215]
    ds_read_b128 a[224:227], v241 offset:3328
    v_mul_i32_i24 v17, 0x1c0, v17
    v_mfma_f32_16x16x32_bf16 v[216:219], a[16:19], a[228:231], v[216:219]
    s_sub_u32 s66, 1, s66
    v_lshlrev_b32 v18, 4, v16
    v_sub_u32 v17, v17, v18
    v_mfma_f32_16x16x32_bf16 v[220:223], a[40:43], a[228:231], v[220:223]
    s_waitcnt lgkmcnt(3)
    v_add_u32 v17, s37, v17
    v_max_u32 v18, s33, v15
    v_mfma_f32_16x16x32_bf16 v[224:227], a[64:67], a[228:231], v[224:227]
    ds_read_b128 a[228:231], v241 offset:4864
    buffer_load_dwordx4 v173, s[8:11], s62 offen offset:1024 lds
    v_mfma_f32_16x16x32_bf16 v[228:231], a[16:19], a[232:235], v[228:231]
    s_waitcnt lgkmcnt(3)
    v_sub_u32 v18, v14, v18
    v_add_u32 v244, 0, v18
    v_mfma_f32_16x16x32_bf16 v[232:235], a[40:43], a[232:235], v[232:235]
    v_cmp_gt_u32 vcc, 7, v244
    v_add_u32 v244, 0xfffdc870, v17
    v_mfma_f32_16x16x32_bf16 v[236:239], a[64:67], a[232:235], v[236:239]
    ds_read_b128 a[232:235], v241 offset:30976
    v_cndmask_b32 v244, 0, v244, vcc
    v_mfma_f32_16x16x32_bf16 v[138:141], a[16:19], a[236:239], v[138:141]
    s_waitcnt lgkmcnt(3)
    v_add_u32 v244, 0x237c0, v244
    v_add_u32 v245, 4, v18
    v_mfma_f32_16x16x32_bf16 v[142:145], a[40:43], a[236:239], v[142:145]
    buffer_load_dwordx4 v174, s[8:11], s62 offen offset:2048 lds
    s_add_u32 m0, s29, 0x2400
    v_mfma_f32_16x16x32_bf16 v[146:149], a[64:67], a[236:239], v[146:149]
    s_add_u32 s62, s39, 0x12000
    s_waitcnt vmcnt(12) lgkmcnt(2)
    v_cmp_gt_u32 vcc, 7, v245
    v_mfma_f32_16x16x32_bf16 v[150:153], a[16:19], a[240:243], v[150:153]
    ds_read_b64_tr_b16 a[76:77], v249 offset:9216
    ds_read_b64_tr_b16 a[78:79], v250 offset:9216
    v_mfma_f32_16x16x32_bf16 v[154:157], a[40:43], a[240:243], v[154:157]
    ds_read_b64_tr_b16 a[100:101], v249 offset:9248
    ds_read_b64_tr_b16 a[102:103], v250 offset:9248
    v_mfma_f32_16x16x32_bf16 v[158:161], a[64:67], a[240:243], v[158:161]
    ds_read_b64_tr_b16 a[124:125], v249 offset:9280
    ds_read_b64_tr_b16 a[126:127], v250 offset:9280
    v_mfma_f32_16x16x32_bf16 v[162:165], a[16:19], a[244:247], v[162:165]
    ds_read_b128 a[236:239], v241 offset:32512
    ds_read_b128 a[240:243], v241 offset:34048
    v_mfma_f32_16x16x32_bf16 v[24:27], a[40:43], a[244:247], v[24:27]
    s_waitcnt lgkmcnt(8)
    v_add_u32 v245, 0xfffdcf70, v17
    v_cndmask_b32 v245, 0, v245, vcc
    v_mfma_f32_16x16x32_bf16 v[54:57], a[64:67], a[244:247], v[54:57]
    ds_read_b128 a[244:247], v241 offset:35584
    v_add_u32 v245, 0x237c0, v245
    v_mfma_f32_16x16x32_bf16 v[180:183], a[20:23], a[216:219], v[180:183]
    v_add_u32 v246, 8, v18
    v_cmp_gt_u32 vcc, 7, v246
    v_mfma_f32_16x16x32_bf16 v[184:187], a[44:47], a[216:219], v[184:187]
    v_add_u32 v246, 0xfffdd670, v17
    v_cndmask_b32 v246, 0, v246, vcc
    v_mfma_f32_16x16x32_bf16 v[188:191], a[68:71], a[216:219], v[188:191]
    ds_read_b128 a[216:219], v240 offset:0
    v_add_u32 v246, 0x237c0, v246
    v_mfma_f32_16x16x32_bf16 v[192:195], a[20:23], a[220:223], v[192:195]
    v_cvt_pk_bf16_f32 v90, v180, v181
    v_cvt_pk_bf16_f32 v91, v182, v183
    v_mfma_f32_16x16x32_bf16 v[196:199], a[44:47], a[220:223], v[196:199]
    v_cvt_pk_bf16_f32 v92, v184, v185
    s_waitcnt lgkmcnt(4)
    v_mfma_f32_16x16x32_bf16 v[200:203], a[68:71], a[220:223], v[200:203]
    buffer_load_dwordx4 v172, s[8:11], s63 offen lds
    v_cvt_pk_bf16_f32 v93, v186, v187
    v_mfma_f32_16x16x32_bf16 v[204:207], a[20:23], a[224:227], v[204:207]
    s_waitcnt vmcnt(10) lgkmcnt(3)
    v_cvt_pk_bf16_f32 v94, v188, v189
    v_cvt_pk_bf16_f32 v95, v190, v191
    v_mfma_f32_16x16x32_bf16 v[208:211], a[44:47], a[224:227], v[208:211]
    s_barrier
    v_cvt_pk_bf16_f32 v96, v192, v193
    v_cvt_pk_bf16_f32 v97, v194, v195
    v_mfma_f32_16x16x32_bf16 v[212:215], a[68:71], a[224:227], v[212:215]
    s_waitcnt lgkmcnt(1)
    v_cvt_pk_bf16_f32 v98, v196, v197
    v_cvt_pk_bf16_f32 v99, v198, v199
    v_mfma_f32_16x16x32_bf16 v[216:219], a[20:23], a[228:231], v[216:219]
    buffer_load_dwordx4 v173, s[8:11], s63 offen offset:1024 lds
    v_cvt_pk_bf16_f32 v100, v200, v201
    v_mfma_f32_16x16x32_bf16 v[220:223], a[44:47], a[228:231], v[220:223]
    v_cvt_pk_bf16_f32 v101, v202, v203
    v_cvt_pk_bf16_f32 v102, v204, v205
    v_mfma_f32_16x16x32_bf16 v[224:227], a[68:71], a[228:231], v[224:227]
    s_waitcnt lgkmcnt(0)
    v_cvt_pk_bf16_f32 v103, v206, v207
    v_cvt_pk_bf16_f32 v104, v208, v209
    v_mfma_f32_16x16x32_bf16 v[228:231], a[20:23], a[232:235], v[228:231]
    v_cvt_pk_bf16_f32 v105, v210, v211
    v_cvt_pk_bf16_f32 v106, v212, v213
    v_mfma_f32_16x16x32_bf16 v[232:235], a[44:47], a[232:235], v[232:235]
    buffer_load_dwordx4 v174, s[8:11], s63 offen offset:2048 lds
    s_add_u32 m0, s29, 0
    v_mfma_f32_16x16x32_bf16 v[236:239], a[68:71], a[232:235], v[236:239]
    s_add_u32 s63, s39, 0x1b000
    v_cvt_pk_bf16_f32 v107, v214, v215
    v_cvt_pk_bf16_f32 v108, v216, v217
    v_mfma_f32_16x16x32_bf16 v[138:141], a[20:23], a[236:239], v[138:141]
    v_cvt_pk_bf16_f32 v109, v218, v219
    v_cvt_pk_bf16_f32 v110, v220, v221
    v_mfma_f32_16x16x32_bf16 v[142:145], a[44:47], a[236:239], v[142:145]
    v_cvt_pk_bf16_f32 v111, v222, v223
    v_cvt_pk_bf16_f32 v112, v224, v225
    v_mfma_f32_16x16x32_bf16 v[146:149], a[68:71], a[236:239], v[146:149]
    v_cvt_pk_bf16_f32 v113, v226, v227
    v_cvt_pk_bf16_f32 v114, v228, v229
    v_mfma_f32_16x16x32_bf16 v[150:153], a[20:23], a[240:243], v[150:153]
    s_waitcnt vmcnt(9)
    ds_read_b64_tr_b16 a[80:81], v249 offset:0
    v_mfma_f32_16x16x32_bf16 v[154:157], a[44:47], a[240:243], v[154:157]
    ds_read_b64_tr_b16 a[82:83], v250 offset:0
    ds_read_b64_tr_b16 a[104:105], v249 offset:32
    v_mfma_f32_16x16x32_bf16 v[158:161], a[68:71], a[240:243], v[158:161]
    ds_read_b64_tr_b16 a[106:107], v250 offset:32
    ds_read_b64_tr_b16 a[128:129], v249 offset:64
    v_mfma_f32_16x16x32_bf16 v[162:165], a[20:23], a[244:247], v[162:165]
    ds_read_b64_tr_b16 a[130:131], v250 offset:64
    v_cvt_pk_bf16_f32 v115, v230, v231
    v_mfma_f32_16x16x32_bf16 v[24:27], a[44:47], a[244:247], v[24:27]
    v_cvt_pk_bf16_f32 v116, v232, v233
    v_cvt_pk_bf16_f32 v117, v234, v235
    v_mfma_f32_16x16x32_bf16 v[54:57], a[68:71], a[244:247], v[54:57]
    v_cvt_pk_bf16_f32 v118, v236, v237
    v_cvt_pk_bf16_f32 v119, v238, v239
    v_mfma_f32_16x16x32_bf16 v[84:87], a[216:219], a[72:75], 0
    v_cvt_pk_bf16_f32 v120, v138, v139
    v_cvt_pk_bf16_f32 v121, v140, v141
    v_mfma_f32_16x16x32_bf16 v[180:183], a[216:219], a[96:99], 0
    v_cvt_pk_bf16_f32 v122, v142, v143
    v_cvt_pk_bf16_f32 v123, v144, v145
    v_mfma_f32_16x16x32_bf16 v[184:187], a[216:219], a[120:123], 0
    v_cvt_pk_bf16_f32 v124, v146, v147
    v_cvt_pk_bf16_f32 v125, v148, v149
    v_cvt_pk_bf16_f32 v126, v150, v151
    v_cvt_pk_bf16_f32 v127, v152, v153
    v_cvt_pk_bf16_f32 v128, v154, v155
    v_cvt_pk_bf16_f32 v129, v156, v157
    v_cvt_pk_bf16_f32 v130, v158, v159
    v_cvt_pk_bf16_f32 v131, v160, v161
    v_cvt_pk_bf16_f32 v132, v162, v163
    v_cvt_pk_bf16_f32 v133, v164, v165
    v_cvt_pk_bf16_f32 v134, v24, v25
    v_cvt_pk_bf16_f32 v135, v26, v27
    s_waitcnt lgkmcnt(0)
    buffer_load_dwordx4 v172, s[8:11], s60 offen lds
    v_cvt_pk_bf16_f32 v136, v54, v55
    v_cvt_pk_bf16_f32 v137, v56, v57
    ds_read_b128 a[220:223], v240 offset:1536
    s_waitcnt vmcnt(7)
    ds_read_b64_tr_b16 a[84:85], v249 offset:3072
    ds_read_b64_tr_b16 a[86:87], v250 offset:3072
    ds_read_b64_tr_b16 a[108:109], v249 offset:3104
    ds_read_b64_tr_b16 a[110:111], v250 offset:3104
    ds_read_b64_tr_b16 a[132:133], v249 offset:3136
    ds_read_b64_tr_b16 a[134:135], v250 offset:3136
    ds_read_b128 a[224:227], v240 offset:3072
    ds_read_b128 a[228:231], v240 offset:4608
    ds_read_b128 a[232:235], v240 offset:30720
    ds_read_b128 a[236:239], v240 offset:32256
    ds_read_b128 a[240:243], v240 offset:33792
    ds_read_b128 a[244:247], v240 offset:35328
    ds_read_b128 a[216:219], v241 offset:0
    v_min_u32 v20, 55, v1
    v_lshlrev_b32 v62, 3, v20
    buffer_load_dwordx4 v173, s[8:11], s60 offen offset:1024 lds
    v_add_u32 v62, s64, v62
    v_lshrrev_b32 v21, 1, v20
    v_and_b32 v20, 1, v20
    v_lshlrev_b32 v20, 1, v20
    v_add_u32 v22, -12, v21
    v_cmp_lt_u32 vcc, 11, v21
    v_mov_b32 v23, s34
    v_add_u32 v63, 0, v20
    s_waitcnt lgkmcnt(13)
    v_mfma_f32_16x16x32_bf16 v[188:191], a[220:223], a[72:75], 0
    s_and_b32 s64, s48, 15
    v_cndmask_b32 v22, v21, v22, vcc
    v_cndmask_b32 v23, 0, v23, vcc
    v_mfma_f32_16x16x32_bf16 v[192:195], a[220:223], a[96:99], 0
    s_add_u32 s64, s64, s37
    v_add3_u32 v64, v22, v63, -6
    v_add_u32 v65, 3, v64
    v_mfma_f32_16x16x32_bf16 v[196:199], a[220:223], a[120:123], 0
    ds_read_b128 a[220:223], v241 offset:1536
    v_and_b32 v66, 12, v22
    v_add3_u32 v66, v66, v63, -3
    v_cmp_ne_u32 vcc, 0, v23
    v_mul_i32_i24 v64, s66, v64
    v_add_lshl_u32 v64, v64, 6, 1
    s_waitcnt lgkmcnt(7)
    v_mfma_f32_16x16x32_bf16 v[200:203], a[224:227], a[72:75], 0
    buffer_load_dwordx4 v174, s[8:11], s60 offen offset:2048 lds
    s_add_u32 m0, s29, 0xc00
    v_mfma_f32_16x16x32_bf16 v[204:207], a[224:227], a[96:99], 0
    s_add_u32 s60, s39, 0x24000
    s_waitcnt vmcnt(6) lgkmcnt(6)
    v_cndmask_b32 v65, v65, v66, vcc
    v_mfma_f32_16x16x32_bf16 v[208:211], a[224:227], a[120:123], 0
    ds_read_b64_tr_b16 a[88:89], v249 offset:6144
    ds_read_b64_tr_b16 a[90:91], v250 offset:6144
    v_mfma_f32_16x16x32_bf16 v[212:215], a[228:231], a[72:75], 0
    ds_read_b64_tr_b16 a[112:113], v249 offset:6176
    ds_read_b64_tr_b16 a[114:115], v250 offset:6176
    v_mfma_f32_16x16x32_bf16 v[216:219], a[228:231], a[96:99], 0
    ds_read_b64_tr_b16 a[136:137], v249 offset:6208
    ds_read_b64_tr_b16 a[138:139], v250 offset:6208
    v_mfma_f32_16x16x32_bf16 v[220:223], a[228:231], a[120:123], 0
    s_waitcnt lgkmcnt(8)
    ds_read_b128 a[224:227], v241 offset:3072
    v_mfma_f32_16x16x32_bf16 v[224:227], a[232:235], a[72:75], 0
    ds_read_b128 a[228:231], v241 offset:4608
    buffer_load_dwordx4 v172, s[8:11], s61 offen lds
    v_mfma_f32_16x16x32_bf16 v[228:231], a[232:235], a[96:99], 0
    s_waitcnt lgkmcnt(8)
    v_cmp_gt_u32 vcc, 7, v65
    v_mov_b32 v65, 0xf149f2ca
    v_mfma_f32_16x16x32_bf16 v[232:235], a[232:235], a[120:123], 0
    ds_read_b128 a[232:235], v241 offset:30720
    v_cndmask_b32 v50, 0, v64, vcc
    v_mfma_f32_16x16x32_bf16 v[236:239], a[236:239], a[72:75], 0
    v_mov_b32 v64, 0x3fb8aa3b
    v_cndmask_b32 v52, 0, v64, vcc
    v_mfma_f32_16x16x32_bf16 v[138:141], a[236:239], a[96:99], 0
    v_mov_b32 v64, 0
    v_cndmask_b32 v60, v65, v64, vcc
    v_mfma_f32_16x16x32_bf16 v[142:145], a[236:239], a[120:123], 0
    ds_read_b128 a[236:239], v241 offset:32256
    v_add_u32 v63, 1, v20
    v_mfma_f32_16x16x32_bf16 v[146:149], a[240:243], a[72:75], 0
    v_add3_u32 v64, v22, v63, -6
    v_add_u32 v65, 3, v64
    v_mfma_f32_16x16x32_bf16 v[150:153], a[240:243], a[96:99], 0
    v_and_b32 v66, 12, v22
    v_add3_u32 v66, v66, v63, -3
    v_mfma_f32_16x16x32_bf16 v[154:157], a[240:243], a[120:123], 0
    buffer_load_dwordx4 v173, s[8:11], s61 offen offset:1024 lds
    ds_read_b128 a[240:243], v241 offset:33792
    v_mfma_f32_16x16x32_bf16 v[158:161], a[244:247], a[72:75], 0
    s_waitcnt lgkmcnt(3)
    v_cmp_ne_u32 vcc, 0, v23
    v_mul_i32_i24 v64, s66, v64
    v_mfma_f32_16x16x32_bf16 v[162:165], a[244:247], a[96:99], 0
    s_mul_i32 s66, s28, 0xffffee00
    v_cndmask_b32 v65, v65, v66, vcc
    v_cmp_gt_u32 vcc, 7, v65
    v_mfma_f32_16x16x32_bf16 v[24:27], a[244:247], a[120:123], 0
    ds_read_b128 a[244:247], v241 offset:35328
    v_add_lshl_u32 v64, v64, 6, 1
    v_mfma_f32_16x16x32_bf16 v[84:87], a[216:219], a[76:79], v[84:87]
    s_waitcnt lgkmcnt(3)
    v_cndmask_b32 v51, 0, v64, vcc
    v_mov_b32 v64, 0x3fb8aa3b
    v_mfma_f32_16x16x32_bf16 v[180:183], a[216:219], a[100:103], v[180:183]
    v_cndmask_b32 v53, 0, v64, vcc
    v_mov_b32 v64, 0
    v_mfma_f32_16x16x32_bf16 v[184:187], a[216:219], a[124:127], v[184:187]
    s_waitcnt vmcnt(5) lgkmcnt(2)
    ds_read_b64_tr_b16 a[92:93], v249 offset:9216
    v_mfma_f32_16x16x32_bf16 v[188:191], a[220:223], a[76:79], v[188:191]
    buffer_load_dwordx4 v174, s[8:11], s61 offen offset:2048 lds
    s_add_u32 m0, s29, 0x1800
    v_mfma_f32_16x16x32_bf16 v[192:195], a[220:223], a[100:103], v[192:195]
    s_add_u32 s61, s39, 0x2d000
    ds_read_b64_tr_b16 a[94:95], v250 offset:9216
    v_mfma_f32_16x16x32_bf16 v[196:199], a[220:223], a[124:127], v[196:199]
    ds_read_b64_tr_b16 a[116:117], v249 offset:9248
    ds_read_b64_tr_b16 a[118:119], v250 offset:9248
    v_mfma_f32_16x16x32_bf16 v[200:203], a[224:227], a[76:79], v[200:203]
    ds_read_b64_tr_b16 a[140:141], v249 offset:9280
    ds_read_b64_tr_b16 a[142:143], v250 offset:9280
    v_mfma_f32_16x16x32_bf16 v[204:207], a[224:227], a[100:103], v[204:207]
    ds_read_b128 a[216:219], v240 offset:128
    ds_read_b128 a[220:223], v240 offset:1664
    v_mfma_f32_16x16x32_bf16 v[208:211], a[224:227], a[124:127], v[208:211]
    ds_read_b128 a[224:227], v240 offset:3200
    v_mov_b32 v65, 0xf149f2ca
    v_mfma_f32_16x16x32_bf16 v[212:215], a[228:231], a[76:79], v[212:215]
    s_waitcnt lgkmcnt(9)
    v_cndmask_b32 v61, v65, v64, vcc
    s_mov_b32 vcc_lo, 0xcccccccc
    v_mfma_f32_16x16x32_bf16 v[216:219], a[228:231], a[100:103], v[216:219]
    buffer_load_dwordx4 v172, s[8:11], s62 offen lds
    s_mov_b32 vcc_hi, 0xcccccccc
    v_mfma_f32_16x16x32_bf16 v[220:223], a[228:231], a[124:127], v[220:223]
    ds_read_b128 a[228:231], v240 offset:4736
    v_add_u32 v50, s64, v50
    v_mfma_f32_16x16x32_bf16 v[224:227], a[232:235], a[76:79], v[224:227]
    ds_read_u16 v30, v50 offset:3456
    v_add_u32 v51, s64, v51
    v_mfma_f32_16x16x32_bf16 v[228:231], a[232:235], a[100:103], v[228:231]
    ds_read_u16 v31, v51 offset:3456
    ds_read_u16 v32, v50 offset:3482
    v_mfma_f32_16x16x32_bf16 v[232:235], a[232:235], a[124:127], v[232:235]
    ds_read_b128 a[232:235], v240 offset:30848
    ds_read_u16 v33, v51 offset:3482
    v_mfma_f32_16x16x32_bf16 v[236:239], a[236:239], a[76:79], v[236:239]
    ds_read_u16 v34, v50 offset:3508
    ds_read_u16 v35, v51 offset:3508
    v_mfma_f32_16x16x32_bf16 v[138:141], a[236:239], a[100:103], v[138:141]
    ds_read_u16 v36, v50 offset:3534
    buffer_load_dwordx4 v173, s[8:11], s62 offen offset:1024 lds
    v_mfma_f32_16x16x32_bf16 v[142:145], a[236:239], a[124:127], v[142:145]
    ds_read_b128 a[236:239], v240 offset:32384
    ds_read_u16 v37, v51 offset:3534
    v_mfma_f32_16x16x32_bf16 v[146:149], a[240:243], a[76:79], v[146:149]
    ds_read_u16 v38, v50 offset:3560
    ds_read_u16 v39, v51 offset:3560
    v_mfma_f32_16x16x32_bf16 v[150:153], a[240:243], a[100:103], v[150:153]
    ds_read_u16 v40, v50 offset:3586
    ds_read_u16 v41, v51 offset:3586
    v_mfma_f32_16x16x32_bf16 v[154:157], a[240:243], a[124:127], v[154:157]
    ds_read_b128 a[240:243], v240 offset:33920
    s_waitcnt lgkmcnt(14)
    v_mfma_f32_16x16x32_bf16 v[158:161], a[244:247], a[76:79], v[158:161]
    ds_read_u16 v42, v50 offset:3612
    ds_read_u16 v43, v51 offset:3612
    v_mfma_f32_16x16x32_bf16 v[162:165], a[244:247], a[100:103], v[162:165]
    ds_read_u16 v44, v50 offset:3638
    ds_read_u16 v45, v51 offset:3638
    v_mfma_f32_16x16x32_bf16 v[24:27], a[244:247], a[124:127], v[24:27]
    buffer_load_dwordx4 v174, s[8:11], s62 offen offset:2048 lds
    s_add_u32 m0, s29, 0x2400
    v_mfma_f32_16x16x32_bf16 v[84:87], a[216:219], a[80:83], v[84:87]
    s_lshl_b32 s62, s28, 5
    s_add_u32 s62, s62, 0
    v_lshlrev_b32 v30, 16, v30
    v_mfma_f32_16x16x32_bf16 v[180:183], a[216:219], a[104:107], v[180:183]
    ds_read_b128 a[244:247], v240 offset:35456
    ds_read_u16 v46, v50 offset:3664
    v_mfma_f32_16x16x32_bf16 v[184:187], a[216:219], a[128:131], v[184:187]
    ds_read_b128 a[216:219], v241 offset:128
    ds_read_u16 v47, v51 offset:3664
    v_mfma_f32_16x16x32_bf16 v[188:191], a[220:223], a[80:83], v[188:191]
    ds_read_u16 v48, v50 offset:3690
    ds_read_u16 v49, v51 offset:3690
    v_mfma_f32_16x16x32_bf16 v[192:195], a[220:223], a[104:107], v[192:195]
    s_waitcnt lgkmcnt(11)
    v_fma_f32 v30, v30, v52, v60
    v_lshlrev_b32 v31, 16, v31
    v_mfma_f32_16x16x32_bf16 v[196:199], a[220:223], a[128:131], v[196:199]
    ds_read_b128 a[220:223], v241 offset:1664
    v_fma_f32 v31, v31, v53, v61
    v_mfma_f32_16x16x32_bf16 v[200:203], a[224:227], a[80:83], v[200:203]
    buffer_load_dwordx4 v172, s[8:11], s63 offen lds
    v_lshlrev_b32 v32, 16, v32
    v_mfma_f32_16x16x32_bf16 v[204:207], a[224:227], a[104:107], v[204:207]
    s_waitcnt vmcnt(7) lgkmcnt(7)
    ds_read_b64_tr_b16 a[144:145], v249 offset:0
    v_mfma_f32_16x16x32_bf16 v[208:211], a[224:227], a[128:131], v[208:211]
    ds_read_b64_tr_b16 a[146:147], v250 offset:0
    ds_read_b64_tr_b16 a[168:169], v249 offset:32
    v_mfma_f32_16x16x32_bf16 v[212:215], a[228:231], a[80:83], v[212:215]
    ds_read_b64_tr_b16 a[170:171], v250 offset:32
    ds_read_b64_tr_b16 a[192:193], v249 offset:64
    v_mfma_f32_16x16x32_bf16 v[216:219], a[228:231], a[104:107], v[216:219]
    ds_read_b64_tr_b16 a[194:195], v250 offset:64
    ds_read_b128 a[224:227], v241 offset:3200
    v_mfma_f32_16x16x32_bf16 v[220:223], a[228:231], a[128:131], v[220:223]
    ds_read_b128 a[228:231], v241 offset:4736
    v_fma_f32 v32, v32, v52, v60
    v_mfma_f32_16x16x32_bf16 v[224:227], a[232:235], a[80:83], v[224:227]
    ds_write_b64 v62, v[30:31] offset:0
    v_mfma_f32_16x16x32_bf16 v[228:231], a[232:235], a[104:107], v[228:231]
    buffer_load_dwordx4 v173, s[8:11], s63 offen offset:1024 lds
    v_add_u32 v62, s49, v62
    v_mfma_f32_16x16x32_bf16 v[232:235], a[232:235], a[128:131], v[232:235]
    ds_read_b128 a[232:235], v241 offset:30848
    v_lshlrev_b32 v33, 16, v33
    v_mfma_f32_16x16x32_bf16 v[236:239], a[236:239], a[80:83], v[236:239]
    s_waitcnt lgkmcnt(10)
    v_fma_f32 v33, v33, v53, v61
    v_lshlrev_b32 v34, 16, v34
    v_mfma_f32_16x16x32_bf16 v[138:141], a[236:239], a[104:107], v[138:141]
    ds_write_b64 v62, v[32:33] offset:0
    v_mfma_f32_16x16x32_bf16 v[142:145], a[236:239], a[128:131], v[142:145]
    ds_read_b128 a[236:239], v241 offset:32384
    v_add_u32 v62, s49, v62
    v_mfma_f32_16x16x32_bf16 v[146:149], a[240:243], a[80:83], v[146:149]
    v_fma_f32 v34, v34, v52, v60
    v_lshlrev_b32 v35, 16, v35
    v_mfma_f32_16x16x32_bf16 v[150:153], a[240:243], a[104:107], v[150:153]
    s_waitcnt lgkmcnt(5)
    v_fma_f32 v35, v35, v53, v61
    v_lshlrev_b32 v36, 16, v36
    v_mfma_f32_16x16x32_bf16 v[154:157], a[240:243], a[128:131], v[154:157]
    buffer_load_dwordx4 v174, s[8:11], s63 offen offset:2048 lds
    s_add_u32 m0, s29, 0
    v_mfma_f32_16x16x32_bf16 v[158:161], a[244:247], a[80:83], v[158:161]
    s_lshl_b32 s63, s28, 5
    s_add_u32 s63, s63, 0x4800
    v_fma_f32 v36, v36, v52, v60
    v_mfma_f32_16x16x32_bf16 v[162:165], a[244:247], a[104:107], v[162:165]
    ds_read_b128 a[240:243], v241 offset:33920
    v_lshlrev_b32 v37, 16, v37
    v_mfma_f32_16x16x32_bf16 v[24:27], a[244:247], a[128:131], v[24:27]
    ds_read_b128 a[244:247], v241 offset:35456
    v_fma_f32 v37, v37, v53, v61
    v_mfma_f32_16x16x32_bf16 v[84:87], a[216:219], a[84:87], v[84:87]
    ds_write_b64 v62, v[34:35] offset:0
    v_mfma_f32_16x16x32_bf16 v[180:183], a[216:219], a[108:111], v[180:183]
    s_waitcnt lgkmcnt(3)
    v_add_u32 v62, s49, v62
    v_lshlrev_b32 v38, 16, v38
    v_mfma_f32_16x16x32_bf16 v[184:187], a[216:219], a[132:135], v[184:187]
    ds_read_b128 a[216:219], v240 offset:256
    buffer_load_dwordx4 v172, s[8:11], s60 offen lds
    v_mfma_f32_16x16x32_bf16 v[188:191], a[220:223], a[84:87], v[188:191]
    ds_write_b64 v62, v[36:37] offset:0
    v_mfma_f32_16x16x32_bf16 v[192:195], a[220:223], a[108:111], v[192:195]
    s_waitcnt vmcnt(7)
    ds_read_b64_tr_b16 a[148:149], v249 offset:3072
    v_mfma_f32_16x16x32_bf16 v[196:199], a[220:223], a[132:135], v[196:199]
    ds_read_b64_tr_b16 a[150:151], v250 offset:3072
    ds_read_b64_tr_b16 a[172:173], v249 offset:3104
    v_mfma_f32_16x16x32_bf16 v[200:203], a[224:227], a[84:87], v[200:203]
    ds_read_b64_tr_b16 a[174:175], v250 offset:3104
    ds_read_b64_tr_b16 a[196:197], v249 offset:3136
    v_mfma_f32_16x16x32_bf16 v[204:207], a[224:227], a[108:111], v[204:207]
    ds_read_b64_tr_b16 a[198:199], v250 offset:3136
    ds_read_b128 a[220:223], v240 offset:1792
    v_mfma_f32_16x16x32_bf16 v[208:211], a[224:227], a[132:135], v[208:211]
    ds_read_b128 a[224:227], v240 offset:3328
    v_add_u32 v62, s49, v62
    v_mfma_f32_16x16x32_bf16 v[212:215], a[228:231], a[84:87], v[212:215]
    buffer_load_dwordx4 v173, s[8:11], s60 offen offset:1024 lds
    v_fma_f32 v38, v38, v52, v60
    v_mfma_f32_16x16x32_bf16 v[216:219], a[228:231], a[108:111], v[216:219]
    s_waitcnt lgkmcnt(9)
    v_lshlrev_b32 v39, 16, v39
    v_fma_f32 v39, v39, v53, v61
    v_mfma_f32_16x16x32_bf16 v[220:223], a[228:231], a[132:135], v[220:223]
    ds_read_b128 a[228:231], v240 offset:4864
    v_lshlrev_b32 v40, 16, v40
    v_mfma_f32_16x16x32_bf16 v[224:227], a[232:235], a[84:87], v[224:227]
    ds_write_b64 v62, v[38:39] offset:0
    v_mfma_f32_16x16x32_bf16 v[228:231], a[232:235], a[108:111], v[228:231]
    v_add_u32 v62, s49, v62
    v_fma_f32 v40, v40, v52, v60
    v_mfma_f32_16x16x32_bf16 v[232:235], a[232:235], a[132:135], v[232:235]
    ds_read_b128 a[232:235], v240 offset:30976
    v_lshlrev_b32 v41, 16, v41
    v_mfma_f32_16x16x32_bf16 v[236:239], a[236:239], a[84:87], v[236:239]
    v_fma_f32 v41, v41, v53, v61
    v_lshlrev_b32 v42, 16, v42
    v_mfma_f32_16x16x32_bf16 v[138:141], a[236:239], a[108:111], v[138:141]
    buffer_load_dwordx4 v174, s[8:11], s60 offen offset:2048 lds
    s_add_u32 m0, s29, 0xc00
    v_mfma_f32_16x16x32_bf16 v[142:145], a[236:239], a[132:135], v[142:145]
    s_waitcnt lgkmcnt(3)
    s_lshl_b32 s60, s28, 5
    s_add_u32 s60, s60, 0x1800
    v_mfma_f32_16x16x32_bf16 v[146:149], a[240:243], a[84:87], v[146:149]
    ds_read_b128 a[236:239], v240 offset:32512
    v_fma_f32 v42, v42, v52, v60
    v_mfma_f32_16x16x32_bf16 v[150:153], a[240:243], a[108:111], v[150:153]
    ds_write_b64 v62, v[40:41] offset:0
    v_mfma_f32_16x16x32_bf16 v[154:157], a[240:243], a[132:135], v[154:157]
    ds_read_b128 a[240:243], v240 offset:34048
    v_add_u32 v62, s49, v62
    v_mfma_f32_16x16x32_bf16 v[158:161], a[244:247], a[84:87], v[158:161]
    s_waitcnt lgkmcnt(5)
    v_lshlrev_b32 v43, 16, v43
    v_fma_f32 v43, v43, v53, v61
    v_mfma_f32_16x16x32_bf16 v[162:165], a[244:247], a[108:111], v[162:165]
    ds_write_b64 v62, v[42:43] offset:0
    v_mfma_f32_16x16x32_bf16 v[24:27], a[244:247], a[132:135], v[24:27]
    buffer_load_dwordx4 v172, s[8:11], s61 offen lds
    s_waitcnt vmcnt(7) lgkmcnt(4)
    v_mfma_f32_16x16x32_bf16 v[84:87], a[216:219], a[88:91], v[84:87]
    ds_read_b64_tr_b16 a[152:153], v249 offset:6144
    ds_read_b64_tr_b16 a[154:155], v250 offset:6144
    v_mfma_f32_16x16x32_bf16 v[180:183], a[216:219], a[112:115], v[180:183]
    ds_read_b64_tr_b16 a[176:177], v249 offset:6176
    ds_read_b64_tr_b16 a[178:179], v250 offset:6176
    v_mfma_f32_16x16x32_bf16 v[184:187], a[216:219], a[136:139], v[184:187]
    ds_read_b64_tr_b16 a[200:201], v249 offset:6208
    ds_read_b64_tr_b16 a[202:203], v250 offset:6208
    v_mfma_f32_16x16x32_bf16 v[188:191], a[220:223], a[88:91], v[188:191]
    ds_read_b128 a[244:247], v240 offset:35584
    ds_read_b128 a[216:219], v241 offset:256
    v_mfma_f32_16x16x32_bf16 v[192:195], a[220:223], a[112:115], v[192:195]
    s_waitcnt lgkmcnt(9)
    v_add_u32 v62, s49, v62
    v_lshlrev_b32 v44, 16, v44
    v_mfma_f32_16x16x32_bf16 v[196:199], a[220:223], a[136:139], v[196:199]
    ds_read_b128 a[220:223], v241 offset:1792
    buffer_load_dwordx4 v173, s[8:11], s61 offen offset:1024 lds
    v_mfma_f32_16x16x32_bf16 v[200:203], a[224:227], a[88:91], v[200:203]
    v_fma_f32 v44, v44, v52, v60
    v_lshlrev_b32 v45, 16, v45
    v_mfma_f32_16x16x32_bf16 v[204:207], a[224:227], a[112:115], v[204:207]
    v_fma_f32 v45, v45, v53, v61
    v_lshlrev_b32 v46, 16, v46
    v_mfma_f32_16x16x32_bf16 v[208:211], a[224:227], a[136:139], v[208:211]
    ds_read_b128 a[224:227], v241 offset:3328
    v_fma_f32 v46, v46, v52, v60
    v_mfma_f32_16x16x32_bf16 v[212:215], a[228:231], a[88:91], v[212:215]
    ds_write_b64 v62, v[44:45] offset:0
    v_mfma_f32_16x16x32_bf16 v[216:219], a[228:231], a[112:115], v[216:219]
    v_add_u32 v62, s49, v62
    v_lshlrev_b32 v47, 16, v47
    v_mfma_f32_16x16x32_bf16 v[220:223], a[228:231], a[136:139], v[220:223]
    ds_read_b128 a[228:231], v241 offset:4864
    v_fma_f32 v47, v47, v53, v61
    v_mfma_f32_16x16x32_bf16 v[224:227], a[232:235], a[88:91], v[224:227]
    buffer_load_dwordx4 v174, s[8:11], s61 offen offset:2048 lds
    s_add_u32 m0, s46, 0x1800
    v_mfma_f32_16x16x32_bf16 v[228:231], a[232:235], a[112:115], v[228:231]
    s_lshl_b32 s61, s28, 5
    s_add_u32 s61, s61, 0x6000
    v_lshlrev_b32 v48, 16, v48
    v_mfma_f32_16x16x32_bf16 v[232:235], a[232:235], a[136:139], v[232:235]
    ds_read_b128 a[232:235], v241 offset:30976
    v_fma_f32 v48, v48, v52, v60
    v_mfma_f32_16x16x32_bf16 v[236:239], a[236:239], a[88:91], v[236:239]
    ds_write_b64 v62, v[46:47] offset:0
    v_mfma_f32_16x16x32_bf16 v[138:141], a[236:239], a[112:115], v[138:141]
    s_waitcnt lgkmcnt(4)
    v_add_u32 v62, s49, v62
    v_lshlrev_b32 v49, 16, v49
    v_mfma_f32_16x16x32_bf16 v[142:145], a[236:239], a[136:139], v[142:145]
    ds_read_b128 a[236:239], v241 offset:32512
    v_fma_f32 v49, v49, v53, v61
    v_mfma_f32_16x16x32_bf16 v[146:149], a[240:243], a[88:91], v[146:149]
    ds_write_b64 v62, v[48:49] offset:0
    v_mfma_f32_16x16x32_bf16 v[150:153], a[240:243], a[112:115], v[150:153]
    buffer_load_dwordx4 v168, s[4:7], s58 offen lds
    s_waitcnt vmcnt(7) lgkmcnt(4)
    v_mfma_f32_16x16x32_bf16 v[154:157], a[240:243], a[136:139], v[154:157]
    ds_read_b64_tr_b16 a[156:157], v249 offset:9216
    ds_read_b64_tr_b16 a[158:159], v250 offset:9216
    v_mfma_f32_16x16x32_bf16 v[158:161], a[244:247], a[88:91], v[158:161]
    ds_read_b64_tr_b16 a[180:181], v249 offset:9248
    ds_read_b64_tr_b16 a[182:183], v250 offset:9248
    v_mfma_f32_16x16x32_bf16 v[162:165], a[244:247], a[112:115], v[162:165]
    ds_read_b64_tr_b16 a[204:205], v249 offset:9280
    ds_read_b64_tr_b16 a[206:207], v250 offset:9280
    v_mfma_f32_16x16x32_bf16 v[24:27], a[244:247], a[136:139], v[24:27]
    buffer_load_dwordx4 v171, s[4:7], s58 offen offset:512 lds
    s_lshl1_add_u32 s58, s45, s41
    v_mfma_f32_16x16x32_bf16 v[84:87], a[216:219], a[92:95], v[84:87]
    s_add_u32 m0, s46, 0x9000
    ds_read_b128 a[240:243], v241 offset:34048
    v_mfma_f32_16x16x32_bf16 v[180:183], a[216:219], a[116:119], v[180:183]
    ds_read_b128 a[244:247], v241 offset:35584
    v_add_u32 v62, s49, v62
    v_mfma_f32_16x16x32_bf16 v[184:187], a[216:219], a[140:143], v[184:187]
    ds_read_b128 a[216:219], v240 offset:61440
    v_mov_b32 v64, 0xf149f2ca
    v_mfma_f32_16x16x32_bf16 v[188:191], a[220:223], a[92:95], v[188:191]
    buffer_load_dwordx4 v168, s[4:7], s58 offen lds
    v_cvt_pk_bf16_f32 v0, v84, v85
    v_mfma_f32_16x16x32_bf16 v[192:195], a[220:223], a[116:119], v[192:195]
    s_waitcnt lgkmcnt(10)
    v_cvt_pk_bf16_f32 v3, v86, v87
    v_cvt_pk_bf16_f32 v30, v180, v181
    v_mfma_f32_16x16x32_bf16 v[196:199], a[220:223], a[140:143], v[196:199]
    v_cvt_pk_bf16_f32 v33, v182, v183
    v_cvt_pk_bf16_f32 v60, v184, v185
    v_mfma_f32_16x16x32_bf16 v[200:203], a[224:227], a[92:95], v[200:203]
    v_cvt_pk_bf16_f32 v6, v188, v189
    v_cvt_pk_bf16_f32 v9, v190, v191
    v_mfma_f32_16x16x32_bf16 v[204:207], a[224:227], a[116:119], v[204:207]
    buffer_load_dwordx4 v171, s[4:7], s58 offen offset:512 lds
    s_lshl1_add_u32 s58, s45, s42
    v_mfma_f32_16x16x32_bf16 v[208:211], a[224:227], a[140:143], v[208:211]
    s_add_u32 m0, s46, 0x10800
    v_cvt_pk_bf16_f32 v36, v192, v193
    v_cvt_pk_bf16_f32 v39, v194, v195
    v_mfma_f32_16x16x32_bf16 v[212:215], a[228:231], a[92:95], v[212:215]
    s_waitcnt lgkmcnt(2)
    v_cvt_pk_bf16_f32 v66, v196, v197
    v_cvt_pk_bf16_f32 v69, v198, v199
    v_mfma_f32_16x16x32_bf16 v[216:219], a[228:231], a[116:119], v[216:219]
    s_waitcnt lgkmcnt(1)
    v_cvt_pk_bf16_f32 v12, v200, v201
    v_cvt_pk_bf16_f32 v15, v202, v203
    v_mfma_f32_16x16x32_bf16 v[220:223], a[228:231], a[140:143], v[220:223]
    buffer_load_dwordx4 v168, s[4:7], s58 offen lds
    v_cvt_pk_bf16_f32 v42, v204, v205
    v_mfma_f32_16x16x32_bf16 v[224:227], a[232:235], a[92:95], v[224:227]
    v_cvt_pk_bf16_f32 v45, v206, v207
    v_cvt_pk_bf16_f32 v72, v208, v209
    v_mfma_f32_16x16x32_bf16 v[228:231], a[232:235], a[116:119], v[228:231]
    v_cvt_pk_bf16_f32 v75, v210, v211
    v_cvt_pk_bf16_f32 v18, v212, v213
    v_mfma_f32_16x16x32_bf16 v[232:235], a[232:235], a[140:143], v[232:235]
    v_cvt_pk_bf16_f32 v21, v214, v215
    v_cvt_pk_bf16_f32 v48, v216, v217
    v_mfma_f32_16x16x32_bf16 v[236:239], a[236:239], a[92:95], v[236:239]
    buffer_load_dwordx4 v171, s[4:7], s58 offen offset:512 lds
    v_cvt_pk_bf16_f32 v51, v218, v219
    v_mfma_f32_16x16x32_bf16 v[138:141], a[236:239], a[116:119], v[138:141]
    s_add_u32 m0, s46, 0x16800
    s_waitcnt vmcnt(9)
    v_cvt_pk_bf16_f32 v78, v220, v221
    v_mfma_f32_16x16x32_bf16 v[142:145], a[236:239], a[140:143], v[142:145]
    ds_read_b64_tr_b16 a[160:161], v249 offset:0
    ds_read_b64_tr_b16 a[162:163], v250 offset:0
    v_mfma_f32_16x16x32_bf16 v[146:149], a[240:243], a[92:95], v[146:149]
    ds_read_b64_tr_b16 a[184:185], v249 offset:32
    ds_read_b64_tr_b16 a[186:187], v250 offset:32
    v_mfma_f32_16x16x32_bf16 v[150:153], a[240:243], a[116:119], v[150:153]
    ds_read_b64_tr_b16 a[208:209], v249 offset:64
    ds_read_b64_tr_b16 a[210:211], v250 offset:64
    v_mfma_f32_16x16x32_bf16 v[154:157], a[240:243], a[140:143], v[154:157]
    s_lshl1_add_u32 s58, s45, s43
    v_cvt_pk_bf16_f32 v81, v222, v223
    v_cvt_pk_bf16_f32 v4, v226, v227
    v_mfma_f32_16x16x32_bf16 v[158:161], a[244:247], a[92:95], v[158:161]
    v_cvt_pk_bf16_f32 v31, v228, v229
    v_cvt_pk_bf16_f32 v34, v230, v231
    v_mfma_f32_16x16x32_bf16 v[162:165], a[244:247], a[116:119], v[162:165]
    s_waitcnt lgkmcnt(6)
    v_cvt_pk_bf16_f32 v61, v232, v233
    v_cvt_pk_bf16_f32 v7, v236, v237
    v_mfma_f32_16x16x32_bf16 v[24:27], a[244:247], a[140:143], v[24:27]
    v_cvt_pk_bf16_f32 v10, v238, v239
    v_cvt_pk_bf16_f32 v37, v138, v139
    v_mfma_f32_16x16x32_bf16 v[228:231], a[0:3], a[216:219], 0
    v_cvt_pk_bf16_f32 v40, v140, v141
    v_cvt_pk_bf16_f32 v67, v142, v143
    v_mfma_f32_16x16x32_bf16 v[236:239], a[48:51], a[216:219], 0
    v_cvt_pk_bf16_f32 v70, v144, v145
    v_cvt_pk_bf16_f32 v13, v146, v147
    v_cvt_pk_bf16_f32 v16, v148, v149
    v_cvt_pk_bf16_f32 v43, v150, v151
    v_cvt_pk_bf16_f32 v46, v152, v153
    v_cvt_pk_bf16_f32 v73, v154, v155
    v_cvt_pk_bf16_f32 v76, v156, v157
    v_cvt_pk_bf16_f32 v19, v158, v159
    v_cvt_pk_bf16_f32 v22, v160, v161
    v_cvt_pk_bf16_f32 v49, v162, v163
    v_cvt_pk_bf16_f32 v52, v164, v165
    v_cvt_pk_bf16_f32 v79, v24, v25
    v_cvt_pk_bf16_f32 v82, v26, v27
    ds_read_b128 a[220:223], v241 offset:61440
    ds_read_b128 a[224:227], v240 offset:61568
    ds_read_b128 a[228:231], v241 offset:61568
    ds_read_b128 a[232:235], v240 offset:61696
    ds_read_b128 a[236:239], v241 offset:61696
    ds_read_b128 a[240:243], v240 offset:62976
    ds_read_b128 a[244:247], v241 offset:62976
    v_mov_b32 v195, 0
    v_mov_b32 v65, 0xf149f2ca
    v_lshlrev_b32 v63, 3, v1
    v_cvt_pk_bf16_f32 v1, v224, v225
    v_add_u32 v63, 0x237c0, v63
    ds_write_b64 v63, v[64:65] offset:0
    v_cvt_pk_bf16_f32 v63, v186, v187
    v_cvt_pk_bf16_f32 v64, v234, v235
    v_mfma_f32_16x16x32_bf16 v[232:235], a[24:27], a[216:219], 0
    ds_read_b128 v[196:199], v244 offset:192
    ds_read_b128 v[200:203], v245 offset:192
    ds_read_b128 v[204:207], v246 offset:192
    ds_read_b128 v[208:211], v244 offset:256
    s_waitcnt lgkmcnt(11)
    v_mfma_f32_16x16x32_bf16 v[228:231], a[4:7], a[220:223], v[228:231]
    s_waitcnt vmcnt(6)
    ds_read_b64_tr_b16 a[164:165], v249 offset:3072
    v_mfma_f32_16x16x32_bf16 v[232:235], a[28:31], a[220:223], v[232:235]
    ds_read_b64_tr_b16 a[166:167], v250 offset:3072
    ds_read_b64_tr_b16 a[188:189], v249 offset:3104
    v_mfma_f32_16x16x32_bf16 v[236:239], a[52:55], a[220:223], v[236:239]
    s_waitcnt lgkmcnt(13)
    ds_read_b64_tr_b16 a[190:191], v250 offset:3104
    v_mfma_f32_16x16x32_bf16 v[228:231], a[8:11], a[224:227], v[228:231]
    ds_read_b64_tr_b16 a[212:213], v249 offset:3136
    ds_read_b64_tr_b16 a[214:215], v250 offset:3136
    v_mfma_f32_16x16x32_bf16 v[232:235], a[32:35], a[224:227], v[232:235]
    s_waitcnt lgkmcnt(15)
    v_add_u32 v249, s66, v249
    v_add_u32 v250, s66, v250
    v_mfma_f32_16x16x32_bf16 v[228:231], a[12:15], a[228:231], v[228:231]
    s_lshl_b32 s66, s28, 1
    s_waitcnt lgkmcnt(14)
    v_mfma_f32_16x16x32_bf16 v[228:231], a[16:19], a[232:235], v[228:231]
    s_waitcnt lgkmcnt(13)
    v_mfma_f32_16x16x32_bf16 v[228:231], a[20:23], a[236:239], v[228:231]
    v_mfma_f32_16x16x32_bf16 v[232:235], a[36:39], a[228:231], v[232:235]
    v_mfma_f32_16x16x32_bf16 v[232:235], a[40:43], a[232:235], v[232:235]
    v_mfma_f32_16x16x32_bf16 v[232:235], a[44:47], a[236:239], v[232:235]
    v_mfma_f32_16x16x32_bf16 v[236:239], a[56:59], a[224:227], v[236:239]
    v_mfma_f32_16x16x32_bf16 v[236:239], a[60:63], a[228:231], v[236:239]
    v_mfma_f32_16x16x32_bf16 v[236:239], a[64:67], a[232:235], v[236:239]
    v_mfma_f32_16x16x32_bf16 v[236:239], a[68:71], a[236:239], v[236:239]
    s_nop 0
    v_cvt_pk_bf16_f32 v138, v228, v229
    v_cvt_pk_bf16_f32 v139, v230, v231
    v_mfma_f32_16x16x32_bf16 v[228:231], a[216:219], a[72:75], 0
    v_cvt_pk_bf16_f32 v140, v232, v233
    v_cvt_pk_bf16_f32 v141, v234, v235
    v_mfma_f32_16x16x32_bf16 v[228:231], a[220:223], a[76:79], v[228:231]
    v_mfma_f32_16x16x32_bf16 v[228:231], a[224:227], a[80:83], v[228:231]
    v_cvt_pk_bf16_f32 v142, v236, v237
    v_cvt_pk_bf16_f32 v143, v238, v239
    v_mfma_f32_16x16x32_bf16 v[228:231], a[228:231], a[84:87], v[228:231]
    v_mfma_f32_16x16x32_bf16 v[228:231], a[232:235], a[88:91], v[228:231]
    v_mfma_f32_16x16x32_bf16 v[228:231], a[236:239], a[92:95], v[228:231]
    v_mfma_f32_16x16x32_bf16 v[232:235], a[216:219], a[96:99], 0
    v_mfma_f32_16x16x32_bf16 v[232:235], a[220:223], a[100:103], v[232:235]
    v_mfma_f32_16x16x32_bf16 v[232:235], a[224:227], a[104:107], v[232:235]
    v_mfma_f32_16x16x32_bf16 v[232:235], a[228:231], a[108:111], v[232:235]
    v_mfma_f32_16x16x32_bf16 v[232:235], a[232:235], a[112:115], v[232:235]
    v_mfma_f32_16x16x32_bf16 v[232:235], a[236:239], a[116:119], v[232:235]
    v_mfma_f32_16x16x32_bf16 v[236:239], a[216:219], a[120:123], 0
    ds_read_b128 a[216:219], v240 offset:63104
    v_cvt_pk_bf16_f32 v2, v228, v229
    v_mfma_f32_16x16x32_bf16 v[236:239], a[220:223], a[124:127], v[236:239]
    ds_read_b128 a[220:223], v241 offset:63104
    v_cvt_pk_bf16_f32 v5, v230, v231
    v_mfma_f32_16x16x32_bf16 v[236:239], a[224:227], a[128:131], v[236:239]
    ds_read_b128 a[224:227], v240 offset:63232
    v_cvt_pk_bf16_f32 v32, v232, v233
    v_mfma_f32_16x16x32_bf16 v[236:239], a[228:231], a[132:135], v[236:239]
    ds_read_b128 a[228:231], v241 offset:63232
    v_cvt_pk_bf16_f32 v35, v234, v235
    v_mfma_f32_16x16x32_bf16 v[236:239], a[232:235], a[136:139], v[236:239]
    ds_read_b128 a[232:235], v240 offset:64512
    s_waitcnt vmcnt(0) lgkmcnt(5)
    v_mfma_f32_16x16x32_bf16 v[236:239], a[236:239], a[140:143], v[236:239]
    ds_read_b128 a[236:239], v241 offset:64512
    s_barrier
    v_mfma_f32_16x16x32_bf16 v[228:231], a[0:3], a[240:243], 0
    buffer_load_dwordx4 v254, s[4:7], s43 offen lds
    v_accvgpr_read_b32 v254, a254
    v_mfma_f32_16x16x32_bf16 v[228:231], a[4:7], a[244:247], v[228:231]
    v_mfma_f32_16x16x32_bf16 v[232:235], a[24:27], a[240:243], 0
    v_mfma_f32_16x16x32_bf16 v[232:235], a[28:31], a[244:247], v[232:235]
    s_waitcnt lgkmcnt(5)
    v_cvt_pk_bf16_f32 v62, v236, v237
    v_cvt_pk_bf16_f32 v65, v238, v239
    v_mfma_f32_16x16x32_bf16 v[228:231], a[8:11], a[216:219], v[228:231]
    buffer_load_dwordx4 v255, s[4:7], s43 offen offset:1024 lds
    v_accvgpr_read_b32 v255, a252
    v_mfma_f32_16x16x32_bf16 v[232:235], a[32:35], a[216:219], v[232:235]
    s_waitcnt lgkmcnt(4)
    v_mfma_f32_16x16x32_bf16 v[228:231], a[12:15], a[220:223], v[228:231]
    s_waitcnt lgkmcnt(3)
    v_mfma_f32_16x16x32_bf16 v[228:231], a[16:19], a[224:227], v[228:231]
    s_waitcnt lgkmcnt(2)
    v_mfma_f32_16x16x32_bf16 v[228:231], a[20:23], a[228:231], v[228:231]
    buffer_load_dwordx4 v254, s[4:7], s43 offen offset:2048 lds
    s_add_u32 m0, s46, 0x17400
    v_mfma_f32_16x16x32_bf16 v[232:235], a[36:39], a[220:223], v[232:235]
    v_accvgpr_read_b32 v254, a253
    v_mfma_f32_16x16x32_bf16 v[232:235], a[40:43], a[224:227], v[232:235]
    v_mfma_f32_16x16x32_bf16 v[232:235], a[44:47], a[228:231], v[232:235]
    v_mfma_f32_16x16x32_bf16 v[236:239], a[48:51], a[240:243], 0
    buffer_load_dwordx4 v255, s[4:7], s59 offen lds
    v_cvt_pk_bf16_f32 v144, v228, v229
    v_mfma_f32_16x16x32_bf16 v[236:239], a[52:55], a[244:247], v[236:239]
    v_cvt_pk_bf16_f32 v145, v230, v231
    v_accvgpr_read_b32 v255, a254
    v_mfma_f32_16x16x32_bf16 v[236:239], a[56:59], a[216:219], v[236:239]
    v_mfma_f32_16x16x32_bf16 v[236:239], a[60:63], a[220:223], v[236:239]
    v_cvt_pk_bf16_f32 v146, v232, v233
    v_cvt_pk_bf16_f32 v147, v234, v235
    v_mfma_f32_16x16x32_bf16 v[236:239], a[64:67], a[224:227], v[236:239]
    buffer_load_dwordx4 v254, s[4:7], s59 offen offset:1024 lds
    v_accvgpr_read_b32 v254, a252
    v_mfma_f32_16x16x32_bf16 v[236:239], a[68:71], a[228:231], v[236:239]
    v_mfma_f32_16x16x32_bf16 v[228:231], a[240:243], a[72:75], 0
    v_mfma_f32_16x16x32_bf16 v[228:231], a[244:247], a[76:79], v[228:231]
    v_mfma_f32_16x16x32_bf16 v[228:231], a[216:219], a[80:83], v[228:231]
    buffer_load_dwordx4 v255, s[4:7], s59 offen offset:2048 lds
    s_add_u32 m0, s46, 0x18000
    v_mfma_f32_16x16x32_bf16 v[228:231], a[220:223], a[84:87], v[228:231]
    s_add_u32 s59, s44, s45
    v_accvgpr_read_b32 v255, a255
    v_cvt_pk_bf16_f32 v148, v236, v237
    v_mfma_f32_16x16x32_bf16 v[228:231], a[224:227], a[88:91], v[228:231]
    v_cvt_pk_bf16_f32 v149, v238, v239
    v_mfma_f32_16x16x32_bf16 v[228:231], a[228:231], a[92:95], v[228:231]
    v_mfma_f32_16x16x32_bf16 v[232:235], a[240:243], a[96:99], 0
    buffer_load_dwordx4 v254, s[4:7], s58 offen lds
    v_xor_b32 v254, 16, v242
    v_mfma_f32_16x16x32_bf16 v[232:235], a[244:247], a[100:103], v[232:235]
    v_add_u32 v254, 0x7500, v254
    v_cndmask_b32 v254, v242, v254, vcc
    v_mfma_f32_16x16x32_bf16 v[232:235], a[216:219], a[104:107], v[232:235]
    s_mov_b32 vcc_lo, 0x33333333
    v_cvt_pk_bf16_f32 v8, v228, v229
    v_cvt_pk_bf16_f32 v11, v230, v231
    v_mfma_f32_16x16x32_bf16 v[232:235], a[220:223], a[108:111], v[232:235]
    s_mov_b32 vcc_hi, 0x33333333
    s_waitcnt lgkmcnt(0)
    v_mfma_f32_16x16x32_bf16 v[232:235], a[224:227], a[112:115], v[232:235]
    buffer_load_dwordx4 v255, s[4:7], s58 offen offset:512 lds
    v_xor_b32 v255, 64, v254
    v_mfma_f32_16x16x32_bf16 v[232:235], a[228:231], a[116:119], v[232:235]
    s_add_u32 m0, s46, 0
    s_lshl1_add_u32 s58, s45, s44
    v_mfma_f32_16x16x32_bf16 v[236:239], a[240:243], a[120:123], 0
    ds_read_b128 a[240:243], v240 offset:64640
    v_mfma_f32_16x16x32_bf16 v[236:239], a[244:247], a[124:127], v[236:239]
    ds_read_b128 a[244:247], v241 offset:64640
    v_mfma_f32_16x16x32_bf16 v[236:239], a[216:219], a[128:131], v[236:239]
    ds_read_b128 a[216:219], v240 offset:64768
    v_cvt_pk_bf16_f32 v38, v232, v233
    v_mfma_f32_16x16x32_bf16 v[236:239], a[220:223], a[132:135], v[236:239]
    ds_read_b128 a[220:223], v241 offset:64768
    v_cvt_pk_bf16_f32 v41, v234, v235
    v_mfma_f32_16x16x32_bf16 v[236:239], a[224:227], a[136:139], v[236:239]
    ds_read_b128 a[224:227], v242 offset:0
    v_add_u32 v240, 0xf000, v240
    v_mfma_f32_16x16x32_bf16 v[236:239], a[228:231], a[140:143], v[236:239]
    ds_read_b128 a[228:231], v243 offset:0
    v_add_u32 v241, 0xf000, v241
    v_mfma_f32_16x16x32_bf16 v[228:231], a[0:3], a[232:235], 0
    v_mfma_f32_16x16x32_bf16 v[228:231], a[4:7], a[236:239], v[228:231]
    v_mfma_f32_16x16x32_bf16 v[232:235], a[24:27], a[232:235], 0
    v_mfma_f32_16x16x32_bf16 v[232:235], a[28:31], a[236:239], v[232:235]
    s_waitcnt lgkmcnt(5)
    v_mfma_f32_16x16x32_bf16 v[228:231], a[8:11], a[240:243], v[228:231]
    s_waitcnt lgkmcnt(4)
    v_cvt_pk_bf16_f32 v68, v236, v237
    v_cvt_pk_bf16_f32 v71, v238, v239
    v_mfma_f32_16x16x32_bf16 v[228:231], a[12:15], a[244:247], v[228:231]
    s_waitcnt lgkmcnt(3)
    v_mfma_f32_16x16x32_bf16 v[228:231], a[16:19], a[216:219], v[228:231]
    s_waitcnt lgkmcnt(2)
    v_mfma_f32_16x16x32_bf16 v[228:231], a[20:23], a[220:223], v[228:231]
    v_mfma_f32_16x16x32_bf16 v[232:235], a[32:35], a[240:243], v[232:235]
    v_mfma_f32_16x16x32_bf16 v[232:235], a[36:39], a[244:247], v[232:235]
    v_mfma_f32_16x16x32_bf16 v[232:235], a[40:43], a[216:219], v[232:235]
    v_mfma_f32_16x16x32_bf16 v[232:235], a[44:47], a[220:223], v[232:235]
    v_mfma_f32_16x16x32_bf16 v[236:239], a[48:51], a[232:235], 0
    v_mfma_f32_16x16x32_bf16 v[236:239], a[52:55], a[236:239], v[236:239]
    v_mfma_f32_16x16x32_bf16 v[236:239], a[56:59], a[240:243], v[236:239]
    v_mfma_f32_16x16x32_bf16 v[236:239], a[60:63], a[244:247], v[236:239]
    v_cvt_pk_bf16_f32 v150, v228, v229
    v_cvt_pk_bf16_f32 v151, v230, v231
    v_mfma_f32_16x16x32_bf16 v[236:239], a[64:67], a[216:219], v[236:239]
    v_mfma_f32_16x16x32_bf16 v[236:239], a[68:71], a[220:223], v[236:239]
    v_cvt_pk_bf16_f32 v152, v232, v233
    v_cvt_pk_bf16_f32 v153, v234, v235
    v_mfma_f32_16x16x32_bf16 v[228:231], a[232:235], a[72:75], 0
    v_mfma_f32_16x16x32_bf16 v[228:231], a[236:239], a[76:79], v[228:231]
    v_mfma_f32_16x16x32_bf16 v[228:231], a[240:243], a[80:83], v[228:231]
    v_mfma_f32_16x16x32_bf16 v[228:231], a[244:247], a[84:87], v[228:231]
    v_mfma_f32_16x16x32_bf16 v[228:231], a[216:219], a[88:91], v[228:231]
    v_mfma_f32_16x16x32_bf16 v[228:231], a[220:223], a[92:95], v[228:231]
    v_cvt_pk_bf16_f32 v154, v236, v237
    v_cvt_pk_bf16_f32 v155, v238, v239
    v_mfma_f32_16x16x32_bf16 v[232:235], a[232:235], a[96:99], 0
    v_mfma_f32_16x16x32_bf16 v[232:235], a[236:239], a[100:103], v[232:235]
    v_mfma_f32_16x16x32_bf16 v[232:235], a[240:243], a[104:107], v[232:235]
    v_mfma_f32_16x16x32_bf16 v[232:235], a[244:247], a[108:111], v[232:235]
    v_mfma_f32_16x16x32_bf16 v[232:235], a[216:219], a[112:115], v[232:235]
    v_mfma_f32_16x16x32_bf16 v[232:235], a[220:223], a[116:119], v[232:235]
    v_cvt_pk_bf16_f32 v14, v228, v229
    v_cvt_pk_bf16_f32 v17, v230, v231
    v_mfma_f32_16x16x32_bf16 v[236:239], a[232:235], a[120:123], 0
    ds_read_b128 a[232:235], v242 offset:128
    s_waitcnt lgkmcnt(1)
    v_mfma_f32_16x16x32_bf16 v[236:239], a[236:239], a[124:127], v[236:239]
    ds_read_b128 a[236:239], v243 offset:128
    v_mfma_f32_16x16x32_bf16 v[236:239], a[240:243], a[128:131], v[236:239]
    v_cvt_pk_bf16_f32 v44, v232, v233
    v_cvt_pk_bf16_f32 v47, v234, v235
    v_mfma_f32_16x16x32_bf16 v[236:239], a[244:247], a[132:135], v[236:239]
    ds_read_b128 a[240:243], v242 offset:256
    ds_read_b128 a[244:247], v243 offset:256
    v_mfma_f32_16x16x32_bf16 v[236:239], a[216:219], a[136:139], v[236:239]
    ds_read_b128 a[216:219], v240 offset:4608
    v_mfma_f32_16x16x32_bf16 v[236:239], a[220:223], a[140:143], v[236:239]
    ds_read_b128 a[220:223], v241 offset:4608
    v_mfma_f32_16x16x32_bf16 v[228:231], a[144:147], a[224:227], 0
    v_mfma_f32_16x16x32_bf16 v[228:231], a[148:151], a[228:231], v[228:231]
    v_mfma_f32_16x16x32_bf16 v[232:235], a[168:171], a[224:227], 0
    v_mfma_f32_16x16x32_bf16 v[232:235], a[172:175], a[228:231], v[232:235]
    s_waitcnt lgkmcnt(5)
    v_mfma_f32_16x16x32_bf16 v[228:231], a[152:155], a[232:235], v[228:231]
    s_waitcnt lgkmcnt(4)
    v_cvt_pk_bf16_f32 v74, v236, v237
    v_cvt_pk_bf16_f32 v77, v238, v239
    v_mfma_f32_16x16x32_bf16 v[228:231], a[156:159], a[236:239], v[228:231]
    v_mfma_f32_16x16x32_bf16 v[232:235], a[176:179], a[232:235], v[232:235]
    s_waitcnt lgkmcnt(3)
    v_mfma_f32_16x16x32_bf16 v[228:231], a[160:163], a[240:243], v[228:231]
    s_waitcnt lgkmcnt(2)
    v_mfma_f32_16x16x32_bf16 v[228:231], a[164:167], a[244:247], v[228:231]
    v_mfma_f32_16x16x32_bf16 v[232:235], a[180:183], a[236:239], v[232:235]
    v_mfma_f32_16x16x32_bf16 v[232:235], a[184:187], a[240:243], v[232:235]
    v_mfma_f32_16x16x32_bf16 v[232:235], a[188:191], a[244:247], v[232:235]
    v_mfma_f32_16x16x32_bf16 v[236:239], a[192:195], a[224:227], 0
    ds_read_b128 a[224:227], v240 offset:4736
    v_mfma_f32_16x16x32_bf16 v[236:239], a[196:199], a[228:231], v[236:239]
    ds_read_b128 a[228:231], v241 offset:4736
    v_mfma_f32_16x16x32_bf16 v[236:239], a[200:203], a[232:235], v[236:239]
    v_mul_f32 v228, s38, v228
    v_mul_f32 v229, s38, v229
    v_mfma_f32_16x16x32_bf16 v[236:239], a[204:207], a[236:239], v[236:239]
    v_mul_f32 v230, s38, v230
    v_mul_f32 v231, s38, v231
    v_mfma_f32_16x16x32_bf16 v[236:239], a[208:211], a[240:243], v[236:239]
    v_cvt_pk_bf16_f32 v168, v228, v229
    v_cvt_pk_bf16_f32 v169, v230, v231
    v_mfma_f32_16x16x32_bf16 v[236:239], a[212:215], a[244:247], v[236:239]
    s_waitcnt lgkmcnt(2)
    v_mul_f32 v232, s3, v232
    v_mul_f32 v233, s3, v233
    v_mfma_f32_16x16x32_bf16 v[228:231], a[0:3], a[216:219], 0
    v_mul_f32 v234, s3, v234
    v_mul_f32 v235, s3, v235
    v_mfma_f32_16x16x32_bf16 v[228:231], a[4:7], a[220:223], v[228:231]
    v_cvt_pk_bf16_f32 v170, v232, v233
    v_cvt_pk_bf16_f32 v171, v234, v235
    v_mfma_f32_16x16x32_bf16 v[232:235], a[24:27], a[216:219], 0
    v_mul_f32 v236, s38, v236
    v_mul_f32 v237, s38, v237
    v_mfma_f32_16x16x32_bf16 v[196:199], v[90:93], v[168:171], v[196:199]
    s_waitcnt lgkmcnt(1)
    v_mul_f32 v238, s38, v238
    v_mul_f32 v239, s38, v239
    v_mfma_f32_16x16x32_bf16 v[200:203], v[114:117], v[168:171], v[200:203]
    v_cvt_pk_bf16_f32 v172, v236, v237
    v_cvt_pk_bf16_f32 v173, v238, v239
    v_mfma_f32_16x16x32_bf16 v[204:207], v[138:141], v[168:171], v[204:207]
    ds_read_b128 a[232:235], v240 offset:4864
    ds_read_b128 a[236:239], v241 offset:4864
    v_mfma_f32_16x16x32_bf16 v[196:199], v[92:95], v[170:173], v[196:199]
    ds_read_b128 a[240:243], v242 offset:1536
    ds_read_b128 a[244:247], v243 offset:1536
    v_mfma_f32_16x16x32_bf16 v[200:203], v[116:119], v[170:173], v[200:203]
    v_add_u32 v240, 0xffff1000, v240
    v_add_u32 v241, 0xffff1000, v241
    v_mfma_f32_16x16x32_bf16 v[204:207], v[140:143], v[170:173], v[204:207]
    v_mfma_f32_16x16x32_bf16 v[208:211], v[96:99], v[168:171], v[208:211]
    v_mfma_f32_16x16x32_bf16 v[208:211], v[98:101], v[170:173], v[208:211]
    v_max_f32 v248, v196, v197
    v_max3_f32 v248, v248, v198, v199
    v_mfma_f32_16x16x32_bf16 v[228:231], a[8:11], a[224:227], v[228:231]
    ds_read_b128 v[196:199], v245 offset:256
    v_max3_f32 v248, v248, v200, v201
    v_mfma_f32_16x16x32_bf16 v[232:235], a[28:31], a[220:223], v[232:235]
    s_waitcnt lgkmcnt(5)
    v_max3_f32 v248, v248, v202, v203
    v_max3_f32 v248, v248, v204, v205
    v_mfma_f32_16x16x32_bf16 v[228:231], a[12:15], a[228:231], v[228:231]
    ds_read_b128 v[200:203], v246 offset:256
    v_max3_f32 v248, v248, v206, v207
    v_mfma_f32_16x16x32_bf16 v[232:235], a[32:35], a[224:227], v[232:235]
    ds_read_b128 v[204:207], v244 offset:320
    v_max3_f32 v248, v248, v208, v209
    v_mfma_f32_16x16x32_bf16 v[232:235], a[36:39], a[228:231], v[232:235]
    s_waitcnt lgkmcnt(6)
    v_max3_f32 v248, v248, v210, v211
    v_mfma_f32_16x16x32_bf16 v[228:231], a[16:19], a[232:235], v[228:231]
    ds_read_b128 v[208:211], v245 offset:320
    s_waitcnt lgkmcnt(6)
    v_mfma_f32_16x16x32_bf16 v[228:231], a[20:23], a[236:239], v[228:231]
    v_mfma_f32_16x16x32_bf16 v[232:235], a[40:43], a[232:235], v[232:235]
    v_mfma_f32_16x16x32_bf16 v[232:235], a[44:47], a[236:239], v[232:235]
    v_mfma_f32_16x16x32_bf16 v[236:239], a[48:51], a[216:219], 0
    s_waitcnt lgkmcnt(3)
    v_mfma_f32_16x16x32_bf16 v[196:199], v[120:123], v[168:171], v[196:199]
    v_mfma_f32_16x16x32_bf16 v[196:199], v[122:125], v[170:173], v[196:199]
    s_waitcnt lgkmcnt(2)
    s_waitcnt lgkmcnt(1)
    v_cvt_pk_bf16_f32 v156, v228, v229
    v_mfma_f32_16x16x32_bf16 v[200:203], v[144:147], v[168:171], v[200:203]
    v_cvt_pk_bf16_f32 v157, v230, v231
    v_cvt_pk_bf16_f32 v158, v232, v233
    v_mfma_f32_16x16x32_bf16 v[200:203], v[146:149], v[170:173], v[200:203]
    v_cvt_pk_bf16_f32 v159, v234, v235
    v_max3_f32 v248, v248, v196, v197
    v_mfma_f32_16x16x32_bf16 v[204:207], v[102:105], v[168:171], v[204:207]
    s_waitcnt lgkmcnt(0)
    v_max3_f32 v248, v248, v198, v199
    v_mfma_f32_16x16x32_bf16 v[204:207], v[104:107], v[170:173], v[204:207]
    ds_read_b128 v[196:199], v246 offset:320
    v_mfma_f32_16x16x32_bf16 v[208:211], v[126:129], v[168:171], v[208:211]
    v_max3_f32 v248, v248, v200, v201
    v_max3_f32 v248, v248, v202, v203
    v_mfma_f32_16x16x32_bf16 v[208:211], v[128:131], v[170:173], v[208:211]
    ds_read_b128 v[200:203], v244 offset:192
    v_mfma_f32_16x16x32_bf16 v[236:239], a[52:55], a[220:223], v[236:239]
    v_mfma_f32_16x16x32_bf16 v[236:239], a[56:59], a[224:227], v[236:239]
    v_max3_f32 v248, v248, v204, v205
    v_mfma_f32_16x16x32_bf16 v[236:239], a[60:63], a[228:231], v[236:239]
    ds_read_b128 v[204:207], v245 offset:192
    v_mfma_f32_16x16x32_bf16 v[236:239], a[64:67], a[232:235], v[236:239]
    v_mfma_f32_16x16x32_bf16 v[236:239], a[68:71], a[236:239], v[236:239]
    v_max3_f32 v248, v248, v208, v209
    v_mfma_f32_16x16x32_bf16 v[228:231], a[216:219], a[72:75], 0
    ds_read_b128 v[208:211], v246 offset:192
    s_waitcnt lgkmcnt(3)
    v_mfma_f32_16x16x32_bf16 v[196:199], v[150:153], v[168:171], v[196:199]
    v_mfma_f32_16x16x32_bf16 v[196:199], v[152:155], v[170:173], v[196:199]
    v_mfma_f32_16x16x32_bf16 v[228:231], a[220:223], a[76:79], v[228:231]
    s_waitcnt lgkmcnt(2)
    v_cvt_pk_bf16_f32 v160, v236, v237
    v_cvt_pk_bf16_f32 v161, v238, v239
    v_mfma_f32_16x16x32_bf16 v[200:203], v[90:93], v[168:171], v[200:203]
    v_mfma_f32_16x16x32_bf16 v[200:203], v[92:95], v[170:173], v[200:203]
    v_mfma_f32_16x16x32_bf16 v[228:231], a[224:227], a[80:83], v[228:231]
    s_waitcnt lgkmcnt(1)
    v_max3_f32 v248, v248, v196, v197
    v_mov_b32 v225, v248
    v_mfma_f32_16x16x32_bf16 v[204:207], v[114:117], v[168:171], v[204:207]
    ds_read_b128 v[196:199], v244 offset:256
    v_permlane16_swap_b32 v248, v225
    v_mfma_f32_16x16x32_bf16 v[204:207], v[116:119], v[170:173], v[204:207]
    v_max_f32 v248, v248, v225
    v_mov_b32 v225, v248
    v_mfma_f32_16x16x32_bf16 v[228:231], a[228:231], a[84:87], v[228:231]
    s_waitcnt lgkmcnt(1)
    v_permlane32_swap_b32 v248, v225
    v_max_f32 v248, v248, v225
    v_mfma_f32_16x16x32_bf16 v[208:211], v[138:141], v[168:171], v[208:211]
    v_sub_f32 v200, v200, v248
    v_sub_f32 v201, v201, v248
    v_mfma_f32_16x16x32_bf16 v[208:211], v[140:143], v[170:173], v[208:211]
    v_exp_f32 v200, v200
    v_mfma_f32_16x16x32_bf16 v[228:231], a[232:235], a[88:91], v[228:231]
    v_exp_f32 v201, v201
    v_mfma_f32_16x16x32_bf16 v[228:231], a[236:239], a[92:95], v[228:231]
    v_sub_f32 v202, v202, v248
    v_sub_f32 v203, v203, v248
    v_mfma_f32_16x16x32_bf16 v[232:235], a[216:219], a[96:99], 0
    v_exp_f32 v202, v202
    v_mfma_f32_16x16x32_bf16 v[232:235], a[220:223], a[100:103], v[232:235]
    v_exp_f32 v203, v203
    v_mfma_f32_16x16x32_bf16 v[232:235], a[224:227], a[104:107], v[232:235]
    s_waitcnt lgkmcnt(0)
    v_cvt_pk_bf16_f32 v20, v228, v229
    v_cvt_pk_bf16_f32 v23, v230, v231
    v_mfma_f32_16x16x32_bf16 v[196:199], v[96:99], v[168:171], v[196:199]
    v_cvt_pk_bf16_f32 v180, v200, v201
    v_cvt_pk_bf16_f32 v183, v202, v203
    v_mfma_f32_16x16x32_bf16 v[196:199], v[98:101], v[170:173], v[196:199]
    ds_read_b128 v[200:203], v245 offset:256
    v_sub_f32 v204, v204, v248
    v_mfma_f32_16x16x32_bf16 v[232:235], a[228:231], a[108:111], v[232:235]
    v_exp_f32 v204, v204
    v_mfma_f32_16x16x32_bf16 v[232:235], a[232:235], a[112:115], v[232:235]
    v_sub_f32 v205, v205, v248
    v_sub_f32 v206, v206, v248
    v_mfma_f32_16x16x32_bf16 v[232:235], a[236:239], a[116:119], v[232:235]
    v_exp_f32 v205, v205
    v_mfma_f32_16x16x32_bf16 v[236:239], a[216:219], a[120:123], 0
    ds_read_b128 a[216:219], v242 offset:1664
    v_sub_f32 v207, v207, v248
    v_mfma_f32_16x16x32_bf16 v[236:239], a[220:223], a[124:127], v[236:239]
    ds_read_b128 a[220:223], v243 offset:1664
    v_cvt_pk_bf16_f32 v181, v204, v205
    v_mfma_f32_16x16x32_bf16 v[236:239], a[224:227], a[128:131], v[236:239]
    v_cvt_pk_bf16_f32 v50, v232, v233
    v_cvt_pk_bf16_f32 v53, v234, v235
    v_mfma_f32_16x16x32_bf16 v[236:239], a[228:231], a[132:135], v[236:239]
    ds_read_b128 a[224:227], v242 offset:1792
    ds_read_b128 a[228:231], v243 offset:1792
    v_mfma_f32_16x16x32_bf16 v[236:239], a[232:235], a[136:139], v[236:239]
    ds_read_b128 a[232:235], v240 offset:6144
    v_sub_f32 v208, v208, v248
    v_mfma_f32_16x16x32_bf16 v[236:239], a[236:239], a[140:143], v[236:239]
    ds_read_b128 a[236:239], v241 offset:6144
    v_sub_f32 v209, v209, v248
    v_mfma_f32_16x16x32_bf16 v[228:231], a[144:147], a[240:243], 0
    s_waitcnt lgkmcnt(6)
    v_exp_f32 v206, v206
    v_mfma_f32_16x16x32_bf16 v[200:203], v[120:123], v[168:171], v[200:203]
    v_exp_f32 v207, v207
    v_mfma_f32_16x16x32_bf16 v[200:203], v[122:125], v[170:173], v[200:203]
    v_cvt_pk_bf16_f32 v80, v236, v237
    v_cvt_pk_bf16_f32 v83, v238, v239
    v_mfma_f32_16x16x32_bf16 v[228:231], a[148:151], a[244:247], v[228:231]
    s_waitcnt lgkmcnt(5)
    v_cvt_pk_bf16_f32 v184, v206, v207
    v_sub_f32 v210, v210, v248
    v_mfma_f32_16x16x32_bf16 v[228:231], a[152:155], a[216:219], v[228:231]
    ds_read_b128 v[204:207], v246 offset:256
    v_sub_f32 v211, v211, v248
    v_mfma_f32_16x16x32_bf16 v[232:235], a[168:171], a[240:243], 0
    s_waitcnt lgkmcnt(5)
    v_exp_f32 v208, v208
    v_mfma_f32_16x16x32_bf16 v[228:231], a[156:159], a[220:223], v[228:231]
    s_waitcnt lgkmcnt(4)
    v_exp_f32 v209, v209
    v_mfma_f32_16x16x32_bf16 v[228:231], a[160:163], a[224:227], v[228:231]
    s_waitcnt lgkmcnt(3)
    v_exp_f32 v210, v210
    v_mfma_f32_16x16x32_bf16 v[228:231], a[164:167], a[228:231], v[228:231]
    v_exp_f32 v211, v211
    v_mfma_f32_16x16x32_bf16 v[232:235], a[172:175], a[244:247], v[232:235]
    v_cvt_pk_bf16_f32 v182, v208, v209
    v_cvt_pk_bf16_f32 v185, v210, v211
    v_mfma_f32_16x16x32_bf16 v[232:235], a[176:179], a[216:219], v[232:235]
    ds_read_b128 v[208:211], v244 offset:320
    v_sub_f32 v196, v196, v248
    v_mfma_f32_16x16x32_bf16 v[212:215], v[0:3], v[180:183], 0
    v_mul_f32 v228, s38, v228
    v_mul_f32 v229, s38, v229
    v_mfma_f32_16x16x32_bf16 v[216:219], v[30:33], v[180:183], 0
    v_mul_f32 v230, s38, v230
    v_mul_f32 v231, s38, v231
    v_mfma_f32_16x16x32_bf16 v[220:223], v[60:63], v[180:183], 0
    s_waitcnt lgkmcnt(1)
    v_cvt_pk_bf16_f32 v174, v228, v229
    v_cvt_pk_bf16_f32 v175, v230, v231
    v_mfma_f32_16x16x32_bf16 v[224:227], a[248:251], v[180:183], 0
    v_exp_f32 v196, v196
    v_mfma_f32_16x16x32_bf16 v[204:207], v[144:147], v[168:171], v[204:207]
    v_sub_f32 v197, v197, v248
    v_sub_f32 v198, v198, v248
    v_mfma_f32_16x16x32_bf16 v[204:207], v[146:149], v[170:173], v[204:207]
    v_exp_f32 v197, v197
    v_mfma_f32_16x16x32_bf16 v[232:235], a[180:183], a[220:223], v[232:235]
    v_exp_f32 v198, v198
    v_mfma_f32_16x16x32_bf16 v[232:235], a[184:187], a[224:227], v[232:235]
    v_sub_f32 v199, v199, v248
    v_cvt_pk_bf16_f32 v186, v196, v197
    v_mfma_f32_16x16x32_bf16 v[232:235], a[188:191], a[228:231], v[232:235]
    s_waitcnt lgkmcnt(0)
    v_exp_f32 v199, v199
    v_mfma_f32_16x16x32_bf16 v[208:211], v[102:105], v[168:171], v[208:211]
    v_cvt_pk_bf16_f32 v189, v198, v199
    v_sub_f32 v200, v200, v248
    v_mfma_f32_16x16x32_bf16 v[208:211], v[104:107], v[170:173], v[208:211]
    ds_read_b128 v[196:199], v245 offset:320
    v_sub_f32 v201, v201, v248
    v_mfma_f32_16x16x32_bf16 v[236:239], a[192:195], a[240:243], 0
    v_mul_f32 v232, s3, v232
    v_mul_f32 v233, s3, v233
    v_mfma_f32_16x16x32_bf16 v[236:239], a[196:199], a[244:247], v[236:239]
    v_mul_f32 v234, s3, v234
    v_mul_f32 v235, s3, v235
    v_mfma_f32_16x16x32_bf16 v[236:239], a[200:203], a[216:219], v[236:239]
    v_cvt_pk_bf16_f32 v176, v232, v233
    v_cvt_pk_bf16_f32 v177, v234, v235
    v_mfma_f32_16x16x32_bf16 v[236:239], a[204:207], a[220:223], v[236:239]
    ds_read_b128 a[240:243], v240 offset:6272
    ds_read_b128 a[244:247], v241 offset:6272
    v_mfma_f32_16x16x32_bf16 v[236:239], a[208:211], a[224:227], v[236:239]
    ds_read_b128 a[216:219], v240 offset:6400
    ds_read_b128 a[220:223], v241 offset:6400
    v_mfma_f32_16x16x32_bf16 v[236:239], a[212:215], a[228:231], v[236:239]
    ds_read_b128 a[224:227], v240 offset:6144
    ds_read_b128 a[228:231], v241 offset:6144
    v_mfma_f32_16x16x32_bf16 v[228:231], a[0:3], a[232:235], 0
    v_exp_f32 v200, v200
    v_mfma_f32_16x16x32_bf16 v[228:231], a[4:7], a[236:239], v[228:231]
    s_waitcnt lgkmcnt(6)
    v_exp_f32 v201, v201
    v_mfma_f32_16x16x32_bf16 v[196:199], v[126:129], v[168:171], v[196:199]
    v_mul_f32 v236, s38, v236
    v_mul_f32 v237, s38, v237
    v_mfma_f32_16x16x32_bf16 v[196:199], v[128:131], v[170:173], v[196:199]
    v_mul_f32 v238, s38, v238
    v_mul_f32 v239, s38, v239
    v_mfma_f32_16x16x32_bf16 v[232:235], a[24:27], a[232:235], 0
    v_cvt_pk_bf16_f32 v178, v236, v237
    v_cvt_pk_bf16_f32 v179, v238, v239
    v_mfma_f32_16x16x32_bf16 v[232:235], a[28:31], a[236:239], v[232:235]
    s_waitcnt lgkmcnt(5)
    v_sub_f32 v202, v202, v248
    v_sub_f32 v203, v203, v248
    v_mfma_f32_16x16x32_bf16 v[228:231], a[8:11], a[240:243], v[228:231]
    s_waitcnt lgkmcnt(4)
    v_exp_f32 v202, v202
    v_mfma_f32_16x16x32_bf16 v[228:231], a[12:15], a[244:247], v[228:231]
    s_waitcnt lgkmcnt(3)
    v_exp_f32 v203, v203
    v_mfma_f32_16x16x32_bf16 v[228:231], a[16:19], a[216:219], v[228:231]
    s_waitcnt lgkmcnt(2)
    v_cvt_pk_bf16_f32 v187, v200, v201
    v_cvt_pk_bf16_f32 v190, v202, v203
    v_mfma_f32_16x16x32_bf16 v[228:231], a[20:23], a[220:223], v[228:231]
    ds_read_b128 v[200:203], v246 offset:320
    v_sub_f32 v204, v204, v248
    v_mfma_f32_16x16x32_bf16 v[212:215], v[4:7], v[184:187], v[212:215]
    v_exp_f32 v204, v204
    v_mfma_f32_16x16x32_bf16 v[216:219], v[34:37], v[184:187], v[216:219]
    v_sub_f32 v205, v205, v248
    v_sub_f32 v206, v206, v248
    v_mfma_f32_16x16x32_bf16 v[220:223], v[64:67], v[184:187], v[220:223]
    v_cvt_pk_bf16_f32 v162, v228, v229
    v_cvt_pk_bf16_f32 v163, v230, v231
    v_mfma_f32_16x16x32_bf16 v[224:227], a[248:251], v[184:187], v[224:227]
    s_waitcnt lgkmcnt(2)
    v_exp_f32 v205, v205
    v_mfma_f32_16x16x32_bf16 v[232:235], a[32:35], a[240:243], v[232:235]
    v_exp_f32 v206, v206
    v_mfma_f32_16x16x32_bf16 v[232:235], a[36:39], a[244:247], v[232:235]
    v_sub_f32 v207, v207, v248
    v_cvt_pk_bf16_f32 v188, v204, v205
    v_mfma_f32_16x16x32_bf16 v[232:235], a[40:43], a[216:219], v[232:235]
    v_exp_f32 v207, v207
    v_mfma_f32_16x16x32_bf16 v[232:235], a[44:47], a[220:223], v[232:235]
    v_cvt_pk_bf16_f32 v191, v206, v207
    v_sub_f32 v208, v208, v248
    v_mfma_f32_16x16x32_bf16 v[236:239], a[48:51], a[232:235], 0
    ds_read_b128 a[232:235], v240 offset:6272
    ds_read_b128 v[204:207], v244 offset:0
    v_mfma_f32_16x16x32_bf16 v[212:215], v[8:11], v[188:191], v[212:215]
    s_waitcnt lgkmcnt(2)
    v_exp_f32 v208, v208
    v_mfma_f32_16x16x32_bf16 v[216:219], v[38:41], v[188:191], v[216:219]
    v_cvt_pk_bf16_f32 v164, v232, v233
    v_cvt_pk_bf16_f32 v165, v234, v235
    v_mfma_f32_16x16x32_bf16 v[220:223], v[68:71], v[188:191], v[220:223]
    v_sub_f32 v209, v209, v248
    v_sub_f32 v196, v196, v248
    v_mfma_f32_16x16x32_bf16 v[224:227], a[248:251], v[188:191], v[224:227]
    v_exp_f32 v209, v209
    v_mfma_f32_16x16x32_bf16 v[200:203], v[150:153], v[168:171], v[200:203]
    v_cvt_pk_bf16_f32 v192, v208, v209
    v_sub_f32 v197, v197, v248
    v_mfma_f32_16x16x32_bf16 v[200:203], v[152:155], v[170:173], v[200:203]
    ds_read_b128 v[208:211], v245 offset:0
    v_mfma_f32_16x16x32_bf16 v[236:239], a[52:55], a[236:239], v[236:239]
    ds_read_b128 a[236:239], v241 offset:6272
    v_mfma_f32_16x16x32_bf16 v[236:239], a[56:59], a[240:243], v[236:239]
    ds_read_b128 a[240:243], v240 offset:6400
    v_mfma_f32_16x16x32_bf16 v[236:239], a[60:63], a[244:247], v[236:239]
    ds_read_b128 a[244:247], v241 offset:6400
    s_waitcnt lgkmcnt(4)
    v_mfma_f32_16x16x32_bf16 v[204:207], v[96:99], v[174:177], v[204:207]
    v_exp_f32 v196, v196
    v_mfma_f32_16x16x32_bf16 v[204:207], v[98:101], v[176:179], v[204:207]
    v_exp_f32 v197, v197
    v_mfma_f32_16x16x32_bf16 v[236:239], a[64:67], a[216:219], v[236:239]
    ds_read_b128 a[216:219], v240 offset:36864
    v_cvt_pk_bf16_f32 v193, v196, v197
    v_mfma_f32_16x16x32_bf16 v[236:239], a[68:71], a[220:223], v[236:239]
    ds_read_b128 a[220:223], v241 offset:36864
    ds_read_b128 v[196:199], v246 offset:0
    v_mfma_f32_16x16x32_bf16 v[228:231], a[224:227], a[72:75], 0
    v_sub_f32 v200, v200, v248
    v_sub_f32 v201, v201, v248
    v_mfma_f32_16x16x32_bf16 v[228:231], a[228:231], a[76:79], v[228:231]
    s_waitcnt lgkmcnt(6)
    v_exp_f32 v200, v200
    v_mfma_f32_16x16x32_bf16 v[208:211], v[120:123], v[174:177], v[208:211]
    v_cvt_pk_bf16_f32 v166, v236, v237
    v_cvt_pk_bf16_f32 v167, v238, v239
    v_mfma_f32_16x16x32_bf16 v[208:211], v[122:125], v[176:179], v[208:211]
    v_exp_f32 v201, v201
    v_mfma_f32_16x16x32_bf16 v[228:231], a[232:235], a[80:83], v[228:231]
    s_waitcnt lgkmcnt(5)
    v_cvt_pk_bf16_f32 v194, v200, v201
    v_max_f32 v248, v204, v205
    v_mfma_f32_16x16x32_bf16 v[228:231], a[236:239], a[84:87], v[228:231]
    ds_read_b128 v[200:203], v244 offset:64
    v_max3_f32 v248, v248, v206, v207
    v_mfma_f32_16x16x32_bf16 v[212:215], v[12:15], v[192:195], v[212:215]
    ds_read_b128 v[204:207], v245 offset:64
    v_max3_f32 v248, v248, v208, v209
    v_mfma_f32_16x16x32_bf16 v[216:219], v[42:45], v[192:195], v[216:219]
    s_waitcnt lgkmcnt(6)
    v_max3_f32 v248, v248, v210, v211
    v_mfma_f32_16x16x32_bf16 v[220:223], v[72:75], v[192:195], v[220:223]
    ds_read_b128 v[208:211], v246 offset:64
    s_waitcnt lgkmcnt(3)
    v_mfma_f32_16x16x32_bf16 v[224:227], a[248:251], v[192:195], v[224:227]
    v_mfma_f32_16x16x32_bf16 v[196:199], v[144:147], v[174:177], v[196:199]
    v_mfma_f32_16x16x32_bf16 v[196:199], v[146:149], v[176:179], v[196:199]
    v_mfma_f32_16x16x32_bf16 v[228:231], a[240:243], a[88:91], v[228:231]
    v_mfma_f32_16x16x32_bf16 v[228:231], a[244:247], a[92:95], v[228:231]
    v_mfma_f32_16x16x32_bf16 v[232:235], a[224:227], a[96:99], 0
    s_waitcnt lgkmcnt(2)
    s_waitcnt lgkmcnt(1)
    v_mfma_f32_16x16x32_bf16 v[200:203], v[102:105], v[174:177], v[200:203]
    v_rcp_f32 v225, v224
    v_mfma_f32_16x16x32_bf16 v[200:203], v[104:107], v[176:179], v[200:203]
    v_mul_f32 v212, v212, v225
    v_mul_f32 v213, v213, v225
    v_mfma_f32_16x16x32_bf16 v[204:207], v[126:129], v[174:177], v[204:207]
    s_waitcnt lgkmcnt(0)
    v_cvt_pk_bf16_f32 v24, v228, v229
    v_cvt_pk_bf16_f32 v27, v230, v231
    v_mfma_f32_16x16x32_bf16 v[204:207], v[128:131], v[176:179], v[204:207]
    v_mul_f32 v214, v214, v225
    v_mul_f32 v215, v215, v225
    v_mfma_f32_16x16x32_bf16 v[208:211], v[150:153], v[174:177], v[208:211]
    v_cvt_pk_bf16_f32 v212, v212, v213
    v_cvt_pk_bf16_f32 v213, v214, v215
    v_mfma_f32_16x16x32_bf16 v[208:211], v[152:155], v[176:179], v[208:211]
    ds_write_b64 v251, v[212:213] offset:0
    v_mfma_f32_16x16x32_bf16 v[232:235], a[228:231], a[100:103], v[232:235]
    v_mul_f32 v216, v216, v225
    v_mul_f32 v217, v217, v225
    v_mfma_f32_16x16x32_bf16 v[232:235], a[232:235], a[104:107], v[232:235]
    v_mul_f32 v218, v218, v225
    v_mul_f32 v219, v219, v225
    v_mfma_f32_16x16x32_bf16 v[232:235], a[236:239], a[108:111], v[232:235]
    v_cvt_pk_bf16_f32 v216, v216, v217
    v_cvt_pk_bf16_f32 v217, v218, v219
    v_mfma_f32_16x16x32_bf16 v[232:235], a[240:243], a[112:115], v[232:235]
    ds_write_b64 v251, v[216:217] offset:128
    v_mfma_f32_16x16x32_bf16 v[232:235], a[244:247], a[116:119], v[232:235]
    v_mul_f32 v220, v220, v225
    v_mul_f32 v221, v221, v225
    v_mfma_f32_16x16x32_bf16 v[236:239], a[224:227], a[120:123], 0
    ds_read_b128 a[224:227], v240 offset:36992
    v_mul_f32 v222, v222, v225
    v_mfma_f32_16x16x32_bf16 v[236:239], a[228:231], a[124:127], v[236:239]
    ds_read_b128 a[228:231], v241 offset:36992
    v_mul_f32 v223, v223, v225
    v_mfma_f32_16x16x32_bf16 v[236:239], a[232:235], a[128:131], v[236:239]
    v_cvt_pk_bf16_f32 v54, v232, v233
    v_cvt_pk_bf16_f32 v57, v234, v235
    v_mfma_f32_16x16x32_bf16 v[236:239], a[236:239], a[132:135], v[236:239]
    ds_read_b128 a[232:235], v240 offset:37120
    ds_read_b128 a[236:239], v241 offset:37120
    v_mfma_f32_16x16x32_bf16 v[236:239], a[240:243], a[136:139], v[236:239]
    ds_read_b128 a[240:243], v242 offset:3072
    v_add_u32 v240, 0xf000, v240
    v_mfma_f32_16x16x32_bf16 v[236:239], a[244:247], a[140:143], v[236:239]
    ds_read_b128 a[244:247], v243 offset:3072
    v_add_u32 v241, 0xf000, v241
    v_mfma_f32_16x16x32_bf16 v[228:231], a[0:3], a[216:219], 0
    v_cvt_pk_bf16_f32 v220, v220, v221
    v_cvt_pk_bf16_f32 v221, v222, v223
    v_mfma_f32_16x16x32_bf16 v[228:231], a[4:7], a[220:223], v[228:231]
    ds_write_b64 v251, v[220:221] offset:256
    v_mfma_f32_16x16x32_bf16 v[232:235], a[24:27], a[216:219], 0
    s_waitcnt lgkmcnt(6)
    v_cvt_pk_bf16_f32 v84, v236, v237
    v_cvt_pk_bf16_f32 v87, v238, v239
    v_mfma_f32_16x16x32_bf16 v[228:231], a[8:11], a[224:227], v[228:231]
    s_waitcnt lgkmcnt(5)
    v_max3_f32 v248, v248, v196, v197
    v_max3_f32 v248, v248, v198, v199
    v_mfma_f32_16x16x32_bf16 v[228:231], a[12:15], a[228:231], v[228:231]
    ds_read_b128 v[196:199], v244 offset:128
    v_max3_f32 v248, v248, v200, v201
    v_mfma_f32_16x16x32_bf16 v[232:235], a[28:31], a[220:223], v[232:235]
    s_waitcnt lgkmcnt(5)
    v_max3_f32 v248, v248, v202, v203
    v_max3_f32 v248, v248, v204, v205
    v_mfma_f32_16x16x32_bf16 v[228:231], a[16:19], a[232:235], v[228:231]
    ds_read_b128 v[200:203], v245 offset:128
    v_max3_f32 v248, v248, v206, v207
    v_mfma_f32_16x16x32_bf16 v[232:235], a[32:35], a[224:227], v[232:235]
    ds_read_b128 v[204:207], v246 offset:128
    v_max3_f32 v248, v248, v208, v209
    v_mfma_f32_16x16x32_bf16 v[232:235], a[36:39], a[228:231], v[232:235]
    s_waitcnt lgkmcnt(6)
    v_max3_f32 v248, v248, v210, v211
    v_mfma_f32_16x16x32_bf16 v[228:231], a[20:23], a[236:239], v[228:231]
    ds_read_b128 v[208:211], v244 offset:0
    v_mfma_f32_16x16x32_bf16 v[232:235], a[40:43], a[232:235], v[232:235]
    v_mfma_f32_16x16x32_bf16 v[232:235], a[44:47], a[236:239], v[232:235]
    v_mfma_f32_16x16x32_bf16 v[236:239], a[48:51], a[216:219], 0
    v_mfma_f32_16x16x32_bf16 v[236:239], a[52:55], a[220:223], v[236:239]
    s_waitcnt lgkmcnt(3)
    v_mfma_f32_16x16x32_bf16 v[196:199], v[108:111], v[174:177], v[196:199]
    v_mfma_f32_16x16x32_bf16 v[196:199], v[110:113], v[176:179], v[196:199]
    s_waitcnt lgkmcnt(2)
    v_cvt_pk_bf16_f32 v90, v228, v229
    v_cvt_pk_bf16_f32 v91, v230, v231
    v_mfma_f32_16x16x32_bf16 v[200:203], v[132:135], v[174:177], v[200:203]
    s_waitcnt lgkmcnt(1)
    v_cvt_pk_bf16_f32 v92, v232, v233
    v_cvt_pk_bf16_f32 v93, v234, v235
    v_mfma_f32_16x16x32_bf16 v[200:203], v[134:137], v[176:179], v[200:203]
    v_max3_f32 v248, v248, v196, v197
    s_waitcnt lgkmcnt(0)
    v_mfma_f32_16x16x32_bf16 v[204:207], v[156:159], v[174:177], v[204:207]
    ds_read_b128 v[196:199], v245 offset:0
    v_mfma_f32_16x16x32_bf16 v[204:207], v[158:161], v[176:179], v[204:207]
    v_mfma_f32_16x16x32_bf16 v[208:211], v[96:99], v[174:177], v[208:211]
    v_mfma_f32_16x16x32_bf16 v[208:211], v[98:101], v[176:179], v[208:211]
    v_mfma_f32_16x16x32_bf16 v[236:239], a[56:59], a[224:227], v[236:239]
    v_max3_f32 v248, v248, v200, v201
    v_mfma_f32_16x16x32_bf16 v[236:239], a[60:63], a[228:231], v[236:239]
    ds_read_b128 v[200:203], v246 offset:0
    v_mfma_f32_16x16x32_bf16 v[236:239], a[64:67], a[232:235], v[236:239]
    v_mfma_f32_16x16x32_bf16 v[236:239], a[68:71], a[236:239], v[236:239]
    v_max3_f32 v248, v248, v204, v205
    v_mov_b32 v225, v248
    v_mfma_f32_16x16x32_bf16 v[228:231], a[216:219], a[72:75], 0
    ds_read_b128 v[204:207], v244 offset:64
    v_permlane16_swap_b32 v248, v225
    v_mfma_f32_16x16x32_bf16 v[228:231], a[220:223], a[76:79], v[228:231]
    s_waitcnt lgkmcnt(2)
    v_max_f32 v248, v248, v225
    v_cvt_pk_bf16_f32 v94, v236, v237
    v_mfma_f32_16x16x32_bf16 v[196:199], v[120:123], v[174:177], v[196:199]
    v_cvt_pk_bf16_f32 v95, v238, v239
    v_mov_b32 v225, v248
    v_mfma_f32_16x16x32_bf16 v[196:199], v[122:125], v[176:179], v[196:199]
    v_mfma_f32_16x16x32_bf16 v[228:231], a[224:227], a[80:83], v[228:231]
    v_permlane32_swap_b32 v248, v225
    v_max_f32 v248, v248, v225
    v_mfma_f32_16x16x32_bf16 v[228:231], a[228:231], a[84:87], v[228:231]
    v_sub_f32 v208, v208, v248
    v_sub_f32 v209, v209, v248
    v_mfma_f32_16x16x32_bf16 v[228:231], a[232:235], a[88:91], v[228:231]
    s_waitcnt lgkmcnt(1)
    v_exp_f32 v208, v208
    v_mfma_f32_16x16x32_bf16 v[200:203], v[144:147], v[174:177], v[200:203]
    v_exp_f32 v209, v209
    v_mfma_f32_16x16x32_bf16 v[200:203], v[146:149], v[176:179], v[200:203]
    v_sub_f32 v210, v210, v248
    v_sub_f32 v211, v211, v248
    v_mfma_f32_16x16x32_bf16 v[228:231], a[236:239], a[92:95], v[228:231]
    s_waitcnt lgkmcnt(0)
    v_exp_f32 v210, v210
    v_mfma_f32_16x16x32_bf16 v[204:207], v[102:105], v[174:177], v[204:207]
    v_exp_f32 v211, v211
    v_mfma_f32_16x16x32_bf16 v[204:207], v[104:107], v[176:179], v[204:207]
    v_cvt_pk_bf16_f32 v180, v208, v209
    v_cvt_pk_bf16_f32 v183, v210, v211
    v_mfma_f32_16x16x32_bf16 v[232:235], a[216:219], a[96:99], 0
    v_cvt_pk_bf16_f32 v25, v228, v229
    v_cvt_pk_bf16_f32 v28, v230, v231
    v_mfma_f32_16x16x32_bf16 v[232:235], a[220:223], a[100:103], v[232:235]
    ds_read_b128 v[208:211], v245 offset:64
    v_sub_f32 v196, v196, v248
    v_mfma_f32_16x16x32_bf16 v[232:235], a[224:227], a[104:107], v[232:235]
    v_exp_f32 v196, v196
    v_mfma_f32_16x16x32_bf16 v[232:235], a[228:231], a[108:111], v[232:235]
    v_sub_f32 v197, v197, v248
    v_sub_f32 v198, v198, v248
    v_mfma_f32_16x16x32_bf16 v[232:235], a[232:235], a[112:115], v[232:235]
    v_exp_f32 v197, v197
    v_mfma_f32_16x16x32_bf16 v[232:235], a[236:239], a[116:119], v[232:235]
    v_exp_f32 v198, v198
    v_mfma_f32_16x16x32_bf16 v[236:239], a[216:219], a[120:123], 0
    ds_read_b128 a[216:219], v242 offset:3200
    v_sub_f32 v199, v199, v248
    v_mfma_f32_16x16x32_bf16 v[236:239], a[220:223], a[124:127], v[236:239]
    ds_read_b128 a[220:223], v243 offset:3200
    v_cvt_pk_bf16_f32 v181, v196, v197
    v_mfma_f32_16x16x32_bf16 v[236:239], a[224:227], a[128:131], v[236:239]
    v_cvt_pk_bf16_f32 v55, v232, v233
    v_cvt_pk_bf16_f32 v58, v234, v235
    v_mfma_f32_16x16x32_bf16 v[236:239], a[228:231], a[132:135], v[236:239]
    ds_read_b128 a[224:227], v242 offset:3328
    ds_read_b128 a[228:231], v243 offset:3328
    v_mfma_f32_16x16x32_bf16 v[236:239], a[232:235], a[136:139], v[236:239]
    ds_read_b128 a[232:235], v240 offset:6144
    v_sub_f32 v200, v200, v248
    v_mfma_f32_16x16x32_bf16 v[236:239], a[236:239], a[140:143], v[236:239]
    ds_read_b128 a[236:239], v241 offset:6144
    v_sub_f32 v201, v201, v248
    v_mfma_f32_16x16x32_bf16 v[228:231], a[144:147], a[240:243], 0
    s_waitcnt lgkmcnt(6)
    v_exp_f32 v199, v199
    v_mfma_f32_16x16x32_bf16 v[208:211], v[126:129], v[174:177], v[208:211]
    v_cvt_pk_bf16_f32 v184, v198, v199
    v_sub_f32 v202, v202, v248
    v_mfma_f32_16x16x32_bf16 v[208:211], v[128:131], v[176:179], v[208:211]
    v_cvt_pk_bf16_f32 v85, v236, v237
    v_cvt_pk_bf16_f32 v88, v238, v239
    v_mfma_f32_16x16x32_bf16 v[228:231], a[148:151], a[244:247], v[228:231]
    ds_read_b128 v[196:199], v246 offset:64
    v_sub_f32 v203, v203, v248
    v_mfma_f32_16x16x32_bf16 v[232:235], a[168:171], a[240:243], 0
    s_waitcnt lgkmcnt(6)
    v_exp_f32 v200, v200
    v_mfma_f32_16x16x32_bf16 v[228:231], a[152:155], a[216:219], v[228:231]
    s_waitcnt lgkmcnt(5)
    v_exp_f32 v201, v201
    v_mfma_f32_16x16x32_bf16 v[228:231], a[156:159], a[220:223], v[228:231]
    s_waitcnt lgkmcnt(4)
    v_exp_f32 v202, v202
    v_mfma_f32_16x16x32_bf16 v[228:231], a[160:163], a[224:227], v[228:231]
    s_waitcnt lgkmcnt(3)
    v_exp_f32 v203, v203
    v_mfma_f32_16x16x32_bf16 v[228:231], a[164:167], a[228:231], v[228:231]
    v_cvt_pk_bf16_f32 v182, v200, v201
    v_cvt_pk_bf16_f32 v185, v202, v203
    v_mfma_f32_16x16x32_bf16 v[232:235], a[172:175], a[244:247], v[232:235]
    ds_read_b128 v[200:203], v244 offset:128
    v_sub_f32 v204, v204, v248
    v_mfma_f32_16x16x32_bf16 v[212:215], v[6:9], v[180:183], 0
    v_exp_f32 v204, v204
    v_mfma_f32_16x16x32_bf16 v[216:219], v[36:39], v[180:183], 0
    v_mul_f32 v228, s38, v228
    v_mul_f32 v229, s38, v229
    v_mfma_f32_16x16x32_bf16 v[220:223], v[66:69], v[180:183], 0
    s_waitcnt lgkmcnt(1)
    v_mul_f32 v230, s38, v230
    v_mul_f32 v231, s38, v231
    v_mfma_f32_16x16x32_bf16 v[224:227], a[248:251], v[180:183], 0
    v_cvt_pk_bf16_f32 v168, v228, v229
    v_cvt_pk_bf16_f32 v169, v230, v231
    v_mfma_f32_16x16x32_bf16 v[196:199], v[150:153], v[174:177], v[196:199]
    v_sub_f32 v205, v205, v248
    v_sub_f32 v206, v206, v248
    v_mfma_f32_16x16x32_bf16 v[196:199], v[152:155], v[176:179], v[196:199]
    v_exp_f32 v205, v205
    v_mfma_f32_16x16x32_bf16 v[232:235], a[176:179], a[216:219], v[232:235]
    v_exp_f32 v206, v206
    v_mfma_f32_16x16x32_bf16 v[232:235], a[180:183], a[220:223], v[232:235]
    v_sub_f32 v207, v207, v248
    v_cvt_pk_bf16_f32 v186, v204, v205
    v_mfma_f32_16x16x32_bf16 v[232:235], a[184:187], a[224:227], v[232:235]
    s_waitcnt lgkmcnt(0)
    v_exp_f32 v207, v207
    v_mfma_f32_16x16x32_bf16 v[200:203], v[108:111], v[174:177], v[200:203]
    v_cvt_pk_bf16_f32 v189, v206, v207
    v_sub_f32 v208, v208, v248
    v_mfma_f32_16x16x32_bf16 v[200:203], v[110:113], v[176:179], v[200:203]
    ds_read_b128 v[204:207], v245 offset:128
    v_sub_f32 v209, v209, v248
    v_mfma_f32_16x16x32_bf16 v[232:235], a[188:191], a[228:231], v[232:235]
    v_exp_f32 v208, v208
    v_mfma_f32_16x16x32_bf16 v[236:239], a[192:195], a[240:243], 0
    ds_read_b128 a[240:243], v240 offset:6272
    v_sub_f32 v210, v210, v248
    v_mfma_f32_16x16x32_bf16 v[236:239], a[196:199], a[244:247], v[236:239]
    ds_read_b128 a[244:247], v241 offset:6272
    v_sub_f32 v211, v211, v248
    v_mfma_f32_16x16x32_bf16 v[236:239], a[200:203], a[216:219], v[236:239]
    v_mul_f32 v232, s3, v232
    v_mul_f32 v233, s3, v233
    v_mfma_f32_16x16x32_bf16 v[236:239], a[204:207], a[220:223], v[236:239]
    v_mul_f32 v234, s3, v234
    v_mul_f32 v235, s3, v235
    v_mfma_f32_16x16x32_bf16 v[236:239], a[208:211], a[224:227], v[236:239]
    v_cvt_pk_bf16_f32 v170, v232, v233
    v_cvt_pk_bf16_f32 v171, v234, v235
    v_mfma_f32_16x16x32_bf16 v[236:239], a[212:215], a[228:231], v[236:239]
    ds_read_b128 a[216:219], v240 offset:6400
    ds_read_b128 a[220:223], v241 offset:6400
    v_mfma_f32_16x16x32_bf16 v[228:231], a[0:3], a[232:235], 0
    ds_read_b128 a[224:227], v254 offset:4608
    ds_read_b128 a[228:231], v255 offset:4608
    v_mfma_f32_16x16x32_bf16 v[228:231], a[4:7], a[236:239], v[228:231]
    s_waitcnt lgkmcnt(6)
    v_exp_f32 v209, v209
    v_mfma_f32_16x16x32_bf16 v[204:207], v[132:135], v[174:177], v[204:207]
    s_waitcnt lgkmcnt(5)
    v_mul_f32 v236, s38, v236
    v_mul_f32 v237, s38, v237
    v_mfma_f32_16x16x32_bf16 v[204:207], v[134:137], v[176:179], v[204:207]
    v_mul_f32 v238, s38, v238
    v_mul_f32 v239, s38, v239
    v_mfma_f32_16x16x32_bf16 v[228:231], a[8:11], a[240:243], v[228:231]
    s_waitcnt lgkmcnt(4)
    v_cvt_pk_bf16_f32 v172, v236, v237
    v_cvt_pk_bf16_f32 v173, v238, v239
    v_mfma_f32_16x16x32_bf16 v[228:231], a[12:15], a[244:247], v[228:231]
    v_exp_f32 v210, v210
    v_mfma_f32_16x16x32_bf16 v[232:235], a[24:27], a[232:235], 0
    v_exp_f32 v211, v211
    v_mfma_f32_16x16x32_bf16 v[232:235], a[28:31], a[236:239], v[232:235]
    s_waitcnt lgkmcnt(3)
    v_cvt_pk_bf16_f32 v187, v208, v209
    v_cvt_pk_bf16_f32 v190, v210, v211
    v_mfma_f32_16x16x32_bf16 v[228:231], a[16:19], a[216:219], v[228:231]
    ds_read_b128 v[208:211], v246 offset:128
    v_sub_f32 v196, v196, v248
    v_mfma_f32_16x16x32_bf16 v[212:215], v[10:13], v[184:187], v[212:215]
    s_waitcnt lgkmcnt(3)
    v_exp_f32 v196, v196
    v_mfma_f32_16x16x32_bf16 v[216:219], v[40:43], v[184:187], v[216:219]
    v_sub_f32 v197, v197, v248
    v_sub_f32 v198, v198, v248
    v_mfma_f32_16x16x32_bf16 v[220:223], v[70:73], v[184:187], v[220:223]
    v_exp_f32 v197, v197
    v_mfma_f32_16x16x32_bf16 v[224:227], a[248:251], v[184:187], v[224:227]
    v_exp_f32 v198, v198
    v_mfma_f32_16x16x32_bf16 v[228:231], a[20:23], a[220:223], v[228:231]
    v_sub_f32 v199, v199, v248
    v_cvt_pk_bf16_f32 v188, v196, v197
    v_mfma_f32_16x16x32_bf16 v[232:235], a[32:35], a[240:243], v[232:235]
    v_exp_f32 v199, v199
    v_mfma_f32_16x16x32_bf16 v[232:235], a[36:39], a[244:247], v[232:235]
    v_cvt_pk_bf16_f32 v191, v198, v199
    v_sub_f32 v200, v200, v248
    v_mfma_f32_16x16x32_bf16 v[232:235], a[40:43], a[216:219], v[232:235]
    v_cvt_pk_bf16_f32 v96, v228, v229
    v_cvt_pk_bf16_f32 v97, v230, v231
    v_mfma_f32_16x16x32_bf16 v[212:215], v[14:17], v[188:191], v[212:215]
    ds_read_b128 v[196:199], v244 offset:0
    v_sub_f32 v201, v201, v248
    v_mfma_f32_16x16x32_bf16 v[216:219], v[44:47], v[188:191], v[216:219]
    s_waitcnt lgkmcnt(1)
    v_exp_f32 v200, v200
    v_mfma_f32_16x16x32_bf16 v[220:223], v[74:77], v[188:191], v[220:223]
    v_exp_f32 v201, v201
    v_mfma_f32_16x16x32_bf16 v[224:227], a[248:251], v[188:191], v[224:227]
    v_cvt_pk_bf16_f32 v192, v200, v201
    v_sub_f32 v204, v204, v248
    v_mfma_f32_16x16x32_bf16 v[208:211], v[156:159], v[174:177], v[208:211]
    ds_read_b128 v[200:203], v245 offset:0
    v_sub_f32 v205, v205, v248
    v_mfma_f32_16x16x32_bf16 v[208:211], v[158:161], v[176:179], v[208:211]
    v_exp_f32 v204, v204
    v_mfma_f32_16x16x32_bf16 v[232:235], a[44:47], a[220:223], v[232:235]
    v_exp_f32 v205, v205
    v_mfma_f32_16x16x32_bf16 v[236:239], a[48:51], a[232:235], 0
    v_cvt_pk_bf16_f32 v193, v204, v205
    v_mfma_f32_16x16x32_bf16 v[236:239], a[52:55], a[236:239], v[236:239]
    ds_read_b128 v[204:207], v246 offset:0
    s_waitcnt lgkmcnt(2)
    v_mfma_f32_16x16x32_bf16 v[196:199], v[102:105], v[168:171], v[196:199]
    v_sub_f32 v208, v208, v248
    v_cvt_pk_bf16_f32 v98, v232, v233
    v_mfma_f32_16x16x32_bf16 v[196:199], v[104:107], v[170:173], v[196:199]
    v_cvt_pk_bf16_f32 v99, v234, v235
    v_sub_f32 v209, v209, v248
    v_mfma_f32_16x16x32_bf16 v[236:239], a[56:59], a[240:243], v[236:239]
    v_exp_f32 v208, v208
    v_mfma_f32_16x16x32_bf16 v[236:239], a[60:63], a[244:247], v[236:239]
    v_exp_f32 v209, v209
    v_mfma_f32_16x16x32_bf16 v[236:239], a[64:67], a[216:219], v[236:239]
    s_waitcnt lgkmcnt(1)
    v_cvt_pk_bf16_f32 v194, v208, v209
    v_max_f32 v248, v196, v197
    v_mfma_f32_16x16x32_bf16 v[200:203], v[126:129], v[168:171], v[200:203]
    ds_read_b128 v[208:211], v244 offset:64
    v_max3_f32 v248, v248, v198, v199
    v_mfma_f32_16x16x32_bf16 v[212:215], v[18:21], v[192:195], v[212:215]
    ds_read_b128 v[196:199], v245 offset:64
    v_mfma_f32_16x16x32_bf16 v[216:219], v[48:51], v[192:195], v[216:219]
    v_mfma_f32_16x16x32_bf16 v[220:223], v[78:81], v[192:195], v[220:223]
    s_waitcnt lgkmcnt(2)
    v_mfma_f32_16x16x32_bf16 v[224:227], a[248:251], v[192:195], v[224:227]
    v_mfma_f32_16x16x32_bf16 v[200:203], v[128:131], v[170:173], v[200:203]
    v_mfma_f32_16x16x32_bf16 v[204:207], v[150:153], v[168:171], v[204:207]
    v_mfma_f32_16x16x32_bf16 v[204:207], v[152:155], v[170:173], v[204:207]
    v_mfma_f32_16x16x32_bf16 v[236:239], a[68:71], a[220:223], v[236:239]
    v_mfma_f32_16x16x32_bf16 v[228:231], a[232:235], a[72:75], 0
    s_waitcnt lgkmcnt(1)
    s_waitcnt lgkmcnt(0)
    v_mfma_f32_16x16x32_bf16 v[208:211], v[108:111], v[168:171], v[208:211]
    v_rcp_f32 v225, v224
    v_mfma_f32_16x16x32_bf16 v[208:211], v[110:113], v[170:173], v[208:211]
    v_mul_f32 v212, v212, v225
    v_mul_f32 v213, v213, v225
    v_mfma_f32_16x16x32_bf16 v[196:199], v[132:135], v[168:171], v[196:199]
    v_cvt_pk_bf16_f32 v100, v236, v237
    v_cvt_pk_bf16_f32 v101, v238, v239
    v_mfma_f32_16x16x32_bf16 v[196:199], v[134:137], v[170:173], v[196:199]
    v_mul_f32 v214, v214, v225
    v_mul_f32 v215, v215, v225
    v_mfma_f32_16x16x32_bf16 v[228:231], a[236:239], a[76:79], v[228:231]
    v_cvt_pk_bf16_f32 v212, v212, v213
    v_cvt_pk_bf16_f32 v213, v214, v215
    v_mfma_f32_16x16x32_bf16 v[228:231], a[240:243], a[80:83], v[228:231]
    ds_write_b64 v251, v[212:213] offset:6144
    v_mfma_f32_16x16x32_bf16 v[228:231], a[244:247], a[84:87], v[228:231]
    v_mul_f32 v216, v216, v225
    v_mul_f32 v217, v217, v225
    v_mfma_f32_16x16x32_bf16 v[228:231], a[216:219], a[88:91], v[228:231]
    v_mul_f32 v218, v218, v225
    v_mul_f32 v219, v219, v225
    v_mfma_f32_16x16x32_bf16 v[228:231], a[220:223], a[92:95], v[228:231]
    v_cvt_pk_bf16_f32 v216, v216, v217
    v_cvt_pk_bf16_f32 v217, v218, v219
    v_mfma_f32_16x16x32_bf16 v[232:235], a[232:235], a[96:99], 0
    ds_write_b64 v251, v[216:217] offset:6272
    v_mfma_f32_16x16x32_bf16 v[232:235], a[236:239], a[100:103], v[232:235]
    v_mul_f32 v220, v220, v225
    v_mul_f32 v221, v221, v225
    v_mfma_f32_16x16x32_bf16 v[232:235], a[240:243], a[104:107], v[232:235]
    v_cvt_pk_bf16_f32 v26, v228, v229
    v_cvt_pk_bf16_f32 v29, v230, v231
    v_mfma_f32_16x16x32_bf16 v[232:235], a[244:247], a[108:111], v[232:235]
    v_mul_f32 v222, v222, v225
    v_mul_f32 v223, v223, v225
    v_mfma_f32_16x16x32_bf16 v[232:235], a[216:219], a[112:115], v[232:235]
    v_cvt_pk_bf16_f32 v220, v220, v221
    v_cvt_pk_bf16_f32 v221, v222, v223
    v_mfma_f32_16x16x32_bf16 v[232:235], a[220:223], a[116:119], v[232:235]
    ds_write_b64 v251, v[220:221] offset:6400
    v_mfma_f32_16x16x32_bf16 v[236:239], a[232:235], a[120:123], 0
    ds_read_b128 a[232:235], v254 offset:4736
    v_max3_f32 v248, v248, v200, v201
    v_mfma_f32_16x16x32_bf16 v[236:239], a[236:239], a[124:127], v[236:239]
    ds_read_b128 a[236:239], v255 offset:4736
    v_max3_f32 v248, v248, v202, v203
    v_mfma_f32_16x16x32_bf16 v[236:239], a[240:243], a[128:131], v[236:239]
    v_cvt_pk_bf16_f32 v56, v232, v233
    v_cvt_pk_bf16_f32 v59, v234, v235
    v_mfma_f32_16x16x32_bf16 v[236:239], a[244:247], a[132:135], v[236:239]
    ds_read_b128 a[240:243], v254 offset:4864
    ds_read_b128 a[244:247], v255 offset:4864
    v_mfma_f32_16x16x32_bf16 v[236:239], a[216:219], a[136:139], v[236:239]
    ds_read_b128 v[200:203], v246 offset:64
    v_accvgpr_read_b32 v254, a252
    v_mfma_f32_16x16x32_bf16 v[236:239], a[220:223], a[140:143], v[236:239]
    buffer_load_dwordx4 v254, s[4:7], s44 offen lds
    v_accvgpr_read_b32 v255, a253
    v_mfma_f32_16x16x32_bf16 v[228:231], a[144:147], a[224:227], 0
    v_accvgpr_read_b32 v254, a254
    v_max3_f32 v248, v248, v204, v205
    v_mfma_f32_16x16x32_bf16 v[228:231], a[148:151], a[228:231], v[228:231]
    v_max3_f32 v248, v248, v206, v207
    v_max3_f32 v248, v248, v208, v209
    v_mfma_f32_16x16x32_bf16 v[232:235], a[168:171], a[224:227], 0
    v_cvt_pk_bf16_f32 v86, v236, v237
    v_cvt_pk_bf16_f32 v89, v238, v239
    v_mfma_f32_16x16x32_bf16 v[232:235], a[172:175], a[228:231], v[232:235]
    ds_read_b128 v[204:207], v244 offset:128
    v_max3_f32 v248, v248, v210, v211
    v_mfma_f32_16x16x32_bf16 v[236:239], a[192:195], a[224:227], 0
    ds_read_b128 v[208:211], v245 offset:128
    v_max3_f32 v248, v248, v196, v197
    v_mfma_f32_16x16x32_bf16 v[236:239], a[196:199], a[228:231], v[236:239]
    s_waitcnt lgkmcnt(6)
    v_max3_f32 v248, v248, v198, v199
    v_mfma_f32_16x16x32_bf16 v[228:231], a[152:155], a[232:235], v[228:231]
    ds_read_b128 v[196:199], v246 offset:128
    s_waitcnt vmcnt(6) lgkmcnt(4)
    v_mfma_f32_16x16x32_bf16 v[228:231], a[156:159], a[236:239], v[228:231]
    s_barrier
    ds_read_b128 a[216:219], v240 offset:30720
    v_mfma_f32_16x16x32_bf16 v[228:231], a[160:163], a[240:243], v[228:231]
    ds_read_b128 a[220:223], v241 offset:30720
    ds_read_b128 a[224:227], v240 offset:30848
    v_mfma_f32_16x16x32_bf16 v[228:231], a[164:167], a[244:247], v[228:231]
    ds_read_b128 a[228:231], v241 offset:30848
    buffer_load_dwordx4 v255, s[4:7], s44 offen offset:1024 lds
    v_mfma_f32_16x16x32_bf16 v[232:235], a[176:179], a[232:235], v[232:235]
    s_waitcnt lgkmcnt(7)
    v_accvgpr_read_b32 v255, a252
    v_mfma_f32_16x16x32_bf16 v[200:203], v[156:159], v[168:171], v[200:203]
    s_waitcnt lgkmcnt(6)
    v_mfma_f32_16x16x32_bf16 v[200:203], v[158:161], v[170:173], v[200:203]
    s_waitcnt lgkmcnt(5)
    v_mul_f32 v228, s38, v228
    v_mul_f32 v229, s38, v229
    v_mfma_f32_16x16x32_bf16 v[204:207], v[162:165], v[168:171], v[204:207]
    v_mul_f32 v230, s38, v230
    v_mul_f32 v231, s38, v231
    v_mfma_f32_16x16x32_bf16 v[204:207], v[164:167], v[170:173], v[204:207]
    s_waitcnt lgkmcnt(4)
    v_cvt_pk_bf16_f32 v174, v228, v229
    v_cvt_pk_bf16_f32 v175, v230, v231
    v_mfma_f32_16x16x32_bf16 v[208:211], v[90:93], v[168:171], v[208:211]
    ds_write_b64 v247, v[174:175] offset:0
    v_mfma_f32_16x16x32_bf16 v[208:211], v[92:95], v[170:173], v[208:211]
    buffer_load_dwordx4 v254, s[4:7], s44 offen offset:2048 lds
    s_add_u32 m0, s46, 0xc00
    v_mfma_f32_16x16x32_bf16 v[196:199], v[96:99], v[168:171], v[196:199]
    s_waitcnt lgkmcnt(4)
    v_accvgpr_read_b32 v254, a253
    v_max3_f32 v248, v248, v200, v201
    v_mfma_f32_16x16x32_bf16 v[196:199], v[98:101], v[170:173], v[196:199]
    v_max3_f32 v248, v248, v202, v203
    v_max3_f32 v248, v248, v204, v205
    v_mfma_f32_16x16x32_bf16 v[232:235], a[180:183], a[236:239], v[232:235]
    ds_read_b128 v[200:203], v244 offset:0
    ds_read_b128 v[204:207], v245 offset:0
    v_mfma_f32_16x16x32_bf16 v[232:235], a[184:187], a[240:243], v[232:235]
    buffer_load_dwordx4 v255, s[4:7], s59 offen lds
    v_accvgpr_read_b32 v255, a254
    v_mfma_f32_16x16x32_bf16 v[232:235], a[188:191], a[244:247], v[232:235]
    v_max3_f32 v248, v248, v208, v209
    v_max3_f32 v248, v248, v196, v197
    v_mfma_f32_16x16x32_bf16 v[236:239], a[200:203], a[232:235], v[236:239]
    ds_read_b128 a[232:235], v240 offset:30976
    ds_read_b128 v[208:211], v246 offset:0
    v_mfma_f32_16x16x32_bf16 v[236:239], a[204:207], a[236:239], v[236:239]
    ds_read_b128 a[236:239], v241 offset:30976
    ds_read_b128 v[196:199], v244 offset:64
    v_mfma_f32_16x16x32_bf16 v[236:239], a[208:211], a[240:243], v[236:239]
    v_mul_f32 v232, s3, v232
    v_mul_f32 v233, s3, v233
    v_mfma_f32_16x16x32_bf16 v[236:239], a[212:215], a[244:247], v[236:239]
    v_mul_f32 v234, s3, v234
    v_mul_f32 v235, s3, v235
    v_mfma_f32_16x16x32_bf16 v[228:231], a[0:3], a[216:219], 0
    s_waitcnt lgkmcnt(7)
    v_cvt_pk_bf16_f32 v176, v232, v233
    v_cvt_pk_bf16_f32 v177, v234, v235
    v_mfma_f32_16x16x32_bf16 v[228:231], a[4:7], a[220:223], v[228:231]
    ds_write_b64 v247, v[176:177] offset:128
    v_mfma_f32_16x16x32_bf16 v[228:231], a[8:11], a[224:227], v[228:231]
    s_waitcnt lgkmcnt(5)
    v_mul_f32 v236, s38, v236
    v_mul_f32 v237, s38, v237
    v_mfma_f32_16x16x32_bf16 v[200:203], v[102:105], v[168:171], v[200:203]
    v_mul_f32 v238, s38, v238
    v_mul_f32 v239, s38, v239
    v_mfma_f32_16x16x32_bf16 v[200:203], v[104:107], v[170:173], v[200:203]
    v_cvt_pk_bf16_f32 v178, v236, v237
    v_cvt_pk_bf16_f32 v179, v238, v239
    v_mfma_f32_16x16x32_bf16 v[204:207], v[126:129], v[168:171], v[204:207]
    ds_write_b64 v247, v[178:179] offset:256
    v_mfma_f32_16x16x32_bf16 v[204:207], v[128:131], v[170:173], v[204:207]
    ds_read_b128 a[240:243], v242 offset:30720
    ds_read_b128 a[244:247], v243 offset:30720
    v_mfma_f32_16x16x32_bf16 v[228:231], a[12:15], a[228:231], v[228:231]
    buffer_load_dwordx4 v254, s[4:7], s59 offen offset:1024 lds
    v_accvgpr_read_b32 v254, a252
    v_mfma_f32_16x16x32_bf16 v[232:235], a[24:27], a[216:219], 0
    s_waitcnt lgkmcnt(4)
    v_mov_b32 v225, v248
    v_mfma_f32_16x16x32_bf16 v[208:211], v[150:153], v[168:171], v[208:211]
    v_mfma_f32_16x16x32_bf16 v[208:211], v[152:155], v[170:173], v[208:211]
    v_permlane16_swap_b32 v248, v225
    v_max_f32 v248, v248, v225
    v_mfma_f32_16x16x32_bf16 v[196:199], v[108:111], v[168:171], v[196:199]
    buffer_load_dwordx4 v255, s[4:7], s59 offen offset:2048 lds
    s_add_u32 m0, s46, 0x1800
    v_mfma_f32_16x16x32_bf16 v[196:199], v[110:113], v[170:173], v[196:199]
    v_accvgpr_read_b32 v255, a255
    v_mov_b32 v225, v248
    v_mfma_f32_16x16x32_bf16 v[228:231], a[16:19], a[232:235], v[228:231]
    v_mfma_f32_16x16x32_bf16 v[228:231], a[20:23], a[236:239], v[228:231]
    v_permlane32_swap_b32 v248, v225
    v_max_f32 v248, v248, v225
    v_mfma_f32_16x16x32_bf16 v[232:235], a[28:31], a[220:223], v[232:235]
    buffer_load_dwordx4 v254, s[4:7], s58 offen lds
    v_sub_f32 v200, v200, v248
    v_mfma_f32_16x16x32_bf16 v[232:235], a[32:35], a[224:227], v[232:235]
    v_exp_f32 v200, v200
    v_mfma_f32_16x16x32_bf16 v[232:235], a[36:39], a[228:231], v[232:235]
    v_cvt_pk_bf16_f32 v102, v228, v229
    v_cvt_pk_bf16_f32 v103, v230, v231
    v_mfma_f32_16x16x32_bf16 v[232:235], a[40:43], a[232:235], v[232:235]
    v_sub_f32 v201, v201, v248
    v_sub_f32 v202, v202, v248
    v_mfma_f32_16x16x32_bf16 v[232:235], a[44:47], a[236:239], v[232:235]
    buffer_load_dwordx4 v255, s[4:7], s58 offen offset:512 lds
    s_add_u32 m0, s46, 0x16800
    v_mfma_f32_16x16x32_bf16 v[236:239], a[48:51], a[216:219], 0
    v_exp_f32 v201, v201
    v_mfma_f32_16x16x32_bf16 v[236:239], a[52:55], a[220:223], v[236:239]
    v_exp_f32 v202, v202
    v_mfma_f32_16x16x32_bf16 v[236:239], a[56:59], a[224:227], v[236:239]
    v_sub_f32 v203, v203, v248
    v_cvt_pk_bf16_f32 v104, v232, v233
    v_mfma_f32_16x16x32_bf16 v[236:239], a[60:63], a[228:231], v[236:239]
    v_cvt_pk_bf16_f32 v105, v234, v235
    v_cvt_pk_bf16_f32 v180, v200, v201
    v_mfma_f32_16x16x32_bf16 v[236:239], a[64:67], a[232:235], v[236:239]
    v_exp_f32 v203, v203
    v_mfma_f32_16x16x32_bf16 v[236:239], a[68:71], a[236:239], v[236:239]
    v_cvt_pk_bf16_f32 v183, v202, v203
    v_sub_f32 v204, v204, v248
    v_mfma_f32_16x16x32_bf16 v[228:231], a[216:219], a[72:75], 0
    ds_read_b128 v[200:203], v245 offset:64
    v_sub_f32 v205, v205, v248
    v_mfma_f32_16x16x32_bf16 v[228:231], a[220:223], a[76:79], v[228:231]
    v_exp_f32 v204, v204
    v_mfma_f32_16x16x32_bf16 v[228:231], a[224:227], a[80:83], v[228:231]
    v_cvt_pk_bf16_f32 v106, v236, v237
    v_cvt_pk_bf16_f32 v107, v238, v239
    v_mfma_f32_16x16x32_bf16 v[228:231], a[228:231], a[84:87], v[228:231]
    v_exp_f32 v205, v205
    v_mfma_f32_16x16x32_bf16 v[228:231], a[232:235], a[88:91], v[228:231]
    v_sub_f32 v206, v206, v248
    v_sub_f32 v207, v207, v248
    v_mfma_f32_16x16x32_bf16 v[228:231], a[236:239], a[92:95], v[228:231]
    v_exp_f32 v206, v206
    v_mfma_f32_16x16x32_bf16 v[232:235], a[216:219], a[96:99], 0
    v_exp_f32 v207, v207
    v_mfma_f32_16x16x32_bf16 v[232:235], a[220:223], a[100:103], v[232:235]
    v_cvt_pk_bf16_f32 v181, v204, v205
    v_cvt_pk_bf16_f32 v184, v206, v207
    v_mfma_f32_16x16x32_bf16 v[232:235], a[224:227], a[104:107], v[232:235]
    ds_read_b128 v[204:207], v246 offset:64
    v_cvt_pk_bf16_f32 v0, v228, v229
    v_mfma_f32_16x16x32_bf16 v[232:235], a[228:231], a[108:111], v[232:235]
    s_waitcnt lgkmcnt(1)
    v_cvt_pk_bf16_f32 v3, v230, v231
    v_sub_f32 v208, v208, v248
    v_mfma_f32_16x16x32_bf16 v[200:203], v[132:135], v[168:171], v[200:203]
    v_exp_f32 v208, v208
    v_mfma_f32_16x16x32_bf16 v[200:203], v[134:137], v[170:173], v[200:203]
    v_sub_f32 v209, v209, v248
    v_sub_f32 v210, v210, v248
    v_mfma_f32_16x16x32_bf16 v[232:235], a[232:235], a[112:115], v[232:235]
    v_exp_f32 v209, v209
    v_mfma_f32_16x16x32_bf16 v[232:235], a[236:239], a[116:119], v[232:235]
    v_exp_f32 v210, v210
    v_mfma_f32_16x16x32_bf16 v[236:239], a[216:219], a[120:123], 0
    ds_read_b128 a[216:219], v242 offset:30848
    v_sub_f32 v211, v211, v248
    v_mfma_f32_16x16x32_bf16 v[236:239], a[220:223], a[124:127], v[236:239]
    ds_read_b128 a[220:223], v243 offset:30848
    v_cvt_pk_bf16_f32 v182, v208, v209
    v_mfma_f32_16x16x32_bf16 v[236:239], a[224:227], a[128:131], v[236:239]
    v_cvt_pk_bf16_f32 v30, v232, v233
    v_cvt_pk_bf16_f32 v33, v234, v235
    v_mfma_f32_16x16x32_bf16 v[212:215], v[12:15], v[180:183], 0
    ds_read_b128 a[224:227], v242 offset:30976
    v_sub_f32 v196, v196, v248
    v_mfma_f32_16x16x32_bf16 v[216:219], v[42:45], v[180:183], 0
    s_waitcnt lgkmcnt(3)
    v_exp_f32 v211, v211
    v_mfma_f32_16x16x32_bf16 v[220:223], v[72:75], v[180:183], 0
    v_cvt_pk_bf16_f32 v185, v210, v211
    v_sub_f32 v197, v197, v248
    v_mfma_f32_16x16x32_bf16 v[224:227], a[248:251], v[180:183], 0
    ds_read_b128 v[208:211], v244 offset:128
    v_sub_f32 v198, v198, v248
    v_mfma_f32_16x16x32_bf16 v[204:207], v[156:159], v[168:171], v[204:207]
    v_exp_f32 v196, v196
    v_mfma_f32_16x16x32_bf16 v[204:207], v[158:161], v[170:173], v[204:207]
    v_exp_f32 v197, v197
    v_mfma_f32_16x16x32_bf16 v[236:239], a[228:231], a[132:135], v[236:239]
    ds_read_b128 a[228:231], v243 offset:30976
    v_sub_f32 v199, v199, v248
    v_mfma_f32_16x16x32_bf16 v[236:239], a[232:235], a[136:139], v[236:239]
    ds_read_b128 a[232:235], v240 offset:32256
    v_cvt_pk_bf16_f32 v186, v196, v197
    v_mfma_f32_16x16x32_bf16 v[236:239], a[236:239], a[140:143], v[236:239]
    ds_read_b128 a[236:239], v241 offset:32256
    v_sub_f32 v200, v200, v248
    v_mfma_f32_16x16x32_bf16 v[228:231], a[144:147], a[240:243], 0
    v_exp_f32 v198, v198
    v_mfma_f32_16x16x32_bf16 v[228:231], a[148:151], a[244:247], v[228:231]
    s_waitcnt lgkmcnt(6)
    v_exp_f32 v199, v199
    v_mfma_f32_16x16x32_bf16 v[228:231], a[152:155], a[216:219], v[228:231]
    s_waitcnt lgkmcnt(5)
    v_cvt_pk_bf16_f32 v60, v236, v237
    v_cvt_pk_bf16_f32 v63, v238, v239
    v_mfma_f32_16x16x32_bf16 v[228:231], a[156:159], a[220:223], v[228:231]
    s_waitcnt lgkmcnt(3)
    v_cvt_pk_bf16_f32 v189, v198, v199
    v_sub_f32 v201, v201, v248
    v_mfma_f32_16x16x32_bf16 v[208:211], v[162:165], v[168:171], v[208:211]
    ds_read_b128 v[196:199], v245 offset:128
    v_sub_f32 v202, v202, v248
    v_mfma_f32_16x16x32_bf16 v[208:211], v[164:167], v[170:173], v[208:211]
    v_exp_f32 v200, v200
    v_mfma_f32_16x16x32_bf16 v[228:231], a[160:163], a[224:227], v[228:231]
    s_waitcnt lgkmcnt(3)
    v_exp_f32 v201, v201
    v_mfma_f32_16x16x32_bf16 v[228:231], a[164:167], a[228:231], v[228:231]
    v_exp_f32 v202, v202
    v_mfma_f32_16x16x32_bf16 v[232:235], a[168:171], a[240:243], 0
    v_sub_f32 v203, v203, v248
    v_cvt_pk_bf16_f32 v187, v200, v201
    v_mfma_f32_16x16x32_bf16 v[232:235], a[172:175], a[244:247], v[232:235]
    v_exp_f32 v203, v203
    v_mfma_f32_16x16x32_bf16 v[212:215], v[16:19], v[184:187], v[212:215]
    v_cvt_pk_bf16_f32 v190, v202, v203
    v_mul_f32 v228, s38, v228
    v_mfma_f32_16x16x32_bf16 v[216:219], v[46:49], v[184:187], v[216:219]
    v_mul_f32 v229, s38, v229
    v_mul_f32 v230, s38, v230
    v_mfma_f32_16x16x32_bf16 v[220:223], v[76:79], v[184:187], v[220:223]
    ds_read_b128 v[200:203], v246 offset:128
    v_mul_f32 v231, s38, v231
    v_mfma_f32_16x16x32_bf16 v[224:227], a[248:251], v[184:187], v[224:227]
    s_waitcnt lgkmcnt(1)
    v_sub_f32 v204, v204, v248
    v_sub_f32 v205, v205, v248
    v_mfma_f32_16x16x32_bf16 v[196:199], v[90:93], v[168:171], v[196:199]
    v_exp_f32 v204, v204
    v_mfma_f32_16x16x32_bf16 v[196:199], v[92:95], v[170:173], v[196:199]
    v_exp_f32 v205, v205
    v_mfma_f32_16x16x32_bf16 v[232:235], a[176:179], a[216:219], v[232:235]
    v_sub_f32 v206, v206, v248
    v_sub_f32 v207, v207, v248
    v_mfma_f32_16x16x32_bf16 v[232:235], a[180:183], a[220:223], v[232:235]
    v_exp_f32 v206, v206
    v_mfma_f32_16x16x32_bf16 v[232:235], a[184:187], a[224:227], v[232:235]
    v_exp_f32 v207, v207
    v_mfma_f32_16x16x32_bf16 v[232:235], a[188:191], a[228:231], v[232:235]
    v_cvt_pk_bf16_f32 v188, v204, v205
    v_cvt_pk_bf16_f32 v191, v206, v207
    v_mfma_f32_16x16x32_bf16 v[236:239], a[192:195], a[240:243], 0
    ds_read_b128 a[240:243], v240 offset:32384
    ds_read_b128 v[204:207], v244 offset:0
    v_mfma_f32_16x16x32_bf16 v[212:215], v[20:23], v[188:191], v[212:215]
    s_waitcnt lgkmcnt(2)
    v_sub_f32 v208, v208, v248
    v_mul_f32 v232, s3, v232
    v_mfma_f32_16x16x32_bf16 v[216:219], v[50:53], v[188:191], v[216:219]
    v_mul_f32 v233, s3, v233
    v_mul_f32 v234, s3, v234
    v_mfma_f32_16x16x32_bf16 v[220:223], v[80:83], v[188:191], v[220:223]
    v_mul_f32 v235, s3, v235
    v_sub_f32 v209, v209, v248
    v_mfma_f32_16x16x32_bf16 v[224:227], a[248:251], v[188:191], v[224:227]
    v_exp_f32 v208, v208
    v_mfma_f32_16x16x32_bf16 v[200:203], v[96:99], v[168:171], v[200:203]
    v_cvt_pk_bf16_f32 v168, v228, v229
    v_cvt_pk_bf16_f32 v169, v230, v231
    v_mfma_f32_16x16x32_bf16 v[200:203], v[98:101], v[170:173], v[200:203]
    v_cvt_pk_bf16_f32 v170, v232, v233
    v_cvt_pk_bf16_f32 v171, v234, v235
    v_mfma_f32_16x16x32_bf16 v[236:239], a[196:199], a[244:247], v[236:239]
    ds_read_b128 a[244:247], v241 offset:32384
    v_sub_f32 v196, v196, v248
    v_mfma_f32_16x16x32_bf16 v[236:239], a[200:203], a[216:219], v[236:239]
    ds_read_b128 a[216:219], v240 offset:32512
    v_sub_f32 v197, v197, v248
    v_mfma_f32_16x16x32_bf16 v[236:239], a[204:207], a[220:223], v[236:239]
    ds_read_b128 a[220:223], v241 offset:32512
    v_sub_f32 v200, v200, v248
    v_mfma_f32_16x16x32_bf16 v[236:239], a[208:211], a[224:227], v[236:239]
    ds_read_b128 a[224:227], v242 offset:32256
    v_sub_f32 v201, v201, v248
    v_mfma_f32_16x16x32_bf16 v[236:239], a[212:215], a[228:231], v[236:239]
    ds_read_b128 a[228:231], v243 offset:32256
    s_waitcnt lgkmcnt(5)
    v_mfma_f32_16x16x32_bf16 v[204:207], v[108:111], v[174:177], v[204:207]
    v_exp_f32 v209, v209
    v_mfma_f32_16x16x32_bf16 v[204:207], v[110:113], v[176:179], v[204:207]
    v_exp_f32 v196, v196
    v_mfma_f32_16x16x32_bf16 v[228:231], a[0:3], a[232:235], 0
    v_exp_f32 v197, v197
    v_mfma_f32_16x16x32_bf16 v[228:231], a[4:7], a[236:239], v[228:231]
    v_mul_f32 v236, s38, v236
    v_mul_f32 v237, s38, v237
    v_mfma_f32_16x16x32_bf16 v[228:231], a[8:11], a[240:243], v[228:231]
    s_waitcnt lgkmcnt(4)
    v_mul_f32 v238, s38, v238
    v_mul_f32 v239, s38, v239
    v_mfma_f32_16x16x32_bf16 v[228:231], a[12:15], a[244:247], v[228:231]
    s_waitcnt lgkmcnt(3)
    v_cvt_pk_bf16_f32 v172, v236, v237
    v_cvt_pk_bf16_f32 v173, v238, v239
    v_mfma_f32_16x16x32_bf16 v[228:231], a[16:19], a[216:219], v[228:231]
    s_waitcnt lgkmcnt(2)
    v_cvt_pk_bf16_f32 v192, v208, v209
    v_cvt_pk_bf16_f32 v193, v196, v197
    v_mfma_f32_16x16x32_bf16 v[228:231], a[20:23], a[220:223], v[228:231]
    ds_read_b128 v[208:211], v245 offset:0
    ds_read_b128 v[196:199], v246 offset:0
    v_mfma_f32_16x16x32_bf16 v[232:235], a[24:27], a[232:235], 0
    v_exp_f32 v200, v200
    v_mfma_f32_16x16x32_bf16 v[232:235], a[28:31], a[236:239], v[232:235]
    v_exp_f32 v201, v201
    v_mfma_f32_16x16x32_bf16 v[232:235], a[32:35], a[240:243], v[232:235]
    v_cvt_pk_bf16_f32 v194, v200, v201
    v_max_f32 v248, v204, v205
    v_mfma_f32_16x16x32_bf16 v[232:235], a[36:39], a[244:247], v[232:235]
    ds_read_b128 v[200:203], v244 offset:64
    v_max3_f32 v248, v248, v206, v207
    v_mfma_f32_16x16x32_bf16 v[212:215], v[24:27], v[192:195], v[212:215]
    ds_read_b128 v[204:207], v245 offset:64
    v_mfma_f32_16x16x32_bf16 v[216:219], v[54:57], v[192:195], v[216:219]
    v_mfma_f32_16x16x32_bf16 v[220:223], v[84:87], v[192:195], v[220:223]
    v_mfma_f32_16x16x32_bf16 v[224:227], a[248:251], v[192:195], v[224:227]
    v_mfma_f32_16x16x32_bf16 v[232:235], a[40:43], a[216:219], v[232:235]
    s_waitcnt lgkmcnt(3)
    s_waitcnt lgkmcnt(2)
    v_mfma_f32_16x16x32_bf16 v[208:211], v[132:135], v[174:177], v[208:211]
    v_mfma_f32_16x16x32_bf16 v[208:211], v[134:137], v[176:179], v[208:211]
    v_mfma_f32_16x16x32_bf16 v[196:199], v[156:159], v[174:177], v[196:199]
    v_mfma_f32_16x16x32_bf16 v[196:199], v[158:161], v[176:179], v[196:199]
    s_waitcnt lgkmcnt(1)
    v_rcp_f32 v225, v224
    v_mfma_f32_16x16x32_bf16 v[200:203], v[162:165], v[174:177], v[200:203]
    s_waitcnt lgkmcnt(0)
    v_mul_f32 v212, v212, v225
    v_mul_f32 v213, v213, v225
    v_mfma_f32_16x16x32_bf16 v[200:203], v[164:167], v[176:179], v[200:203]
    v_mul_f32 v214, v214, v225
    v_mul_f32 v215, v215, v225
    v_mfma_f32_16x16x32_bf16 v[204:207], v[90:93], v[174:177], v[204:207]
    v_cvt_pk_bf16_f32 v212, v212, v213
    v_cvt_pk_bf16_f32 v213, v214, v215
    v_mfma_f32_16x16x32_bf16 v[204:207], v[92:95], v[176:179], v[204:207]
    ds_write_b64 v251, v[212:213] offset:12288
    v_mfma_f32_16x16x32_bf16 v[232:235], a[44:47], a[220:223], v[232:235]
    v_mul_f32 v216, v216, v225
    v_mul_f32 v217, v217, v225
    v_mfma_f32_16x16x32_bf16 v[236:239], a[48:51], a[232:235], 0
    v_mul_f32 v218, v218, v225
    v_mul_f32 v219, v219, v225
    v_mfma_f32_16x16x32_bf16 v[236:239], a[52:55], a[236:239], v[236:239]
    v_cvt_pk_bf16_f32 v216, v216, v217
    v_cvt_pk_bf16_f32 v217, v218, v219
    v_mfma_f32_16x16x32_bf16 v[236:239], a[56:59], a[240:243], v[236:239]
    ds_write_b64 v251, v[216:217] offset:12416
    v_mfma_f32_16x16x32_bf16 v[236:239], a[60:63], a[244:247], v[236:239]
    v_mul_f32 v220, v220, v225
    v_mul_f32 v221, v221, v225
    v_mfma_f32_16x16x32_bf16 v[236:239], a[64:67], a[216:219], v[236:239]
    v_mul_f32 v222, v222, v225
    v_mul_f32 v223, v223, v225
    v_mfma_f32_16x16x32_bf16 v[236:239], a[68:71], a[220:223], v[236:239]
    v_cvt_pk_bf16_f32 v220, v220, v221
    v_cvt_pk_bf16_f32 v221, v222, v223
    ds_write_b64 v251, v[220:221] offset:12544
    v_max3_f32 v248, v248, v208, v209
    v_max3_f32 v248, v248, v210, v211
    ds_read_b128 v[208:211], v246 offset:64
    v_max3_f32 v248, v248, v196, v197
    v_max3_f32 v248, v248, v198, v199
    ds_read_b128 v[196:199], v244 offset:0
    v_max3_f32 v248, v248, v200, v201
    v_max3_f32 v248, v248, v202, v203
    ds_read_b128 v[200:203], v245 offset:0
    v_max3_f32 v248, v248, v204, v205
    v_max3_f32 v248, v248, v206, v207
    ds_read_b128 v[204:207], v246 offset:0
    s_waitcnt lgkmcnt(3)
    v_mfma_f32_16x16x32_bf16 v[208:211], v[96:99], v[174:177], v[208:211]
    v_mfma_f32_16x16x32_bf16 v[208:211], v[98:101], v[176:179], v[208:211]
    s_waitcnt lgkmcnt(2)
    v_mfma_f32_16x16x32_bf16 v[196:199], v[108:111], v[174:177], v[196:199]
    s_waitcnt lgkmcnt(1)
    v_cvt_pk_bf16_f32 v108, v228, v229
    v_cvt_pk_bf16_f32 v109, v230, v231
    v_mfma_f32_16x16x32_bf16 v[196:199], v[110:113], v[176:179], v[196:199]
    v_cvt_pk_bf16_f32 v110, v232, v233
    v_cvt_pk_bf16_f32 v111, v234, v235
    v_mfma_f32_16x16x32_bf16 v[200:203], v[132:135], v[174:177], v[200:203]
    s_waitcnt lgkmcnt(0)
    v_cvt_pk_bf16_f32 v112, v236, v237
    v_cvt_pk_bf16_f32 v113, v238, v239
    v_mfma_f32_16x16x32_bf16 v[200:203], v[134:137], v[176:179], v[200:203]
    v_max3_f32 v248, v248, v208, v209
    v_max3_f32 v248, v248, v210, v211
    v_mfma_f32_16x16x32_bf16 v[204:207], v[156:159], v[174:177], v[204:207]
    ds_read_b128 v[208:211], v244 offset:64
    v_mov_b32 v225, v248
    v_mfma_f32_16x16x32_bf16 v[204:207], v[158:161], v[176:179], v[204:207]
    v_mfma_f32_16x16x32_bf16 v[228:231], a[232:235], a[72:75], 0
    v_permlane16_swap_b32 v248, v225
    v_max_f32 v248, v248, v225
    v_mfma_f32_16x16x32_bf16 v[228:231], a[236:239], a[76:79], v[228:231]
    v_mov_b32 v225, v248
    v_mfma_f32_16x16x32_bf16 v[228:231], a[240:243], a[80:83], v[228:231]
    v_mfma_f32_16x16x32_bf16 v[228:231], a[244:247], a[84:87], v[228:231]
    v_permlane32_swap_b32 v248, v225
    v_max_f32 v248, v248, v225
    v_mfma_f32_16x16x32_bf16 v[228:231], a[216:219], a[88:91], v[228:231]
    v_sub_f32 v196, v196, v248
    v_sub_f32 v197, v197, v248
    v_mfma_f32_16x16x32_bf16 v[228:231], a[220:223], a[92:95], v[228:231]
    v_exp_f32 v196, v196
    v_mfma_f32_16x16x32_bf16 v[232:235], a[232:235], a[96:99], 0
    v_exp_f32 v197, v197
    v_mfma_f32_16x16x32_bf16 v[232:235], a[236:239], a[100:103], v[232:235]
    s_waitcnt lgkmcnt(0)
    v_sub_f32 v198, v198, v248
    v_sub_f32 v199, v199, v248
    v_mfma_f32_16x16x32_bf16 v[208:211], v[162:165], v[174:177], v[208:211]
    v_cvt_pk_bf16_f32 v6, v228, v229
    v_cvt_pk_bf16_f32 v9, v230, v231
    v_mfma_f32_16x16x32_bf16 v[208:211], v[164:167], v[176:179], v[208:211]
    v_exp_f32 v198, v198
    v_mfma_f32_16x16x32_bf16 v[232:235], a[240:243], a[104:107], v[232:235]
    v_exp_f32 v199, v199
    v_mfma_f32_16x16x32_bf16 v[232:235], a[244:247], a[108:111], v[232:235]
    v_cvt_pk_bf16_f32 v180, v196, v197
    v_cvt_pk_bf16_f32 v183, v198, v199
    v_mfma_f32_16x16x32_bf16 v[232:235], a[216:219], a[112:115], v[232:235]
    ds_read_b128 v[196:199], v245 offset:64
    v_sub_f32 v200, v200, v248
    v_mfma_f32_16x16x32_bf16 v[232:235], a[220:223], a[116:119], v[232:235]
    v_exp_f32 v200, v200
    v_mfma_f32_16x16x32_bf16 v[236:239], a[232:235], a[120:123], 0
    ds_read_b128 a[232:235], v242 offset:32384
    v_sub_f32 v201, v201, v248
    v_mfma_f32_16x16x32_bf16 v[236:239], a[236:239], a[124:127], v[236:239]
    ds_read_b128 a[236:239], v243 offset:32384
    v_sub_f32 v202, v202, v248
    v_mfma_f32_16x16x32_bf16 v[236:239], a[240:243], a[128:131], v[236:239]
    v_cvt_pk_bf16_f32 v36, v232, v233
    v_cvt_pk_bf16_f32 v39, v234, v235
    v_mfma_f32_16x16x32_bf16 v[236:239], a[244:247], a[132:135], v[236:239]
    ds_read_b128 a[240:243], v242 offset:32512
    ds_read_b128 a[244:247], v243 offset:32512
    v_mfma_f32_16x16x32_bf16 v[236:239], a[216:219], a[136:139], v[236:239]
    ds_read_b128 a[216:219], v242 offset:33792
    v_sub_f32 v203, v203, v248
    v_mfma_f32_16x16x32_bf16 v[236:239], a[220:223], a[140:143], v[236:239]
    ds_read_b128 a[220:223], v243 offset:33792
    v_sub_f32 v204, v204, v248
    v_mfma_f32_16x16x32_bf16 v[228:231], a[144:147], a[224:227], 0
    v_exp_f32 v201, v201
    v_mfma_f32_16x16x32_bf16 v[228:231], a[148:151], a[228:231], v[228:231]
    s_waitcnt lgkmcnt(6)
    v_exp_f32 v202, v202
    v_mfma_f32_16x16x32_bf16 v[196:199], v[90:93], v[174:177], v[196:199]
    v_cvt_pk_bf16_f32 v66, v236, v237
    v_cvt_pk_bf16_f32 v69, v238, v239
    v_mfma_f32_16x16x32_bf16 v[196:199], v[92:95], v[176:179], v[196:199]
    s_waitcnt lgkmcnt(5)
    v_exp_f32 v203, v203
    v_mfma_f32_16x16x32_bf16 v[228:231], a[152:155], a[232:235], v[228:231]
    s_waitcnt lgkmcnt(4)
    v_cvt_pk_bf16_f32 v181, v200, v201
    v_cvt_pk_bf16_f32 v184, v202, v203
    v_mfma_f32_16x16x32_bf16 v[228:231], a[156:159], a[236:239], v[228:231]
    ds_read_b128 v[200:203], v246 offset:64
    v_sub_f32 v205, v205, v248
    v_mfma_f32_16x16x32_bf16 v[232:235], a[168:171], a[224:227], 0
    s_waitcnt lgkmcnt(4)
    v_exp_f32 v204, v204
    v_mfma_f32_16x16x32_bf16 v[228:231], a[160:163], a[240:243], v[228:231]
    s_waitcnt lgkmcnt(3)
    v_exp_f32 v205, v205
    v_mfma_f32_16x16x32_bf16 v[228:231], a[164:167], a[244:247], v[228:231]
    v_sub_f32 v206, v206, v248
    v_sub_f32 v207, v207, v248
    v_mfma_f32_16x16x32_bf16 v[232:235], a[172:175], a[228:231], v[232:235]
    v_exp_f32 v206, v206
    v_mfma_f32_16x16x32_bf16 v[232:235], a[176:179], a[232:235], v[232:235]
    v_exp_f32 v207, v207
    v_mfma_f32_16x16x32_bf16 v[232:235], a[180:183], a[236:239], v[232:235]
    v_cvt_pk_bf16_f32 v182, v204, v205
    v_mul_f32 v228, s38, v228
    v_mfma_f32_16x16x32_bf16 v[232:235], a[184:187], a[240:243], v[232:235]
    v_mul_f32 v229, s38, v229
    v_mul_f32 v230, s38, v230
    v_mfma_f32_16x16x32_bf16 v[212:215], v[18:21], v[180:183], 0
    v_mul_f32 v231, s38, v231
    v_cvt_pk_bf16_f32 v185, v206, v207
    v_mfma_f32_16x16x32_bf16 v[216:219], v[48:51], v[180:183], 0
    s_waitcnt lgkmcnt(0)
    v_sub_f32 v208, v208, v248
    v_sub_f32 v209, v209, v248
    v_mfma_f32_16x16x32_bf16 v[220:223], v[78:81], v[180:183], 0
    v_exp_f32 v208, v208
    v_mfma_f32_16x16x32_bf16 v[224:227], a[248:251], v[180:183], 0
    v_exp_f32 v209, v209
    v_mfma_f32_16x16x32_bf16 v[200:203], v[96:99], v[174:177], v[200:203]
    v_cvt_pk_bf16_f32 v174, v228, v229
    v_cvt_pk_bf16_f32 v175, v230, v231
    v_mfma_f32_16x16x32_bf16 v[200:203], v[98:101], v[176:179], v[200:203]
    v_sub_f32 v210, v210, v248
    v_sub_f32 v211, v211, v248
    v_mfma_f32_16x16x32_bf16 v[232:235], a[188:191], a[244:247], v[232:235]
    v_exp_f32 v210, v210
    v_mfma_f32_16x16x32_bf16 v[236:239], a[192:195], a[224:227], 0
    ds_read_b128 a[224:227], v242 offset:33920
    v_cvt_pk_bf16_f32 v186, v208, v209
    v_mfma_f32_16x16x32_bf16 v[236:239], a[196:199], a[228:231], v[236:239]
    ds_read_b128 a[228:231], v243 offset:33920
    v_sub_f32 v196, v196, v248
    v_mfma_f32_16x16x32_bf16 v[236:239], a[200:203], a[232:235], v[236:239]
    v_mul_f32 v232, s3, v232
    v_mul_f32 v233, s3, v233
    v_mfma_f32_16x16x32_bf16 v[236:239], a[204:207], a[236:239], v[236:239]
    v_mul_f32 v234, s3, v234
    v_mul_f32 v235, s3, v235
    v_mfma_f32_16x16x32_bf16 v[236:239], a[208:211], a[240:243], v[236:239]
    v_cvt_pk_bf16_f32 v176, v232, v233
    v_cvt_pk_bf16_f32 v177, v234, v235
    v_mfma_f32_16x16x32_bf16 v[236:239], a[212:215], a[244:247], v[236:239]
    ds_read_b128 a[232:235], v242 offset:34048
    ds_read_b128 a[236:239], v243 offset:34048
    v_mfma_f32_16x16x32_bf16 v[228:231], a[144:147], a[216:219], 0
    v_exp_f32 v211, v211
    v_mfma_f32_16x16x32_bf16 v[228:231], a[148:151], a[220:223], v[228:231]
    v_cvt_pk_bf16_f32 v189, v210, v211
    v_sub_f32 v197, v197, v248
    v_mfma_f32_16x16x32_bf16 v[232:235], a[168:171], a[216:219], 0
    v_mul_f32 v236, s38, v236
    v_mul_f32 v237, s38, v237
    v_mfma_f32_16x16x32_bf16 v[232:235], a[172:175], a[220:223], v[232:235]
    s_waitcnt lgkmcnt(3)
    v_mul_f32 v238, s38, v238
    v_mul_f32 v239, s38, v239
    v_mfma_f32_16x16x32_bf16 v[228:231], a[152:155], a[224:227], v[228:231]
    s_waitcnt lgkmcnt(2)
    v_cvt_pk_bf16_f32 v178, v236, v237
    v_cvt_pk_bf16_f32 v179, v238, v239
    v_mfma_f32_16x16x32_bf16 v[228:231], a[156:159], a[228:231], v[228:231]
    v_exp_f32 v196, v196
    v_mfma_f32_16x16x32_bf16 v[232:235], a[176:179], a[224:227], v[232:235]
    v_exp_f32 v197, v197
    v_mfma_f32_16x16x32_bf16 v[232:235], a[180:183], a[228:231], v[232:235]
    v_sub_f32 v198, v198, v248
    v_sub_f32 v199, v199, v248
    v_mfma_f32_16x16x32_bf16 v[236:239], a[192:195], a[216:219], 0
    s_waitcnt lgkmcnt(1)
    s_waitcnt vmcnt(8) lgkmcnt(0)
    s_barrier
    v_mfma_f32_16x16x32_bf16 v[228:231], a[160:163], a[232:235], v[228:231]
    ds_read_b128 a[240:243], v240 offset:33792
    ds_read_b128 a[244:247], v241 offset:33792
    v_mfma_f32_16x16x32_bf16 v[228:231], a[164:167], a[236:239], v[228:231]
    ds_read_b128 a[216:219], v240 offset:33920
    v_cvt_pk_bf16_f32 v187, v196, v197
    v_mfma_f32_16x16x32_bf16 v[232:235], a[184:187], a[232:235], v[232:235]
    v_exp_f32 v198, v198
    v_mfma_f32_16x16x32_bf16 v[212:215], v[22:25], v[184:187], v[212:215]
    v_exp_f32 v199, v199
    v_mfma_f32_16x16x32_bf16 v[216:219], v[52:55], v[184:187], v[216:219]
    v_cvt_pk_bf16_f32 v190, v198, v199
    v_mul_f32 v228, s38, v228
    v_mfma_f32_16x16x32_bf16 v[220:223], v[82:85], v[184:187], v[220:223]
    v_mul_f32 v229, s38, v229
    v_mul_f32 v230, s38, v230
    v_mfma_f32_16x16x32_bf16 v[224:227], a[248:251], v[184:187], v[224:227]
    v_mul_f32 v231, s38, v231
    v_cvt_pk_bf16_f32 v228, v228, v229
    v_mfma_f32_16x16x32_bf16 v[232:235], a[188:191], a[236:239], v[232:235]
    v_cvt_pk_bf16_f32 v229, v230, v231
    v_sub_f32 v200, v200, v248
    v_mfma_f32_16x16x32_bf16 v[236:239], a[196:199], a[220:223], v[236:239]
    ds_write_b64 v247, v[228:229] offset:18432
    v_mfma_f32_16x16x32_bf16 v[236:239], a[200:203], a[224:227], v[236:239]
    ds_read_b128 a[220:223], v241 offset:33920
    ds_read_b128 a[224:227], v240 offset:34048
    v_mfma_f32_16x16x32_bf16 v[236:239], a[204:207], a[228:231], v[236:239]
    s_waitcnt lgkmcnt(5)
    v_mul_f32 v232, s3, v232
    v_mul_f32 v233, s3, v233
    v_mfma_f32_16x16x32_bf16 v[236:239], a[208:211], a[232:235], v[236:239]
    v_mul_f32 v234, s3, v234
    v_mul_f32 v235, s3, v235
    v_mfma_f32_16x16x32_bf16 v[236:239], a[212:215], a[236:239], v[236:239]
    ds_read_b128 a[228:231], v241 offset:34048
    v_cvt_pk_bf16_f32 v232, v232, v233
    v_mfma_f32_16x16x32_bf16 v[228:231], a[0:3], a[240:243], 0
    s_waitcnt lgkmcnt(5)
    v_cvt_pk_bf16_f32 v233, v234, v235
    v_sub_f32 v201, v201, v248
    v_mfma_f32_16x16x32_bf16 v[228:231], a[4:7], a[244:247], v[228:231]
    s_waitcnt lgkmcnt(4)
    v_mul_f32 v236, s38, v236
    v_mul_f32 v237, s38, v237
    v_mfma_f32_16x16x32_bf16 v[228:231], a[8:11], a[216:219], v[228:231]
    ds_write_b64 v247, v[232:233] offset:18560
    v_mfma_f32_16x16x32_bf16 v[232:235], a[24:27], a[240:243], 0
    v_mul_f32 v238, s38, v238
    v_mul_f32 v239, s38, v239
    v_mfma_f32_16x16x32_bf16 v[232:235], a[28:31], a[244:247], v[232:235]
    ds_read_b128 a[232:235], v242 offset:61440
    v_cvt_pk_bf16_f32 v236, v236, v237
    v_mfma_f32_16x16x32_bf16 v[232:235], a[32:35], a[216:219], v[232:235]
    s_waitcnt lgkmcnt(4)
    v_cvt_pk_bf16_f32 v237, v238, v239
    v_sub_f32 v202, v202, v248
    v_mfma_f32_16x16x32_bf16 v[228:231], a[12:15], a[220:223], v[228:231]
    ds_write_b64 v247, v[236:237] offset:18688
    v_mfma_f32_16x16x32_bf16 v[232:235], a[36:39], a[220:223], v[232:235]
    ds_read_b128 a[236:239], v243 offset:61440
    v_sub_f32 v203, v203, v248
    v_mfma_f32_16x16x32_bf16 v[236:239], a[48:51], a[240:243], 0
    s_waitcnt lgkmcnt(5)
    v_exp_f32 v200, v200
    v_mfma_f32_16x16x32_bf16 v[228:231], a[16:19], a[224:227], v[228:231]
    s_waitcnt lgkmcnt(4)
    v_exp_f32 v201, v201
    v_mfma_f32_16x16x32_bf16 v[228:231], a[20:23], a[228:231], v[228:231]
    v_exp_f32 v202, v202
    v_mfma_f32_16x16x32_bf16 v[232:235], a[40:43], a[224:227], v[232:235]
    v_exp_f32 v203, v203
    v_mfma_f32_16x16x32_bf16 v[232:235], a[44:47], a[228:231], v[232:235]
    v_cvt_pk_bf16_f32 v188, v200, v201
    v_cvt_pk_bf16_f32 v191, v202, v203
    v_mfma_f32_16x16x32_bf16 v[236:239], a[52:55], a[244:247], v[236:239]
    v_mov_b32 v204, 0x237c0
    v_cvt_pk_bf16_f32 v162, v228, v229
    v_mfma_f32_16x16x32_bf16 v[212:215], v[26:29], v[188:191], v[212:215]
    v_cvt_pk_bf16_f32 v163, v230, v231
    v_add_u32 v205, 0xfffff900, v245
    v_mfma_f32_16x16x32_bf16 v[216:219], v[56:59], v[188:191], v[216:219]
    v_cvt_pk_bf16_f32 v164, v232, v233
    v_cvt_pk_bf16_f32 v165, v234, v235
    v_mfma_f32_16x16x32_bf16 v[220:223], v[86:89], v[188:191], v[220:223]
    v_add_u32 v246, 0x700, v245
    v_mfma_f32_16x16x32_bf16 v[224:227], a[248:251], v[188:191], v[224:227]
    v_mov_b32 v191, 0
    v_mfma_f32_16x16x32_bf16 v[236:239], a[56:59], a[216:219], v[236:239]
    v_mfma_f32_16x16x32_bf16 v[236:239], a[60:63], a[220:223], v[236:239]
    v_mfma_f32_16x16x32_bf16 v[236:239], a[64:67], a[224:227], v[236:239]
    v_mfma_f32_16x16x32_bf16 v[236:239], a[68:71], a[228:231], v[236:239]
    v_mfma_f32_16x16x32_bf16 v[228:231], a[240:243], a[72:75], 0
    v_mfma_f32_16x16x32_bf16 v[228:231], a[244:247], a[76:79], v[228:231]
    v_mfma_f32_16x16x32_bf16 v[228:231], a[216:219], a[80:83], v[228:231]
    v_rcp_f32 v225, v224
    v_mfma_f32_16x16x32_bf16 v[228:231], a[220:223], a[84:87], v[228:231]
    v_mov_b32 v226, 0x22e00
    v_cndmask_b32 v226, v226, v247, vcc
    v_mfma_f32_16x16x32_bf16 v[228:231], a[224:227], a[88:91], v[228:231]
    s_mov_b32 vcc_lo, 0x0
    v_cvt_pk_bf16_f32 v166, v236, v237
    v_cvt_pk_bf16_f32 v167, v238, v239
    v_mfma_f32_16x16x32_bf16 v[228:231], a[228:231], a[92:95], v[228:231]
    s_mov_b32 vcc_hi, 0xf0000
    v_mul_f32 v212, v212, v225
    v_mul_f32 v213, v213, v225
    v_mfma_f32_16x16x32_bf16 v[232:235], a[240:243], a[96:99], 0
    v_mul_f32 v214, v214, v225
    v_mul_f32 v215, v215, v225
    v_mfma_f32_16x16x32_bf16 v[232:235], a[244:247], a[100:103], v[232:235]
    v_cvt_pk_bf16_f32 v212, v212, v213
    v_cvt_pk_bf16_f32 v12, v228, v229
    v_mfma_f32_16x16x32_bf16 v[232:235], a[216:219], a[104:107], v[232:235]
    v_cvt_pk_bf16_f32 v15, v230, v231
    v_cvt_pk_bf16_f32 v213, v214, v215
    v_mfma_f32_16x16x32_bf16 v[232:235], a[220:223], a[108:111], v[232:235]
    ds_write_b64 v226, v[212:213] offset:0
    v_mfma_f32_16x16x32_bf16 v[232:235], a[224:227], a[112:115], v[232:235]
    s_waitcnt lgkmcnt(1)
    v_mul_f32 v216, v216, v225
    v_mul_f32 v217, v217, v225
    v_mfma_f32_16x16x32_bf16 v[232:235], a[228:231], a[116:119], v[232:235]
    v_mul_f32 v218, v218, v225
    v_mul_f32 v219, v219, v225
    v_mfma_f32_16x16x32_bf16 v[236:239], a[240:243], a[120:123], 0
    ds_read_b128 a[240:243], v242 offset:61568
    v_cvt_pk_bf16_f32 v216, v216, v217
    v_mfma_f32_16x16x32_bf16 v[236:239], a[244:247], a[124:127], v[236:239]
    ds_read_b128 a[244:247], v243 offset:61568
    v_cvt_pk_bf16_f32 v217, v218, v219
    v_mfma_f32_16x16x32_bf16 v[236:239], a[216:219], a[128:131], v[236:239]
    v_cvt_pk_bf16_f32 v42, v232, v233
    v_cvt_pk_bf16_f32 v45, v234, v235
    v_mfma_f32_16x16x32_bf16 v[236:239], a[220:223], a[132:135], v[236:239]
    ds_read_b128 a[216:219], v242 offset:61696
    ds_read_b128 a[220:223], v243 offset:61696
    v_mfma_f32_16x16x32_bf16 v[236:239], a[224:227], a[136:139], v[236:239]
    ds_read_b128 a[224:227], v242 offset:62976
    v_mul_f32 v220, v220, v225
    v_mfma_f32_16x16x32_bf16 v[236:239], a[228:231], a[140:143], v[236:239]
    ds_read_b128 a[228:231], v243 offset:62976
    v_mul_f32 v221, v221, v225
    v_mfma_f32_16x16x32_bf16 v[228:231], a[144:147], a[232:235], 0
    ds_write_b64 v226, v[216:217] offset:128
    v_mfma_f32_16x16x32_bf16 v[228:231], a[148:151], a[236:239], v[228:231]
    v_mul_f32 v222, v222, v225
    v_mul_f32 v223, v223, v225
    v_mfma_f32_16x16x32_bf16 v[232:235], a[168:171], a[232:235], 0
    s_waitcnt lgkmcnt(6)
    v_cvt_pk_bf16_f32 v72, v236, v237
    v_cvt_pk_bf16_f32 v75, v238, v239
    v_mfma_f32_16x16x32_bf16 v[228:231], a[152:155], a[240:243], v[228:231]
    s_waitcnt lgkmcnt(5)
    v_cvt_pk_bf16_f32 v220, v220, v221
    v_cvt_pk_bf16_f32 v221, v222, v223
    v_mfma_f32_16x16x32_bf16 v[228:231], a[156:159], a[244:247], v[228:231]
    ds_write_b64 v226, v[220:221] offset:256
    v_mfma_f32_16x16x32_bf16 v[232:235], a[172:175], a[236:239], v[232:235]
    s_waitcnt lgkmcnt(5)
    v_cndmask_b32 v244, v205, v244, vcc
    v_cndmask_b32 v245, v245, v204, vcc
    v_mfma_f32_16x16x32_bf16 v[228:231], a[160:163], a[216:219], v[228:231]
    ds_read_b128 v[208:211], v245 offset:192
    s_waitcnt vmcnt(0) lgkmcnt(5)
    v_mfma_f32_16x16x32_bf16 v[228:231], a[164:167], a[220:223], v[228:231]
    s_barrier
    s_mov_b32 vcc_lo, 0xff00fff0
    s_mov_b32 vcc_hi, 0xf000
    v_mfma_f32_16x16x32_bf16 v[232:235], a[176:179], a[240:243], v[232:235]
    v_cndmask_b32 v244, v244, v204, vcc
    s_mov_b32 vcc_lo, 0xfff00ff
    v_mfma_f32_16x16x32_bf16 v[232:235], a[180:183], a[244:247], v[232:235]
    ds_read_b128 v[200:203], v244 offset:256
    v_mul_f32 v228, s38, v228
    v_mfma_f32_16x16x32_bf16 v[232:235], a[184:187], a[216:219], v[232:235]
    s_mov_b32 vcc_hi, 0xffffffff
    v_mul_f32 v229, s38, v229
    v_mul_f32 v230, s38, v230
    v_mfma_f32_16x16x32_bf16 v[232:235], a[188:191], a[220:223], v[232:235]
    v_mul_f32 v231, s38, v231
    v_cvt_pk_bf16_f32 v228, v228, v229
    v_mfma_f32_16x16x32_bf16 v[236:239], a[192:195], a[232:235], 0
    ds_read_b128 a[232:235], v242 offset:63104
    v_cvt_pk_bf16_f32 v229, v230, v231
    v_mfma_f32_16x16x32_bf16 v[236:239], a[196:199], a[236:239], v[236:239]
    ds_write_b64 v247, v[228:229] offset:24576
    v_mfma_f32_16x16x32_bf16 v[236:239], a[200:203], a[240:243], v[236:239]
    s_waitcnt lgkmcnt(3)
    v_mul_f32 v232, s3, v232
    v_mul_f32 v233, s3, v233
    v_mfma_f32_16x16x32_bf16 v[208:211], v[138:141], v[168:171], v[208:211]
    v_mul_f32 v234, s3, v234
    v_mul_f32 v235, s3, v235
    v_mfma_f32_16x16x32_bf16 v[208:211], v[140:143], v[170:173], v[208:211]
    ds_read_b128 a[236:239], v243 offset:63104
    v_cvt_pk_bf16_f32 v232, v232, v233
    v_mfma_f32_16x16x32_bf16 v[236:239], a[204:207], a[244:247], v[236:239]
    ds_read_b128 a[240:243], v242 offset:63232
    v_cvt_pk_bf16_f32 v233, v234, v235
    v_mfma_f32_16x16x32_bf16 v[236:239], a[208:211], a[216:219], v[236:239]
    ds_write_b64 v247, v[232:233] offset:24704
    v_mfma_f32_16x16x32_bf16 v[236:239], a[212:215], a[220:223], v[236:239]
    ds_read_b128 a[244:247], v243 offset:63232
    ds_read_b128 a[216:219], v240 offset:35328
    v_mfma_f32_16x16x32_bf16 v[228:231], a[144:147], a[224:227], 0
    ds_read_b128 a[220:223], v241 offset:35328
    v_cndmask_b32 v246, v246, v204, vcc
    v_mfma_f32_16x16x32_bf16 v[228:231], a[148:151], a[228:231], v[228:231]
    ds_read_b128 v[204:207], v244 offset:192
    ds_read_b128 v[196:199], v246 offset:192
    v_mfma_f32_16x16x32_bf16 v[232:235], a[168:171], a[224:227], 0
    s_mov_b32 vcc_lo, 0xff00ff00
    v_mul_f32 v236, s38, v236
    v_mul_f32 v237, s38, v237
    v_mfma_f32_16x16x32_bf16 v[232:235], a[172:175], a[228:231], v[232:235]
    s_waitcnt lgkmcnt(9)
    v_mul_f32 v238, s38, v238
    v_mul_f32 v239, s38, v239
    v_mfma_f32_16x16x32_bf16 v[200:203], v[120:123], v[168:171], v[200:203]
    s_mov_b32 vcc_hi, 0xff00ff00
    v_cvt_pk_bf16_f32 v236, v236, v237
    v_cvt_pk_bf16_f32 v237, v238, v239
    v_mfma_f32_16x16x32_bf16 v[200:203], v[122:125], v[170:173], v[200:203]
    ds_write_b64 v247, v[236:237] offset:24832
    v_mfma_f32_16x16x32_bf16 v[228:231], a[152:155], a[232:235], v[228:231]
    s_waitcnt lgkmcnt(8)
    v_mfma_f32_16x16x32_bf16 v[228:231], a[156:159], a[236:239], v[228:231]
    s_waitcnt lgkmcnt(7)
    v_mfma_f32_16x16x32_bf16 v[228:231], a[160:163], a[240:243], v[228:231]
    s_waitcnt lgkmcnt(5)
    v_mfma_f32_16x16x32_bf16 v[228:231], a[164:167], a[244:247], v[228:231]
    v_mfma_f32_16x16x32_bf16 v[232:235], a[176:179], a[232:235], v[232:235]
    s_waitcnt lgkmcnt(2)
    v_mfma_f32_16x16x32_bf16 v[204:207], v[114:117], v[168:171], v[204:207]
    s_waitcnt lgkmcnt(1)
    v_mfma_f32_16x16x32_bf16 v[204:207], v[116:119], v[170:173], v[204:207]
    v_mfma_f32_16x16x32_bf16 v[196:199], v[102:105], v[168:171], v[196:199]
    v_mfma_f32_16x16x32_bf16 v[196:199], v[104:107], v[170:173], v[196:199]
    v_mfma_f32_16x16x32_bf16 v[232:235], a[180:183], a[236:239], v[232:235]
    v_mul_f32 v228, s38, v228
    v_mul_f32 v229, s38, v229
    v_mfma_f32_16x16x32_bf16 v[232:235], a[184:187], a[240:243], v[232:235]
    v_mul_f32 v230, s38, v230
    v_mul_f32 v231, s38, v231
    v_mfma_f32_16x16x32_bf16 v[232:235], a[188:191], a[244:247], v[232:235]
    v_cvt_pk_bf16_f32 v228, v228, v229
    v_cvt_pk_bf16_f32 v229, v230, v231
    v_mfma_f32_16x16x32_bf16 v[236:239], a[192:195], a[224:227], 0
    ds_write_b64 v247, v[228:229] offset:30720
    v_mfma_f32_16x16x32_bf16 v[236:239], a[196:199], a[228:231], v[236:239]
    ds_read_b128 a[224:227], v240 offset:35456
    ds_read_b128 a[228:231], v241 offset:35456
    v_mfma_f32_16x16x32_bf16 v[236:239], a[200:203], a[232:235], v[236:239]
    v_mul_f32 v232, s3, v232
    v_mul_f32 v233, s3, v233
    v_mfma_f32_16x16x32_bf16 v[236:239], a[204:207], a[236:239], v[236:239]
    v_mul_f32 v234, s3, v234
    v_mul_f32 v235, s3, v235
    v_mfma_f32_16x16x32_bf16 v[236:239], a[208:211], a[240:243], v[236:239]
    ds_read_b128 a[232:235], v240 offset:35584
    v_cvt_pk_bf16_f32 v232, v232, v233
    v_mfma_f32_16x16x32_bf16 v[236:239], a[212:215], a[244:247], v[236:239]
    ds_read_b128 a[236:239], v241 offset:35584
    v_cvt_pk_bf16_f32 v233, v234, v235
    v_mfma_f32_16x16x32_bf16 v[228:231], a[0:3], a[216:219], 0
    ds_write_b64 v247, v[232:233] offset:30848
    v_mfma_f32_16x16x32_bf16 v[228:231], a[4:7], a[220:223], v[228:231]
    ds_read_b128 a[240:243], v242 offset:64512
    ds_read_b128 a[244:247], v243 offset:64512
    v_mfma_f32_16x16x32_bf16 v[232:235], a[24:27], a[216:219], 0
    v_mul_f32 v236, s38, v236
    v_mul_f32 v237, s38, v237
    v_mfma_f32_16x16x32_bf16 v[232:235], a[28:31], a[220:223], v[232:235]
    s_waitcnt lgkmcnt(6)
    v_mul_f32 v238, s38, v238
    v_mul_f32 v239, s38, v239
    v_mfma_f32_16x16x32_bf16 v[228:231], a[8:11], a[224:227], v[228:231]
    s_waitcnt lgkmcnt(5)
    v_cvt_pk_bf16_f32 v236, v236, v237
    v_cvt_pk_bf16_f32 v237, v238, v239
    v_mfma_f32_16x16x32_bf16 v[228:231], a[12:15], a[228:231], v[228:231]
    ds_write_b64 v247, v[236:237] offset:30976
    v_mfma_f32_16x16x32_bf16 v[232:235], a[32:35], a[224:227], v[232:235]
    s_waitcnt lgkmcnt(5)
    v_max_f32 v248, v204, v205
    v_max3_f32 v248, v248, v206, v207
    v_mfma_f32_16x16x32_bf16 v[228:231], a[16:19], a[232:235], v[228:231]
    ds_read_b128 v[204:207], v245 offset:256
    v_max3_f32 v248, v248, v208, v209
    v_mfma_f32_16x16x32_bf16 v[232:235], a[36:39], a[228:231], v[232:235]
    s_waitcnt lgkmcnt(5)
    v_max3_f32 v248, v248, v210, v211
    v_max3_f32 v248, v248, v196, v197
    v_mfma_f32_16x16x32_bf16 v[228:231], a[20:23], a[236:239], v[228:231]
    ds_read_b128 v[208:211], v246 offset:256
    v_max3_f32 v248, v248, v198, v199
    v_mfma_f32_16x16x32_bf16 v[232:235], a[40:43], a[232:235], v[232:235]
    ds_read_b128 v[196:199], v244 offset:320
    v_max3_f32 v248, v248, v200, v201
    v_mfma_f32_16x16x32_bf16 v[232:235], a[44:47], a[236:239], v[232:235]
    v_max3_f32 v248, v248, v202, v203
    v_mfma_f32_16x16x32_bf16 v[236:239], a[48:51], a[216:219], 0
    ds_read_b128 v[200:203], v245 offset:320
    v_mfma_f32_16x16x32_bf16 v[236:239], a[52:55], a[220:223], v[236:239]
    v_mfma_f32_16x16x32_bf16 v[236:239], a[56:59], a[224:227], v[236:239]
    v_mfma_f32_16x16x32_bf16 v[236:239], a[60:63], a[228:231], v[236:239]
    v_mfma_f32_16x16x32_bf16 v[236:239], a[64:67], a[232:235], v[236:239]
    s_waitcnt lgkmcnt(3)
    v_mfma_f32_16x16x32_bf16 v[204:207], v[144:147], v[168:171], v[204:207]
    v_mfma_f32_16x16x32_bf16 v[204:207], v[146:149], v[170:173], v[204:207]
    s_waitcnt lgkmcnt(2)
    s_waitcnt lgkmcnt(1)
    v_mfma_f32_16x16x32_bf16 v[208:211], v[108:111], v[168:171], v[208:211]
    v_mfma_f32_16x16x32_bf16 v[208:211], v[110:113], v[170:173], v[208:211]
    v_mfma_f32_16x16x32_bf16 v[196:199], v[126:129], v[168:171], v[196:199]
    s_waitcnt lgkmcnt(0)
    v_mfma_f32_16x16x32_bf16 v[196:199], v[128:131], v[170:173], v[196:199]
    v_mfma_f32_16x16x32_bf16 v[200:203], v[150:153], v[168:171], v[200:203]
    v_max3_f32 v248, v248, v204, v205
    v_max3_f32 v248, v248, v206, v207
    v_mfma_f32_16x16x32_bf16 v[200:203], v[152:155], v[170:173], v[200:203]
    ds_read_b128 v[204:207], v246 offset:320
    v_max3_f32 v248, v248, v208, v209
    v_mfma_f32_16x16x32_bf16 v[236:239], a[68:71], a[236:239], v[236:239]
    v_max3_f32 v248, v248, v210, v211
    ds_read_b128 v[208:211], v244 offset:192
    v_max3_f32 v248, v248, v196, v197
    ds_read_b128 v[196:199], v245 offset:192
    s_nop 0
    v_max3_f32 v248, v248, v200, v201
    ds_read_b128 v[200:203], v246 offset:192
    s_waitcnt lgkmcnt(3)
    v_mfma_f32_16x16x32_bf16 v[204:207], v[162:165], v[168:171], v[204:207]
    v_mfma_f32_16x16x32_bf16 v[204:207], v[164:167], v[170:173], v[204:207]
    s_nop 7
    s_waitcnt lgkmcnt(1)
    v_mfma_f32_16x16x32_bf16 v[208:211], v[114:117], v[168:171], v[208:211]
    s_waitcnt lgkmcnt(0)
    v_cvt_pk_bf16_f32 v114, v228, v229
    v_cvt_pk_bf16_f32 v115, v230, v231
    v_mfma_f32_16x16x32_bf16 v[208:211], v[116:119], v[170:173], v[208:211]
    v_cvt_pk_bf16_f32 v116, v232, v233
    v_cvt_pk_bf16_f32 v117, v234, v235
    v_mfma_f32_16x16x32_bf16 v[196:199], v[138:141], v[168:171], v[196:199]
    v_cvt_pk_bf16_f32 v118, v236, v237
    v_cvt_pk_bf16_f32 v119, v238, v239
    v_mfma_f32_16x16x32_bf16 v[196:199], v[140:143], v[170:173], v[196:199]
    v_max3_f32 v248, v248, v204, v205
    v_mov_b32 v225, v248
    v_mfma_f32_16x16x32_bf16 v[200:203], v[102:105], v[168:171], v[200:203]
    ds_read_b128 v[204:207], v244 offset:256
    v_permlane16_swap_b32 v248, v225
    v_mfma_f32_16x16x32_bf16 v[200:203], v[104:107], v[170:173], v[200:203]
    v_max_f32 v248, v248, v225
    v_mov_b32 v225, v248
    v_mfma_f32_16x16x32_bf16 v[228:231], a[216:219], a[72:75], 0
    v_mfma_f32_16x16x32_bf16 v[228:231], a[220:223], a[76:79], v[228:231]
    v_permlane32_swap_b32 v248, v225
    v_max_f32 v248, v248, v225
    v_mfma_f32_16x16x32_bf16 v[228:231], a[224:227], a[80:83], v[228:231]
    v_sub_f32 v208, v208, v248
    v_sub_f32 v209, v209, v248
    v_mfma_f32_16x16x32_bf16 v[228:231], a[228:231], a[84:87], v[228:231]
    v_exp_f32 v208, v208
    v_mfma_f32_16x16x32_bf16 v[228:231], a[232:235], a[88:91], v[228:231]
    v_exp_f32 v209, v209
    v_mfma_f32_16x16x32_bf16 v[228:231], a[236:239], a[92:95], v[228:231]
    v_sub_f32 v210, v210, v248
    v_sub_f32 v211, v211, v248
    v_mfma_f32_16x16x32_bf16 v[232:235], a[216:219], a[96:99], 0
    v_exp_f32 v210, v210
    v_mfma_f32_16x16x32_bf16 v[232:235], a[220:223], a[100:103], v[232:235]
    s_waitcnt lgkmcnt(0)
    v_exp_f32 v211, v211
    v_mfma_f32_16x16x32_bf16 v[204:207], v[120:123], v[168:171], v[204:207]
    v_cvt_pk_bf16_f32 v18, v228, v229
    v_cvt_pk_bf16_f32 v21, v230, v231
    v_mfma_f32_16x16x32_bf16 v[204:207], v[122:125], v[170:173], v[204:207]
    v_cvt_pk_bf16_f32 v193, v208, v209
    v_cvt_pk_bf16_f32 v180, v210, v211
    v_mfma_f32_16x16x32_bf16 v[232:235], a[224:227], a[104:107], v[232:235]
    ds_read_b128 v[208:211], v245 offset:256
    v_sub_f32 v196, v196, v248
    v_mfma_f32_16x16x32_bf16 v[232:235], a[228:231], a[108:111], v[232:235]
    v_exp_f32 v196, v196
    v_mfma_f32_16x16x32_bf16 v[232:235], a[232:235], a[112:115], v[232:235]
    v_sub_f32 v197, v197, v248
    v_sub_f32 v198, v198, v248
    v_mfma_f32_16x16x32_bf16 v[232:235], a[236:239], a[116:119], v[232:235]
    v_exp_f32 v197, v197
    v_mfma_f32_16x16x32_bf16 v[236:239], a[216:219], a[120:123], 0
    ds_read_b128 a[216:219], v242 offset:64640
    v_sub_f32 v199, v199, v248
    v_mfma_f32_16x16x32_bf16 v[236:239], a[220:223], a[124:127], v[236:239]
    ds_read_b128 a[220:223], v243 offset:64640
    v_cvt_pk_bf16_f32 v194, v196, v197
    v_mfma_f32_16x16x32_bf16 v[236:239], a[224:227], a[128:131], v[236:239]
    v_cvt_pk_bf16_f32 v48, v232, v233
    v_cvt_pk_bf16_f32 v51, v234, v235
    v_mfma_f32_16x16x32_bf16 v[236:239], a[228:231], a[132:135], v[236:239]
    ds_read_b128 a[224:227], v242 offset:64768
    ds_read_b128 a[228:231], v243 offset:64768
    v_mfma_f32_16x16x32_bf16 v[236:239], a[232:235], a[136:139], v[236:239]
    v_add_u32 v242, 0xf000, v242
    v_add_u32 v243, 0xf000, v243
    v_mfma_f32_16x16x32_bf16 v[236:239], a[236:239], a[140:143], v[236:239]
    ds_read_b128 a[232:235], v242 offset:4608
    ds_read_b128 a[236:239], v243 offset:4608
    v_mfma_f32_16x16x32_bf16 v[228:231], a[144:147], a[240:243], 0
    s_waitcnt lgkmcnt(6)
    v_exp_f32 v198, v198
    v_mfma_f32_16x16x32_bf16 v[208:211], v[144:147], v[168:171], v[208:211]
    v_exp_f32 v199, v199
    v_mfma_f32_16x16x32_bf16 v[208:211], v[146:149], v[170:173], v[208:211]
    v_cvt_pk_bf16_f32 v78, v236, v237
    v_cvt_pk_bf16_f32 v81, v238, v239
    v_mfma_f32_16x16x32_bf16 v[228:231], a[148:151], a[244:247], v[228:231]
    s_waitcnt lgkmcnt(5)
    v_cvt_pk_bf16_f32 v181, v198, v199
    v_sub_f32 v200, v200, v248
    v_mfma_f32_16x16x32_bf16 v[228:231], a[152:155], a[216:219], v[228:231]
    ds_read_b128 v[196:199], v246 offset:256
    v_sub_f32 v201, v201, v248
    v_mfma_f32_16x16x32_bf16 v[232:235], a[168:171], a[240:243], 0
    s_waitcnt lgkmcnt(5)
    v_exp_f32 v200, v200
    v_mfma_f32_16x16x32_bf16 v[228:231], a[156:159], a[220:223], v[228:231]
    s_waitcnt lgkmcnt(4)
    v_exp_f32 v201, v201
    v_mfma_f32_16x16x32_bf16 v[228:231], a[160:163], a[224:227], v[228:231]
    s_waitcnt lgkmcnt(3)
    v_sub_f32 v202, v202, v248
    v_sub_f32 v203, v203, v248
    v_mfma_f32_16x16x32_bf16 v[228:231], a[164:167], a[228:231], v[228:231]
    v_exp_f32 v202, v202
    v_mfma_f32_16x16x32_bf16 v[232:235], a[172:175], a[244:247], v[232:235]
    v_exp_f32 v203, v203
    v_mfma_f32_16x16x32_bf16 v[232:235], a[176:179], a[216:219], v[232:235]
    v_cvt_pk_bf16_f32 v192, v200, v201
    v_cvt_pk_bf16_f32 v195, v202, v203
    v_mfma_f32_16x16x32_bf16 v[232:235], a[180:183], a[220:223], v[232:235]
    ds_read_b128 v[200:203], v244 offset:320
    v_mul_f32 v228, s38, v228
    v_mfma_f32_16x16x32_bf16 v[212:215], v[0:3], v[192:195], 0
    v_mul_f32 v229, s38, v229
    v_mul_f32 v230, s38, v230
    v_mfma_f32_16x16x32_bf16 v[216:219], v[30:33], v[192:195], 0
    s_waitcnt lgkmcnt(1)
    v_mul_f32 v231, s38, v231
    v_cvt_pk_bf16_f32 v228, v228, v229
    v_mfma_f32_16x16x32_bf16 v[220:223], v[60:63], v[192:195], 0
    v_cvt_pk_bf16_f32 v229, v230, v231
    v_sub_f32 v204, v204, v248
    v_mfma_f32_16x16x32_bf16 v[224:227], a[248:251], v[192:195], 0
    ds_write_b64 v247, v[228:229] offset:36864
    v_mfma_f32_16x16x32_bf16 v[196:199], v[108:111], v[168:171], v[196:199]
    v_exp_f32 v204, v204
    v_mfma_f32_16x16x32_bf16 v[196:199], v[110:113], v[170:173], v[196:199]
    v_sub_f32 v205, v205, v248
    v_sub_f32 v206, v206, v248
    v_mfma_f32_16x16x32_bf16 v[232:235], a[184:187], a[224:227], v[232:235]
    v_exp_f32 v205, v205
    v_mfma_f32_16x16x32_bf16 v[232:235], a[188:191], a[228:231], v[232:235]
    s_waitcnt lgkmcnt(1)
    v_exp_f32 v206, v206
    v_mfma_f32_16x16x32_bf16 v[200:203], v[126:129], v[168:171], v[200:203]
    v_sub_f32 v207, v207, v248
    v_cvt_pk_bf16_f32 v183, v204, v205
    v_mfma_f32_16x16x32_bf16 v[200:203], v[128:131], v[170:173], v[200:203]
    v_exp_f32 v207, v207
    v_mfma_f32_16x16x32_bf16 v[236:239], a[192:195], a[240:243], 0
    v_mul_f32 v232, s3, v232
    v_mul_f32 v233, s3, v233
    v_mfma_f32_16x16x32_bf16 v[236:239], a[196:199], a[244:247], v[236:239]
    v_mul_f32 v234, s3, v234
    v_mul_f32 v235, s3, v235
    v_mfma_f32_16x16x32_bf16 v[236:239], a[200:203], a[216:219], v[236:239]
    ds_read_b128 a[240:243], v242 offset:4736
    v_cvt_pk_bf16_f32 v232, v232, v233
    v_mfma_f32_16x16x32_bf16 v[236:239], a[204:207], a[220:223], v[236:239]
    ds_read_b128 a[244:247], v243 offset:4736
    v_cvt_pk_bf16_f32 v233, v234, v235
    v_mfma_f32_16x16x32_bf16 v[236:239], a[208:211], a[224:227], v[236:239]
    ds_write_b64 v247, v[232:233] offset:36992
    v_mfma_f32_16x16x32_bf16 v[236:239], a[212:215], a[228:231], v[236:239]
    ds_read_b128 a[216:219], v242 offset:4864
    ds_read_b128 a[220:223], v243 offset:4864
    v_mfma_f32_16x16x32_bf16 v[228:231], a[144:147], a[232:235], 0
    v_add_u32 v242, 0x7800, v242
    v_add_u32 v243, 0x4200, v243
    v_mfma_f32_16x16x32_bf16 v[228:231], a[148:151], a[236:239], v[228:231]
    v_cndmask_b32 v242, v242, v243, vcc
    v_add_u32 v243, 0xfffe2000, v242
    v_mfma_f32_16x16x32_bf16 v[232:235], a[168:171], a[232:235], 0
    s_mov_b32 vcc_lo, 0xf0f0f0f0
    v_mul_f32 v236, s38, v236
    v_mul_f32 v237, s38, v237
    v_mfma_f32_16x16x32_bf16 v[232:235], a[172:175], a[236:239], v[232:235]
    v_mul_f32 v238, s38, v238
    v_mul_f32 v239, s38, v239
    v_cvt_pk_bf16_f32 v236, v236, v237
    s_waitcnt lgkmcnt(4)
    v_mfma_f32_16x16x32_bf16 v[228:231], a[152:155], a[240:243], v[228:231]
    s_mov_b32 vcc_hi, 0xf0f0f0f0
    v_cvt_pk_bf16_f32 v237, v238, v239
    v_cndmask_b32 v242, v242, v243, vcc
    v_mfma_f32_16x16x32_bf16 v[232:235], a[176:179], a[240:243], v[232:235]
    s_waitcnt lgkmcnt(3)
    ds_read_b128 a[224:227], v242 offset:0
    v_mfma_f32_16x16x32_bf16 v[228:231], a[156:159], a[244:247], v[228:231]
    ds_write_b64 v247, v[236:237] offset:37120
    v_mfma_f32_16x16x32_bf16 v[232:235], a[180:183], a[244:247], v[232:235]
    s_mov_b32 vcc_lo, 0xcccccccc
    v_xor_b32 v243, 64, v242
    v_cvt_pk_bf16_f32 v186, v206, v207
    v_mfma_f32_16x16x32_bf16 v[236:239], a[192:195], a[232:235], 0
    ds_read_b128 a[228:231], v243 offset:0
    ds_read_b128 a[232:235], v242 offset:128
    v_mfma_f32_16x16x32_bf16 v[236:239], a[196:199], a[236:239], v[236:239]
    ds_read_b128 a[236:239], v243 offset:128
    ds_read_b128 v[204:207], v245 offset:320
    v_mfma_f32_16x16x32_bf16 v[236:239], a[200:203], a[240:243], v[236:239]
    ds_read_b128 a[240:243], v242 offset:256
    v_sub_f32 v208, v208, v248
    v_mfma_f32_16x16x32_bf16 v[236:239], a[204:207], a[244:247], v[236:239]
    s_waitcnt lgkmcnt(8)
    ds_read_b128 a[244:247], v243 offset:256
    v_mfma_f32_16x16x32_bf16 v[228:231], a[160:163], a[216:219], v[228:231]
    s_mov_b32 vcc_hi, 0xcccccccc
    v_exp_f32 v208, v208
    v_mfma_f32_16x16x32_bf16 v[232:235], a[184:187], a[216:219], v[232:235]
    s_waitcnt lgkmcnt(8)
    v_sub_f32 v209, v209, v248
    v_sub_f32 v210, v210, v248
    v_mfma_f32_16x16x32_bf16 v[228:231], a[164:167], a[220:223], v[228:231]
    v_exp_f32 v209, v209
    v_mfma_f32_16x16x32_bf16 v[232:235], a[188:191], a[220:223], v[232:235]
    v_exp_f32 v210, v210
    v_mfma_f32_16x16x32_bf16 v[236:239], a[208:211], a[216:219], v[236:239]
    ds_read_b128 a[216:219], v240 offset:36864
    v_sub_f32 v211, v211, v248
    v_mfma_f32_16x16x32_bf16 v[236:239], a[212:215], a[220:223], v[236:239]
    ds_read_b128 a[220:223], v241 offset:36864
    v_mul_f32 v228, s38, v228
    v_mul_f32 v229, s38, v229
    v_mul_f32 v230, s38, v230
    v_mul_f32 v231, s38, v231
    v_cvt_pk_bf16_f32 v228, v228, v229
    v_cvt_pk_bf16_f32 v229, v230, v231
    s_waitcnt lgkmcnt(4)
    v_mfma_f32_16x16x32_bf16 v[204:207], v[150:153], v[168:171], v[204:207]
    ds_write_b64 v247, v[228:229] offset:43008
    v_mfma_f32_16x16x32_bf16 v[204:207], v[152:155], v[170:173], v[204:207]
    v_mul_f32 v232, s3, v232
    v_mul_f32 v233, s3, v233
    v_mfma_f32_16x16x32_bf16 v[228:231], a[144:147], a[224:227], 0
    v_mul_f32 v234, s3, v234
    v_mul_f32 v235, s3, v235
    v_mfma_f32_16x16x32_bf16 v[228:231], a[148:151], a[228:231], v[228:231]
    v_cvt_pk_bf16_f32 v232, v232, v233
    v_cvt_pk_bf16_f32 v233, v234, v235
    v_mfma_f32_16x16x32_bf16 v[228:231], a[152:155], a[232:235], v[228:231]
    ds_write_b64 v247, v[232:233] offset:43136
    v_mfma_f32_16x16x32_bf16 v[228:231], a[156:159], a[236:239], v[228:231]
    s_waitcnt lgkmcnt(5)
    v_mul_f32 v236, s38, v236
    v_mul_f32 v237, s38, v237
    v_mfma_f32_16x16x32_bf16 v[228:231], a[160:163], a[240:243], v[228:231]
    s_waitcnt lgkmcnt(4)
    v_mul_f32 v238, s38, v238
    v_mul_f32 v239, s38, v239
    v_mfma_f32_16x16x32_bf16 v[228:231], a[164:167], a[244:247], v[228:231]
    v_cvt_pk_bf16_f32 v236, v236, v237
    v_cvt_pk_bf16_f32 v237, v238, v239
    v_mfma_f32_16x16x32_bf16 v[232:235], a[168:171], a[224:227], 0
    ds_write_b64 v247, v[236:237] offset:43264
    v_mfma_f32_16x16x32_bf16 v[232:235], a[172:175], a[228:231], v[232:235]
    v_exp_f32 v211, v211
    v_mfma_f32_16x16x32_bf16 v[232:235], a[176:179], a[232:235], v[232:235]
    v_cvt_pk_bf16_f32 v184, v208, v209
    v_mul_f32 v228, s38, v228
    v_mfma_f32_16x16x32_bf16 v[232:235], a[180:183], a[236:239], v[232:235]
    v_mul_f32 v229, s38, v229
    v_mul_f32 v230, s38, v230
    v_mfma_f32_16x16x32_bf16 v[232:235], a[184:187], a[240:243], v[232:235]
    v_mul_f32 v231, s38, v231
    v_cvt_pk_bf16_f32 v228, v228, v229
    v_mfma_f32_16x16x32_bf16 v[232:235], a[188:191], a[244:247], v[232:235]
    v_cvt_pk_bf16_f32 v229, v230, v231
    v_cvt_pk_bf16_f32 v187, v210, v211
    v_mfma_f32_16x16x32_bf16 v[236:239], a[192:195], a[224:227], 0
    ds_write_b64 v247, v[228:229] offset:49152
    v_mfma_f32_16x16x32_bf16 v[236:239], a[196:199], a[228:231], v[236:239]
    ds_read_b128 a[224:227], v240 offset:36992
    ds_read_b128 a[228:231], v241 offset:36992
    v_mfma_f32_16x16x32_bf16 v[236:239], a[200:203], a[232:235], v[236:239]
    s_waitcnt lgkmcnt(5)
    v_mul_f32 v232, s3, v232
    v_mul_f32 v233, s3, v233
    v_mfma_f32_16x16x32_bf16 v[236:239], a[204:207], a[236:239], v[236:239]
    v_mul_f32 v234, s3, v234
    v_mul_f32 v235, s3, v235
    v_mfma_f32_16x16x32_bf16 v[236:239], a[208:211], a[240:243], v[236:239]
    ds_read_b128 a[232:235], v240 offset:37120
    v_cvt_pk_bf16_f32 v232, v232, v233
    v_mfma_f32_16x16x32_bf16 v[236:239], a[212:215], a[244:247], v[236:239]
    ds_read_b128 a[236:239], v241 offset:37120
    v_cvt_pk_bf16_f32 v233, v234, v235
    v_mfma_f32_16x16x32_bf16 v[228:231], a[0:3], a[216:219], 0
    ds_write_b64 v247, v[232:233] offset:49280
    v_mfma_f32_16x16x32_bf16 v[228:231], a[4:7], a[220:223], v[228:231]
    ds_read_b128 a[240:243], v242 offset:3072
    ds_read_b128 a[244:247], v243 offset:3072
    v_mfma_f32_16x16x32_bf16 v[232:235], a[24:27], a[216:219], 0
    v_mul_f32 v236, s38, v236
    v_mul_f32 v237, s38, v237
    v_mfma_f32_16x16x32_bf16 v[232:235], a[28:31], a[220:223], v[232:235]
    s_waitcnt lgkmcnt(6)
    v_mul_f32 v238, s38, v238
    v_mul_f32 v239, s38, v239
    v_mfma_f32_16x16x32_bf16 v[228:231], a[8:11], a[224:227], v[228:231]
    s_waitcnt lgkmcnt(5)
    v_cvt_pk_bf16_f32 v236, v236, v237
    v_cvt_pk_bf16_f32 v237, v238, v239
    v_mfma_f32_16x16x32_bf16 v[228:231], a[12:15], a[228:231], v[228:231]
    ds_write_b64 v247, v[236:237] offset:49408
    v_mfma_f32_16x16x32_bf16 v[232:235], a[32:35], a[224:227], v[232:235]
    s_waitcnt lgkmcnt(5)
    v_add_u32 v240, 0xffff1000, v240
    v_add_u32 v241, 0xffff1000, v241
    v_mfma_f32_16x16x32_bf16 v[228:231], a[16:19], a[232:235], v[228:231]
    ds_read_b128 v[208:211], v246 offset:320
    v_sub_f32 v196, v196, v248
    v_mfma_f32_16x16x32_bf16 v[232:235], a[36:39], a[228:231], v[232:235]
    s_waitcnt lgkmcnt(5)
    v_exp_f32 v196, v196
    v_mfma_f32_16x16x32_bf16 v[228:231], a[20:23], a[236:239], v[228:231]
    v_sub_f32 v197, v197, v248
    v_sub_f32 v198, v198, v248
    v_mfma_f32_16x16x32_bf16 v[232:235], a[40:43], a[232:235], v[232:235]
    v_exp_f32 v197, v197
    v_mfma_f32_16x16x32_bf16 v[232:235], a[44:47], a[236:239], v[232:235]
    v_exp_f32 v198, v198
    v_mfma_f32_16x16x32_bf16 v[236:239], a[48:51], a[216:219], 0
    v_sub_f32 v199, v199, v248
    v_cvt_pk_bf16_f32 v182, v196, v197
    v_mfma_f32_16x16x32_bf16 v[236:239], a[52:55], a[220:223], v[236:239]
    v_exp_f32 v199, v199
    v_mfma_f32_16x16x32_bf16 v[212:215], v[4:7], v[180:183], v[212:215]
    v_cvt_pk_bf16_f32 v185, v198, v199
    v_sub_f32 v200, v200, v248
    v_mfma_f32_16x16x32_bf16 v[216:219], v[34:37], v[180:183], v[216:219]
    ds_read_b128 v[196:199], v244 offset:0
    v_sub_f32 v201, v201, v248
    v_mfma_f32_16x16x32_bf16 v[220:223], v[64:67], v[180:183], v[220:223]
    s_waitcnt lgkmcnt(1)
    v_exp_f32 v200, v200
    v_mfma_f32_16x16x32_bf16 v[224:227], a[248:251], v[180:183], v[224:227]
    v_exp_f32 v201, v201
    v_mfma_f32_16x16x32_bf16 v[212:215], v[8:11], v[184:187], v[212:215]
    v_cvt_pk_bf16_f32 v189, v200, v201
    v_sub_f32 v204, v204, v248
    v_mfma_f32_16x16x32_bf16 v[216:219], v[38:41], v[184:187], v[216:219]
    ds_read_b128 v[200:203], v245 offset:0
    v_sub_f32 v205, v205, v248
    v_mfma_f32_16x16x32_bf16 v[220:223], v[68:71], v[184:187], v[220:223]
    v_exp_f32 v204, v204
    v_mfma_f32_16x16x32_bf16 v[224:227], a[248:251], v[184:187], v[224:227]
    v_exp_f32 v205, v205
    v_mfma_f32_16x16x32_bf16 v[208:211], v[162:165], v[168:171], v[208:211]
    ds_read_b64 v[168:169], v247 offset:18432
    v_cvt_pk_bf16_f32 v190, v204, v205
    v_mfma_f32_16x16x32_bf16 v[208:211], v[164:167], v[170:173], v[208:211]
    ds_read_b128 v[204:207], v246 offset:0
    ds_read_b64 v[170:171], v247 offset:18560
    v_mfma_f32_16x16x32_bf16 v[236:239], a[56:59], a[224:227], v[236:239]
    ds_read_b64 v[172:173], v247 offset:18688
    s_waitcnt lgkmcnt(5)
    v_mfma_f32_16x16x32_bf16 v[196:199], v[120:123], v[174:177], v[196:199]
    v_mfma_f32_16x16x32_bf16 v[196:199], v[122:125], v[176:179], v[196:199]
    v_mfma_f32_16x16x32_bf16 v[236:239], a[60:63], a[228:231], v[236:239]
    v_sub_f32 v208, v208, v248
    v_sub_f32 v209, v209, v248
    v_mfma_f32_16x16x32_bf16 v[236:239], a[64:67], a[232:235], v[236:239]
    s_waitcnt lgkmcnt(4)
    v_exp_f32 v208, v208
    v_mfma_f32_16x16x32_bf16 v[200:203], v[144:147], v[174:177], v[200:203]
    v_exp_f32 v209, v209
    v_mfma_f32_16x16x32_bf16 v[200:203], v[146:149], v[176:179], v[200:203]
    v_cvt_pk_bf16_f32 v188, v208, v209
    v_max_f32 v248, v196, v197
    v_mfma_f32_16x16x32_bf16 v[236:239], a[68:71], a[236:239], v[236:239]
    ds_read_b128 v[208:211], v244 offset:64
    v_max3_f32 v248, v248, v198, v199
    v_mfma_f32_16x16x32_bf16 v[212:215], v[12:15], v[188:191], v[212:215]
    ds_read_b128 v[196:199], v245 offset:64
    s_waitcnt lgkmcnt(4)
    v_mfma_f32_16x16x32_bf16 v[216:219], v[42:45], v[188:191], v[216:219]
    v_max3_f32 v248, v248, v200, v201
    v_max3_f32 v248, v248, v202, v203
    v_mfma_f32_16x16x32_bf16 v[220:223], v[72:75], v[188:191], v[220:223]
    ds_read_b128 v[200:203], v246 offset:64
    v_mfma_f32_16x16x32_bf16 v[224:227], a[248:251], v[188:191], v[224:227]
    v_mfma_f32_16x16x32_bf16 v[204:207], v[108:111], v[174:177], v[204:207]
    v_mfma_f32_16x16x32_bf16 v[204:207], v[110:113], v[176:179], v[204:207]
    s_nop 5
    v_rcp_f32 v225, v224
    s_nop 0
    s_waitcnt lgkmcnt(2)
    v_mfma_f32_16x16x32_bf16 v[208:211], v[126:129], v[174:177], v[208:211]
    v_mul_f32 v212, v212, v225
    v_mul_f32 v213, v213, v225
    v_mfma_f32_16x16x32_bf16 v[208:211], v[128:131], v[176:179], v[208:211]
    s_waitcnt lgkmcnt(1)
    v_mul_f32 v214, v214, v225
    v_mul_f32 v215, v215, v225
    v_mfma_f32_16x16x32_bf16 v[196:199], v[150:153], v[174:177], v[196:199]
    v_cvt_pk_bf16_f32 v212, v212, v213
    v_cvt_pk_bf16_f32 v213, v214, v215
    v_mfma_f32_16x16x32_bf16 v[196:199], v[152:155], v[176:179], v[196:199]
    s_waitcnt lgkmcnt(0)
    v_mul_f32 v216, v216, v225
    v_mul_f32 v217, v217, v225
    v_mfma_f32_16x16x32_bf16 v[200:203], v[162:165], v[174:177], v[200:203]
    ds_write_b64 v247, v[212:213] offset:6144
    v_mfma_f32_16x16x32_bf16 v[200:203], v[164:167], v[176:179], v[200:203]
    v_mul_f32 v218, v218, v225
    v_mul_f32 v219, v219, v225
    v_cvt_pk_bf16_f32 v216, v216, v217
    v_cvt_pk_bf16_f32 v217, v218, v219
    ds_write_b64 v247, v[216:217] offset:6272
    v_mul_f32 v220, v220, v225
    v_mul_f32 v221, v221, v225
    v_mul_f32 v222, v222, v225
    v_mul_f32 v223, v223, v225
    v_cvt_pk_bf16_f32 v220, v220, v221
    v_cvt_pk_bf16_f32 v221, v222, v223
    ds_write_b64 v247, v[220:221] offset:6400
    v_max3_f32 v248, v248, v204, v205
    v_max3_f32 v248, v248, v206, v207
    ds_read_b128 v[204:207], v244 offset:128
    v_max3_f32 v248, v248, v208, v209
    v_max3_f32 v248, v248, v210, v211
    ds_read_b128 v[208:211], v245 offset:128
    v_max3_f32 v248, v248, v196, v197
    v_max3_f32 v248, v248, v198, v199
    ds_read_b128 v[196:199], v246 offset:128
    v_max3_f32 v248, v248, v200, v201
    v_max3_f32 v248, v248, v202, v203
    ds_read_b128 v[200:203], v244 offset:0
    s_waitcnt lgkmcnt(3)
    v_mfma_f32_16x16x32_bf16 v[204:207], v[132:135], v[174:177], v[204:207]
    v_mfma_f32_16x16x32_bf16 v[204:207], v[134:137], v[176:179], v[204:207]
    s_waitcnt lgkmcnt(2)
    v_mfma_f32_16x16x32_bf16 v[208:211], v[156:159], v[174:177], v[208:211]
    s_waitcnt lgkmcnt(1)
    v_mfma_f32_16x16x32_bf16 v[208:211], v[158:161], v[176:179], v[208:211]
    v_mfma_f32_16x16x32_bf16 v[196:199], v[114:117], v[174:177], v[196:199]
    s_waitcnt lgkmcnt(0)
    v_mfma_f32_16x16x32_bf16 v[196:199], v[116:119], v[176:179], v[196:199]
    v_mfma_f32_16x16x32_bf16 v[200:203], v[120:123], v[174:177], v[200:203]
    v_cvt_pk_bf16_f32 v120, v228, v229
    v_cvt_pk_bf16_f32 v121, v230, v231
    v_mfma_f32_16x16x32_bf16 v[200:203], v[122:125], v[176:179], v[200:203]
    v_cvt_pk_bf16_f32 v122, v232, v233
    v_cvt_pk_bf16_f32 v123, v234, v235
    v_mfma_f32_16x16x32_bf16 v[228:231], a[216:219], a[72:75], 0
    v_cvt_pk_bf16_f32 v124, v236, v237
    v_cvt_pk_bf16_f32 v125, v238, v239
    v_mfma_f32_16x16x32_bf16 v[228:231], a[220:223], a[76:79], v[228:231]
    v_max3_f32 v248, v248, v204, v205
    v_max3_f32 v248, v248, v208, v209
    v_mfma_f32_16x16x32_bf16 v[228:231], a[224:227], a[80:83], v[228:231]
    ds_read_b128 v[204:207], v245 offset:0
    ds_read_b128 v[208:211], v246 offset:0
    v_mfma_f32_16x16x32_bf16 v[228:231], a[228:231], a[84:87], v[228:231]
    v_max3_f32 v248, v248, v196, v197
    v_mov_b32 v225, v248
    v_mfma_f32_16x16x32_bf16 v[228:231], a[232:235], a[88:91], v[228:231]
    ds_read_b128 v[196:199], v244 offset:64
    v_permlane16_swap_b32 v248, v225
    v_mfma_f32_16x16x32_bf16 v[228:231], a[236:239], a[92:95], v[228:231]
    v_max_f32 v248, v248, v225
    v_mov_b32 v225, v248
    v_mfma_f32_16x16x32_bf16 v[232:235], a[216:219], a[96:99], 0
    v_mfma_f32_16x16x32_bf16 v[232:235], a[220:223], a[100:103], v[232:235]
    v_permlane32_swap_b32 v248, v225
    v_max_f32 v248, v248, v225
    v_mfma_f32_16x16x32_bf16 v[232:235], a[224:227], a[104:107], v[232:235]
    v_sub_f32 v200, v200, v248
    v_cvt_pk_bf16_f32 v24, v228, v229
    v_mfma_f32_16x16x32_bf16 v[232:235], a[228:231], a[108:111], v[232:235]
    v_cvt_pk_bf16_f32 v27, v230, v231
    v_mbcnt_lo_u32_b32 v228, -1, 0
    v_mfma_f32_16x16x32_bf16 v[232:235], a[232:235], a[112:115], v[232:235]
    v_mbcnt_hi_u32_b32 v228, -1, v228
    v_lshrrev_b32 v229, 1, v228
    v_mfma_f32_16x16x32_bf16 v[232:235], a[236:239], a[116:119], v[232:235]
    s_waitcnt lgkmcnt(2)
    v_add_u32 v229, 64, v229
    v_mul_u32_u24 v230, 43, v229
    v_mfma_f32_16x16x32_bf16 v[204:207], v[144:147], v[174:177], v[204:207]
    s_waitcnt lgkmcnt(1)
    v_lshrrev_b32 v231, 8, v230
    v_lshrrev_b32 v230, 7, v230
    v_mfma_f32_16x16x32_bf16 v[204:207], v[146:149], v[176:179], v[204:207]
    s_waitcnt lgkmcnt(0)
    v_cvt_pk_bf16_f32 v54, v232, v233
    v_cvt_pk_bf16_f32 v57, v234, v235
    v_mfma_f32_16x16x32_bf16 v[208:211], v[108:111], v[174:177], v[208:211]
    v_mad_i32_i24 v229, v230, -3, v229
    v_and_b32 v231, 4, v231
    v_mfma_f32_16x16x32_bf16 v[208:211], v[110:113], v[176:179], v[208:211]
    v_xor_b32 v230, v230, v231
    v_and_b32 v231, 4, v230
    v_mfma_f32_16x16x32_bf16 v[196:199], v[126:129], v[174:177], v[196:199]
    v_mul_u32_u24 v251, 24, v231
    v_lshrrev_b32 v231, 3, v230
    v_mfma_f32_16x16x32_bf16 v[196:199], v[128:131], v[176:179], v[196:199]
    v_lshl_add_u32 v251, v231, 2, v251
    v_and_or_b32 v251, v230, 3, v251
    v_mfma_f32_16x16x32_bf16 v[236:239], a[216:219], a[120:123], 0
    ds_read_b128 a[216:219], v242 offset:3200
    v_mad_u32_u24 v251, v251, 3, v229
    v_mfma_f32_16x16x32_bf16 v[236:239], a[220:223], a[124:127], v[236:239]
    ds_read_b128 a[220:223], v243 offset:3200
    v_and_b32 v231, 1, v228
    v_mfma_f32_16x16x32_bf16 v[236:239], a[224:227], a[128:131], v[236:239]
    ds_read_b128 a[224:227], v242 offset:3328
    v_lshl_add_u32 v251, v251, 3, v231
    v_mfma_f32_16x16x32_bf16 v[236:239], a[228:231], a[132:135], v[236:239]
    ds_read_b128 a[228:231], v243 offset:3328
    v_lshlrev_b32 v251, 4, v251
    v_mfma_f32_16x16x32_bf16 v[236:239], a[232:235], a[136:139], v[236:239]
    ds_read_b128 a[232:235], v240 offset:0
    v_add_u32 v251, 0xfffff800, v251
    v_mfma_f32_16x16x32_bf16 v[236:239], a[236:239], a[140:143], v[236:239]
    ds_read_b128 a[236:239], v241 offset:0
    v_sub_f32 v201, v201, v248
    v_mfma_f32_16x16x32_bf16 v[232:235], a[144:147], a[240:243], 0
    v_exp_f32 v200, v200
    v_mfma_f32_16x16x32_bf16 v[232:235], a[148:151], a[244:247], v[232:235]
    v_exp_f32 v201, v201
    v_mfma_f32_16x16x32_bf16 v[228:231], a[192:195], a[240:243], 0
    v_sub_f32 v202, v202, v248
    v_cvt_pk_bf16_f32 v84, v236, v237
    v_mfma_f32_16x16x32_bf16 v[228:231], a[196:199], a[244:247], v[228:231]
    s_waitcnt lgkmcnt(5)
    v_cvt_pk_bf16_f32 v87, v238, v239
    v_sub_f32 v203, v203, v248
    v_mfma_f32_16x16x32_bf16 v[232:235], a[152:155], a[216:219], v[232:235]
    s_waitcnt lgkmcnt(4)
    v_exp_f32 v202, v202
    v_mfma_f32_16x16x32_bf16 v[232:235], a[156:159], a[220:223], v[232:235]
    s_waitcnt lgkmcnt(3)
    s_waitcnt lgkmcnt(2)
    s_barrier
    v_mfma_f32_16x16x32_bf16 v[232:235], a[160:163], a[224:227], v[232:235]
    buffer_load_dwordx4 v252, s[12:15], s62 offen lds
    v_cvt_pk_bf16_f32 v193, v200, v201
    v_mfma_f32_16x16x32_bf16 v[232:235], a[164:167], a[228:231], v[232:235]
    v_exp_f32 v203, v203
    v_mfma_f32_16x16x32_bf16 v[236:239], a[168:171], a[240:243], 0
    ds_read_b128 a[240:243], v240 offset:128
    v_cvt_pk_bf16_f32 v180, v202, v203
    v_mfma_f32_16x16x32_bf16 v[236:239], a[172:175], a[244:247], v[236:239]
    ds_read_b128 a[244:247], v241 offset:128
    ds_read_b128 v[200:203], v245 offset:64
    v_mfma_f32_16x16x32_bf16 v[236:239], a[176:179], a[216:219], v[236:239]
    buffer_load_dwordx4 v253, s[12:15], s62 offen offset:1024 lds
    v_mul_f32 v232, s38, v232
    v_mfma_f32_16x16x32_bf16 v[236:239], a[180:183], a[220:223], v[236:239]
    v_mul_f32 v233, s38, v233
    v_mul_f32 v234, s38, v234
    v_mfma_f32_16x16x32_bf16 v[236:239], a[184:187], a[224:227], v[236:239]
    v_mul_f32 v235, s38, v235
    v_cvt_pk_bf16_f32 v232, v232, v233
    v_mfma_f32_16x16x32_bf16 v[236:239], a[188:191], a[228:231], v[236:239]
    v_cvt_pk_bf16_f32 v233, v234, v235
    v_sub_f32 v204, v204, v248
    v_mfma_f32_16x16x32_bf16 v[228:231], a[200:203], a[216:219], v[228:231]
    buffer_load_dwordx4 v251, s[12:15], s62 offen offset:2048 lds
    s_add_u32 m0, s46, 0x17400
    v_mfma_f32_16x16x32_bf16 v[228:231], a[204:207], a[220:223], v[228:231]
    s_lshl_b32 s62, s28, 5
    s_add_u32 s62, s62, 0x3000
    v_mul_f32 v236, s3, v236
    v_mfma_f32_16x16x32_bf16 v[228:231], a[208:211], a[224:227], v[228:231]
    ds_write_b64 v247, v[232:233] offset:55296
    v_mfma_f32_16x16x32_bf16 v[228:231], a[212:215], a[228:231], v[228:231]
    s_waitcnt lgkmcnt(4)
    v_mul_f32 v237, s3, v237
    v_mul_f32 v238, s3, v238
    v_mfma_f32_16x16x32_bf16 v[232:235], a[0:3], a[232:235], 0
    buffer_load_dwordx4 v252, s[12:15], s63 offen lds
    v_mul_f32 v239, s3, v239
    v_mfma_f32_16x16x32_bf16 v[232:235], a[4:7], a[236:239], v[232:235]
    s_waitcnt lgkmcnt(1)
    v_cvt_pk_bf16_f32 v236, v236, v237
    v_cvt_pk_bf16_f32 v237, v238, v239
    v_mfma_f32_16x16x32_bf16 v[200:203], v[150:153], v[174:177], v[200:203]
    ds_write_b64 v247, v[236:237] offset:55424
    v_mfma_f32_16x16x32_bf16 v[200:203], v[152:155], v[176:179], v[200:203]
    v_mul_f32 v228, s38, v228
    v_mul_f32 v229, s38, v229
    v_mfma_f32_16x16x32_bf16 v[232:235], a[8:11], a[240:243], v[232:235]
    buffer_load_dwordx4 v253, s[12:15], s63 offen offset:1024 lds
    v_mul_f32 v230, s38, v230
    v_mfma_f32_16x16x32_bf16 v[232:235], a[12:15], a[244:247], v[232:235]
    v_mul_f32 v231, s38, v231
    v_cvt_pk_bf16_f32 v228, v228, v229
    v_mfma_f32_16x16x32_bf16 v[236:239], a[24:27], a[232:235], 0
    ds_read_b128 a[216:219], v240 offset:256
    v_cvt_pk_bf16_f32 v229, v230, v231
    v_mfma_f32_16x16x32_bf16 v[236:239], a[28:31], a[236:239], v[236:239]
    ds_write_b64 v247, v[228:229] offset:55552
    v_mfma_f32_16x16x32_bf16 v[236:239], a[32:35], a[240:243], v[236:239]
    buffer_load_dwordx4 v251, s[12:15], s63 offen offset:2048 lds
    s_add_u32 m0, s46, 0x16800
    v_mfma_f32_16x16x32_bf16 v[236:239], a[36:39], a[244:247], v[236:239]
    s_lshl_b32 s63, s28, 5
    s_add_u32 s63, s63, 0x7800
    v_sub_f32 v205, v205, v248
    v_mfma_f32_16x16x32_bf16 v[228:231], a[48:51], a[232:235], 0
    ds_read_b128 a[220:223], v241 offset:256
    ds_read_b128 a[224:227], v240 offset:1536
    v_mfma_f32_16x16x32_bf16 v[228:231], a[52:55], a[236:239], v[228:231]
    ds_read_b128 a[228:231], v241 offset:1536
    v_sub_f32 v206, v206, v248
    v_mfma_f32_16x16x32_bf16 v[228:231], a[56:59], a[240:243], v[228:231]
    v_exp_f32 v204, v204
    v_mfma_f32_16x16x32_bf16 v[228:231], a[60:63], a[244:247], v[228:231]
    v_exp_f32 v205, v205
    v_exp_f32 v206, v206
    s_waitcnt lgkmcnt(4)
    v_mfma_f32_16x16x32_bf16 v[232:235], a[16:19], a[216:219], v[232:235]
    v_sub_f32 v207, v207, v248
    v_cvt_pk_bf16_f32 v194, v204, v205
    v_mfma_f32_16x16x32_bf16 v[236:239], a[40:43], a[216:219], v[236:239]
    v_exp_f32 v207, v207
    v_mfma_f32_16x16x32_bf16 v[228:231], a[64:67], a[216:219], v[228:231]
    v_cvt_pk_bf16_f32 v181, v206, v207
    ds_read_b128 v[204:207], v246 offset:64
    v_sub_f32 v208, v208, v248
    s_waitcnt lgkmcnt(3)
    v_mfma_f32_16x16x32_bf16 v[232:235], a[20:23], a[220:223], v[232:235]
    v_exp_f32 v208, v208
    v_mfma_f32_16x16x32_bf16 v[236:239], a[44:47], a[220:223], v[236:239]
    v_sub_f32 v209, v209, v248
    v_sub_f32 v210, v210, v248
    v_mfma_f32_16x16x32_bf16 v[228:231], a[68:71], a[220:223], v[228:231]
    v_exp_f32 v209, v209
    v_exp_f32 v210, v210
    v_sub_f32 v211, v211, v248
    v_exp_f32 v211, v211
    v_cvt_pk_bf16_f32 v192, v208, v209
    v_cvt_pk_bf16_f32 v195, v210, v211
    ds_read_b128 v[208:211], v244 offset:128
    v_sub_f32 v196, v196, v248
    v_mfma_f32_16x16x32_bf16 v[212:215], v[6:9], v[192:195], 0
    v_exp_f32 v196, v196
    v_mfma_f32_16x16x32_bf16 v[216:219], v[36:39], v[192:195], 0
    v_sub_f32 v197, v197, v248
    v_sub_f32 v198, v198, v248
    v_mfma_f32_16x16x32_bf16 v[220:223], v[66:69], v[192:195], 0
    s_waitcnt lgkmcnt(1)
    v_exp_f32 v197, v197
    v_mfma_f32_16x16x32_bf16 v[224:227], a[248:251], v[192:195], 0
    v_exp_f32 v198, v198
    v_mfma_f32_16x16x32_bf16 v[204:207], v[162:165], v[174:177], v[204:207]
    v_sub_f32 v199, v199, v248
    v_cvt_pk_bf16_f32 v183, v196, v197
    v_mfma_f32_16x16x32_bf16 v[204:207], v[164:167], v[176:179], v[204:207]
    v_exp_f32 v199, v199
    v_sub_f32 v200, v200, v248
    v_cvt_pk_bf16_f32 v186, v198, v199
    ds_read_b128 v[196:199], v245 offset:128
    v_exp_f32 v200, v200
    s_waitcnt lgkmcnt(1)
    v_mfma_f32_16x16x32_bf16 v[208:211], v[132:135], v[174:177], v[208:211]
    v_sub_f32 v201, v201, v248
    v_sub_f32 v202, v202, v248
    v_mfma_f32_16x16x32_bf16 v[208:211], v[134:137], v[176:179], v[208:211]
    v_exp_f32 v201, v201
    v_exp_f32 v202, v202
    v_sub_f32 v203, v203, v248
    v_exp_f32 v203, v203
    v_cvt_pk_bf16_f32 v184, v200, v201
    v_cvt_pk_bf16_f32 v187, v202, v203
    ds_read_b128 v[200:203], v246 offset:128
    v_sub_f32 v204, v204, v248
    v_exp_f32 v204, v204
    v_sub_f32 v205, v205, v248
    v_exp_f32 v205, v205
    v_sub_f32 v206, v206, v248
    v_exp_f32 v206, v206
    v_sub_f32 v207, v207, v248
    s_waitcnt lgkmcnt(1)
    v_mfma_f32_16x16x32_bf16 v[196:199], v[156:159], v[174:177], v[196:199]
    v_exp_f32 v207, v207
    v_mfma_f32_16x16x32_bf16 v[196:199], v[158:161], v[176:179], v[196:199]
    v_cvt_pk_bf16_f32 v182, v204, v205
    v_cvt_pk_bf16_f32 v185, v206, v207
    ds_read_b128 v[204:207], v244 offset:0
    v_mfma_f32_16x16x32_bf16 v[212:215], v[10:13], v[180:183], v[212:215]
    v_sub_f32 v208, v208, v248
    v_sub_f32 v209, v209, v248
    v_mfma_f32_16x16x32_bf16 v[216:219], v[40:43], v[180:183], v[216:219]
    v_exp_f32 v208, v208
    v_mfma_f32_16x16x32_bf16 v[220:223], v[70:73], v[180:183], v[220:223]
    s_waitcnt lgkmcnt(1)
    v_exp_f32 v209, v209
    v_mfma_f32_16x16x32_bf16 v[224:227], a[248:251], v[180:183], v[224:227]
    v_cvt_pk_bf16_f32 v189, v208, v209
    s_waitcnt vmcnt(3)
    v_mfma_f32_16x16x32_bf16 v[212:215], v[14:17], v[184:187], v[212:215]
    ds_read_b64_tr_b16 a[144:145], v249 offset:0
    ds_read_b64_tr_b16 a[146:147], v250 offset:0
    v_mfma_f32_16x16x32_bf16 v[216:219], v[44:47], v[184:187], v[216:219]
    ds_read_b64_tr_b16 a[168:169], v249 offset:32
    ds_read_b64_tr_b16 a[170:171], v250 offset:32
    v_mfma_f32_16x16x32_bf16 v[220:223], v[74:77], v[184:187], v[220:223]
    ds_read_b64_tr_b16 a[192:193], v249 offset:64
    ds_read_b64_tr_b16 a[194:195], v250 offset:64
    v_mfma_f32_16x16x32_bf16 v[224:227], a[248:251], v[184:187], v[224:227]
    ds_read_b128 v[208:211], v245 offset:0
    v_sub_f32 v196, v196, v248
    v_mfma_f32_16x16x32_bf16 v[200:203], v[114:117], v[174:177], v[200:203]
    ds_read_b64 v[174:175], v247 offset:0
    v_sub_f32 v197, v197, v248
    v_mfma_f32_16x16x32_bf16 v[200:203], v[116:119], v[176:179], v[200:203]
    s_waitcnt lgkmcnt(8)
    ds_read_b64 v[176:177], v247 offset:128
    v_mfma_f32_16x16x32_bf16 v[204:207], v[126:129], v[168:171], v[204:207]
    ds_read_b64 v[178:179], v247 offset:256
    v_mfma_f32_16x16x32_bf16 v[204:207], v[128:131], v[170:173], v[204:207]
    v_exp_f32 v196, v196
    v_exp_f32 v197, v197
    s_nop 0
    v_cvt_pk_bf16_f32 v190, v196, v197
    ds_read_b128 v[196:199], v246 offset:0
    v_sub_f32 v200, v200, v248
    v_exp_f32 v200, v200
    v_sub_f32 v201, v201, v248
    v_exp_f32 v201, v201
    s_waitcnt lgkmcnt(5)
    buffer_load_dwordx4 v252, s[12:15], s60 offen lds
    s_waitcnt lgkmcnt(4)
    v_mfma_f32_16x16x32_bf16 v[208:211], v[150:153], v[168:171], v[208:211]
    v_cvt_pk_bf16_f32 v188, v200, v201
    s_waitcnt vmcnt(1)
    v_mfma_f32_16x16x32_bf16 v[208:211], v[152:155], v[170:173], v[208:211]
    ds_read_b64_tr_b16 a[148:149], v249 offset:3072
    ds_read_b64_tr_b16 a[150:151], v250 offset:3072
    v_mfma_f32_16x16x32_bf16 v[212:215], v[18:21], v[188:191], v[212:215]
    ds_read_b64_tr_b16 a[172:173], v249 offset:3104
    ds_read_b64_tr_b16 a[174:175], v250 offset:3104
    v_mfma_f32_16x16x32_bf16 v[216:219], v[48:51], v[188:191], v[216:219]
    buffer_load_dwordx4 v253, s[12:15], s60 offen offset:1024 lds
    ds_read_b64_tr_b16 a[196:197], v249 offset:3136
    v_mfma_f32_16x16x32_bf16 v[220:223], v[78:81], v[188:191], v[220:223]
    ds_read_b64_tr_b16 a[198:199], v250 offset:3136
    ds_read_b128 v[200:203], v244 offset:64
    v_mfma_f32_16x16x32_bf16 v[224:227], a[248:251], v[188:191], v[224:227]
    s_waitcnt lgkmcnt(7)
    v_max_f32 v248, v204, v205
    v_max3_f32 v248, v248, v206, v207
    v_mfma_f32_16x16x32_bf16 v[196:199], v[162:165], v[168:171], v[196:199]
    ds_read_b128 v[204:207], v245 offset:64
    v_max3_f32 v248, v248, v208, v209
    v_mfma_f32_16x16x32_bf16 v[196:199], v[164:167], v[170:173], v[196:199]
    buffer_load_dwordx4 v251, s[12:15], s60 offen offset:2048 lds
    s_add_u32 m0, s46, 0x17400
    v_rcp_f32 v225, v224
    v_max3_f32 v248, v248, v210, v211
    ds_read_b128 v[208:211], v246 offset:64
    v_mul_f32 v212, v212, v225
    v_mul_f32 v213, v213, v225
    v_mul_f32 v214, v214, v225
    v_mul_f32 v215, v215, v225
    v_cvt_pk_bf16_f32 v212, v212, v213
    v_cvt_pk_bf16_f32 v213, v214, v215
    ds_write_b64 v247, v[212:213] offset:12288
    v_mul_f32 v216, v216, v225
    s_waitcnt lgkmcnt(4)
    buffer_load_dwordx4 v252, s[12:15], s61 offen lds
    v_mul_f32 v217, v217, v225
    s_waitcnt lgkmcnt(3)
    v_mfma_f32_16x16x32_bf16 v[200:203], v[132:135], v[168:171], v[200:203]
    v_mul_f32 v218, v218, v225
    v_mul_f32 v219, v219, v225
    v_mfma_f32_16x16x32_bf16 v[200:203], v[134:137], v[170:173], v[200:203]
    s_waitcnt lgkmcnt(2)
    v_cvt_pk_bf16_f32 v216, v216, v217
    v_cvt_pk_bf16_f32 v217, v218, v219
    v_mfma_f32_16x16x32_bf16 v[204:207], v[156:159], v[168:171], v[204:207]
    ds_write_b64 v247, v[216:217] offset:12416
    v_mfma_f32_16x16x32_bf16 v[204:207], v[158:161], v[170:173], v[204:207]
    s_waitcnt lgkmcnt(2)
    buffer_load_dwordx4 v253, s[12:15], s61 offen offset:1024 lds
    v_mfma_f32_16x16x32_bf16 v[208:211], v[114:117], v[168:171], v[208:211]
    v_mul_f32 v220, v220, v225
    v_mul_f32 v221, v221, v225
    v_mfma_f32_16x16x32_bf16 v[208:211], v[116:119], v[170:173], v[208:211]
    v_mul_f32 v222, v222, v225
    v_mul_f32 v223, v223, v225
    v_cvt_pk_bf16_f32 v220, v220, v221
    v_cvt_pk_bf16_f32 v221, v222, v223
    ds_write_b64 v247, v[220:221] offset:12544
    buffer_load_dwordx4 v251, s[12:15], s61 offen offset:2048 lds
    s_add_u32 m0, s46, 0x16800
    v_max3_f32 v248, v248, v196, v197
    v_max3_f32 v248, v248, v198, v199
    ds_read_b128 v[196:199], v244 offset:128
    v_max3_f32 v248, v248, v200, v201
    v_max3_f32 v248, v248, v202, v203
    ds_read_b128 v[200:203], v245 offset:128
    v_max3_f32 v248, v248, v204, v205
    v_max3_f32 v248, v248, v206, v207
    ds_read_b128 v[204:207], v246 offset:128
    v_max3_f32 v248, v248, v208, v209
    v_max3_f32 v248, v248, v210, v211
    ds_read_b128 v[208:211], v244 offset:0
    s_waitcnt lgkmcnt(3)
    v_mfma_f32_16x16x32_bf16 v[196:199], v[90:93], v[168:171], v[196:199]
    v_mfma_f32_16x16x32_bf16 v[196:199], v[92:95], v[170:173], v[196:199]
    s_waitcnt lgkmcnt(2)
    v_mfma_f32_16x16x32_bf16 v[200:203], v[96:99], v[168:171], v[200:203]
    s_waitcnt lgkmcnt(1)
    v_mfma_f32_16x16x32_bf16 v[200:203], v[98:101], v[170:173], v[200:203]
    v_mfma_f32_16x16x32_bf16 v[204:207], v[120:123], v[168:171], v[204:207]
    s_waitcnt lgkmcnt(0)
    v_mfma_f32_16x16x32_bf16 v[204:207], v[122:125], v[170:173], v[204:207]
    v_mfma_f32_16x16x32_bf16 v[208:211], v[126:129], v[168:171], v[208:211]
    v_cvt_pk_bf16_f32 v126, v232, v233
    v_cvt_pk_bf16_f32 v127, v234, v235
    v_mfma_f32_16x16x32_bf16 v[208:211], v[128:131], v[170:173], v[208:211]
    v_cvt_pk_bf16_f32 v128, v236, v237
    v_cvt_pk_bf16_f32 v129, v238, v239
    v_mfma_f32_16x16x32_bf16 v[232:235], a[232:235], a[72:75], 0
    v_cvt_pk_bf16_f32 v130, v228, v229
    v_cvt_pk_bf16_f32 v131, v230, v231
    v_mfma_f32_16x16x32_bf16 v[232:235], a[236:239], a[76:79], v[232:235]
    v_max3_f32 v248, v248, v196, v197
    v_max3_f32 v248, v248, v200, v201
    v_mfma_f32_16x16x32_bf16 v[232:235], a[240:243], a[80:83], v[232:235]
    ds_read_b128 v[196:199], v245 offset:0
    ds_read_b128 v[200:203], v246 offset:0
    v_mfma_f32_16x16x32_bf16 v[232:235], a[244:247], a[84:87], v[232:235]
    v_max3_f32 v248, v248, v204, v205
    v_mov_b32 v225, v248
    v_mfma_f32_16x16x32_bf16 v[232:235], a[216:219], a[88:91], v[232:235]
    ds_read_b128 v[204:207], v244 offset:64
    v_permlane16_swap_b32 v248, v225
    v_mfma_f32_16x16x32_bf16 v[232:235], a[220:223], a[92:95], v[232:235]
    v_max_f32 v248, v248, v225
    v_mov_b32 v225, v248
    v_mfma_f32_16x16x32_bf16 v[236:239], a[232:235], a[96:99], 0
    v_mfma_f32_16x16x32_bf16 v[236:239], a[236:239], a[100:103], v[236:239]
    v_permlane32_swap_b32 v248, v225
    v_max_f32 v248, v248, v225
    v_mfma_f32_16x16x32_bf16 v[236:239], a[240:243], a[104:107], v[236:239]
    v_sub_f32 v208, v208, v248
    v_cvt_pk_bf16_f32 v1, v232, v233
    v_mfma_f32_16x16x32_bf16 v[236:239], a[244:247], a[108:111], v[236:239]
    v_cvt_pk_bf16_f32 v4, v234, v235
    v_sub_f32 v209, v209, v248
    v_mfma_f32_16x16x32_bf16 v[236:239], a[216:219], a[112:115], v[236:239]
    v_exp_f32 v208, v208
    v_mfma_f32_16x16x32_bf16 v[236:239], a[220:223], a[116:119], v[236:239]
    s_waitcnt lgkmcnt(2)
    v_exp_f32 v209, v209
    v_mfma_f32_16x16x32_bf16 v[196:199], v[150:153], v[168:171], v[196:199]
    s_waitcnt lgkmcnt(1)
    v_sub_f32 v210, v210, v248
    v_sub_f32 v211, v211, v248
    v_mfma_f32_16x16x32_bf16 v[196:199], v[152:155], v[170:173], v[196:199]
    s_waitcnt lgkmcnt(0)
    v_cvt_pk_bf16_f32 v31, v236, v237
    v_cvt_pk_bf16_f32 v34, v238, v239
    v_mfma_f32_16x16x32_bf16 v[200:203], v[162:165], v[168:171], v[200:203]
    v_exp_f32 v210, v210
    v_mfma_f32_16x16x32_bf16 v[200:203], v[164:167], v[170:173], v[200:203]
    v_exp_f32 v211, v211
    v_mfma_f32_16x16x32_bf16 v[204:207], v[132:135], v[168:171], v[204:207]
    v_cvt_pk_bf16_f32 v193, v208, v209
    v_cvt_pk_bf16_f32 v180, v210, v211
    v_mfma_f32_16x16x32_bf16 v[204:207], v[134:137], v[170:173], v[204:207]
    ds_read_b128 v[208:211], v245 offset:64
    v_sub_f32 v196, v196, v248
    v_mfma_f32_16x16x32_bf16 v[228:231], a[232:235], a[120:123], 0
    s_waitcnt vmcnt(3)
    ds_read_b64_tr_b16 a[152:153], v249 offset:0
    v_mfma_f32_16x16x32_bf16 v[228:231], a[236:239], a[124:127], v[228:231]
    ds_read_b64_tr_b16 a[154:155], v250 offset:0
    ds_read_b64_tr_b16 a[176:177], v249 offset:32
    v_mfma_f32_16x16x32_bf16 v[228:231], a[240:243], a[128:131], v[228:231]
    ds_read_b64_tr_b16 a[178:179], v250 offset:32
    ds_read_b64_tr_b16 a[200:201], v249 offset:64
    v_mfma_f32_16x16x32_bf16 v[228:231], a[244:247], a[132:135], v[228:231]
    ds_read_b64_tr_b16 a[202:203], v250 offset:64
    ds_read_b128 a[232:235], v240 offset:1664
    v_mfma_f32_16x16x32_bf16 v[228:231], a[216:219], a[136:139], v[228:231]
    ds_read_b128 a[236:239], v241 offset:1664
    ds_read_b128 a[240:243], v240 offset:1792
    v_mfma_f32_16x16x32_bf16 v[228:231], a[220:223], a[140:143], v[228:231]
    ds_read_b128 a[244:247], v241 offset:1792
    ds_read_b128 a[216:219], v240 offset:3072
    v_mfma_f32_16x16x32_bf16 v[232:235], a[0:3], a[224:227], 0
    ds_read_b128 a[220:223], v241 offset:3072
    v_sub_f32 v197, v197, v248
    v_mfma_f32_16x16x32_bf16 v[232:235], a[4:7], a[228:231], v[232:235]
    s_waitcnt lgkmcnt(12)
    v_exp_f32 v196, v196
    v_mfma_f32_16x16x32_bf16 v[208:211], v[156:159], v[168:171], v[208:211]
    v_cvt_pk_bf16_f32 v61, v228, v229
    v_cvt_pk_bf16_f32 v64, v230, v231
    v_mfma_f32_16x16x32_bf16 v[208:211], v[158:161], v[170:173], v[208:211]
    v_exp_f32 v197, v197
    v_mfma_f32_16x16x32_bf16 v[236:239], a[24:27], a[224:227], 0
    v_sub_f32 v198, v198, v248
    v_sub_f32 v199, v199, v248
    v_mfma_f32_16x16x32_bf16 v[236:239], a[28:31], a[228:231], v[236:239]
    s_waitcnt lgkmcnt(6)
    buffer_load_dwordx4 v252, s[12:15], s62 offen lds
    v_mfma_f32_16x16x32_bf16 v[228:231], a[48:51], a[224:227], 0
    s_waitcnt lgkmcnt(5)
    v_exp_f32 v198, v198
    v_mfma_f32_16x16x32_bf16 v[232:235], a[8:11], a[232:235], v[232:235]
    s_waitcnt lgkmcnt(4)
    v_exp_f32 v199, v199
    v_mfma_f32_16x16x32_bf16 v[232:235], a[12:15], a[236:239], v[232:235]
    s_waitcnt vmcnt(1) lgkmcnt(3)
    ds_read_b64_tr_b16 a[156:157], v249 offset:3072
    v_mfma_f32_16x16x32_bf16 v[232:235], a[16:19], a[240:243], v[232:235]
    buffer_load_dwordx4 v253, s[12:15], s62 offen offset:1024 lds
    ds_read_b64_tr_b16 a[158:159], v250 offset:3072
    v_mfma_f32_16x16x32_bf16 v[236:239], a[32:35], a[232:235], v[236:239]
    ds_read_b64_tr_b16 a[180:181], v249 offset:3104
    ds_read_b64_tr_b16 a[182:183], v250 offset:3104
    v_mfma_f32_16x16x32_bf16 v[236:239], a[36:39], a[236:239], v[236:239]
    ds_read_b64_tr_b16 a[204:205], v249 offset:3136
    ds_read_b64_tr_b16 a[206:207], v250 offset:3136
    v_mfma_f32_16x16x32_bf16 v[236:239], a[40:43], a[240:243], v[236:239]
    s_waitcnt lgkmcnt(8)
    v_cvt_pk_bf16_f32 v194, v196, v197
    v_cvt_pk_bf16_f32 v181, v198, v199
    v_mfma_f32_16x16x32_bf16 v[232:235], a[20:23], a[244:247], v[232:235]
    buffer_load_dwordx4 v251, s[12:15], s62 offen offset:2048 lds
    s_add_u32 m0, s46, 0x17400
    v_mfma_f32_16x16x32_bf16 v[236:239], a[44:47], a[244:247], v[236:239]
    ds_read_b128 v[196:199], v246 offset:64
    v_sub_f32 v200, v200, v248
    v_mfma_f32_16x16x32_bf16 v[228:231], a[52:55], a[228:231], v[228:231]
    v_exp_f32 v200, v200
    v_mfma_f32_16x16x32_bf16 v[228:231], a[56:59], a[232:235], v[228:231]
    v_sub_f32 v201, v201, v248
    v_sub_f32 v202, v202, v248
    v_mfma_f32_16x16x32_bf16 v[228:231], a[60:63], a[236:239], v[228:231]
    v_exp_f32 v201, v201
    v_mfma_f32_16x16x32_bf16 v[228:231], a[64:67], a[240:243], v[228:231]
    v_exp_f32 v202, v202
    v_mfma_f32_16x16x32_bf16 v[228:231], a[68:71], a[244:247], v[228:231]
    v_sub_f32 v203, v203, v248
    v_exp_f32 v203, v203
    s_waitcnt lgkmcnt(1)
    buffer_load_dwordx4 v252, s[12:15], s63 offen lds
    v_cvt_pk_bf16_f32 v192, v200, v201
    v_cvt_pk_bf16_f32 v195, v202, v203
    ds_read_b128 v[200:203], v244 offset:128
    v_sub_f32 v204, v204, v248
    v_mfma_f32_16x16x32_bf16 v[212:215], v[12:15], v[192:195], 0
    s_waitcnt lgkmcnt(1)
    v_exp_f32 v204, v204
    v_mfma_f32_16x16x32_bf16 v[216:219], v[42:45], v[192:195], 0
    v_sub_f32 v205, v205, v248
    v_sub_f32 v206, v206, v248
    v_mfma_f32_16x16x32_bf16 v[220:223], v[72:75], v[192:195], 0
    buffer_load_dwordx4 v253, s[12:15], s63 offen offset:1024 lds
    v_sub_f32 v207, v207, v248
    v_mfma_f32_16x16x32_bf16 v[224:227], a[248:251], v[192:195], 0
    v_exp_f32 v205, v205
    v_mfma_f32_16x16x32_bf16 v[196:199], v[114:117], v[168:171], v[196:199]
    v_exp_f32 v206, v206
    v_mfma_f32_16x16x32_bf16 v[196:199], v[116:119], v[170:173], v[196:199]
    v_exp_f32 v207, v207
    buffer_load_dwordx4 v251, s[12:15], s63 offen offset:2048 lds
    v_cvt_pk_bf16_f32 v183, v204, v205
    v_cvt_pk_bf16_f32 v186, v206, v207
    ds_read_b128 v[204:207], v245 offset:128
    s_waitcnt lgkmcnt(1)
    v_mfma_f32_16x16x32_bf16 v[200:203], v[90:93], v[168:171], v[200:203]
    v_sub_f32 v208, v208, v248
    v_sub_f32 v209, v209, v248
    v_mfma_f32_16x16x32_bf16 v[200:203], v[92:95], v[170:173], v[200:203]
    v_exp_f32 v208, v208
    v_exp_f32 v209, v209
    v_sub_f32 v210, v210, v248
    v_exp_f32 v210, v210
    v_sub_f32 v211, v211, v248
    v_exp_f32 v211, v211
    v_cvt_pk_bf16_f32 v184, v208, v209
    v_cvt_pk_bf16_f32 v187, v210, v211
    ds_read_b128 v[208:211], v246 offset:128
    v_sub_f32 v196, v196, v248
    v_exp_f32 v196, v196
    v_sub_f32 v197, v197, v248
    v_exp_f32 v197, v197
    v_sub_f32 v198, v198, v248
    v_exp_f32 v198, v198
    s_waitcnt lgkmcnt(1)
    v_mfma_f32_16x16x32_bf16 v[204:207], v[96:99], v[168:171], v[204:207]
    v_sub_f32 v199, v199, v248
    v_cvt_pk_bf16_f32 v182, v196, v197
    v_mfma_f32_16x16x32_bf16 v[204:207], v[98:101], v[170:173], v[204:207]
    v_exp_f32 v199, v199
    v_mfma_f32_16x16x32_bf16 v[212:215], v[16:19], v[180:183], v[212:215]
    v_cvt_pk_bf16_f32 v185, v198, v199
    v_sub_f32 v200, v200, v248
    v_mfma_f32_16x16x32_bf16 v[216:219], v[46:49], v[180:183], v[216:219]
    ds_read_b128 v[196:199], v244 offset:32
    v_sub_f32 v201, v201, v248
    v_mfma_f32_16x16x32_bf16 v[220:223], v[76:79], v[180:183], v[220:223]
    v_exp_f32 v200, v200
    v_mfma_f32_16x16x32_bf16 v[224:227], a[248:251], v[180:183], v[224:227]
    s_waitcnt lgkmcnt(1)
    v_exp_f32 v201, v201
    v_mfma_f32_16x16x32_bf16 v[212:215], v[20:23], v[184:187], v[212:215]
    v_cvt_pk_bf16_f32 v189, v200, v201
    v_sub_f32 v204, v204, v248
    v_mfma_f32_16x16x32_bf16 v[216:219], v[50:53], v[184:187], v[216:219]
    ds_read_b128 v[200:203], v245 offset:32
    v_sub_f32 v205, v205, v248
    v_mfma_f32_16x16x32_bf16 v[220:223], v[80:83], v[184:187], v[220:223]
    v_exp_f32 v204, v204
    v_mfma_f32_16x16x32_bf16 v[224:227], a[248:251], v[184:187], v[224:227]
    v_exp_f32 v205, v205
    v_mfma_f32_16x16x32_bf16 v[208:211], v[120:123], v[168:171], v[208:211]
    ds_read_b64 v[168:169], v247 offset:24576
    v_cvt_pk_bf16_f32 v190, v204, v205
    v_mfma_f32_16x16x32_bf16 v[208:211], v[122:125], v[170:173], v[208:211]
    ds_read_b128 v[204:207], v246 offset:32
    s_waitcnt lgkmcnt(3)
    v_mfma_f32_16x16x32_bf16 v[196:199], v[132:135], v[174:177], v[196:199]
    ds_read_b64 v[170:171], v247 offset:24704
    ds_read_b64 v[172:173], v247 offset:24832
    v_mfma_f32_16x16x32_bf16 v[196:199], v[134:137], v[176:179], v[196:199]
    s_nop 1
    v_sub_f32 v208, v208, v248
    v_exp_f32 v208, v208
    v_sub_f32 v209, v209, v248
    v_exp_f32 v209, v209
    s_nop 0
    s_waitcnt lgkmcnt(4)
    v_mfma_f32_16x16x32_bf16 v[200:203], v[156:159], v[174:177], v[200:203]
    v_cvt_pk_bf16_f32 v188, v208, v209
    v_max_f32 v248, v196, v197
    v_mfma_f32_16x16x32_bf16 v[200:203], v[158:161], v[176:179], v[200:203]
    ds_read_b128 v[208:211], v244 offset:96
    v_max3_f32 v248, v248, v198, v199
    v_mfma_f32_16x16x32_bf16 v[212:215], v[24:27], v[188:191], v[212:215]
    ds_read_b128 v[196:199], v245 offset:96
    v_mfma_f32_16x16x32_bf16 v[216:219], v[54:57], v[188:191], v[216:219]
    v_mfma_f32_16x16x32_bf16 v[220:223], v[84:87], v[188:191], v[220:223]
    s_waitcnt lgkmcnt(4)
    v_mfma_f32_16x16x32_bf16 v[224:227], a[248:251], v[188:191], v[224:227]
    v_max3_f32 v248, v248, v200, v201
    v_max3_f32 v248, v248, v202, v203
    v_mfma_f32_16x16x32_bf16 v[204:207], v[114:117], v[174:177], v[204:207]
    ds_read_b128 v[200:203], v246 offset:96
    v_mfma_f32_16x16x32_bf16 v[204:207], v[116:119], v[176:179], v[204:207]
    s_nop 2
    v_rcp_f32 v225, v224
    s_nop 0
    v_mul_f32 v212, v212, v225
    v_mul_f32 v213, v213, v225
    v_mul_f32 v214, v214, v225
    s_waitcnt lgkmcnt(2)
    v_mfma_f32_16x16x32_bf16 v[208:211], v[90:93], v[174:177], v[208:211]
    s_waitcnt vmcnt(3)
    ds_read_b64_tr_b16 a[160:161], v249 offset:0
    v_mfma_f32_16x16x32_bf16 v[208:211], v[92:95], v[176:179], v[208:211]
    s_waitcnt lgkmcnt(2)
    ds_read_b64_tr_b16 a[162:163], v250 offset:0
    v_mfma_f32_16x16x32_bf16 v[196:199], v[96:99], v[174:177], v[196:199]
    ds_read_b64_tr_b16 a[184:185], v249 offset:32
    ds_read_b64_tr_b16 a[186:187], v250 offset:32
    v_mfma_f32_16x16x32_bf16 v[196:199], v[98:101], v[176:179], v[196:199]
    ds_read_b64_tr_b16 a[208:209], v249 offset:64
    ds_read_b64_tr_b16 a[210:211], v250 offset:64
    v_mul_f32 v215, v215, v225
    v_cvt_pk_bf16_f32 v212, v212, v213
    s_waitcnt lgkmcnt(6)
    v_mfma_f32_16x16x32_bf16 v[200:203], v[120:123], v[174:177], v[200:203]
    v_cvt_pk_bf16_f32 v213, v214, v215
    v_mul_f32 v216, v216, v225
    v_mfma_f32_16x16x32_bf16 v[200:203], v[122:125], v[176:179], v[200:203]
    ds_write_b64 v247, v[212:213] offset:18432
    v_mul_f32 v217, v217, v225
    v_mul_f32 v218, v218, v225
    v_mul_f32 v219, v219, v225
    v_cvt_pk_bf16_f32 v216, v216, v217
    v_cvt_pk_bf16_f32 v217, v218, v219
    ds_write_b64 v247, v[216:217] offset:18560
    v_mul_f32 v220, v220, v225
    v_mul_f32 v221, v221, v225
    v_mul_f32 v222, v222, v225
    v_mul_f32 v223, v223, v225
    v_cvt_pk_bf16_f32 v220, v220, v221
    v_cvt_pk_bf16_f32 v221, v222, v223
    ds_write_b64 v247, v[220:221] offset:18688
    v_max3_f32 v248, v248, v204, v205
    v_max3_f32 v248, v248, v206, v207
    ds_read_b128 v[204:207], v244 offset:32
    v_max3_f32 v248, v248, v208, v209
    v_max3_f32 v248, v248, v210, v211
    ds_read_b128 v[208:211], v245 offset:32
    v_max3_f32 v248, v248, v196, v197
    v_max3_f32 v248, v248, v198, v199
    s_waitcnt vmcnt(0)
    ds_read_b64_tr_b16 a[164:165], v249 offset:3072
    ds_read_b64_tr_b16 a[166:167], v250 offset:3072
    ds_read_b64_tr_b16 a[188:189], v249 offset:3104
    ds_read_b64_tr_b16 a[190:191], v250 offset:3104
    ds_read_b64_tr_b16 a[212:213], v249 offset:3136
    ds_read_b64_tr_b16 a[214:215], v250 offset:3136
    ds_read_b128 v[196:199], v246 offset:32
    v_max3_f32 v248, v248, v200, v201
    v_max3_f32 v248, v248, v202, v203
    ds_read_b128 v[200:203], v244 offset:96
    v_mov_b32 v225, v248
    s_nop 1
    v_permlane16_swap_b32 v248, v225
    v_max_f32 v248, v248, v225
    v_mov_b32 v225, v248
    s_nop 1
    s_waitcnt lgkmcnt(9)
    v_mfma_f32_16x16x32_bf16 v[204:207], v[132:135], v[174:177], v[204:207]
    v_cvt_pk_bf16_f32 v132, v232, v233
    v_cvt_pk_bf16_f32 v133, v234, v235
    v_mfma_f32_16x16x32_bf16 v[204:207], v[134:137], v[176:179], v[204:207]
    s_waitcnt lgkmcnt(8)
    v_cvt_pk_bf16_f32 v134, v236, v237
    v_cvt_pk_bf16_f32 v135, v238, v239
    v_mfma_f32_16x16x32_bf16 v[208:211], v[156:159], v[174:177], v[208:211]
    v_cvt_pk_bf16_f32 v136, v228, v229
    v_cvt_pk_bf16_f32 v137, v230, v231
    v_mfma_f32_16x16x32_bf16 v[208:211], v[158:161], v[176:179], v[208:211]
    v_permlane32_swap_b32 v248, v225
    v_max_f32 v248, v248, v225
    v_mfma_f32_16x16x32_bf16 v[232:235], a[224:227], a[72:75], 0
    v_sub_f32 v204, v204, v248
    s_waitcnt lgkmcnt(2)
    v_mfma_f32_16x16x32_bf16 v[232:235], a[228:231], a[76:79], v[232:235]
    s_barrier
    v_exp_f32 v204, v204
    v_mfma_f32_16x16x32_bf16 v[232:235], a[232:235], a[80:83], v[232:235]
    s_waitcnt lgkmcnt(1)
    v_sub_f32 v205, v205, v248
    v_sub_f32 v206, v206, v248
    v_mfma_f32_16x16x32_bf16 v[196:199], v[114:117], v[174:177], v[196:199]
    s_waitcnt lgkmcnt(0)
    v_exp_f32 v205, v205
    v_mfma_f32_16x16x32_bf16 v[196:199], v[116:119], v[176:179], v[196:199]
    v_exp_f32 v206, v206
    v_mfma_f32_16x16x32_bf16 v[200:203], v[90:93], v[174:177], v[200:203]
    v_sub_f32 v207, v207, v248
    v_cvt_pk_bf16_f32 v193, v204, v205
    v_mfma_f32_16x16x32_bf16 v[200:203], v[92:95], v[176:179], v[200:203]
    v_exp_f32 v207, v207
    v_mfma_f32_16x16x32_bf16 v[232:235], a[236:239], a[84:87], v[232:235]
    v_cvt_pk_bf16_f32 v180, v206, v207
    v_sub_f32 v208, v208, v248
    v_mfma_f32_16x16x32_bf16 v[232:235], a[240:243], a[88:91], v[232:235]
    ds_read_b128 v[204:207], v245 offset:96
    v_sub_f32 v209, v209, v248
    v_mfma_f32_16x16x32_bf16 v[232:235], a[244:247], a[92:95], v[232:235]
    v_exp_f32 v208, v208
    v_mfma_f32_16x16x32_bf16 v[236:239], a[224:227], a[96:99], 0
    v_exp_f32 v209, v209
    v_mfma_f32_16x16x32_bf16 v[236:239], a[228:231], a[100:103], v[236:239]
    v_sub_f32 v210, v210, v248
    v_sub_f32 v211, v211, v248
    v_mfma_f32_16x16x32_bf16 v[236:239], a[232:235], a[104:107], v[236:239]
    v_exp_f32 v210, v210
    v_mfma_f32_16x16x32_bf16 v[236:239], a[236:239], a[108:111], v[236:239]
    v_cvt_pk_bf16_f32 v7, v232, v233
    v_cvt_pk_bf16_f32 v10, v234, v235
    v_mfma_f32_16x16x32_bf16 v[236:239], a[240:243], a[112:115], v[236:239]
    v_exp_f32 v211, v211
    v_mfma_f32_16x16x32_bf16 v[236:239], a[244:247], a[116:119], v[236:239]
    v_cvt_pk_bf16_f32 v194, v208, v209
    v_cvt_pk_bf16_f32 v181, v210, v211
    v_mfma_f32_16x16x32_bf16 v[228:231], a[224:227], a[120:123], 0
    ds_read_b128 a[224:227], v240 offset:3200
    ds_read_b128 v[208:211], v246 offset:96
    v_mfma_f32_16x16x32_bf16 v[228:231], a[228:231], a[124:127], v[228:231]
    ds_read_b128 a[228:231], v241 offset:3200
    v_sub_f32 v196, v196, v248
    v_mfma_f32_16x16x32_bf16 v[228:231], a[232:235], a[128:131], v[228:231]
    s_waitcnt lgkmcnt(3)
    v_cvt_pk_bf16_f32 v37, v236, v237
    v_cvt_pk_bf16_f32 v40, v238, v239
    v_mfma_f32_16x16x32_bf16 v[204:207], v[96:99], v[174:177], v[204:207]
    ds_read_b128 a[232:235], v240 offset:3328
    v_sub_f32 v197, v197, v248
    v_mfma_f32_16x16x32_bf16 v[204:207], v[98:101], v[176:179], v[204:207]
    v_exp_f32 v196, v196
    v_mfma_f32_16x16x32_bf16 v[228:231], a[236:239], a[132:135], v[228:231]
    ds_read_b128 a[236:239], v241 offset:3328
    v_sub_f32 v198, v198, v248
    v_mfma_f32_16x16x32_bf16 v[228:231], a[240:243], a[136:139], v[228:231]
    ds_read_b128 a[240:243], v240 offset:4608
    v_sub_f32 v199, v199, v248
    v_mfma_f32_16x16x32_bf16 v[228:231], a[244:247], a[140:143], v[228:231]
    ds_read_b128 a[244:247], v241 offset:4608
    v_sub_f32 v200, v200, v248
    v_mfma_f32_16x16x32_bf16 v[232:235], a[0:3], a[216:219], 0
    v_exp_f32 v197, v197
    v_mfma_f32_16x16x32_bf16 v[232:235], a[4:7], a[220:223], v[232:235]
    s_waitcnt lgkmcnt(6)
    v_exp_f32 v198, v198
    v_mfma_f32_16x16x32_bf16 v[232:235], a[8:11], a[224:227], v[232:235]
    s_waitcnt lgkmcnt(5)
    v_cvt_pk_bf16_f32 v67, v228, v229
    v_cvt_pk_bf16_f32 v70, v230, v231
    v_mfma_f32_16x16x32_bf16 v[208:211], v[120:123], v[174:177], v[208:211]
    ds_read_b64 v[174:175], v247 offset:30720
    v_cvt_pk_bf16_f32 v192, v196, v197
    v_mfma_f32_16x16x32_bf16 v[208:211], v[122:125], v[176:179], v[208:211]
    ds_read_b64 v[176:177], v247 offset:30848
    ds_read_b64 v[178:179], v247 offset:30976
    v_mfma_f32_16x16x32_bf16 v[236:239], a[24:27], a[216:219], 0
    s_waitcnt lgkmcnt(7)
    v_exp_f32 v199, v199
    v_mfma_f32_16x16x32_bf16 v[232:235], a[12:15], a[228:231], v[232:235]
    s_waitcnt lgkmcnt(6)
    v_cvt_pk_bf16_f32 v195, v198, v199
    v_sub_f32 v201, v201, v248
    v_mfma_f32_16x16x32_bf16 v[232:235], a[16:19], a[232:235], v[232:235]
    ds_read_b128 v[196:199], v244 offset:192
    v_sub_f32 v202, v202, v248
    v_mfma_f32_16x16x32_bf16 v[212:215], v[18:21], v[192:195], 0
    s_waitcnt lgkmcnt(6)
    v_exp_f32 v200, v200
    v_mfma_f32_16x16x32_bf16 v[216:219], v[48:51], v[192:195], 0
    v_exp_f32 v201, v201
    v_mfma_f32_16x16x32_bf16 v[220:223], v[78:81], v[192:195], 0
    v_exp_f32 v202, v202
    v_mfma_f32_16x16x32_bf16 v[224:227], a[248:251], v[192:195], 0
    v_sub_f32 v203, v203, v248
    v_cvt_pk_bf16_f32 v183, v200, v201
    v_mfma_f32_16x16x32_bf16 v[232:235], a[20:23], a[236:239], v[232:235]
    v_exp_f32 v203, v203
    v_mfma_f32_16x16x32_bf16 v[236:239], a[28:31], a[220:223], v[236:239]
    v_cvt_pk_bf16_f32 v186, v202, v203
    v_sub_f32 v204, v204, v248
    v_mfma_f32_16x16x32_bf16 v[236:239], a[32:35], a[224:227], v[236:239]
    ds_read_b128 v[200:203], v245 offset:192
    v_sub_f32 v205, v205, v248
    v_mfma_f32_16x16x32_bf16 v[236:239], a[36:39], a[228:231], v[236:239]
    v_cvt_pk_bf16_f32 v90, v232, v233
    v_cvt_pk_bf16_f32 v91, v234, v235
    v_mfma_f32_16x16x32_bf16 v[236:239], a[40:43], a[232:235], v[236:239]
    s_waitcnt lgkmcnt(1)
    v_exp_f32 v204, v204
    v_mfma_f32_16x16x32_bf16 v[196:199], v[138:141], v[168:171], v[196:199]
    v_exp_f32 v205, v205
    v_mfma_f32_16x16x32_bf16 v[196:199], v[140:143], v[170:173], v[196:199]
    v_sub_f32 v206, v206, v248
    v_sub_f32 v207, v207, v248
    v_mfma_f32_16x16x32_bf16 v[236:239], a[44:47], a[236:239], v[236:239]
    v_exp_f32 v206, v206
    v_mfma_f32_16x16x32_bf16 v[228:231], a[48:51], a[216:219], 0
    v_exp_f32 v207, v207
    v_mfma_f32_16x16x32_bf16 v[228:231], a[52:55], a[220:223], v[228:231]
    v_cvt_pk_bf16_f32 v184, v204, v205
    v_cvt_pk_bf16_f32 v187, v206, v207
    v_mfma_f32_16x16x32_bf16 v[228:231], a[56:59], a[224:227], v[228:231]
    ds_read_b128 v[204:207], v246 offset:192
    v_cvt_pk_bf16_f32 v92, v236, v237
    v_mfma_f32_16x16x32_bf16 v[228:231], a[60:63], a[228:231], v[228:231]
    s_waitcnt lgkmcnt(1)
    v_cvt_pk_bf16_f32 v93, v238, v239
    v_sub_f32 v208, v208, v248
    v_mfma_f32_16x16x32_bf16 v[200:203], v[102:105], v[168:171], v[200:203]
    v_exp_f32 v208, v208
    v_mfma_f32_16x16x32_bf16 v[200:203], v[104:107], v[170:173], v[200:203]
    v_sub_f32 v209, v209, v248
    v_sub_f32 v210, v210, v248
    v_mfma_f32_16x16x32_bf16 v[228:231], a[64:67], a[232:235], v[228:231]
    v_exp_f32 v209, v209
    v_mfma_f32_16x16x32_bf16 v[228:231], a[68:71], a[236:239], v[228:231]
    v_exp_f32 v210, v210
    v_mfma_f32_16x16x32_bf16 v[232:235], a[216:219], a[72:75], 0
    v_sub_f32 v211, v211, v248
    v_cvt_pk_bf16_f32 v182, v208, v209
    v_mfma_f32_16x16x32_bf16 v[232:235], a[220:223], a[76:79], v[232:235]
    v_exp_f32 v211, v211
    v_mfma_f32_16x16x32_bf16 v[212:215], v[22:25], v[180:183], v[212:215]
    v_cvt_pk_bf16_f32 v185, v210, v211
    v_cvt_pk_bf16_f32 v94, v228, v229
    v_mfma_f32_16x16x32_bf16 v[216:219], v[52:55], v[180:183], v[216:219]
    ds_read_b128 v[208:211], v244 offset:256
    v_cvt_pk_bf16_f32 v95, v230, v231
    v_mfma_f32_16x16x32_bf16 v[220:223], v[82:85], v[180:183], v[220:223]
    s_waitcnt lgkmcnt(1)
    v_max_f32 v248, v196, v197
    v_max3_f32 v248, v248, v198, v199
    v_mfma_f32_16x16x32_bf16 v[224:227], a[248:251], v[180:183], v[224:227]
    ds_read_b128 v[196:199], v245 offset:256
    v_max3_f32 v248, v248, v200, v201
    v_mfma_f32_16x16x32_bf16 v[212:215], v[26:29], v[184:187], v[212:215]
    v_max3_f32 v248, v248, v202, v203
    v_mfma_f32_16x16x32_bf16 v[216:219], v[56:59], v[184:187], v[216:219]
    ds_read_b128 v[200:203], v246 offset:256
    v_mfma_f32_16x16x32_bf16 v[220:223], v[86:89], v[184:187], v[220:223]
    v_mfma_f32_16x16x32_bf16 v[224:227], a[248:251], v[184:187], v[224:227]
    v_mov_b32 v187, 0
    v_mfma_f32_16x16x32_bf16 v[204:207], v[126:129], v[168:171], v[204:207]
    v_mfma_f32_16x16x32_bf16 v[204:207], v[128:131], v[170:173], v[204:207]
    v_mfma_f32_16x16x32_bf16 v[232:235], a[224:227], a[80:83], v[232:235]
    s_waitcnt lgkmcnt(2)
    v_mfma_f32_16x16x32_bf16 v[208:211], v[144:147], v[168:171], v[208:211]
    v_mfma_f32_16x16x32_bf16 v[208:211], v[146:149], v[170:173], v[208:211]
    s_waitcnt lgkmcnt(1)
    v_rcp_f32 v225, v224
    v_mfma_f32_16x16x32_bf16 v[196:199], v[108:111], v[168:171], v[196:199]
    v_mov_b32 v226, 0x22e00
    v_cndmask_b32 v226, v226, v247, vcc
    v_mfma_f32_16x16x32_bf16 v[196:199], v[110:113], v[170:173], v[196:199]
    s_mov_b32 vcc_lo, 0xff00fff0
    v_mul_f32 v212, v212, v225
    v_mul_f32 v213, v213, v225
    v_mfma_f32_16x16x32_bf16 v[232:235], a[228:231], a[84:87], v[232:235]
    s_mov_b32 vcc_hi, 0xf000
    v_mul_f32 v214, v214, v225
    v_mul_f32 v215, v215, v225
    v_mfma_f32_16x16x32_bf16 v[232:235], a[232:235], a[88:91], v[232:235]
    s_waitcnt lgkmcnt(0)
    v_cvt_pk_bf16_f32 v212, v212, v213
    v_cvt_pk_bf16_f32 v213, v214, v215
    v_mfma_f32_16x16x32_bf16 v[200:203], v[132:135], v[168:171], v[200:203]
    ds_write_b64 v226, v[212:213] offset:0
    v_mfma_f32_16x16x32_bf16 v[200:203], v[134:137], v[170:173], v[200:203]
    v_mul_f32 v216, v216, v225
    v_mul_f32 v217, v217, v225
    v_mfma_f32_16x16x32_bf16 v[232:235], a[236:239], a[92:95], v[232:235]
    v_mul_f32 v218, v218, v225
    v_mul_f32 v219, v219, v225
    v_mfma_f32_16x16x32_bf16 v[236:239], a[216:219], a[96:99], 0
    v_cvt_pk_bf16_f32 v216, v216, v217
    v_cvt_pk_bf16_f32 v217, v218, v219
    v_mfma_f32_16x16x32_bf16 v[236:239], a[220:223], a[100:103], v[236:239]
    ds_write_b64 v226, v[216:217] offset:128
    v_mfma_f32_16x16x32_bf16 v[236:239], a[224:227], a[104:107], v[236:239]
    v_cvt_pk_bf16_f32 v13, v232, v233
    v_cvt_pk_bf16_f32 v16, v234, v235
    v_mfma_f32_16x16x32_bf16 v[236:239], a[228:231], a[108:111], v[236:239]
    v_mul_f32 v220, v220, v225
    v_mul_f32 v221, v221, v225
    v_mfma_f32_16x16x32_bf16 v[236:239], a[232:235], a[112:115], v[236:239]
    v_mul_f32 v222, v222, v225
    v_mul_f32 v223, v223, v225
    v_mfma_f32_16x16x32_bf16 v[236:239], a[236:239], a[116:119], v[236:239]
    v_cvt_pk_bf16_f32 v220, v220, v221
    v_cvt_pk_bf16_f32 v221, v222, v223
    v_mfma_f32_16x16x32_bf16 v[228:231], a[216:219], a[120:123], 0
    ds_read_b128 a[216:219], v240 offset:4736
    v_max3_f32 v248, v248, v204, v205
    v_mfma_f32_16x16x32_bf16 v[228:231], a[220:223], a[124:127], v[228:231]
    ds_read_b128 a[220:223], v241 offset:4736
    v_max3_f32 v248, v248, v206, v207
    v_mfma_f32_16x16x32_bf16 v[228:231], a[224:227], a[128:131], v[228:231]
    v_cvt_pk_bf16_f32 v43, v236, v237
    v_cvt_pk_bf16_f32 v46, v238, v239
    v_mfma_f32_16x16x32_bf16 v[228:231], a[228:231], a[132:135], v[228:231]
    ds_read_b128 a[224:227], v240 offset:4864
    ds_read_b128 a[228:231], v241 offset:4864
    v_mfma_f32_16x16x32_bf16 v[228:231], a[232:235], a[136:139], v[228:231]
    ds_read_b128 v[204:207], v244 offset:320
    v_max3_f32 v248, v248, v208, v209
    v_mfma_f32_16x16x32_bf16 v[228:231], a[236:239], a[140:143], v[228:231]
    ds_write_b64 v226, v[220:221] offset:256
    v_mfma_f32_16x16x32_bf16 v[232:235], a[0:3], a[240:243], 0
    v_max3_f32 v248, v248, v210, v211
    v_max3_f32 v248, v248, v196, v197
    v_mfma_f32_16x16x32_bf16 v[232:235], a[4:7], a[244:247], v[232:235]
    ds_read_b128 v[208:211], v245 offset:320
    v_max3_f32 v248, v248, v198, v199
    v_mfma_f32_16x16x32_bf16 v[236:239], a[24:27], a[240:243], 0
    s_waitcnt lgkmcnt(6)
    v_cvt_pk_bf16_f32 v73, v228, v229
    v_cvt_pk_bf16_f32 v76, v230, v231
    v_mfma_f32_16x16x32_bf16 v[232:235], a[8:11], a[216:219], v[232:235]
    ds_read_b128 v[196:199], v246 offset:320
    v_max3_f32 v248, v248, v200, v201
    v_mfma_f32_16x16x32_bf16 v[236:239], a[28:31], a[244:247], v[236:239]
    s_waitcnt lgkmcnt(6)
    v_max3_f32 v248, v248, v202, v203
    v_mfma_f32_16x16x32_bf16 v[232:235], a[12:15], a[220:223], v[232:235]
    ds_read_b128 v[200:203], v244 offset:192
    s_waitcnt lgkmcnt(6)
    v_mfma_f32_16x16x32_bf16 v[232:235], a[16:19], a[224:227], v[232:235]
    s_waitcnt lgkmcnt(5)
    v_mfma_f32_16x16x32_bf16 v[232:235], a[20:23], a[228:231], v[232:235]
    s_waitcnt lgkmcnt(4)
    v_mfma_f32_16x16x32_bf16 v[204:207], v[150:153], v[168:171], v[204:207]
    v_mfma_f32_16x16x32_bf16 v[204:207], v[152:155], v[170:173], v[204:207]
    v_mfma_f32_16x16x32_bf16 v[236:239], a[32:35], a[216:219], v[236:239]
    s_waitcnt lgkmcnt(2)
    v_mfma_f32_16x16x32_bf16 v[208:211], v[162:165], v[168:171], v[208:211]
    v_mfma_f32_16x16x32_bf16 v[208:211], v[164:167], v[170:173], v[208:211]
    s_waitcnt lgkmcnt(1)
    v_mfma_f32_16x16x32_bf16 v[196:199], v[90:93], v[168:171], v[196:199]
    v_mfma_f32_16x16x32_bf16 v[196:199], v[92:95], v[170:173], v[196:199]
    s_waitcnt lgkmcnt(0)
    v_max3_f32 v248, v248, v204, v205
    v_mfma_f32_16x16x32_bf16 v[200:203], v[138:141], v[168:171], v[200:203]
    v_cvt_pk_bf16_f32 v138, v232, v233
    v_cvt_pk_bf16_f32 v139, v234, v235
    v_mfma_f32_16x16x32_bf16 v[200:203], v[140:143], v[170:173], v[200:203]
    ds_read_b128 v[204:207], v245 offset:192
    v_max3_f32 v248, v248, v208, v209
    v_mfma_f32_16x16x32_bf16 v[236:239], a[36:39], a[220:223], v[236:239]
    ds_read_b128 v[208:211], v246 offset:192
    v_max3_f32 v248, v248, v196, v197
    v_mfma_f32_16x16x32_bf16 v[236:239], a[40:43], a[224:227], v[236:239]
    ds_read_b128 v[196:199], v244 offset:256
    v_mov_b32 v225, v248
    v_mfma_f32_16x16x32_bf16 v[236:239], a[44:47], a[228:231], v[236:239]
    v_mfma_f32_16x16x32_bf16 v[228:231], a[48:51], a[240:243], 0
    v_permlane16_swap_b32 v248, v225
    v_max_f32 v248, v248, v225
    v_mfma_f32_16x16x32_bf16 v[228:231], a[52:55], a[244:247], v[228:231]
    v_mov_b32 v225, v248
    v_mfma_f32_16x16x32_bf16 v[228:231], a[56:59], a[216:219], v[228:231]
    v_mfma_f32_16x16x32_bf16 v[228:231], a[60:63], a[220:223], v[228:231]
    v_permlane32_swap_b32 v248, v225
    v_cvt_pk_bf16_f32 v140, v236, v237
    v_mfma_f32_16x16x32_bf16 v[228:231], a[64:67], a[224:227], v[228:231]
    v_cvt_pk_bf16_f32 v141, v238, v239
    v_max_f32 v248, v248, v225
    v_mfma_f32_16x16x32_bf16 v[228:231], a[68:71], a[228:231], v[228:231]
    s_waitcnt lgkmcnt(2)
    v_sub_f32 v200, v200, v248
    v_sub_f32 v201, v201, v248
    v_mfma_f32_16x16x32_bf16 v[204:207], v[102:105], v[168:171], v[204:207]
    s_waitcnt lgkmcnt(1)
    v_exp_f32 v200, v200
    v_mfma_f32_16x16x32_bf16 v[204:207], v[104:107], v[170:173], v[204:207]
    s_waitcnt lgkmcnt(0)
    v_cvt_pk_bf16_f32 v142, v228, v229
    v_cvt_pk_bf16_f32 v143, v230, v231
    v_mfma_f32_16x16x32_bf16 v[208:211], v[126:129], v[168:171], v[208:211]
    v_exp_f32 v201, v201
    v_mfma_f32_16x16x32_bf16 v[208:211], v[128:131], v[170:173], v[208:211]
    v_sub_f32 v202, v202, v248
    v_sub_f32 v203, v203, v248
    v_mfma_f32_16x16x32_bf16 v[196:199], v[144:147], v[168:171], v[196:199]
    v_exp_f32 v202, v202
    v_mfma_f32_16x16x32_bf16 v[196:199], v[146:149], v[170:173], v[196:199]
    v_exp_f32 v203, v203
    v_mfma_f32_16x16x32_bf16 v[232:235], a[240:243], a[72:75], 0
    v_cvt_pk_bf16_f32 v190, v200, v201
    v_cvt_pk_bf16_f32 v193, v202, v203
    v_mfma_f32_16x16x32_bf16 v[232:235], a[244:247], a[76:79], v[232:235]
    ds_read_b128 v[200:203], v245 offset:256
    v_sub_f32 v204, v204, v248
    v_mfma_f32_16x16x32_bf16 v[232:235], a[216:219], a[80:83], v[232:235]
    v_exp_f32 v204, v204
    v_mfma_f32_16x16x32_bf16 v[232:235], a[220:223], a[84:87], v[232:235]
    v_sub_f32 v205, v205, v248
    v_sub_f32 v206, v206, v248
    v_mfma_f32_16x16x32_bf16 v[232:235], a[224:227], a[88:91], v[232:235]
    v_exp_f32 v205, v205
    v_mfma_f32_16x16x32_bf16 v[232:235], a[228:231], a[92:95], v[232:235]
    v_exp_f32 v206, v206
    v_mfma_f32_16x16x32_bf16 v[236:239], a[240:243], a[96:99], 0
    v_sub_f32 v207, v207, v248
    v_cvt_pk_bf16_f32 v188, v204, v205
    v_mfma_f32_16x16x32_bf16 v[236:239], a[244:247], a[100:103], v[236:239]
    v_exp_f32 v207, v207
    v_mfma_f32_16x16x32_bf16 v[236:239], a[216:219], a[104:107], v[236:239]
    v_cvt_pk_bf16_f32 v191, v206, v207
    v_cvt_pk_bf16_f32 v19, v232, v233
    v_mfma_f32_16x16x32_bf16 v[236:239], a[220:223], a[108:111], v[236:239]
    ds_read_b128 v[204:207], v246 offset:256
    v_cvt_pk_bf16_f32 v22, v234, v235
    v_mfma_f32_16x16x32_bf16 v[236:239], a[224:227], a[112:115], v[236:239]
    s_waitcnt lgkmcnt(1)
    v_mbcnt_lo_u32_b32 v232, -1, 0
    v_mbcnt_hi_u32_b32 v232, -1, v232
    v_mfma_f32_16x16x32_bf16 v[200:203], v[108:111], v[168:171], v[200:203]
    v_and_b32 v233, 15, v232
    v_lshrrev_b32 v232, 4, v232
    v_mfma_f32_16x16x32_bf16 v[200:203], v[110:113], v[170:173], v[200:203]
    v_lshrrev_b32 v234, 1, v233
    v_mul_u32_u24 v235, 0x180, v233
    v_mfma_f32_16x16x32_bf16 v[236:239], a[228:231], a[116:119], v[236:239]
    v_xor_b32 v243, v232, v234
    v_lshl_add_u32 v242, v243, 4, v235
    v_mfma_f32_16x16x32_bf16 v[228:231], a[240:243], a[120:123], 0
    v_xor_b32 v243, 64, v242
    v_add_u32 v242, 0x1e000, v242
    v_mfma_f32_16x16x32_bf16 v[228:231], a[244:247], a[124:127], v[228:231]
    ds_read_b128 a[232:235], v242 offset:0
    v_add_u32 v243, 0x1e000, v243
    v_mfma_f32_16x16x32_bf16 v[228:231], a[216:219], a[128:131], v[228:231]
    v_cvt_pk_bf16_f32 v49, v236, v237
    v_cvt_pk_bf16_f32 v52, v238, v239
    v_mfma_f32_16x16x32_bf16 v[228:231], a[220:223], a[132:135], v[228:231]
    ds_read_b128 a[236:239], v243 offset:0
    ds_read_b128 a[240:243], v242 offset:128
    v_mfma_f32_16x16x32_bf16 v[228:231], a[224:227], a[136:139], v[228:231]
    ds_read_b128 a[244:247], v243 offset:128
    ds_read_b128 a[216:219], v242 offset:256
    v_mfma_f32_16x16x32_bf16 v[228:231], a[228:231], a[140:143], v[228:231]
    s_waitcnt lgkmcnt(5)
    ds_read_b128 a[220:223], v243 offset:256
    v_mfma_f32_16x16x32_bf16 v[204:207], v[132:135], v[168:171], v[204:207]
    ds_read_b128 a[224:227], v242 offset:6144
    ds_read_b128 a[228:231], v243 offset:6144
    v_mfma_f32_16x16x32_bf16 v[204:207], v[134:137], v[170:173], v[204:207]
    v_lshrrev_b32 v249, 1, v232
    v_or_b32 v249, s66, v249
    v_cvt_pk_bf16_f32 v79, v228, v229
    v_cvt_pk_bf16_f32 v82, v230, v231
    v_mov_b32 v253, v249
    v_xor_b32 v249, v249, v234
    v_lshl_add_u32 v249, v249, 4, v235
    s_waitcnt lgkmcnt(7)
    v_mfma_f32_16x16x32_bf16 v[236:239], a[144:147], a[232:235], 0
    v_and_b32 v235, 1, v232
    v_lshl_add_u32 v249, v235, 3, v249
    v_mfma_f32_16x16x32_bf16 v[228:231], a[168:171], a[232:235], 0
    v_add_u32 v249, 0x16800, v249
    s_waitcnt lgkmcnt(6)
    v_mfma_f32_16x16x32_bf16 v[236:239], a[148:151], a[236:239], v[236:239]
    v_xor_b32 v250, s67, v232
    v_mul_u32_u24 v250, 0x300, v250
    v_mfma_f32_16x16x32_bf16 v[228:231], a[172:175], a[236:239], v[228:231]
    s_waitcnt lgkmcnt(5)
    s_mul_i32 s67, s28, 0x600
    s_add_u32 s67, s67, 0x16800
    v_mfma_f32_16x16x32_bf16 v[236:239], a[152:155], a[240:243], v[236:239]
    s_waitcnt lgkmcnt(4)
    v_mul_u32_u24 v232, 0x180, v232
    v_add_u32 v232, s67, v232
    v_mfma_f32_16x16x32_bf16 v[236:239], a[156:159], a[244:247], v[236:239]
    s_waitcnt lgkmcnt(3)
    v_lshlrev_b32 v235, 3, v235
    v_xor_b32 v252, v233, v235
    v_mfma_f32_16x16x32_bf16 v[236:239], a[160:163], a[216:219], v[236:239]
    s_waitcnt lgkmcnt(2)
    v_xor_b32 v252, v252, v253
    v_lshl_add_u32 v252, v252, 4, v232
    v_mfma_f32_16x16x32_bf16 v[236:239], a[164:167], a[220:223], v[236:239]
    v_xor_b32 v253, v253, v234
    v_lshl_add_u32 v253, v253, 4, v232
    v_mfma_f32_16x16x32_bf16 v[228:231], a[176:179], a[240:243], v[228:231]
    v_and_b32 v234, 1, v233
    v_lshl_add_u32 v253, v234, 3, v253
    v_mfma_f32_16x16x32_bf16 v[228:231], a[180:183], a[244:247], v[228:231]
    v_lshl_add_u32 v251, v233, 3, v250
    v_xor_b32 v233, v233, v235
    v_mfma_f32_16x16x32_bf16 v[228:231], a[184:187], a[216:219], v[228:231]
    v_cvt_pk_bf16_f32 v236, v236, v237
    v_cvt_pk_bf16_f32 v237, v238, v239
    v_mfma_f32_16x16x32_bf16 v[228:231], a[188:191], a[220:223], v[228:231]
    ds_write_b64 v249, v[236:237] offset:0
    s_waitcnt lgkmcnt(2)
    v_mfma_f32_16x16x32_bf16 v[236:239], a[144:147], a[224:227], 0
    s_waitcnt lgkmcnt(1)
    v_lshl_add_u32 v250, v233, 4, v250
    v_sub_f32 v208, v208, v248
    v_mfma_f32_16x16x32_bf16 v[232:235], a[192:195], a[232:235], 0
    ds_read_b128 a[232:235], v242 offset:6272
    v_cvt_pk_bf16_f32 v228, v228, v229
    v_mfma_f32_16x16x32_bf16 v[232:235], a[196:199], a[236:239], v[232:235]
    ds_read_b128 a[236:239], v243 offset:6272
    v_cvt_pk_bf16_f32 v229, v230, v231
    v_mfma_f32_16x16x32_bf16 v[232:235], a[200:203], a[240:243], v[232:235]
    ds_write_b64 v249, v[228:229] offset:128
    v_mfma_f32_16x16x32_bf16 v[232:235], a[204:207], a[244:247], v[232:235]
    ds_read_b128 a[240:243], v242 offset:6400
    ds_read_b128 a[244:247], v243 offset:6400
    v_mfma_f32_16x16x32_bf16 v[232:235], a[208:211], a[216:219], v[232:235]
    ds_read_b128 a[216:219], v242 offset:12288
    v_sub_f32 v209, v209, v248
    v_mfma_f32_16x16x32_bf16 v[232:235], a[212:215], a[220:223], v[232:235]
    ds_read_b128 a[220:223], v243 offset:12288
    v_sub_f32 v210, v210, v248
    v_mfma_f32_16x16x32_bf16 v[236:239], a[148:151], a[228:231], v[236:239]
    v_exp_f32 v208, v208
    v_mfma_f32_16x16x32_bf16 v[228:231], a[168:171], a[224:227], 0
    v_exp_f32 v209, v209
    v_mfma_f32_16x16x32_bf16 v[228:231], a[172:175], a[228:231], v[228:231]
    s_waitcnt lgkmcnt(6)
    v_cvt_pk_bf16_f32 v232, v232, v233
    v_cvt_pk_bf16_f32 v233, v234, v235
    v_mfma_f32_16x16x32_bf16 v[236:239], a[152:155], a[232:235], v[236:239]
    ds_write_b64 v249, v[232:233] offset:256
    v_mfma_f32_16x16x32_bf16 v[228:231], a[176:179], a[232:235], v[228:231]
    s_waitcnt lgkmcnt(6)
    v_exp_f32 v210, v210
    v_mfma_f32_16x16x32_bf16 v[236:239], a[156:159], a[236:239], v[236:239]
    v_sub_f32 v211, v211, v248
    v_cvt_pk_bf16_f32 v189, v208, v209
    v_mfma_f32_16x16x32_bf16 v[228:231], a[180:183], a[236:239], v[228:231]
    s_waitcnt lgkmcnt(4)
    v_exp_f32 v211, v211
    v_mfma_f32_16x16x32_bf16 v[212:215], v[0:3], v[188:191], 0
    v_cvt_pk_bf16_f32 v192, v210, v211
    v_sub_f32 v196, v196, v248
    v_mfma_f32_16x16x32_bf16 v[216:219], v[30:33], v[188:191], 0
    ds_read_b128 v[208:211], v244 offset:320
    v_sub_f32 v197, v197, v248
    v_mfma_f32_16x16x32_bf16 v[220:223], v[60:63], v[188:191], 0
    v_exp_f32 v196, v196
    v_mfma_f32_16x16x32_bf16 v[224:227], a[248:251], v[188:191], 0
    v_exp_f32 v197, v197
    v_mfma_f32_16x16x32_bf16 v[236:239], a[160:163], a[240:243], v[236:239]
    s_waitcnt lgkmcnt(4)
    v_sub_f32 v198, v198, v248
    v_sub_f32 v199, v199, v248
    v_mfma_f32_16x16x32_bf16 v[236:239], a[164:167], a[244:247], v[236:239]
    v_exp_f32 v198, v198
    v_mfma_f32_16x16x32_bf16 v[228:231], a[184:187], a[240:243], v[228:231]
    v_exp_f32 v199, v199
    v_mfma_f32_16x16x32_bf16 v[228:231], a[188:191], a[244:247], v[228:231]
    v_cvt_pk_bf16_f32 v180, v196, v197
    v_cvt_pk_bf16_f32 v183, v198, v199
    v_mfma_f32_16x16x32_bf16 v[232:235], a[192:195], a[224:227], 0
    ds_read_b128 a[224:227], v242 offset:12416
    v_cvt_pk_bf16_f32 v236, v236, v237
    v_mfma_f32_16x16x32_bf16 v[232:235], a[196:199], a[228:231], v[232:235]
    ds_read_b128 a[228:231], v243 offset:12416
    v_cvt_pk_bf16_f32 v237, v238, v239
    v_mfma_f32_16x16x32_bf16 v[232:235], a[200:203], a[232:235], v[232:235]
    ds_write_b64 v249, v[236:237] offset:6144
    v_mfma_f32_16x16x32_bf16 v[232:235], a[204:207], a[236:239], v[232:235]
    ds_read_b128 a[232:235], v242 offset:12544
    v_cvt_pk_bf16_f32 v228, v228, v229
    v_mfma_f32_16x16x32_bf16 v[232:235], a[208:211], a[240:243], v[232:235]
    ds_read_b128 a[236:239], v243 offset:12544
    v_cvt_pk_bf16_f32 v229, v230, v231
    v_mfma_f32_16x16x32_bf16 v[232:235], a[212:215], a[244:247], v[232:235]
    s_waitcnt lgkmcnt(5)
    v_add_u32 v242, 0xfffe9800, v242
    v_add_u32 v243, 0xfffe9800, v243
    v_mfma_f32_16x16x32_bf16 v[208:211], v[150:153], v[168:171], v[208:211]
    ds_write_b64 v249, v[228:229] offset:6272
    v_mfma_f32_16x16x32_bf16 v[208:211], v[152:155], v[170:173], v[208:211]
    ds_read_b128 a[240:243], v242 offset:6144
    ds_read_b128 a[244:247], v243 offset:6144
    v_mfma_f32_16x16x32_bf16 v[236:239], a[144:147], a[216:219], 0
    ds_read_b128 v[196:199], v245 offset:320
    v_cvt_pk_bf16_f32 v232, v232, v233
    v_mfma_f32_16x16x32_bf16 v[236:239], a[148:151], a[220:223], v[236:239]
    s_waitcnt lgkmcnt(8)
    v_cvt_pk_bf16_f32 v233, v234, v235
    v_sub_f32 v200, v200, v248
    v_mfma_f32_16x16x32_bf16 v[236:239], a[152:155], a[224:227], v[236:239]
    ds_write_b64 v249, v[232:233] offset:6400
    v_mfma_f32_16x16x32_bf16 v[228:231], a[168:171], a[216:219], 0
    s_waitcnt lgkmcnt(8)
    v_exp_f32 v200, v200
    v_mfma_f32_16x16x32_bf16 v[236:239], a[156:159], a[228:231], v[236:239]
    s_waitcnt lgkmcnt(6)
    v_sub_f32 v201, v201, v248
    v_sub_f32 v202, v202, v248
    v_mfma_f32_16x16x32_bf16 v[236:239], a[160:163], a[232:235], v[236:239]
    s_waitcnt lgkmcnt(5)
    v_exp_f32 v201, v201
    v_mfma_f32_16x16x32_bf16 v[236:239], a[164:167], a[236:239], v[236:239]
    v_exp_f32 v202, v202
    v_mfma_f32_16x16x32_bf16 v[228:231], a[172:175], a[220:223], v[228:231]
    v_sub_f32 v203, v203, v248
    v_cvt_pk_bf16_f32 v194, v200, v201
    v_mfma_f32_16x16x32_bf16 v[228:231], a[176:179], a[224:227], v[228:231]
    v_exp_f32 v203, v203
    v_mfma_f32_16x16x32_bf16 v[228:231], a[180:183], a[228:231], v[228:231]
    s_waitcnt lgkmcnt(1)
    v_cvt_pk_bf16_f32 v236, v236, v237
    v_cvt_pk_bf16_f32 v237, v238, v239
    v_mfma_f32_16x16x32_bf16 v[196:199], v[162:165], v[168:171], v[196:199]
    ds_write_b64 v249, v[236:237] offset:12288
    v_mfma_f32_16x16x32_bf16 v[196:199], v[164:167], v[170:173], v[196:199]
    v_cvt_pk_bf16_f32 v181, v202, v203
    v_sub_f32 v204, v204, v248
    v_mfma_f32_16x16x32_bf16 v[228:231], a[184:187], a[232:235], v[228:231]
    ds_read_b128 v[200:203], v246 offset:320
    v_sub_f32 v205, v205, v248
    v_mfma_f32_16x16x32_bf16 v[228:231], a[188:191], a[236:239], v[228:231]
    v_exp_f32 v204, v204
    v_mfma_f32_16x16x32_bf16 v[232:235], a[192:195], a[216:219], 0
    ds_read_b128 a[216:219], v242 offset:6272
    v_sub_f32 v206, v206, v248
    v_mfma_f32_16x16x32_bf16 v[232:235], a[196:199], a[220:223], v[232:235]
    ds_read_b128 a[220:223], v243 offset:6272
    v_sub_f32 v207, v207, v248
    v_mfma_f32_16x16x32_bf16 v[232:235], a[200:203], a[224:227], v[232:235]
    ds_read_b128 a[224:227], v242 offset:6400
    v_cvt_pk_bf16_f32 v228, v228, v229
    v_mfma_f32_16x16x32_bf16 v[232:235], a[204:207], a[228:231], v[232:235]
    ds_read_b128 a[228:231], v243 offset:6400
    v_cvt_pk_bf16_f32 v229, v230, v231
    v_mfma_f32_16x16x32_bf16 v[232:235], a[208:211], a[232:235], v[232:235]
    ds_write_b64 v249, v[228:229] offset:12416
    v_mfma_f32_16x16x32_bf16 v[232:235], a[212:215], a[236:239], v[232:235]
    ds_read_b128 a[232:235], v240 offset:6144
    ds_read_b128 a[236:239], v241 offset:6144
    v_mfma_f32_16x16x32_bf16 v[236:239], a[144:147], a[240:243], 0
    s_waitcnt lgkmcnt(7)
    v_exp_f32 v205, v205
    v_mfma_f32_16x16x32_bf16 v[200:203], v[90:93], v[168:171], v[200:203]
    ds_read_b64 v[168:169], v247 offset:36864
    v_cvt_pk_bf16_f32 v195, v204, v205
    v_mfma_f32_16x16x32_bf16 v[200:203], v[92:95], v[170:173], v[200:203]
    ds_read_b64 v[170:171], v247 offset:36992
    v_cvt_pk_bf16_f32 v232, v232, v233
    v_mfma_f32_16x16x32_bf16 v[212:215], v[4:7], v[192:195], v[212:215]
    ds_read_b64 v[172:173], v247 offset:37120
    v_cvt_pk_bf16_f32 v233, v234, v235
    v_mfma_f32_16x16x32_bf16 v[216:219], v[34:37], v[192:195], v[216:219]
    ds_write_b64 v249, v[232:233] offset:12544
    v_mfma_f32_16x16x32_bf16 v[220:223], v[64:67], v[192:195], v[220:223]
    v_exp_f32 v206, v206
    v_mfma_f32_16x16x32_bf16 v[224:227], a[248:251], v[192:195], v[224:227]
    v_exp_f32 v207, v207
    v_mfma_f32_16x16x32_bf16 v[236:239], a[148:151], a[244:247], v[236:239]
    s_waitcnt lgkmcnt(10)
    v_cvt_pk_bf16_f32 v182, v206, v207
    v_sub_f32 v208, v208, v248
    v_mfma_f32_16x16x32_bf16 v[236:239], a[152:155], a[216:219], v[236:239]
    ds_read_b128 v[204:207], v244 offset:0
    v_sub_f32 v209, v209, v248
    v_mfma_f32_16x16x32_bf16 v[212:215], v[8:11], v[180:183], v[212:215]
    s_waitcnt lgkmcnt(9)
    v_exp_f32 v208, v208
    v_mfma_f32_16x16x32_bf16 v[216:219], v[38:41], v[180:183], v[216:219]
    v_exp_f32 v209, v209
    v_mfma_f32_16x16x32_bf16 v[220:223], v[68:71], v[180:183], v[220:223]
    v_cvt_pk_bf16_f32 v186, v208, v209
    v_sub_f32 v196, v196, v248
    v_mfma_f32_16x16x32_bf16 v[224:227], a[248:251], v[180:183], v[224:227]
    ds_read_b128 v[208:211], v245 offset:0
    s_waitcnt lgkmcnt(2)
    v_mfma_f32_16x16x32_bf16 v[236:239], a[156:159], a[220:223], v[236:239]
    s_barrier
    ds_read_b128 a[252:255], v252 offset:0
    v_mfma_f32_16x16x32_bf16 v[236:239], a[160:163], a[224:227], v[236:239]
    ds_read_b64 v[254:255], v253 offset:256
    v_sub_f32 v197, v197, v248
    v_mfma_f32_16x16x32_bf16 v[236:239], a[164:167], a[228:231], v[236:239]
    v_exp_f32 v196, v196
    v_mfma_f32_16x16x32_bf16 v[228:231], a[168:171], a[240:243], 0
    v_exp_f32 v197, v197
    v_mfma_f32_16x16x32_bf16 v[228:231], a[172:175], a[244:247], v[228:231]
    s_waitcnt lgkmcnt(3)
    v_cvt_pk_bf16_f32 v184, v196, v197
    v_sub_f32 v200, v200, v248
    v_mfma_f32_16x16x32_bf16 v[204:207], v[144:147], v[174:177], v[204:207]
    ds_read_b128 v[196:199], v246 offset:0
    v_cvt_pk_bf16_f32 v236, v236, v237
    v_mfma_f32_16x16x32_bf16 v[204:207], v[146:149], v[176:179], v[204:207]
    v_cvt_pk_bf16_f32 v237, v238, v239
    v_sub_f32 v201, v201, v248
    v_mfma_f32_16x16x32_bf16 v[228:231], a[176:179], a[216:219], v[228:231]
    ds_write_b64 v249, v[236:237] offset:18432
    v_mfma_f32_16x16x32_bf16 v[228:231], a[180:183], a[220:223], v[228:231]
    s_waitcnt lgkmcnt(4)
    s_waitcnt lgkmcnt(3)
    v_mfma_f32_16x16x32_bf16 v[208:211], v[108:111], v[174:177], v[208:211]
    buffer_store_dwordx4 a[252:255], v250, s[20:23], s55 offen nt
    v_mfma_f32_16x16x32_bf16 v[208:211], v[110:113], v[176:179], v[208:211]
    s_waitcnt lgkmcnt(2)
    ds_read_b128 a[252:255], v252 offset:6144
    v_mfma_f32_16x16x32_bf16 v[228:231], a[184:187], a[224:227], v[228:231]
    v_exp_f32 v200, v200
    v_mfma_f32_16x16x32_bf16 v[228:231], a[188:191], a[228:231], v[228:231]
    buffer_store_dwordx2 v[254:255], v251, s[20:23], s55 offen offset:256 nt
    v_mfma_f32_16x16x32_bf16 v[232:235], a[192:195], a[240:243], 0
    ds_read_b128 a[240:243], v240 offset:6272
    ds_read_b64 v[254:255], v253 offset:6400
    v_mfma_f32_16x16x32_bf16 v[232:235], a[196:199], a[244:247], v[232:235]
    ds_read_b128 a[244:247], v241 offset:6272
    s_mul_i32 s55, s31, 3
    v_mfma_f32_16x16x32_bf16 v[232:235], a[200:203], a[216:219], v[232:235]
    ds_read_b128 a[216:219], v240 offset:6400
    v_cvt_pk_bf16_f32 v228, v228, v229
    v_mfma_f32_16x16x32_bf16 v[232:235], a[204:207], a[220:223], v[232:235]
    ds_read_b128 a[220:223], v241 offset:6400
    v_cvt_pk_bf16_f32 v229, v230, v231
    v_mfma_f32_16x16x32_bf16 v[232:235], a[208:211], a[224:227], v[232:235]
    ds_write_b64 v249, v[228:229] offset:18560
    v_mfma_f32_16x16x32_bf16 v[232:235], a[212:215], a[228:231], v[232:235]
    ds_read_b128 a[224:227], v242 offset:12288
    ds_read_b128 a[228:231], v243 offset:12288
    v_mfma_f32_16x16x32_bf16 v[236:239], a[0:3], a[232:235], 0
    s_waitcnt lgkmcnt(8)
    s_add_u32 s54, s54, s55
    s_add_u32 s54, s54, s32
    v_mfma_f32_16x16x32_bf16 v[196:199], v[132:135], v[174:177], v[196:199]
    buffer_store_dwordx4 a[252:255], v250, s[20:23], s57 offen nt
    v_mfma_f32_16x16x32_bf16 v[196:199], v[134:137], v[176:179], v[196:199]
    s_waitcnt lgkmcnt(6)
    v_cvt_pk_bf16_f32 v232, v232, v233
    v_cvt_pk_bf16_f32 v233, v234, v235
    v_mfma_f32_16x16x32_bf16 v[236:239], a[4:7], a[236:239], v[236:239]
    ds_write_b64 v249, v[232:233] offset:18688
    v_mfma_f32_16x16x32_bf16 v[236:239], a[8:11], a[240:243], v[236:239]
    buffer_store_dwordx2 v[254:255], v251, s[20:23], s57 offen offset:256 nt
    v_mfma_f32_16x16x32_bf16 v[228:231], a[24:27], a[232:235], 0
    ds_read_b128 a[252:255], v252 offset:12288
    ds_read_b64 v[254:255], v253 offset:12544
    v_mfma_f32_16x16x32_bf16 v[228:231], a[28:31], a[236:239], v[228:231]
    s_mul_i32 s57, s31, 7
    s_add_u32 s56, s56, s57
    s_add_u32 s56, s56, s32
    v_mfma_f32_16x16x32_bf16 v[228:231], a[32:35], a[240:243], v[228:231]
    s_add_u32 s55, s28, 7
    s_mul_i32 s55, s55, s30
    s_add_u32 s57, s28, 11
    v_mfma_f32_16x16x32_bf16 v[232:235], a[48:51], a[232:235], 0
    s_mul_i32 s57, s57, s30
    v_exp_f32 v201, v201
    v_mfma_f32_16x16x32_bf16 v[232:235], a[52:55], a[236:239], v[232:235]
    s_waitcnt lgkmcnt(6)
    v_cvt_pk_bf16_f32 v185, v200, v201
    v_max_f32 v248, v204, v205
    v_mfma_f32_16x16x32_bf16 v[236:239], a[12:15], a[244:247], v[236:239]
    ds_read_b128 v[200:203], v244 offset:64
    v_max3_f32 v248, v248, v206, v207
    v_mfma_f32_16x16x32_bf16 v[212:215], v[12:15], v[184:187], v[212:215]
    ds_read_b128 v[204:207], v245 offset:64
    v_max3_f32 v248, v248, v208, v209
    v_mfma_f32_16x16x32_bf16 v[216:219], v[42:45], v[184:187], v[216:219]
    v_max3_f32 v248, v248, v210, v211
    v_max3_f32 v248, v248, v196, v197
    v_mfma_f32_16x16x32_bf16 v[220:223], v[72:75], v[184:187], v[220:223]
    ds_read_b128 v[208:211], v246 offset:64
    s_waitcnt lgkmcnt(4)
    v_mfma_f32_16x16x32_bf16 v[224:227], a[248:251], v[184:187], v[224:227]
    buffer_store_dwordx4 a[252:255], v250, s[20:23], s52 offen nt
    v_mfma_f32_16x16x32_bf16 v[236:239], a[16:19], a[216:219], v[236:239]
    s_waitcnt lgkmcnt(3)
    v_max3_f32 v248, v248, v198, v199
    v_mfma_f32_16x16x32_bf16 v[236:239], a[20:23], a[220:223], v[236:239]
    ds_read_b128 v[196:199], v244 offset:128
    v_mfma_f32_16x16x32_bf16 v[228:231], a[36:39], a[244:247], v[228:231]
    buffer_store_dwordx2 v[254:255], v251, s[20:23], s52 offen offset:256 nt
    v_mfma_f32_16x16x32_bf16 v[228:231], a[40:43], a[216:219], v[228:231]
    s_mul_i32 s52, s31, 11
    s_add_u32 s51, s51, s52
    s_add_u32 s51, s51, s32
    v_mfma_f32_16x16x32_bf16 v[228:231], a[44:47], a[220:223], v[228:231]
    s_add_u32 s52, s28, 11
    s_mul_i32 s52, s52, s30
    s_waitcnt lgkmcnt(2)
    v_mfma_f32_16x16x32_bf16 v[200:203], v[150:153], v[174:177], v[200:203]
    v_rcp_f32 v225, v224
    v_mfma_f32_16x16x32_bf16 v[200:203], v[152:155], v[176:179], v[200:203]
    s_waitcnt lgkmcnt(1)
    v_mul_f32 v212, v212, v225
    v_mul_f32 v213, v213, v225
    v_mfma_f32_16x16x32_bf16 v[204:207], v[162:165], v[174:177], v[204:207]
    v_mul_f32 v214, v214, v225
    v_mul_f32 v215, v215, v225
    v_mfma_f32_16x16x32_bf16 v[204:207], v[164:167], v[176:179], v[204:207]
    v_cvt_pk_bf16_f32 v212, v212, v213
    v_cvt_pk_bf16_f32 v213, v214, v215
    v_mfma_f32_16x16x32_bf16 v[208:211], v[90:93], v[174:177], v[208:211]
    ds_write_b64 v247, v[212:213] offset:24576
    v_mfma_f32_16x16x32_bf16 v[208:211], v[92:95], v[176:179], v[208:211]
    s_waitcnt lgkmcnt(1)
    v_mul_f32 v216, v216, v225
    v_mul_f32 v217, v217, v225
    v_mfma_f32_16x16x32_bf16 v[196:199], v[156:159], v[174:177], v[196:199]
    v_mul_f32 v218, v218, v225
    v_mul_f32 v219, v219, v225
    v_mfma_f32_16x16x32_bf16 v[196:199], v[158:161], v[176:179], v[196:199]
    v_cvt_pk_bf16_f32 v216, v216, v217
    v_cvt_pk_bf16_f32 v217, v218, v219
    v_mfma_f32_16x16x32_bf16 v[232:235], a[56:59], a[240:243], v[232:235]
    ds_write_b64 v247, v[216:217] offset:24704
    v_mfma_f32_16x16x32_bf16 v[232:235], a[60:63], a[244:247], v[232:235]
    v_mul_f32 v220, v220, v225
    v_mul_f32 v221, v221, v225
    v_mfma_f32_16x16x32_bf16 v[232:235], a[64:67], a[216:219], v[232:235]
    v_mul_f32 v222, v222, v225
    v_mul_f32 v223, v223, v225
    v_mfma_f32_16x16x32_bf16 v[232:235], a[68:71], a[220:223], v[232:235]
    v_cvt_pk_bf16_f32 v220, v220, v221
    v_cvt_pk_bf16_f32 v221, v222, v223
    ds_write_b64 v247, v[220:221] offset:24832
    v_max3_f32 v248, v248, v200, v201
    v_max3_f32 v248, v248, v202, v203
    ds_read_b128 v[200:203], v245 offset:128
    v_max3_f32 v248, v248, v204, v205
    v_max3_f32 v248, v248, v206, v207
    ds_read_b128 v[204:207], v246 offset:128
    v_max3_f32 v248, v248, v208, v209
    v_max3_f32 v248, v248, v210, v211
    ds_read_b128 v[208:211], v244 offset:0
    v_max3_f32 v248, v248, v196, v197
    ds_read_b128 v[196:199], v245 offset:0
    s_waitcnt lgkmcnt(3)
    v_mfma_f32_16x16x32_bf16 v[200:203], v[114:117], v[174:177], v[200:203]
    v_mfma_f32_16x16x32_bf16 v[200:203], v[116:119], v[176:179], v[200:203]
    s_waitcnt lgkmcnt(2)
    v_mfma_f32_16x16x32_bf16 v[204:207], v[138:141], v[174:177], v[204:207]
    s_waitcnt lgkmcnt(1)
    v_mfma_f32_16x16x32_bf16 v[204:207], v[140:143], v[176:179], v[204:207]
    s_waitcnt lgkmcnt(0)
    v_mfma_f32_16x16x32_bf16 v[208:211], v[144:147], v[174:177], v[208:211]
    v_cvt_pk_bf16_f32 v144, v236, v237
    v_cvt_pk_bf16_f32 v145, v238, v239
    v_mfma_f32_16x16x32_bf16 v[208:211], v[146:149], v[176:179], v[208:211]
    v_cvt_pk_bf16_f32 v146, v228, v229
    v_cvt_pk_bf16_f32 v147, v230, v231
    v_mfma_f32_16x16x32_bf16 v[196:199], v[108:111], v[174:177], v[196:199]
    v_cvt_pk_bf16_f32 v148, v232, v233
    v_cvt_pk_bf16_f32 v149, v234, v235
    v_mfma_f32_16x16x32_bf16 v[196:199], v[110:113], v[176:179], v[196:199]
    v_max3_f32 v248, v248, v200, v201
    v_max3_f32 v248, v248, v204, v205
    v_mfma_f32_16x16x32_bf16 v[236:239], a[232:235], a[72:75], 0
    ds_read_b128 v[200:203], v246 offset:0
    ds_read_b128 v[204:207], v244 offset:64
    v_mfma_f32_16x16x32_bf16 v[236:239], a[236:239], a[76:79], v[236:239]
    v_mov_b32 v225, v248
    v_mfma_f32_16x16x32_bf16 v[236:239], a[240:243], a[80:83], v[236:239]
    v_mfma_f32_16x16x32_bf16 v[236:239], a[244:247], a[84:87], v[236:239]
    v_permlane16_swap_b32 v248, v225
    v_max_f32 v248, v248, v225
    v_mfma_f32_16x16x32_bf16 v[236:239], a[216:219], a[88:91], v[236:239]
    v_mov_b32 v225, v248
    v_mfma_f32_16x16x32_bf16 v[236:239], a[220:223], a[92:95], v[236:239]
    v_mfma_f32_16x16x32_bf16 v[228:231], a[232:235], a[96:99], 0
    v_permlane32_swap_b32 v248, v225
    v_max_f32 v248, v248, v225
    v_mfma_f32_16x16x32_bf16 v[228:231], a[236:239], a[100:103], v[228:231]
    v_sub_f32 v208, v208, v248
    v_sub_f32 v209, v209, v248
    v_mfma_f32_16x16x32_bf16 v[228:231], a[240:243], a[104:107], v[228:231]
    v_exp_f32 v208, v208
    v_mfma_f32_16x16x32_bf16 v[228:231], a[244:247], a[108:111], v[228:231]
    s_waitcnt lgkmcnt(1)
    v_cvt_pk_bf16_f32 v25, v236, v237
    v_cvt_pk_bf16_f32 v28, v238, v239
    v_mfma_f32_16x16x32_bf16 v[200:203], v[132:135], v[174:177], v[200:203]
    s_waitcnt lgkmcnt(0)
    v_exp_f32 v209, v209
    v_mfma_f32_16x16x32_bf16 v[200:203], v[134:137], v[176:179], v[200:203]
    v_sub_f32 v210, v210, v248
    v_sub_f32 v211, v211, v248
    v_mfma_f32_16x16x32_bf16 v[204:207], v[150:153], v[174:177], v[204:207]
    v_exp_f32 v210, v210
    v_mfma_f32_16x16x32_bf16 v[204:207], v[152:155], v[176:179], v[204:207]
    v_exp_f32 v211, v211
    v_mfma_f32_16x16x32_bf16 v[228:231], a[216:219], a[112:115], v[228:231]
    v_cvt_pk_bf16_f32 v190, v208, v209
    v_cvt_pk_bf16_f32 v193, v210, v211
    v_mfma_f32_16x16x32_bf16 v[228:231], a[220:223], a[116:119], v[228:231]
    ds_read_b128 v[208:211], v245 offset:64
    v_sub_f32 v196, v196, v248
    v_mfma_f32_16x16x32_bf16 v[232:235], a[232:235], a[120:123], 0
    ds_read_b128 a[232:235], v242 offset:12416
    v_sub_f32 v197, v197, v248
    v_mfma_f32_16x16x32_bf16 v[232:235], a[236:239], a[124:127], v[232:235]
    ds_read_b128 a[236:239], v243 offset:12416
    v_sub_f32 v198, v198, v248
    v_mfma_f32_16x16x32_bf16 v[232:235], a[240:243], a[128:131], v[232:235]
    v_cvt_pk_bf16_f32 v55, v228, v229
    v_cvt_pk_bf16_f32 v58, v230, v231
    v_mfma_f32_16x16x32_bf16 v[232:235], a[244:247], a[132:135], v[232:235]
    ds_read_b128 a[240:243], v242 offset:12544
    ds_read_b128 a[244:247], v243 offset:12544
    v_mfma_f32_16x16x32_bf16 v[232:235], a[216:219], a[136:139], v[232:235]
    ds_read_b128 a[216:219], v242 offset:18432
    v_sub_f32 v199, v199, v248
    v_mfma_f32_16x16x32_bf16 v[232:235], a[220:223], a[140:143], v[232:235]
    ds_read_b128 a[220:223], v243 offset:18432
    v_sub_f32 v200, v200, v248
    v_mfma_f32_16x16x32_bf16 v[236:239], a[144:147], a[224:227], 0
    v_exp_f32 v196, v196
    v_mfma_f32_16x16x32_bf16 v[236:239], a[148:151], a[228:231], v[236:239]
    v_exp_f32 v197, v197
    v_mfma_f32_16x16x32_bf16 v[228:231], a[168:171], a[224:227], 0
    s_waitcnt lgkmcnt(6)
    v_cvt_pk_bf16_f32 v85, v232, v233
    v_cvt_pk_bf16_f32 v88, v234, v235
    v_mfma_f32_16x16x32_bf16 v[208:211], v[162:165], v[174:177], v[208:211]
    s_waitcnt lgkmcnt(5)
    v_exp_f32 v198, v198
    v_mfma_f32_16x16x32_bf16 v[208:211], v[164:167], v[176:179], v[208:211]
    v_exp_f32 v199, v199
    v_mfma_f32_16x16x32_bf16 v[236:239], a[152:155], a[232:235], v[236:239]
    s_waitcnt lgkmcnt(4)
    v_cvt_pk_bf16_f32 v188, v196, v197
    v_cvt_pk_bf16_f32 v191, v198, v199
    v_mfma_f32_16x16x32_bf16 v[236:239], a[156:159], a[236:239], v[236:239]
    ds_read_b128 v[196:199], v246 offset:64
    v_sub_f32 v201, v201, v248
    v_mfma_f32_16x16x32_bf16 v[228:231], a[172:175], a[228:231], v[228:231]
    s_waitcnt lgkmcnt(4)
    v_exp_f32 v200, v200
    v_mfma_f32_16x16x32_bf16 v[236:239], a[160:163], a[240:243], v[236:239]
    s_waitcnt lgkmcnt(3)
    v_exp_f32 v201, v201
    v_mfma_f32_16x16x32_bf16 v[236:239], a[164:167], a[244:247], v[236:239]
    v_sub_f32 v202, v202, v248
    v_sub_f32 v203, v203, v248
    v_mfma_f32_16x16x32_bf16 v[228:231], a[176:179], a[232:235], v[228:231]
    v_exp_f32 v202, v202
    v_mfma_f32_16x16x32_bf16 v[228:231], a[180:183], a[236:239], v[228:231]
    v_exp_f32 v203, v203
    v_mfma_f32_16x16x32_bf16 v[228:231], a[184:187], a[240:243], v[228:231]
    v_cvt_pk_bf16_f32 v189, v200, v201
    v_cvt_pk_bf16_f32 v236, v236, v237
    v_mfma_f32_16x16x32_bf16 v[228:231], a[188:191], a[244:247], v[228:231]
    v_cvt_pk_bf16_f32 v237, v238, v239
    v_cvt_pk_bf16_f32 v192, v202, v203
    v_mfma_f32_16x16x32_bf16 v[212:215], v[6:9], v[188:191], 0
    ds_write_b64 v249, v[236:237] offset:24576
    v_mfma_f32_16x16x32_bf16 v[216:219], v[36:39], v[188:191], 0
    ds_read_b128 v[200:203], v244 offset:128
    v_sub_f32 v204, v204, v248
    v_mfma_f32_16x16x32_bf16 v[220:223], v[66:69], v[188:191], 0
    s_waitcnt lgkmcnt(2)
    v_cvt_pk_bf16_f32 v228, v228, v229
    v_cvt_pk_bf16_f32 v229, v230, v231
    v_mfma_f32_16x16x32_bf16 v[224:227], a[248:251], v[188:191], 0
    ds_write_b64 v249, v[228:229] offset:24704
    v_mfma_f32_16x16x32_bf16 v[196:199], v[90:93], v[174:177], v[196:199]
    v_exp_f32 v204, v204
    v_mfma_f32_16x16x32_bf16 v[196:199], v[92:95], v[176:179], v[196:199]
    v_sub_f32 v205, v205, v248
    v_sub_f32 v206, v206, v248
    v_mfma_f32_16x16x32_bf16 v[232:235], a[192:195], a[224:227], 0
    ds_read_b128 a[224:227], v242 offset:18560
    v_sub_f32 v207, v207, v248
    v_mfma_f32_16x16x32_bf16 v[232:235], a[196:199], a[228:231], v[232:235]
    ds_read_b128 a[228:231], v243 offset:18560
    v_sub_f32 v208, v208, v248
    v_mfma_f32_16x16x32_bf16 v[232:235], a[200:203], a[232:235], v[232:235]
    ds_read_b128 a[232:235], v242 offset:18688
    v_sub_f32 v209, v209, v248
    v_mfma_f32_16x16x32_bf16 v[232:235], a[204:207], a[236:239], v[232:235]
    ds_read_b128 a[236:239], v243 offset:18688
    v_sub_f32 v210, v210, v248
    v_mfma_f32_16x16x32_bf16 v[232:235], a[208:211], a[240:243], v[232:235]
    ds_read_b128 a[240:243], v242 offset:0
    v_sub_f32 v211, v211, v248
    v_mfma_f32_16x16x32_bf16 v[232:235], a[212:215], a[244:247], v[232:235]
    ds_read_b128 a[244:247], v243 offset:0
    v_sub_f32 v196, v196, v248
    v_mfma_f32_16x16x32_bf16 v[236:239], a[144:147], a[216:219], 0
    s_waitcnt lgkmcnt(7)
    v_exp_f32 v205, v205
    v_mfma_f32_16x16x32_bf16 v[200:203], v[156:159], v[174:177], v[200:203]
    v_exp_f32 v206, v206
    v_mfma_f32_16x16x32_bf16 v[200:203], v[158:161], v[176:179], v[200:203]
    v_cvt_pk_bf16_f32 v232, v232, v233
    v_cvt_pk_bf16_f32 v233, v234, v235
    v_mfma_f32_16x16x32_bf16 v[236:239], a[148:151], a[220:223], v[236:239]
    ds_write_b64 v249, v[232:233] offset:24832
    v_mfma_f32_16x16x32_bf16 v[228:231], a[168:171], a[216:219], 0
    s_waitcnt lgkmcnt(6)
    v_exp_f32 v207, v207
    v_mfma_f32_16x16x32_bf16 v[236:239], a[152:155], a[224:227], v[236:239]
    s_waitcnt lgkmcnt(5)
    v_cvt_pk_bf16_f32 v180, v204, v205
    v_cvt_pk_bf16_f32 v183, v206, v207
    v_mfma_f32_16x16x32_bf16 v[236:239], a[156:159], a[228:231], v[236:239]
    ds_read_b128 v[204:207], v245 offset:128
    v_sub_f32 v197, v197, v248
    v_mfma_f32_16x16x32_bf16 v[228:231], a[172:175], a[220:223], v[228:231]
    s_waitcnt lgkmcnt(5)
    v_exp_f32 v208, v208
    v_mfma_f32_16x16x32_bf16 v[236:239], a[160:163], a[232:235], v[236:239]
    s_waitcnt lgkmcnt(4)
    v_exp_f32 v209, v209
    v_mfma_f32_16x16x32_bf16 v[236:239], a[164:167], a[236:239], v[236:239]
    v_exp_f32 v210, v210
    v_mfma_f32_16x16x32_bf16 v[228:231], a[176:179], a[224:227], v[228:231]
    v_exp_f32 v211, v211
    v_mfma_f32_16x16x32_bf16 v[228:231], a[180:183], a[228:231], v[228:231]
    s_waitcnt lgkmcnt(1)
    s_barrier
    v_cvt_pk_bf16_f32 v194, v208, v209
    v_mfma_f32_16x16x32_bf16 v[228:231], a[184:187], a[232:235], v[228:231]
    ds_read_b128 a[252:255], v252 offset:18432
    v_cvt_pk_bf16_f32 v236, v236, v237
    v_mfma_f32_16x16x32_bf16 v[228:231], a[188:191], a[236:239], v[228:231]
    ds_read_b64 v[254:255], v253 offset:18688
    v_cvt_pk_bf16_f32 v237, v238, v239
    v_mfma_f32_16x16x32_bf16 v[232:235], a[192:195], a[216:219], 0
    ds_write_b64 v249, v[236:237] offset:0
    v_mfma_f32_16x16x32_bf16 v[232:235], a[196:199], a[220:223], v[232:235]
    ds_read_b128 a[216:219], v242 offset:128
    ds_read_b128 a[220:223], v243 offset:128
    v_mfma_f32_16x16x32_bf16 v[232:235], a[200:203], a[224:227], v[232:235]
    ds_read_b128 a[224:227], v242 offset:256
    v_cvt_pk_bf16_f32 v228, v228, v229
    v_mfma_f32_16x16x32_bf16 v[232:235], a[204:207], a[228:231], v[232:235]
    ds_read_b128 a[228:231], v243 offset:256
    v_cvt_pk_bf16_f32 v229, v230, v231
    v_mfma_f32_16x16x32_bf16 v[232:235], a[208:211], a[232:235], v[232:235]
    ds_write_b64 v249, v[228:229] offset:128
    v_mfma_f32_16x16x32_bf16 v[232:235], a[212:215], a[236:239], v[232:235]
    ds_read_b128 a[232:235], v242 offset:24576
    ds_read_b128 a[236:239], v243 offset:24576
    v_mfma_f32_16x16x32_bf16 v[236:239], a[144:147], a[240:243], 0
    s_waitcnt lgkmcnt(9)
    v_cvt_pk_bf16_f32 v181, v210, v211
    s_waitcnt lgkmcnt(8)
    v_mfma_f32_16x16x32_bf16 v[204:207], v[114:117], v[174:177], v[204:207]
    ds_read_b128 v[208:211], v246 offset:128
    v_cvt_pk_bf16_f32 v232, v232, v233
    v_mfma_f32_16x16x32_bf16 v[204:207], v[116:119], v[176:179], v[204:207]
    v_cvt_pk_bf16_f32 v233, v234, v235
    v_sub_f32 v198, v198, v248
    v_mfma_f32_16x16x32_bf16 v[236:239], a[148:151], a[244:247], v[236:239]
    ds_write_b64 v249, v[232:233] offset:256
    v_mfma_f32_16x16x32_bf16 v[228:231], a[168:171], a[240:243], 0
    buffer_store_dwordx4 a[252:255], v250, s[20:23], s54 offen nt
    v_mfma_f32_16x16x32_bf16 v[228:231], a[172:175], a[244:247], v[228:231]
    s_waitcnt lgkmcnt(8)
    ds_read_b128 a[252:255], v252 offset:24576
    v_mfma_f32_16x16x32_bf16 v[236:239], a[152:155], a[216:219], v[236:239]
    s_waitcnt lgkmcnt(8)
    v_exp_f32 v196, v196
    v_mfma_f32_16x16x32_bf16 v[236:239], a[156:159], a[220:223], v[236:239]
    buffer_store_dwordx2 v[254:255], v251, s[20:23], s54 offen offset:256 nt
    v_mfma_f32_16x16x32_bf16 v[228:231], a[176:179], a[216:219], v[228:231]
    ds_read_b64 v[254:255], v253 offset:24832
    s_mul_i32 s54, s31, 15
    v_mfma_f32_16x16x32_bf16 v[228:231], a[180:183], a[220:223], v[228:231]
    s_add_u32 s53, s53, s54
    s_add_u32 s53, s53, s32
    s_add_u32 s54, s28, 11
    v_mfma_f32_16x16x32_bf16 v[232:235], a[192:195], a[240:243], 0
    ds_read_b128 a[240:243], v242 offset:24704
    s_mul_i32 s54, s54, s30
    v_mfma_f32_16x16x32_bf16 v[232:235], a[196:199], a[244:247], v[232:235]
    ds_read_b128 a[244:247], v243 offset:24704
    v_sub_f32 v199, v199, v248
    v_mfma_f32_16x16x32_bf16 v[232:235], a[200:203], a[216:219], v[232:235]
    ds_read_b128 a[216:219], v242 offset:24832
    v_sub_f32 v200, v200, v248
    v_mfma_f32_16x16x32_bf16 v[232:235], a[204:207], a[220:223], v[232:235]
    s_waitcnt lgkmcnt(6)
    ds_read_b128 a[220:223], v243 offset:24832
    v_mfma_f32_16x16x32_bf16 v[208:211], v[138:141], v[174:177], v[208:211]
    s_waitcnt lgkmcnt(5)
    ds_read_b64 v[174:175], v247 offset:43008
    v_mfma_f32_16x16x32_bf16 v[208:211], v[140:143], v[176:179], v[208:211]
    buffer_store_dwordx4 a[252:255], v250, s[20:23], s56 offen nt
    v_mfma_f32_16x16x32_bf16 v[236:239], a[160:163], a[224:227], v[236:239]
    s_waitcnt lgkmcnt(5)
    ds_read_b64 v[176:177], v247 offset:43136
    v_mfma_f32_16x16x32_bf16 v[236:239], a[164:167], a[228:231], v[236:239]
    ds_read_b64 v[178:179], v247 offset:43264
    v_sub_f32 v201, v201, v248
    v_mfma_f32_16x16x32_bf16 v[228:231], a[184:187], a[224:227], v[228:231]
    buffer_store_dwordx2 v[254:255], v251, s[20:23], s56 offen offset:256 nt
    v_mfma_f32_16x16x32_bf16 v[228:231], a[188:191], a[228:231], v[228:231]
    s_mul_i32 s56, s31, 13
    s_add_u32 s55, s55, s56
    s_add_u32 s55, s55, s32
    v_mfma_f32_16x16x32_bf16 v[232:235], a[208:211], a[224:227], v[232:235]
    s_add_u32 s56, s28, 11
    v_cvt_pk_bf16_f32 v236, v236, v237
    v_cvt_pk_bf16_f32 v237, v238, v239
    v_mfma_f32_16x16x32_bf16 v[232:235], a[212:215], a[228:231], v[232:235]
    ds_write_b64 v249, v[236:237] offset:6144
    v_cvt_pk_bf16_f32 v228, v228, v229
    v_cvt_pk_bf16_f32 v229, v230, v231
    ds_write_b64 v249, v[228:229] offset:6272
    s_mul_i32 s56, s56, s30
    v_exp_f32 v197, v197
    v_exp_f32 v198, v198
    v_exp_f32 v199, v199
    v_cvt_pk_bf16_f32 v232, v232, v233
    v_cvt_pk_bf16_f32 v233, v234, v235
    ds_write_b64 v249, v[232:233] offset:6400
    v_cvt_pk_bf16_f32 v195, v196, v197
    v_cvt_pk_bf16_f32 v182, v198, v199
    ds_read_b128 v[196:199], v244 offset:0
    v_mfma_f32_16x16x32_bf16 v[212:215], v[10:13], v[192:195], v[212:215]
    v_exp_f32 v200, v200
    v_mfma_f32_16x16x32_bf16 v[216:219], v[40:43], v[192:195], v[216:219]
    v_exp_f32 v201, v201
    v_mfma_f32_16x16x32_bf16 v[220:223], v[70:73], v[192:195], v[220:223]
    v_cvt_pk_bf16_f32 v186, v200, v201
    v_sub_f32 v204, v204, v248
    v_mfma_f32_16x16x32_bf16 v[224:227], a[248:251], v[192:195], v[224:227]
    ds_read_b128 v[200:203], v245 offset:0
    v_sub_f32 v205, v205, v248
    v_mfma_f32_16x16x32_bf16 v[212:215], v[14:17], v[180:183], v[212:215]
    v_exp_f32 v204, v204
    v_mfma_f32_16x16x32_bf16 v[216:219], v[44:47], v[180:183], v[216:219]
    v_exp_f32 v205, v205
    v_mfma_f32_16x16x32_bf16 v[220:223], v[74:77], v[180:183], v[220:223]
    v_cvt_pk_bf16_f32 v184, v204, v205
    v_sub_f32 v208, v208, v248
    v_mfma_f32_16x16x32_bf16 v[224:227], a[248:251], v[180:183], v[224:227]
    ds_read_b128 v[204:207], v246 offset:0
    s_waitcnt lgkmcnt(2)
    v_mfma_f32_16x16x32_bf16 v[196:199], v[150:153], v[168:171], v[196:199]
    v_exp_f32 v208, v208
    v_mfma_f32_16x16x32_bf16 v[196:199], v[152:155], v[170:173], v[196:199]
    v_sub_f32 v209, v209, v248
    v_exp_f32 v209, v209
    s_nop 0
    v_cvt_pk_bf16_f32 v185, v208, v209
    ds_read_b128 v[208:211], v244 offset:64
    s_waitcnt lgkmcnt(2)
    v_mfma_f32_16x16x32_bf16 v[212:215], v[18:21], v[184:187], v[212:215]
    v_mfma_f32_16x16x32_bf16 v[216:219], v[48:51], v[184:187], v[216:219]
    v_max_f32 v248, v196, v197
    v_max3_f32 v248, v248, v198, v199
    v_mfma_f32_16x16x32_bf16 v[220:223], v[78:81], v[184:187], v[220:223]
    ds_read_b128 v[196:199], v245 offset:64
    v_mfma_f32_16x16x32_bf16 v[224:227], a[248:251], v[184:187], v[224:227]
    v_mfma_f32_16x16x32_bf16 v[200:203], v[162:165], v[168:171], v[200:203]
    s_waitcnt lgkmcnt(2)
    v_mfma_f32_16x16x32_bf16 v[200:203], v[164:167], v[170:173], v[200:203]
    v_mfma_f32_16x16x32_bf16 v[204:207], v[90:93], v[168:171], v[204:207]
    v_mfma_f32_16x16x32_bf16 v[204:207], v[92:95], v[170:173], v[204:207]
    s_nop 2
    s_waitcnt lgkmcnt(1)
    v_mfma_f32_16x16x32_bf16 v[208:211], v[156:159], v[168:171], v[208:211]
    v_rcp_f32 v225, v224
    v_mfma_f32_16x16x32_bf16 v[208:211], v[158:161], v[170:173], v[208:211]
    v_mul_f32 v212, v212, v225
    v_mul_f32 v213, v213, v225
    v_mul_f32 v214, v214, v225
    s_waitcnt lgkmcnt(0)
    v_mfma_f32_16x16x32_bf16 v[196:199], v[114:117], v[168:171], v[196:199]
    v_mul_f32 v215, v215, v225
    v_cvt_pk_bf16_f32 v212, v212, v213
    v_mfma_f32_16x16x32_bf16 v[196:199], v[116:119], v[170:173], v[196:199]
    v_cvt_pk_bf16_f32 v213, v214, v215
    ds_write_b64 v247, v[212:213] offset:30720
    v_mul_f32 v216, v216, v225
    v_mul_f32 v217, v217, v225
    v_mul_f32 v218, v218, v225
    v_mul_f32 v219, v219, v225
    v_cvt_pk_bf16_f32 v216, v216, v217
    v_cvt_pk_bf16_f32 v217, v218, v219
    ds_write_b64 v247, v[216:217] offset:30848
    v_mul_f32 v220, v220, v225
    v_mul_f32 v221, v221, v225
    v_mul_f32 v222, v222, v225
    v_mul_f32 v223, v223, v225
    v_cvt_pk_bf16_f32 v220, v220, v221
    v_cvt_pk_bf16_f32 v221, v222, v223
    ds_write_b64 v247, v[220:221] offset:30976
    v_max3_f32 v248, v248, v200, v201
    v_max3_f32 v248, v248, v202, v203
    ds_read_b128 v[200:203], v246 offset:64
    v_max3_f32 v248, v248, v204, v205
    v_max3_f32 v248, v248, v206, v207
    ds_read_b128 v[204:207], v244 offset:128
    v_max3_f32 v248, v248, v208, v209
    v_max3_f32 v248, v248, v210, v211
    ds_read_b128 v[208:211], v245 offset:128
    v_max3_f32 v248, v248, v196, v197
    v_max3_f32 v248, v248, v198, v199
    ds_read_b128 v[196:199], v246 offset:128
    s_waitcnt lgkmcnt(3)
    v_mfma_f32_16x16x32_bf16 v[200:203], v[138:141], v[168:171], v[200:203]
    v_mfma_f32_16x16x32_bf16 v[200:203], v[140:143], v[170:173], v[200:203]
    s_waitcnt lgkmcnt(2)
    v_mfma_f32_16x16x32_bf16 v[204:207], v[96:99], v[168:171], v[204:207]
    s_waitcnt lgkmcnt(1)
    v_mfma_f32_16x16x32_bf16 v[204:207], v[98:101], v[170:173], v[204:207]
    v_mfma_f32_16x16x32_bf16 v[208:211], v[120:123], v[168:171], v[208:211]
    s_waitcnt lgkmcnt(0)
    v_mfma_f32_16x16x32_bf16 v[208:211], v[122:125], v[170:173], v[208:211]
    v_mfma_f32_16x16x32_bf16 v[196:199], v[144:147], v[168:171], v[196:199]
    v_max3_f32 v248, v248, v200, v201
    v_max3_f32 v248, v248, v202, v203
    v_mfma_f32_16x16x32_bf16 v[196:199], v[146:149], v[170:173], v[196:199]
    ds_read_b128 v[200:203], v244 offset:0
    v_max3_f32 v248, v248, v204, v205
    ds_read_b128 v[204:207], v245 offset:0
    s_nop 0
    v_max3_f32 v248, v248, v208, v209
    ds_read_b128 v[208:211], v246 offset:0
    s_nop 1
    v_max3_f32 v248, v248, v196, v197
    ds_read_b128 v[196:199], v244 offset:64
    v_mov_b32 v225, v248
    s_nop 1
    v_permlane16_swap_b32 v248, v225
    v_max_f32 v248, v248, v225
    v_mov_b32 v225, v248
    s_nop 1
    v_permlane32_swap_b32 v248, v225
    v_max_f32 v248, v248, v225
    s_waitcnt lgkmcnt(3)
    v_mfma_f32_16x16x32_bf16 v[200:203], v[150:153], v[168:171], v[200:203]
    v_mfma_f32_16x16x32_bf16 v[200:203], v[152:155], v[170:173], v[200:203]
    s_waitcnt lgkmcnt(2)
    v_mfma_f32_16x16x32_bf16 v[204:207], v[162:165], v[168:171], v[204:207]
    s_waitcnt lgkmcnt(1)
    v_mfma_f32_16x16x32_bf16 v[204:207], v[164:167], v[170:173], v[204:207]
    v_mfma_f32_16x16x32_bf16 v[208:211], v[90:93], v[168:171], v[208:211]
    s_waitcnt lgkmcnt(0)
    v_mfma_f32_16x16x32_bf16 v[208:211], v[92:95], v[170:173], v[208:211]
    v_mfma_f32_16x16x32_bf16 v[196:199], v[156:159], v[168:171], v[196:199]
    v_sub_f32 v200, v200, v248
    v_sub_f32 v201, v201, v248
    v_mfma_f32_16x16x32_bf16 v[196:199], v[158:161], v[170:173], v[196:199]
    v_exp_f32 v200, v200
    v_exp_f32 v201, v201
    v_sub_f32 v202, v202, v248
    v_exp_f32 v202, v202
    v_sub_f32 v203, v203, v248
    v_exp_f32 v203, v203
    v_cvt_pk_bf16_f32 v190, v200, v201
    v_cvt_pk_bf16_f32 v193, v202, v203
    ds_read_b128 v[200:203], v245 offset:64
    v_sub_f32 v204, v204, v248
    v_exp_f32 v204, v204
    v_sub_f32 v205, v205, v248
    v_exp_f32 v205, v205
    v_sub_f32 v206, v206, v248
    v_exp_f32 v206, v206
    v_sub_f32 v207, v207, v248
    v_exp_f32 v207, v207
    v_cvt_pk_bf16_f32 v188, v204, v205
    v_cvt_pk_bf16_f32 v191, v206, v207
    ds_read_b128 v[204:207], v246 offset:64
    v_sub_f32 v208, v208, v248
    v_exp_f32 v208, v208
    v_sub_f32 v209, v209, v248
    v_exp_f32 v209, v209
    v_sub_f32 v210, v210, v248
    v_exp_f32 v210, v210
    v_sub_f32 v211, v211, v248
    v_exp_f32 v211, v211
    v_cvt_pk_bf16_f32 v189, v208, v209
    v_cvt_pk_bf16_f32 v192, v210, v211
    s_waitcnt lgkmcnt(1)
    v_mfma_f32_16x16x32_bf16 v[212:215], v[12:15], v[188:191], 0
    ds_read_b128 v[208:211], v244 offset:128
    v_sub_f32 v196, v196, v248
    v_mfma_f32_16x16x32_bf16 v[216:219], v[42:45], v[188:191], 0
    v_exp_f32 v196, v196
    v_mfma_f32_16x16x32_bf16 v[220:223], v[72:75], v[188:191], 0
    v_sub_f32 v197, v197, v248
    v_sub_f32 v198, v198, v248
    v_mfma_f32_16x16x32_bf16 v[224:227], a[248:251], v[188:191], 0
    v_exp_f32 v197, v197
    v_mfma_f32_16x16x32_bf16 v[200:203], v[114:117], v[168:171], v[200:203]
    s_waitcnt lgkmcnt(1)
    v_exp_f32 v198, v198
    v_mfma_f32_16x16x32_bf16 v[200:203], v[116:119], v[170:173], v[200:203]
    v_sub_f32 v199, v199, v248
    v_cvt_pk_bf16_f32 v180, v196, v197
    v_mfma_f32_16x16x32_bf16 v[204:207], v[138:141], v[168:171], v[204:207]
    v_exp_f32 v199, v199
    v_mfma_f32_16x16x32_bf16 v[204:207], v[140:143], v[170:173], v[204:207]
    v_cvt_pk_bf16_f32 v183, v198, v199
    ds_read_b128 v[196:199], v245 offset:128
    s_waitcnt lgkmcnt(1)
    v_mfma_f32_16x16x32_bf16 v[208:211], v[96:99], v[168:171], v[208:211]
    v_sub_f32 v200, v200, v248
    v_sub_f32 v201, v201, v248
    v_mfma_f32_16x16x32_bf16 v[208:211], v[98:101], v[170:173], v[208:211]
    v_exp_f32 v200, v200
    v_exp_f32 v201, v201
    v_sub_f32 v202, v202, v248
    v_exp_f32 v202, v202
    v_sub_f32 v203, v203, v248
    v_exp_f32 v203, v203
    v_cvt_pk_bf16_f32 v194, v200, v201
    v_cvt_pk_bf16_f32 v181, v202, v203
    ds_read_b128 v[200:203], v246 offset:128
    v_sub_f32 v204, v204, v248
    v_exp_f32 v204, v204
    v_sub_f32 v205, v205, v248
    v_exp_f32 v205, v205
    v_sub_f32 v206, v206, v248
    v_exp_f32 v206, v206
    s_waitcnt lgkmcnt(1)
    v_mfma_f32_16x16x32_bf16 v[196:199], v[120:123], v[168:171], v[196:199]
    v_sub_f32 v207, v207, v248
    v_cvt_pk_bf16_f32 v195, v204, v205
    v_mfma_f32_16x16x32_bf16 v[196:199], v[122:125], v[170:173], v[196:199]
    v_exp_f32 v207, v207
    v_mfma_f32_16x16x32_bf16 v[212:215], v[16:19], v[192:195], v[212:215]
    v_cvt_pk_bf16_f32 v182, v206, v207
    v_sub_f32 v208, v208, v248
    v_mfma_f32_16x16x32_bf16 v[216:219], v[46:49], v[192:195], v[216:219]
    ds_read_b128 v[204:207], v244 offset:0
    v_sub_f32 v209, v209, v248
    v_mfma_f32_16x16x32_bf16 v[220:223], v[76:79], v[192:195], v[220:223]
    v_exp_f32 v208, v208
    v_mfma_f32_16x16x32_bf16 v[224:227], a[248:251], v[192:195], v[224:227]
    s_waitcnt lgkmcnt(1)
    v_exp_f32 v209, v209
    v_mfma_f32_16x16x32_bf16 v[212:215], v[20:23], v[180:183], v[212:215]
    v_cvt_pk_bf16_f32 v186, v208, v209
    v_sub_f32 v196, v196, v248
    v_mfma_f32_16x16x32_bf16 v[216:219], v[50:53], v[180:183], v[216:219]
    ds_read_b128 v[208:211], v245 offset:0
    v_sub_f32 v197, v197, v248
    v_mfma_f32_16x16x32_bf16 v[220:223], v[80:83], v[180:183], v[220:223]
    v_exp_f32 v196, v196
    v_mfma_f32_16x16x32_bf16 v[224:227], a[248:251], v[180:183], v[224:227]
    v_exp_f32 v197, v197
    v_mfma_f32_16x16x32_bf16 v[200:203], v[144:147], v[168:171], v[200:203]
    ds_read_b64 v[168:169], v247 offset:49152
    v_cvt_pk_bf16_f32 v184, v196, v197
    v_mfma_f32_16x16x32_bf16 v[200:203], v[146:149], v[170:173], v[200:203]
    ds_read_b128 v[196:199], v246 offset:0
    s_waitcnt lgkmcnt(3)
    v_mfma_f32_16x16x32_bf16 v[204:207], v[156:159], v[174:177], v[204:207]
    ds_read_b64 v[170:171], v247 offset:49280
    ds_read_b64 v[172:173], v247 offset:49408
    v_mfma_f32_16x16x32_bf16 v[204:207], v[158:161], v[176:179], v[204:207]
    s_nop 1
    v_sub_f32 v200, v200, v248
    v_exp_f32 v200, v200
    v_sub_f32 v201, v201, v248
    v_exp_f32 v201, v201
    s_nop 0
    s_waitcnt lgkmcnt(4)
    v_mfma_f32_16x16x32_bf16 v[208:211], v[114:117], v[174:177], v[208:211]
    v_cvt_pk_bf16_f32 v185, v200, v201
    v_max_f32 v248, v204, v205
    v_mfma_f32_16x16x32_bf16 v[208:211], v[116:119], v[176:179], v[208:211]
    ds_read_b128 v[200:203], v244 offset:64
    v_max3_f32 v248, v248, v206, v207
    v_mfma_f32_16x16x32_bf16 v[212:215], v[24:27], v[184:187], v[212:215]
    ds_read_b128 v[204:207], v245 offset:64
    v_mfma_f32_16x16x32_bf16 v[216:219], v[54:57], v[184:187], v[216:219]
    v_mfma_f32_16x16x32_bf16 v[220:223], v[84:87], v[184:187], v[220:223]
    s_waitcnt lgkmcnt(4)
    v_mfma_f32_16x16x32_bf16 v[224:227], a[248:251], v[184:187], v[224:227]
    v_max3_f32 v248, v248, v208, v209
    v_max3_f32 v248, v248, v210, v211
    v_mfma_f32_16x16x32_bf16 v[196:199], v[138:141], v[174:177], v[196:199]
    ds_read_b128 v[208:211], v246 offset:64
    v_mov_b32 v186, 0
    v_mfma_f32_16x16x32_bf16 v[196:199], v[140:143], v[176:179], v[196:199]
    s_nop 1
    v_rcp_f32 v225, v224
    s_nop 0
    v_mul_f32 v212, v212, v225
    v_mul_f32 v213, v213, v225
    v_mul_f32 v214, v214, v225
    v_mul_f32 v215, v215, v225
    s_waitcnt lgkmcnt(2)
    v_mfma_f32_16x16x32_bf16 v[200:203], v[96:99], v[174:177], v[200:203]
    v_cvt_pk_bf16_f32 v212, v212, v213
    v_cvt_pk_bf16_f32 v213, v214, v215
    v_mfma_f32_16x16x32_bf16 v[200:203], v[98:101], v[176:179], v[200:203]
    s_waitcnt lgkmcnt(1)
    v_mul_f32 v216, v216, v225
    v_mul_f32 v217, v217, v225
    v_mfma_f32_16x16x32_bf16 v[204:207], v[120:123], v[174:177], v[204:207]
    ds_write_b64 v247, v[212:213] offset:36864
    v_mfma_f32_16x16x32_bf16 v[204:207], v[122:125], v[176:179], v[204:207]
    v_mul_f32 v218, v218, v225
    v_mul_f32 v219, v219, v225
    v_cvt_pk_bf16_f32 v216, v216, v217
    v_cvt_pk_bf16_f32 v217, v218, v219
    s_waitcnt lgkmcnt(1)
    v_mfma_f32_16x16x32_bf16 v[208:211], v[144:147], v[174:177], v[208:211]
    ds_write_b64 v247, v[216:217] offset:36992
    v_mfma_f32_16x16x32_bf16 v[208:211], v[146:149], v[176:179], v[208:211]
    v_mul_f32 v220, v220, v225
    v_mul_f32 v221, v221, v225
    v_mul_f32 v222, v222, v225
    v_mul_f32 v223, v223, v225
    v_cvt_pk_bf16_f32 v220, v220, v221
    v_cvt_pk_bf16_f32 v221, v222, v223
    ds_write_b64 v247, v[220:221] offset:37120
    v_max3_f32 v248, v248, v196, v197
    v_max3_f32 v248, v248, v198, v199
    ds_read_b128 v[196:199], v244 offset:0
    v_max3_f32 v248, v248, v200, v201
    v_max3_f32 v248, v248, v202, v203
    ds_read_b128 v[200:203], v245 offset:0
    v_max3_f32 v248, v248, v204, v205
    v_max3_f32 v248, v248, v206, v207
    ds_read_b128 v[204:207], v246 offset:0
    v_max3_f32 v248, v248, v208, v209
    v_max3_f32 v248, v248, v210, v211
    ds_read_b128 v[208:211], v244 offset:64
    v_mov_b32 v225, v248
    s_nop 1
    v_permlane16_swap_b32 v248, v225
    v_max_f32 v248, v248, v225
    v_mov_b32 v225, v248
    s_nop 1
    v_permlane32_swap_b32 v248, v225
    v_max_f32 v248, v248, v225
    s_waitcnt lgkmcnt(3)
    v_mfma_f32_16x16x32_bf16 v[196:199], v[156:159], v[174:177], v[196:199]
    v_mfma_f32_16x16x32_bf16 v[196:199], v[158:161], v[176:179], v[196:199]
    s_waitcnt lgkmcnt(2)
    v_mfma_f32_16x16x32_bf16 v[200:203], v[114:117], v[174:177], v[200:203]
    s_waitcnt lgkmcnt(1)
    v_mfma_f32_16x16x32_bf16 v[200:203], v[116:119], v[176:179], v[200:203]
    v_mfma_f32_16x16x32_bf16 v[204:207], v[138:141], v[174:177], v[204:207]
    s_waitcnt lgkmcnt(0)
    v_mfma_f32_16x16x32_bf16 v[204:207], v[140:143], v[176:179], v[204:207]
    v_mfma_f32_16x16x32_bf16 v[208:211], v[96:99], v[174:177], v[208:211]
    v_sub_f32 v196, v196, v248
    v_sub_f32 v197, v197, v248
    v_mfma_f32_16x16x32_bf16 v[208:211], v[98:101], v[176:179], v[208:211]
    v_exp_f32 v196, v196
    v_exp_f32 v197, v197
    v_sub_f32 v198, v198, v248
    v_exp_f32 v198, v198
    v_sub_f32 v199, v199, v248
    v_exp_f32 v199, v199
    v_cvt_pk_bf16_f32 v190, v196, v197
    v_cvt_pk_bf16_f32 v193, v198, v199
    ds_read_b128 v[196:199], v245 offset:64
    v_sub_f32 v200, v200, v248
    v_exp_f32 v200, v200
    v_sub_f32 v201, v201, v248
    v_exp_f32 v201, v201
    v_sub_f32 v202, v202, v248
    v_exp_f32 v202, v202
    v_sub_f32 v203, v203, v248
    v_exp_f32 v203, v203
    v_cvt_pk_bf16_f32 v188, v200, v201
    v_cvt_pk_bf16_f32 v191, v202, v203
    ds_read_b128 v[200:203], v246 offset:64
    v_sub_f32 v204, v204, v248
    v_exp_f32 v204, v204
    v_sub_f32 v205, v205, v248
    v_exp_f32 v205, v205
    v_sub_f32 v206, v206, v248
    v_exp_f32 v206, v206
    v_sub_f32 v207, v207, v248
    v_exp_f32 v207, v207
    v_cvt_pk_bf16_f32 v189, v204, v205
    v_cvt_pk_bf16_f32 v192, v206, v207
    s_waitcnt lgkmcnt(1)
    v_mfma_f32_16x16x32_bf16 v[212:215], v[18:21], v[188:191], 0
    v_sub_f32 v208, v208, v248
    v_sub_f32 v209, v209, v248
    v_mfma_f32_16x16x32_bf16 v[216:219], v[48:51], v[188:191], 0
    v_exp_f32 v208, v208
    v_mfma_f32_16x16x32_bf16 v[220:223], v[78:81], v[188:191], 0
    v_exp_f32 v209, v209
    v_mfma_f32_16x16x32_bf16 v[224:227], a[248:251], v[188:191], 0
    v_sub_f32 v210, v210, v248
    v_sub_f32 v211, v211, v248
    v_mfma_f32_16x16x32_bf16 v[196:199], v[120:123], v[174:177], v[196:199]
    s_waitcnt lgkmcnt(0)
    v_exp_f32 v210, v210
    v_mfma_f32_16x16x32_bf16 v[196:199], v[122:125], v[176:179], v[196:199]
    v_exp_f32 v211, v211
    v_mfma_f32_16x16x32_bf16 v[200:203], v[144:147], v[174:177], v[200:203]
    ds_read_b64 v[174:175], v247 offset:55296
    v_cvt_pk_bf16_f32 v180, v208, v209
    v_mfma_f32_16x16x32_bf16 v[200:203], v[146:149], v[176:179], v[200:203]
    ds_read_b64 v[176:177], v247 offset:55424
    ds_read_b64 v[178:179], v247 offset:55552
    v_cvt_pk_bf16_f32 v183, v210, v211
    v_sub_f32 v196, v196, v248
    v_exp_f32 v196, v196
    v_sub_f32 v197, v197, v248
    v_exp_f32 v197, v197
    v_sub_f32 v198, v198, v248
    v_exp_f32 v198, v198
    v_sub_f32 v199, v199, v248
    v_exp_f32 v199, v199
    v_cvt_pk_bf16_f32 v194, v196, v197
    v_cvt_pk_bf16_f32 v181, v198, v199
    v_sub_f32 v200, v200, v248
    v_exp_f32 v200, v200
    v_sub_f32 v201, v201, v248
    v_exp_f32 v201, v201
    v_sub_f32 v202, v202, v248
    v_exp_f32 v202, v202
    v_sub_f32 v203, v203, v248
    v_exp_f32 v203, v203
    v_cvt_pk_bf16_f32 v195, v200, v201
    v_cvt_pk_bf16_f32 v182, v202, v203
    v_mov_b32 v204, 0x237c0
    v_mfma_f32_16x16x32_bf16 v[212:215], v[22:25], v[192:195], v[212:215]
    v_add_u32 v205, 0xfffff900, v245
    v_cndmask_b32 v205, v244, v205, vcc
    v_mfma_f32_16x16x32_bf16 v[216:219], v[52:55], v[192:195], v[216:219]
    s_mov_b32 vcc_lo, 0xff00ff00
    v_add_u32 v206, 0xc0, v205
    v_add_u32 v205, 0x340, v205
    v_mfma_f32_16x16x32_bf16 v[220:223], v[82:85], v[192:195], v[220:223]
    s_mov_b32 vcc_hi, 0xff00ff00
    v_cndmask_b32 v244, v206, v205, vcc
    v_add_u32 v245, 0x700, v244
    v_mfma_f32_16x16x32_bf16 v[224:227], a[248:251], v[192:195], v[224:227]
    s_mov_b32 vcc_lo, 0xf0f0
    s_mov_b32 vcc_hi, 0x0
    v_cndmask_b32 v244, v244, v204, vcc
    v_mfma_f32_16x16x32_bf16 v[212:215], v[26:29], v[180:183], v[212:215]
    ds_read_b128 v[196:199], v244 offset:64
    s_mov_b32 vcc_lo, 0x0
    v_mfma_f32_16x16x32_bf16 v[216:219], v[56:59], v[180:183], v[216:219]
    s_mov_b32 vcc_hi, 0xf0f0000
    v_cndmask_b32 v245, v245, v204, vcc
    v_mov_b32 v189, 0
    v_mfma_f32_16x16x32_bf16 v[220:223], v[86:89], v[180:183], v[220:223]
    ds_read_b128 v[204:207], v244 offset:0
    ds_read_b128 v[208:211], v245 offset:0
    v_mfma_f32_16x16x32_bf16 v[224:227], a[248:251], v[180:183], v[224:227]
    ds_read_b128 v[200:203], v245 offset:64
    v_mov_b32 v192, 0
    v_mov_b32 v195, 0
    v_mov_b32 v182, 0
    s_mov_b32 vcc_lo, 0xff000f
    s_mov_b32 vcc_hi, 0xff00ff
    s_nop 1
    v_rcp_f32 v225, v224
    s_nop 0
    v_mul_f32 v212, v212, v225
    v_mul_f32 v213, v213, v225
    v_mul_f32 v214, v214, v225
    v_mul_f32 v215, v215, v225
    v_cvt_pk_bf16_f32 v212, v212, v213
    v_cvt_pk_bf16_f32 v213, v214, v215
    ds_write_b64 v247, v[212:213] offset:43008
    s_waitcnt lgkmcnt(4)
    v_mfma_f32_16x16x32_bf16 v[196:199], v[108:111], v[168:171], v[196:199]
    v_mul_f32 v216, v216, v225
    v_mul_f32 v217, v217, v225
    v_mfma_f32_16x16x32_bf16 v[196:199], v[110:113], v[170:173], v[196:199]
    s_waitcnt lgkmcnt(3)
    v_mul_f32 v218, v218, v225
    v_mul_f32 v219, v219, v225
    v_mfma_f32_16x16x32_bf16 v[204:207], v[102:105], v[168:171], v[204:207]
    s_waitcnt lgkmcnt(2)
    v_cvt_pk_bf16_f32 v216, v216, v217
    v_cvt_pk_bf16_f32 v217, v218, v219
    v_mfma_f32_16x16x32_bf16 v[204:207], v[104:107], v[170:173], v[204:207]
    ds_write_b64 v247, v[216:217] offset:43136
    v_mfma_f32_16x16x32_bf16 v[208:211], v[126:129], v[168:171], v[208:211]
    s_waitcnt lgkmcnt(2)
    v_mul_f32 v220, v220, v225
    v_mul_f32 v221, v221, v225
    v_mfma_f32_16x16x32_bf16 v[208:211], v[128:131], v[170:173], v[208:211]
    v_mul_f32 v222, v222, v225
    v_mul_f32 v223, v223, v225
    v_mfma_f32_16x16x32_bf16 v[200:203], v[132:135], v[168:171], v[200:203]
    v_cvt_pk_bf16_f32 v220, v220, v221
    v_cvt_pk_bf16_f32 v221, v222, v223
    v_mfma_f32_16x16x32_bf16 v[200:203], v[134:137], v[170:173], v[200:203]
    ds_write_b64 v247, v[220:221] offset:43264
    v_mfma_f32_16x16x32_bf16 v[236:239], a[144:147], a[232:235], 0
    v_max_f32 v248, v204, v205
    v_max3_f32 v248, v248, v206, v207
    v_mfma_f32_16x16x32_bf16 v[236:239], a[148:151], a[236:239], v[236:239]
    ds_read_b128 v[204:207], v244 offset:128
    v_max3_f32 v248, v248, v208, v209
    v_mfma_f32_16x16x32_bf16 v[236:239], a[152:155], a[240:243], v[236:239]
    v_max3_f32 v248, v248, v210, v211
    v_max3_f32 v248, v248, v196, v197
    v_mfma_f32_16x16x32_bf16 v[236:239], a[156:159], a[244:247], v[236:239]
    ds_read_b128 v[208:211], v245 offset:128
    v_max3_f32 v248, v248, v198, v199
    v_mfma_f32_16x16x32_bf16 v[236:239], a[160:163], a[216:219], v[236:239]
    ds_read_b128 v[196:199], v244 offset:192
    v_max3_f32 v248, v248, v200, v201
    v_mfma_f32_16x16x32_bf16 v[236:239], a[164:167], a[220:223], v[236:239]
    v_max3_f32 v248, v248, v202, v203
    v_mfma_f32_16x16x32_bf16 v[228:231], a[168:171], a[232:235], 0
    ds_read_b128 v[200:203], v245 offset:192
    v_mfma_f32_16x16x32_bf16 v[228:231], a[172:175], a[236:239], v[228:231]
    v_mfma_f32_16x16x32_bf16 v[228:231], a[176:179], a[240:243], v[228:231]
    v_mfma_f32_16x16x32_bf16 v[228:231], a[180:183], a[244:247], v[228:231]
    v_mfma_f32_16x16x32_bf16 v[228:231], a[184:187], a[216:219], v[228:231]
    s_waitcnt lgkmcnt(3)
    v_cvt_pk_bf16_f32 v236, v236, v237
    v_cvt_pk_bf16_f32 v237, v238, v239
    v_mfma_f32_16x16x32_bf16 v[204:207], v[162:165], v[168:171], v[204:207]
    ds_write_b64 v249, v[236:237] offset:12288
    v_mfma_f32_16x16x32_bf16 v[204:207], v[164:167], v[170:173], v[204:207]
    s_waitcnt lgkmcnt(2)
    v_mfma_f32_16x16x32_bf16 v[208:211], v[90:93], v[168:171], v[208:211]
    v_mfma_f32_16x16x32_bf16 v[208:211], v[92:95], v[170:173], v[208:211]
    s_waitcnt lgkmcnt(1)
    v_mfma_f32_16x16x32_bf16 v[196:199], v[114:117], v[168:171], v[196:199]
    v_mfma_f32_16x16x32_bf16 v[196:199], v[116:119], v[170:173], v[196:199]
    v_mfma_f32_16x16x32_bf16 v[200:203], v[138:141], v[168:171], v[200:203]
    v_mfma_f32_16x16x32_bf16 v[200:203], v[140:143], v[170:173], v[200:203]
    v_max3_f32 v248, v248, v204, v205
    v_max3_f32 v248, v248, v206, v207
    v_mfma_f32_16x16x32_bf16 v[228:231], a[188:191], a[220:223], v[228:231]
    ds_read_b128 v[204:207], v244 offset:0
    v_max3_f32 v248, v248, v208, v209
    v_mfma_f32_16x16x32_bf16 v[232:235], a[192:195], a[232:235], 0
    v_max3_f32 v248, v248, v210, v211
    v_max3_f32 v248, v248, v196, v197
    v_mfma_f32_16x16x32_bf16 v[232:235], a[196:199], a[236:239], v[232:235]
    ds_read_b128 v[208:211], v245 offset:0
    ds_read_b128 v[196:199], v244 offset:64
    v_mfma_f32_16x16x32_bf16 v[232:235], a[200:203], a[240:243], v[232:235]
    v_cvt_pk_bf16_f32 v228, v228, v229
    v_cvt_pk_bf16_f32 v229, v230, v231
    v_mfma_f32_16x16x32_bf16 v[232:235], a[204:207], a[244:247], v[232:235]
    ds_write_b64 v249, v[228:229] offset:12416
    v_mfma_f32_16x16x32_bf16 v[232:235], a[208:211], a[216:219], v[232:235]
    v_max3_f32 v248, v248, v200, v201
    v_mov_b32 v225, v248
    v_mfma_f32_16x16x32_bf16 v[232:235], a[212:215], a[220:223], v[232:235]
    ds_read_b128 v[200:203], v245 offset:64
    v_permlane16_swap_b32 v248, v225
    v_max_f32 v248, v248, v225
    v_mov_b32 v225, v248
    s_nop 1
    v_permlane32_swap_b32 v248, v225
    s_waitcnt lgkmcnt(4)
    v_mfma_f32_16x16x32_bf16 v[204:207], v[102:105], v[168:171], v[204:207]
    v_cvt_pk_bf16_f32 v232, v232, v233
    v_cvt_pk_bf16_f32 v233, v234, v235
    v_mfma_f32_16x16x32_bf16 v[204:207], v[104:107], v[170:173], v[204:207]
    ds_write_b64 v249, v[232:233] offset:12544
    s_waitcnt lgkmcnt(4)
    v_mfma_f32_16x16x32_bf16 v[208:211], v[126:129], v[168:171], v[208:211]
    s_waitcnt lgkmcnt(3)
    v_max_f32 v248, v248, v225
    v_mfma_f32_16x16x32_bf16 v[208:211], v[128:131], v[170:173], v[208:211]
    v_mfma_f32_16x16x32_bf16 v[196:199], v[108:111], v[168:171], v[196:199]
    v_mfma_f32_16x16x32_bf16 v[196:199], v[110:113], v[170:173], v[196:199]
    v_sub_f32 v204, v204, v248
    s_waitcnt lgkmcnt(1)
    v_mfma_f32_16x16x32_bf16 v[200:203], v[132:135], v[168:171], v[200:203]
    v_exp_f32 v204, v204
    v_mfma_f32_16x16x32_bf16 v[200:203], v[134:137], v[170:173], v[200:203]
    v_sub_f32 v205, v205, v248
    v_exp_f32 v205, v205
    v_sub_f32 v206, v206, v248
    v_exp_f32 v206, v206
    s_waitcnt lgkmcnt(0)
    s_barrier
    ds_read_b128 a[224:227], v242 offset:30720
    ds_read_b128 a[228:231], v243 offset:30720
    ds_read_b128 a[232:235], v242 offset:30848
    ds_read_b128 a[236:239], v243 offset:30848
    ds_read_b128 a[240:243], v242 offset:30976
    ds_read_b128 a[244:247], v243 offset:30976
    ds_read_b128 a[216:219], v242 offset:36864
    ds_read_b128 a[220:223], v243 offset:36864
    ds_read_b128 a[252:255], v252 offset:0
    ds_read_b64 v[254:255], v253 offset:256
    v_sub_f32 v207, v207, v248
    v_exp_f32 v207, v207
    v_cvt_pk_bf16_f32 v184, v204, v205
    v_cvt_pk_bf16_f32 v187, v206, v207
    ds_read_b128 v[204:207], v244 offset:128
    v_sub_f32 v208, v208, v248
    v_exp_f32 v208, v208
    v_sub_f32 v209, v209, v248
    v_exp_f32 v209, v209
    v_sub_f32 v210, v210, v248
    v_exp_f32 v210, v210
    v_sub_f32 v211, v211, v248
    v_exp_f32 v211, v211
    s_waitcnt lgkmcnt(10)
    v_mfma_f32_16x16x32_bf16 v[236:239], a[144:147], a[224:227], 0
    v_cvt_pk_bf16_f32 v185, v208, v209
    v_cvt_pk_bf16_f32 v188, v210, v211
    v_mfma_f32_16x16x32_bf16 v[228:231], a[168:171], a[224:227], 0
    ds_read_b128 v[208:211], v245 offset:128
    v_sub_f32 v196, v196, v248
    v_mfma_f32_16x16x32_bf16 v[212:215], v[0:3], v[184:187], 0
    s_waitcnt lgkmcnt(10)
    v_exp_f32 v196, v196
    v_mfma_f32_16x16x32_bf16 v[216:219], v[30:33], v[184:187], 0
    v_sub_f32 v197, v197, v248
    v_sub_f32 v198, v198, v248
    v_mfma_f32_16x16x32_bf16 v[220:223], v[60:63], v[184:187], 0
    v_exp_f32 v197, v197
    v_mfma_f32_16x16x32_bf16 v[224:227], a[248:251], v[184:187], 0
    v_exp_f32 v198, v198
    v_mfma_f32_16x16x32_bf16 v[236:239], a[148:151], a[228:231], v[236:239]
    s_waitcnt lgkmcnt(9)
    v_sub_f32 v199, v199, v248
    v_cvt_pk_bf16_f32 v190, v196, v197
    v_mfma_f32_16x16x32_bf16 v[236:239], a[152:155], a[232:235], v[236:239]
    s_waitcnt lgkmcnt(8)
    v_exp_f32 v199, v199
    v_mfma_f32_16x16x32_bf16 v[236:239], a[156:159], a[236:239], v[236:239]
    s_waitcnt lgkmcnt(2)
    v_cvt_pk_bf16_f32 v193, v198, v199
    v_sub_f32 v200, v200, v248
    v_mfma_f32_16x16x32_bf16 v[236:239], a[160:163], a[240:243], v[236:239]
    ds_read_b128 v[196:199], v244 offset:192
    v_sub_f32 v201, v201, v248
    v_mfma_f32_16x16x32_bf16 v[236:239], a[164:167], a[244:247], v[236:239]
    buffer_store_dwordx4 a[252:255], v250, s[20:23], s51 offen nt
    v_mfma_f32_16x16x32_bf16 v[228:231], a[172:175], a[228:231], v[228:231]
    s_waitcnt lgkmcnt(1)
    ds_read_b128 a[252:255], v252 offset:6144
    v_mfma_f32_16x16x32_bf16 v[204:207], v[162:165], v[168:171], v[204:207]
    v_exp_f32 v200, v200
    v_mfma_f32_16x16x32_bf16 v[204:207], v[164:167], v[170:173], v[204:207]
    buffer_store_dwordx2 v[254:255], v251, s[20:23], s51 offen offset:256 nt
    v_mfma_f32_16x16x32_bf16 v[208:211], v[90:93], v[168:171], v[208:211]
    ds_read_b64 v[254:255], v253 offset:6400
    v_cvt_pk_bf16_f32 v236, v236, v237
    v_mfma_f32_16x16x32_bf16 v[208:211], v[92:95], v[170:173], v[208:211]
    s_mul_i32 s51, s31, 3
    v_cvt_pk_bf16_f32 v237, v238, v239
    s_add_u32 s57, s57, s51
    v_mfma_f32_16x16x32_bf16 v[228:231], a[176:179], a[232:235], v[228:231]
    ds_write_b64 v249, v[236:237] offset:18432
    v_mfma_f32_16x16x32_bf16 v[228:231], a[180:183], a[236:239], v[228:231]
    s_add_u32 s57, s57, s32
    s_and_b32 s51, s28, 1
    s_add_u32 s51, s51, 15
    v_mfma_f32_16x16x32_bf16 v[228:231], a[184:187], a[240:243], v[228:231]
    s_mul_i32 s51, s51, s30
    v_exp_f32 v201, v201
    v_mfma_f32_16x16x32_bf16 v[228:231], a[188:191], a[244:247], v[228:231]
    s_waitcnt lgkmcnt(2)
    v_sub_f32 v202, v202, v248
    v_sub_f32 v203, v203, v248
    v_mfma_f32_16x16x32_bf16 v[196:199], v[114:117], v[168:171], v[196:199]
    s_mov_b32 exec_hi, 0
    buffer_store_dwordx4 a[252:255], v250, s[20:23], s53 offen nt
    s_mov_b32 exec_hi, -1
    v_mfma_f32_16x16x32_bf16 v[196:199], v[116:119], v[170:173], v[196:199]
    v_exp_f32 v202, v202
    v_mfma_f32_16x16x32_bf16 v[232:235], a[192:195], a[224:227], 0
    ds_read_b128 a[224:227], v242 offset:36992
    v_cvt_pk_bf16_f32 v228, v228, v229
    v_mfma_f32_16x16x32_bf16 v[232:235], a[196:199], a[228:231], v[232:235]
    ds_read_b128 a[228:231], v243 offset:36992
    v_cvt_pk_bf16_f32 v229, v230, v231
    v_mfma_f32_16x16x32_bf16 v[232:235], a[200:203], a[232:235], v[232:235]
    ds_write_b64 v249, v[228:229] offset:18560
    v_mfma_f32_16x16x32_bf16 v[232:235], a[204:207], a[236:239], v[232:235]
    ds_read_b128 a[232:235], v242 offset:37120
    ds_read_b128 a[236:239], v243 offset:37120
    v_mfma_f32_16x16x32_bf16 v[232:235], a[208:211], a[240:243], v[232:235]
    ds_read_b128 a[240:243], v242 offset:43008
    s_waitcnt lgkmcnt(7)
    v_mfma_f32_16x16x32_bf16 v[232:235], a[212:215], a[244:247], v[232:235]
    ds_read_b128 a[244:247], v243 offset:43008
    s_mov_b32 exec_hi, 0
    buffer_store_dwordx2 v[254:255], v251, s[20:23], s53 offen offset:256 nt
    s_mov_b32 exec_hi, -1
    s_mul_i32 s53, s31, 7
    s_add_u32 s52, s52, s53
    s_add_u32 s52, s52, s32
    s_lshr_b32 s53, s28, 1
    s_sub_u32 s53, s53, 1
    v_exp_f32 v203, v203
    v_cvt_pk_bf16_f32 v232, v232, v233
    v_cvt_pk_bf16_f32 v233, v234, v235
    ds_write_b64 v249, v[232:233] offset:18688
    s_mov_b32 exec_lo, 0
    buffer_store_dwordx4 a[252:255], v250, s[20:23], s55 offen nt
    s_mov_b32 exec_lo, -1
    v_cvt_pk_bf16_f32 v191, v200, v201
    v_cvt_pk_bf16_f32 v194, v202, v203
    ds_read_b128 v[200:203], v245 offset:192
    v_mfma_f32_16x16x32_bf16 v[212:215], v[4:7], v[188:191], v[212:215]
    ds_read_b128 a[252:255], v252 offset:12288
    v_sub_f32 v204, v204, v248
    v_mfma_f32_16x16x32_bf16 v[216:219], v[34:37], v[188:191], v[216:219]
    s_mov_b32 exec_lo, 0
    buffer_store_dwordx2 v[254:255], v251, s[20:23], s55 offen offset:256 nt
    s_mov_b32 exec_lo, -1
    v_mfma_f32_16x16x32_bf16 v[220:223], v[64:67], v[188:191], v[220:223]
    ds_read_b64 v[254:255], v253 offset:12544
    s_mul_i32 s55, s31, 11
    v_mfma_f32_16x16x32_bf16 v[224:227], a[248:251], v[188:191], v[224:227]
    s_add_u32 s54, s54, s55
    s_add_u32 s54, s54, s32
    s_lshr_b32 s55, s28, 1
    v_mfma_f32_16x16x32_bf16 v[212:215], v[8:11], v[192:195], v[212:215]
    s_lshl2_add_u32 s55, s55, 11
    s_mul_i32 s55, s55, s31
    v_sub_f32 v205, v205, v248
    v_mfma_f32_16x16x32_bf16 v[216:219], v[38:41], v[192:195], v[216:219]
    v_exp_f32 v204, v204
    v_mfma_f32_16x16x32_bf16 v[220:223], v[68:71], v[192:195], v[220:223]
    v_exp_f32 v205, v205
    v_mfma_f32_16x16x32_bf16 v[224:227], a[248:251], v[192:195], v[224:227]
    v_sub_f32 v206, v206, v248
    s_waitcnt lgkmcnt(2)
    v_mfma_f32_16x16x32_bf16 v[200:203], v[138:141], v[168:171], v[200:203]
    v_exp_f32 v206, v206
    v_mfma_f32_16x16x32_bf16 v[200:203], v[140:143], v[170:173], v[200:203]
    s_waitcnt lgkmcnt(1)
    buffer_store_dwordx4 a[252:255], v250, s[20:23], s57 offen nt
    s_waitcnt lgkmcnt(0)
    v_sub_f32 v207, v207, v248
    v_exp_f32 v207, v207
    v_cvt_pk_bf16_f32 v180, v204, v205
    v_cvt_pk_bf16_f32 v183, v206, v207
    v_sub_f32 v208, v208, v248
    v_exp_f32 v208, v208
    buffer_store_dwordx2 v[254:255], v251, s[20:23], s57 offen offset:256 nt
    s_mul_i32 s57, s31, 15
    s_add_u32 s56, s56, s57
    s_add_u32 s56, s56, s32
    v_sub_f32 v209, v209, v248
    v_exp_f32 v209, v209
    v_sub_f32 v210, v210, v248
    v_exp_f32 v210, v210
    v_sub_f32 v211, v211, v248
    v_exp_f32 v211, v211
    v_cvt_pk_bf16_f32 v181, v208, v209
    v_cvt_pk_bf16_f32 v184, v210, v211
    v_sub_f32 v196, v196, v248
    v_mfma_f32_16x16x32_bf16 v[212:215], v[12:15], v[180:183], v[212:215]
    v_exp_f32 v196, v196
    v_mfma_f32_16x16x32_bf16 v[216:219], v[42:45], v[180:183], v[216:219]
    v_sub_f32 v197, v197, v248
    v_sub_f32 v200, v200, v248
    v_mfma_f32_16x16x32_bf16 v[220:223], v[72:75], v[180:183], v[220:223]
    v_exp_f32 v197, v197
    v_mfma_f32_16x16x32_bf16 v[224:227], a[248:251], v[180:183], v[224:227]
    v_cvt_pk_bf16_f32 v186, v196, v197
    v_exp_f32 v200, v200
    v_sub_f32 v201, v201, v248
    v_exp_f32 v201, v201
    v_mov_b32 v185, 0
    v_cvt_pk_bf16_f32 v187, v200, v201
    v_add_u32 v204, 0xffffff40, v244
    v_cndmask_b32 v244, v244, v204, vcc
    v_mfma_f32_16x16x32_bf16 v[212:215], v[16:19], v[184:187], v[212:215]
    ds_read_b128 v[196:199], v244 offset:64
    v_add_u32 v205, 0xffffff40, v245
    v_mfma_f32_16x16x32_bf16 v[216:219], v[46:49], v[184:187], v[216:219]
    s_mov_b32 vcc_lo, 0xff00ff
    s_mov_b32 vcc_hi, 0xf000ff
    v_cndmask_b32 v245, v245, v205, vcc
    v_mfma_f32_16x16x32_bf16 v[220:223], v[76:79], v[184:187], v[220:223]
    ds_read_b128 v[204:207], v244 offset:0
    ds_read_b128 v[208:211], v245 offset:0
    v_mfma_f32_16x16x32_bf16 v[224:227], a[248:251], v[184:187], v[224:227]
    ds_read_b128 v[200:203], v245 offset:64
    v_mov_b32 v190, 0
    v_mov_b32 v193, 0
    v_mov_b32 v180, 0
    v_mov_b32 v183, 0
    v_mov_b32 v186, 0
    s_nop 1
    v_rcp_f32 v225, v224
    s_nop 0
    v_mul_f32 v212, v212, v225
    v_mul_f32 v213, v213, v225
    v_mul_f32 v214, v214, v225
    v_mul_f32 v215, v215, v225
    v_cvt_pk_bf16_f32 v212, v212, v213
    v_cvt_pk_bf16_f32 v213, v214, v215
    ds_write_b64 v247, v[212:213] offset:49152
    s_waitcnt lgkmcnt(4)
    v_mfma_f32_16x16x32_bf16 v[196:199], v[114:117], v[174:177], v[196:199]
    v_mul_f32 v216, v216, v225
    v_mul_f32 v217, v217, v225
    v_mfma_f32_16x16x32_bf16 v[196:199], v[116:119], v[176:179], v[196:199]
    s_waitcnt lgkmcnt(3)
    v_mul_f32 v218, v218, v225
    v_mul_f32 v219, v219, v225
    v_mfma_f32_16x16x32_bf16 v[204:207], v[162:165], v[174:177], v[204:207]
    s_waitcnt lgkmcnt(2)
    v_cvt_pk_bf16_f32 v216, v216, v217
    v_cvt_pk_bf16_f32 v217, v218, v219
    v_mfma_f32_16x16x32_bf16 v[204:207], v[164:167], v[176:179], v[204:207]
    ds_write_b64 v247, v[216:217] offset:49280
    v_mfma_f32_16x16x32_bf16 v[208:211], v[90:93], v[174:177], v[208:211]
    s_waitcnt lgkmcnt(2)
    v_mul_f32 v220, v220, v225
    v_mul_f32 v221, v221, v225
    v_mfma_f32_16x16x32_bf16 v[208:211], v[92:95], v[176:179], v[208:211]
    v_mul_f32 v222, v222, v225
    v_mul_f32 v223, v223, v225
    v_mfma_f32_16x16x32_bf16 v[200:203], v[138:141], v[174:177], v[200:203]
    v_cvt_pk_bf16_f32 v220, v220, v221
    v_cvt_pk_bf16_f32 v221, v222, v223
    v_mfma_f32_16x16x32_bf16 v[200:203], v[140:143], v[176:179], v[200:203]
    ds_write_b64 v247, v[220:221] offset:49408
    v_mfma_f32_16x16x32_bf16 v[236:239], a[144:147], a[216:219], 0
    v_max_f32 v248, v204, v205
    v_max3_f32 v248, v248, v206, v207
    v_mfma_f32_16x16x32_bf16 v[236:239], a[148:151], a[220:223], v[236:239]
    ds_read_b128 v[204:207], v244 offset:128
    v_max3_f32 v248, v248, v208, v209
    v_mfma_f32_16x16x32_bf16 v[236:239], a[152:155], a[224:227], v[236:239]
    v_max3_f32 v248, v248, v210, v211
    v_max3_f32 v248, v248, v196, v197
    v_mfma_f32_16x16x32_bf16 v[236:239], a[156:159], a[228:231], v[236:239]
    ds_read_b128 v[208:211], v245 offset:128
    v_max3_f32 v248, v248, v198, v199
    v_mfma_f32_16x16x32_bf16 v[236:239], a[160:163], a[232:235], v[236:239]
    ds_read_b128 v[196:199], v244 offset:0
    v_max3_f32 v248, v248, v200, v201
    v_mfma_f32_16x16x32_bf16 v[236:239], a[164:167], a[236:239], v[236:239]
    v_max3_f32 v248, v248, v202, v203
    v_mfma_f32_16x16x32_bf16 v[228:231], a[168:171], a[216:219], 0
    ds_read_b128 v[200:203], v245 offset:0
    v_mfma_f32_16x16x32_bf16 v[228:231], a[172:175], a[220:223], v[228:231]
    v_mfma_f32_16x16x32_bf16 v[228:231], a[176:179], a[224:227], v[228:231]
    v_mfma_f32_16x16x32_bf16 v[228:231], a[180:183], a[228:231], v[228:231]
    v_mfma_f32_16x16x32_bf16 v[228:231], a[184:187], a[232:235], v[228:231]
    s_waitcnt lgkmcnt(3)
    v_cvt_pk_bf16_f32 v236, v236, v237
    v_cvt_pk_bf16_f32 v237, v238, v239
    v_mfma_f32_16x16x32_bf16 v[204:207], v[120:123], v[174:177], v[204:207]
    ds_write_b64 v249, v[236:237] offset:24576
    v_mfma_f32_16x16x32_bf16 v[204:207], v[122:125], v[176:179], v[204:207]
    s_waitcnt lgkmcnt(2)
    v_mfma_f32_16x16x32_bf16 v[208:211], v[144:147], v[174:177], v[208:211]
    v_mfma_f32_16x16x32_bf16 v[208:211], v[146:149], v[176:179], v[208:211]
    s_waitcnt lgkmcnt(1)
    v_mfma_f32_16x16x32_bf16 v[196:199], v[162:165], v[174:177], v[196:199]
    v_mfma_f32_16x16x32_bf16 v[196:199], v[164:167], v[176:179], v[196:199]
    v_mfma_f32_16x16x32_bf16 v[200:203], v[90:93], v[174:177], v[200:203]
    v_mfma_f32_16x16x32_bf16 v[200:203], v[92:95], v[176:179], v[200:203]
    v_max3_f32 v248, v248, v204, v205
    v_max3_f32 v248, v248, v206, v207
    v_mfma_f32_16x16x32_bf16 v[228:231], a[188:191], a[236:239], v[228:231]
    ds_read_b128 v[204:207], v244 offset:64
    v_max3_f32 v248, v248, v208, v209
    v_mfma_f32_16x16x32_bf16 v[232:235], a[192:195], a[216:219], 0
    ds_read_b128 a[216:219], v242 offset:43136
    v_max3_f32 v248, v248, v210, v211
    v_mfma_f32_16x16x32_bf16 v[232:235], a[196:199], a[220:223], v[232:235]
    ds_read_b128 a[220:223], v243 offset:43136
    ds_read_b128 v[208:211], v245 offset:64
    v_mfma_f32_16x16x32_bf16 v[232:235], a[200:203], a[224:227], v[232:235]
    ds_read_b128 a[224:227], v242 offset:43264
    v_cvt_pk_bf16_f32 v228, v228, v229
    v_mfma_f32_16x16x32_bf16 v[232:235], a[204:207], a[228:231], v[232:235]
    ds_read_b128 a[228:231], v243 offset:43264
    v_cvt_pk_bf16_f32 v229, v230, v231
    v_mfma_f32_16x16x32_bf16 v[232:235], a[208:211], a[232:235], v[232:235]
    ds_write_b64 v249, v[228:229] offset:24704
    v_mfma_f32_16x16x32_bf16 v[232:235], a[212:215], a[236:239], v[232:235]
    v_mov_b32 v225, v248
    v_mfma_f32_16x16x32_bf16 v[236:239], a[144:147], a[240:243], 0
    v_mfma_f32_16x16x32_bf16 v[236:239], a[148:151], a[244:247], v[236:239]
    s_waitcnt lgkmcnt(6)
    v_permlane16_swap_b32 v248, v225
    v_max_f32 v248, v248, v225
    v_mfma_f32_16x16x32_bf16 v[204:207], v[114:117], v[174:177], v[204:207]
    s_waitcnt lgkmcnt(5)
    v_cvt_pk_bf16_f32 v232, v232, v233
    v_cvt_pk_bf16_f32 v233, v234, v235
    v_mfma_f32_16x16x32_bf16 v[204:207], v[116:119], v[176:179], v[204:207]
    ds_write_b64 v249, v[232:233] offset:24832
    v_mfma_f32_16x16x32_bf16 v[236:239], a[152:155], a[216:219], v[236:239]
    s_waitcnt lgkmcnt(4)
    v_mov_b32 v225, v248
    v_mfma_f32_16x16x32_bf16 v[208:211], v[138:141], v[174:177], v[208:211]
    v_mfma_f32_16x16x32_bf16 v[208:211], v[140:143], v[176:179], v[208:211]
    v_permlane32_swap_b32 v248, v225
    v_max_f32 v248, v248, v225
    v_mfma_f32_16x16x32_bf16 v[236:239], a[156:159], a[220:223], v[236:239]
    s_waitcnt lgkmcnt(3)
    v_sub_f32 v196, v196, v248
    v_sub_f32 v197, v197, v248
    v_mfma_f32_16x16x32_bf16 v[236:239], a[160:163], a[224:227], v[236:239]
    s_waitcnt lgkmcnt(2)
    v_exp_f32 v196, v196
    v_mfma_f32_16x16x32_bf16 v[236:239], a[164:167], a[228:231], v[236:239]
    v_exp_f32 v197, v197
    v_mfma_f32_16x16x32_bf16 v[228:231], a[168:171], a[240:243], 0
    v_sub_f32 v198, v198, v248
    v_sub_f32 v199, v199, v248
    v_mfma_f32_16x16x32_bf16 v[228:231], a[172:175], a[244:247], v[228:231]
    s_waitcnt lgkmcnt(0)
    s_barrier
    v_cvt_pk_bf16_f32 v188, v196, v197
    v_mfma_f32_16x16x32_bf16 v[228:231], a[176:179], a[216:219], v[228:231]
    ds_read_b128 a[232:235], v242 offset:49152
    v_cvt_pk_bf16_f32 v236, v236, v237
    v_mfma_f32_16x16x32_bf16 v[228:231], a[180:183], a[220:223], v[228:231]
    ds_read_b128 a[236:239], v243 offset:49152
    v_cvt_pk_bf16_f32 v237, v238, v239
    v_mfma_f32_16x16x32_bf16 v[228:231], a[184:187], a[224:227], v[228:231]
    ds_write_b64 v249, v[236:237] offset:0
    v_mfma_f32_16x16x32_bf16 v[228:231], a[188:191], a[228:231], v[228:231]
    ds_read_b128 a[252:255], v252 offset:18432
    ds_read_b64 v[254:255], v253 offset:18688
    v_mfma_f32_16x16x32_bf16 v[232:235], a[192:195], a[240:243], 0
    ds_read_b128 a[240:243], v242 offset:49280
    v_sub_f32 v200, v200, v248
    v_mfma_f32_16x16x32_bf16 v[232:235], a[196:199], a[244:247], v[232:235]
    ds_read_b128 a[244:247], v243 offset:49280
    v_sub_f32 v201, v201, v248
    v_mfma_f32_16x16x32_bf16 v[232:235], a[200:203], a[216:219], v[232:235]
    ds_read_b128 a[216:219], v242 offset:49408
    v_cvt_pk_bf16_f32 v228, v228, v229
    v_mfma_f32_16x16x32_bf16 v[232:235], a[204:207], a[220:223], v[232:235]
    ds_read_b128 a[220:223], v243 offset:49408
    v_cvt_pk_bf16_f32 v229, v230, v231
    v_mfma_f32_16x16x32_bf16 v[232:235], a[208:211], a[224:227], v[232:235]
    ds_write_b64 v249, v[228:229] offset:128
    v_mfma_f32_16x16x32_bf16 v[232:235], a[212:215], a[228:231], v[232:235]
    s_waitcnt lgkmcnt(9)
    v_exp_f32 v198, v198
    v_mfma_f32_16x16x32_bf16 v[236:239], a[144:147], a[232:235], 0
    s_waitcnt lgkmcnt(8)
    v_exp_f32 v199, v199
    v_mfma_f32_16x16x32_bf16 v[236:239], a[148:151], a[236:239], v[236:239]
    v_cvt_pk_bf16_f32 v191, v198, v199
    s_waitcnt lgkmcnt(6)
    v_mfma_f32_16x16x32_bf16 v[228:231], a[168:171], a[232:235], 0
    ds_read_b128 v[196:199], v244 offset:128
    v_cvt_pk_bf16_f32 v232, v232, v233
    v_mfma_f32_16x16x32_bf16 v[228:231], a[172:175], a[236:239], v[228:231]
    s_waitcnt lgkmcnt(5)
    v_cvt_pk_bf16_f32 v233, v234, v235
    v_sub_f32 v202, v202, v248
    v_mfma_f32_16x16x32_bf16 v[236:239], a[152:155], a[240:243], v[236:239]
    ds_write_b64 v249, v[232:233] offset:256
    v_mfma_f32_16x16x32_bf16 v[228:231], a[176:179], a[240:243], v[228:231]
    buffer_store_dwordx4 a[252:255], v250, s[20:23], s52 offen nt
    v_mfma_f32_16x16x32_bf16 v[232:235], a[192:195], a[232:235], 0
    s_waitcnt lgkmcnt(5)
    ds_read_b128 a[252:255], v252 offset:24576
    v_mfma_f32_16x16x32_bf16 v[236:239], a[156:159], a[244:247], v[236:239]
    s_waitcnt lgkmcnt(5)
    v_exp_f32 v200, v200
    v_mfma_f32_16x16x32_bf16 v[236:239], a[160:163], a[216:219], v[236:239]
    buffer_store_dwordx2 v[254:255], v251, s[20:23], s52 offen offset:256 nt
    v_mfma_f32_16x16x32_bf16 v[228:231], a[180:183], a[244:247], v[228:231]
    ds_read_b64 v[254:255], v253 offset:24832
    s_lshr_b32 s52, s28, 1
    v_mfma_f32_16x16x32_bf16 v[228:231], a[184:187], a[216:219], v[228:231]
    s_lshl2_add_u32 s52, s52, 3
    s_mul_i32 s52, s52, s31
    s_add_u32 s51, s51, s52
    v_mfma_f32_16x16x32_bf16 v[232:235], a[196:199], a[236:239], v[232:235]
    s_add_u32 s51, s51, s32
    v_exp_f32 v201, v201
    v_mfma_f32_16x16x32_bf16 v[232:235], a[200:203], a[240:243], v[232:235]
    s_waitcnt lgkmcnt(3)
    v_exp_f32 v202, v202
    v_mfma_f32_16x16x32_bf16 v[196:199], v[120:123], v[174:177], v[196:199]
    v_sub_f32 v203, v203, v248
    v_cvt_pk_bf16_f32 v189, v200, v201
    v_mfma_f32_16x16x32_bf16 v[196:199], v[122:125], v[176:179], v[196:199]
    v_exp_f32 v203, v203
    v_mfma_f32_16x16x32_bf16 v[212:215], v[12:15], v[188:191], 0
    s_waitcnt lgkmcnt(1)
    v_cvt_pk_bf16_f32 v192, v202, v203
    v_sub_f32 v204, v204, v248
    v_mfma_f32_16x16x32_bf16 v[216:219], v[42:45], v[188:191], 0
    ds_read_b128 v[200:203], v245 offset:128
    v_sub_f32 v205, v205, v248
    v_mfma_f32_16x16x32_bf16 v[220:223], v[72:75], v[188:191], 0
    buffer_store_dwordx4 a[252:255], v250, s[20:23], s54 offen nt
    v_mfma_f32_16x16x32_bf16 v[224:227], a[248:251], v[188:191], 0
    s_waitcnt lgkmcnt(1)
    v_exp_f32 v204, v204
    v_mfma_f32_16x16x32_bf16 v[236:239], a[164:167], a[220:223], v[236:239]
    v_exp_f32 v205, v205
    v_mfma_f32_16x16x32_bf16 v[228:231], a[188:191], a[220:223], v[228:231]
    buffer_store_dwordx2 v[254:255], v251, s[20:23], s54 offen offset:256 nt
    v_mfma_f32_16x16x32_bf16 v[232:235], a[204:207], a[244:247], v[232:235]
    s_and_b32 s54, s28, 1
    s_add_u32 s54, s54, 15
    s_mul_i32 s54, s54, s30
    v_mfma_f32_16x16x32_bf16 v[232:235], a[208:211], a[216:219], v[232:235]
    s_add_u32 s54, s54, s55
    v_cvt_pk_bf16_f32 v236, v236, v237
    v_cvt_pk_bf16_f32 v237, v238, v239
    v_mfma_f32_16x16x32_bf16 v[232:235], a[212:215], a[220:223], v[232:235]
    ds_write_b64 v249, v[236:237] offset:6144
    s_waitcnt lgkmcnt(1)
    v_mfma_f32_16x16x32_bf16 v[200:203], v[144:147], v[174:177], v[200:203]
    s_add_u32 s54, s54, s32
    v_cvt_pk_bf16_f32 v228, v228, v229
    v_cvt_pk_bf16_f32 v229, v230, v231
    v_mfma_f32_16x16x32_bf16 v[200:203], v[146:149], v[176:179], v[200:203]
    ds_write_b64 v249, v[228:229] offset:6272
    v_cvt_pk_bf16_f32 v232, v232, v233
    v_cvt_pk_bf16_f32 v233, v234, v235
    ds_write_b64 v249, v[232:233] offset:6400
    v_sub_f32 v206, v206, v248
    v_exp_f32 v206, v206
    v_sub_f32 v207, v207, v248
    v_exp_f32 v207, v207
    v_cvt_pk_bf16_f32 v194, v204, v205
    v_cvt_pk_bf16_f32 v181, v206, v207
    v_sub_f32 v208, v208, v248
    v_exp_f32 v208, v208
    v_sub_f32 v209, v209, v248
    v_exp_f32 v209, v209
    v_sub_f32 v210, v210, v248
    v_exp_f32 v210, v210
    v_sub_f32 v211, v211, v248
    v_exp_f32 v211, v211
    v_cvt_pk_bf16_f32 v195, v208, v209
    v_cvt_pk_bf16_f32 v182, v210, v211
    v_sub_f32 v196, v196, v248
    v_mfma_f32_16x16x32_bf16 v[212:215], v[16:19], v[192:195], v[212:215]
    v_exp_f32 v196, v196
    v_mfma_f32_16x16x32_bf16 v[216:219], v[46:49], v[192:195], v[216:219]
    v_sub_f32 v197, v197, v248
    v_sub_f32 v198, v198, v248
    v_mfma_f32_16x16x32_bf16 v[220:223], v[76:79], v[192:195], v[220:223]
    v_exp_f32 v197, v197
    v_mfma_f32_16x16x32_bf16 v[224:227], a[248:251], v[192:195], v[224:227]
    v_exp_f32 v198, v198
    v_mfma_f32_16x16x32_bf16 v[212:215], v[20:23], v[180:183], v[212:215]
    v_sub_f32 v199, v199, v248
    v_cvt_pk_bf16_f32 v184, v196, v197
    v_mfma_f32_16x16x32_bf16 v[216:219], v[50:53], v[180:183], v[216:219]
    v_exp_f32 v199, v199
    v_mfma_f32_16x16x32_bf16 v[220:223], v[80:83], v[180:183], v[220:223]
    v_cvt_pk_bf16_f32 v187, v198, v199
    v_sub_f32 v200, v200, v248
    v_mfma_f32_16x16x32_bf16 v[224:227], a[248:251], v[180:183], v[224:227]
    v_exp_f32 v200, v200
    v_sub_f32 v201, v201, v248
    v_exp_f32 v201, v201
    v_sub_f32 v202, v202, v248
    v_exp_f32 v202, v202
    v_sub_f32 v203, v203, v248
    v_exp_f32 v203, v203
    v_cvt_pk_bf16_f32 v185, v200, v201
    v_cvt_pk_bf16_f32 v188, v202, v203
    v_mov_b32 v189, 0
    v_mfma_f32_16x16x32_bf16 v[212:215], v[24:27], v[184:187], v[212:215]
    v_mov_b32 v191, 0
    v_mfma_f32_16x16x32_bf16 v[216:219], v[54:57], v[184:187], v[216:219]
    v_mfma_f32_16x16x32_bf16 v[220:223], v[84:87], v[184:187], v[220:223]
    v_mfma_f32_16x16x32_bf16 v[224:227], a[248:251], v[184:187], v[224:227]
    v_mfma_f32_16x16x32_bf16 v[212:215], v[28:31], v[188:191], v[212:215]
    v_mfma_f32_16x16x32_bf16 v[216:219], v[58:61], v[188:191], v[216:219]
    v_mfma_f32_16x16x32_bf16 v[220:223], v[88:91], v[188:191], v[220:223]
    v_mfma_f32_16x16x32_bf16 v[224:227], a[248:251], v[188:191], v[224:227]
    s_nop 7
    v_rcp_f32 v225, v224
    s_nop 0
    v_mul_f32 v212, v212, v225
    v_mul_f32 v213, v213, v225
    v_mul_f32 v214, v214, v225
    v_mul_f32 v215, v215, v225
    v_cvt_pk_bf16_f32 v212, v212, v213
    v_cvt_pk_bf16_f32 v213, v214, v215
    ds_write_b64 v247, v[212:213] offset:55296
    v_mul_f32 v216, v216, v225
    v_mul_f32 v217, v217, v225
    v_mul_f32 v218, v218, v225
    v_mul_f32 v219, v219, v225
    v_cvt_pk_bf16_f32 v216, v216, v217
    v_cvt_pk_bf16_f32 v217, v218, v219
    ds_write_b64 v247, v[216:217] offset:55424
    v_mul_f32 v220, v220, v225
    v_mul_f32 v221, v221, v225
    v_mul_f32 v222, v222, v225
    v_mul_f32 v223, v223, v225
    v_cvt_pk_bf16_f32 v220, v220, v221
    v_cvt_pk_bf16_f32 v221, v222, v223
    ds_write_b64 v247, v[220:221] offset:55552
    s_waitcnt lgkmcnt(0)
    s_barrier
    ds_read_b128 a[224:227], v242 offset:55296
    ds_read_b128 a[228:231], v243 offset:55296
    ds_read_b128 a[232:235], v242 offset:55424
    ds_read_b128 a[236:239], v243 offset:55424
    ds_read_b128 a[240:243], v242 offset:55552
    ds_read_b128 a[244:247], v243 offset:55552
    ds_read_b128 a[252:255], v252 offset:0
    ds_read_b64 v[254:255], v253 offset:256
    s_waitcnt lgkmcnt(7)
    v_mfma_f32_16x16x32_bf16 v[236:239], a[144:147], a[224:227], 0
    v_mfma_f32_16x16x32_bf16 v[228:231], a[168:171], a[224:227], 0
    s_waitcnt lgkmcnt(6)
    v_mfma_f32_16x16x32_bf16 v[236:239], a[148:151], a[228:231], v[236:239]
    s_waitcnt lgkmcnt(5)
    v_mfma_f32_16x16x32_bf16 v[236:239], a[152:155], a[232:235], v[236:239]
    s_waitcnt lgkmcnt(4)
    v_mfma_f32_16x16x32_bf16 v[236:239], a[156:159], a[236:239], v[236:239]
    s_waitcnt lgkmcnt(3)
    v_mfma_f32_16x16x32_bf16 v[236:239], a[160:163], a[240:243], v[236:239]
    s_waitcnt lgkmcnt(2)
    v_mfma_f32_16x16x32_bf16 v[236:239], a[164:167], a[244:247], v[236:239]
    s_waitcnt lgkmcnt(0)
    v_mfma_f32_16x16x32_bf16 v[228:231], a[172:175], a[228:231], v[228:231]
    s_mov_b32 exec_hi, 0
    buffer_store_dwordx4 a[252:255], v250, s[20:23], s56 offen nt
    s_mov_b32 exec_hi, -1
    v_mfma_f32_16x16x32_bf16 v[228:231], a[176:179], a[232:235], v[228:231]
    v_mfma_f32_16x16x32_bf16 v[228:231], a[180:183], a[236:239], v[228:231]
    ds_read_b128 a[252:255], v252 offset:6144
    v_mfma_f32_16x16x32_bf16 v[228:231], a[184:187], a[240:243], v[228:231]
    s_mov_b32 exec_hi, 0
    buffer_store_dwordx2 v[254:255], v251, s[20:23], s56 offen offset:256 nt
    s_mov_b32 exec_hi, -1
    v_mfma_f32_16x16x32_bf16 v[228:231], a[188:191], a[244:247], v[228:231]
    ds_read_b64 v[254:255], v253 offset:6400
    v_cvt_pk_bf16_f32 v236, v236, v237
    v_mfma_f32_16x16x32_bf16 v[232:235], a[192:195], a[224:227], 0
    v_cvt_pk_bf16_f32 v237, v238, v239
    v_mfma_f32_16x16x32_bf16 v[232:235], a[196:199], a[228:231], v[232:235]
    ds_write_b64 v249, v[236:237] offset:12288
    v_mfma_f32_16x16x32_bf16 v[232:235], a[200:203], a[232:235], v[232:235]
    v_mfma_f32_16x16x32_bf16 v[232:235], a[204:207], a[236:239], v[232:235]
    v_cvt_pk_bf16_f32 v228, v228, v229
    v_cvt_pk_bf16_f32 v229, v230, v231
    v_mfma_f32_16x16x32_bf16 v[232:235], a[208:211], a[240:243], v[232:235]
    ds_write_b64 v249, v[228:229] offset:12416
    v_mfma_f32_16x16x32_bf16 v[232:235], a[212:215], a[244:247], v[232:235]
    s_waitcnt lgkmcnt(3)
    buffer_store_dwordx4 a[252:255], v250, s[20:23], s51 offen nt
    s_waitcnt lgkmcnt(2)
    s_nop 4
    v_cvt_pk_bf16_f32 v232, v232, v233
    v_cvt_pk_bf16_f32 v233, v234, v235
    ds_write_b64 v249, v[232:233] offset:12544
    buffer_store_dwordx2 v[254:255], v251, s[20:23], s51 offen offset:256 nt
    s_waitcnt lgkmcnt(0)
    s_barrier
    ds_read_b128 a[252:255], v252 offset:12288
    ds_read_b64 v[254:255], v253 offset:12544
    s_waitcnt lgkmcnt(1)
    s_mov_b32 exec_hi, s53
    buffer_store_dwordx4 a[252:255], v250, s[20:23], s54 offen nt
    s_mov_b32 exec_hi, -1
    s_waitcnt lgkmcnt(0)
    s_mov_b32 exec_hi, s53
    buffer_store_dwordx2 v[254:255], v251, s[20:23], s54 offen offset:256 nt
    s_mov_b32 exec_hi, -1
    s_endpgm
.section .rodata,"a"
.p2align 6
.amdhsa_kernel standalone__neighborhood_dinat__vision_kernel
  .amdhsa_next_free_vgpr 512
  .amdhsa_next_free_sgpr 102
  .amdhsa_accum_offset 256
  .amdhsa_group_segment_fixed_size 0
  .amdhsa_kernarg_size 56
  .amdhsa_user_sgpr_count 2
  .amdhsa_user_sgpr_kernarg_segment_ptr 1
  .amdhsa_system_sgpr_workgroup_id_x 1
.end_amdhsa_kernel
```

```asm
; @launch grid=(256,1,1) block=(256,1,1) lds=163840
.amdgcn_target "amdgcn-amd-amdhsa--gfx950"
.text
.globl standalone__neighborhood_dinat__vision_kernel
.p2align 12
.p2align 8
.type standalone__neighborhood_dinat__vision_kernel,@function
standalone__neighborhood_dinat__vision_kernel:
    s_cmpk_ge_u32 s2, 0x100
    s_cbranch_scc1 L_exit
    s_load_dwordx2 s[4:5], s[0:1], 0
    s_load_dwordx2 s[8:9], s[0:1], 8
    s_load_dwordx2 s[12:13], s[0:1], 16
    s_load_dwordx2 s[16:17], s[0:1], 24
    s_load_dwordx2 s[20:21], s[0:1], 32
    s_getpc_b64 s[68:69]
    v_lshrrev_b32 v4, 6, v0
    s_bfe_u32 s65, s2, 0x30003
    v_readfirstlane_b32 s28, v4
    s_lshl_b32 s66, s65, 13
    v_lshl_add_u32 v12, v0, 5, s66
    global_load_dword v11, v12, s[68:69]
    s_lshr_b32 s66, s2, 6
    s_and_b32 s67, s2, 1
    s_lshl2_add_u32 s64, s67, s66
    s_mov_b32 s30, 0x2a000
    s_mul_i32 s66, s64, 14
    s_bitcmp1_b32 s64, 0
    s_cselect_b32 s67, 16, -3
    s_cselect_b32 s35, -1, 1
    s_add_u32 s66, s66, s67
    s_mul_i32 s32, s66, s30
    s_mul_i32 s40, s30, 0x6f
    s_mul_i32 s30, s30, s35
    s_mul_i32 s66, s65, 28
    s_cmp_eq_u32 s65, 7
    s_cselect_b32 s36, 1, 0
    s_cselect_b32 s67, 18, -6
    s_cselect_b32 s31, -3, 3
    s_add_u32 s66, s66, s67
    s_bfe_u32 s67, s2, 0x10001
    s_add_u32 s66, s66, s67
    s_bfe_u32 s67, s2, 0x10002
    s_mulk_i32 s67, 0xe0
    s_add_u32 s66, s66, s67
    s_mulk_i32 s66, 0x180
    s_lshl_b32 s67, s36, 11
    s_sub_u32 s66, s66, s67
    s_lshl_b32 s45, s31, 11
    s_lshl_b32 s31, s31, 8
    s_mul_i32 s67, s30, s28
    s_add_u32 s67, s67, s32
    s_add_u32 s32, s32, s66
    s_min_i32 s40, s40, s67
    s_max_i32 s40, s40, 0
    s_add_u32 s40, s40, s66
    s_add_u32 s67, s67, s66
    s_lshl2_add_u32 s41, s30, s67
    s_mul_i32 s46, s28, 0x1e00
    s_mul_i32 s29, s28, 0x3000
    s_add_u32 s29, s29, 0x16800
    s_mul_i32 s39, s28, 0x60
    s_mov_b32 s6, 0x1260000
    s_mov_b32 s7, 0x20000
    s_mov_b32 s10, 0x36000
    s_mov_b32 s11, 0x20000
    v_mbcnt_lo_u32_b32 v1, -1, 0
    v_mbcnt_hi_u32_b32 v1, -1, v1
    s_lshl_b32 s51, s28, 1
    s_add_u32 s50, s31, 0xfffffe80
    s_mul_i32 s52, s36, 0x1d00
    v_lshrrev_b32 v2, 3, v1
    v_and_b32 v3, 7, v1
    v_xor_b32 v3, s51, v3
    v_lshl_add_u32 v4, v2, 7, s52
    v_mul_u32_u24 v8, 11, v2
    v_bfe_u32 v9, v8, 6, 1
    v_lshrrev_b32 v8, 5, v8
    v_xor_b32 v9, v3, v9
    v_mad_i32_i24 v8, v8, s50, v4
    v_lshl_add_u32 v168, v9, 4, v8
    v_add_u32 v8, 8, v2
    v_mul_u32_u24 v8, 11, v8
    v_bfe_u32 v9, v8, 6, 1
    v_lshrrev_b32 v8, 5, v8
    v_xor_b32 v9, v3, v9
    v_mad_i32_i24 v8, v8, s50, v4
    v_lshl_add_u32 v169, v9, 4, v8
    v_add_u32 v8, 16, v2
    v_mul_u32_u24 v8, 11, v8
    v_bfe_u32 v9, v8, 6, 1
    v_lshrrev_b32 v8, 5, v8
    v_xor_b32 v9, v3, v9
    v_mad_i32_i24 v8, v8, s50, v4
    v_lshl_add_u32 v170, v9, 4, v8
    s_movk_i32 s53, 0x480
    s_movk_i32 s54, -96
    v_lshrrev_b32 v10, 1, v1
    v_lshlrev_b32 v12, 4, v1
    v_mul_u32_u24 v8, 43, v10
    v_lshrrev_b32 v9, 8, v8
    v_lshrrev_b32 v8, 7, v8
    v_and_b32 v9, 4, v9
    v_xor_b32 v9, v8, v9
    v_mad_i32_i24 v8, v8, s54, v12
    v_mad_u32_u24 v172, v9, s53, v8
    v_add_u32 v8, 32, v10
    v_mul_u32_u24 v8, 43, v8
    v_lshrrev_b32 v9, 8, v8
    v_lshrrev_b32 v8, 7, v8
    v_and_b32 v9, 4, v9
    v_xor_b32 v9, v8, v9
    v_mad_i32_i24 v8, v8, s54, v12
    v_mad_u32_u24 v173, v9, s53, v8
    v_add_u32 v8, 64, v10
    v_mul_u32_u24 v8, 43, v8
    v_lshrrev_b32 v9, 8, v8
    v_lshrrev_b32 v8, 7, v8
    v_and_b32 v9, 4, v9
    v_xor_b32 v9, v8, v9
    v_mad_i32_i24 v8, v8, s54, v12
    v_mad_u32_u24 v174, v9, s53, v8
    s_waitcnt lgkmcnt(0)
    s_add_u32 m0, s46, 0xc00
    s_add_u32 s59, s40, s45
    buffer_load_dwordx4 v168, s[4:7], s59 offen lds
    s_add_u32 m0, s29, 0
    s_add_u32 s60, s39, 0x180
    buffer_load_dwordx4 v172, s[8:11], s60 offen lds
    s_add_u32 m0, s46, 0xc00
    s_add_u32 s52, s40, 0
    buffer_load_dwordx4 v169, s[4:7], s59 offen offset:1024 lds
    s_add_u32 m0, s29, 0
    v_add_u32 v5, s52, v168
    buffer_load_dwordx4 v173, s[8:11], s60 offen offset:1024 lds
    s_add_u32 m0, s46, 0xc00
    v_max_i32 v5, 0, v5
    buffer_load_dwordx4 v170, s[4:7], s59 offen offset:2048 lds
    s_add_u32 m0, s29, 0
    s_add_u32 s53, s40, 0x400
    buffer_load_dwordx4 v174, s[8:11], s60 offen offset:2048 lds
    s_add_u32 m0, s46, 0
    v_add_u32 v6, s53, v169
    buffer_load_dwordx4 v5, s[4:7], 0 offen lds
    s_add_u32 m0, s46, 0x400
    v_max_i32 v6, 0, v6
    buffer_load_dwordx4 v6, s[4:7], 0 offen lds
    s_add_u32 s54, s40, 0x800
    s_add_u32 m0, s46, 0x800
    v_add_u32 v7, s54, v170
    v_max_i32 v7, 0, v7
    buffer_load_dwordx4 v7, s[4:7], 0 offen lds
    s_add_u32 m0, s29, 0xc00
    s_add_u32 s61, s39, 0x9180
    buffer_load_dwordx4 v172, s[8:11], s61 offen lds
    buffer_load_dwordx4 v173, s[8:11], s61 offen offset:1024 lds
    buffer_load_dwordx4 v174, s[8:11], s61 offen offset:2048 lds
    s_add_u32 m0, s29, 0x1800
    s_mov_b32 s33, 0
    s_add_u32 s66, s64, 1
    s_and_b32 s66, s66, 6
    s_cselect_b32 s33, 0, 3
    s_add_u32 s66, s65, 1
    s_and_b32 s66, s66, 6
    s_cselect_b32 s34, 0, 1
    s_cmp_lt_i32 s30, 0
    s_cselect_b32 s35, 1, 0
    s_cselect_b32 s49, -1, 1
    s_mul_i32 s49, s49, 0x1c0
    s_cselect_b32 s48, 0, 0x4e
    s_mul_i32 s66, s28, 0x152
    s_add_u32 s48, s48, s66
    s_lshl2_add_u32 s42, s30, s41
    s_lshl2_add_u32 s43, s30, s42
    s_lshl2_add_u32 s44, s30, s43
    s_mul_i32 s66, s36, 0x1400
    s_add_u32 s32, s32, s66
    s_mul_i32 s37, s28, 0x1180
    s_add_u32 s37, s37, 0x239c0
    s_mov_b32 s38, 0x3e553b95
    s_mov_b32 s3, 0x3dd53b95
    s_mov_b32 s14, 0x12000
    s_mov_b32 s15, 0x20000
    s_mov_b32 s18, 0x548
    s_mov_b32 s19, 0x20000
    s_mov_b32 s22, 0x1260000
    s_mov_b32 s23, 0x20000
    s_mov_b32 s26, 0x1000000
    s_mov_b32 s27, 0x20000
    s_add_u32 s62, s39, 0x12180
    s_add_u32 s63, s39, 0x1b180
    v_and_b32 v13, 15, v1
    v_lshrrev_b32 v14, 4, v1
    v_lshrrev_b32 v15, 2, v13
    v_and_b32 v17, 1, v14
    v_lshl_add_u32 v18, v14, 3, v15
    v_xor_b32 v19, 0, v17
    v_lshl_add_u32 v19, v19, 2, v18
    v_and_b32 v16, 3, v13
    v_mul_u32_u24 v19, 0x60, v19
    v_lshl_add_u32 v19, v16, 3, v19
    v_add_u32 v249, s29, v19
    v_xor_b32 v19, 1, v17
    v_lshl_add_u32 v19, v19, 2, v18
    v_mov_b32 v17, v15
    v_and_b32 v18, 3, v17
    v_lshlrev_b32 v18, 1, v18
    v_bfe_u32 v241, v16, 1, 1
    v_or_b32 v18, v18, v241
    v_mul_u32_u24 v17, 0x1e00, v17
    v_xor_b32 v18, v18, v14
    v_lshl_add_u32 v17, v18, 4, v17
    v_mul_u32_u24 v19, 0x60, v19
    v_mul_u32_u24 v18, 0x180, v16
    v_lshl_add_u32 v19, v16, 3, v19
    v_add_u32 v240, v17, v18
    v_add_u32 v250, s29, v19
    v_xor_b32 v241, 64, v240
    s_add_u32 s59, s41, s45
    s_add_u32 s60, s39, 0x24180
    s_add_u32 s61, s39, 0x2d180
    s_and_b32 s65, s48, 0xfff0
    s_lshl1_add_u32 s58, s45, s40
    s_add_u32 s55, s28, 3
    s_mul_i32 s56, s31, 3
    s_mul_i32 s55, s55, s30
    s_add_u32 s55, s55, s56
    s_add_u32 s55, s55, s32
    s_add_u32 s57, s28, 3
    s_mul_i32 s51, s31, 7
    s_mul_i32 s57, s57, s30
    s_add_u32 s57, s57, s51
    s_add_u32 s57, s57, s32
    s_add_u32 s52, s28, 3
    s_mul_i32 s53, s31, 11
    s_mul_i32 s52, s52, s30
    s_add_u32 s52, s52, s53
    s_add_u32 s52, s52, s32
    s_add_u32 s54, s28, 7
    s_mul_i32 s54, s54, s30
    s_add_u32 s56, s28, 7
    s_mul_i32 s56, s56, s30
    s_add_u32 s51, s28, 7
    s_mul_i32 s51, s51, s30
    s_add_u32 s53, s28, 3
    s_mul_i32 s53, s53, s30
    buffer_load_dwordx4 v172, s[8:11], s62 offen lds
    buffer_load_dwordx4 v173, s[8:11], s62 offen offset:1024 lds
    buffer_load_dwordx4 v174, s[8:11], s62 offen offset:2048 lds
    s_add_u32 m0, s46, 0x7800
    s_add_u32 s62, s39, 0x300
    buffer_load_dwordx4 v168, s[4:7], s41 offen lds
    buffer_load_dwordx4 v169, s[4:7], s41 offen offset:1024 lds
    s_waitcnt vmcnt(12)
    s_barrier
    ds_read_b128 a[216:219], v240 offset:3072
    ds_read_b128 a[220:223], v240 offset:4608
    ds_read_b128 a[240:243], v241 offset:3072
    ds_read_b128 a[244:247], v241 offset:4608
    buffer_load_dwordx4 v170, s[4:7], s41 offen offset:2048 lds
    s_add_u32 m0, s29, 0x2400
    s_waitcnt vmcnt(12)
    ds_read_b64_tr_b16 a[0:1], v249 offset:0
    ds_read_b64_tr_b16 a[2:3], v250 offset:0
    ds_read_b64_tr_b16 a[24:25], v249 offset:32
    ds_read_b64_tr_b16 a[26:27], v250 offset:32
    ds_read_b64_tr_b16 a[48:49], v249 offset:64
    ds_read_b64_tr_b16 a[50:51], v250 offset:64
    buffer_load_dwordx4 v172, s[8:11], s63 offen lds
    buffer_load_dwordx4 v173, s[8:11], s63 offen offset:1024 lds
    s_waitcnt lgkmcnt(4)
    v_mfma_f32_16x16x32_bf16 v[180:183], a[0:3], a[216:219], 0
    v_mfma_f32_16x16x32_bf16 v[192:195], a[0:3], a[220:223], 0
    s_waitcnt lgkmcnt(2)
    v_mfma_f32_16x16x32_bf16 v[184:187], a[24:27], a[216:219], 0
    s_waitcnt lgkmcnt(0)
    v_mfma_f32_16x16x32_bf16 v[188:191], a[48:51], a[216:219], 0
    buffer_load_dwordx4 v174, s[8:11], s63 offen offset:2048 lds
    s_waitcnt vmcnt(12)
    v_mfma_f32_16x16x32_bf16 v[196:199], a[24:27], a[220:223], 0
    s_barrier
    s_add_u32 m0, s46, 0x8400
    s_add_u32 s63, s39, 0x9300
    v_mfma_f32_16x16x32_bf16 v[200:203], a[48:51], a[220:223], 0
    ds_read_b128 a[224:227], v240 offset:0
    ds_read_b128 a[228:231], v240 offset:1536
    ds_read_b128 a[232:235], v241 offset:0
    ds_read_b128 a[236:239], v241 offset:1536
    ds_read_b128 a[216:219], v240 offset:128
    ds_read_b128 a[220:223], v240 offset:1664
    s_mov_b64 exec, 0
    s_cmp_eq_u32 s28, 0
    s_cbranch_scc1 L_h1
    s_cmp_eq_u32 s28, 1
    s_cbranch_scc1 L_h2
    s_cmp_eq_u32 s28, 2
    s_cbranch_scc1 L_h3
    s_branch L_h4
    L_hback:
    s_mov_b64 exec, -1
    buffer_load_dwordx4 v168, s[4:7], s59 offen lds
    buffer_load_dwordx4 v169, s[4:7], s59 offen offset:1024 lds
    s_waitcnt lgkmcnt(5)
    v_mfma_f32_16x16x32_bf16 v[204:207], a[0:3], a[224:227], 0
    v_mfma_f32_16x16x32_bf16 v[208:211], a[24:27], a[224:227], 0
    s_waitcnt lgkmcnt(4)
    v_mfma_f32_16x16x32_bf16 v[212:215], a[48:51], a[224:227], 0
    ds_read_b128 a[224:227], v240 offset:3200
    s_waitcnt vmcnt(11)
    v_mfma_f32_16x16x32_bf16 v[216:219], a[0:3], a[228:231], 0
    ds_read_b64_tr_b16 a[4:5], v249 offset:3072
    ds_read_b64_tr_b16 a[6:7], v250 offset:3072
    v_mfma_f32_16x16x32_bf16 v[220:223], a[24:27], a[228:231], 0
    ds_read_b64_tr_b16 a[28:29], v249 offset:3104
    ds_read_b64_tr_b16 a[30:31], v250 offset:3104
    v_mfma_f32_16x16x32_bf16 v[224:227], a[48:51], a[228:231], 0
    ds_read_b64_tr_b16 a[52:53], v249 offset:3136
    ds_read_b64_tr_b16 a[54:55], v250 offset:3136
    buffer_load_dwordx4 v170, s[4:7], s59 offen offset:2048 lds
    ds_read_b128 a[228:231], v240 offset:4736
    s_add_u32 m0, s29, 0
    s_add_u32 s59, s42, s45
    buffer_load_dwordx4 v172, s[8:11], s60 offen lds
    s_waitcnt lgkmcnt(5)
    v_mfma_f32_16x16x32_bf16 v[204:207], a[4:7], a[232:235], v[204:207]
    v_mfma_f32_16x16x32_bf16 v[216:219], a[4:7], a[236:239], v[216:219]
    s_waitcnt lgkmcnt(3)
    v_mfma_f32_16x16x32_bf16 v[208:211], a[28:31], a[232:235], v[208:211]
    s_waitcnt lgkmcnt(1)
    buffer_load_dwordx4 v173, s[8:11], s60 offen offset:1024 lds
    v_mfma_f32_16x16x32_bf16 v[212:215], a[52:55], a[232:235], v[212:215]
    v_mfma_f32_16x16x32_bf16 v[220:223], a[28:31], a[236:239], v[220:223]
    s_waitcnt vmcnt(11)
    ds_read_b64_tr_b16 a[8:9], v249 offset:6144
    v_mfma_f32_16x16x32_bf16 v[224:227], a[52:55], a[236:239], v[224:227]
    ds_read_b64_tr_b16 a[10:11], v250 offset:6144
    ds_read_b64_tr_b16 a[32:33], v249 offset:6176
    v_mfma_f32_16x16x32_bf16 v[180:183], a[4:7], a[240:243], v[180:183]
    ds_read_b64_tr_b16 a[34:35], v250 offset:6176
    ds_read_b64_tr_b16 a[56:57], v249 offset:6208
    v_mfma_f32_16x16x32_bf16 v[184:187], a[28:31], a[240:243], v[184:187]
    ds_read_b64_tr_b16 a[58:59], v250 offset:6208
    buffer_load_dwordx4 v174, s[8:11], s60 offen offset:2048 lds
    v_mfma_f32_16x16x32_bf16 v[188:191], a[52:55], a[240:243], v[188:191]
    s_add_u32 m0, s29, 0xc00
    s_add_u32 s60, s39, 0x12300
    v_mfma_f32_16x16x32_bf16 v[192:195], a[4:7], a[244:247], v[192:195]
    v_mfma_f32_16x16x32_bf16 v[196:199], a[28:31], a[244:247], v[196:199]
    v_mfma_f32_16x16x32_bf16 v[200:203], a[52:55], a[244:247], v[200:203]
    buffer_load_dwordx4 v172, s[8:11], s61 offen lds
    s_waitcnt lgkmcnt(4)
    v_mfma_f32_16x16x32_bf16 v[204:207], a[8:11], a[216:219], v[204:207]
    v_mfma_f32_16x16x32_bf16 v[216:219], a[8:11], a[220:223], v[216:219]
    s_waitcnt lgkmcnt(2)
    v_mfma_f32_16x16x32_bf16 v[208:211], a[32:35], a[216:219], v[208:211]
    s_waitcnt lgkmcnt(0)
    buffer_load_dwordx4 v173, s[8:11], s61 offen offset:1024 lds
    v_mfma_f32_16x16x32_bf16 v[212:215], a[56:59], a[216:219], v[212:215]
    s_waitcnt vmcnt(11)
    s_barrier
    v_mfma_f32_16x16x32_bf16 v[220:223], a[32:35], a[220:223], v[220:223]
    ds_read_b128 a[232:235], v240 offset:30720
    ds_read_b128 a[236:239], v240 offset:32256
    v_mfma_f32_16x16x32_bf16 v[224:227], a[56:59], a[220:223], v[224:227]
    ds_read_b128 a[240:243], v241 offset:30720
    ds_read_b128 a[244:247], v241 offset:32256
    v_mfma_f32_16x16x32_bf16 v[180:183], a[8:11], a[224:227], v[180:183]
    ds_read_b128 a[216:219], v240 offset:30848
    ds_read_b128 a[220:223], v240 offset:32384
    v_mfma_f32_16x16x32_bf16 v[184:187], a[32:35], a[224:227], v[184:187]
    buffer_load_dwordx4 v174, s[8:11], s61 offen offset:2048 lds
    v_add_u32 v17, 3, v15
    v_mfma_f32_16x16x32_bf16 v[188:191], a[56:59], a[224:227], v[188:191]
    ds_read_b128 a[224:227], v241 offset:128
    v_add_u32 v19, 3, v16
    v_mfma_f32_16x16x32_bf16 v[192:195], a[8:11], a[228:231], v[192:195]
    s_add_u32 m0, s37, 0xd80
    v_and_b32 v18, 3, v17
    v_lshlrev_b32 v18, 1, v18
    v_mfma_f32_16x16x32_bf16 v[196:199], a[32:35], a[228:231], v[196:199]
    s_add_u32 s61, s39, 0x1b300
    v_bfe_u32 v243, v19, 1, 1
    v_or_b32 v18, v18, v243
    v_mfma_f32_16x16x32_bf16 v[200:203], a[56:59], a[228:231], v[200:203]
    ds_read_b128 a[228:231], v241 offset:1664
    buffer_load_dwordx4 v12, s[16:19], s65 offen lds
    s_add_u32 m0, s29, 0x1800
    s_waitcnt lgkmcnt(7)
    v_mfma_f32_16x16x32_bf16 v[228:231], a[0:3], a[232:235], 0
    s_and_b32 s66, s28, 1
    v_mul_u32_u24 v17, 0x1e00, v17
    s_waitcnt lgkmcnt(6)
    v_mfma_f32_16x16x32_bf16 v[232:235], a[24:27], a[232:235], 0
    s_lshl_b32 s66, s66, 2
    v_xor_b32 v18, v18, v14
    v_lshl_add_u32 v17, v18, 4, v17
    v_mfma_f32_16x16x32_bf16 v[236:239], a[48:51], a[232:235], 0
    ds_read_b128 a[232:235], v241 offset:3200
    v_mul_u32_u24 v18, 0x180, v19
    v_mfma_f32_16x16x32_bf16 v[138:141], a[0:3], a[236:239], 0
    s_waitcnt lgkmcnt(6)
    v_add_u32 v242, v17, v18
    v_mov_b32 v17, 0x3f803f80
    v_mfma_f32_16x16x32_bf16 v[142:145], a[24:27], a[236:239], 0
    buffer_load_dwordx4 v172, s[8:11], s62 offen lds
    v_lshrrev_b32 v18, 1, v13
    v_mfma_f32_16x16x32_bf16 v[146:149], a[48:51], a[236:239], 0
    ds_read_b128 a[236:239], v241 offset:4736
    v_accvgpr_write_b32 a248, v17
    v_mfma_f32_16x16x32_bf16 v[228:231], a[4:7], a[240:243], v[228:231]
    s_waitcnt vmcnt(11) lgkmcnt(6)
    ds_read_b64_tr_b16 a[12:13], v249 offset:9216
    v_mfma_f32_16x16x32_bf16 v[232:235], a[28:31], a[240:243], v[232:235]
    ds_read_b64_tr_b16 a[14:15], v250 offset:9216
    ds_read_b64_tr_b16 a[36:37], v249 offset:9248
    v_mfma_f32_16x16x32_bf16 v[236:239], a[52:55], a[240:243], v[236:239]
    ds_read_b64_tr_b16 a[38:39], v250 offset:9248
    ds_read_b64_tr_b16 a[60:61], v249 offset:9280
    v_mfma_f32_16x16x32_bf16 v[138:141], a[4:7], a[244:247], v[138:141]
    ds_read_b64_tr_b16 a[62:63], v250 offset:9280
    s_waitcnt lgkmcnt(10)
    v_mfma_f32_16x16x32_bf16 v[142:145], a[28:31], a[244:247], v[142:145]
    ds_read_b128 a[240:243], v241 offset:30848
    v_accvgpr_write_b32 a249, v17
    v_mfma_f32_16x16x32_bf16 v[146:149], a[52:55], a[244:247], v[146:149]
    ds_read_b128 a[244:247], v241 offset:32384
    v_accvgpr_write_b32 a250, v17
    v_mfma_f32_16x16x32_bf16 v[228:231], a[8:11], a[216:219], v[228:231]
    buffer_load_dwordx4 v173, s[8:11], s62 offen offset:1024 lds
    v_accvgpr_write_b32 a251, v17
    v_mfma_f32_16x16x32_bf16 v[232:235], a[32:35], a[216:219], v[232:235]
    s_lshr_b32 s67, s28, 1
    v_xor_b32 v18, v14, v18
    v_xor_b32 v18, s66, v18
    v_mfma_f32_16x16x32_bf16 v[236:239], a[56:59], a[216:219], v[236:239]
    s_lshl_b32 s67, s67, 3
    v_mul_u32_u24 v17, 0x180, v13
    v_lshl_add_u32 v17, v18, 4, v17
    v_mfma_f32_16x16x32_bf16 v[138:141], a[8:11], a[220:223], v[138:141]
    s_waitcnt lgkmcnt(6)
    v_add_u32 v17, s67, v17
    v_add_u32 v247, 0x7800, v17
    v_mfma_f32_16x16x32_bf16 v[142:145], a[32:35], a[220:223], v[142:145]
    buffer_load_dwordx4 v174, s[8:11], s62 offen offset:2048 lds
    s_waitcnt lgkmcnt(4)
    v_mfma_f32_16x16x32_bf16 v[146:149], a[56:59], a[220:223], v[146:149]
    s_add_u32 m0, s46, 0xf000
    s_waitcnt lgkmcnt(2)
    v_add_u32 v251, 0x1e000, v17
    v_mfma_f32_16x16x32_bf16 v[204:207], a[12:15], a[224:227], v[204:207]
    s_add_u32 s62, s39, 0x24300
    v_sub_u32 v17, v14, v15
    v_mul_i32_i24 v17, 0x1c0, v17
    v_mfma_f32_16x16x32_bf16 v[208:211], a[36:39], a[224:227], v[208:211]
    s_lshl_b32 s66, s36, 1
    v_lshlrev_b32 v18, 4, v16
    v_sub_u32 v17, v17, v18
    v_mfma_f32_16x16x32_bf16 v[212:215], a[60:63], a[224:227], v[212:215]
    buffer_load_dwordx4 v168, s[4:7], s42 offen lds
    v_max_u32 v18, s33, v15
    v_mfma_f32_16x16x32_bf16 v[216:219], a[12:15], a[228:231], v[216:219]
    s_add_u32 m0, s29, 0x2400
    v_sub_u32 v18, v14, v18
    v_add_u32 v244, 0, v18
    v_mfma_f32_16x16x32_bf16 v[220:223], a[36:39], a[228:231], v[220:223]
    s_sub_u32 s66, 1, s66
    v_cmp_gt_u32 vcc, 7, v244
    v_add_u32 v17, s37, v17
    v_mfma_f32_16x16x32_bf16 v[224:227], a[60:63], a[228:231], v[224:227]
    s_waitcnt vmcnt(11)
    s_barrier
    v_add_u32 v244, 0xfffdc870, v17
    v_mfma_f32_16x16x32_bf16 v[180:183], a[12:15], a[232:235], v[180:183]
    ds_read_b128 a[216:219], v240 offset:33792
    s_waitcnt lgkmcnt(1)
    v_mfma_f32_16x16x32_bf16 v[184:187], a[36:39], a[232:235], v[184:187]
    ds_read_b128 a[220:223], v240 offset:35328
    v_cndmask_b32 v244, 0, v244, vcc
    v_mfma_f32_16x16x32_bf16 v[188:191], a[60:63], a[232:235], v[188:191]
    ds_read_b128 a[224:227], v241 offset:33792
    v_add_u32 v245, 4, v18
    v_mfma_f32_16x16x32_bf16 v[192:195], a[12:15], a[236:239], v[192:195]
    ds_read_b128 a[228:231], v241 offset:35328
    v_cmp_gt_u32 vcc, 7, v245
    v_mfma_f32_16x16x32_bf16 v[196:199], a[36:39], a[236:239], v[196:199]
    ds_read_b128 a[232:235], v240 offset:33920
    v_add_u32 v245, 0xfffdcf70, v17
    v_mfma_f32_16x16x32_bf16 v[200:203], a[60:63], a[236:239], v[200:203]
    ds_read_b128 a[236:239], v240 offset:35456
    v_cndmask_b32 v245, 0, v245, vcc
    v_mfma_f32_16x16x32_bf16 v[228:231], a[12:15], a[240:243], v[228:231]
    buffer_load_dwordx4 v172, s[8:11], s63 offen lds
    v_add_u32 v246, 8, v18
    v_mfma_f32_16x16x32_bf16 v[232:235], a[36:39], a[240:243], v[232:235]
    s_add_u32 m0, s46, 0xf000
    v_cmp_gt_u32 vcc, 7, v246
    v_add_u32 v246, 0xfffdd670, v17
    v_mfma_f32_16x16x32_bf16 v[236:239], a[60:63], a[240:243], v[236:239]
    ds_read_b128 a[240:243], v241 offset:33920
    v_min_u32 v20, 55, v1
    v_mfma_f32_16x16x32_bf16 v[138:141], a[12:15], a[244:247], v[138:141]
    s_waitcnt lgkmcnt(6)
    v_cndmask_b32 v246, 0, v246, vcc
    v_lshrrev_b32 v21, 1, v20
    v_mfma_f32_16x16x32_bf16 v[142:145], a[36:39], a[244:247], v[142:145]
    buffer_load_dwordx4 v169, s[4:7], s42 offen offset:1024 lds
    v_cmp_lt_u32 vcc, 11, v21
    v_mfma_f32_16x16x32_bf16 v[146:149], a[60:63], a[244:247], v[146:149]
    ds_read_b128 a[244:247], v241 offset:35456
    v_lshlrev_b32 v62, 3, v20
    v_mfma_f32_16x16x32_bf16 v[150:153], a[0:3], a[216:219], 0
    s_waitcnt lgkmcnt(6)
    v_add_u32 v22, -12, v21
    v_mov_b32 v23, s34
    v_mfma_f32_16x16x32_bf16 v[154:157], a[24:27], a[216:219], 0
    s_add_u32 m0, s29, 0x2400
    v_and_b32 v20, 1, v20
    v_cndmask_b32 v22, v21, v22, vcc
    v_mfma_f32_16x16x32_bf16 v[158:161], a[48:51], a[216:219], 0
    ds_read_b128 a[216:219], v240 offset:256
    v_cndmask_b32 v23, 0, v23, vcc
    v_mfma_f32_16x16x32_bf16 v[162:165], a[0:3], a[220:223], 0
    s_waitcnt lgkmcnt(6)
    v_lshlrev_b32 v20, 1, v20
    v_cmp_ne_u32 vcc, 0, v23
    v_mfma_f32_16x16x32_bf16 v[24:27], a[24:27], a[220:223], 0
    buffer_load_dwordx4 v173, s[8:11], s63 offen offset:1024 lds
    s_waitcnt lgkmcnt(5)
    v_mfma_f32_16x16x32_bf16 v[54:57], a[48:51], a[220:223], 0
    ds_read_b128 a[220:223], v240 offset:1792
    v_add_u32 v63, 0, v20
    v_mfma_f32_16x16x32_bf16 v[150:153], a[4:7], a[224:227], v[150:153]
    s_waitcnt lgkmcnt(5)
    v_add3_u32 v64, v22, v63, -6
    v_and_b32 v66, 12, v22
    v_mfma_f32_16x16x32_bf16 v[154:157], a[28:31], a[224:227], v[154:157]
    s_add_u32 m0, s46, 0xf000
    v_add_u32 v65, 3, v64
    v_add3_u32 v66, v66, v63, -3
    v_mfma_f32_16x16x32_bf16 v[158:161], a[52:55], a[224:227], v[158:161]
    ds_read_b128 a[224:227], v240 offset:3328
    v_cndmask_b32 v65, v65, v66, vcc
    v_mfma_f32_16x16x32_bf16 v[162:165], a[4:7], a[228:231], v[162:165]
    s_waitcnt lgkmcnt(5)
L_h1:
    s_cbranch_execz L_h5
    v_cmp_gt_u32 vcc, 7, v65
    v_mul_i32_i24 v64, s66, v64
    v_mfma_f32_16x16x32_bf16 v[24:27], a[28:31], a[228:231], v[24:27]
    buffer_load_dwordx4 v170, s[4:7], s42 offen offset:2048 lds
    v_add_lshl_u32 v64, v64, 6, 1
    v_mfma_f32_16x16x32_bf16 v[54:57], a[52:55], a[228:231], v[54:57]
    ds_read_b128 a[228:231], v240 offset:4864
    v_cndmask_b32 v50, 0, v64, vcc
    v_mfma_f32_16x16x32_bf16 v[150:153], a[8:11], a[232:235], v[150:153]
    s_waitcnt vmcnt(12) lgkmcnt(5)
    ds_read_b64_tr_b16 a[16:17], v249 offset:0
    v_mfma_f32_16x16x32_bf16 v[154:157], a[32:35], a[232:235], v[154:157]
    ds_read_b64_tr_b16 a[18:19], v250 offset:0
    ds_read_b64_tr_b16 a[40:41], v249 offset:32
    v_mfma_f32_16x16x32_bf16 v[158:161], a[56:59], a[232:235], v[158:161]
    ds_read_b64_tr_b16 a[42:43], v250 offset:32
    ds_read_b64_tr_b16 a[64:65], v249 offset:64
    v_mfma_f32_16x16x32_bf16 v[162:165], a[8:11], a[236:239], v[162:165]
    ds_read_b64_tr_b16 a[66:67], v250 offset:64
    s_waitcnt lgkmcnt(9)
    v_mfma_f32_16x16x32_bf16 v[24:27], a[32:35], a[236:239], v[24:27]
    ds_read_b128 a[232:235], v240 offset:30976
    v_mov_b32 v64, 0x3fb8aa3b
    v_mfma_f32_16x16x32_bf16 v[54:57], a[56:59], a[236:239], v[54:57]
    s_add_u32 m0, s29, 0x2400
    v_cndmask_b32 v52, 0, v64, vcc
    v_mov_b32 v64, 0
    v_mfma_f32_16x16x32_bf16 v[150:153], a[12:15], a[240:243], v[150:153]
    buffer_load_dwordx4 v174, s[8:11], s63 offen offset:2048 lds
    v_mov_b32 v65, 0xf149f2ca
    v_mfma_f32_16x16x32_bf16 v[154:157], a[36:39], a[240:243], v[154:157]
    ds_read_b128 a[236:239], v240 offset:32512
    v_cndmask_b32 v60, v65, v64, vcc
    v_mfma_f32_16x16x32_bf16 v[158:161], a[60:63], a[240:243], v[158:161]
    s_add_u32 m0, s46, 0xfc00
    v_cmp_ne_u32 vcc, 0, v23
    v_add_u32 v63, 1, v20
    v_mfma_f32_16x16x32_bf16 v[162:165], a[12:15], a[244:247], v[162:165]
    s_waitcnt lgkmcnt(6)
    v_add3_u32 v64, v22, v63, -6
    v_and_b32 v66, 12, v22
    v_mfma_f32_16x16x32_bf16 v[24:27], a[36:39], a[244:247], v[24:27]
    buffer_load_dwordx4 v168, s[4:7], s59 offen lds
    s_waitcnt lgkmcnt(4)
    v_mfma_f32_16x16x32_bf16 v[54:57], a[60:63], a[244:247], v[54:57]
    ds_read_b128 a[240:243], v240 offset:34048
    s_waitcnt lgkmcnt(3)
    v_mfma_f32_16x16x32_bf16 v[204:207], a[16:19], a[216:219], v[204:207]
    ds_read_b128 a[244:247], v240 offset:35584
    v_add_u32 v65, 3, v64
    v_mfma_f32_16x16x32_bf16 v[208:211], a[40:43], a[216:219], v[208:211]
    s_add_u32 m0, s29, 0
    v_add3_u32 v66, v66, v63, -3
    v_cndmask_b32 v65, v65, v66, vcc
    v_mfma_f32_16x16x32_bf16 v[212:215], a[64:67], a[216:219], v[212:215]
    buffer_load_dwordx4 v172, s[8:11], s60 offen lds
    v_cmp_gt_u32 vcc, 7, v65
    v_mfma_f32_16x16x32_bf16 v[216:219], a[16:19], a[220:223], v[216:219]
    ds_read_b128 a[216:219], v241 offset:256
    v_mul_i32_i24 v64, s66, v64
    v_mfma_f32_16x16x32_bf16 v[220:223], a[40:43], a[220:223], v[220:223]
    s_add_u32 m0, s46, 0xfc00
    v_add_lshl_u32 v64, v64, 6, 1
    v_cndmask_b32 v51, 0, v64, vcc
    v_mfma_f32_16x16x32_bf16 v[224:227], a[64:67], a[220:223], v[224:227]
    ds_read_b128 a[220:223], v241 offset:1792
    v_mov_b32 v64, 0x3fb8aa3b
    v_mfma_f32_16x16x32_bf16 v[180:183], a[16:19], a[224:227], v[180:183]
    s_waitcnt lgkmcnt(5)
    v_cndmask_b32 v53, 0, v64, vcc
    v_mov_b32 v64, 0
    v_mfma_f32_16x16x32_bf16 v[184:187], a[40:43], a[224:227], v[184:187]
    buffer_load_dwordx4 v169, s[4:7], s59 offen offset:1024 lds
    v_mov_b32 v65, 0xf149f2ca
    v_mfma_f32_16x16x32_bf16 v[188:191], a[64:67], a[224:227], v[188:191]
    ds_read_b128 a[224:227], v241 offset:3328
    v_cndmask_b32 v61, v65, v64, vcc
    v_mfma_f32_16x16x32_bf16 v[192:195], a[16:19], a[228:231], v[192:195]
    s_waitcnt lgkmcnt(5)
    v_lshlrev_b32 v63, 3, v1
    v_mov_b32 v64, 0xf149f2ca
    v_mfma_f32_16x16x32_bf16 v[196:199], a[40:43], a[228:231], v[196:199]
    s_add_u32 m0, s29, 0
    v_mov_b32 v65, 0xf149f2ca
    v_add_u32 v63, 0x237c0, v63
    v_mfma_f32_16x16x32_bf16 v[200:203], a[64:67], a[228:231], v[200:203]
    buffer_load_dwordx4 v173, s[8:11], s60 offen offset:1024 lds
    v_mbcnt_lo_u32_b32 v67, -1, 0
    v_mfma_f32_16x16x32_bf16 v[228:231], a[16:19], a[232:235], v[228:231]
    s_waitcnt vmcnt(14)
    ds_read_b64_tr_b16 a[20:21], v249 offset:3072
    v_mfma_f32_16x16x32_bf16 v[232:235], a[40:43], a[232:235], v[232:235]
    ds_read_b64_tr_b16 a[22:23], v250 offset:3072
    ds_read_b64_tr_b16 a[44:45], v249 offset:3104
    v_mfma_f32_16x16x32_bf16 v[236:239], a[64:67], a[232:235], v[236:239]
    ds_read_b64_tr_b16 a[46:47], v250 offset:3104
    ds_read_b64_tr_b16 a[68:69], v249 offset:3136
    v_mfma_f32_16x16x32_bf16 v[138:141], a[16:19], a[236:239], v[138:141]
    ds_read_b64_tr_b16 a[70:71], v250 offset:3136
    s_waitcnt lgkmcnt(9)
    v_mfma_f32_16x16x32_bf16 v[142:145], a[40:43], a[236:239], v[142:145]
    ds_read_b128 a[228:231], v241 offset:4864
    v_mbcnt_hi_u32_b32 v67, -1, v67
    v_mfma_f32_16x16x32_bf16 v[146:149], a[64:67], a[236:239], v[146:149]
    s_add_u32 m0, s46, 0xfc00
    v_lshrrev_b32 v68, 1, v67
    v_add_u32 v68, 0, v68
    v_mfma_f32_16x16x32_bf16 v[150:153], a[16:19], a[240:243], v[150:153]
    buffer_load_dwordx4 v170, s[4:7], s59 offen offset:2048 lds
    v_mul_u32_u24 v69, 43, v68
    v_mfma_f32_16x16x32_bf16 v[154:157], a[40:43], a[240:243], v[154:157]
    ds_read_b128 a[232:235], v241 offset:30976
    v_lshrrev_b32 v70, 8, v69
    v_mfma_f32_16x16x32_bf16 v[158:161], a[64:67], a[240:243], v[158:161]
    ds_read_b128 a[236:239], v241 offset:32512
    v_lshrrev_b32 v69, 7, v69
    v_mfma_f32_16x16x32_bf16 v[162:165], a[16:19], a[244:247], v[162:165]
    s_waitcnt lgkmcnt(7)
    v_mad_i32_i24 v68, v69, -3, v68
    v_and_b32 v70, 4, v70
    v_mfma_f32_16x16x32_bf16 v[24:27], a[40:43], a[244:247], v[24:27]
    s_add_u32 m0, s29, 0
    s_waitcnt lgkmcnt(5)
    v_xor_b32 v69, v69, v70
    v_mfma_f32_16x16x32_bf16 v[54:57], a[64:67], a[244:247], v[54:57]
    buffer_load_dwordx4 v174, s[8:11], s60 offen offset:2048 lds
    s_waitcnt lgkmcnt(3)
    v_mfma_f32_16x16x32_bf16 v[204:207], a[20:23], a[216:219], v[204:207]
    ds_read_b128 a[240:243], v241 offset:34048
    v_and_b32 v70, 4, v69
    v_mfma_f32_16x16x32_bf16 v[208:211], a[44:47], a[216:219], v[208:211]
    ds_read_b128 a[244:247], v241 offset:35584
    v_mul_u32_u24 v252, 24, v70
    v_mfma_f32_16x16x32_bf16 v[212:215], a[68:71], a[216:219], v[212:215]
    ds_read_b128 a[216:219], v240 offset:0
    v_lshrrev_b32 v70, 3, v69
    v_mfma_f32_16x16x32_bf16 v[216:219], a[20:23], a[220:223], v[216:219]
    s_add_u32 m0, s29, 0xc00
    v_cvt_pk_bf16_f32 v102, v204, v205
    v_cvt_pk_bf16_f32 v103, v206, v207
    v_mfma_f32_16x16x32_bf16 v[220:223], a[44:47], a[220:223], v[220:223]
    buffer_load_dwordx4 v172, s[8:11], s61 offen lds
    v_cvt_pk_bf16_f32 v104, v208, v209
    v_mfma_f32_16x16x32_bf16 v[224:227], a[68:71], a[220:223], v[224:227]
    ds_read_b128 a[220:223], v240 offset:1536
    s_waitcnt lgkmcnt(6)
    v_mfma_f32_16x16x32_bf16 v[180:183], a[20:23], a[224:227], v[180:183]
    s_add_u32 s63, s39, 0x2d300
    v_cvt_pk_bf16_f32 v105, v210, v211
    v_cvt_pk_bf16_f32 v106, v212, v213
    v_mfma_f32_16x16x32_bf16 v[184:187], a[44:47], a[224:227], v[184:187]
    s_add_u32 s60, s39, 0
    v_cvt_pk_bf16_f32 v107, v214, v215
    v_cvt_pk_bf16_f32 v108, v216, v217
    v_mfma_f32_16x16x32_bf16 v[188:191], a[68:71], a[224:227], v[188:191]
    ds_read_b128 a[224:227], v240 offset:3072
    s_waitcnt lgkmcnt(6)
    v_mfma_f32_16x16x32_bf16 v[192:195], a[20:23], a[228:231], v[192:195]
    buffer_load_dwordx4 v173, s[8:11], s61 offen offset:1024 lds
    s_waitcnt lgkmcnt(5)
    v_mfma_f32_16x16x32_bf16 v[196:199], a[44:47], a[228:231], v[196:199]
    s_mul_i32 s64, s35, 0xfc0
    v_cvt_pk_bf16_f32 v109, v218, v219
    v_cvt_pk_bf16_f32 v110, v220, v221
    v_mfma_f32_16x16x32_bf16 v[200:203], a[68:71], a[228:231], v[200:203]
    ds_read_b128 a[228:231], v240 offset:4608
    v_cvt_pk_bf16_f32 v111, v222, v223
    v_mfma_f32_16x16x32_bf16 v[228:231], a[20:23], a[232:235], v[228:231]
    s_waitcnt vmcnt(14)
    ds_read_b64_tr_b16 a[72:73], v249 offset:6144
    v_mfma_f32_16x16x32_bf16 v[232:235], a[44:47], a[232:235], v[232:235]
    ds_read_b64_tr_b16 a[74:75], v250 offset:6144
    ds_read_b64_tr_b16 a[96:97], v249 offset:6176
    v_mfma_f32_16x16x32_bf16 v[236:239], a[68:71], a[232:235], v[236:239]
    ds_read_b64_tr_b16 a[98:99], v250 offset:6176
    ds_read_b64_tr_b16 a[120:121], v249 offset:6208
    v_mfma_f32_16x16x32_bf16 v[138:141], a[20:23], a[236:239], v[138:141]
    ds_read_b64_tr_b16 a[122:123], v250 offset:6208
    s_waitcnt lgkmcnt(9)
    v_mfma_f32_16x16x32_bf16 v[142:145], a[44:47], a[236:239], v[142:145]
    ds_read_b128 a[232:235], v240 offset:30720
    v_cvt_pk_bf16_f32 v112, v224, v225
    v_mfma_f32_16x16x32_bf16 v[146:149], a[68:71], a[236:239], v[146:149]
    ds_read_b128 a[236:239], v240 offset:32256
    v_cvt_pk_bf16_f32 v113, v226, v227
    v_mfma_f32_16x16x32_bf16 v[150:153], a[20:23], a[240:243], v[150:153]
    buffer_load_dwordx4 v174, s[8:11], s61 offen offset:2048 lds
    v_cvt_pk_bf16_f32 v90, v180, v181
    v_mfma_f32_16x16x32_bf16 v[154:157], a[44:47], a[240:243], v[154:157]
    s_add_u32 m0, s29, 0x1800
    v_cvt_pk_bf16_f32 v91, v182, v183
    v_cvt_pk_bf16_f32 v92, v184, v185
    v_mfma_f32_16x16x32_bf16 v[158:161], a[68:71], a[240:243], v[158:161]
    ds_read_b128 a[240:243], v240 offset:33792
    v_cvt_pk_bf16_f32 v93, v186, v187
    v_mfma_f32_16x16x32_bf16 v[162:165], a[20:23], a[244:247], v[162:165]
    s_waitcnt lgkmcnt(7)
    v_cvt_pk_bf16_f32 v94, v188, v189
    v_cvt_pk_bf16_f32 v95, v190, v191
    v_mfma_f32_16x16x32_bf16 v[24:27], a[44:47], a[244:247], v[24:27]
    s_add_u32 s61, s39, 0x9000
    s_waitcnt lgkmcnt(5)
    v_cvt_pk_bf16_f32 v96, v192, v193
    v_mfma_f32_16x16x32_bf16 v[54:57], a[68:71], a[244:247], v[54:57]
    s_add_u32 s64, s64, s37
    s_waitcnt lgkmcnt(3)
    v_cvt_pk_bf16_f32 v97, v194, v195
    v_mfma_f32_16x16x32_bf16 v[84:87], a[216:219], a[72:75], 0
    s_add_u32 s50, s31, 0xfffffe80
    v_cvt_pk_bf16_f32 v98, v196, v197
    v_cvt_pk_bf16_f32 v99, v198, v199
    v_mfma_f32_16x16x32_bf16 v[204:207], a[216:219], a[96:99], 0
    ds_read_b128 a[244:247], v240 offset:35328
    v_cvt_pk_bf16_f32 v100, v200, v201
    v_mfma_f32_16x16x32_bf16 v[208:211], a[216:219], a[120:123], 0
    s_add_u32 s59, s43, s45
    v_cvt_pk_bf16_f32 v101, v202, v203
    v_cvt_pk_bf16_f32 v114, v228, v229
    v_mfma_f32_16x16x32_bf16 v[212:215], a[220:223], a[72:75], 0
    s_mov_b32 vcc_lo, 0xcccccccc
    v_cvt_pk_bf16_f32 v115, v230, v231
    v_cvt_pk_bf16_f32 v116, v232, v233
    v_mfma_f32_16x16x32_bf16 v[216:219], a[220:223], a[96:99], 0
    ds_read_b128 a[216:219], v241 offset:0
    v_cvt_pk_bf16_f32 v117, v234, v235
    v_mfma_f32_16x16x32_bf16 v[220:223], a[220:223], a[120:123], 0
    s_mov_b32 vcc_hi, 0xcccccccc
    v_cvt_pk_bf16_f32 v118, v236, v237
    v_cvt_pk_bf16_f32 v119, v238, v239
    v_mfma_f32_16x16x32_bf16 v[224:227], a[224:227], a[72:75], 0
    s_waitcnt lgkmcnt(4)
    v_cvt_pk_bf16_f32 v120, v138, v139
    v_cvt_pk_bf16_f32 v121, v140, v141
    v_mfma_f32_16x16x32_bf16 v[180:183], a[224:227], a[96:99], 0
    s_waitcnt lgkmcnt(3)
    v_cvt_pk_bf16_f32 v122, v142, v143
    v_cvt_pk_bf16_f32 v123, v144, v145
    v_mfma_f32_16x16x32_bf16 v[184:187], a[224:227], a[120:123], 0
    ds_read_b128 a[220:223], v241 offset:1536
    v_cvt_pk_bf16_f32 v124, v146, v147
    v_mfma_f32_16x16x32_bf16 v[188:191], a[228:231], a[72:75], 0
    s_mul_i32 s66, s28, 0xffffee00
    v_cvt_pk_bf16_f32 v125, v148, v149
    v_cvt_pk_bf16_f32 v126, v150, v151
    v_mfma_f32_16x16x32_bf16 v[192:195], a[228:231], a[96:99], 0
    s_waitcnt lgkmcnt(3)
    v_cvt_pk_bf16_f32 v127, v152, v153
    v_cvt_pk_bf16_f32 v128, v154, v155
    v_mfma_f32_16x16x32_bf16 v[196:199], a[228:231], a[120:123], 0
    ds_read_b128 a[224:227], v241 offset:3072
    v_cvt_pk_bf16_f32 v129, v156, v157
    v_mfma_f32_16x16x32_bf16 v[200:203], a[232:235], a[72:75], 0
    s_waitcnt vmcnt(9)
    ds_read_b64_tr_b16 a[76:77], v249 offset:9216
    v_mfma_f32_16x16x32_bf16 v[228:231], a[232:235], a[96:99], 0
    ds_read_b64_tr_b16 a[78:79], v250 offset:9216
    ds_read_b64_tr_b16 a[100:101], v249 offset:9248
    v_mfma_f32_16x16x32_bf16 v[232:235], a[232:235], a[120:123], 0
    ds_read_b64_tr_b16 a[102:103], v250 offset:9248
    ds_read_b64_tr_b16 a[124:125], v249 offset:9280
    v_mfma_f32_16x16x32_bf16 v[236:239], a[236:239], a[72:75], 0
    ds_read_b64_tr_b16 a[126:127], v250 offset:9280
    v_cvt_pk_bf16_f32 v130, v158, v159
    v_mfma_f32_16x16x32_bf16 v[138:141], a[236:239], a[96:99], 0
    buffer_load_dwordx4 v172, s[8:11], s62 offen lds
    v_cvt_pk_bf16_f32 v131, v160, v161
    v_mfma_f32_16x16x32_bf16 v[142:145], a[236:239], a[120:123], 0
    s_waitcnt lgkmcnt(8)
    v_cvt_pk_bf16_f32 v132, v162, v163
    v_cvt_pk_bf16_f32 v133, v164, v165
    v_mfma_f32_16x16x32_bf16 v[146:149], a[240:243], a[72:75], 0
    s_mul_i32 s67, s36, 3
    v_cvt_pk_bf16_f32 v134, v24, v25
    v_cvt_pk_bf16_f32 v135, v26, v27
    v_mfma_f32_16x16x32_bf16 v[150:153], a[240:243], a[96:99], 0
    ds_read_b128 a[228:231], v241 offset:4608
    v_add_u32 v62, s64, v62
    v_mfma_f32_16x16x32_bf16 v[154:157], a[240:243], a[120:123], 0
    buffer_load_dwordx4 v173, s[8:11], s62 offen offset:1024 lds
    v_lshl_add_u32 v252, v70, 2, v252
    v_mfma_f32_16x16x32_bf16 v[158:161], a[244:247], a[72:75], 0
    s_waitcnt lgkmcnt(5)
    v_and_or_b32 v252, v69, 3, v252
    v_mad_u32_u24 v252, v252, 3, v68
    v_mfma_f32_16x16x32_bf16 v[162:165], a[244:247], a[96:99], 0
    ds_read_b128 a[232:235], v241 offset:30720
    s_waitcnt lgkmcnt(4)
    v_mfma_f32_16x16x32_bf16 v[24:27], a[244:247], a[120:123], 0
    ds_read_b128 a[236:239], v241 offset:32256
    s_waitcnt lgkmcnt(3)
    v_mfma_f32_16x16x32_bf16 v[84:87], a[216:219], a[76:79], v[84:87]
    buffer_load_dwordx4 v174, s[8:11], s62 offen offset:2048 lds
    v_lshrrev_b32 v68, 1, v67
    v_mfma_f32_16x16x32_bf16 v[204:207], a[216:219], a[100:103], v[204:207]
    ds_read_b128 a[240:243], v241 offset:33792
    v_and_b32 v70, 1, v67
    v_mfma_f32_16x16x32_bf16 v[208:211], a[216:219], a[124:127], v[208:211]
    ds_read_b128 a[244:247], v241 offset:35328
    v_add_u32 v68, 32, v68
    v_mfma_f32_16x16x32_bf16 v[212:215], a[220:223], a[76:79], v[212:215]
    ds_read_b128 a[216:219], v240 offset:128
    v_lshl_add_u32 v252, v252, 3, v70
    v_mfma_f32_16x16x32_bf16 v[216:219], a[220:223], a[100:103], v[216:219]
    s_add_u32 m0, s29, 0x2400
    v_mul_u32_u24 v69, 43, v68
    v_lshrrev_b32 v70, 8, v69
    v_mfma_f32_16x16x32_bf16 v[220:223], a[220:223], a[124:127], v[220:223]
    ds_read_b128 a[220:223], v240 offset:1664
    v_lshrrev_b32 v69, 7, v69
    v_mfma_f32_16x16x32_bf16 v[224:227], a[224:227], a[76:79], v[224:227]
    s_waitcnt lgkmcnt(6)
    v_mad_i32_i24 v68, v69, -3, v68
    v_and_b32 v70, 4, v70
    v_mfma_f32_16x16x32_bf16 v[180:183], a[224:227], a[100:103], v[180:183]
    buffer_load_dwordx4 v172, s[8:11], s63 offen lds
    v_xor_b32 v69, v69, v70
    v_mfma_f32_16x16x32_bf16 v[184:187], a[224:227], a[124:127], v[184:187]
    ds_read_b128 a[224:227], v240 offset:3200
    v_and_b32 v70, 4, v69
    v_mfma_f32_16x16x32_bf16 v[188:191], a[228:231], a[76:79], v[188:191]
    s_waitcnt lgkmcnt(6)
    v_mul_u32_u24 v253, 24, v70
    v_lshrrev_b32 v70, 3, v69
    v_mfma_f32_16x16x32_bf16 v[192:195], a[228:231], a[100:103], v[192:195]
    s_add_u32 s62, s39, 0x12000
    v_lshl_add_u32 v253, v70, 2, v253
    v_and_b32 v70, 1, v67
    v_mfma_f32_16x16x32_bf16 v[196:199], a[228:231], a[124:127], v[196:199]
    ds_read_b128 a[228:231], v240 offset:4736
    v_add_u32 v8, 4, v2
    v_mfma_f32_16x16x32_bf16 v[200:203], a[232:235], a[76:79], v[200:203]
    s_waitcnt vmcnt(7) lgkmcnt(6)
    ds_read_b64_tr_b16 a[80:81], v249 offset:0
    v_mfma_f32_16x16x32_bf16 v[228:231], a[232:235], a[100:103], v[228:231]
    ds_read_b64_tr_b16 a[82:83], v250 offset:0
    ds_read_b64_tr_b16 a[104:105], v249 offset:32
    v_mfma_f32_16x16x32_bf16 v[232:235], a[232:235], a[124:127], v[232:235]
    ds_read_b64_tr_b16 a[106:107], v250 offset:32
    ds_read_b64_tr_b16 a[128:129], v249 offset:64
    v_mfma_f32_16x16x32_bf16 v[236:239], a[236:239], a[76:79], v[236:239]
    ds_read_b64_tr_b16 a[130:131], v250 offset:64
    s_waitcnt lgkmcnt(10)
    v_mfma_f32_16x16x32_bf16 v[138:141], a[236:239], a[100:103], v[138:141]
    buffer_load_dwordx4 v173, s[8:11], s63 offen offset:1024 lds
    v_and_or_b32 v253, v69, 3, v253
    v_mfma_f32_16x16x32_bf16 v[142:145], a[236:239], a[124:127], v[142:145]
    ds_read_b128 a[232:235], v240 offset:30848
    v_mad_u32_u24 v253, v253, 3, v68
    v_mfma_f32_16x16x32_bf16 v[146:149], a[240:243], a[76:79], v[146:149]
    ds_read_b128 a[236:239], v240 offset:32384
    v_lshl_add_u32 v253, v253, 3, v70
    v_mfma_f32_16x16x32_bf16 v[150:153], a[240:243], a[100:103], v[150:153]
    s_and_b32 s64, s48, 15
    v_mul_u32_u24 v8, 11, v8
    v_bfe_u32 v9, v8, 6, 1
    v_mfma_f32_16x16x32_bf16 v[154:157], a[240:243], a[124:127], v[154:157]
    buffer_load_dwordx4 v174, s[8:11], s63 offen offset:2048 lds
    v_lshrrev_b32 v8, 5, v8
    v_mfma_f32_16x16x32_bf16 v[158:161], a[244:247], a[76:79], v[158:161]
    s_waitcnt lgkmcnt(6)
    v_xor_b32 v9, v3, v9
    v_mad_i32_i24 v8, v8, s50, v4
    v_mfma_f32_16x16x32_bf16 v[162:165], a[244:247], a[100:103], v[162:165]
    ds_read_b128 a[240:243], v240 offset:33920
    s_waitcnt lgkmcnt(5)
    v_mfma_f32_16x16x32_bf16 v[24:27], a[244:247], a[124:127], v[24:27]
    ds_read_b128 a[244:247], v240 offset:35456
    s_waitcnt lgkmcnt(4)
    v_mfma_f32_16x16x32_bf16 v[84:87], a[216:219], a[80:83], v[84:87]
    s_add_u32 m0, s29, 0
    v_lshl_add_u32 v171, v9, 4, v8
    v_xor_b32 v243, 64, v242
    v_mfma_f32_16x16x32_bf16 v[204:207], a[216:219], a[104:107], v[204:207]
    buffer_load_dwordx4 v172, s[8:11], s60 offen lds
    v_add_u32 v244, 0x237c0, v244
    v_mfma_f32_16x16x32_bf16 v[208:211], a[216:219], a[128:131], v[208:211]
    ds_read_b128 a[216:219], v241 offset:128
    v_add_u32 v245, 0x237c0, v245
    v_mfma_f32_16x16x32_bf16 v[212:215], a[220:223], a[80:83], v[212:215]
    s_add_u32 s64, s64, s37
    v_add_u32 v50, s64, v50
    v_add_u32 v51, s64, v51
    v_mfma_f32_16x16x32_bf16 v[216:219], a[220:223], a[104:107], v[216:219]
    ds_read_u16 v30, v50 offset:3456
    v_add_u32 v246, 0x237c0, v246
    v_mfma_f32_16x16x32_bf16 v[220:223], a[220:223], a[128:131], v[220:223]
    ds_read_b128 a[220:223], v241 offset:1664
    v_accvgpr_write_b32 a252, v168
    v_mfma_f32_16x16x32_bf16 v[224:227], a[224:227], a[80:83], v[224:227]
    ds_read_u16 v31, v51 offset:3456
    s_waitcnt lgkmcnt(7)
    v_mfma_f32_16x16x32_bf16 v[180:183], a[224:227], a[104:107], v[180:183]
    ds_read_u16 v32, v50 offset:3482
    v_accvgpr_write_b32 a253, v169
    v_mfma_f32_16x16x32_bf16 v[184:187], a[224:227], a[128:131], v[184:187]
    s_waitcnt lgkmcnt(7)
    v_accvgpr_write_b32 a254, v170
    v_accvgpr_write_b32 a255, v171
    v_mfma_f32_16x16x32_bf16 v[188:191], a[228:231], a[80:83], v[188:191]
    ds_read_b128 a[224:227], v241 offset:3200
    v_mov_b32 v248, 0
    v_mfma_f32_16x16x32_bf16 v[192:195], a[228:231], a[104:107], v[192:195]
    buffer_load_dwordx4 v173, s[8:11], s60 offen offset:1024 lds
    v_cvt_pk_bf16_f32 v136, v54, v55
    v_mfma_f32_16x16x32_bf16 v[196:199], a[228:231], a[128:131], v[196:199]
    ds_read_b128 a[228:231], v241 offset:4736
    v_cvt_pk_bf16_f32 v137, v56, v57
    v_mfma_f32_16x16x32_bf16 v[200:203], a[232:235], a[80:83], v[200:203]
    s_waitcnt vmcnt(8) lgkmcnt(8)
    ds_read_b64_tr_b16 a[84:85], v249 offset:3072
    v_mfma_f32_16x16x32_bf16 v[228:231], a[232:235], a[104:107], v[228:231]
    ds_read_b64_tr_b16 a[86:87], v250 offset:3072
    ds_read_b64_tr_b16 a[108:109], v249 offset:3104
    v_mfma_f32_16x16x32_bf16 v[232:235], a[232:235], a[128:131], v[232:235]
    ds_read_b64_tr_b16 a[110:111], v250 offset:3104
    ds_read_b64_tr_b16 a[132:133], v249 offset:3136
    v_mfma_f32_16x16x32_bf16 v[236:239], a[236:239], a[80:83], v[236:239]
    ds_read_b64_tr_b16 a[134:135], v250 offset:3136
    s_waitcnt lgkmcnt(12)
    v_mfma_f32_16x16x32_bf16 v[138:141], a[236:239], a[104:107], v[138:141]
    ds_read_b128 a[232:235], v241 offset:30848
    v_accvgpr_read_b32 v254, a252
    v_mfma_f32_16x16x32_bf16 v[142:145], a[236:239], a[128:131], v[142:145]
    ds_read_b128 a[236:239], v241 offset:32384
    v_accvgpr_read_b32 v255, a253
    v_mfma_f32_16x16x32_bf16 v[146:149], a[240:243], a[80:83], v[146:149]
    buffer_load_dwordx4 v174, s[8:11], s60 offen offset:2048 lds
    v_lshlrev_b32 v252, 4, v252
    v_mfma_f32_16x16x32_bf16 v[150:153], a[240:243], a[104:107], v[150:153]
    s_add_u32 m0, s29, 0xc00
    v_lshlrev_b32 v253, 4, v253
    v_add_u32 v253, 0xfffffc00, v253
    v_mfma_f32_16x16x32_bf16 v[154:157], a[240:243], a[128:131], v[154:157]
    ds_read_b128 a[240:243], v241 offset:33920
    ds_read_u16 v33, v51 offset:3482
    v_mfma_f32_16x16x32_bf16 v[158:161], a[244:247], a[80:83], v[158:161]
    s_waitcnt lgkmcnt(8)
    v_lshlrev_b32 v30, 16, v30
    v_lshlrev_b32 v31, 16, v31
    v_mfma_f32_16x16x32_bf16 v[162:165], a[244:247], a[104:107], v[162:165]
    s_waitcnt lgkmcnt(6)
    v_fma_f32 v30, v30, v52, v60
    v_fma_f32 v31, v31, v53, v61
    v_mfma_f32_16x16x32_bf16 v[24:27], a[244:247], a[128:131], v[24:27]
    ds_read_b128 a[244:247], v241 offset:35456
    s_waitcnt lgkmcnt(5)
    v_mfma_f32_16x16x32_bf16 v[84:87], a[216:219], a[84:87], v[84:87]
    ds_read_u16 v34, v50 offset:3508
    v_lshlrev_b32 v32, 16, v32
    v_mfma_f32_16x16x32_bf16 v[204:207], a[216:219], a[108:111], v[204:207]
    buffer_load_dwordx4 v172, s[8:11], s61 offen lds
    v_fma_f32 v32, v32, v52, v60
    v_mfma_f32_16x16x32_bf16 v[208:211], a[216:219], a[132:135], v[208:211]
    ds_read_b128 a[216:219], v240 offset:256
    ds_read_u16 v35, v51 offset:3508
    v_mfma_f32_16x16x32_bf16 v[212:215], a[220:223], a[84:87], v[212:215]
    s_barrier
    ds_read_u16 v37, v51 offset:3534
    v_mfma_f32_16x16x32_bf16 v[216:219], a[220:223], a[108:111], v[216:219]
    ds_read_u16 v39, v51 offset:3560
    ds_read_u16 v41, v51 offset:3586
    v_mfma_f32_16x16x32_bf16 v[220:223], a[220:223], a[132:135], v[220:223]
    s_waitcnt lgkmcnt(10)
    ds_read_b128 a[220:223], v240 offset:1792
    v_mfma_f32_16x16x32_bf16 v[224:227], a[224:227], a[84:87], v[224:227]
    s_waitcnt lgkmcnt(10)
    ds_read_u16 v43, v51 offset:3612
    v_mfma_f32_16x16x32_bf16 v[180:183], a[224:227], a[108:111], v[180:183]
    ds_read_u16 v45, v51 offset:3638
    buffer_load_dwordx4 v173, s[8:11], s61 offen offset:1024 lds
    v_mfma_f32_16x16x32_bf16 v[184:187], a[224:227], a[132:135], v[184:187]
    ds_read_b128 a[224:227], v240 offset:3328
    ds_read_u16 v47, v51 offset:3664
    v_mfma_f32_16x16x32_bf16 v[188:191], a[228:231], a[84:87], v[188:191]
    s_waitcnt lgkmcnt(13)
    ds_read_u16 v49, v51 offset:3690
    v_mfma_f32_16x16x32_bf16 v[192:195], a[228:231], a[108:111], v[192:195]
    s_add_u32 s63, s39, 0x1b000
    ds_read_u16 v36, v50 offset:3534
    v_mfma_f32_16x16x32_bf16 v[196:199], a[228:231], a[132:135], v[196:199]
    ds_read_b128 a[228:231], v240 offset:4864
    ds_read_u16 v38, v50 offset:3560
    v_mfma_f32_16x16x32_bf16 v[200:203], a[232:235], a[84:87], v[200:203]
    s_waitcnt vmcnt(8) lgkmcnt(15)
    ds_read_b64_tr_b16 a[88:89], v249 offset:6144
    v_mfma_f32_16x16x32_bf16 v[228:231], a[232:235], a[108:111], v[228:231]
    ds_read_b64_tr_b16 a[90:91], v250 offset:6144
    ds_read_b64_tr_b16 a[112:113], v249 offset:6176
    v_mfma_f32_16x16x32_bf16 v[232:235], a[232:235], a[132:135], v[232:235]
    ds_read_b64_tr_b16 a[114:115], v250 offset:6176
    ds_read_b64_tr_b16 a[136:137], v249 offset:6208
    v_mfma_f32_16x16x32_bf16 v[236:239], a[236:239], a[84:87], v[236:239]
    ds_read_b64_tr_b16 a[138:139], v250 offset:6208
    v_lshlrev_b32 v33, 16, v33
    v_mfma_f32_16x16x32_bf16 v[138:141], a[236:239], a[108:111], v[138:141]
    ds_read_b128 a[232:235], v240 offset:30976
    v_fma_f32 v33, v33, v53, v61
    v_mfma_f32_16x16x32_bf16 v[142:145], a[236:239], a[132:135], v[142:145]
    ds_read_b128 a[236:239], v240 offset:32512
    buffer_load_dwordx4 v174, s[8:11], s61 offen offset:2048 lds
    v_mfma_f32_16x16x32_bf16 v[146:149], a[240:243], a[84:87], v[146:149]
    s_add_u32 m0, s29, 0x1800
    ds_read_u16 v40, v50 offset:3586
    v_mfma_f32_16x16x32_bf16 v[150:153], a[240:243], a[108:111], v[150:153]
    ds_read_u16 v42, v50 offset:3612
    ds_read_u16 v44, v50 offset:3638
    v_mfma_f32_16x16x32_bf16 v[154:157], a[240:243], a[132:135], v[154:157]
    ds_read_b128 a[240:243], v240 offset:34048
    ds_read_u16 v46, v50 offset:3664
    v_mfma_f32_16x16x32_bf16 v[158:161], a[244:247], a[84:87], v[158:161]
    s_waitcnt lgkmcnt(11)
    v_lshlrev_b32 v34, 16, v34
    v_lshlrev_b32 v35, 16, v35
    v_mfma_f32_16x16x32_bf16 v[162:165], a[244:247], a[108:111], v[162:165]
    s_waitcnt lgkmcnt(9)
    v_fma_f32 v34, v34, v52, v60
    v_fma_f32 v35, v35, v53, v61
    v_mfma_f32_16x16x32_bf16 v[24:27], a[244:247], a[132:135], v[24:27]
    s_waitcnt lgkmcnt(7)
    v_lshlrev_b32 v37, 16, v37
    v_lshlrev_b32 v39, 16, v39
    v_mfma_f32_16x16x32_bf16 v[84:87], a[216:219], a[88:91], v[84:87]
    ds_read_b128 a[244:247], v240 offset:35584
    v_lshlrev_b32 v41, 16, v41
    v_mfma_f32_16x16x32_bf16 v[204:207], a[216:219], a[112:115], v[204:207]
    buffer_load_dwordx4 v172, s[8:11], s62 offen lds
    v_lshlrev_b32 v43, 16, v43
    v_mfma_f32_16x16x32_bf16 v[208:211], a[216:219], a[136:139], v[208:211]
    ds_read_b128 a[216:219], v241 offset:256
    v_lshlrev_b32 v45, 16, v45
    v_mfma_f32_16x16x32_bf16 v[212:215], a[220:223], a[88:91], v[212:215]
    ds_read_u16 v48, v50 offset:3690
    v_lshlrev_b32 v47, 16, v47
    v_mfma_f32_16x16x32_bf16 v[216:219], a[220:223], a[112:115], v[216:219]
    ds_write_b64 v62, v[30:31] offset:0
    v_mfma_f32_16x16x32_bf16 v[220:223], a[220:223], a[136:139], v[220:223]
    s_waitcnt lgkmcnt(10)
    v_add_u32 v62, s49, v62
    v_lshlrev_b32 v49, 16, v49
    v_mfma_f32_16x16x32_bf16 v[224:227], a[224:227], a[88:91], v[224:227]
    s_waitcnt lgkmcnt(9)
    v_fma_f32 v37, v37, v53, v61
    v_fma_f32 v39, v39, v53, v61
    v_mfma_f32_16x16x32_bf16 v[180:183], a[224:227], a[112:115], v[180:183]
    ds_read_b128 a[220:223], v241 offset:1792
    v_fma_f32 v41, v41, v53, v61
    v_mfma_f32_16x16x32_bf16 v[184:187], a[224:227], a[136:139], v[184:187]
    ds_read_b128 a[224:227], v241 offset:3328
    v_fma_f32 v43, v43, v53, v61
    v_mfma_f32_16x16x32_bf16 v[188:191], a[228:231], a[88:91], v[188:191]
    buffer_load_dwordx4 v173, s[8:11], s62 offen offset:1024 lds
    v_fma_f32 v45, v45, v53, v61
    v_mfma_f32_16x16x32_bf16 v[192:195], a[228:231], a[112:115], v[192:195]
    s_waitcnt lgkmcnt(6)
    v_fma_f32 v47, v47, v53, v61
    v_fma_f32 v49, v49, v53, v61
    v_mfma_f32_16x16x32_bf16 v[196:199], a[228:231], a[136:139], v[196:199]
    ds_read_b128 a[228:231], v241 offset:4864
    v_lshlrev_b32 v36, 16, v36
    v_mfma_f32_16x16x32_bf16 v[200:203], a[232:235], a[88:91], v[200:203]
    s_waitcnt vmcnt(8)
    ds_read_b64_tr_b16 a[92:93], v249 offset:9216
    v_mfma_f32_16x16x32_bf16 v[228:231], a[232:235], a[112:115], v[228:231]
    ds_read_b64_tr_b16 a[94:95], v250 offset:9216
    ds_read_b64_tr_b16 a[116:117], v249 offset:9248
    v_mfma_f32_16x16x32_bf16 v[232:235], a[232:235], a[136:139], v[232:235]
    ds_read_b64_tr_b16 a[118:119], v250 offset:9248
    ds_read_b64_tr_b16 a[140:141], v249 offset:9280
    v_mfma_f32_16x16x32_bf16 v[236:239], a[236:239], a[88:91], v[236:239]
    ds_read_b64_tr_b16 a[142:143], v250 offset:9280
    s_waitcnt lgkmcnt(11)
    v_mfma_f32_16x16x32_bf16 v[138:141], a[236:239], a[112:115], v[138:141]
    ds_read_b128 a[232:235], v241 offset:30976
    v_fma_f32 v36, v36, v52, v60
    v_mfma_f32_16x16x32_bf16 v[142:145], a[236:239], a[136:139], v[142:145]
    ds_read_b128 a[236:239], v241 offset:32512
    v_lshlrev_b32 v38, 16, v38
    v_mfma_f32_16x16x32_bf16 v[146:149], a[240:243], a[88:91], v[146:149]
L_h2:
    s_cbranch_execz L_h6
    buffer_load_dwordx4 v174, s[8:11], s62 offen offset:2048 lds
    v_fma_f32 v38, v38, v52, v60
    v_mfma_f32_16x16x32_bf16 v[150:153], a[240:243], a[112:115], v[150:153]
    s_add_u32 m0, s29, 0x2400
    v_lshlrev_b32 v40, 16, v40
    v_fma_f32 v40, v40, v52, v60
    v_mfma_f32_16x16x32_bf16 v[154:157], a[240:243], a[136:139], v[154:157]
    ds_read_b128 a[240:243], v241 offset:34048
    v_lshlrev_b32 v42, 16, v42
    v_mfma_f32_16x16x32_bf16 v[158:161], a[244:247], a[88:91], v[158:161]
    s_waitcnt lgkmcnt(7)
    v_fma_f32 v42, v42, v52, v60
    v_lshlrev_b32 v44, 16, v44
    v_mfma_f32_16x16x32_bf16 v[162:165], a[244:247], a[112:115], v[162:165]
    ds_write_b64 v62, v[32:33] offset:0
    v_mfma_f32_16x16x32_bf16 v[24:27], a[244:247], a[136:139], v[24:27]
    s_waitcnt lgkmcnt(4)
    v_add_u32 v62, s49, v62
    v_fma_f32 v44, v44, v52, v60
    v_mfma_f32_16x16x32_bf16 v[84:87], a[216:219], a[92:95], v[84:87]
    ds_read_b128 a[244:247], v241 offset:35584
    v_lshlrev_b32 v46, 16, v46
    v_mfma_f32_16x16x32_bf16 v[204:207], a[216:219], a[116:119], v[204:207]
    buffer_load_dwordx4 v172, s[8:11], s63 offen lds
    v_fma_f32 v46, v46, v52, v60
    v_mfma_f32_16x16x32_bf16 v[208:211], a[216:219], a[140:143], v[208:211]
    ds_read_b128 a[216:219], v240 offset:61440
    v_lshlrev_b32 v48, 16, v48
    v_mfma_f32_16x16x32_bf16 v[212:215], a[220:223], a[92:95], v[212:215]
    ds_write_b64 v62, v[34:35] offset:0
    v_mfma_f32_16x16x32_bf16 v[216:219], a[220:223], a[116:119], v[216:219]
    ds_write_b64 v63, v[64:65] offset:0
    v_mfma_f32_16x16x32_bf16 v[220:223], a[220:223], a[140:143], v[220:223]
    s_waitcnt lgkmcnt(7)
    v_add_u32 v62, s49, v62
    v_fma_f32 v48, v48, v52, v60
    v_mfma_f32_16x16x32_bf16 v[224:227], a[224:227], a[92:95], v[224:227]
    s_waitcnt lgkmcnt(6)
    v_cvt_pk_bf16_f32 v30, v204, v205
    v_cvt_pk_bf16_f32 v33, v206, v207
    v_mfma_f32_16x16x32_bf16 v[180:183], a[224:227], a[116:119], v[180:183]
    ds_read_b128 a[220:223], v241 offset:61440
    v_cvt_pk_bf16_f32 v60, v208, v209
    v_mfma_f32_16x16x32_bf16 v[184:187], a[224:227], a[140:143], v[184:187]
    ds_read_b128 a[224:227], v240 offset:61568
    v_cvt_pk_bf16_f32 v63, v210, v211
    v_mfma_f32_16x16x32_bf16 v[188:191], a[228:231], a[92:95], v[188:191]
    s_waitcnt lgkmcnt(7)
    v_cvt_pk_bf16_f32 v0, v84, v85
    v_cvt_pk_bf16_f32 v3, v86, v87
    v_mfma_f32_16x16x32_bf16 v[192:195], a[228:231], a[116:119], v[192:195]
    buffer_load_dwordx4 v173, s[8:11], s63 offen offset:1024 lds
    v_cvt_pk_bf16_f32 v72, v184, v185
    v_mfma_f32_16x16x32_bf16 v[196:199], a[228:231], a[140:143], v[196:199]
    ds_read_b128 a[228:231], v241 offset:61568
    v_cvt_pk_bf16_f32 v6, v212, v213
    v_mfma_f32_16x16x32_bf16 v[200:203], a[232:235], a[92:95], v[200:203]
    s_add_u32 s60, s39, 0x24000
    v_cvt_pk_bf16_f32 v9, v214, v215
    v_cvt_pk_bf16_f32 v66, v220, v221
    v_mfma_f32_16x16x32_bf16 v[228:231], a[232:235], a[116:119], v[228:231]
    s_waitcnt lgkmcnt(6)
    v_cvt_pk_bf16_f32 v78, v196, v197
    v_cvt_pk_bf16_f32 v81, v198, v199
    v_mfma_f32_16x16x32_bf16 v[232:235], a[232:235], a[140:143], v[232:235]
    ds_read_b128 a[232:235], v240 offset:61696
    v_cvt_pk_bf16_f32 v1, v200, v201
    v_mfma_f32_16x16x32_bf16 v[236:239], a[236:239], a[92:95], v[236:239]
    ds_write_b64 v62, v[36:37] offset:0
    v_mfma_f32_16x16x32_bf16 v[138:141], a[236:239], a[116:119], v[138:141]
    s_add_u32 s61, s39, 0x2d000
    v_cvt_pk_bf16_f32 v31, v228, v229
    v_cvt_pk_bf16_f32 v34, v230, v231
    v_mfma_f32_16x16x32_bf16 v[142:145], a[236:239], a[140:143], v[142:145]
    ds_read_b128 a[236:239], v241 offset:61696
    v_cvt_pk_bf16_f32 v61, v232, v233
    v_mfma_f32_16x16x32_bf16 v[146:149], a[240:243], a[92:95], v[146:149]
    s_waitcnt lgkmcnt(6)
    v_cvt_pk_bf16_f32 v64, v234, v235
    v_cvt_pk_bf16_f32 v7, v236, v237
    v_mfma_f32_16x16x32_bf16 v[150:153], a[240:243], a[116:119], v[150:153]
    buffer_load_dwordx4 v174, s[8:11], s63 offen offset:2048 lds
    v_cvt_pk_bf16_f32 v10, v238, v239
    v_mfma_f32_16x16x32_bf16 v[154:157], a[240:243], a[140:143], v[154:157]
    s_add_u32 m0, s29, 0
    v_cvt_pk_bf16_f32 v37, v138, v139
    v_add_u32 v62, s49, v62
    v_mfma_f32_16x16x32_bf16 v[158:161], a[244:247], a[92:95], v[158:161]
    ds_write_b64 v62, v[38:39] offset:0
    v_mfma_f32_16x16x32_bf16 v[162:165], a[244:247], a[116:119], v[162:165]
    ds_read_b128 a[240:243], v240 offset:62976
    v_add_u32 v62, s49, v62
    v_mfma_f32_16x16x32_bf16 v[24:27], a[244:247], a[140:143], v[24:27]
    ds_write_b64 v62, v[40:41] offset:0
    v_mfma_f32_16x16x32_bf16 v[228:231], a[0:3], a[216:219], 0
    s_waitcnt lgkmcnt(6)
    v_cvt_pk_bf16_f32 v40, v140, v141
    v_cvt_pk_bf16_f32 v67, v142, v143
    v_mfma_f32_16x16x32_bf16 v[228:231], a[4:7], a[220:223], v[228:231]
    ds_read_b128 a[244:247], v241 offset:62976
    v_add_u32 v62, s49, v62
    v_mfma_f32_16x16x32_bf16 v[228:231], a[8:11], a[224:227], v[228:231]
    s_waitcnt vmcnt(9)
    ds_read_b64_tr_b16 a[144:145], v249 offset:0
    v_mfma_f32_16x16x32_bf16 v[228:231], a[12:15], a[228:231], v[228:231]
    s_waitcnt lgkmcnt(7)
    ds_read_b64_tr_b16 a[146:147], v250 offset:0
    v_mfma_f32_16x16x32_bf16 v[228:231], a[16:19], a[232:235], v[228:231]
    ds_read_b64_tr_b16 a[168:169], v249 offset:32
    ds_read_b64_tr_b16 a[170:171], v250 offset:32
    v_mfma_f32_16x16x32_bf16 v[232:235], a[24:27], a[216:219], 0
    ds_read_b64_tr_b16 a[192:193], v249 offset:64
    ds_read_b64_tr_b16 a[194:195], v250 offset:64
    v_mfma_f32_16x16x32_bf16 v[232:235], a[28:31], a[220:223], v[232:235]
    s_waitcnt lgkmcnt(10)
    v_cvt_pk_bf16_f32 v70, v144, v145
    v_cvt_pk_bf16_f32 v13, v146, v147
    v_mfma_f32_16x16x32_bf16 v[228:231], a[20:23], a[236:239], v[228:231]
    ds_write_b64 v62, v[42:43] offset:0
    v_mfma_f32_16x16x32_bf16 v[232:235], a[32:35], a[224:227], v[232:235]
    s_lshl_b32 s62, s28, 5
    v_add_u32 v62, s49, v62
    v_cvt_pk_bf16_f32 v16, v148, v149
    v_mfma_f32_16x16x32_bf16 v[232:235], a[36:39], a[228:231], v[232:235]
    ds_write_b64 v62, v[44:45] offset:0
    v_mfma_f32_16x16x32_bf16 v[232:235], a[40:43], a[232:235], v[232:235]
    s_add_u32 s62, s62, 0
    v_cvt_pk_bf16_f32 v138, v228, v229
    v_cvt_pk_bf16_f32 v139, v230, v231
    v_mfma_f32_16x16x32_bf16 v[232:235], a[44:47], a[236:239], v[232:235]
    s_lshl_b32 s63, s28, 5
    v_add_u32 v62, s49, v62
    v_cvt_pk_bf16_f32 v43, v150, v151
    v_mfma_f32_16x16x32_bf16 v[236:239], a[48:51], a[216:219], 0
    ds_write_b64 v62, v[46:47] offset:0
    v_mfma_f32_16x16x32_bf16 v[236:239], a[52:55], a[220:223], v[236:239]
    s_waitcnt lgkmcnt(3)
    buffer_load_dwordx4 v172, s[8:11], s60 offen lds
    v_mfma_f32_16x16x32_bf16 v[236:239], a[56:59], a[224:227], v[236:239]
    s_add_u32 s63, s63, 0x4800
    v_cvt_pk_bf16_f32 v140, v232, v233
    v_cvt_pk_bf16_f32 v141, v234, v235
    v_mfma_f32_16x16x32_bf16 v[236:239], a[60:63], a[228:231], v[236:239]
    v_add_u32 v62, s49, v62
    v_cvt_pk_bf16_f32 v46, v152, v153
    v_mfma_f32_16x16x32_bf16 v[236:239], a[64:67], a[232:235], v[236:239]
    ds_write_b64 v62, v[48:49] offset:0
    v_mfma_f32_16x16x32_bf16 v[236:239], a[68:71], a[236:239], v[236:239]
    v_add_u32 v62, s49, v62
    v_cvt_pk_bf16_f32 v73, v154, v155
    v_mfma_f32_16x16x32_bf16 v[228:231], a[216:219], a[72:75], 0
    ds_read_b128 v[196:199], v244 offset:192
    v_cvt_pk_bf16_f32 v4, v202, v203
    v_mfma_f32_16x16x32_bf16 v[228:231], a[220:223], a[76:79], v[228:231]
    ds_read_b128 v[200:203], v245 offset:192
    v_cvt_pk_bf16_f32 v42, v180, v181
    v_mfma_f32_16x16x32_bf16 v[228:231], a[224:227], a[80:83], v[228:231]
    buffer_load_dwordx4 v173, s[8:11], s60 offen offset:1024 lds
    v_cvt_pk_bf16_f32 v142, v236, v237
    v_mfma_f32_16x16x32_bf16 v[228:231], a[228:231], a[84:87], v[228:231]
    ds_read_b128 v[204:207], v246 offset:192
    v_cvt_pk_bf16_f32 v143, v238, v239
    v_mfma_f32_16x16x32_bf16 v[228:231], a[232:235], a[88:91], v[228:231]
    s_waitcnt vmcnt(8)
    ds_read_b64_tr_b16 a[148:149], v249 offset:3072
    v_mfma_f32_16x16x32_bf16 v[228:231], a[236:239], a[92:95], v[228:231]
    ds_read_b64_tr_b16 a[150:151], v250 offset:3072
    ds_read_b64_tr_b16 a[172:173], v249 offset:3104
    v_mfma_f32_16x16x32_bf16 v[232:235], a[216:219], a[96:99], 0
    ds_read_b64_tr_b16 a[174:175], v250 offset:3104
    ds_read_b64_tr_b16 a[196:197], v249 offset:3136
    v_mfma_f32_16x16x32_bf16 v[232:235], a[220:223], a[100:103], v[232:235]
    ds_read_b64_tr_b16 a[198:199], v250 offset:3136
    v_cvt_pk_bf16_f32 v45, v182, v183
    v_mfma_f32_16x16x32_bf16 v[232:235], a[224:227], a[104:107], v[232:235]
    v_cvt_pk_bf16_f32 v2, v228, v229
    v_cvt_pk_bf16_f32 v5, v230, v231
    v_mfma_f32_16x16x32_bf16 v[232:235], a[228:231], a[108:111], v[232:235]
    buffer_load_dwordx4 v174, s[8:11], s60 offen offset:2048 lds
    v_cvt_pk_bf16_f32 v76, v156, v157
    v_mfma_f32_16x16x32_bf16 v[232:235], a[232:235], a[112:115], v[232:235]
    s_add_u32 m0, s29, 0xc00
    v_cvt_pk_bf16_f32 v36, v216, v217
    v_cvt_pk_bf16_f32 v39, v218, v219
    v_mfma_f32_16x16x32_bf16 v[232:235], a[236:239], a[116:119], v[232:235]
    ds_read_b128 v[208:211], v244 offset:256
    v_cvt_pk_bf16_f32 v69, v222, v223
    v_mfma_f32_16x16x32_bf16 v[236:239], a[216:219], a[120:123], 0
    ds_read_b128 a[216:219], v240 offset:63104
    v_cvt_pk_bf16_f32 v12, v224, v225
    v_mfma_f32_16x16x32_bf16 v[236:239], a[220:223], a[124:127], v[236:239]
    ds_read_b128 a[220:223], v241 offset:63104
    v_cvt_pk_bf16_f32 v15, v226, v227
    v_mfma_f32_16x16x32_bf16 v[236:239], a[224:227], a[128:131], v[236:239]
    ds_read_b128 a[224:227], v240 offset:63232
    v_cvt_pk_bf16_f32 v32, v232, v233
    v_mfma_f32_16x16x32_bf16 v[236:239], a[228:231], a[132:135], v[236:239]
    ds_read_b128 a[228:231], v241 offset:63232
    s_waitcnt lgkmcnt(5)
    v_mfma_f32_16x16x32_bf16 v[236:239], a[232:235], a[136:139], v[236:239]
    buffer_load_dwordx4 v172, s[8:11], s61 offen lds
    v_cvt_pk_bf16_f32 v35, v234, v235
    v_mfma_f32_16x16x32_bf16 v[236:239], a[236:239], a[140:143], v[236:239]
    ds_read_b128 a[232:235], v240 offset:64512
    v_cvt_pk_bf16_f32 v75, v186, v187
    v_mfma_f32_16x16x32_bf16 v[228:231], a[0:3], a[240:243], 0
    ds_read_b128 a[236:239], v241 offset:64512
    v_cvt_pk_bf16_f32 v18, v188, v189
    v_mfma_f32_16x16x32_bf16 v[228:231], a[4:7], a[244:247], v[228:231]
    s_lshl_b32 s60, s28, 5
    v_cvt_pk_bf16_f32 v21, v190, v191
    v_cvt_pk_bf16_f32 v62, v236, v237
    v_mfma_f32_16x16x32_bf16 v[232:235], a[24:27], a[240:243], 0
    s_add_u32 s60, s60, 0x1800
    s_waitcnt lgkmcnt(5)
    v_cvt_pk_bf16_f32 v65, v238, v239
    v_mfma_f32_16x16x32_bf16 v[228:231], a[8:11], a[216:219], v[228:231]
    v_cvt_pk_bf16_f32 v19, v158, v159
    s_waitcnt lgkmcnt(4)
    v_mfma_f32_16x16x32_bf16 v[228:231], a[12:15], a[220:223], v[228:231]
    v_cvt_pk_bf16_f32 v48, v192, v193
    s_waitcnt lgkmcnt(3)
    v_mfma_f32_16x16x32_bf16 v[228:231], a[16:19], a[224:227], v[228:231]
    buffer_load_dwordx4 v173, s[8:11], s61 offen offset:1024 lds
    s_waitcnt lgkmcnt(2)
    v_mfma_f32_16x16x32_bf16 v[228:231], a[20:23], a[228:231], v[228:231]
    v_cvt_pk_bf16_f32 v51, v194, v195
    v_mov_b32 v195, 0
    v_mfma_f32_16x16x32_bf16 v[232:235], a[28:31], a[244:247], v[232:235]
    v_cvt_pk_bf16_f32 v22, v160, v161
    v_cvt_pk_bf16_f32 v49, v162, v163
    v_mfma_f32_16x16x32_bf16 v[232:235], a[32:35], a[216:219], v[232:235]
    v_cvt_pk_bf16_f32 v52, v164, v165
    v_cvt_pk_bf16_f32 v79, v24, v25
    v_mfma_f32_16x16x32_bf16 v[232:235], a[36:39], a[220:223], v[232:235]
    v_cvt_pk_bf16_f32 v144, v228, v229
    v_cvt_pk_bf16_f32 v145, v230, v231
    v_mfma_f32_16x16x32_bf16 v[232:235], a[40:43], a[224:227], v[232:235]
    v_cvt_pk_bf16_f32 v82, v26, v27
    v_mfma_f32_16x16x32_bf16 v[232:235], a[44:47], a[228:231], v[232:235]
    v_mfma_f32_16x16x32_bf16 v[236:239], a[48:51], a[240:243], 0
    buffer_load_dwordx4 v174, s[8:11], s61 offen offset:2048 lds
    s_add_u32 m0, s46, 0x1800
    v_mfma_f32_16x16x32_bf16 v[236:239], a[52:55], a[244:247], v[236:239]
    s_lshl_b32 s61, s28, 5
    s_add_u32 s61, s61, 0x6000
    v_mfma_f32_16x16x32_bf16 v[236:239], a[56:59], a[216:219], v[236:239]
    v_mfma_f32_16x16x32_bf16 v[236:239], a[60:63], a[220:223], v[236:239]
    v_cvt_pk_bf16_f32 v146, v232, v233
    v_cvt_pk_bf16_f32 v147, v234, v235
    v_mfma_f32_16x16x32_bf16 v[236:239], a[64:67], a[224:227], v[236:239]
    v_mfma_f32_16x16x32_bf16 v[236:239], a[68:71], a[228:231], v[236:239]
    v_mfma_f32_16x16x32_bf16 v[228:231], a[240:243], a[72:75], 0
    v_mfma_f32_16x16x32_bf16 v[228:231], a[244:247], a[76:79], v[228:231]
    buffer_load_dwordx4 v168, s[4:7], s58 offen lds
    v_mfma_f32_16x16x32_bf16 v[228:231], a[216:219], a[80:83], v[228:231]
    v_mfma_f32_16x16x32_bf16 v[228:231], a[220:223], a[84:87], v[228:231]
    v_mfma_f32_16x16x32_bf16 v[228:231], a[224:227], a[88:91], v[228:231]
    v_mfma_f32_16x16x32_bf16 v[228:231], a[228:231], a[92:95], v[228:231]
    buffer_load_dwordx4 v171, s[4:7], s58 offen offset:512 lds
    v_cvt_pk_bf16_f32 v148, v236, v237
    v_mfma_f32_16x16x32_bf16 v[232:235], a[240:243], a[96:99], 0
    s_add_u32 m0, s46, 0x9000
    v_cvt_pk_bf16_f32 v149, v238, v239
    s_lshl1_add_u32 s58, s45, s41
    v_mfma_f32_16x16x32_bf16 v[232:235], a[244:247], a[100:103], v[232:235]
    v_mfma_f32_16x16x32_bf16 v[232:235], a[216:219], a[104:107], v[232:235]
    v_cvt_pk_bf16_f32 v8, v228, v229
    v_cvt_pk_bf16_f32 v11, v230, v231
    v_mfma_f32_16x16x32_bf16 v[232:235], a[220:223], a[108:111], v[232:235]
    s_waitcnt lgkmcnt(0)
    buffer_load_dwordx4 v168, s[4:7], s58 offen lds
    v_mfma_f32_16x16x32_bf16 v[232:235], a[224:227], a[112:115], v[232:235]
    v_mfma_f32_16x16x32_bf16 v[232:235], a[228:231], a[116:119], v[232:235]
    v_mfma_f32_16x16x32_bf16 v[236:239], a[240:243], a[120:123], 0
    ds_read_b128 a[240:243], v240 offset:64640
    v_mfma_f32_16x16x32_bf16 v[236:239], a[244:247], a[124:127], v[236:239]
    ds_read_b128 a[244:247], v241 offset:64640
    s_waitcnt vmcnt(12)
    v_mfma_f32_16x16x32_bf16 v[236:239], a[216:219], a[128:131], v[236:239]
    ds_read_b128 a[216:219], v240 offset:64768
    v_add_u32 v240, 0xf000, v240
    v_mfma_f32_16x16x32_bf16 v[236:239], a[220:223], a[132:135], v[236:239]
    ds_read_b128 a[220:223], v241 offset:64768
    v_cvt_pk_bf16_f32 v38, v232, v233
    v_mfma_f32_16x16x32_bf16 v[236:239], a[224:227], a[136:139], v[236:239]
    ds_read_b128 a[224:227], v242 offset:0
    v_cvt_pk_bf16_f32 v41, v234, v235
    v_mfma_f32_16x16x32_bf16 v[236:239], a[228:231], a[140:143], v[236:239]
    ds_read_b128 a[228:231], v243 offset:0
    v_add_u32 v241, 0xf000, v241
    v_mfma_f32_16x16x32_bf16 v[228:231], a[0:3], a[232:235], 0
    ds_read_b64_tr_b16 a[152:153], v249 offset:6144
    ds_read_b64_tr_b16 a[154:155], v250 offset:6144
    v_mfma_f32_16x16x32_bf16 v[228:231], a[4:7], a[236:239], v[228:231]
    ds_read_b64_tr_b16 a[176:177], v249 offset:6176
    ds_read_b64_tr_b16 a[178:179], v250 offset:6176
    v_mfma_f32_16x16x32_bf16 v[232:235], a[24:27], a[232:235], 0
    s_waitcnt lgkmcnt(9)
    v_cvt_pk_bf16_f32 v68, v236, v237
    v_cvt_pk_bf16_f32 v71, v238, v239
    v_mfma_f32_16x16x32_bf16 v[228:231], a[8:11], a[240:243], v[228:231]
    s_waitcnt lgkmcnt(8)
    ds_read_b64_tr_b16 a[200:201], v249 offset:6208
    v_mfma_f32_16x16x32_bf16 v[228:231], a[12:15], a[244:247], v[228:231]
    s_waitcnt lgkmcnt(8)
    ds_read_b64_tr_b16 a[202:203], v250 offset:6208
    v_mfma_f32_16x16x32_bf16 v[228:231], a[16:19], a[216:219], v[228:231]
    s_waitcnt lgkmcnt(8)
    buffer_load_dwordx4 v171, s[4:7], s58 offen offset:512 lds
    v_mfma_f32_16x16x32_bf16 v[228:231], a[20:23], a[220:223], v[228:231]
    s_add_u32 m0, s46, 0x10800
    s_lshl1_add_u32 s58, s45, s42
    v_mfma_f32_16x16x32_bf16 v[232:235], a[28:31], a[236:239], v[232:235]
    v_mfma_f32_16x16x32_bf16 v[232:235], a[32:35], a[240:243], v[232:235]
    v_mfma_f32_16x16x32_bf16 v[232:235], a[36:39], a[244:247], v[232:235]
    buffer_load_dwordx4 v168, s[4:7], s58 offen lds
    v_mfma_f32_16x16x32_bf16 v[232:235], a[40:43], a[216:219], v[232:235]
    v_mfma_f32_16x16x32_bf16 v[232:235], a[44:47], a[220:223], v[232:235]
    v_cvt_pk_bf16_f32 v150, v228, v229
    v_cvt_pk_bf16_f32 v151, v230, v231
    v_mfma_f32_16x16x32_bf16 v[236:239], a[48:51], a[232:235], 0
    v_mfma_f32_16x16x32_bf16 v[236:239], a[52:55], a[236:239], v[236:239]
    buffer_load_dwordx4 v171, s[4:7], s58 offen offset:512 lds
    s_add_u32 m0, s46, 0x16800
    v_mfma_f32_16x16x32_bf16 v[236:239], a[56:59], a[240:243], v[236:239]
    s_lshl1_add_u32 s58, s45, s43
    v_cvt_pk_bf16_f32 v152, v232, v233
    v_cvt_pk_bf16_f32 v153, v234, v235
    v_mfma_f32_16x16x32_bf16 v[236:239], a[60:63], a[244:247], v[236:239]
    v_mfma_f32_16x16x32_bf16 v[236:239], a[64:67], a[216:219], v[236:239]
    v_mfma_f32_16x16x32_bf16 v[236:239], a[68:71], a[220:223], v[236:239]
    v_mfma_f32_16x16x32_bf16 v[228:231], a[232:235], a[72:75], 0
    v_mfma_f32_16x16x32_bf16 v[228:231], a[236:239], a[76:79], v[228:231]
    v_mfma_f32_16x16x32_bf16 v[228:231], a[240:243], a[80:83], v[228:231]
    v_mfma_f32_16x16x32_bf16 v[228:231], a[244:247], a[84:87], v[228:231]
    v_mfma_f32_16x16x32_bf16 v[228:231], a[216:219], a[88:91], v[228:231]
    s_waitcnt vmcnt(12)
    ds_read_b64_tr_b16 a[156:157], v249 offset:9216
    v_mfma_f32_16x16x32_bf16 v[228:231], a[220:223], a[92:95], v[228:231]
    v_cvt_pk_bf16_f32 v154, v236, v237
    v_cvt_pk_bf16_f32 v155, v238, v239
    v_mfma_f32_16x16x32_bf16 v[232:235], a[232:235], a[96:99], 0
    ds_read_b64_tr_b16 a[158:159], v250 offset:9216
    ds_read_b64_tr_b16 a[180:181], v249 offset:9248
    v_mfma_f32_16x16x32_bf16 v[232:235], a[236:239], a[100:103], v[232:235]
    ds_read_b64_tr_b16 a[182:183], v250 offset:9248
    ds_read_b64_tr_b16 a[204:205], v249 offset:9280
    v_mfma_f32_16x16x32_bf16 v[232:235], a[240:243], a[104:107], v[232:235]
    v_cvt_pk_bf16_f32 v14, v228, v229
    v_cvt_pk_bf16_f32 v17, v230, v231
    v_mfma_f32_16x16x32_bf16 v[232:235], a[244:247], a[108:111], v[232:235]
    s_waitcnt lgkmcnt(5)
    ds_read_b64_tr_b16 a[206:207], v250 offset:9280
    v_mfma_f32_16x16x32_bf16 v[232:235], a[216:219], a[112:115], v[232:235]
    v_mfma_f32_16x16x32_bf16 v[232:235], a[220:223], a[116:119], v[232:235]
    s_waitcnt vmcnt(9)
    ds_read_b64_tr_b16 a[160:161], v249 offset:0
    v_mfma_f32_16x16x32_bf16 v[236:239], a[232:235], a[120:123], 0
    ds_read_b128 a[232:235], v242 offset:128
    ds_read_b64_tr_b16 a[162:163], v250 offset:0
    v_mfma_f32_16x16x32_bf16 v[236:239], a[236:239], a[124:127], v[236:239]
    ds_read_b128 a[236:239], v243 offset:128
    s_waitcnt vmcnt(6)
    v_mfma_f32_16x16x32_bf16 v[236:239], a[240:243], a[128:131], v[236:239]
    ds_read_b128 a[240:243], v242 offset:256
    ds_read_b64_tr_b16 a[164:165], v249 offset:3072
    v_mfma_f32_16x16x32_bf16 v[236:239], a[244:247], a[132:135], v[236:239]
    ds_read_b64_tr_b16 a[166:167], v250 offset:3072
    ds_read_b128 a[244:247], v243 offset:256
    v_mfma_f32_16x16x32_bf16 v[236:239], a[216:219], a[136:139], v[236:239]
    ds_read_b64_tr_b16 a[184:185], v249 offset:32
    ds_read_b64_tr_b16 a[186:187], v250 offset:32
    v_mfma_f32_16x16x32_bf16 v[236:239], a[220:223], a[140:143], v[236:239]
    ds_read_b64_tr_b16 a[188:189], v249 offset:3104
    ds_read_b64_tr_b16 a[190:191], v250 offset:3104
    v_mfma_f32_16x16x32_bf16 v[228:231], a[144:147], a[224:227], 0
    v_cvt_pk_bf16_f32 v44, v232, v233
    v_cvt_pk_bf16_f32 v47, v234, v235
    v_mfma_f32_16x16x32_bf16 v[228:231], a[148:151], a[228:231], v[228:231]
    ds_read_b64_tr_b16 a[208:209], v249 offset:64
    ds_read_b64_tr_b16 a[210:211], v250 offset:64
    v_mfma_f32_16x16x32_bf16 v[232:235], a[168:171], a[224:227], 0
    s_waitcnt lgkmcnt(12)
    v_cvt_pk_bf16_f32 v74, v236, v237
    v_cvt_pk_bf16_f32 v77, v238, v239
    v_mfma_f32_16x16x32_bf16 v[228:231], a[152:155], a[232:235], v[228:231]
    ds_read_b64_tr_b16 a[212:213], v249 offset:3136
    s_waitcnt lgkmcnt(11)
    v_mfma_f32_16x16x32_bf16 v[228:231], a[156:159], a[236:239], v[228:231]
    ds_read_b64_tr_b16 a[214:215], v250 offset:3136
    s_waitcnt lgkmcnt(11)
    v_mfma_f32_16x16x32_bf16 v[228:231], a[160:163], a[240:243], v[228:231]
    ds_read_b128 a[216:219], v240 offset:4608
    v_add_u32 v249, s66, v249
    v_mfma_f32_16x16x32_bf16 v[232:235], a[172:175], a[228:231], v[232:235]
    ds_read_b128 a[220:223], v241 offset:4608
    s_waitcnt lgkmcnt(10)
    v_mfma_f32_16x16x32_bf16 v[228:231], a[164:167], a[244:247], v[228:231]
    v_add_u32 v250, s66, v250
    s_lshl_b32 s66, s28, 1
    v_mfma_f32_16x16x32_bf16 v[232:235], a[176:179], a[232:235], v[232:235]
    v_mfma_f32_16x16x32_bf16 v[232:235], a[180:183], a[236:239], v[232:235]
    s_waitcnt lgkmcnt(8)
    v_mfma_f32_16x16x32_bf16 v[232:235], a[184:187], a[240:243], v[232:235]
    s_waitcnt lgkmcnt(6)
    v_mfma_f32_16x16x32_bf16 v[232:235], a[188:191], a[244:247], v[232:235]
    v_mul_f32 v228, s38, v228
    v_mul_f32 v229, s38, v229
    v_mfma_f32_16x16x32_bf16 v[236:239], a[192:195], a[224:227], 0
    v_mul_f32 v230, s38, v230
    v_mul_f32 v231, s38, v231
    v_mfma_f32_16x16x32_bf16 v[236:239], a[196:199], a[228:231], v[236:239]
    v_cvt_pk_bf16_f32 v168, v228, v229
    v_cvt_pk_bf16_f32 v169, v230, v231
    v_mfma_f32_16x16x32_bf16 v[236:239], a[200:203], a[232:235], v[236:239]
    v_mul_f32 v232, s3, v232
    v_mul_f32 v233, s3, v233
    v_mfma_f32_16x16x32_bf16 v[236:239], a[204:207], a[236:239], v[236:239]
    s_waitcnt lgkmcnt(1)
    v_mul_f32 v234, s3, v234
    v_mul_f32 v235, s3, v235
    v_mfma_f32_16x16x32_bf16 v[236:239], a[208:211], a[240:243], v[236:239]
    v_cvt_pk_bf16_f32 v170, v232, v233
    v_cvt_pk_bf16_f32 v171, v234, v235
    v_mfma_f32_16x16x32_bf16 v[236:239], a[212:215], a[244:247], v[236:239]
    ds_read_b128 a[224:227], v240 offset:4736
    ds_read_b128 a[228:231], v241 offset:4736
    v_mfma_f32_16x16x32_bf16 v[196:199], v[102:105], v[168:171], v[196:199]
    ds_read_b128 a[232:235], v240 offset:4864
    ds_read_b128 a[236:239], v241 offset:4864
    v_mfma_f32_16x16x32_bf16 v[200:203], v[114:117], v[168:171], v[200:203]
    ds_read_b128 a[240:243], v242 offset:1536
    v_add_u32 v240, 0xffff1000, v240
    v_mfma_f32_16x16x32_bf16 v[204:207], v[138:141], v[168:171], v[204:207]
    v_mul_f32 v236, s38, v236
    v_mul_f32 v237, s38, v237
    v_mfma_f32_16x16x32_bf16 v[208:211], v[108:111], v[168:171], v[208:211]
    v_mul_f32 v238, s38, v238
    v_mul_f32 v239, s38, v239
    v_mfma_f32_16x16x32_bf16 v[228:231], a[0:3], a[216:219], 0
    s_waitcnt lgkmcnt(5)
    v_cvt_pk_bf16_f32 v172, v236, v237
    v_cvt_pk_bf16_f32 v173, v238, v239
    v_mfma_f32_16x16x32_bf16 v[228:231], a[4:7], a[220:223], v[228:231]
    ds_read_b128 a[244:247], v243 offset:1536
    v_add_u32 v241, 0xffff1000, v241
    v_mfma_f32_16x16x32_bf16 v[196:199], v[104:107], v[170:173], v[196:199]
    v_mfma_f32_16x16x32_bf16 v[200:203], v[116:119], v[170:173], v[200:203]
    s_waitcnt lgkmcnt(5)
    v_mfma_f32_16x16x32_bf16 v[204:207], v[140:143], v[170:173], v[204:207]
    v_mfma_f32_16x16x32_bf16 v[208:211], v[110:113], v[170:173], v[208:211]
    v_mfma_f32_16x16x32_bf16 v[228:231], a[8:11], a[224:227], v[228:231]
    s_waitcnt lgkmcnt(4)
    v_mfma_f32_16x16x32_bf16 v[228:231], a[12:15], a[228:231], v[228:231]
    s_waitcnt lgkmcnt(3)
    v_exp_f32 v196, v196
    v_mfma_f32_16x16x32_bf16 v[228:231], a[16:19], a[232:235], v[228:231]
    s_waitcnt lgkmcnt(2)
    v_exp_f32 v197, v197
    v_mfma_f32_16x16x32_bf16 v[228:231], a[20:23], a[236:239], v[228:231]
    v_exp_f32 v198, v198
    v_mfma_f32_16x16x32_bf16 v[232:235], a[24:27], a[216:219], 0
    v_exp_f32 v199, v199
    v_mfma_f32_16x16x32_bf16 v[232:235], a[28:31], a[220:223], v[232:235]
    v_cvt_pk_bf16_f32 v180, v196, v197
    v_cvt_pk_bf16_f32 v183, v198, v199
    v_mfma_f32_16x16x32_bf16 v[232:235], a[32:35], a[224:227], v[232:235]
    ds_read_b128 v[196:199], v245 offset:256
    v_cvt_pk_bf16_f32 v156, v228, v229
    v_mfma_f32_16x16x32_bf16 v[232:235], a[36:39], a[228:231], v[232:235]
    v_exp_f32 v200, v200
    v_mfma_f32_16x16x32_bf16 v[232:235], a[40:43], a[232:235], v[232:235]
    v_exp_f32 v201, v201
    v_mfma_f32_16x16x32_bf16 v[232:235], a[44:47], a[236:239], v[232:235]
    v_exp_f32 v202, v202
    v_mfma_f32_16x16x32_bf16 v[236:239], a[48:51], a[216:219], 0
    v_exp_f32 v203, v203
    v_mfma_f32_16x16x32_bf16 v[236:239], a[52:55], a[220:223], v[236:239]
    v_cvt_pk_bf16_f32 v181, v200, v201
    v_cvt_pk_bf16_f32 v184, v202, v203
    v_mfma_f32_16x16x32_bf16 v[236:239], a[56:59], a[224:227], v[236:239]
    ds_read_b128 v[200:203], v246 offset:256
    v_cvt_pk_bf16_f32 v157, v230, v231
    v_mfma_f32_16x16x32_bf16 v[236:239], a[60:63], a[228:231], v[236:239]
    v_exp_f32 v204, v204
    v_mfma_f32_16x16x32_bf16 v[236:239], a[64:67], a[232:235], v[236:239]
    v_exp_f32 v205, v205
    v_mfma_f32_16x16x32_bf16 v[236:239], a[68:71], a[236:239], v[236:239]
    s_waitcnt lgkmcnt(1)
    v_exp_f32 v206, v206
    v_mfma_f32_16x16x32_bf16 v[196:199], v[120:123], v[168:171], v[196:199]
    v_exp_f32 v207, v207
    v_mfma_f32_16x16x32_bf16 v[196:199], v[122:125], v[170:173], v[196:199]
    v_cvt_pk_bf16_f32 v182, v204, v205
    v_cvt_pk_bf16_f32 v185, v206, v207
    v_mfma_f32_16x16x32_bf16 v[228:231], a[216:219], a[72:75], 0
    ds_read_b128 v[204:207], v244 offset:320
    v_cvt_pk_bf16_f32 v158, v232, v233
    v_mfma_f32_16x16x32_bf16 v[212:215], v[0:3], v[180:183], 0
    v_exp_f32 v208, v208
    v_mfma_f32_16x16x32_bf16 v[216:219], v[30:33], v[180:183], 0
    v_exp_f32 v209, v209
    v_mfma_f32_16x16x32_bf16 v[220:223], v[60:63], v[180:183], 0
    s_waitcnt lgkmcnt(1)
    v_exp_f32 v210, v210
    v_mfma_f32_16x16x32_bf16 v[224:227], a[248:251], v[180:183], 0
    v_exp_f32 v211, v211
    v_mfma_f32_16x16x32_bf16 v[200:203], v[144:147], v[168:171], v[200:203]
    v_cvt_pk_bf16_f32 v186, v208, v209
    v_cvt_pk_bf16_f32 v189, v210, v211
    v_mfma_f32_16x16x32_bf16 v[200:203], v[146:149], v[170:173], v[200:203]
    ds_read_b128 v[208:211], v245 offset:320
    v_cvt_pk_bf16_f32 v159, v234, v235
    v_mfma_f32_16x16x32_bf16 v[228:231], a[220:223], a[76:79], v[228:231]
    v_exp_f32 v196, v196
    v_mfma_f32_16x16x32_bf16 v[228:231], a[224:227], a[80:83], v[228:231]
    v_exp_f32 v197, v197
    v_mfma_f32_16x16x32_bf16 v[228:231], a[228:231], a[84:87], v[228:231]
    s_waitcnt lgkmcnt(1)
    v_cvt_pk_bf16_f32 v187, v196, v197
    v_cvt_pk_bf16_f32 v160, v236, v237
    v_mfma_f32_16x16x32_bf16 v[204:207], v[90:93], v[168:171], v[204:207]
    v_exp_f32 v198, v198
    v_mfma_f32_16x16x32_bf16 v[212:215], v[4:7], v[184:187], v[212:215]
    v_exp_f32 v199, v199
    v_mfma_f32_16x16x32_bf16 v[216:219], v[34:37], v[184:187], v[216:219]
    v_cvt_pk_bf16_f32 v190, v198, v199
    v_cvt_pk_bf16_f32 v161, v238, v239
    v_mfma_f32_16x16x32_bf16 v[220:223], v[64:67], v[184:187], v[220:223]
    ds_read_b128 v[196:199], v246 offset:320
    v_mfma_f32_16x16x32_bf16 v[224:227], a[248:251], v[184:187], v[224:227]
    v_exp_f32 v200, v200
    v_mfma_f32_16x16x32_bf16 v[204:207], v[92:95], v[170:173], v[204:207]
    s_waitcnt lgkmcnt(1)
    v_exp_f32 v201, v201
    v_mfma_f32_16x16x32_bf16 v[208:211], v[126:129], v[168:171], v[208:211]
    v_exp_f32 v202, v202
    v_mfma_f32_16x16x32_bf16 v[208:211], v[128:131], v[170:173], v[208:211]
    v_exp_f32 v203, v203
    v_mfma_f32_16x16x32_bf16 v[228:231], a[232:235], a[88:91], v[228:231]
    v_cvt_pk_bf16_f32 v188, v200, v201
    v_cvt_pk_bf16_f32 v191, v202, v203
    v_mfma_f32_16x16x32_bf16 v[228:231], a[236:239], a[92:95], v[228:231]
    v_exp_f32 v204, v204
    v_mfma_f32_16x16x32_bf16 v[212:215], v[8:11], v[188:191], v[212:215]
    v_exp_f32 v205, v205
    v_mfma_f32_16x16x32_bf16 v[216:219], v[38:41], v[188:191], v[216:219]
    v_exp_f32 v208, v208
    v_mfma_f32_16x16x32_bf16 v[220:223], v[68:71], v[188:191], v[220:223]
    s_waitcnt lgkmcnt(0)
    v_exp_f32 v209, v209
    v_mfma_f32_16x16x32_bf16 v[224:227], a[248:251], v[188:191], v[224:227]
    v_cvt_pk_bf16_f32 v192, v204, v205
    v_cvt_pk_bf16_f32 v193, v208, v209
    v_mfma_f32_16x16x32_bf16 v[196:199], v[150:153], v[168:171], v[196:199]
    v_cvt_pk_bf16_f32 v20, v228, v229
    v_cvt_pk_bf16_f32 v23, v230, v231
    v_mfma_f32_16x16x32_bf16 v[196:199], v[152:155], v[170:173], v[196:199]
    ds_read_b128 v[200:203], v244 offset:0
    ds_read_b128 v[204:207], v245 offset:0
    v_mfma_f32_16x16x32_bf16 v[232:235], a[216:219], a[96:99], 0
    ds_read_b128 v[208:211], v246 offset:0
    v_mfma_f32_16x16x32_bf16 v[232:235], a[220:223], a[100:103], v[232:235]
    v_mfma_f32_16x16x32_bf16 v[232:235], a[224:227], a[104:107], v[232:235]
    v_mfma_f32_16x16x32_bf16 v[232:235], a[228:231], a[108:111], v[232:235]
    v_mfma_f32_16x16x32_bf16 v[232:235], a[232:235], a[112:115], v[232:235]
L_h3:
    s_cbranch_execz L_h7
    v_exp_f32 v196, v196
    v_mfma_f32_16x16x32_bf16 v[232:235], a[236:239], a[116:119], v[232:235]
    v_exp_f32 v197, v197
    v_mfma_f32_16x16x32_bf16 v[236:239], a[216:219], a[120:123], 0
    ds_read_b128 a[216:219], v242 offset:1664
    v_cvt_pk_bf16_f32 v194, v196, v197
    v_mfma_f32_16x16x32_bf16 v[236:239], a[220:223], a[124:127], v[236:239]
    ds_read_b128 a[220:223], v243 offset:1664
    ds_read_b128 v[196:199], v244 offset:64
    v_mfma_f32_16x16x32_bf16 v[212:215], v[12:15], v[192:195], v[212:215]
    s_waitcnt vmcnt(0)
    v_cvt_pk_bf16_f32 v50, v232, v233
    v_cvt_pk_bf16_f32 v53, v234, v235
    v_mfma_f32_16x16x32_bf16 v[216:219], v[42:45], v[192:195], v[216:219]
    s_barrier
    buffer_load_dwordx4 v254, s[4:7], s43 offen lds
    v_mfma_f32_16x16x32_bf16 v[220:223], v[72:75], v[192:195], v[220:223]
    v_accvgpr_read_b32 v254, a254
    v_mfma_f32_16x16x32_bf16 v[224:227], a[248:251], v[192:195], v[224:227]
    v_mfma_f32_16x16x32_bf16 v[236:239], a[224:227], a[128:131], v[236:239]
    ds_read_b128 a[224:227], v242 offset:1792
    v_mfma_f32_16x16x32_bf16 v[236:239], a[228:231], a[132:135], v[236:239]
    ds_read_b128 a[228:231], v243 offset:1792
    buffer_load_dwordx4 v255, s[4:7], s43 offen offset:1024 lds
    v_mfma_f32_16x16x32_bf16 v[236:239], a[232:235], a[136:139], v[236:239]
    ds_read_b128 a[232:235], v240 offset:6144
    v_accvgpr_read_b32 v255, a252
    v_mfma_f32_16x16x32_bf16 v[236:239], a[236:239], a[140:143], v[236:239]
    ds_read_b128 a[236:239], v241 offset:6144
    v_mfma_f32_16x16x32_bf16 v[228:231], a[144:147], a[240:243], 0
    v_rcp_f32 v225, v224
    v_mfma_f32_16x16x32_bf16 v[228:231], a[148:151], a[244:247], v[228:231]
    s_waitcnt lgkmcnt(6)
    v_mul_f32 v212, v212, v225
    v_mul_f32 v213, v213, v225
    v_mfma_f32_16x16x32_bf16 v[228:231], a[152:155], a[216:219], v[228:231]
    s_waitcnt lgkmcnt(5)
    v_cvt_pk_bf16_f32 v80, v236, v237
    v_cvt_pk_bf16_f32 v83, v238, v239
    v_mfma_f32_16x16x32_bf16 v[228:231], a[156:159], a[220:223], v[228:231]
    v_mul_f32 v214, v214, v225
    v_mul_f32 v215, v215, v225
    v_mfma_f32_16x16x32_bf16 v[232:235], a[168:171], a[240:243], 0
    v_cvt_pk_bf16_f32 v212, v212, v213
    s_waitcnt lgkmcnt(3)
    v_mfma_f32_16x16x32_bf16 v[228:231], a[160:163], a[224:227], v[228:231]
    v_cvt_pk_bf16_f32 v213, v214, v215
    s_waitcnt lgkmcnt(2)
    v_mfma_f32_16x16x32_bf16 v[228:231], a[164:167], a[228:231], v[228:231]
    ds_write_b64 v251, v[212:213] offset:0
    v_mfma_f32_16x16x32_bf16 v[232:235], a[172:175], a[244:247], v[232:235]
    v_mul_f32 v216, v216, v225
    v_mul_f32 v217, v217, v225
    v_mfma_f32_16x16x32_bf16 v[232:235], a[176:179], a[216:219], v[232:235]
    v_mul_f32 v218, v218, v225
    v_mul_f32 v219, v219, v225
    v_mfma_f32_16x16x32_bf16 v[232:235], a[180:183], a[220:223], v[232:235]
    v_mul_f32 v228, s38, v228
    v_mul_f32 v229, s38, v229
    v_mfma_f32_16x16x32_bf16 v[232:235], a[184:187], a[224:227], v[232:235]
    v_mul_f32 v230, s38, v230
    v_mul_f32 v231, s38, v231
    v_mfma_f32_16x16x32_bf16 v[232:235], a[188:191], a[228:231], v[232:235]
    v_cvt_pk_bf16_f32 v174, v228, v229
    v_cvt_pk_bf16_f32 v175, v230, v231
    v_mfma_f32_16x16x32_bf16 v[236:239], a[192:195], a[240:243], 0
    ds_read_b128 a[240:243], v240 offset:6272
    v_cvt_pk_bf16_f32 v216, v216, v217
    v_mfma_f32_16x16x32_bf16 v[236:239], a[196:199], a[244:247], v[236:239]
    ds_read_b128 a[244:247], v241 offset:6272
    v_cvt_pk_bf16_f32 v217, v218, v219
    v_mfma_f32_16x16x32_bf16 v[236:239], a[200:203], a[216:219], v[236:239]
    s_waitcnt lgkmcnt(3)
    v_mul_f32 v232, s3, v232
    v_mul_f32 v233, s3, v233
    v_mfma_f32_16x16x32_bf16 v[236:239], a[204:207], a[220:223], v[236:239]
    v_mul_f32 v234, s3, v234
    v_mul_f32 v235, s3, v235
    v_mfma_f32_16x16x32_bf16 v[236:239], a[208:211], a[224:227], v[236:239]
    v_cvt_pk_bf16_f32 v176, v232, v233
    v_cvt_pk_bf16_f32 v177, v234, v235
    v_mfma_f32_16x16x32_bf16 v[236:239], a[212:215], a[228:231], v[236:239]
    ds_read_b128 a[216:219], v240 offset:6400
    ds_read_b128 a[220:223], v241 offset:6400
    v_mfma_f32_16x16x32_bf16 v[200:203], v[108:111], v[174:177], v[200:203]
    ds_read_b128 a[224:227], v240 offset:6144
    v_max3_f32 v248, v248, v224, v225
    v_mfma_f32_16x16x32_bf16 v[204:207], v[120:123], v[174:177], v[204:207]
    ds_read_b128 a[228:231], v241 offset:6144
    v_mul_f32 v220, v220, v225
    v_mfma_f32_16x16x32_bf16 v[208:211], v[144:147], v[174:177], v[208:211]
    v_mul_f32 v236, s38, v236
    v_mul_f32 v237, s38, v237
    v_mfma_f32_16x16x32_bf16 v[196:199], v[90:93], v[174:177], v[196:199]
    v_mul_f32 v238, s38, v238
    v_mul_f32 v239, s38, v239
    v_mfma_f32_16x16x32_bf16 v[228:231], a[0:3], a[232:235], 0
    v_cvt_pk_bf16_f32 v178, v236, v237
    v_cvt_pk_bf16_f32 v179, v238, v239
    v_mfma_f32_16x16x32_bf16 v[228:231], a[4:7], a[236:239], v[228:231]
    ds_write_b64 v251, v[216:217] offset:128
    v_mfma_f32_16x16x32_bf16 v[200:203], v[110:113], v[176:179], v[200:203]
    v_mul_f32 v221, v221, v225
    v_mul_f32 v222, v222, v225
    v_mfma_f32_16x16x32_bf16 v[204:207], v[122:125], v[176:179], v[204:207]
    s_waitcnt lgkmcnt(6)
    v_mul_f32 v223, v223, v225
    v_cvt_pk_bf16_f32 v220, v220, v221
    v_mfma_f32_16x16x32_bf16 v[208:211], v[146:149], v[176:179], v[208:211]
    buffer_load_dwordx4 v254, s[4:7], s43 offen offset:2048 lds
    v_cvt_pk_bf16_f32 v221, v222, v223
    v_mfma_f32_16x16x32_bf16 v[196:199], v[92:95], v[176:179], v[196:199]
    s_add_u32 m0, s46, 0x17400
    v_exp_f32 v200, v200
    v_mfma_f32_16x16x32_bf16 v[228:231], a[8:11], a[240:243], v[228:231]
    s_waitcnt lgkmcnt(5)
    v_exp_f32 v201, v201
    v_mfma_f32_16x16x32_bf16 v[228:231], a[12:15], a[244:247], v[228:231]
    s_waitcnt lgkmcnt(4)
    v_exp_f32 v202, v202
    v_mfma_f32_16x16x32_bf16 v[228:231], a[16:19], a[216:219], v[228:231]
    s_waitcnt lgkmcnt(3)
    v_exp_f32 v203, v203
    v_mfma_f32_16x16x32_bf16 v[228:231], a[20:23], a[220:223], v[228:231]
    v_cvt_pk_bf16_f32 v180, v200, v201
    v_cvt_pk_bf16_f32 v183, v202, v203
    v_mfma_f32_16x16x32_bf16 v[232:235], a[24:27], a[232:235], 0
    ds_read_b128 v[200:203], v245 offset:64
    v_accvgpr_read_b32 v254, a253
    v_mfma_f32_16x16x32_bf16 v[232:235], a[28:31], a[236:239], v[232:235]
    v_exp_f32 v204, v204
    v_mfma_f32_16x16x32_bf16 v[232:235], a[32:35], a[240:243], v[232:235]
    v_cvt_pk_bf16_f32 v162, v228, v229
    v_cvt_pk_bf16_f32 v163, v230, v231
    v_mfma_f32_16x16x32_bf16 v[232:235], a[36:39], a[244:247], v[232:235]
    s_waitcnt lgkmcnt(2)
    v_exp_f32 v205, v205
    v_mfma_f32_16x16x32_bf16 v[232:235], a[40:43], a[216:219], v[232:235]
    v_exp_f32 v208, v208
    v_mfma_f32_16x16x32_bf16 v[232:235], a[44:47], a[220:223], v[232:235]
    v_exp_f32 v209, v209
    v_mfma_f32_16x16x32_bf16 v[236:239], a[48:51], a[232:235], 0
    ds_read_b128 a[232:235], v240 offset:6272
    v_cvt_pk_bf16_f32 v181, v204, v205
    v_mfma_f32_16x16x32_bf16 v[236:239], a[52:55], a[236:239], v[236:239]
    ds_read_b128 a[236:239], v241 offset:6272
    v_cvt_pk_bf16_f32 v182, v208, v209
    v_mfma_f32_16x16x32_bf16 v[236:239], a[56:59], a[240:243], v[236:239]
    ds_read_b128 a[240:243], v240 offset:6400
    v_cvt_pk_bf16_f32 v164, v232, v233
    v_mfma_f32_16x16x32_bf16 v[212:215], v[6:9], v[180:183], 0
    buffer_load_dwordx4 v255, s[4:7], s59 offen lds
    v_cvt_pk_bf16_f32 v165, v234, v235
    v_mfma_f32_16x16x32_bf16 v[216:219], v[36:39], v[180:183], 0
    v_exp_f32 v206, v206
    v_mfma_f32_16x16x32_bf16 v[224:227], a[248:251], v[180:183], 0
    v_exp_f32 v207, v207
    v_mfma_f32_16x16x32_bf16 v[236:239], a[60:63], a[244:247], v[236:239]
    ds_read_b128 a[244:247], v241 offset:6400
    s_waitcnt lgkmcnt(4)
    v_mfma_f32_16x16x32_bf16 v[200:203], v[126:129], v[174:177], v[200:203]
    buffer_load_dwordx4 v254, s[4:7], s59 offen offset:1024 lds
    v_cvt_pk_bf16_f32 v184, v206, v207
    v_mfma_f32_16x16x32_bf16 v[200:203], v[128:131], v[176:179], v[200:203]
    ds_read_b128 v[204:207], v246 offset:64
    v_accvgpr_read_b32 v255, a254
    v_mfma_f32_16x16x32_bf16 v[236:239], a[64:67], a[216:219], v[236:239]
    ds_write_b64 v251, v[220:221] offset:256
    v_mfma_f32_16x16x32_bf16 v[220:223], v[66:69], v[180:183], 0
    v_exp_f32 v210, v210
    v_mfma_f32_16x16x32_bf16 v[236:239], a[68:71], a[220:223], v[236:239]
    v_exp_f32 v211, v211
    v_mfma_f32_16x16x32_bf16 v[228:231], a[224:227], a[72:75], 0
    ds_read_b128 a[216:219], v240 offset:36864
    v_cvt_pk_bf16_f32 v185, v210, v211
    v_mfma_f32_16x16x32_bf16 v[228:231], a[228:231], a[76:79], v[228:231]
    s_waitcnt lgkmcnt(6)
    v_exp_f32 v196, v196
    v_mfma_f32_16x16x32_bf16 v[228:231], a[232:235], a[80:83], v[228:231]
    s_waitcnt lgkmcnt(5)
    v_exp_f32 v197, v197
    v_mfma_f32_16x16x32_bf16 v[228:231], a[236:239], a[84:87], v[228:231]
    s_waitcnt lgkmcnt(4)
    v_exp_f32 v200, v200
    v_mfma_f32_16x16x32_bf16 v[228:231], a[240:243], a[88:91], v[228:231]
    s_waitcnt lgkmcnt(3)
    v_exp_f32 v201, v201
    v_mfma_f32_16x16x32_bf16 v[228:231], a[244:247], a[92:95], v[228:231]
    s_waitcnt lgkmcnt(2)
    ds_read_b128 v[208:211], v244 offset:128
    v_mfma_f32_16x16x32_bf16 v[204:207], v[150:153], v[174:177], v[204:207]
    v_cvt_pk_bf16_f32 v166, v236, v237
    v_cvt_pk_bf16_f32 v167, v238, v239
    v_mfma_f32_16x16x32_bf16 v[204:207], v[152:155], v[176:179], v[204:207]
    v_cvt_pk_bf16_f32 v186, v196, v197
    v_cvt_pk_bf16_f32 v187, v200, v201
    v_mfma_f32_16x16x32_bf16 v[232:235], a[224:227], a[96:99], 0
    v_exp_f32 v198, v198
    v_mfma_f32_16x16x32_bf16 v[212:215], v[10:13], v[184:187], v[212:215]
    v_exp_f32 v199, v199
    v_mfma_f32_16x16x32_bf16 v[216:219], v[40:43], v[184:187], v[216:219]
    ds_read_b128 a[220:223], v241 offset:36864
    v_cvt_pk_bf16_f32 v189, v198, v199
    v_mfma_f32_16x16x32_bf16 v[220:223], v[70:73], v[184:187], v[220:223]
    ds_read_b128 v[196:199], v245 offset:128
    v_cvt_pk_bf16_f32 v24, v228, v229
    v_mfma_f32_16x16x32_bf16 v[224:227], a[248:251], v[184:187], v[224:227]
    v_exp_f32 v202, v202
    v_mfma_f32_16x16x32_bf16 v[232:235], a[228:231], a[100:103], v[232:235]
    v_exp_f32 v203, v203
    v_mfma_f32_16x16x32_bf16 v[232:235], a[232:235], a[104:107], v[232:235]
    v_exp_f32 v204, v204
    v_mfma_f32_16x16x32_bf16 v[232:235], a[236:239], a[108:111], v[232:235]
    v_exp_f32 v205, v205
    v_mfma_f32_16x16x32_bf16 v[232:235], a[240:243], a[112:115], v[232:235]
    s_waitcnt lgkmcnt(2)
    v_exp_f32 v206, v206
    v_mfma_f32_16x16x32_bf16 v[208:211], v[96:99], v[174:177], v[208:211]
    v_exp_f32 v207, v207
    v_mfma_f32_16x16x32_bf16 v[208:211], v[98:101], v[176:179], v[208:211]
    v_cvt_pk_bf16_f32 v190, v202, v203
    v_cvt_pk_bf16_f32 v188, v204, v205
    v_mfma_f32_16x16x32_bf16 v[232:235], a[244:247], a[116:119], v[232:235]
    ds_read_b128 v[200:203], v246 offset:128
    v_cvt_pk_bf16_f32 v191, v206, v207
    v_mfma_f32_16x16x32_bf16 v[236:239], a[224:227], a[120:123], 0
    ds_read_b128 a[224:227], v240 offset:36992
    v_cvt_pk_bf16_f32 v27, v230, v231
    v_mfma_f32_16x16x32_bf16 v[212:215], v[14:17], v[188:191], v[212:215]
    v_exp_f32 v208, v208
    v_mfma_f32_16x16x32_bf16 v[216:219], v[44:47], v[188:191], v[216:219]
    v_exp_f32 v209, v209
    v_mfma_f32_16x16x32_bf16 v[220:223], v[74:77], v[188:191], v[220:223]
    s_waitcnt lgkmcnt(2)
    v_cvt_pk_bf16_f32 v54, v232, v233
    v_cvt_pk_bf16_f32 v57, v234, v235
    v_mfma_f32_16x16x32_bf16 v[224:227], a[248:251], v[188:191], v[224:227]
    ds_read_b128 v[204:207], v244 offset:0
    v_cvt_pk_bf16_f32 v192, v208, v209
    v_mfma_f32_16x16x32_bf16 v[196:199], v[132:135], v[174:177], v[196:199]
    ds_read_b128 v[208:211], v245 offset:0
    v_accvgpr_read_b32 v254, a252
    v_mfma_f32_16x16x32_bf16 v[196:199], v[134:137], v[176:179], v[196:199]
    buffer_load_dwordx4 v255, s[4:7], s59 offen offset:2048 lds
    v_accvgpr_read_b32 v255, a255
    v_mfma_f32_16x16x32_bf16 v[236:239], a[228:231], a[124:127], v[236:239]
    ds_read_b128 a[228:231], v241 offset:36992
    s_add_u32 m0, s46, 0x18000
    v_mfma_f32_16x16x32_bf16 v[236:239], a[232:235], a[128:131], v[236:239]
    ds_read_b128 a[232:235], v240 offset:37120
    s_waitcnt lgkmcnt(5)
    v_mfma_f32_16x16x32_bf16 v[200:203], v[156:159], v[174:177], v[200:203]
    s_add_u32 s59, s44, s45
    v_exp_f32 v196, v196
    v_mfma_f32_16x16x32_bf16 v[200:203], v[158:161], v[176:179], v[200:203]
    v_exp_f32 v197, v197
    v_mfma_f32_16x16x32_bf16 v[236:239], a[236:239], a[132:135], v[236:239]
    ds_read_b128 a[236:239], v241 offset:37120
    v_cvt_pk_bf16_f32 v193, v196, v197
    v_mfma_f32_16x16x32_bf16 v[236:239], a[240:243], a[136:139], v[236:239]
    ds_read_b128 a[240:243], v242 offset:3072
    v_add_u32 v240, 0xf000, v240
    v_mfma_f32_16x16x32_bf16 v[236:239], a[244:247], a[140:143], v[236:239]
    v_exp_f32 v200, v200
    v_mfma_f32_16x16x32_bf16 v[228:231], a[0:3], a[216:219], 0
    v_exp_f32 v201, v201
    v_mfma_f32_16x16x32_bf16 v[228:231], a[4:7], a[220:223], v[228:231]
    s_waitcnt lgkmcnt(6)
    v_cvt_pk_bf16_f32 v194, v200, v201
    v_add_u32 v241, 0xf000, v241
    v_mfma_f32_16x16x32_bf16 v[228:231], a[8:11], a[224:227], v[228:231]
    s_waitcnt lgkmcnt(3)
    v_cvt_pk_bf16_f32 v84, v236, v237
    v_cvt_pk_bf16_f32 v87, v238, v239
    v_mfma_f32_16x16x32_bf16 v[212:215], v[18:21], v[192:195], v[212:215]
    ds_read_b128 a[244:247], v243 offset:3072
    ds_read_b128 v[196:199], v246 offset:0
    v_mfma_f32_16x16x32_bf16 v[216:219], v[48:51], v[192:195], v[216:219]
    ds_read_b128 v[200:203], v244 offset:64
    buffer_load_dwordx4 v254, s[4:7], s58 offen lds
    v_mfma_f32_16x16x32_bf16 v[220:223], v[78:81], v[192:195], v[220:223]
    v_xor_b32 v254, 16, v242
    v_add_u32 v254, 0x7500, v254
    v_mfma_f32_16x16x32_bf16 v[224:227], a[248:251], v[192:195], v[224:227]
    v_cndmask_b32 v254, v242, v254, vcc
    s_mov_b32 vcc_lo, 0x33333333
    v_mfma_f32_16x16x32_bf16 v[228:231], a[12:15], a[228:231], v[228:231]
    s_waitcnt lgkmcnt(5)
    s_mov_b32 vcc_hi, 0x33333333
    v_mfma_f32_16x16x32_bf16 v[228:231], a[16:19], a[232:235], v[228:231]
    s_waitcnt lgkmcnt(4)
    buffer_load_dwordx4 v255, s[4:7], s58 offen offset:512 lds
    v_mfma_f32_16x16x32_bf16 v[228:231], a[20:23], a[236:239], v[228:231]
    s_add_u32 m0, s46, 0
    v_rcp_f32 v225, v224
    v_mfma_f32_16x16x32_bf16 v[232:235], a[24:27], a[216:219], 0
    s_lshl1_add_u32 s58, s45, s44
    v_mul_f32 v212, v212, v225
    v_mul_f32 v213, v213, v225
    v_mfma_f32_16x16x32_bf16 v[232:235], a[28:31], a[220:223], v[232:235]
    v_mul_f32 v214, v214, v225
    v_cvt_pk_bf16_f32 v102, v228, v229
    v_mfma_f32_16x16x32_bf16 v[232:235], a[32:35], a[224:227], v[232:235]
    v_cvt_pk_bf16_f32 v103, v230, v231
    v_mul_f32 v215, v215, v225
    v_mfma_f32_16x16x32_bf16 v[232:235], a[36:39], a[228:231], v[232:235]
    v_cvt_pk_bf16_f32 v212, v212, v213
    v_cvt_pk_bf16_f32 v213, v214, v215
    v_mfma_f32_16x16x32_bf16 v[232:235], a[40:43], a[232:235], v[232:235]
    ds_write_b64 v251, v[212:213] offset:6144
    v_mfma_f32_16x16x32_bf16 v[232:235], a[44:47], a[236:239], v[232:235]
    v_mul_f32 v216, v216, v225
    v_mul_f32 v217, v217, v225
    v_mfma_f32_16x16x32_bf16 v[236:239], a[48:51], a[216:219], 0
    v_mul_f32 v218, v218, v225
    v_mul_f32 v219, v219, v225
    v_mfma_f32_16x16x32_bf16 v[236:239], a[52:55], a[220:223], v[236:239]
    v_cvt_pk_bf16_f32 v216, v216, v217
    v_cvt_pk_bf16_f32 v217, v218, v219
    v_mfma_f32_16x16x32_bf16 v[236:239], a[56:59], a[224:227], v[236:239]
    v_cvt_pk_bf16_f32 v104, v232, v233
    v_cvt_pk_bf16_f32 v105, v234, v235
    v_mfma_f32_16x16x32_bf16 v[236:239], a[60:63], a[228:231], v[236:239]
    ds_write_b64 v251, v[216:217] offset:6272
    v_mfma_f32_16x16x32_bf16 v[236:239], a[64:67], a[232:235], v[236:239]
    v_mul_f32 v220, v220, v225
    v_mul_f32 v221, v221, v225
    v_mfma_f32_16x16x32_bf16 v[236:239], a[68:71], a[236:239], v[236:239]
    v_mul_f32 v222, v222, v225
    v_mul_f32 v223, v223, v225
    v_mfma_f32_16x16x32_bf16 v[228:231], a[216:219], a[72:75], 0
    v_cvt_pk_bf16_f32 v220, v220, v221
    v_cvt_pk_bf16_f32 v221, v222, v223
    v_mfma_f32_16x16x32_bf16 v[228:231], a[220:223], a[76:79], v[228:231]
    ds_write_b64 v251, v[220:221] offset:6400
    v_mfma_f32_16x16x32_bf16 v[228:231], a[224:227], a[80:83], v[228:231]
    v_cvt_pk_bf16_f32 v106, v236, v237
    v_cvt_pk_bf16_f32 v107, v238, v239
    v_mfma_f32_16x16x32_bf16 v[228:231], a[228:231], a[84:87], v[228:231]
    v_max3_f32 v248, v248, v224, v225
    v_xor_b32 v255, 64, v254
    v_mfma_f32_16x16x32_bf16 v[228:231], a[232:235], a[88:91], v[228:231]
    v_mfma_f32_16x16x32_bf16 v[228:231], a[236:239], a[92:95], v[228:231]
    v_mfma_f32_16x16x32_bf16 v[232:235], a[216:219], a[96:99], 0
    v_mfma_f32_16x16x32_bf16 v[232:235], a[220:223], a[100:103], v[232:235]
    v_mfma_f32_16x16x32_bf16 v[232:235], a[224:227], a[104:107], v[232:235]
    v_mfma_f32_16x16x32_bf16 v[232:235], a[228:231], a[108:111], v[232:235]
    v_mfma_f32_16x16x32_bf16 v[232:235], a[232:235], a[112:115], v[232:235]
    v_mfma_f32_16x16x32_bf16 v[232:235], a[236:239], a[116:119], v[232:235]
    v_mfma_f32_16x16x32_bf16 v[236:239], a[216:219], a[120:123], 0
    ds_read_b128 a[216:219], v242 offset:3200
    v_cvt_pk_bf16_f32 v25, v228, v229
    v_mfma_f32_16x16x32_bf16 v[236:239], a[220:223], a[124:127], v[236:239]
    ds_read_b128 a[220:223], v243 offset:3200
    v_cvt_pk_bf16_f32 v28, v230, v231
    v_mfma_f32_16x16x32_bf16 v[236:239], a[224:227], a[128:131], v[236:239]
    ds_read_b128 a[224:227], v242 offset:3328
    s_waitcnt lgkmcnt(3)
    v_mfma_f32_16x16x32_bf16 v[236:239], a[228:231], a[132:135], v[236:239]
    ds_read_b128 a[228:231], v243 offset:3328
    v_cvt_pk_bf16_f32 v55, v232, v233
    v_mfma_f32_16x16x32_bf16 v[236:239], a[232:235], a[136:139], v[236:239]
    ds_read_b128 a[232:235], v240 offset:6144
    v_cvt_pk_bf16_f32 v58, v234, v235
    v_mfma_f32_16x16x32_bf16 v[236:239], a[236:239], a[140:143], v[236:239]
    ds_read_b128 a[236:239], v241 offset:6144
    v_mfma_f32_16x16x32_bf16 v[228:231], a[144:147], a[240:243], 0
    v_mfma_f32_16x16x32_bf16 v[228:231], a[148:151], a[244:247], v[228:231]
    v_mfma_f32_16x16x32_bf16 v[232:235], a[168:171], a[240:243], 0
    v_mfma_f32_16x16x32_bf16 v[232:235], a[172:175], a[244:247], v[232:235]
    s_waitcnt lgkmcnt(5)
    v_mfma_f32_16x16x32_bf16 v[228:231], a[152:155], a[216:219], v[228:231]
    s_waitcnt lgkmcnt(4)
    v_cvt_pk_bf16_f32 v85, v236, v237
    v_cvt_pk_bf16_f32 v88, v238, v239
    v_mfma_f32_16x16x32_bf16 v[228:231], a[156:159], a[220:223], v[228:231]
    s_waitcnt lgkmcnt(3)
    v_mfma_f32_16x16x32_bf16 v[228:231], a[160:163], a[224:227], v[228:231]
    s_waitcnt lgkmcnt(2)
    v_mfma_f32_16x16x32_bf16 v[228:231], a[164:167], a[228:231], v[228:231]
    v_mfma_f32_16x16x32_bf16 v[232:235], a[176:179], a[216:219], v[232:235]
    v_mfma_f32_16x16x32_bf16 v[232:235], a[180:183], a[220:223], v[232:235]
    v_mfma_f32_16x16x32_bf16 v[232:235], a[184:187], a[224:227], v[232:235]
    v_mfma_f32_16x16x32_bf16 v[232:235], a[188:191], a[228:231], v[232:235]
    v_mfma_f32_16x16x32_bf16 v[236:239], a[192:195], a[240:243], 0
    ds_read_b128 a[240:243], v240 offset:6272
    v_mfma_f32_16x16x32_bf16 v[236:239], a[196:199], a[244:247], v[236:239]
    ds_read_b128 a[244:247], v241 offset:6272
    v_mul_f32 v228, s38, v228
    v_mfma_f32_16x16x32_bf16 v[236:239], a[200:203], a[216:219], v[236:239]
    v_mul_f32 v229, s38, v229
    v_mul_f32 v230, s38, v230
    v_mfma_f32_16x16x32_bf16 v[236:239], a[204:207], a[220:223], v[236:239]
    v_mul_f32 v231, s38, v231
    v_cvt_pk_bf16_f32 v168, v228, v229
    v_mfma_f32_16x16x32_bf16 v[236:239], a[208:211], a[224:227], v[236:239]
    v_cvt_pk_bf16_f32 v169, v230, v231
    s_waitcnt lgkmcnt(2)
    v_mfma_f32_16x16x32_bf16 v[236:239], a[212:215], a[228:231], v[236:239]
    v_mul_f32 v232, s3, v232
    v_mul_f32 v233, s3, v233
    v_mfma_f32_16x16x32_bf16 v[228:231], a[0:3], a[232:235], 0
    v_mul_f32 v234, s3, v234
    v_mul_f32 v235, s3, v235
    v_mfma_f32_16x16x32_bf16 v[228:231], a[4:7], a[236:239], v[228:231]
    v_cvt_pk_bf16_f32 v170, v232, v233
    v_cvt_pk_bf16_f32 v171, v234, v235
    v_mfma_f32_16x16x32_bf16 v[232:235], a[24:27], a[232:235], 0
    ds_read_b128 a[216:219], v240 offset:6400
    ds_read_b128 a[220:223], v241 offset:6400
    v_mfma_f32_16x16x32_bf16 v[204:207], v[90:93], v[168:171], v[204:207]
    v_mul_f32 v236, s38, v236
    v_mul_f32 v237, s38, v237
    v_mfma_f32_16x16x32_bf16 v[208:211], v[126:129], v[168:171], v[208:211]
    v_mul_f32 v238, s38, v238
    v_mul_f32 v239, s38, v239
    v_mfma_f32_16x16x32_bf16 v[196:199], v[150:153], v[168:171], v[196:199]
    v_cvt_pk_bf16_f32 v172, v236, v237
    v_cvt_pk_bf16_f32 v173, v238, v239
    v_mfma_f32_16x16x32_bf16 v[200:203], v[96:99], v[168:171], v[200:203]
    ds_read_b128 a[224:227], v254 offset:4608
    ds_read_b128 a[228:231], v255 offset:4608
    v_mfma_f32_16x16x32_bf16 v[204:207], v[92:95], v[170:173], v[204:207]
    s_waitcnt lgkmcnt(5)
    v_mfma_f32_16x16x32_bf16 v[208:211], v[128:131], v[170:173], v[208:211]
    v_mfma_f32_16x16x32_bf16 v[196:199], v[152:155], v[170:173], v[196:199]
    v_mfma_f32_16x16x32_bf16 v[200:203], v[98:101], v[170:173], v[200:203]
    v_mfma_f32_16x16x32_bf16 v[228:231], a[8:11], a[240:243], v[228:231]
    s_waitcnt lgkmcnt(4)
    v_mfma_f32_16x16x32_bf16 v[228:231], a[12:15], a[244:247], v[228:231]
    s_waitcnt lgkmcnt(3)
    v_exp_f32 v204, v204
    v_mfma_f32_16x16x32_bf16 v[228:231], a[16:19], a[216:219], v[228:231]
    s_waitcnt lgkmcnt(2)
    v_exp_f32 v205, v205
    v_mfma_f32_16x16x32_bf16 v[228:231], a[20:23], a[220:223], v[228:231]
    v_exp_f32 v206, v206
    v_mfma_f32_16x16x32_bf16 v[232:235], a[28:31], a[236:239], v[232:235]
    v_exp_f32 v207, v207
    v_mfma_f32_16x16x32_bf16 v[232:235], a[32:35], a[240:243], v[232:235]
    v_cvt_pk_bf16_f32 v180, v204, v205
    v_cvt_pk_bf16_f32 v183, v206, v207
    v_mfma_f32_16x16x32_bf16 v[232:235], a[36:39], a[244:247], v[232:235]
    ds_read_b128 v[204:207], v245 offset:64
    v_cvt_pk_bf16_f32 v108, v228, v229
    v_mfma_f32_16x16x32_bf16 v[232:235], a[40:43], a[216:219], v[232:235]
    v_exp_f32 v208, v208
    v_mfma_f32_16x16x32_bf16 v[232:235], a[44:47], a[220:223], v[232:235]
    v_exp_f32 v209, v209
    v_mfma_f32_16x16x32_bf16 v[236:239], a[48:51], a[232:235], 0
    v_exp_f32 v210, v210
    v_mfma_f32_16x16x32_bf16 v[236:239], a[52:55], a[236:239], v[236:239]
    v_exp_f32 v211, v211
    v_mfma_f32_16x16x32_bf16 v[236:239], a[56:59], a[240:243], v[236:239]
    v_cvt_pk_bf16_f32 v181, v208, v209
    v_cvt_pk_bf16_f32 v184, v210, v211
    v_mfma_f32_16x16x32_bf16 v[236:239], a[60:63], a[244:247], v[236:239]
    ds_read_b128 v[208:211], v246 offset:64
    v_cvt_pk_bf16_f32 v109, v230, v231
    v_mfma_f32_16x16x32_bf16 v[236:239], a[64:67], a[216:219], v[236:239]
    v_exp_f32 v196, v196
    v_mfma_f32_16x16x32_bf16 v[236:239], a[68:71], a[220:223], v[236:239]
    v_exp_f32 v197, v197
    v_mfma_f32_16x16x32_bf16 v[228:231], a[232:235], a[72:75], 0
    s_waitcnt lgkmcnt(1)
    v_exp_f32 v198, v198
    v_mfma_f32_16x16x32_bf16 v[204:207], v[132:135], v[168:171], v[204:207]
    v_exp_f32 v199, v199
    v_mfma_f32_16x16x32_bf16 v[204:207], v[134:137], v[170:173], v[204:207]
    v_cvt_pk_bf16_f32 v182, v196, v197
    v_cvt_pk_bf16_f32 v185, v198, v199
    v_mfma_f32_16x16x32_bf16 v[228:231], a[236:239], a[76:79], v[228:231]
    ds_read_b128 v[196:199], v244 offset:128
    v_cvt_pk_bf16_f32 v110, v232, v233
    v_mfma_f32_16x16x32_bf16 v[212:215], v[12:15], v[180:183], 0
    v_exp_f32 v200, v200
    v_mfma_f32_16x16x32_bf16 v[216:219], v[42:45], v[180:183], 0
    v_exp_f32 v201, v201
    v_mfma_f32_16x16x32_bf16 v[220:223], v[72:75], v[180:183], 0
    s_waitcnt lgkmcnt(1)
    v_exp_f32 v202, v202
    v_mfma_f32_16x16x32_bf16 v[224:227], a[248:251], v[180:183], 0
    v_exp_f32 v203, v203
    v_mfma_f32_16x16x32_bf16 v[208:211], v[156:159], v[168:171], v[208:211]
    v_cvt_pk_bf16_f32 v186, v200, v201
    v_cvt_pk_bf16_f32 v189, v202, v203
    v_mfma_f32_16x16x32_bf16 v[208:211], v[158:161], v[170:173], v[208:211]
    ds_read_b128 v[200:203], v245 offset:128
    v_cvt_pk_bf16_f32 v111, v234, v235
    v_mfma_f32_16x16x32_bf16 v[228:231], a[240:243], a[80:83], v[228:231]
    v_exp_f32 v204, v204
    v_mfma_f32_16x16x32_bf16 v[228:231], a[244:247], a[84:87], v[228:231]
    v_exp_f32 v205, v205
    v_mfma_f32_16x16x32_bf16 v[228:231], a[216:219], a[88:91], v[228:231]
    s_waitcnt lgkmcnt(1)
    v_cvt_pk_bf16_f32 v187, v204, v205
    v_cvt_pk_bf16_f32 v112, v236, v237
    v_mfma_f32_16x16x32_bf16 v[196:199], v[162:165], v[168:171], v[196:199]
    v_exp_f32 v206, v206
    v_mfma_f32_16x16x32_bf16 v[212:215], v[16:19], v[184:187], v[212:215]
    v_exp_f32 v207, v207
    v_mfma_f32_16x16x32_bf16 v[216:219], v[46:49], v[184:187], v[216:219]
    v_cvt_pk_bf16_f32 v190, v206, v207
    v_cvt_pk_bf16_f32 v113, v238, v239
    v_mfma_f32_16x16x32_bf16 v[220:223], v[76:79], v[184:187], v[220:223]
    ds_read_b128 v[204:207], v246 offset:128
    v_mfma_f32_16x16x32_bf16 v[224:227], a[248:251], v[184:187], v[224:227]
    v_exp_f32 v208, v208
    v_mfma_f32_16x16x32_bf16 v[196:199], v[164:167], v[170:173], v[196:199]
    v_exp_f32 v209, v209
    v_mfma_f32_16x16x32_bf16 v[228:231], a[220:223], a[92:95], v[228:231]
    s_waitcnt lgkmcnt(1)
    v_exp_f32 v210, v210
    v_mfma_f32_16x16x32_bf16 v[200:203], v[102:105], v[168:171], v[200:203]
    v_exp_f32 v211, v211
    v_mfma_f32_16x16x32_bf16 v[200:203], v[104:107], v[170:173], v[200:203]
    v_cvt_pk_bf16_f32 v188, v208, v209
    v_cvt_pk_bf16_f32 v191, v210, v211
    v_mfma_f32_16x16x32_bf16 v[232:235], a[232:235], a[96:99], 0
    v_cvt_pk_bf16_f32 v26, v228, v229
    v_cvt_pk_bf16_f32 v29, v230, v231
    v_mfma_f32_16x16x32_bf16 v[212:215], v[20:23], v[188:191], v[212:215]
    v_exp_f32 v196, v196
    v_mfma_f32_16x16x32_bf16 v[216:219], v[50:53], v[188:191], v[216:219]
    v_exp_f32 v197, v197
    v_mfma_f32_16x16x32_bf16 v[220:223], v[80:83], v[188:191], v[220:223]
    s_waitcnt lgkmcnt(0)
    v_exp_f32 v200, v200
    v_mfma_f32_16x16x32_bf16 v[224:227], a[248:251], v[188:191], v[224:227]
    v_exp_f32 v201, v201
    v_mfma_f32_16x16x32_bf16 v[204:207], v[108:111], v[168:171], v[204:207]
    v_cvt_pk_bf16_f32 v192, v196, v197
    v_cvt_pk_bf16_f32 v193, v200, v201
    v_mfma_f32_16x16x32_bf16 v[204:207], v[110:113], v[170:173], v[204:207]
    ds_read_b128 v[208:211], v244 offset:0
    ds_read_b128 v[196:199], v245 offset:0
    v_mfma_f32_16x16x32_bf16 v[232:235], a[236:239], a[100:103], v[232:235]
    ds_read_b128 v[200:203], v246 offset:0
    v_mfma_f32_16x16x32_bf16 v[232:235], a[240:243], a[104:107], v[232:235]
    v_mfma_f32_16x16x32_bf16 v[232:235], a[244:247], a[108:111], v[232:235]
    v_mfma_f32_16x16x32_bf16 v[232:235], a[216:219], a[112:115], v[232:235]
    v_mfma_f32_16x16x32_bf16 v[232:235], a[220:223], a[116:119], v[232:235]
    v_exp_f32 v204, v204
    v_mfma_f32_16x16x32_bf16 v[236:239], a[232:235], a[120:123], 0
    ds_read_b128 a[232:235], v254 offset:4736
    v_mfma_f32_16x16x32_bf16 v[236:239], a[236:239], a[124:127], v[236:239]
    ds_read_b128 a[236:239], v255 offset:4736
    v_mfma_f32_16x16x32_bf16 v[236:239], a[240:243], a[128:131], v[236:239]
    ds_read_b128 a[240:243], v254 offset:4864
    v_accvgpr_read_b32 v254, a252
    v_mfma_f32_16x16x32_bf16 v[236:239], a[244:247], a[132:135], v[236:239]
    ds_read_b128 a[244:247], v255 offset:4864
    v_cvt_pk_bf16_f32 v56, v232, v233
    v_mfma_f32_16x16x32_bf16 v[236:239], a[216:219], a[136:139], v[236:239]
    buffer_load_dwordx4 v254, s[4:7], s44 offen lds
    v_cvt_pk_bf16_f32 v59, v234, v235
    v_mfma_f32_16x16x32_bf16 v[236:239], a[220:223], a[140:143], v[236:239]
    v_exp_f32 v205, v205
    v_mfma_f32_16x16x32_bf16 v[228:231], a[144:147], a[224:227], 0
    v_cvt_pk_bf16_f32 v194, v204, v205
    v_accvgpr_read_b32 v255, a253
    v_mfma_f32_16x16x32_bf16 v[228:231], a[148:151], a[228:231], v[228:231]
    ds_read_b128 v[204:207], v244 offset:64
    v_accvgpr_read_b32 v254, a254
    v_mfma_f32_16x16x32_bf16 v[212:215], v[24:27], v[192:195], v[212:215]
    v_cvt_pk_bf16_f32 v86, v236, v237
    s_waitcnt lgkmcnt(4)
    v_mfma_f32_16x16x32_bf16 v[216:219], v[54:57], v[192:195], v[216:219]
    buffer_load_dwordx4 v255, s[4:7], s44 offen offset:1024 lds
    v_cvt_pk_bf16_f32 v89, v238, v239
    v_mfma_f32_16x16x32_bf16 v[220:223], v[84:87], v[192:195], v[220:223]
    v_accvgpr_read_b32 v255, a252
    v_mfma_f32_16x16x32_bf16 v[224:227], a[248:251], v[192:195], v[224:227]
    v_mfma_f32_16x16x32_bf16 v[228:231], a[152:155], a[232:235], v[228:231]
    s_waitcnt lgkmcnt(3)
    v_mfma_f32_16x16x32_bf16 v[228:231], a[156:159], a[236:239], v[228:231]
    s_waitcnt lgkmcnt(2)
    v_mfma_f32_16x16x32_bf16 v[228:231], a[160:163], a[240:243], v[228:231]
    s_waitcnt lgkmcnt(1)
    s_waitcnt vmcnt(7)
    s_barrier
    v_mfma_f32_16x16x32_bf16 v[228:231], a[164:167], a[244:247], v[228:231]
    ds_read_b128 a[216:219], v240 offset:30720
    ds_read_b128 a[220:223], v241 offset:30720
    v_mfma_f32_16x16x32_bf16 v[232:235], a[168:171], a[224:227], 0
    v_rcp_f32 v225, v224
    v_mfma_f32_16x16x32_bf16 v[232:235], a[172:175], a[228:231], v[232:235]
    v_mul_f32 v212, v212, v225
    v_mul_f32 v213, v213, v225
    v_mfma_f32_16x16x32_bf16 v[232:235], a[176:179], a[232:235], v[232:235]
    v_mul_f32 v228, s38, v228
    v_mul_f32 v229, s38, v229
    v_mfma_f32_16x16x32_bf16 v[232:235], a[180:183], a[236:239], v[232:235]
    v_mul_f32 v230, s38, v230
    v_mul_f32 v231, s38, v231
    v_mfma_f32_16x16x32_bf16 v[232:235], a[184:187], a[240:243], v[232:235]
    v_cvt_pk_bf16_f32 v174, v228, v229
    v_cvt_pk_bf16_f32 v175, v230, v231
    v_mfma_f32_16x16x32_bf16 v[232:235], a[188:191], a[244:247], v[232:235]
L_h4:
    s_cbranch_execz L_h8
    v_mul_f32 v214, v214, v225
    v_mul_f32 v215, v215, v225
    v_mfma_f32_16x16x32_bf16 v[236:239], a[192:195], a[224:227], 0
    ds_read_b128 a[224:227], v240 offset:30848
    v_cvt_pk_bf16_f32 v212, v212, v213
    v_mfma_f32_16x16x32_bf16 v[236:239], a[196:199], a[228:231], v[236:239]
    ds_read_b128 a[228:231], v241 offset:30848
    v_cvt_pk_bf16_f32 v213, v214, v215
    v_mfma_f32_16x16x32_bf16 v[236:239], a[200:203], a[232:235], v[236:239]
    v_mul_f32 v232, s3, v232
    v_mul_f32 v233, s3, v233
    v_mfma_f32_16x16x32_bf16 v[236:239], a[204:207], a[236:239], v[236:239]
    v_mul_f32 v234, s3, v234
    v_mul_f32 v235, s3, v235
    v_mfma_f32_16x16x32_bf16 v[236:239], a[208:211], a[240:243], v[236:239]
    v_cvt_pk_bf16_f32 v176, v232, v233
    v_cvt_pk_bf16_f32 v177, v234, v235
    v_mfma_f32_16x16x32_bf16 v[236:239], a[212:215], a[244:247], v[236:239]
    s_waitcnt lgkmcnt(3)
    ds_read_b128 a[232:235], v240 offset:30976
    v_mfma_f32_16x16x32_bf16 v[208:211], v[96:99], v[174:177], v[208:211]
    ds_read_b128 a[236:239], v241 offset:30976
    v_mul_f32 v216, v216, v225
    v_mfma_f32_16x16x32_bf16 v[196:199], v[132:135], v[174:177], v[196:199]
    ds_write_b64 v251, v[212:213] offset:12288
    v_mfma_f32_16x16x32_bf16 v[200:203], v[156:159], v[174:177], v[200:203]
    v_mul_f32 v236, s38, v236
    v_mul_f32 v237, s38, v237
    v_mfma_f32_16x16x32_bf16 v[204:207], v[162:165], v[174:177], v[204:207]
    v_mul_f32 v238, s38, v238
    v_mul_f32 v239, s38, v239
    v_mfma_f32_16x16x32_bf16 v[228:231], a[0:3], a[216:219], 0
    s_waitcnt lgkmcnt(5)
    v_cvt_pk_bf16_f32 v178, v236, v237
    v_cvt_pk_bf16_f32 v179, v238, v239
    v_mfma_f32_16x16x32_bf16 v[228:231], a[4:7], a[220:223], v[228:231]
    v_mul_f32 v217, v217, v225
    v_mul_f32 v218, v218, v225
    v_mfma_f32_16x16x32_bf16 v[208:211], v[98:101], v[176:179], v[208:211]
    v_mul_f32 v219, v219, v225
    v_cvt_pk_bf16_f32 v216, v216, v217
    v_mfma_f32_16x16x32_bf16 v[196:199], v[134:137], v[176:179], v[196:199]
    s_waitcnt lgkmcnt(4)
    v_cvt_pk_bf16_f32 v217, v218, v219
    v_mul_f32 v220, v220, v225
    v_mfma_f32_16x16x32_bf16 v[200:203], v[158:161], v[176:179], v[200:203]
    ds_write_b64 v251, v[216:217] offset:12416
    v_mfma_f32_16x16x32_bf16 v[204:207], v[164:167], v[176:179], v[204:207]
    v_exp_f32 v208, v208
    v_mfma_f32_16x16x32_bf16 v[228:231], a[8:11], a[224:227], v[228:231]
    s_waitcnt lgkmcnt(4)
    v_exp_f32 v209, v209
    v_mfma_f32_16x16x32_bf16 v[228:231], a[12:15], a[228:231], v[228:231]
    s_waitcnt lgkmcnt(3)
    v_exp_f32 v210, v210
    v_mfma_f32_16x16x32_bf16 v[228:231], a[16:19], a[232:235], v[228:231]
    s_waitcnt lgkmcnt(2)
    v_exp_f32 v211, v211
    v_mfma_f32_16x16x32_bf16 v[228:231], a[20:23], a[236:239], v[228:231]
    v_cvt_pk_bf16_f32 v180, v208, v209
    v_cvt_pk_bf16_f32 v183, v210, v211
    v_mfma_f32_16x16x32_bf16 v[232:235], a[24:27], a[216:219], 0
    ds_read_b128 v[208:211], v245 offset:64
    v_mul_f32 v221, v221, v225
    v_mfma_f32_16x16x32_bf16 v[232:235], a[28:31], a[220:223], v[232:235]
    v_exp_f32 v196, v196
    v_mfma_f32_16x16x32_bf16 v[232:235], a[32:35], a[224:227], v[232:235]
    v_exp_f32 v197, v197
    v_mfma_f32_16x16x32_bf16 v[232:235], a[36:39], a[228:231], v[232:235]
    v_exp_f32 v198, v198
    v_mfma_f32_16x16x32_bf16 v[232:235], a[40:43], a[232:235], v[232:235]
    v_exp_f32 v199, v199
    v_mfma_f32_16x16x32_bf16 v[232:235], a[44:47], a[236:239], v[232:235]
    v_cvt_pk_bf16_f32 v181, v196, v197
    v_cvt_pk_bf16_f32 v184, v198, v199
    v_mfma_f32_16x16x32_bf16 v[236:239], a[48:51], a[216:219], 0
    v_exp_f32 v200, v200
    v_mfma_f32_16x16x32_bf16 v[236:239], a[52:55], a[220:223], v[236:239]
    v_exp_f32 v201, v201
    v_mfma_f32_16x16x32_bf16 v[236:239], a[56:59], a[224:227], v[236:239]
    ds_read_b128 v[196:199], v246 offset:64
    v_cvt_pk_bf16_f32 v90, v228, v229
    v_mfma_f32_16x16x32_bf16 v[236:239], a[60:63], a[228:231], v[236:239]
    v_cvt_pk_bf16_f32 v91, v230, v231
    v_cvt_pk_bf16_f32 v182, v200, v201
    v_mfma_f32_16x16x32_bf16 v[236:239], a[64:67], a[232:235], v[236:239]
    v_mul_f32 v222, v222, v225
    v_mul_f32 v223, v223, v225
    v_mfma_f32_16x16x32_bf16 v[212:215], v[18:21], v[180:183], 0
    v_cvt_pk_bf16_f32 v220, v220, v221
    v_cvt_pk_bf16_f32 v221, v222, v223
    v_mfma_f32_16x16x32_bf16 v[216:219], v[48:51], v[180:183], 0
    s_waitcnt lgkmcnt(1)
    v_max3_f32 v248, v248, v224, v225
    v_cvt_pk_bf16_f32 v92, v232, v233
    v_mfma_f32_16x16x32_bf16 v[224:227], a[248:251], v[180:183], 0
    ds_write_b64 v251, v[220:221] offset:12544
    v_mfma_f32_16x16x32_bf16 v[220:223], v[78:81], v[180:183], 0
    ds_read_b128 a[240:243], v242 offset:30720
    v_cvt_pk_bf16_f32 v93, v234, v235
    v_mfma_f32_16x16x32_bf16 v[208:211], v[102:105], v[174:177], v[208:211]
    v_exp_f32 v202, v202
    v_mfma_f32_16x16x32_bf16 v[208:211], v[104:107], v[176:179], v[208:211]
    v_exp_f32 v203, v203
    v_mfma_f32_16x16x32_bf16 v[236:239], a[68:71], a[236:239], v[236:239]
    v_exp_f32 v204, v204
    v_mfma_f32_16x16x32_bf16 v[228:231], a[216:219], a[72:75], 0
    s_waitcnt lgkmcnt(2)
    v_exp_f32 v205, v205
    v_mfma_f32_16x16x32_bf16 v[196:199], v[108:111], v[174:177], v[196:199]
    v_cvt_pk_bf16_f32 v185, v202, v203
    v_cvt_pk_bf16_f32 v186, v204, v205
    v_mfma_f32_16x16x32_bf16 v[196:199], v[110:113], v[176:179], v[196:199]
    v_exp_f32 v208, v208
    v_mfma_f32_16x16x32_bf16 v[228:231], a[220:223], a[76:79], v[228:231]
    v_exp_f32 v209, v209
    v_mfma_f32_16x16x32_bf16 v[228:231], a[224:227], a[80:83], v[228:231]
    v_cvt_pk_bf16_f32 v187, v208, v209
    v_cvt_pk_bf16_f32 v94, v236, v237
    v_mfma_f32_16x16x32_bf16 v[228:231], a[228:231], a[84:87], v[228:231]
    ds_read_b128 a[244:247], v243 offset:30720
    v_cvt_pk_bf16_f32 v95, v238, v239
    v_mfma_f32_16x16x32_bf16 v[212:215], v[22:25], v[184:187], v[212:215]
    v_exp_f32 v206, v206
    v_mfma_f32_16x16x32_bf16 v[216:219], v[52:55], v[184:187], v[216:219]
    v_exp_f32 v207, v207
    v_mfma_f32_16x16x32_bf16 v[220:223], v[82:85], v[184:187], v[220:223]
    v_exp_f32 v210, v210
    v_mfma_f32_16x16x32_bf16 v[224:227], a[248:251], v[184:187], v[224:227]
    v_exp_f32 v211, v211
    v_mfma_f32_16x16x32_bf16 v[228:231], a[232:235], a[88:91], v[228:231]
    v_exp_f32 v196, v196
    v_mfma_f32_16x16x32_bf16 v[228:231], a[236:239], a[92:95], v[228:231]
    v_exp_f32 v197, v197
    v_mfma_f32_16x16x32_bf16 v[232:235], a[216:219], a[96:99], 0
    v_exp_f32 v198, v198
    v_mfma_f32_16x16x32_bf16 v[232:235], a[220:223], a[100:103], v[232:235]
    v_exp_f32 v199, v199
    v_mfma_f32_16x16x32_bf16 v[232:235], a[224:227], a[104:107], v[232:235]
    v_cvt_pk_bf16_f32 v189, v206, v207
    v_cvt_pk_bf16_f32 v190, v210, v211
    v_mfma_f32_16x16x32_bf16 v[232:235], a[228:231], a[108:111], v[232:235]
    v_cvt_pk_bf16_f32 v0, v228, v229
    v_cvt_pk_bf16_f32 v3, v230, v231
    v_mfma_f32_16x16x32_bf16 v[232:235], a[232:235], a[112:115], v[232:235]
    s_waitcnt lgkmcnt(1)
    v_cvt_pk_bf16_f32 v188, v196, v197
    v_cvt_pk_bf16_f32 v191, v198, v199
    v_mfma_f32_16x16x32_bf16 v[232:235], a[236:239], a[116:119], v[232:235]
    v_mov_b32 v200, 0x237c0
    v_add_u32 v201, 0xfffff900, v245
    v_mfma_f32_16x16x32_bf16 v[212:215], v[26:29], v[188:191], v[212:215]
    buffer_load_dwordx4 v254, s[4:7], s44 offen offset:2048 lds
    v_add_u32 v246, 0x700, v245
    v_mfma_f32_16x16x32_bf16 v[216:219], v[56:59], v[188:191], v[216:219]
    ds_write_b64 v247, v[174:175] offset:0
    v_mfma_f32_16x16x32_bf16 v[220:223], v[86:89], v[188:191], v[220:223]
    s_add_u32 m0, s46, 0xc00
    v_cvt_pk_bf16_f32 v30, v232, v233
    v_cvt_pk_bf16_f32 v33, v234, v235
    v_mfma_f32_16x16x32_bf16 v[224:227], a[248:251], v[188:191], v[224:227]
    ds_write_b64 v247, v[176:177] offset:128
    v_mfma_f32_16x16x32_bf16 v[236:239], a[216:219], a[120:123], 0
    ds_read_b128 a[216:219], v242 offset:30848
    v_mov_b32 v191, 0
    v_mfma_f32_16x16x32_bf16 v[236:239], a[220:223], a[124:127], v[236:239]
    ds_read_b128 a[220:223], v243 offset:30848
    v_accvgpr_read_b32 v254, a253
    v_mfma_f32_16x16x32_bf16 v[236:239], a[224:227], a[128:131], v[236:239]
    ds_read_b128 a[224:227], v242 offset:30976
    v_mov_b32 v226, 0x22e00
    v_mfma_f32_16x16x32_bf16 v[236:239], a[228:231], a[132:135], v[236:239]
    ds_read_b128 a[228:231], v243 offset:30976
    v_cndmask_b32 v226, v226, v247, vcc
    v_mfma_f32_16x16x32_bf16 v[236:239], a[232:235], a[136:139], v[236:239]
    ds_read_b128 a[232:235], v240 offset:32256
    s_mov_b32 vcc_lo, 0x0
    v_mfma_f32_16x16x32_bf16 v[236:239], a[236:239], a[140:143], v[236:239]
    ds_read_b128 a[236:239], v241 offset:32256
    s_mov_b32 vcc_hi, 0xf0000
    v_mfma_f32_16x16x32_bf16 v[228:231], a[144:147], a[240:243], 0
    s_waitcnt lgkmcnt(8)
    v_cndmask_b32 v245, v245, v200, vcc
    v_cndmask_b32 v244, v201, v244, vcc
    v_mfma_f32_16x16x32_bf16 v[228:231], a[148:151], a[244:247], v[228:231]
    ds_read_b128 v[204:207], v245 offset:192
    v_cvt_pk_bf16_f32 v60, v236, v237
    v_mfma_f32_16x16x32_bf16 v[232:235], a[168:171], a[240:243], 0
    s_mov_b32 vcc_lo, 0xff00fff0
    s_waitcnt lgkmcnt(6)
    v_cvt_pk_bf16_f32 v63, v238, v239
    v_mfma_f32_16x16x32_bf16 v[228:231], a[152:155], a[216:219], v[228:231]
    s_mov_b32 vcc_hi, 0xf000
    s_waitcnt lgkmcnt(5)
    v_cndmask_b32 v244, v244, v200, vcc
    v_mfma_f32_16x16x32_bf16 v[228:231], a[156:159], a[220:223], v[228:231]
    ds_read_b128 v[196:199], v244 offset:256
    s_waitcnt lgkmcnt(5)
    v_mfma_f32_16x16x32_bf16 v[228:231], a[160:163], a[224:227], v[228:231]
    s_mov_b32 vcc_lo, 0xfff00ff
    s_waitcnt lgkmcnt(4)
    s_mov_b32 vcc_hi, 0xffffffff
    v_mfma_f32_16x16x32_bf16 v[228:231], a[164:167], a[228:231], v[228:231]
    buffer_load_dwordx4 v255, s[4:7], s59 offen lds
    v_cndmask_b32 v246, v246, v200, vcc
    v_mfma_f32_16x16x32_bf16 v[232:235], a[172:175], a[244:247], v[232:235]
    ds_read_b128 v[200:203], v244 offset:192
    v_accvgpr_read_b32 v255, a254
    v_mfma_f32_16x16x32_bf16 v[232:235], a[176:179], a[216:219], v[232:235]
    ds_read_b128 v[208:211], v246 offset:192
    s_mov_b32 vcc_lo, 0xff00ff00
    v_mfma_f32_16x16x32_bf16 v[232:235], a[180:183], a[220:223], v[232:235]
    s_mov_b32 vcc_hi, 0xff00ff00
    v_mul_f32 v228, s38, v228
    v_mul_f32 v229, s38, v229
    v_mfma_f32_16x16x32_bf16 v[232:235], a[184:187], a[224:227], v[232:235]
    v_mul_f32 v230, s38, v230
    v_mul_f32 v231, s38, v231
    v_mfma_f32_16x16x32_bf16 v[232:235], a[188:191], a[228:231], v[232:235]
    v_cvt_pk_bf16_f32 v168, v228, v229
    v_cvt_pk_bf16_f32 v169, v230, v231
    v_mfma_f32_16x16x32_bf16 v[236:239], a[192:195], a[240:243], 0
    ds_read_b128 a[240:243], v240 offset:32384
    s_waitcnt lgkmcnt(5)
    v_mfma_f32_16x16x32_bf16 v[236:239], a[196:199], a[244:247], v[236:239]
    ds_read_b128 a[244:247], v241 offset:32384
    buffer_load_dwordx4 v254, s[4:7], s59 offen offset:1024 lds
    v_mfma_f32_16x16x32_bf16 v[236:239], a[200:203], a[216:219], v[236:239]
    ds_read_b128 a[216:219], v240 offset:32512
    v_mul_f32 v232, s3, v232
    v_mfma_f32_16x16x32_bf16 v[236:239], a[204:207], a[220:223], v[236:239]
    ds_read_b128 a[220:223], v241 offset:32512
    v_mul_f32 v233, s3, v233
    v_mfma_f32_16x16x32_bf16 v[236:239], a[208:211], a[224:227], v[236:239]
    v_mul_f32 v234, s3, v234
    v_mul_f32 v235, s3, v235
    v_mfma_f32_16x16x32_bf16 v[236:239], a[212:215], a[228:231], v[236:239]
    v_cvt_pk_bf16_f32 v170, v232, v233
    v_cvt_pk_bf16_f32 v171, v234, v235
    v_mfma_f32_16x16x32_bf16 v[228:231], a[0:3], a[232:235], 0
    s_waitcnt lgkmcnt(6)
    v_rcp_f32 v225, v224
    v_mfma_f32_16x16x32_bf16 v[204:207], v[138:141], v[168:171], v[204:207]
    v_mul_f32 v212, v212, v225
    v_mul_f32 v213, v213, v225
    v_mfma_f32_16x16x32_bf16 v[196:199], v[120:123], v[168:171], v[196:199]
    v_mul_f32 v236, s38, v236
    v_mul_f32 v237, s38, v237
    v_mfma_f32_16x16x32_bf16 v[228:231], a[4:7], a[236:239], v[228:231]
    s_waitcnt lgkmcnt(3)
    v_mul_f32 v238, s38, v238
    v_mul_f32 v239, s38, v239
    v_mfma_f32_16x16x32_bf16 v[200:203], v[114:117], v[168:171], v[200:203]
    v_cvt_pk_bf16_f32 v172, v236, v237
    v_cvt_pk_bf16_f32 v173, v238, v239
    v_mfma_f32_16x16x32_bf16 v[208:211], v[90:93], v[168:171], v[208:211]
    v_mul_f32 v214, v214, v225
    v_mul_f32 v215, v215, v225
    v_mfma_f32_16x16x32_bf16 v[200:203], v[116:119], v[170:173], v[200:203]
    v_cvt_pk_bf16_f32 v212, v212, v213
    v_cvt_pk_bf16_f32 v213, v214, v215
    v_mfma_f32_16x16x32_bf16 v[204:207], v[140:143], v[170:173], v[204:207]
    ds_write_b64 v247, v[178:179] offset:256
    v_mfma_f32_16x16x32_bf16 v[208:211], v[92:95], v[170:173], v[208:211]
    ds_write_b64 v226, v[212:213] offset:0
    v_mfma_f32_16x16x32_bf16 v[196:199], v[122:125], v[170:173], v[196:199]
    v_mul_f32 v216, v216, v225
    v_mul_f32 v217, v217, v225
    v_mfma_f32_16x16x32_bf16 v[228:231], a[8:11], a[240:243], v[228:231]
    s_waitcnt lgkmcnt(2)
    v_exp_f32 v204, v204
    v_mfma_f32_16x16x32_bf16 v[228:231], a[12:15], a[244:247], v[228:231]
    v_exp_f32 v205, v205
    v_mfma_f32_16x16x32_bf16 v[228:231], a[16:19], a[216:219], v[228:231]
    v_exp_f32 v206, v206
    v_mfma_f32_16x16x32_bf16 v[228:231], a[20:23], a[220:223], v[228:231]
    v_exp_f32 v207, v207
    v_mfma_f32_16x16x32_bf16 v[232:235], a[24:27], a[232:235], 0
    v_cvt_pk_bf16_f32 v194, v204, v205
    v_cvt_pk_bf16_f32 v181, v206, v207
    v_mfma_f32_16x16x32_bf16 v[232:235], a[28:31], a[236:239], v[232:235]
    ds_read_b128 v[204:207], v246 offset:256
    v_mul_f32 v218, v218, v225
    v_mfma_f32_16x16x32_bf16 v[232:235], a[32:35], a[240:243], v[232:235]
    v_cvt_pk_bf16_f32 v96, v228, v229
    v_cvt_pk_bf16_f32 v97, v230, v231
    v_mfma_f32_16x16x32_bf16 v[232:235], a[36:39], a[244:247], v[232:235]
    v_exp_f32 v200, v200
    v_mfma_f32_16x16x32_bf16 v[232:235], a[40:43], a[216:219], v[232:235]
    v_exp_f32 v201, v201
    v_mfma_f32_16x16x32_bf16 v[232:235], a[44:47], a[220:223], v[232:235]
    v_exp_f32 v202, v202
    v_mfma_f32_16x16x32_bf16 v[236:239], a[48:51], a[232:235], 0
    v_exp_f32 v203, v203
    v_mfma_f32_16x16x32_bf16 v[236:239], a[52:55], a[236:239], v[236:239]
    v_cvt_pk_bf16_f32 v193, v200, v201
    v_cvt_pk_bf16_f32 v180, v202, v203
    v_mfma_f32_16x16x32_bf16 v[236:239], a[56:59], a[240:243], v[236:239]
    ds_read_b128 v[200:203], v245 offset:256
    v_cvt_pk_bf16_f32 v98, v232, v233
    v_mfma_f32_16x16x32_bf16 v[236:239], a[60:63], a[244:247], v[236:239]
    v_cvt_pk_bf16_f32 v99, v234, v235
    v_mul_f32 v219, v219, v225
    v_mfma_f32_16x16x32_bf16 v[236:239], a[64:67], a[216:219], v[236:239]
    v_exp_f32 v208, v208
    v_mfma_f32_16x16x32_bf16 v[236:239], a[68:71], a[220:223], v[236:239]
    v_exp_f32 v209, v209
    v_mfma_f32_16x16x32_bf16 v[228:231], a[232:235], a[72:75], 0
    v_exp_f32 v210, v210
    v_mfma_f32_16x16x32_bf16 v[228:231], a[236:239], a[76:79], v[228:231]
    v_exp_f32 v211, v211
    v_mfma_f32_16x16x32_bf16 v[228:231], a[240:243], a[80:83], v[228:231]
    s_waitcnt lgkmcnt(1)
    v_cvt_pk_bf16_f32 v192, v208, v209
    v_cvt_pk_bf16_f32 v100, v236, v237
    v_mfma_f32_16x16x32_bf16 v[204:207], v[96:99], v[168:171], v[204:207]
    v_cvt_pk_bf16_f32 v101, v238, v239
    v_cvt_pk_bf16_f32 v195, v210, v211
    v_mfma_f32_16x16x32_bf16 v[228:231], a[244:247], a[84:87], v[228:231]
    v_cvt_pk_bf16_f32 v216, v216, v217
    v_cvt_pk_bf16_f32 v217, v218, v219
    v_mfma_f32_16x16x32_bf16 v[212:215], v[0:3], v[192:195], 0
    ds_write_b64 v226, v[216:217] offset:128
    v_mfma_f32_16x16x32_bf16 v[216:219], v[30:33], v[192:195], 0
    v_mul_f32 v220, v220, v225
    v_mul_f32 v221, v221, v225
    v_mfma_f32_16x16x32_bf16 v[204:207], v[98:101], v[170:173], v[204:207]
    v_mul_f32 v222, v222, v225
    v_mul_f32 v223, v223, v225
    v_mfma_f32_16x16x32_bf16 v[228:231], a[216:219], a[88:91], v[228:231]
    v_cvt_pk_bf16_f32 v220, v220, v221
    v_cvt_pk_bf16_f32 v221, v222, v223
    v_mfma_f32_16x16x32_bf16 v[228:231], a[220:223], a[92:95], v[228:231]
    ds_write_b64 v226, v[220:221] offset:256
    v_mfma_f32_16x16x32_bf16 v[220:223], v[60:63], v[192:195], 0
    ds_read_b128 v[208:211], v244 offset:320
    v_max3_f32 v248, v248, v224, v225
    v_mfma_f32_16x16x32_bf16 v[224:227], a[248:251], v[192:195], 0
    s_waitcnt lgkmcnt(3)
    v_exp_f32 v196, v196
    v_mfma_f32_16x16x32_bf16 v[200:203], v[144:147], v[168:171], v[200:203]
    v_exp_f32 v197, v197
    v_mfma_f32_16x16x32_bf16 v[200:203], v[146:149], v[170:173], v[200:203]
    v_exp_f32 v204, v204
    v_mfma_f32_16x16x32_bf16 v[232:235], a[232:235], a[96:99], 0
    v_exp_f32 v205, v205
    v_mfma_f32_16x16x32_bf16 v[232:235], a[236:239], a[100:103], v[232:235]
    v_cvt_pk_bf16_f32 v6, v228, v229
    v_cvt_pk_bf16_f32 v183, v196, v197
    v_mfma_f32_16x16x32_bf16 v[232:235], a[240:243], a[104:107], v[232:235]
    ds_read_b128 a[224:227], v242 offset:32256
    v_cvt_pk_bf16_f32 v182, v204, v205
    v_mfma_f32_16x16x32_bf16 v[232:235], a[244:247], a[108:111], v[232:235]
    v_exp_f32 v198, v198
    v_mfma_f32_16x16x32_bf16 v[212:215], v[4:7], v[180:183], v[212:215]
    v_exp_f32 v199, v199
    v_mfma_f32_16x16x32_bf16 v[224:227], a[248:251], v[180:183], v[224:227]
    s_waitcnt lgkmcnt(1)
    v_cvt_pk_bf16_f32 v186, v198, v199
    v_cvt_pk_bf16_f32 v9, v230, v231
    v_mfma_f32_16x16x32_bf16 v[208:211], v[126:129], v[168:171], v[208:211]
    ds_read_b128 v[196:199], v245 offset:320
    ds_read_b128 a[228:231], v243 offset:32256
    v_mfma_f32_16x16x32_bf16 v[208:211], v[128:131], v[170:173], v[208:211]
    v_exp_f32 v200, v200
    v_mfma_f32_16x16x32_bf16 v[232:235], a[216:219], a[112:115], v[232:235]
    v_exp_f32 v201, v201
    v_mfma_f32_16x16x32_bf16 v[232:235], a[220:223], a[116:119], v[232:235]
    v_exp_f32 v202, v202
    v_mfma_f32_16x16x32_bf16 v[236:239], a[232:235], a[120:123], 0
    ds_read_b128 a[232:235], v242 offset:32384
    v_cvt_pk_bf16_f32 v184, v200, v201
    v_mfma_f32_16x16x32_bf16 v[236:239], a[236:239], a[124:127], v[236:239]
    ds_read_b128 a[236:239], v243 offset:32384
    v_accvgpr_read_b32 v254, a252
    v_mfma_f32_16x16x32_bf16 v[236:239], a[240:243], a[128:131], v[236:239]
    ds_read_b128 a[240:243], v242 offset:32512
    v_cvt_pk_bf16_f32 v36, v232, v233
    v_mfma_f32_16x16x32_bf16 v[236:239], a[244:247], a[132:135], v[236:239]
    ds_read_b128 a[244:247], v243 offset:32512
    v_cvt_pk_bf16_f32 v39, v234, v235
    v_mfma_f32_16x16x32_bf16 v[216:219], v[34:37], v[180:183], v[216:219]
    v_exp_f32 v203, v203
    v_mfma_f32_16x16x32_bf16 v[236:239], a[216:219], a[136:139], v[236:239]
    s_waitcnt lgkmcnt(5)
    v_exp_f32 v206, v206
    v_mfma_f32_16x16x32_bf16 v[196:199], v[150:153], v[168:171], v[196:199]
    v_exp_f32 v207, v207
    v_mfma_f32_16x16x32_bf16 v[196:199], v[152:155], v[170:173], v[196:199]
    v_cvt_pk_bf16_f32 v187, v202, v203
    v_cvt_pk_bf16_f32 v185, v206, v207
    v_mfma_f32_16x16x32_bf16 v[236:239], a[220:223], a[140:143], v[236:239]
    ds_read_b128 a[216:219], v242 offset:33792
    ds_read_b128 a[220:223], v243 offset:33792
    v_mfma_f32_16x16x32_bf16 v[212:215], v[8:11], v[184:187], v[212:215]
    ds_read_b128 v[204:207], v244 offset:0
    ds_read_b128 v[200:203], v246 offset:320
    v_mfma_f32_16x16x32_bf16 v[216:219], v[38:41], v[184:187], v[216:219]
    v_exp_f32 v208, v208
    v_mfma_f32_16x16x32_bf16 v[224:227], a[248:251], v[184:187], v[224:227]
    v_cvt_pk_bf16_f32 v66, v236, v237
    v_cvt_pk_bf16_f32 v69, v238, v239
    v_mfma_f32_16x16x32_bf16 v[228:231], a[144:147], a[224:227], 0
    s_waitcnt lgkmcnt(8)
    v_exp_f32 v209, v209
    v_mfma_f32_16x16x32_bf16 v[220:223], v[64:67], v[180:183], v[220:223]
    buffer_load_dwordx4 v255, s[4:7], s59 offen offset:2048 lds
    v_cvt_pk_bf16_f32 v189, v208, v209
    v_mfma_f32_16x16x32_bf16 v[220:223], v[68:71], v[184:187], v[220:223]
    ds_read_b128 v[208:211], v245 offset:0
    v_accvgpr_read_b32 v255, a255
    v_mfma_f32_16x16x32_bf16 v[228:231], a[148:151], a[228:231], v[228:231]
    s_waitcnt lgkmcnt(6)
    v_exp_f32 v196, v196
    v_mfma_f32_16x16x32_bf16 v[228:231], a[152:155], a[232:235], v[228:231]
    s_add_u32 m0, s46, 0x1800
    v_exp_f32 v197, v197
    v_mfma_f32_16x16x32_bf16 v[228:231], a[156:159], a[236:239], v[228:231]
    buffer_load_dwordx4 v254, s[4:7], s58 offen lds
    v_cvt_pk_bf16_f32 v190, v196, v197
    v_mfma_f32_16x16x32_bf16 v[228:231], a[160:163], a[240:243], v[228:231]
    s_waitcnt lgkmcnt(5)
    ds_read_b128 v[196:199], v246 offset:0
    v_mfma_f32_16x16x32_bf16 v[228:231], a[164:167], a[244:247], v[228:231]
    v_mfma_f32_16x16x32_bf16 v[232:235], a[168:171], a[224:227], 0
    v_mfma_f32_16x16x32_bf16 v[232:235], a[172:175], a[228:231], v[232:235]
    buffer_load_dwordx4 v255, s[4:7], s58 offen offset:512 lds
    s_add_u32 m0, s46, 0x16800
    v_mfma_f32_16x16x32_bf16 v[232:235], a[176:179], a[232:235], v[232:235]
    v_mfma_f32_16x16x32_bf16 v[232:235], a[180:183], a[236:239], v[232:235]
    v_mfma_f32_16x16x32_bf16 v[232:235], a[184:187], a[240:243], v[232:235]
    v_mfma_f32_16x16x32_bf16 v[232:235], a[188:191], a[244:247], v[232:235]
    v_mul_f32 v228, s38, v228
    v_mul_f32 v229, s38, v229
    v_mfma_f32_16x16x32_bf16 v[236:239], a[192:195], a[224:227], 0
    ds_read_b128 a[224:227], v242 offset:33920
    v_mul_f32 v230, s38, v230
    v_mfma_f32_16x16x32_bf16 v[236:239], a[196:199], a[228:231], v[236:239]
    ds_read_b128 a[228:231], v243 offset:33920
    v_mul_f32 v231, s38, v231
    v_mfma_f32_16x16x32_bf16 v[236:239], a[200:203], a[232:235], v[236:239]
    ds_read_b128 a[232:235], v242 offset:34048
    v_cvt_pk_bf16_f32 v174, v228, v229
    v_mfma_f32_16x16x32_bf16 v[236:239], a[204:207], a[236:239], v[236:239]
    ds_read_b128 a[236:239], v243 offset:34048
    v_cvt_pk_bf16_f32 v175, v230, v231
    v_mfma_f32_16x16x32_bf16 v[236:239], a[208:211], a[240:243], v[236:239]
    s_waitcnt lgkmcnt(5)
    v_mul_f32 v232, s3, v232
    v_mul_f32 v233, s3, v233
    v_mfma_f32_16x16x32_bf16 v[236:239], a[212:215], a[244:247], v[236:239]
    v_mul_f32 v234, s3, v234
    v_mul_f32 v235, s3, v235
    v_mfma_f32_16x16x32_bf16 v[228:231], a[144:147], a[216:219], 0
    v_cvt_pk_bf16_f32 v176, v232, v233
    v_cvt_pk_bf16_f32 v177, v234, v235
    v_mfma_f32_16x16x32_bf16 v[228:231], a[148:151], a[220:223], v[228:231]
    s_waitcnt lgkmcnt(4)
    v_mfma_f32_16x16x32_bf16 v[204:207], v[120:123], v[174:177], v[204:207]
    v_mul_f32 v236, s38, v236
    s_waitcnt lgkmcnt(3)
    v_mfma_f32_16x16x32_bf16 v[208:211], v[144:147], v[174:177], v[208:211]
    v_mul_f32 v237, s38, v237
    v_mul_f32 v238, s38, v238
    v_mfma_f32_16x16x32_bf16 v[196:199], v[96:99], v[174:177], v[196:199]
    v_mul_f32 v239, s38, v239
    v_cvt_pk_bf16_f32 v178, v236, v237
    v_mfma_f32_16x16x32_bf16 v[228:231], a[152:155], a[224:227], v[228:231]
    s_waitcnt lgkmcnt(2)
    v_cvt_pk_bf16_f32 v179, v238, v239
    v_mfma_f32_16x16x32_bf16 v[228:231], a[156:159], a[228:231], v[228:231]
    s_waitcnt lgkmcnt(1)
    v_mfma_f32_16x16x32_bf16 v[204:207], v[122:125], v[176:179], v[204:207]
    v_mfma_f32_16x16x32_bf16 v[208:211], v[146:149], v[176:179], v[208:211]
    v_mfma_f32_16x16x32_bf16 v[196:199], v[98:101], v[176:179], v[196:199]
    v_mfma_f32_16x16x32_bf16 v[228:231], a[160:163], a[232:235], v[228:231]
    s_waitcnt lgkmcnt(0)
    s_waitcnt vmcnt(8)
    s_barrier
    v_mfma_f32_16x16x32_bf16 v[228:231], a[164:167], a[236:239], v[228:231]
    ds_read_b128 a[240:243], v240 offset:33792
    ds_read_b128 a[244:247], v241 offset:33792
    v_mfma_f32_16x16x32_bf16 v[232:235], a[168:171], a[216:219], 0
    v_exp_f32 v204, v204
    v_mfma_f32_16x16x32_bf16 v[232:235], a[172:175], a[220:223], v[232:235]
    v_exp_f32 v205, v205
    v_mfma_f32_16x16x32_bf16 v[232:235], a[176:179], a[224:227], v[232:235]
    v_exp_f32 v206, v206
    v_mfma_f32_16x16x32_bf16 v[232:235], a[180:183], a[228:231], v[232:235]
    v_mul_f32 v228, s38, v228
    v_mul_f32 v229, s38, v229
    v_mfma_f32_16x16x32_bf16 v[232:235], a[184:187], a[232:235], v[232:235]
    v_mul_f32 v230, s38, v230
    v_mul_f32 v231, s38, v231
    v_mfma_f32_16x16x32_bf16 v[232:235], a[188:191], a[236:239], v[232:235]
    v_cvt_pk_bf16_f32 v228, v228, v229
    v_cvt_pk_bf16_f32 v229, v230, v231
    v_mfma_f32_16x16x32_bf16 v[236:239], a[192:195], a[216:219], 0
    ds_read_b128 a[216:219], v240 offset:33920
    v_cvt_pk_bf16_f32 v193, v204, v205
    v_mfma_f32_16x16x32_bf16 v[236:239], a[196:199], a[220:223], v[236:239]
    ds_read_b128 a[220:223], v241 offset:33920
    v_mfma_f32_16x16x32_bf16 v[236:239], a[200:203], a[224:227], v[236:239]
    ds_read_b128 a[224:227], v240 offset:34048
    v_mul_f32 v232, s3, v232
    v_mfma_f32_16x16x32_bf16 v[236:239], a[204:207], a[228:231], v[236:239]
    ds_read_b128 a[228:231], v241 offset:34048
    v_mul_f32 v233, s3, v233
    v_mfma_f32_16x16x32_bf16 v[236:239], a[208:211], a[232:235], v[236:239]
    ds_write_b64 v247, v[228:229] offset:18432
    v_mfma_f32_16x16x32_bf16 v[236:239], a[212:215], a[236:239], v[236:239]
    s_waitcnt lgkmcnt(6)
    v_mul_f32 v234, s3, v234
    v_mul_f32 v235, s3, v235
    v_mfma_f32_16x16x32_bf16 v[228:231], a[0:3], a[240:243], 0
    s_waitcnt lgkmcnt(5)
    v_cvt_pk_bf16_f32 v232, v232, v233
    v_cvt_pk_bf16_f32 v233, v234, v235
    v_mfma_f32_16x16x32_bf16 v[228:231], a[4:7], a[244:247], v[228:231]
    ds_write_b64 v247, v[232:233] offset:18560
    v_mfma_f32_16x16x32_bf16 v[232:235], a[24:27], a[240:243], 0
    s_waitcnt lgkmcnt(5)
    v_mul_f32 v236, s38, v236
    v_mul_f32 v237, s38, v237
    v_mfma_f32_16x16x32_bf16 v[228:231], a[8:11], a[216:219], v[228:231]
    s_waitcnt lgkmcnt(4)
    v_mul_f32 v238, s38, v238
    v_mul_f32 v239, s38, v239
    v_mfma_f32_16x16x32_bf16 v[228:231], a[12:15], a[220:223], v[228:231]
    s_waitcnt lgkmcnt(3)
    v_cvt_pk_bf16_f32 v236, v236, v237
    v_cvt_pk_bf16_f32 v237, v238, v239
    v_mfma_f32_16x16x32_bf16 v[228:231], a[16:19], a[224:227], v[228:231]
    ds_write_b64 v247, v[236:237] offset:18688
    v_mfma_f32_16x16x32_bf16 v[232:235], a[28:31], a[244:247], v[232:235]
    s_waitcnt lgkmcnt(3)
    v_exp_f32 v207, v207
    v_mfma_f32_16x16x32_bf16 v[228:231], a[20:23], a[228:231], v[228:231]
    ds_read_b128 a[232:235], v242 offset:61440
    v_cvt_pk_bf16_f32 v180, v206, v207
    v_mfma_f32_16x16x32_bf16 v[232:235], a[32:35], a[216:219], v[232:235]
    ds_read_b128 v[204:207], v245 offset:64
    ds_read_b128 a[236:239], v243 offset:61440
    v_mfma_f32_16x16x32_bf16 v[232:235], a[36:39], a[220:223], v[232:235]
    v_exp_f32 v208, v208
    v_mfma_f32_16x16x32_bf16 v[232:235], a[40:43], a[224:227], v[232:235]
    v_cvt_pk_bf16_f32 v162, v228, v229
    v_cvt_pk_bf16_f32 v163, v230, v231
    v_mfma_f32_16x16x32_bf16 v[232:235], a[44:47], a[228:231], v[232:235]
    v_exp_f32 v209, v209
    v_mfma_f32_16x16x32_bf16 v[236:239], a[48:51], a[240:243], 0
    v_exp_f32 v210, v210
    v_mfma_f32_16x16x32_bf16 v[236:239], a[52:55], a[244:247], v[236:239]
    v_exp_f32 v211, v211
    v_mfma_f32_16x16x32_bf16 v[236:239], a[56:59], a[216:219], v[236:239]
    v_cvt_pk_bf16_f32 v194, v208, v209
    v_cvt_pk_bf16_f32 v181, v210, v211
    v_mfma_f32_16x16x32_bf16 v[236:239], a[60:63], a[220:223], v[236:239]
    v_cvt_pk_bf16_f32 v164, v232, v233
    v_cvt_pk_bf16_f32 v165, v234, v235
    v_mfma_f32_16x16x32_bf16 v[236:239], a[64:67], a[224:227], v[236:239]
    ds_read_b128 v[208:211], v246 offset:64
    v_mfma_f32_16x16x32_bf16 v[200:203], v[162:165], v[168:171], v[200:203]
    v_exp_f32 v196, v196
    v_mfma_f32_16x16x32_bf16 v[236:239], a[68:71], a[228:231], v[236:239]
    v_exp_f32 v197, v197
    v_mfma_f32_16x16x32_bf16 v[228:231], a[240:243], a[72:75], 0
    v_exp_f32 v198, v198
    v_mfma_f32_16x16x32_bf16 v[228:231], a[244:247], a[76:79], v[228:231]
    v_exp_f32 v199, v199
    v_mfma_f32_16x16x32_bf16 v[228:231], a[216:219], a[80:83], v[228:231]
    v_cvt_pk_bf16_f32 v192, v196, v197
    s_waitcnt lgkmcnt(2)
    v_mfma_f32_16x16x32_bf16 v[204:207], v[150:153], v[174:177], v[204:207]
    v_cvt_pk_bf16_f32 v166, v236, v237
    v_cvt_pk_bf16_f32 v167, v238, v239
    v_mfma_f32_16x16x32_bf16 v[204:207], v[152:155], v[176:179], v[204:207]
    ds_read_b64 v[168:169], v247 offset:18432
    v_cvt_pk_bf16_f32 v195, v198, v199
    v_mfma_f32_16x16x32_bf16 v[200:203], v[164:167], v[170:173], v[200:203]
    ds_read_b128 v[196:199], v244 offset:128
    ds_read_b64 v[170:171], v247 offset:18560
    v_mfma_f32_16x16x32_bf16 v[228:231], a[220:223], a[84:87], v[228:231]
    ds_read_b64 v[172:173], v247 offset:18688
    v_mfma_f32_16x16x32_bf16 v[228:231], a[224:227], a[88:91], v[228:231]
    v_exp_f32 v204, v204
    v_mfma_f32_16x16x32_bf16 v[228:231], a[228:231], a[92:95], v[228:231]
    v_exp_f32 v205, v205
    v_mfma_f32_16x16x32_bf16 v[232:235], a[240:243], a[96:99], 0
    v_exp_f32 v200, v200
    v_mfma_f32_16x16x32_bf16 v[232:235], a[244:247], a[100:103], v[232:235]
    v_exp_f32 v201, v201
    v_mfma_f32_16x16x32_bf16 v[232:235], a[216:219], a[104:107], v[232:235]
    s_waitcnt lgkmcnt(4)
    v_cvt_pk_bf16_f32 v188, v200, v201
    v_cvt_pk_bf16_f32 v12, v228, v229
    v_mfma_f32_16x16x32_bf16 v[208:211], v[162:165], v[174:177], v[208:211]
    ds_read_b128 v[200:203], v244 offset:64
    v_cvt_pk_bf16_f32 v15, v230, v231
    v_mfma_f32_16x16x32_bf16 v[224:227], a[248:251], v[188:191], v[224:227]
    v_exp_f32 v206, v206
    v_mfma_f32_16x16x32_bf16 v[212:215], v[12:15], v[188:191], v[212:215]
L_h5:
    s_cbranch_execz L_h9
    v_exp_f32 v207, v207
    v_mfma_f32_16x16x32_bf16 v[208:211], v[164:167], v[176:179], v[208:211]
    v_cvt_pk_bf16_f32 v184, v204, v205
    v_cvt_pk_bf16_f32 v187, v206, v207
    v_mfma_f32_16x16x32_bf16 v[232:235], a[220:223], a[108:111], v[232:235]
    ds_read_b128 v[204:207], v246 offset:128
    v_mfma_f32_16x16x32_bf16 v[232:235], a[224:227], a[112:115], v[232:235]
    v_rcp_f32 v225, v224
    v_mfma_f32_16x16x32_bf16 v[232:235], a[228:231], a[116:119], v[232:235]
    v_mul_f32 v212, v212, v225
    v_mul_f32 v213, v213, v225
    v_mfma_f32_16x16x32_bf16 v[236:239], a[240:243], a[120:123], 0
    s_waitcnt lgkmcnt(3)
    v_mul_f32 v214, v214, v225
    v_mul_f32 v215, v215, v225
    v_mfma_f32_16x16x32_bf16 v[196:199], v[132:135], v[174:177], v[196:199]
    ds_read_b128 a[240:243], v242 offset:61568
    s_waitcnt lgkmcnt(2)
    v_mfma_f32_16x16x32_bf16 v[200:203], v[126:129], v[174:177], v[200:203]
    v_cvt_pk_bf16_f32 v42, v232, v233
    v_cvt_pk_bf16_f32 v45, v234, v235
    v_mfma_f32_16x16x32_bf16 v[200:203], v[128:131], v[176:179], v[200:203]
    v_cvt_pk_bf16_f32 v212, v212, v213
    v_cvt_pk_bf16_f32 v213, v214, v215
    v_mfma_f32_16x16x32_bf16 v[216:219], v[42:45], v[188:191], v[216:219]
    ds_write_b64 v247, v[212:213] offset:6144
    v_mfma_f32_16x16x32_bf16 v[212:215], v[6:9], v[192:195], 0
    v_exp_f32 v208, v208
    v_mfma_f32_16x16x32_bf16 v[196:199], v[134:137], v[176:179], v[196:199]
    v_exp_f32 v209, v209
    v_mfma_f32_16x16x32_bf16 v[236:239], a[244:247], a[124:127], v[236:239]
    ds_read_b128 a[244:247], v243 offset:61568
    v_max3_f32 v248, v248, v224, v225
    v_mfma_f32_16x16x32_bf16 v[236:239], a[216:219], a[128:131], v[236:239]
    ds_read_b128 a[216:219], v242 offset:61696
    v_mul_f32 v216, v216, v225
    v_mfma_f32_16x16x32_bf16 v[236:239], a[220:223], a[132:135], v[236:239]
    ds_read_b128 a[220:223], v243 offset:61696
    v_mul_f32 v217, v217, v225
    v_mfma_f32_16x16x32_bf16 v[236:239], a[224:227], a[136:139], v[236:239]
    v_mul_f32 v218, v218, v225
    v_mul_f32 v219, v219, v225
    v_mfma_f32_16x16x32_bf16 v[236:239], a[228:231], a[140:143], v[236:239]
    v_cvt_pk_bf16_f32 v216, v216, v217
    v_cvt_pk_bf16_f32 v217, v218, v219
    v_mfma_f32_16x16x32_bf16 v[228:231], a[144:147], a[232:235], 0
    ds_write_b64 v247, v[216:217] offset:6272
    v_mfma_f32_16x16x32_bf16 v[216:219], v[36:39], v[192:195], 0
    v_exp_f32 v200, v200
    v_mfma_f32_16x16x32_bf16 v[228:231], a[148:151], a[236:239], v[228:231]
    s_waitcnt lgkmcnt(5)
    v_cvt_pk_bf16_f32 v72, v236, v237
    v_cvt_pk_bf16_f32 v75, v238, v239
    v_mfma_f32_16x16x32_bf16 v[228:231], a[152:155], a[240:243], v[228:231]
    s_waitcnt lgkmcnt(3)
    v_exp_f32 v201, v201
    v_mfma_f32_16x16x32_bf16 v[220:223], v[72:75], v[188:191], v[220:223]
    v_cvt_pk_bf16_f32 v183, v200, v201
    v_cvt_pk_bf16_f32 v182, v208, v209
    v_mfma_f32_16x16x32_bf16 v[228:231], a[156:159], a[244:247], v[228:231]
    s_waitcnt lgkmcnt(2)
    v_exp_f32 v202, v202
    v_mfma_f32_16x16x32_bf16 v[212:215], v[10:13], v[180:183], v[212:215]
    ds_read_b128 a[224:227], v242 offset:62976
    ds_read_b128 a[228:231], v243 offset:62976
    v_mfma_f32_16x16x32_bf16 v[216:219], v[40:43], v[180:183], v[216:219]
    v_mul_f32 v220, v220, v225
    v_mul_f32 v221, v221, v225
    v_mfma_f32_16x16x32_bf16 v[228:231], a[160:163], a[216:219], v[228:231]
    s_waitcnt lgkmcnt(3)
    v_mul_f32 v222, v222, v225
    v_mul_f32 v223, v223, v225
    v_mfma_f32_16x16x32_bf16 v[224:227], a[248:251], v[192:195], 0
    v_cvt_pk_bf16_f32 v220, v220, v221
    v_cvt_pk_bf16_f32 v221, v222, v223
    v_mfma_f32_16x16x32_bf16 v[224:227], a[248:251], v[180:183], v[224:227]
    ds_write_b64 v247, v[220:221] offset:6400
    v_mfma_f32_16x16x32_bf16 v[220:223], v[66:69], v[192:195], 0
    v_exp_f32 v203, v203
    v_mfma_f32_16x16x32_bf16 v[220:223], v[70:73], v[180:183], v[220:223]
    v_exp_f32 v210, v210
    v_mfma_f32_16x16x32_bf16 v[228:231], a[164:167], a[220:223], v[228:231]
    v_exp_f32 v211, v211
    v_mfma_f32_16x16x32_bf16 v[232:235], a[168:171], a[232:235], 0
    s_waitcnt vmcnt(0)
    v_cvt_pk_bf16_f32 v186, v202, v203
    v_cvt_pk_bf16_f32 v185, v210, v211
    v_mfma_f32_16x16x32_bf16 v[232:235], a[172:175], a[236:239], v[232:235]
    ds_read_b128 v[200:203], v245 offset:128
    ds_read_b128 v[208:211], v244 offset:0
    v_mfma_f32_16x16x32_bf16 v[212:215], v[14:17], v[184:187], v[212:215]
    s_barrier
    v_mul_f32 v228, s38, v228
    v_mul_f32 v229, s38, v229
    v_mfma_f32_16x16x32_bf16 v[216:219], v[44:47], v[184:187], v[216:219]
    v_mul_f32 v230, s38, v230
    v_mul_f32 v231, s38, v231
    v_mfma_f32_16x16x32_bf16 v[220:223], v[74:77], v[184:187], v[220:223]
    v_cvt_pk_bf16_f32 v228, v228, v229
    v_cvt_pk_bf16_f32 v229, v230, v231
    v_mfma_f32_16x16x32_bf16 v[224:227], a[248:251], v[184:187], v[224:227]
    ds_write_b64 v247, v[228:229] offset:24576
    v_mfma_f32_16x16x32_bf16 v[232:235], a[176:179], a[240:243], v[232:235]
    s_waitcnt lgkmcnt(4)
    v_exp_f32 v196, v196
    v_mfma_f32_16x16x32_bf16 v[232:235], a[180:183], a[244:247], v[232:235]
    v_exp_f32 v197, v197
    v_mfma_f32_16x16x32_bf16 v[232:235], a[184:187], a[216:219], v[232:235]
    v_cvt_pk_bf16_f32 v189, v196, v197
    v_mfma_f32_16x16x32_bf16 v[232:235], a[188:191], a[220:223], v[232:235]
    ds_read_b128 v[196:199], v245 offset:0
    v_mfma_f32_16x16x32_bf16 v[236:239], a[192:195], a[232:235], 0
    ds_read_b128 a[232:235], v242 offset:63104
    v_mfma_f32_16x16x32_bf16 v[236:239], a[196:199], a[236:239], v[236:239]
    ds_read_b128 a[236:239], v243 offset:63104
    v_mfma_f32_16x16x32_bf16 v[236:239], a[200:203], a[240:243], v[236:239]
    ds_read_b128 a[240:243], v242 offset:63232
    v_mfma_f32_16x16x32_bf16 v[236:239], a[204:207], a[244:247], v[236:239]
    ds_read_b128 a[244:247], v243 offset:63232
    v_mul_f32 v232, s3, v232
    v_mfma_f32_16x16x32_bf16 v[236:239], a[208:211], a[216:219], v[236:239]
    s_waitcnt lgkmcnt(7)
    v_mul_f32 v233, s3, v233
    v_mul_f32 v234, s3, v234
    v_mfma_f32_16x16x32_bf16 v[200:203], v[156:159], v[174:177], v[200:203]
    s_waitcnt lgkmcnt(6)
    v_mul_f32 v235, s3, v235
    v_cvt_pk_bf16_f32 v232, v232, v233
    v_mfma_f32_16x16x32_bf16 v[200:203], v[158:161], v[176:179], v[200:203]
    ds_read_b128 a[216:219], v240 offset:35328
    v_cvt_pk_bf16_f32 v233, v234, v235
    v_mfma_f32_16x16x32_bf16 v[208:211], v[126:129], v[168:171], v[208:211]
    ds_write_b64 v247, v[232:233] offset:24704
    v_mfma_f32_16x16x32_bf16 v[208:211], v[128:131], v[170:173], v[208:211]
    v_mfma_f32_16x16x32_bf16 v[236:239], a[212:215], a[220:223], v[236:239]
    ds_read_b128 a[220:223], v241 offset:35328
    v_mfma_f32_16x16x32_bf16 v[228:231], a[144:147], a[224:227], 0
    v_exp_f32 v200, v200
    v_mfma_f32_16x16x32_bf16 v[228:231], a[148:151], a[228:231], v[228:231]
    s_waitcnt lgkmcnt(6)
    v_exp_f32 v201, v201
    v_mfma_f32_16x16x32_bf16 v[196:199], v[150:153], v[168:171], v[196:199]
    v_exp_f32 v208, v208
    v_mfma_f32_16x16x32_bf16 v[196:199], v[152:155], v[170:173], v[196:199]
    v_cvt_pk_bf16_f32 v190, v200, v201
    v_mul_f32 v236, s38, v236
    v_mfma_f32_16x16x32_bf16 v[228:231], a[152:155], a[232:235], v[228:231]
    s_waitcnt lgkmcnt(5)
    v_mul_f32 v237, s38, v237
    v_mul_f32 v238, s38, v238
    v_mfma_f32_16x16x32_bf16 v[228:231], a[156:159], a[236:239], v[228:231]
    s_waitcnt lgkmcnt(4)
    ds_read_b128 v[200:203], v246 offset:0
    v_mfma_f32_16x16x32_bf16 v[228:231], a[160:163], a[240:243], v[228:231]
    s_waitcnt lgkmcnt(4)
    v_mul_f32 v239, s38, v239
    v_cvt_pk_bf16_f32 v236, v236, v237
    v_mfma_f32_16x16x32_bf16 v[228:231], a[164:167], a[244:247], v[228:231]
    v_exp_f32 v209, v209
    v_mfma_f32_16x16x32_bf16 v[232:235], a[168:171], a[224:227], 0
    v_cvt_pk_bf16_f32 v237, v238, v239
    v_cvt_pk_bf16_f32 v193, v208, v209
    v_mfma_f32_16x16x32_bf16 v[232:235], a[172:175], a[228:231], v[232:235]
    ds_write_b64 v247, v[236:237] offset:24832
    v_mfma_f32_16x16x32_bf16 v[232:235], a[176:179], a[232:235], v[232:235]
    v_exp_f32 v210, v210
    v_mfma_f32_16x16x32_bf16 v[232:235], a[180:183], a[236:239], v[232:235]
    v_mul_f32 v228, s38, v228
    v_mul_f32 v229, s38, v229
    v_mfma_f32_16x16x32_bf16 v[232:235], a[184:187], a[240:243], v[232:235]
    v_mul_f32 v230, s38, v230
    v_mul_f32 v231, s38, v231
    v_mfma_f32_16x16x32_bf16 v[232:235], a[188:191], a[244:247], v[232:235]
    v_cvt_pk_bf16_f32 v228, v228, v229
    v_cvt_pk_bf16_f32 v229, v230, v231
    v_mfma_f32_16x16x32_bf16 v[236:239], a[192:195], a[224:227], 0
    ds_read_b128 a[224:227], v240 offset:35456
    v_mfma_f32_16x16x32_bf16 v[236:239], a[196:199], a[228:231], v[236:239]
    ds_read_b128 a[228:231], v241 offset:35456
    v_mfma_f32_16x16x32_bf16 v[236:239], a[200:203], a[232:235], v[236:239]
    ds_read_b128 a[232:235], v240 offset:35584
    s_waitcnt lgkmcnt(4)
    v_mfma_f32_16x16x32_bf16 v[200:203], v[162:165], v[168:171], v[200:203]
    ds_write_b64 v247, v[228:229] offset:30720
    v_mfma_f32_16x16x32_bf16 v[200:203], v[164:167], v[170:173], v[200:203]
    v_mul_f32 v232, s3, v232
    v_mul_f32 v233, s3, v233
    v_mfma_f32_16x16x32_bf16 v[236:239], a[204:207], a[236:239], v[236:239]
    ds_read_b128 a[236:239], v241 offset:35584
    v_mul_f32 v234, s3, v234
    v_mfma_f32_16x16x32_bf16 v[236:239], a[208:211], a[240:243], v[236:239]
    v_mul_f32 v235, s3, v235
    v_cvt_pk_bf16_f32 v232, v232, v233
    v_mfma_f32_16x16x32_bf16 v[236:239], a[212:215], a[244:247], v[236:239]
    ds_read_b128 a[240:243], v242 offset:64512
    v_cvt_pk_bf16_f32 v233, v234, v235
    v_mfma_f32_16x16x32_bf16 v[228:231], a[0:3], a[216:219], 0
    ds_write_b64 v247, v[232:233] offset:30848
    v_mfma_f32_16x16x32_bf16 v[228:231], a[4:7], a[220:223], v[228:231]
    s_waitcnt lgkmcnt(6)
    v_exp_f32 v211, v211
    v_mfma_f32_16x16x32_bf16 v[228:231], a[8:11], a[224:227], v[228:231]
    s_waitcnt lgkmcnt(5)
    v_mul_f32 v236, s38, v236
    v_mul_f32 v237, s38, v237
    v_mfma_f32_16x16x32_bf16 v[228:231], a[12:15], a[228:231], v[228:231]
    s_waitcnt lgkmcnt(4)
    v_mul_f32 v238, s38, v238
    v_mul_f32 v239, s38, v239
    v_mfma_f32_16x16x32_bf16 v[228:231], a[16:19], a[232:235], v[228:231]
    v_cvt_pk_bf16_f32 v236, v236, v237
    v_cvt_pk_bf16_f32 v237, v238, v239
    v_mfma_f32_16x16x32_bf16 v[232:235], a[24:27], a[216:219], 0
    s_waitcnt lgkmcnt(2)
    v_exp_f32 v196, v196
    v_mfma_f32_16x16x32_bf16 v[228:231], a[20:23], a[236:239], v[228:231]
    ds_write_b64 v247, v[236:237] offset:30976
    v_mfma_f32_16x16x32_bf16 v[232:235], a[28:31], a[220:223], v[232:235]
    ds_read_b128 a[244:247], v243 offset:64512
    v_cvt_pk_bf16_f32 v180, v210, v211
    v_mfma_f32_16x16x32_bf16 v[232:235], a[32:35], a[224:227], v[232:235]
    ds_read_b128 v[208:211], v245 offset:64
    v_mfma_f32_16x16x32_bf16 v[232:235], a[36:39], a[228:231], v[232:235]
    v_exp_f32 v197, v197
    v_mfma_f32_16x16x32_bf16 v[232:235], a[40:43], a[232:235], v[232:235]
    v_cvt_pk_bf16_f32 v114, v228, v229
    v_cvt_pk_bf16_f32 v115, v230, v231
    v_mfma_f32_16x16x32_bf16 v[232:235], a[44:47], a[236:239], v[232:235]
    v_exp_f32 v198, v198
    v_mfma_f32_16x16x32_bf16 v[236:239], a[48:51], a[216:219], 0
    v_exp_f32 v199, v199
    v_mfma_f32_16x16x32_bf16 v[236:239], a[52:55], a[220:223], v[236:239]
    v_cvt_pk_bf16_f32 v194, v196, v197
    v_cvt_pk_bf16_f32 v181, v198, v199
    v_mfma_f32_16x16x32_bf16 v[236:239], a[56:59], a[224:227], v[236:239]
    ds_read_b128 v[196:199], v246 offset:64
    v_cvt_pk_bf16_f32 v116, v232, v233
    v_mfma_f32_16x16x32_bf16 v[236:239], a[60:63], a[228:231], v[236:239]
    v_cvt_pk_bf16_f32 v117, v234, v235
    v_mfma_f32_16x16x32_bf16 v[236:239], a[64:67], a[232:235], v[236:239]
    v_exp_f32 v200, v200
    v_mfma_f32_16x16x32_bf16 v[204:207], v[114:117], v[174:177], v[204:207]
    v_exp_f32 v201, v201
    v_mfma_f32_16x16x32_bf16 v[236:239], a[68:71], a[236:239], v[236:239]
    v_exp_f32 v202, v202
    v_mfma_f32_16x16x32_bf16 v[228:231], a[216:219], a[72:75], 0
    v_exp_f32 v203, v203
    v_mfma_f32_16x16x32_bf16 v[228:231], a[220:223], a[76:79], v[228:231]
    v_cvt_pk_bf16_f32 v192, v200, v201
    v_cvt_pk_bf16_f32 v195, v202, v203
    v_mfma_f32_16x16x32_bf16 v[228:231], a[224:227], a[80:83], v[228:231]
    ds_read_b128 v[200:203], v244 offset:128
    v_cvt_pk_bf16_f32 v118, v236, v237
    v_mfma_f32_16x16x32_bf16 v[228:231], a[228:231], a[84:87], v[228:231]
    s_waitcnt lgkmcnt(2)
    v_cvt_pk_bf16_f32 v119, v238, v239
    v_mfma_f32_16x16x32_bf16 v[208:211], v[156:159], v[168:171], v[208:211]
    ds_read_b64 v[174:175], v247 offset:0
    v_mfma_f32_16x16x32_bf16 v[204:207], v[116:119], v[176:179], v[204:207]
    ds_read_b64 v[176:177], v247 offset:128
    ds_read_b64 v[178:179], v247 offset:256
    v_mfma_f32_16x16x32_bf16 v[208:211], v[158:161], v[170:173], v[208:211]
    v_mfma_f32_16x16x32_bf16 v[228:231], a[232:235], a[88:91], v[228:231]
    v_mfma_f32_16x16x32_bf16 v[228:231], a[236:239], a[92:95], v[228:231]
    v_mfma_f32_16x16x32_bf16 v[232:235], a[216:219], a[96:99], 0
    s_waitcnt lgkmcnt(4)
    v_mfma_f32_16x16x32_bf16 v[196:199], v[114:117], v[168:171], v[196:199]
    v_exp_f32 v204, v204
    v_mfma_f32_16x16x32_bf16 v[196:199], v[116:119], v[170:173], v[196:199]
    v_exp_f32 v205, v205
    v_mfma_f32_16x16x32_bf16 v[232:235], a[220:223], a[100:103], v[232:235]
    v_cvt_pk_bf16_f32 v188, v204, v205
    v_cvt_pk_bf16_f32 v18, v228, v229
    v_mfma_f32_16x16x32_bf16 v[232:235], a[224:227], a[104:107], v[232:235]
    ds_read_b128 v[204:207], v244 offset:64
    v_cvt_pk_bf16_f32 v21, v230, v231
    v_mfma_f32_16x16x32_bf16 v[224:227], a[248:251], v[188:191], v[224:227]
    s_waitcnt lgkmcnt(4)
    v_exp_f32 v196, v196
    v_mfma_f32_16x16x32_bf16 v[212:215], v[18:21], v[188:191], v[212:215]
    v_exp_f32 v197, v197
    v_mfma_f32_16x16x32_bf16 v[200:203], v[102:105], v[168:171], v[200:203]
    v_exp_f32 v208, v208
    v_mfma_f32_16x16x32_bf16 v[200:203], v[104:107], v[170:173], v[200:203]
    v_exp_f32 v209, v209
    v_mfma_f32_16x16x32_bf16 v[232:235], a[228:231], a[108:111], v[232:235]
    v_rcp_f32 v225, v224
    v_mfma_f32_16x16x32_bf16 v[232:235], a[232:235], a[112:115], v[232:235]
    v_mul_f32 v212, v212, v225
    v_mul_f32 v213, v213, v225
    v_mfma_f32_16x16x32_bf16 v[232:235], a[236:239], a[116:119], v[232:235]
    v_mul_f32 v214, v214, v225
    v_mul_f32 v215, v215, v225
    v_mfma_f32_16x16x32_bf16 v[236:239], a[216:219], a[120:123], 0
    ds_read_b128 a[216:219], v242 offset:64640
    s_waitcnt lgkmcnt(1)
    v_mfma_f32_16x16x32_bf16 v[204:207], v[132:135], v[168:171], v[204:207]
    v_cvt_pk_bf16_f32 v212, v212, v213
    v_cvt_pk_bf16_f32 v213, v214, v215
    v_mfma_f32_16x16x32_bf16 v[204:207], v[134:137], v[170:173], v[204:207]
    v_cvt_pk_bf16_f32 v48, v232, v233
    v_cvt_pk_bf16_f32 v51, v234, v235
    v_mfma_f32_16x16x32_bf16 v[236:239], a[220:223], a[124:127], v[236:239]
    ds_read_b128 a[220:223], v243 offset:64640
    v_max3_f32 v248, v248, v224, v225
    v_mfma_f32_16x16x32_bf16 v[216:219], v[48:51], v[188:191], v[216:219]
    ds_write_b64 v247, v[212:213] offset:12288
    v_mfma_f32_16x16x32_bf16 v[212:215], v[12:15], v[192:195], 0
    v_exp_f32 v204, v204
    v_mfma_f32_16x16x32_bf16 v[236:239], a[224:227], a[128:131], v[236:239]
    ds_read_b128 a[224:227], v242 offset:64768
    v_add_u32 v242, 0xf000, v242
    v_mfma_f32_16x16x32_bf16 v[236:239], a[228:231], a[132:135], v[236:239]
    ds_read_b128 a[228:231], v243 offset:64768
    v_mul_f32 v216, v216, v225
    v_mfma_f32_16x16x32_bf16 v[236:239], a[232:235], a[136:139], v[236:239]
    v_mul_f32 v217, v217, v225
    v_mul_f32 v218, v218, v225
    v_mfma_f32_16x16x32_bf16 v[236:239], a[236:239], a[140:143], v[236:239]
    v_mul_f32 v219, v219, v225
    v_cvt_pk_bf16_f32 v216, v216, v217
    v_mfma_f32_16x16x32_bf16 v[228:231], a[144:147], a[240:243], 0
    ds_read_b128 a[232:235], v242 offset:4608
    v_cvt_pk_bf16_f32 v217, v218, v219
    v_mfma_f32_16x16x32_bf16 v[228:231], a[148:151], a[244:247], v[228:231]
    s_waitcnt lgkmcnt(5)
    v_add_u32 v243, 0xf000, v243
    v_cvt_pk_bf16_f32 v78, v236, v237
    v_mfma_f32_16x16x32_bf16 v[228:231], a[152:155], a[216:219], v[228:231]
    s_waitcnt lgkmcnt(4)
    v_cvt_pk_bf16_f32 v81, v238, v239
    v_cvt_pk_bf16_f32 v182, v196, v197
    v_mfma_f32_16x16x32_bf16 v[228:231], a[156:159], a[220:223], v[228:231]
    ds_write_b64 v247, v[216:217] offset:12416
    v_mfma_f32_16x16x32_bf16 v[220:223], v[78:81], v[188:191], v[220:223]
    s_waitcnt lgkmcnt(3)
    v_exp_f32 v205, v205
    v_mfma_f32_16x16x32_bf16 v[216:219], v[42:45], v[192:195], 0
    ds_read_b128 a[236:239], v243 offset:4608
    v_cvt_pk_bf16_f32 v183, v204, v205
    v_mfma_f32_16x16x32_bf16 v[228:231], a[160:163], a[224:227], v[228:231]
    s_waitcnt lgkmcnt(3)
    v_exp_f32 v206, v206
    v_mfma_f32_16x16x32_bf16 v[212:215], v[16:19], v[180:183], v[212:215]
    v_mul_f32 v220, v220, v225
    v_mul_f32 v221, v221, v225
    v_mfma_f32_16x16x32_bf16 v[216:219], v[46:49], v[180:183], v[216:219]
    v_mul_f32 v222, v222, v225
    v_mul_f32 v223, v223, v225
    v_mfma_f32_16x16x32_bf16 v[224:227], a[248:251], v[192:195], 0
    v_cvt_pk_bf16_f32 v220, v220, v221
    v_cvt_pk_bf16_f32 v221, v222, v223
    v_mfma_f32_16x16x32_bf16 v[224:227], a[248:251], v[180:183], v[224:227]
    ds_write_b64 v247, v[220:221] offset:12544
    v_mfma_f32_16x16x32_bf16 v[220:223], v[72:75], v[192:195], 0
    v_exp_f32 v207, v207
    v_mfma_f32_16x16x32_bf16 v[220:223], v[76:79], v[180:183], v[220:223]
    v_cvt_pk_bf16_f32 v186, v206, v207
    v_cvt_pk_bf16_f32 v184, v208, v209
    v_mfma_f32_16x16x32_bf16 v[228:231], a[164:167], a[228:231], v[228:231]
    ds_read_b128 v[204:207], v245 offset:128
    v_mfma_f32_16x16x32_bf16 v[232:235], a[168:171], a[240:243], 0
    v_exp_f32 v210, v210
    v_mfma_f32_16x16x32_bf16 v[232:235], a[172:175], a[244:247], v[232:235]
    v_exp_f32 v211, v211
    v_mfma_f32_16x16x32_bf16 v[232:235], a[176:179], a[216:219], v[232:235]
    v_exp_f32 v198, v198
    v_mfma_f32_16x16x32_bf16 v[232:235], a[180:183], a[220:223], v[232:235]
    v_mul_f32 v228, s38, v228
    v_mul_f32 v229, s38, v229
    v_mfma_f32_16x16x32_bf16 v[232:235], a[184:187], a[224:227], v[232:235]
    v_mul_f32 v230, s38, v230
    v_mul_f32 v231, s38, v231
    v_mfma_f32_16x16x32_bf16 v[232:235], a[188:191], a[228:231], v[232:235]
    v_cvt_pk_bf16_f32 v228, v228, v229
    v_cvt_pk_bf16_f32 v229, v230, v231
    v_mfma_f32_16x16x32_bf16 v[236:239], a[192:195], a[240:243], 0
    ds_read_b128 a[240:243], v242 offset:4736
    v_cvt_pk_bf16_f32 v187, v210, v211
    v_mfma_f32_16x16x32_bf16 v[236:239], a[196:199], a[244:247], v[236:239]
    ds_read_b128 a[244:247], v243 offset:4736
    ds_read_b128 v[208:211], v246 offset:128
    v_mfma_f32_16x16x32_bf16 v[236:239], a[200:203], a[216:219], v[236:239]
    ds_read_b128 a[216:219], v242 offset:4864
    v_mul_f32 v232, s3, v232
    v_mfma_f32_16x16x32_bf16 v[236:239], a[204:207], a[220:223], v[236:239]
    ds_read_b128 a[220:223], v243 offset:4864
    v_mul_f32 v233, s3, v233
    v_mfma_f32_16x16x32_bf16 v[236:239], a[208:211], a[224:227], v[236:239]
    ds_write_b64 v247, v[228:229] offset:36864
    v_mfma_f32_16x16x32_bf16 v[236:239], a[212:215], a[228:231], v[236:239]
    s_waitcnt lgkmcnt(6)
    v_mul_f32 v234, s3, v234
    v_mul_f32 v235, s3, v235
    v_mfma_f32_16x16x32_bf16 v[204:207], v[108:111], v[168:171], v[204:207]
    v_cvt_pk_bf16_f32 v232, v232, v233
    v_cvt_pk_bf16_f32 v233, v234, v235
    v_mfma_f32_16x16x32_bf16 v[204:207], v[110:113], v[170:173], v[204:207]
    ds_write_b64 v247, v[232:233] offset:36992
    v_mfma_f32_16x16x32_bf16 v[228:231], a[144:147], a[232:235], 0
    v_add_u32 v242, 0x7800, v242
    v_add_u32 v243, 0x4200, v243
    v_mfma_f32_16x16x32_bf16 v[228:231], a[148:151], a[236:239], v[228:231]
    s_waitcnt lgkmcnt(6)
    v_cndmask_b32 v242, v242, v243, vcc
    s_mov_b32 vcc_lo, 0xf0f0f0f0
    v_mfma_f32_16x16x32_bf16 v[228:231], a[152:155], a[240:243], v[228:231]
    s_waitcnt lgkmcnt(5)
    v_add_u32 v243, 0xfffe2000, v242
    s_mov_b32 vcc_hi, 0xf0f0f0f0
    v_mfma_f32_16x16x32_bf16 v[228:231], a[156:159], a[244:247], v[228:231]
    s_waitcnt lgkmcnt(3)
    v_cndmask_b32 v242, v242, v243, vcc
    v_mul_f32 v236, s38, v236
    v_mfma_f32_16x16x32_bf16 v[228:231], a[160:163], a[216:219], v[228:231]
    s_waitcnt lgkmcnt(2)
    ds_read_b128 a[224:227], v242 offset:0
    v_mfma_f32_16x16x32_bf16 v[228:231], a[164:167], a[220:223], v[228:231]
    s_mov_b32 vcc_lo, 0xcccccccc
    v_mul_f32 v237, s38, v237
    v_mul_f32 v238, s38, v238
    v_mfma_f32_16x16x32_bf16 v[232:235], a[168:171], a[232:235], 0
    s_mov_b32 vcc_hi, 0xcccccccc
    v_mul_f32 v239, s38, v239
    v_cvt_pk_bf16_f32 v236, v236, v237
    v_mfma_f32_16x16x32_bf16 v[232:235], a[172:175], a[236:239], v[232:235]
    v_xor_b32 v243, 64, v242
    v_cvt_pk_bf16_f32 v237, v238, v239
    v_mfma_f32_16x16x32_bf16 v[232:235], a[176:179], a[240:243], v[232:235]
    ds_read_b128 a[228:231], v243 offset:0
    v_mul_f32 v228, s38, v228
    v_mfma_f32_16x16x32_bf16 v[232:235], a[180:183], a[244:247], v[232:235]
    ds_write_b64 v247, v[236:237] offset:37120
    v_mfma_f32_16x16x32_bf16 v[232:235], a[184:187], a[216:219], v[232:235]
    v_mul_f32 v229, s38, v229
    v_mul_f32 v230, s38, v230
    v_mfma_f32_16x16x32_bf16 v[232:235], a[188:191], a[220:223], v[232:235]
    v_mul_f32 v231, s38, v231
    v_cvt_pk_bf16_f32 v228, v228, v229
    v_mfma_f32_16x16x32_bf16 v[236:239], a[192:195], a[232:235], 0
    ds_read_b128 a[232:235], v242 offset:128
    v_cvt_pk_bf16_f32 v229, v230, v231
    v_mfma_f32_16x16x32_bf16 v[236:239], a[196:199], a[236:239], v[236:239]
    ds_read_b128 a[236:239], v243 offset:128
    v_mfma_f32_16x16x32_bf16 v[236:239], a[200:203], a[240:243], v[236:239]
    ds_read_b128 a[240:243], v242 offset:256
    v_mul_f32 v232, s3, v232
    v_mfma_f32_16x16x32_bf16 v[236:239], a[204:207], a[244:247], v[236:239]
    ds_read_b128 a[244:247], v243 offset:256
    v_mul_f32 v233, s3, v233
    v_mfma_f32_16x16x32_bf16 v[236:239], a[208:211], a[216:219], v[236:239]
    ds_write_b64 v247, v[228:229] offset:43008
    v_mfma_f32_16x16x32_bf16 v[236:239], a[212:215], a[220:223], v[236:239]
    s_waitcnt lgkmcnt(7)
    v_mul_f32 v234, s3, v234
    v_mul_f32 v235, s3, v235
    v_mfma_f32_16x16x32_bf16 v[228:231], a[144:147], a[224:227], 0
    s_waitcnt lgkmcnt(6)
    v_cvt_pk_bf16_f32 v232, v232, v233
    v_cvt_pk_bf16_f32 v233, v234, v235
    v_mfma_f32_16x16x32_bf16 v[228:231], a[148:151], a[228:231], v[228:231]
    ds_write_b64 v247, v[232:233] offset:43136
    v_mfma_f32_16x16x32_bf16 v[232:235], a[168:171], a[224:227], 0
    s_waitcnt lgkmcnt(5)
    v_mul_f32 v236, s38, v236
    v_mul_f32 v237, s38, v237
    v_mfma_f32_16x16x32_bf16 v[228:231], a[152:155], a[232:235], v[228:231]
    s_waitcnt lgkmcnt(4)
    v_mul_f32 v238, s38, v238
    v_mul_f32 v239, s38, v239
    v_mfma_f32_16x16x32_bf16 v[228:231], a[156:159], a[236:239], v[228:231]
    s_waitcnt lgkmcnt(3)
    v_cvt_pk_bf16_f32 v236, v236, v237
    v_cvt_pk_bf16_f32 v237, v238, v239
    v_mfma_f32_16x16x32_bf16 v[228:231], a[160:163], a[240:243], v[228:231]
    s_waitcnt lgkmcnt(2)
    v_exp_f32 v199, v199
    v_mfma_f32_16x16x32_bf16 v[228:231], a[164:167], a[244:247], v[228:231]
    ds_write_b64 v247, v[236:237] offset:43264
    v_mfma_f32_16x16x32_bf16 v[232:235], a[172:175], a[228:231], v[232:235]
    ds_read_b128 a[216:219], v240 offset:36864
    v_cvt_pk_bf16_f32 v185, v198, v199
    v_mfma_f32_16x16x32_bf16 v[232:235], a[176:179], a[232:235], v[232:235]
    ds_read_b128 a[220:223], v241 offset:36864
    ds_read_b128 v[196:199], v244 offset:32
    v_mfma_f32_16x16x32_bf16 v[212:215], v[20:23], v[184:187], v[212:215]
    v_mul_f32 v228, s38, v228
    v_mul_f32 v229, s38, v229
    v_mfma_f32_16x16x32_bf16 v[216:219], v[50:53], v[184:187], v[216:219]
    v_mul_f32 v230, s38, v230
    v_mul_f32 v231, s38, v231
    v_mfma_f32_16x16x32_bf16 v[220:223], v[80:83], v[184:187], v[220:223]
    v_cvt_pk_bf16_f32 v228, v228, v229
    v_cvt_pk_bf16_f32 v229, v230, v231
    v_mfma_f32_16x16x32_bf16 v[224:227], a[248:251], v[184:187], v[224:227]
    ds_write_b64 v247, v[228:229] offset:49152
    v_mfma_f32_16x16x32_bf16 v[232:235], a[180:183], a[236:239], v[232:235]
    v_exp_f32 v200, v200
    v_mfma_f32_16x16x32_bf16 v[232:235], a[184:187], a[240:243], v[232:235]
    v_exp_f32 v201, v201
    v_mfma_f32_16x16x32_bf16 v[232:235], a[188:191], a[244:247], v[232:235]
    v_exp_f32 v204, v204
    v_mfma_f32_16x16x32_bf16 v[236:239], a[192:195], a[224:227], 0
    ds_read_b128 a[224:227], v240 offset:36992
    v_cvt_pk_bf16_f32 v189, v200, v201
    v_mfma_f32_16x16x32_bf16 v[236:239], a[196:199], a[228:231], v[236:239]
    ds_read_b128 a[228:231], v241 offset:36992
    ds_read_b128 v[200:203], v245 offset:32
    v_mfma_f32_16x16x32_bf16 v[236:239], a[200:203], a[232:235], v[236:239]
    ds_read_b128 a[232:235], v240 offset:37120
    v_mul_f32 v232, s3, v232
    v_mfma_f32_16x16x32_bf16 v[236:239], a[204:207], a[236:239], v[236:239]
    s_waitcnt lgkmcnt(7)
    ds_read_b128 a[236:239], v241 offset:37120
    v_mfma_f32_16x16x32_bf16 v[236:239], a[208:211], a[240:243], v[236:239]
    v_mul_f32 v233, s3, v233
    v_mul_f32 v234, s3, v234
    v_mfma_f32_16x16x32_bf16 v[236:239], a[212:215], a[244:247], v[236:239]
    v_mul_f32 v235, s3, v235
    v_cvt_pk_bf16_f32 v232, v232, v233
    v_mfma_f32_16x16x32_bf16 v[228:231], a[0:3], a[216:219], 0
    s_waitcnt lgkmcnt(6)
    v_cvt_pk_bf16_f32 v233, v234, v235
    v_add_u32 v240, 0xffff1000, v240
    v_mfma_f32_16x16x32_bf16 v[196:199], v[132:135], v[174:177], v[196:199]
    ds_write_b64 v247, v[232:233] offset:49280
    v_mfma_f32_16x16x32_bf16 v[196:199], v[134:137], v[176:179], v[196:199]
    v_exp_f32 v205, v205
    v_mfma_f32_16x16x32_bf16 v[228:231], a[4:7], a[220:223], v[228:231]
    s_waitcnt lgkmcnt(5)
    v_cvt_pk_bf16_f32 v190, v204, v205
    v_mul_f32 v236, s38, v236
    v_mfma_f32_16x16x32_bf16 v[228:231], a[8:11], a[224:227], v[228:231]
    s_waitcnt lgkmcnt(4)
    v_mul_f32 v237, s38, v237
    v_mul_f32 v238, s38, v238
    v_mfma_f32_16x16x32_bf16 v[228:231], a[12:15], a[228:231], v[228:231]
    s_waitcnt lgkmcnt(2)
    v_mul_f32 v239, s38, v239
    v_cvt_pk_bf16_f32 v236, v236, v237
    v_mfma_f32_16x16x32_bf16 v[200:203], v[156:159], v[174:177], v[200:203]
    ds_read_b128 v[204:207], v246 offset:32
    v_cvt_pk_bf16_f32 v237, v238, v239
    v_mfma_f32_16x16x32_bf16 v[200:203], v[158:161], v[176:179], v[200:203]
    ds_write_b64 v247, v[236:237] offset:49408
    v_mfma_f32_16x16x32_bf16 v[228:231], a[16:19], a[232:235], v[228:231]
    s_waitcnt lgkmcnt(3)
    v_exp_f32 v196, v196
    v_mfma_f32_16x16x32_bf16 v[228:231], a[20:23], a[236:239], v[228:231]
    v_exp_f32 v197, v197
    v_mfma_f32_16x16x32_bf16 v[232:235], a[24:27], a[216:219], 0
    v_exp_f32 v198, v198
    v_mfma_f32_16x16x32_bf16 v[232:235], a[28:31], a[220:223], v[232:235]
    v_exp_f32 v199, v199
    v_mfma_f32_16x16x32_bf16 v[232:235], a[32:35], a[224:227], v[232:235]
    v_cvt_pk_bf16_f32 v193, v196, v197
    v_cvt_pk_bf16_f32 v180, v198, v199
    v_mfma_f32_16x16x32_bf16 v[232:235], a[36:39], a[228:231], v[232:235]
    v_cvt_pk_bf16_f32 v120, v228, v229
    v_cvt_pk_bf16_f32 v121, v230, v231
    v_mfma_f32_16x16x32_bf16 v[232:235], a[40:43], a[232:235], v[232:235]
    ds_read_b128 v[196:199], v245 offset:96
    v_add_u32 v241, 0xffff1000, v241
    v_mfma_f32_16x16x32_bf16 v[232:235], a[44:47], a[236:239], v[232:235]
    ds_read_b128 a[240:243], v242 offset:3072
    ds_read_b128 a[244:247], v243 offset:3072
    v_mfma_f32_16x16x32_bf16 v[236:239], a[48:51], a[216:219], 0
    v_exp_f32 v200, v200
    v_mfma_f32_16x16x32_bf16 v[236:239], a[52:55], a[220:223], v[236:239]
    v_exp_f32 v201, v201
    v_mfma_f32_16x16x32_bf16 v[236:239], a[56:59], a[224:227], v[236:239]
    s_waitcnt lgkmcnt(4)
    v_cvt_pk_bf16_f32 v122, v232, v233
    v_cvt_pk_bf16_f32 v123, v234, v235
    v_mfma_f32_16x16x32_bf16 v[204:207], v[114:117], v[174:177], v[204:207]
    v_exp_f32 v202, v202
    v_mfma_f32_16x16x32_bf16 v[208:211], v[120:123], v[168:171], v[208:211]
    v_exp_f32 v203, v203
    v_mfma_f32_16x16x32_bf16 v[204:207], v[116:119], v[176:179], v[204:207]
    v_cvt_pk_bf16_f32 v194, v200, v201
    v_cvt_pk_bf16_f32 v181, v202, v203
    v_mfma_f32_16x16x32_bf16 v[236:239], a[60:63], a[228:231], v[236:239]
    ds_read_b128 v[200:203], v246 offset:96
    ds_read_b64 v[168:169], v247 offset:24576
    v_mfma_f32_16x16x32_bf16 v[236:239], a[64:67], a[232:235], v[236:239]
    v_mfma_f32_16x16x32_bf16 v[236:239], a[68:71], a[236:239], v[236:239]
    v_mfma_f32_16x16x32_bf16 v[228:231], a[216:219], a[72:75], 0
    v_exp_f32 v204, v204
    v_mfma_f32_16x16x32_bf16 v[228:231], a[220:223], a[76:79], v[228:231]
    v_exp_f32 v205, v205
    v_mfma_f32_16x16x32_bf16 v[228:231], a[224:227], a[80:83], v[228:231]
    s_waitcnt lgkmcnt(4)
    v_exp_f32 v206, v206
    v_mfma_f32_16x16x32_bf16 v[196:199], v[108:111], v[174:177], v[196:199]
    v_cvt_pk_bf16_f32 v124, v236, v237
    v_cvt_pk_bf16_f32 v125, v238, v239
    v_mfma_f32_16x16x32_bf16 v[196:199], v[110:113], v[176:179], v[196:199]
    v_exp_f32 v207, v207
    v_mfma_f32_16x16x32_bf16 v[208:211], v[122:125], v[170:173], v[208:211]
    v_cvt_pk_bf16_f32 v192, v204, v205
    v_cvt_pk_bf16_f32 v195, v206, v207
    v_mfma_f32_16x16x32_bf16 v[228:231], a[228:231], a[84:87], v[228:231]
    ds_read_b64 v[170:171], v247 offset:24704
    ds_read_b128 v[204:207], v244 offset:192
    v_mfma_f32_16x16x32_bf16 v[228:231], a[232:235], a[88:91], v[228:231]
    ds_read_b64 v[172:173], v247 offset:24832
    v_mfma_f32_16x16x32_bf16 v[228:231], a[236:239], a[92:95], v[228:231]
L_h6:
    s_cbranch_execz L_hback
    v_exp_f32 v208, v208
    v_mfma_f32_16x16x32_bf16 v[232:235], a[216:219], a[96:99], 0
    v_exp_f32 v209, v209
    v_mfma_f32_16x16x32_bf16 v[232:235], a[220:223], a[100:103], v[232:235]
    s_waitcnt lgkmcnt(4)
    v_exp_f32 v196, v196
    v_mfma_f32_16x16x32_bf16 v[200:203], v[120:123], v[174:177], v[200:203]
    v_exp_f32 v197, v197
    v_mfma_f32_16x16x32_bf16 v[200:203], v[122:125], v[176:179], v[200:203]
    v_cvt_pk_bf16_f32 v24, v228, v229
    v_cvt_pk_bf16_f32 v27, v230, v231
    v_mfma_f32_16x16x32_bf16 v[232:235], a[224:227], a[104:107], v[232:235]
    v_cvt_pk_bf16_f32 v188, v208, v209
    v_mbcnt_lo_u32_b32 v228, -1, 0
    v_mfma_f32_16x16x32_bf16 v[232:235], a[228:231], a[108:111], v[232:235]
    ds_read_b128 v[208:211], v244 offset:96
    v_mbcnt_hi_u32_b32 v228, -1, v228
    v_mfma_f32_16x16x32_bf16 v[212:215], v[24:27], v[188:191], v[212:215]
    v_lshrrev_b32 v229, 1, v228
    v_add_u32 v229, 64, v229
    v_mfma_f32_16x16x32_bf16 v[224:227], a[248:251], v[188:191], v[224:227]
    v_mul_u32_u24 v230, 43, v229
    v_lshrrev_b32 v231, 8, v230
    v_mfma_f32_16x16x32_bf16 v[232:235], a[232:235], a[112:115], v[232:235]
    v_lshrrev_b32 v230, 7, v230
    v_mad_i32_i24 v229, v230, -3, v229
    v_mfma_f32_16x16x32_bf16 v[232:235], a[236:239], a[116:119], v[232:235]
    v_and_b32 v231, 4, v231
    v_xor_b32 v230, v230, v231
    v_mfma_f32_16x16x32_bf16 v[236:239], a[216:219], a[120:123], 0
    ds_read_b128 a[216:219], v242 offset:3200
    v_and_b32 v231, 4, v230
    v_mfma_f32_16x16x32_bf16 v[236:239], a[220:223], a[124:127], v[236:239]
    ds_read_b128 a[220:223], v243 offset:3200
    v_mul_u32_u24 v251, 24, v231
    v_mfma_f32_16x16x32_bf16 v[236:239], a[224:227], a[128:131], v[236:239]
    ds_read_b128 a[224:227], v242 offset:3328
    v_cvt_pk_bf16_f32 v54, v232, v233
    v_mfma_f32_16x16x32_bf16 v[236:239], a[228:231], a[132:135], v[236:239]
    ds_read_b128 a[228:231], v243 offset:3328
    v_cvt_pk_bf16_f32 v57, v234, v235
    v_mfma_f32_16x16x32_bf16 v[236:239], a[232:235], a[136:139], v[236:239]
    s_waitcnt lgkmcnt(4)
    v_lshrrev_b32 v231, 3, v230
    v_lshl_add_u32 v251, v231, 2, v251
    v_mfma_f32_16x16x32_bf16 v[216:219], v[54:57], v[188:191], v[216:219]
    v_and_or_b32 v251, v230, 3, v251
    v_mad_u32_u24 v251, v251, 3, v229
    v_mfma_f32_16x16x32_bf16 v[208:211], v[102:105], v[174:177], v[208:211]
    ds_read_b128 a[232:235], v240 offset:0
    v_and_b32 v231, 1, v228
    v_mfma_f32_16x16x32_bf16 v[208:211], v[104:107], v[176:179], v[208:211]
    v_lshl_add_u32 v251, v251, 3, v231
    v_lshlrev_b32 v251, 4, v251
    v_mfma_f32_16x16x32_bf16 v[204:207], v[138:141], v[168:171], v[204:207]
    v_add_u32 v251, 0xfffff800, v251
    v_cvt_pk_bf16_f32 v184, v196, v197
    v_mfma_f32_16x16x32_bf16 v[204:207], v[140:143], v[170:173], v[204:207]
    v_rcp_f32 v225, v224
    v_mfma_f32_16x16x32_bf16 v[236:239], a[236:239], a[140:143], v[236:239]
    ds_read_b128 a[236:239], v241 offset:0
    v_mul_f32 v212, v212, v225
    v_mfma_f32_16x16x32_bf16 v[232:235], a[144:147], a[240:243], 0
    v_mul_f32 v213, v213, v225
    s_waitcnt lgkmcnt(2)
    v_mfma_f32_16x16x32_bf16 v[232:235], a[148:151], a[244:247], v[232:235]
    s_barrier
    buffer_load_dwordx4 v252, s[12:15], s62 offen lds
    v_mfma_f32_16x16x32_bf16 v[232:235], a[152:155], a[216:219], v[232:235]
    v_cvt_pk_bf16_f32 v84, v236, v237
    v_cvt_pk_bf16_f32 v87, v238, v239
    v_mfma_f32_16x16x32_bf16 v[232:235], a[156:159], a[220:223], v[232:235]
    v_mul_f32 v214, v214, v225
    v_mul_f32 v215, v215, v225
    v_mfma_f32_16x16x32_bf16 v[220:223], v[84:87], v[188:191], v[220:223]
    v_cvt_pk_bf16_f32 v212, v212, v213
    v_cvt_pk_bf16_f32 v213, v214, v215
    v_mfma_f32_16x16x32_bf16 v[232:235], a[160:163], a[224:227], v[232:235]
    buffer_load_dwordx4 v253, s[12:15], s62 offen offset:1024 lds
    v_mul_f32 v216, v216, v225
    v_mfma_f32_16x16x32_bf16 v[232:235], a[164:167], a[228:231], v[232:235]
    ds_write_b64 v247, v[212:213] offset:18432
    v_mfma_f32_16x16x32_bf16 v[212:215], v[18:21], v[192:195], 0
    v_mul_f32 v217, v217, v225
    v_mul_f32 v218, v218, v225
    v_mfma_f32_16x16x32_bf16 v[236:239], a[168:171], a[240:243], 0
    v_mul_f32 v219, v219, v225
    v_cvt_pk_bf16_f32 v216, v216, v217
    v_mfma_f32_16x16x32_bf16 v[236:239], a[172:175], a[244:247], v[236:239]
    buffer_load_dwordx4 v251, s[12:15], s62 offen offset:2048 lds
    s_add_u32 m0, s46, 0x17400
    v_mfma_f32_16x16x32_bf16 v[236:239], a[176:179], a[216:219], v[236:239]
    s_lshl_b32 s62, s28, 5
    v_mul_f32 v232, s38, v232
    v_mul_f32 v233, s38, v233
    v_mfma_f32_16x16x32_bf16 v[236:239], a[180:183], a[220:223], v[236:239]
    s_add_u32 s62, s62, 0x3000
    v_mul_f32 v234, s38, v234
    v_mul_f32 v235, s38, v235
    v_mfma_f32_16x16x32_bf16 v[236:239], a[184:187], a[224:227], v[236:239]
    v_cvt_pk_bf16_f32 v232, v232, v233
    v_cvt_pk_bf16_f32 v233, v234, v235
    v_mfma_f32_16x16x32_bf16 v[236:239], a[188:191], a[228:231], v[236:239]
    buffer_load_dwordx4 v252, s[12:15], s63 offen lds
    v_cvt_pk_bf16_f32 v217, v218, v219
    v_mfma_f32_16x16x32_bf16 v[228:231], a[192:195], a[240:243], 0
    ds_read_b128 a[240:243], v240 offset:128
    v_max3_f32 v248, v248, v224, v225
    v_mfma_f32_16x16x32_bf16 v[228:231], a[196:199], a[244:247], v[228:231]
    ds_read_b128 a[244:247], v241 offset:128
    v_mul_f32 v220, v220, v225
    v_mfma_f32_16x16x32_bf16 v[228:231], a[200:203], a[216:219], v[228:231]
    ds_read_b128 a[216:219], v240 offset:256
    v_mul_f32 v236, s3, v236
    v_mfma_f32_16x16x32_bf16 v[228:231], a[204:207], a[220:223], v[228:231]
    buffer_load_dwordx4 v253, s[12:15], s63 offen offset:1024 lds
    ds_read_b128 a[220:223], v241 offset:256
    v_mfma_f32_16x16x32_bf16 v[228:231], a[208:211], a[224:227], v[228:231]
    ds_write_b64 v247, v[232:233] offset:55296
    v_mfma_f32_16x16x32_bf16 v[228:231], a[212:215], a[228:231], v[228:231]
    s_waitcnt lgkmcnt(5)
    v_mul_f32 v237, s3, v237
    v_mul_f32 v238, s3, v238
    v_mfma_f32_16x16x32_bf16 v[232:235], a[0:3], a[232:235], 0
    v_mul_f32 v239, s3, v239
    v_cvt_pk_bf16_f32 v236, v236, v237
    v_mfma_f32_16x16x32_bf16 v[232:235], a[4:7], a[236:239], v[232:235]
    buffer_load_dwordx4 v251, s[12:15], s63 offen offset:2048 lds
    v_cvt_pk_bf16_f32 v237, v238, v239
    ds_write_b64 v247, v[236:237] offset:55424
    v_mfma_f32_16x16x32_bf16 v[236:239], a[24:27], a[232:235], 0
    s_waitcnt lgkmcnt(5)
    v_mul_f32 v228, s38, v228
    v_mul_f32 v229, s38, v229
    v_mfma_f32_16x16x32_bf16 v[232:235], a[8:11], a[240:243], v[232:235]
    s_waitcnt lgkmcnt(4)
    v_mul_f32 v230, s38, v230
    v_mul_f32 v231, s38, v231
    v_mfma_f32_16x16x32_bf16 v[232:235], a[12:15], a[244:247], v[232:235]
    s_waitcnt lgkmcnt(3)
    v_cvt_pk_bf16_f32 v228, v228, v229
    v_cvt_pk_bf16_f32 v229, v230, v231
    v_mfma_f32_16x16x32_bf16 v[232:235], a[16:19], a[216:219], v[232:235]
    s_waitcnt lgkmcnt(2)
    v_mul_f32 v221, v221, v225
    v_mul_f32 v222, v222, v225
    v_mfma_f32_16x16x32_bf16 v[232:235], a[20:23], a[220:223], v[232:235]
    ds_write_b64 v247, v[228:229] offset:55552
    v_mfma_f32_16x16x32_bf16 v[236:239], a[28:31], a[236:239], v[236:239]
    ds_write_b64 v247, v[216:217] offset:18560
    v_mfma_f32_16x16x32_bf16 v[216:219], v[48:51], v[192:195], 0
    s_add_u32 m0, s46, 0x16800
    v_mul_f32 v223, v223, v225
    v_cvt_pk_bf16_f32 v220, v220, v221
    v_mfma_f32_16x16x32_bf16 v[224:227], a[248:251], v[192:195], 0
    s_lshl_b32 s63, s28, 5
    v_cvt_pk_bf16_f32 v126, v232, v233
    v_cvt_pk_bf16_f32 v127, v234, v235
    v_mfma_f32_16x16x32_bf16 v[236:239], a[32:35], a[240:243], v[236:239]
    ds_read_b128 a[224:227], v240 offset:1536
    v_cvt_pk_bf16_f32 v221, v222, v223
    v_mfma_f32_16x16x32_bf16 v[236:239], a[36:39], a[244:247], v[236:239]
    ds_write_b64 v247, v[220:221] offset:18688
    v_mfma_f32_16x16x32_bf16 v[220:223], v[78:81], v[192:195], 0
    s_add_u32 s63, s63, 0x7800
    v_exp_f32 v208, v208
    v_mfma_f32_16x16x32_bf16 v[236:239], a[40:43], a[216:219], v[236:239]
    v_exp_f32 v209, v209
    v_mfma_f32_16x16x32_bf16 v[236:239], a[44:47], a[220:223], v[236:239]
    v_exp_f32 v210, v210
    v_mfma_f32_16x16x32_bf16 v[228:231], a[48:51], a[232:235], 0
    v_exp_f32 v211, v211
    v_mfma_f32_16x16x32_bf16 v[228:231], a[52:55], a[236:239], v[228:231]
    v_cvt_pk_bf16_f32 v183, v208, v209
    v_cvt_pk_bf16_f32 v186, v210, v211
    v_mfma_f32_16x16x32_bf16 v[228:231], a[56:59], a[240:243], v[228:231]
    ds_read_b128 v[208:211], v245 offset:192
    v_cvt_pk_bf16_f32 v128, v236, v237
    v_mfma_f32_16x16x32_bf16 v[228:231], a[60:63], a[244:247], v[228:231]
    ds_read_b128 a[228:231], v241 offset:1536
    v_cvt_pk_bf16_f32 v129, v238, v239
    v_mfma_f32_16x16x32_bf16 v[228:231], a[64:67], a[216:219], v[228:231]
    v_exp_f32 v200, v200
    v_mfma_f32_16x16x32_bf16 v[228:231], a[68:71], a[220:223], v[228:231]
    v_exp_f32 v201, v201
    v_mfma_f32_16x16x32_bf16 v[232:235], a[232:235], a[72:75], 0
    ds_read_b64 v[174:175], v247 offset:30720
    v_cvt_pk_bf16_f32 v182, v200, v201
    v_mfma_f32_16x16x32_bf16 v[232:235], a[236:239], a[76:79], v[232:235]
    v_exp_f32 v198, v198
    v_mfma_f32_16x16x32_bf16 v[212:215], v[22:25], v[180:183], v[212:215]
    v_exp_f32 v199, v199
    v_mfma_f32_16x16x32_bf16 v[216:219], v[52:55], v[180:183], v[216:219]
    v_cvt_pk_bf16_f32 v130, v228, v229
    v_cvt_pk_bf16_f32 v131, v230, v231
    v_mfma_f32_16x16x32_bf16 v[220:223], v[82:85], v[180:183], v[220:223]
    ds_read_b64 v[176:177], v247 offset:30848
    v_cvt_pk_bf16_f32 v187, v198, v199
    v_mfma_f32_16x16x32_bf16 v[224:227], a[248:251], v[180:183], v[224:227]
    ds_read_b128 v[196:199], v246 offset:192
    ds_read_b64 v[178:179], v247 offset:30976
    v_mfma_f32_16x16x32_bf16 v[232:235], a[240:243], a[80:83], v[232:235]
    v_exp_f32 v202, v202
    v_mfma_f32_16x16x32_bf16 v[232:235], a[244:247], a[84:87], v[232:235]
    v_exp_f32 v203, v203
    v_mfma_f32_16x16x32_bf16 v[232:235], a[216:219], a[88:91], v[232:235]
    v_exp_f32 v204, v204
    v_mfma_f32_16x16x32_bf16 v[232:235], a[220:223], a[92:95], v[232:235]
    v_exp_f32 v205, v205
    v_mfma_f32_16x16x32_bf16 v[236:239], a[232:235], a[96:99], 0
    s_waitcnt lgkmcnt(5)
    v_cvt_pk_bf16_f32 v185, v202, v203
    v_cvt_pk_bf16_f32 v190, v204, v205
    v_mfma_f32_16x16x32_bf16 v[208:211], v[90:93], v[168:171], v[208:211]
    ds_read_b128 v[200:203], v244 offset:256
    v_mfma_f32_16x16x32_bf16 v[212:215], v[26:29], v[184:187], v[212:215]
    v_cvt_pk_bf16_f32 v1, v232, v233
    v_cvt_pk_bf16_f32 v4, v234, v235
    v_mfma_f32_16x16x32_bf16 v[216:219], v[56:59], v[184:187], v[216:219]
    v_exp_f32 v206, v206
    v_mfma_f32_16x16x32_bf16 v[220:223], v[86:89], v[184:187], v[220:223]
    v_exp_f32 v207, v207
    v_mfma_f32_16x16x32_bf16 v[224:227], a[248:251], v[184:187], v[224:227]
    v_cvt_pk_bf16_f32 v193, v206, v207
    v_mov_b32 v187, 0
    v_mfma_f32_16x16x32_bf16 v[208:211], v[92:95], v[170:173], v[208:211]
    ds_read_b128 v[204:207], v245 offset:256
    s_waitcnt vmcnt(3)
    v_mfma_f32_16x16x32_bf16 v[236:239], a[236:239], a[100:103], v[236:239]
    ds_read_b64_tr_b16 a[144:145], v249 offset:0
    ds_read_b64_tr_b16 a[146:147], v250 offset:0
    v_mfma_f32_16x16x32_bf16 v[236:239], a[240:243], a[104:107], v[236:239]
    ds_read_b64_tr_b16 a[168:169], v249 offset:32
    ds_read_b64_tr_b16 a[170:171], v250 offset:32
    v_mfma_f32_16x16x32_bf16 v[236:239], a[244:247], a[108:111], v[236:239]
    ds_read_b64_tr_b16 a[192:193], v249 offset:64
    ds_read_b64_tr_b16 a[194:195], v250 offset:64
    v_mfma_f32_16x16x32_bf16 v[236:239], a[216:219], a[112:115], v[236:239]
    s_waitcnt lgkmcnt(8)
    v_exp_f32 v208, v208
    v_mfma_f32_16x16x32_bf16 v[196:199], v[126:129], v[168:171], v[196:199]
    v_exp_f32 v209, v209
    v_mfma_f32_16x16x32_bf16 v[196:199], v[128:131], v[170:173], v[196:199]
    v_exp_f32 v210, v210
    v_mfma_f32_16x16x32_bf16 v[236:239], a[220:223], a[116:119], v[236:239]
    v_exp_f32 v211, v211
    v_mfma_f32_16x16x32_bf16 v[228:231], a[232:235], a[120:123], 0
    ds_read_b128 a[232:235], v240 offset:1664
    v_cvt_pk_bf16_f32 v188, v208, v209
    v_mfma_f32_16x16x32_bf16 v[228:231], a[236:239], a[124:127], v[228:231]
    ds_read_b128 a[236:239], v241 offset:1664
    v_cvt_pk_bf16_f32 v191, v210, v211
    v_mfma_f32_16x16x32_bf16 v[228:231], a[240:243], a[128:131], v[228:231]
    ds_read_b128 a[240:243], v240 offset:1792
    v_cvt_pk_bf16_f32 v31, v236, v237
    v_mfma_f32_16x16x32_bf16 v[228:231], a[244:247], a[132:135], v[228:231]
    ds_read_b128 a[244:247], v241 offset:1792
    v_cvt_pk_bf16_f32 v34, v238, v239
    v_mfma_f32_16x16x32_bf16 v[228:231], a[216:219], a[136:139], v[228:231]
    s_waitcnt lgkmcnt(4)
    buffer_load_dwordx4 v252, s[12:15], s60 offen lds
    v_mfma_f32_16x16x32_bf16 v[200:203], v[144:147], v[168:171], v[200:203]
    v_rcp_f32 v225, v224
    v_mfma_f32_16x16x32_bf16 v[200:203], v[146:149], v[170:173], v[200:203]
    s_waitcnt vmcnt(1)
    ds_read_b64_tr_b16 a[148:149], v249 offset:3072
    v_mfma_f32_16x16x32_bf16 v[204:207], v[96:99], v[168:171], v[204:207]
    ds_read_b64_tr_b16 a[150:151], v250 offset:3072
    ds_read_b64_tr_b16 a[172:173], v249 offset:3104
    v_mfma_f32_16x16x32_bf16 v[204:207], v[98:101], v[170:173], v[204:207]
    ds_read_b64_tr_b16 a[174:175], v250 offset:3104
    ds_read_b64_tr_b16 a[196:197], v249 offset:3136
    v_mfma_f32_16x16x32_bf16 v[228:231], a[220:223], a[140:143], v[228:231]
    ds_read_b64_tr_b16 a[198:199], v250 offset:3136
    buffer_load_dwordx4 v253, s[12:15], s60 offen offset:1024 lds
    v_mfma_f32_16x16x32_bf16 v[232:235], a[0:3], a[224:227], 0
    v_exp_f32 v196, v196
    v_mfma_f32_16x16x32_bf16 v[232:235], a[4:7], a[228:231], v[232:235]
    s_waitcnt lgkmcnt(9)
    v_exp_f32 v197, v197
    v_mfma_f32_16x16x32_bf16 v[232:235], a[8:11], a[232:235], v[232:235]
    s_waitcnt lgkmcnt(8)
    v_cvt_pk_bf16_f32 v61, v228, v229
    v_cvt_pk_bf16_f32 v64, v230, v231
    v_mfma_f32_16x16x32_bf16 v[232:235], a[12:15], a[236:239], v[232:235]
    s_waitcnt lgkmcnt(7)
    buffer_load_dwordx4 v251, s[12:15], s60 offen offset:2048 lds
    v_mfma_f32_16x16x32_bf16 v[232:235], a[16:19], a[240:243], v[232:235]
    s_waitcnt lgkmcnt(6)
    s_add_u32 m0, s46, 0x17400
    v_mul_f32 v212, v212, v225
    v_mfma_f32_16x16x32_bf16 v[232:235], a[20:23], a[244:247], v[232:235]
    ds_read_b128 v[208:211], v246 offset:256
    v_mul_f32 v213, v213, v225
    v_mfma_f32_16x16x32_bf16 v[236:239], a[24:27], a[224:227], 0
    v_cvt_pk_bf16_f32 v189, v196, v197
    v_mov_b32 v226, 0x22e00
    v_mfma_f32_16x16x32_bf16 v[236:239], a[28:31], a[228:231], v[236:239]
    v_mul_f32 v214, v214, v225
    s_waitcnt lgkmcnt(1)
    v_mfma_f32_16x16x32_bf16 v[236:239], a[32:35], a[232:235], v[236:239]
    buffer_load_dwordx4 v252, s[12:15], s61 offen lds
    v_cvt_pk_bf16_f32 v132, v232, v233
    v_mfma_f32_16x16x32_bf16 v[236:239], a[36:39], a[236:239], v[236:239]
    v_cvt_pk_bf16_f32 v133, v234, v235
    v_mul_f32 v215, v215, v225
    v_mfma_f32_16x16x32_bf16 v[236:239], a[40:43], a[240:243], v[236:239]
    v_cvt_pk_bf16_f32 v212, v212, v213
    v_cndmask_b32 v226, v226, v247, vcc
    v_mfma_f32_16x16x32_bf16 v[236:239], a[44:47], a[244:247], v[236:239]
    ds_read_b128 a[216:219], v240 offset:3072
    v_cvt_pk_bf16_f32 v213, v214, v215
    v_mfma_f32_16x16x32_bf16 v[228:231], a[48:51], a[224:227], 0
    buffer_load_dwordx4 v253, s[12:15], s61 offen offset:1024 lds
    v_mul_f32 v216, v216, v225
    v_mfma_f32_16x16x32_bf16 v[228:231], a[52:55], a[228:231], v[228:231]
    ds_write_b64 v226, v[212:213] offset:0
    v_mfma_f32_16x16x32_bf16 v[212:215], v[0:3], v[188:191], 0
    s_mov_b32 vcc_lo, 0xff00fff0
    v_cvt_pk_bf16_f32 v134, v236, v237
    v_cvt_pk_bf16_f32 v135, v238, v239
    v_mfma_f32_16x16x32_bf16 v[228:231], a[56:59], a[232:235], v[228:231]
    ds_read_b128 a[220:223], v241 offset:3072
    buffer_load_dwordx4 v251, s[12:15], s61 offen offset:2048 lds
    v_mfma_f32_16x16x32_bf16 v[228:231], a[60:63], a[236:239], v[228:231]
    s_add_u32 m0, s46, 0x16800
    v_mul_f32 v217, v217, v225
    v_mul_f32 v218, v218, v225
    v_mfma_f32_16x16x32_bf16 v[228:231], a[64:67], a[240:243], v[228:231]
    s_mov_b32 vcc_hi, 0xf000
    v_mul_f32 v219, v219, v225
    v_cvt_pk_bf16_f32 v216, v216, v217
    v_mfma_f32_16x16x32_bf16 v[228:231], a[68:71], a[244:247], v[228:231]
    s_waitcnt lgkmcnt(3)
    v_cvt_pk_bf16_f32 v217, v218, v219
    v_mul_f32 v220, v220, v225
    v_mfma_f32_16x16x32_bf16 v[208:211], v[132:135], v[168:171], v[208:211]
    ds_write_b64 v226, v[216:217] offset:128
    v_mfma_f32_16x16x32_bf16 v[216:219], v[30:33], v[188:191], 0
    v_mul_f32 v221, v221, v225
    v_mul_f32 v222, v222, v225
    v_mfma_f32_16x16x32_bf16 v[232:235], a[224:227], a[72:75], 0
    v_cvt_pk_bf16_f32 v136, v228, v229
    v_cvt_pk_bf16_f32 v137, v230, v231
    v_mfma_f32_16x16x32_bf16 v[232:235], a[228:231], a[76:79], v[232:235]
    v_mul_f32 v223, v223, v225
    v_cvt_pk_bf16_f32 v220, v220, v221
    v_mfma_f32_16x16x32_bf16 v[208:211], v[134:137], v[170:173], v[208:211]
    v_cvt_pk_bf16_f32 v221, v222, v223
    v_max3_f32 v248, v248, v224, v225
    v_mfma_f32_16x16x32_bf16 v[232:235], a[232:235], a[80:83], v[232:235]
    ds_write_b64 v226, v[220:221] offset:256
    v_mfma_f32_16x16x32_bf16 v[220:223], v[60:63], v[188:191], 0
    v_exp_f32 v198, v198
    v_mfma_f32_16x16x32_bf16 v[224:227], a[248:251], v[188:191], 0
    v_exp_f32 v199, v199
    v_mfma_f32_16x16x32_bf16 v[232:235], a[236:239], a[84:87], v[232:235]
    v_exp_f32 v200, v200
    v_mfma_f32_16x16x32_bf16 v[232:235], a[240:243], a[88:91], v[232:235]
    v_exp_f32 v201, v201
    v_mfma_f32_16x16x32_bf16 v[232:235], a[244:247], a[92:95], v[232:235]
    v_cvt_pk_bf16_f32 v192, v198, v199
    v_cvt_pk_bf16_f32 v180, v200, v201
    v_mfma_f32_16x16x32_bf16 v[236:239], a[224:227], a[96:99], 0
    ds_read_b128 v[196:199], v244 offset:320
    v_mfma_f32_16x16x32_bf16 v[236:239], a[228:231], a[100:103], v[236:239]
    v_exp_f32 v202, v202
    v_mfma_f32_16x16x32_bf16 v[236:239], a[232:235], a[104:107], v[236:239]
    v_exp_f32 v203, v203
    v_mfma_f32_16x16x32_bf16 v[236:239], a[236:239], a[108:111], v[236:239]
    v_cvt_pk_bf16_f32 v7, v232, v233
    v_cvt_pk_bf16_f32 v10, v234, v235
    v_mfma_f32_16x16x32_bf16 v[236:239], a[240:243], a[112:115], v[236:239]
    s_waitcnt lgkmcnt(2)
    v_exp_f32 v204, v204
    v_mfma_f32_16x16x32_bf16 v[236:239], a[244:247], a[116:119], v[236:239]
    v_exp_f32 v205, v205
    v_mfma_f32_16x16x32_bf16 v[228:231], a[224:227], a[120:123], 0
    ds_read_b128 a[224:227], v240 offset:3200
    v_cvt_pk_bf16_f32 v183, v202, v203
    v_mfma_f32_16x16x32_bf16 v[228:231], a[228:231], a[124:127], v[228:231]
    ds_read_b128 a[228:231], v241 offset:3200
    v_cvt_pk_bf16_f32 v194, v204, v205
    v_mfma_f32_16x16x32_bf16 v[228:231], a[232:235], a[128:131], v[228:231]
    ds_read_b128 a[232:235], v240 offset:3328
    v_cvt_pk_bf16_f32 v37, v236, v237
    v_mfma_f32_16x16x32_bf16 v[228:231], a[236:239], a[132:135], v[228:231]
    ds_read_b128 a[236:239], v241 offset:3328
    v_cvt_pk_bf16_f32 v40, v238, v239
    v_mfma_f32_16x16x32_bf16 v[228:231], a[240:243], a[136:139], v[228:231]
    ds_read_b128 v[200:203], v245 offset:320
    ds_read_b128 a[240:243], v240 offset:4608
    v_mfma_f32_16x16x32_bf16 v[228:231], a[244:247], a[140:143], v[228:231]
    v_exp_f32 v208, v208
    v_mfma_f32_16x16x32_bf16 v[232:235], a[0:3], a[216:219], 0
    v_exp_f32 v209, v209
    v_mfma_f32_16x16x32_bf16 v[232:235], a[4:7], a[220:223], v[232:235]
    ds_read_b128 a[244:247], v241 offset:4608
    v_cvt_pk_bf16_f32 v195, v208, v209
    v_mfma_f32_16x16x32_bf16 v[236:239], a[24:27], a[216:219], 0
    s_waitcnt lgkmcnt(7)
    s_waitcnt lgkmcnt(6)
    v_cvt_pk_bf16_f32 v67, v228, v229
    v_mfma_f32_16x16x32_bf16 v[212:215], v[4:7], v[192:195], v[212:215]
    v_exp_f32 v206, v206
    v_mfma_f32_16x16x32_bf16 v[216:219], v[34:37], v[192:195], v[216:219]
    v_exp_f32 v207, v207
    v_mfma_f32_16x16x32_bf16 v[220:223], v[64:67], v[192:195], v[220:223]
    v_cvt_pk_bf16_f32 v70, v230, v231
    v_cvt_pk_bf16_f32 v181, v206, v207
    v_mfma_f32_16x16x32_bf16 v[224:227], a[248:251], v[192:195], v[224:227]
    ds_read_b128 v[204:207], v246 offset:320
    v_mfma_f32_16x16x32_bf16 v[196:199], v[150:153], v[168:171], v[196:199]
    v_exp_f32 v210, v210
    v_mfma_f32_16x16x32_bf16 v[196:199], v[152:155], v[170:173], v[196:199]
    v_exp_f32 v211, v211
    v_mfma_f32_16x16x32_bf16 v[232:235], a[8:11], a[224:227], v[232:235]
    s_waitcnt lgkmcnt(6)
    v_cvt_pk_bf16_f32 v182, v210, v211
    v_mfma_f32_16x16x32_bf16 v[232:235], a[12:15], a[228:231], v[232:235]
    s_waitcnt lgkmcnt(5)
    ds_read_b128 v[208:211], v244 offset:0
    v_mfma_f32_16x16x32_bf16 v[212:215], v[8:11], v[180:183], v[212:215]
    v_exp_f32 v196, v196
    v_mfma_f32_16x16x32_bf16 v[216:219], v[38:41], v[180:183], v[216:219]
    s_waitcnt lgkmcnt(4)
    v_exp_f32 v197, v197
    v_mfma_f32_16x16x32_bf16 v[220:223], v[68:71], v[180:183], v[220:223]
    s_waitcnt vmcnt(3)
    ds_read_b64_tr_b16 a[152:153], v249 offset:0
    v_mfma_f32_16x16x32_bf16 v[224:227], a[248:251], v[180:183], v[224:227]
    ds_read_b64_tr_b16 a[154:155], v250 offset:0
    ds_read_b64_tr_b16 a[176:177], v249 offset:32
    v_mfma_f32_16x16x32_bf16 v[200:203], v[162:165], v[168:171], v[200:203]
    ds_read_b64_tr_b16 a[178:179], v250 offset:32
    ds_read_b64_tr_b16 a[200:201], v249 offset:64
    v_mfma_f32_16x16x32_bf16 v[200:203], v[164:167], v[170:173], v[200:203]
    ds_read_b64_tr_b16 a[202:203], v250 offset:64
    v_cvt_pk_bf16_f32 v186, v196, v197
    v_mfma_f32_16x16x32_bf16 v[232:235], a[16:19], a[232:235], v[232:235]
    ds_read_b128 v[196:199], v245 offset:0
    v_mfma_f32_16x16x32_bf16 v[232:235], a[20:23], a[236:239], v[232:235]
    v_mfma_f32_16x16x32_bf16 v[236:239], a[28:31], a[220:223], v[236:239]
    v_mfma_f32_16x16x32_bf16 v[236:239], a[32:35], a[224:227], v[236:239]
    v_mfma_f32_16x16x32_bf16 v[236:239], a[36:39], a[228:231], v[236:239]
    v_exp_f32 v200, v200
    v_mfma_f32_16x16x32_bf16 v[236:239], a[40:43], a[232:235], v[236:239]
    v_exp_f32 v201, v201
    v_mfma_f32_16x16x32_bf16 v[236:239], a[44:47], a[236:239], v[236:239]
    v_cvt_pk_bf16_f32 v184, v200, v201
    v_cvt_pk_bf16_f32 v102, v232, v233
    v_mfma_f32_16x16x32_bf16 v[228:231], a[48:51], a[216:219], 0
    ds_read_b128 v[200:203], v246 offset:0
    v_cvt_pk_bf16_f32 v103, v234, v235
    v_mfma_f32_16x16x32_bf16 v[228:231], a[52:55], a[220:223], v[228:231]
    s_waitcnt lgkmcnt(2)
    buffer_load_dwordx4 v252, s[12:15], s62 offen lds
    v_mfma_f32_16x16x32_bf16 v[208:211], v[144:147], v[174:177], v[208:211]
    s_waitcnt vmcnt(1)
    ds_read_b64_tr_b16 a[156:157], v249 offset:3072
    v_mfma_f32_16x16x32_bf16 v[208:211], v[146:149], v[176:179], v[208:211]
    ds_read_b64_tr_b16 a[158:159], v250 offset:3072
    ds_read_b64_tr_b16 a[180:181], v249 offset:3104
    v_mfma_f32_16x16x32_bf16 v[228:231], a[56:59], a[224:227], v[228:231]
    ds_read_b64_tr_b16 a[182:183], v250 offset:3104
    ds_read_b64_tr_b16 a[204:205], v249 offset:3136
    v_mfma_f32_16x16x32_bf16 v[228:231], a[60:63], a[228:231], v[228:231]
    ds_read_b64_tr_b16 a[206:207], v250 offset:3136
    buffer_load_dwordx4 v253, s[12:15], s62 offen offset:1024 lds
    v_mfma_f32_16x16x32_bf16 v[228:231], a[64:67], a[232:235], v[228:231]
    s_waitcnt lgkmcnt(7)
    v_cvt_pk_bf16_f32 v104, v236, v237
    v_cvt_pk_bf16_f32 v105, v238, v239
    v_mfma_f32_16x16x32_bf16 v[196:199], v[96:99], v[174:177], v[196:199]
    v_exp_f32 v208, v208
    v_mfma_f32_16x16x32_bf16 v[204:207], v[102:105], v[168:171], v[204:207]
    v_exp_f32 v209, v209
    v_mfma_f32_16x16x32_bf16 v[196:199], v[98:101], v[176:179], v[196:199]
    buffer_load_dwordx4 v251, s[12:15], s62 offen offset:2048 lds
    v_cvt_pk_bf16_f32 v190, v208, v209
    v_mfma_f32_16x16x32_bf16 v[228:231], a[68:71], a[236:239], v[228:231]
    s_add_u32 m0, s46, 0x17400
    v_exp_f32 v210, v210
    v_mfma_f32_16x16x32_bf16 v[232:235], a[216:219], a[72:75], 0
    v_exp_f32 v211, v211
    v_mfma_f32_16x16x32_bf16 v[232:235], a[220:223], a[76:79], v[232:235]
    ds_read_b64 v[168:169], v247 offset:36864
    v_cvt_pk_bf16_f32 v193, v210, v211
    v_mfma_f32_16x16x32_bf16 v[232:235], a[224:227], a[80:83], v[232:235]
    s_waitcnt lgkmcnt(7)
    s_waitcnt lgkmcnt(1)
    v_cvt_pk_bf16_f32 v106, v228, v229
    v_mfma_f32_16x16x32_bf16 v[200:203], v[132:135], v[174:177], v[200:203]
    buffer_load_dwordx4 v252, s[12:15], s63 offen lds
    v_cvt_pk_bf16_f32 v107, v230, v231
    v_mfma_f32_16x16x32_bf16 v[200:203], v[134:137], v[176:179], v[200:203]
    ds_read_b128 v[208:211], v245 offset:64
    v_mfma_f32_16x16x32_bf16 v[204:207], v[104:107], v[170:173], v[204:207]
    v_exp_f32 v196, v196
    v_mfma_f32_16x16x32_bf16 v[232:235], a[228:231], a[84:87], v[232:235]
    v_exp_f32 v197, v197
    v_mfma_f32_16x16x32_bf16 v[232:235], a[232:235], a[88:91], v[232:235]
    buffer_load_dwordx4 v253, s[12:15], s63 offen offset:1024 lds
    v_cvt_pk_bf16_f32 v188, v196, v197
    v_mfma_f32_16x16x32_bf16 v[232:235], a[236:239], a[92:95], v[232:235]
    v_exp_f32 v198, v198
    v_mfma_f32_16x16x32_bf16 v[236:239], a[216:219], a[96:99], 0
    v_exp_f32 v204, v204
    v_mfma_f32_16x16x32_bf16 v[236:239], a[220:223], a[100:103], v[236:239]
    v_exp_f32 v205, v205
    v_mfma_f32_16x16x32_bf16 v[236:239], a[224:227], a[104:107], v[236:239]
    buffer_load_dwordx4 v251, s[12:15], s63 offen offset:2048 lds
    v_cvt_pk_bf16_f32 v185, v204, v205
    v_mfma_f32_16x16x32_bf16 v[236:239], a[228:231], a[108:111], v[236:239]
    ds_read_b128 v[204:207], v244 offset:64
    v_cvt_pk_bf16_f32 v13, v232, v233
    v_mfma_f32_16x16x32_bf16 v[224:227], a[248:251], v[184:187], v[224:227]
    ds_read_b64 v[170:171], v247 offset:36992
    v_cvt_pk_bf16_f32 v16, v234, v235
    v_mfma_f32_16x16x32_bf16 v[212:215], v[12:15], v[184:187], v[212:215]
    v_exp_f32 v199, v199
    v_mfma_f32_16x16x32_bf16 v[236:239], a[232:235], a[112:115], v[236:239]
    v_exp_f32 v200, v200
    v_mfma_f32_16x16x32_bf16 v[236:239], a[236:239], a[116:119], v[236:239]
    v_exp_f32 v201, v201
    v_mfma_f32_16x16x32_bf16 v[228:231], a[216:219], a[120:123], 0
    ds_read_b128 a[216:219], v240 offset:4736
    v_cvt_pk_bf16_f32 v191, v198, v199
    v_mfma_f32_16x16x32_bf16 v[228:231], a[220:223], a[124:127], v[228:231]
    ds_read_b128 a[220:223], v241 offset:4736
    v_cvt_pk_bf16_f32 v189, v200, v201
    v_mfma_f32_16x16x32_bf16 v[228:231], a[224:227], a[128:131], v[228:231]
    ds_read_b128 a[224:227], v240 offset:4864
    v_cvt_pk_bf16_f32 v43, v236, v237
    v_mfma_f32_16x16x32_bf16 v[228:231], a[228:231], a[132:135], v[228:231]
    ds_read_b128 a[228:231], v241 offset:4864
    v_cvt_pk_bf16_f32 v46, v238, v239
    v_mfma_f32_16x16x32_bf16 v[216:219], v[42:45], v[184:187], v[216:219]
    s_waitcnt lgkmcnt(6)
    v_rcp_f32 v225, v224
    v_mfma_f32_16x16x32_bf16 v[208:211], v[162:165], v[174:177], v[208:211]
    v_mul_f32 v212, v212, v225
    v_mul_f32 v213, v213, v225
    v_mfma_f32_16x16x32_bf16 v[208:211], v[164:167], v[176:179], v[208:211]
    v_mul_f32 v214, v214, v225
    v_mul_f32 v215, v215, v225
    v_mfma_f32_16x16x32_bf16 v[228:231], a[232:235], a[136:139], v[228:231]
    ds_read_b128 v[196:199], v246 offset:64
    v_cvt_pk_bf16_f32 v212, v212, v213
    v_mfma_f32_16x16x32_bf16 v[228:231], a[236:239], a[140:143], v[228:231]
    v_cvt_pk_bf16_f32 v213, v214, v215
    s_waitcnt lgkmcnt(6)
    v_mfma_f32_16x16x32_bf16 v[204:207], v[150:153], v[174:177], v[204:207]
    ds_write_b64 v247, v[212:213] offset:24576
    v_mfma_f32_16x16x32_bf16 v[212:215], v[6:9], v[188:191], 0
    v_mul_f32 v216, v216, v225
    v_mul_f32 v217, v217, v225
    v_mfma_f32_16x16x32_bf16 v[204:207], v[152:155], v[176:179], v[204:207]
    v_cvt_pk_bf16_f32 v73, v228, v229
    v_cvt_pk_bf16_f32 v76, v230, v231
    v_mfma_f32_16x16x32_bf16 v[232:235], a[0:3], a[240:243], 0
    v_mul_f32 v218, v218, v225
    v_mul_f32 v219, v219, v225
    v_mfma_f32_16x16x32_bf16 v[220:223], v[72:75], v[184:187], v[220:223]
    v_cvt_pk_bf16_f32 v216, v216, v217
    v_cvt_pk_bf16_f32 v217, v218, v219
    v_mfma_f32_16x16x32_bf16 v[232:235], a[4:7], a[244:247], v[232:235]
    s_waitcnt lgkmcnt(4)
    v_exp_f32 v202, v202
    v_mfma_f32_16x16x32_bf16 v[232:235], a[8:11], a[216:219], v[232:235]
    ds_write_b64 v247, v[216:217] offset:24704
    v_mfma_f32_16x16x32_bf16 v[216:219], v[36:39], v[188:191], 0
    v_mul_f32 v220, v220, v225
    v_mul_f32 v221, v221, v225
    v_mfma_f32_16x16x32_bf16 v[232:235], a[12:15], a[220:223], v[232:235]
    s_waitcnt lgkmcnt(3)
    v_mul_f32 v222, v222, v225
    v_mul_f32 v223, v223, v225
    v_mfma_f32_16x16x32_bf16 v[232:235], a[16:19], a[224:227], v[232:235]
    v_cvt_pk_bf16_f32 v220, v220, v221
    v_cvt_pk_bf16_f32 v221, v222, v223
    v_mfma_f32_16x16x32_bf16 v[232:235], a[20:23], a[228:231], v[232:235]
    ds_write_b64 v247, v[220:221] offset:24832
    v_mfma_f32_16x16x32_bf16 v[220:223], v[66:69], v[188:191], 0
    s_waitcnt lgkmcnt(3)
    v_exp_f32 v203, v203
    v_mfma_f32_16x16x32_bf16 v[196:199], v[102:105], v[174:177], v[196:199]
    v_max3_f32 v248, v248, v224, v225
    v_cvt_pk_bf16_f32 v192, v202, v203
    v_mfma_f32_16x16x32_bf16 v[224:227], a[248:251], v[188:191], 0
    v_cvt_pk_bf16_f32 v138, v232, v233
    v_cvt_pk_bf16_f32 v139, v234, v235
    v_mfma_f32_16x16x32_bf16 v[196:199], v[104:107], v[176:179], v[196:199]
    ds_read_b128 v[200:203], v244 offset:128
    ds_read_b64 v[172:173], v247 offset:37120
    v_mfma_f32_16x16x32_bf16 v[236:239], a[24:27], a[240:243], 0
L_h7:
    s_cbranch_execz L_hback
    v_exp_f32 v204, v204
    v_mfma_f32_16x16x32_bf16 v[236:239], a[28:31], a[244:247], v[236:239]
    v_exp_f32 v205, v205
    v_mfma_f32_16x16x32_bf16 v[236:239], a[32:35], a[216:219], v[236:239]
    v_exp_f32 v206, v206
    v_mfma_f32_16x16x32_bf16 v[236:239], a[36:39], a[220:223], v[236:239]
    v_exp_f32 v207, v207
    v_mfma_f32_16x16x32_bf16 v[236:239], a[40:43], a[224:227], v[236:239]
    v_cvt_pk_bf16_f32 v180, v204, v205
    v_cvt_pk_bf16_f32 v183, v206, v207
    v_mfma_f32_16x16x32_bf16 v[236:239], a[44:47], a[228:231], v[236:239]
    ds_read_b128 v[204:207], v245 offset:128
    v_mfma_f32_16x16x32_bf16 v[228:231], a[48:51], a[240:243], 0
    v_exp_f32 v208, v208
    v_mfma_f32_16x16x32_bf16 v[228:231], a[52:55], a[244:247], v[228:231]
    v_exp_f32 v209, v209
    v_mfma_f32_16x16x32_bf16 v[228:231], a[56:59], a[216:219], v[228:231]
    v_exp_f32 v196, v196
    v_mfma_f32_16x16x32_bf16 v[228:231], a[60:63], a[220:223], v[228:231]
    v_cvt_pk_bf16_f32 v140, v236, v237
    v_cvt_pk_bf16_f32 v141, v238, v239
    v_mfma_f32_16x16x32_bf16 v[228:231], a[64:67], a[224:227], v[228:231]
    v_exp_f32 v197, v197
    v_mfma_f32_16x16x32_bf16 v[228:231], a[68:71], a[228:231], v[228:231]
    v_cvt_pk_bf16_f32 v194, v208, v209
    v_cvt_pk_bf16_f32 v195, v196, v197
    v_mfma_f32_16x16x32_bf16 v[232:235], a[240:243], a[72:75], 0
    v_exp_f32 v210, v210
    v_mfma_f32_16x16x32_bf16 v[212:215], v[10:13], v[192:195], v[212:215]
    s_waitcnt lgkmcnt(1)
    v_exp_f32 v211, v211
    v_mfma_f32_16x16x32_bf16 v[216:219], v[40:43], v[192:195], v[216:219]
    v_cvt_pk_bf16_f32 v142, v228, v229
    v_cvt_pk_bf16_f32 v143, v230, v231
    v_mfma_f32_16x16x32_bf16 v[220:223], v[70:73], v[192:195], v[220:223]
    v_exp_f32 v198, v198
    v_mfma_f32_16x16x32_bf16 v[224:227], a[248:251], v[192:195], v[224:227]
    v_exp_f32 v199, v199
    v_mfma_f32_16x16x32_bf16 v[200:203], v[156:159], v[174:177], v[200:203]
    v_cvt_pk_bf16_f32 v181, v210, v211
    v_cvt_pk_bf16_f32 v182, v198, v199
    v_mfma_f32_16x16x32_bf16 v[200:203], v[158:161], v[176:179], v[200:203]
    ds_read_b128 v[208:211], v246 offset:128
    s_waitcnt lgkmcnt(1)
    v_mfma_f32_16x16x32_bf16 v[212:215], v[14:17], v[180:183], v[212:215]
    ds_read_b128 v[196:199], v244 offset:0
    v_mfma_f32_16x16x32_bf16 v[216:219], v[44:47], v[180:183], v[216:219]
    v_mfma_f32_16x16x32_bf16 v[220:223], v[74:77], v[180:183], v[220:223]
    v_mfma_f32_16x16x32_bf16 v[224:227], a[248:251], v[180:183], v[224:227]
    v_mfma_f32_16x16x32_bf16 v[204:207], v[114:117], v[174:177], v[204:207]
    v_exp_f32 v200, v200
    v_mfma_f32_16x16x32_bf16 v[204:207], v[116:119], v[176:179], v[204:207]
    s_waitcnt vmcnt(3)
    ds_read_b64_tr_b16 a[160:161], v249 offset:0
    v_mfma_f32_16x16x32_bf16 v[232:235], a[244:247], a[76:79], v[232:235]
    ds_read_b64_tr_b16 a[162:163], v250 offset:0
    s_waitcnt vmcnt(0)
    v_mfma_f32_16x16x32_bf16 v[232:235], a[216:219], a[80:83], v[232:235]
    ds_read_b64_tr_b16 a[164:165], v249 offset:3072
    ds_read_b64_tr_b16 a[166:167], v250 offset:3072
    v_mfma_f32_16x16x32_bf16 v[232:235], a[220:223], a[84:87], v[232:235]
    ds_read_b64_tr_b16 a[184:185], v249 offset:32
    ds_read_b64_tr_b16 a[186:187], v250 offset:32
    v_mfma_f32_16x16x32_bf16 v[232:235], a[224:227], a[88:91], v[232:235]
    ds_read_b64_tr_b16 a[188:189], v249 offset:3104
    ds_read_b64_tr_b16 a[190:191], v250 offset:3104
    v_mfma_f32_16x16x32_bf16 v[232:235], a[228:231], a[92:95], v[232:235]
    ds_read_b64_tr_b16 a[208:209], v249 offset:64
    ds_read_b64_tr_b16 a[210:211], v250 offset:64
    v_mfma_f32_16x16x32_bf16 v[236:239], a[240:243], a[96:99], 0
    ds_read_b64_tr_b16 a[212:213], v249 offset:3136
    ds_read_b64_tr_b16 a[214:215], v250 offset:3136
    v_mfma_f32_16x16x32_bf16 v[236:239], a[244:247], a[100:103], v[236:239]
    s_waitcnt lgkmcnt(13)
    v_exp_f32 v201, v201
    v_mfma_f32_16x16x32_bf16 v[208:211], v[138:141], v[174:177], v[208:211]
    s_waitcnt lgkmcnt(12)
    v_cvt_pk_bf16_f32 v19, v232, v233
    v_mbcnt_lo_u32_b32 v232, -1, 0
    v_mfma_f32_16x16x32_bf16 v[208:211], v[140:143], v[176:179], v[208:211]
    v_mbcnt_hi_u32_b32 v232, -1, v232
    v_cvt_pk_bf16_f32 v22, v234, v235
    v_mfma_f32_16x16x32_bf16 v[196:199], v[150:153], v[168:171], v[196:199]
    v_and_b32 v233, 15, v232
    v_lshrrev_b32 v232, 4, v232
    v_mfma_f32_16x16x32_bf16 v[196:199], v[152:155], v[170:173], v[196:199]
    v_lshrrev_b32 v234, 1, v233
    v_mul_u32_u24 v235, 0x180, v233
    v_mfma_f32_16x16x32_bf16 v[236:239], a[216:219], a[104:107], v[236:239]
    v_xor_b32 v243, v232, v234
    v_lshl_add_u32 v242, v243, 4, v235
    v_mfma_f32_16x16x32_bf16 v[236:239], a[220:223], a[108:111], v[236:239]
    v_xor_b32 v243, 64, v242
    v_add_u32 v242, 0x1e000, v242
    v_mfma_f32_16x16x32_bf16 v[236:239], a[224:227], a[112:115], v[236:239]
    ds_read_b128 a[232:235], v242 offset:0
    v_add_u32 v243, 0x1e000, v243
    v_mfma_f32_16x16x32_bf16 v[236:239], a[228:231], a[116:119], v[236:239]
    ds_read_b128 a[236:239], v243 offset:0
    v_lshrrev_b32 v249, 1, v232
    v_mfma_f32_16x16x32_bf16 v[228:231], a[240:243], a[120:123], 0
    ds_read_b128 a[240:243], v242 offset:128
    v_or_b32 v249, s66, v249
    v_mfma_f32_16x16x32_bf16 v[228:231], a[244:247], a[124:127], v[228:231]
    ds_read_b128 a[244:247], v243 offset:128
    v_mov_b32 v253, v249
    v_mfma_f32_16x16x32_bf16 v[228:231], a[216:219], a[128:131], v[228:231]
    ds_read_b128 a[216:219], v242 offset:256
    v_cvt_pk_bf16_f32 v49, v236, v237
    v_mfma_f32_16x16x32_bf16 v[228:231], a[220:223], a[132:135], v[228:231]
    ds_read_b128 a[220:223], v243 offset:256
    v_cvt_pk_bf16_f32 v52, v238, v239
    v_mfma_f32_16x16x32_bf16 v[228:231], a[224:227], a[136:139], v[228:231]
    ds_read_b128 a[224:227], v242 offset:6144
    v_xor_b32 v249, v249, v234
    v_mfma_f32_16x16x32_bf16 v[228:231], a[228:231], a[140:143], v[228:231]
    v_lshl_add_u32 v249, v249, 4, v235
    v_and_b32 v235, 1, v232
    v_lshl_add_u32 v249, v235, 3, v249
    v_lshlrev_b32 v235, 3, v235
    s_waitcnt lgkmcnt(6)
    v_mfma_f32_16x16x32_bf16 v[236:239], a[144:147], a[232:235], 0
    s_barrier
    v_xor_b32 v250, s67, v232
    s_waitcnt lgkmcnt(5)
    v_mfma_f32_16x16x32_bf16 v[236:239], a[148:151], a[236:239], v[236:239]
    s_mul_i32 s67, s28, 0x600
    v_cvt_pk_bf16_f32 v79, v228, v229
    s_waitcnt lgkmcnt(4)
    v_mfma_f32_16x16x32_bf16 v[236:239], a[152:155], a[240:243], v[236:239]
    s_add_u32 s67, s67, 0x16800
    v_cvt_pk_bf16_f32 v82, v230, v231
    s_waitcnt lgkmcnt(3)
    v_mfma_f32_16x16x32_bf16 v[236:239], a[156:159], a[244:247], v[236:239]
    v_xor_b32 v252, v233, v235
    s_waitcnt lgkmcnt(2)
    v_mfma_f32_16x16x32_bf16 v[236:239], a[160:163], a[216:219], v[236:239]
    v_xor_b32 v252, v252, v253
    s_waitcnt lgkmcnt(1)
    v_mfma_f32_16x16x32_bf16 v[236:239], a[164:167], a[220:223], v[236:239]
    v_mul_u32_u24 v250, 0x300, v250
    v_mul_u32_u24 v232, 0x180, v232
    v_mfma_f32_16x16x32_bf16 v[228:231], a[168:171], a[232:235], 0
    v_xor_b32 v253, v253, v234
    v_add_u32 v232, s67, v232
    v_mfma_f32_16x16x32_bf16 v[228:231], a[172:175], a[236:239], v[228:231]
    s_lshl2_add_u32 s67, s28, 0x23000
    v_and_b32 v234, 1, v233
    v_lshl_add_u32 v251, v233, 3, v250
    v_mfma_f32_16x16x32_bf16 v[228:231], a[176:179], a[240:243], v[228:231]
    ds_read_b128 a[228:231], v243 offset:6144
    v_lshl_add_u32 v253, v253, 4, v232
    v_mfma_f32_16x16x32_bf16 v[228:231], a[180:183], a[244:247], v[228:231]
    v_xor_b32 v233, v233, v235
    v_lshl_add_u32 v252, v252, 4, v232
    v_mfma_f32_16x16x32_bf16 v[228:231], a[184:187], a[216:219], v[228:231]
    v_lshl_add_u32 v253, v234, 3, v253
    v_lshl_add_u32 v250, v233, 4, v250
    v_mfma_f32_16x16x32_bf16 v[228:231], a[188:191], a[220:223], v[228:231]
    v_cvt_pk_bf16_f32 v236, v236, v237
    v_add_u32 v249, 0x16800, v249
    v_mfma_f32_16x16x32_bf16 v[232:235], a[192:195], a[232:235], 0
    ds_read_b128 a[232:235], v242 offset:6272
    v_cvt_pk_bf16_f32 v237, v238, v239
    v_mfma_f32_16x16x32_bf16 v[232:235], a[196:199], a[236:239], v[232:235]
    ds_read_b128 a[236:239], v243 offset:6272
    v_cvt_pk_bf16_f32 v186, v200, v201
    v_mfma_f32_16x16x32_bf16 v[232:235], a[200:203], a[240:243], v[232:235]
    ds_read_b128 a[240:243], v242 offset:6400
    v_cvt_pk_bf16_f32 v228, v228, v229
    v_mfma_f32_16x16x32_bf16 v[232:235], a[204:207], a[244:247], v[232:235]
    ds_read_b128 a[244:247], v243 offset:6400
    v_cvt_pk_bf16_f32 v229, v230, v231
    v_mfma_f32_16x16x32_bf16 v[232:235], a[208:211], a[216:219], v[232:235]
    ds_write_b64 v249, v[236:237] offset:0
    v_mfma_f32_16x16x32_bf16 v[232:235], a[212:215], a[220:223], v[232:235]
    s_waitcnt lgkmcnt(6)
    v_exp_f32 v204, v204
    v_mfma_f32_16x16x32_bf16 v[236:239], a[144:147], a[224:227], 0
    s_waitcnt lgkmcnt(5)
    v_exp_f32 v205, v205
    v_mfma_f32_16x16x32_bf16 v[236:239], a[148:151], a[228:231], v[236:239]
    ds_write_b64 v249, v[228:229] offset:128
    v_mfma_f32_16x16x32_bf16 v[228:231], a[168:171], a[224:227], 0
    s_waitcnt lgkmcnt(5)
    ds_read_b128 v[200:203], v245 offset:0
    v_mfma_f32_16x16x32_bf16 v[236:239], a[152:155], a[232:235], v[236:239]
    s_waitcnt lgkmcnt(5)
    v_cvt_pk_bf16_f32 v232, v232, v233
    v_cvt_pk_bf16_f32 v184, v204, v205
    v_mfma_f32_16x16x32_bf16 v[236:239], a[156:159], a[236:239], v[236:239]
    s_waitcnt lgkmcnt(4)
    v_exp_f32 v208, v208
    v_mfma_f32_16x16x32_bf16 v[236:239], a[160:163], a[240:243], v[236:239]
    s_waitcnt lgkmcnt(3)
    v_exp_f32 v209, v209
    v_mfma_f32_16x16x32_bf16 v[236:239], a[164:167], a[244:247], v[236:239]
    ds_read_b128 v[204:207], v246 offset:0
    v_cvt_pk_bf16_f32 v233, v234, v235
    v_mfma_f32_16x16x32_bf16 v[228:231], a[172:175], a[228:231], v[228:231]
    ds_write_b64 v249, v[232:233] offset:256
    v_mfma_f32_16x16x32_bf16 v[228:231], a[176:179], a[232:235], v[228:231]
    ds_read_b128 a[216:219], v242 offset:12288
    v_cvt_pk_bf16_f32 v185, v208, v209
    v_mfma_f32_16x16x32_bf16 v[228:231], a[180:183], a[236:239], v[228:231]
    ds_read_b128 a[220:223], v243 offset:12288
    v_cvt_pk_bf16_f32 v236, v236, v237
    v_mfma_f32_16x16x32_bf16 v[212:215], v[18:21], v[184:187], v[212:215]
    ds_read_b128 v[208:211], v244 offset:64
    v_cvt_pk_bf16_f32 v237, v238, v239
    v_mfma_f32_16x16x32_bf16 v[216:219], v[48:51], v[184:187], v[216:219]
    v_exp_f32 v196, v196
    v_mfma_f32_16x16x32_bf16 v[220:223], v[78:81], v[184:187], v[220:223]
    s_waitcnt lgkmcnt(5)
    v_exp_f32 v197, v197
    v_mfma_f32_16x16x32_bf16 v[224:227], a[248:251], v[184:187], v[224:227]
    v_exp_f32 v198, v198
    v_mfma_f32_16x16x32_bf16 v[200:203], v[162:165], v[168:171], v[200:203]
    v_exp_f32 v199, v199
    v_mfma_f32_16x16x32_bf16 v[200:203], v[164:167], v[170:173], v[200:203]
    v_cvt_pk_bf16_f32 v190, v196, v197
    v_cvt_pk_bf16_f32 v193, v198, v199
    v_mfma_f32_16x16x32_bf16 v[228:231], a[184:187], a[240:243], v[228:231]
    ds_read_b128 v[196:199], v245 offset:64
    ds_read_b64 v[174:175], v247 offset:43008
    v_mfma_f32_16x16x32_bf16 v[228:231], a[188:191], a[244:247], v[228:231]
    ds_write_b64 v249, v[236:237] offset:6144
    v_mfma_f32_16x16x32_bf16 v[232:235], a[192:195], a[224:227], 0
    ds_read_b128 a[224:227], v242 offset:12416
    s_waitcnt lgkmcnt(8)
    v_mfma_f32_16x16x32_bf16 v[204:207], v[102:105], v[168:171], v[204:207]
    v_exp_f32 v200, v200
    v_mfma_f32_16x16x32_bf16 v[204:207], v[104:107], v[170:173], v[204:207]
    v_exp_f32 v201, v201
    v_mfma_f32_16x16x32_bf16 v[232:235], a[196:199], a[228:231], v[232:235]
    ds_read_b128 a[228:231], v243 offset:12416
    s_waitcnt lgkmcnt(7)
    v_mfma_f32_16x16x32_bf16 v[232:235], a[200:203], a[232:235], v[232:235]
    ds_read_b128 a[232:235], v242 offset:12544
    v_cvt_pk_bf16_f32 v228, v228, v229
    v_mfma_f32_16x16x32_bf16 v[232:235], a[204:207], a[236:239], v[232:235]
    ds_read_b128 a[236:239], v243 offset:12544
    s_waitcnt lgkmcnt(7)
    v_mfma_f32_16x16x32_bf16 v[208:211], v[156:159], v[168:171], v[208:211]
    v_cvt_pk_bf16_f32 v229, v230, v231
    v_add_u32 v242, 0xfffe9800, v242
    v_mfma_f32_16x16x32_bf16 v[208:211], v[158:161], v[170:173], v[208:211]
    ds_write_b64 v249, v[228:229] offset:6272
    v_mfma_f32_16x16x32_bf16 v[232:235], a[208:211], a[240:243], v[232:235]
    ds_read_b128 a[240:243], v242 offset:6144
    v_add_u32 v243, 0xfffe9800, v243
    v_mfma_f32_16x16x32_bf16 v[232:235], a[212:215], a[244:247], v[232:235]
    ds_read_b128 a[244:247], v243 offset:6144
    v_cvt_pk_bf16_f32 v188, v200, v201
    v_mfma_f32_16x16x32_bf16 v[236:239], a[144:147], a[216:219], 0
    v_exp_f32 v202, v202
    v_mfma_f32_16x16x32_bf16 v[236:239], a[148:151], a[220:223], v[236:239]
    s_waitcnt lgkmcnt(6)
    v_exp_f32 v203, v203
    v_mfma_f32_16x16x32_bf16 v[196:199], v[114:117], v[168:171], v[196:199]
    v_cvt_pk_bf16_f32 v232, v232, v233
    v_cvt_pk_bf16_f32 v191, v202, v203
    v_mfma_f32_16x16x32_bf16 v[196:199], v[116:119], v[170:173], v[196:199]
    ds_read_b128 v[200:203], v246 offset:64
    v_cvt_pk_bf16_f32 v233, v234, v235
    v_mfma_f32_16x16x32_bf16 v[236:239], a[152:155], a[224:227], v[236:239]
    s_waitcnt lgkmcnt(6)
    v_rcp_f32 v225, v224
    v_mfma_f32_16x16x32_bf16 v[236:239], a[156:159], a[228:231], v[236:239]
    s_waitcnt lgkmcnt(5)
    v_exp_f32 v204, v204
    v_mfma_f32_16x16x32_bf16 v[236:239], a[160:163], a[232:235], v[236:239]
    s_waitcnt lgkmcnt(4)
    v_exp_f32 v205, v205
    v_mfma_f32_16x16x32_bf16 v[236:239], a[164:167], a[236:239], v[236:239]
    ds_write_b64 v249, v[232:233] offset:6400
    v_mfma_f32_16x16x32_bf16 v[228:231], a[168:171], a[216:219], 0
    v_mul_f32 v212, v212, v225
    v_mul_f32 v213, v213, v225
    v_mfma_f32_16x16x32_bf16 v[228:231], a[172:175], a[220:223], v[228:231]
    v_cvt_pk_bf16_f32 v189, v204, v205
    v_mul_f32 v214, v214, v225
    v_mfma_f32_16x16x32_bf16 v[228:231], a[176:179], a[224:227], v[228:231]
    v_cvt_pk_bf16_f32 v236, v236, v237
    v_cvt_pk_bf16_f32 v237, v238, v239
    v_mfma_f32_16x16x32_bf16 v[228:231], a[180:183], a[228:231], v[228:231]
    ds_write_b64 v249, v[236:237] offset:12288
    v_mfma_f32_16x16x32_bf16 v[228:231], a[184:187], a[232:235], v[228:231]
    s_waitcnt lgkmcnt(3)
    v_mul_f32 v215, v215, v225
    v_cvt_pk_bf16_f32 v212, v212, v213
    v_mfma_f32_16x16x32_bf16 v[228:231], a[188:191], a[236:239], v[228:231]
    v_cvt_pk_bf16_f32 v213, v214, v215
    v_mul_f32 v216, v216, v225
    v_mfma_f32_16x16x32_bf16 v[232:235], a[192:195], a[216:219], 0
    ds_read_b128 a[216:219], v242 offset:6272
    v_mul_f32 v217, v217, v225
    v_mfma_f32_16x16x32_bf16 v[232:235], a[196:199], a[220:223], v[232:235]
    ds_read_b128 a[220:223], v243 offset:6272
    v_mul_f32 v218, v218, v225
    v_mfma_f32_16x16x32_bf16 v[232:235], a[200:203], a[224:227], v[232:235]
    ds_read_b128 a[224:227], v242 offset:6400
    v_mul_f32 v219, v219, v225
    v_mfma_f32_16x16x32_bf16 v[232:235], a[204:207], a[228:231], v[232:235]
    ds_read_b128 a[228:231], v243 offset:6400
    s_waitcnt lgkmcnt(6)
    v_mfma_f32_16x16x32_bf16 v[200:203], v[138:141], v[168:171], v[200:203]
    ds_write_b64 v247, v[212:213] offset:30720
    v_mfma_f32_16x16x32_bf16 v[212:215], v[12:15], v[188:191], 0
    v_cvt_pk_bf16_f32 v216, v216, v217
    v_cvt_pk_bf16_f32 v217, v218, v219
    v_mfma_f32_16x16x32_bf16 v[200:203], v[140:143], v[170:173], v[200:203]
    ds_write_b64 v247, v[216:217] offset:30848
    v_mfma_f32_16x16x32_bf16 v[216:219], v[42:45], v[188:191], 0
    v_cvt_pk_bf16_f32 v228, v228, v229
    v_cvt_pk_bf16_f32 v229, v230, v231
    v_mfma_f32_16x16x32_bf16 v[232:235], a[208:211], a[232:235], v[232:235]
    ds_write_b64 v249, v[228:229] offset:12416
    v_mfma_f32_16x16x32_bf16 v[232:235], a[212:215], a[236:239], v[232:235]
    v_max3_f32 v248, v248, v224, v225
    v_mul_f32 v220, v220, v225
    v_mfma_f32_16x16x32_bf16 v[236:239], a[144:147], a[240:243], 0
    v_mul_f32 v221, v221, v225
    v_mul_f32 v222, v222, v225
    v_mfma_f32_16x16x32_bf16 v[236:239], a[148:151], a[244:247], v[236:239]
    s_waitcnt lgkmcnt(6)
    v_mul_f32 v223, v223, v225
    v_cvt_pk_bf16_f32 v220, v220, v221
    v_mfma_f32_16x16x32_bf16 v[224:227], a[248:251], v[188:191], 0
    ds_read_b128 a[232:235], v240 offset:6144
    v_cvt_pk_bf16_f32 v221, v222, v223
    v_mfma_f32_16x16x32_bf16 v[236:239], a[152:155], a[216:219], v[236:239]
    s_waitcnt lgkmcnt(6)
    v_cvt_pk_bf16_f32 v232, v232, v233
    v_cvt_pk_bf16_f32 v233, v234, v235
    v_mfma_f32_16x16x32_bf16 v[236:239], a[156:159], a[220:223], v[236:239]
    s_waitcnt lgkmcnt(5)
    v_exp_f32 v206, v206
    v_mfma_f32_16x16x32_bf16 v[236:239], a[160:163], a[224:227], v[236:239]
    s_waitcnt lgkmcnt(4)
    v_exp_f32 v207, v207
    v_mfma_f32_16x16x32_bf16 v[236:239], a[164:167], a[228:231], v[236:239]
    ds_write_b64 v247, v[220:221] offset:30976
    v_mfma_f32_16x16x32_bf16 v[220:223], v[72:75], v[188:191], 0
    ds_read_b128 a[236:239], v241 offset:6144
    v_cvt_pk_bf16_f32 v192, v206, v207
    v_mfma_f32_16x16x32_bf16 v[228:231], a[168:171], a[240:243], 0
    ds_write_b64 v249, v[232:233] offset:12544
    v_mfma_f32_16x16x32_bf16 v[228:231], a[172:175], a[244:247], v[228:231]
    ds_read_b128 v[204:207], v244 offset:128
    v_cvt_pk_bf16_f32 v236, v236, v237
    v_mfma_f32_16x16x32_bf16 v[228:231], a[176:179], a[216:219], v[228:231]
    ds_read_b64 v[176:177], v247 offset:43136
    v_cvt_pk_bf16_f32 v237, v238, v239
    v_mfma_f32_16x16x32_bf16 v[228:231], a[180:183], a[220:223], v[228:231]
    ds_write_b64 v249, v[236:237] offset:18432
    v_mfma_f32_16x16x32_bf16 v[228:231], a[184:187], a[224:227], v[228:231]
    v_exp_f32 v196, v196
    v_mfma_f32_16x16x32_bf16 v[228:231], a[188:191], a[228:231], v[228:231]
    v_exp_f32 v197, v197
    v_mfma_f32_16x16x32_bf16 v[232:235], a[192:195], a[240:243], 0
    ds_read_b128 a[240:243], v240 offset:6272
    s_waitcnt lgkmcnt(7)
    v_mfma_f32_16x16x32_bf16 v[232:235], a[196:199], a[244:247], v[232:235]
    ds_read_b128 a[244:247], v241 offset:6272
    v_cvt_pk_bf16_f32 v194, v196, v197
    v_mfma_f32_16x16x32_bf16 v[232:235], a[200:203], a[216:219], v[232:235]
    ds_read_b128 a[216:219], v240 offset:6400
    v_cvt_pk_bf16_f32 v228, v228, v229
    v_mfma_f32_16x16x32_bf16 v[232:235], a[204:207], a[220:223], v[232:235]
    ds_read_b128 a[220:223], v241 offset:6400
    v_cvt_pk_bf16_f32 v229, v230, v231
    v_mfma_f32_16x16x32_bf16 v[232:235], a[208:211], a[224:227], v[232:235]
    ds_write_b64 v249, v[228:229] offset:18560
    v_mfma_f32_16x16x32_bf16 v[232:235], a[212:215], a[228:231], v[232:235]
    v_exp_f32 v200, v200
    v_mfma_f32_16x16x32_bf16 v[236:239], a[0:3], a[232:235], 0
    s_waitcnt lgkmcnt(9)
    v_exp_f32 v201, v201
    v_mfma_f32_16x16x32_bf16 v[236:239], a[4:7], a[236:239], v[236:239]
    ds_read_b64 v[178:179], v247 offset:43264
    v_cvt_pk_bf16_f32 v195, v200, v201
    v_mfma_f32_16x16x32_bf16 v[228:231], a[24:27], a[232:235], 0
    s_waitcnt lgkmcnt(5)
    v_exp_f32 v208, v208
    v_mfma_f32_16x16x32_bf16 v[212:215], v[16:19], v[192:195], v[212:215]
    s_barrier
    v_exp_f32 v209, v209
    v_mfma_f32_16x16x32_bf16 v[216:219], v[46:49], v[192:195], v[216:219]
    v_exp_f32 v210, v210
    v_mfma_f32_16x16x32_bf16 v[220:223], v[76:79], v[192:195], v[220:223]
    v_exp_f32 v211, v211
    v_mfma_f32_16x16x32_bf16 v[224:227], a[248:251], v[192:195], v[224:227]
    v_cvt_pk_bf16_f32 v180, v208, v209
    v_cvt_pk_bf16_f32 v183, v210, v211
    v_mfma_f32_16x16x32_bf16 v[204:207], v[108:111], v[168:171], v[204:207]
    ds_read_b128 v[208:211], v245 offset:128
    v_cvt_pk_bf16_f32 v232, v232, v233
    v_mfma_f32_16x16x32_bf16 v[204:207], v[110:113], v[170:173], v[204:207]
    ds_read_b128 a[224:227], v242 offset:12288
    v_cvt_pk_bf16_f32 v233, v234, v235
    v_mfma_f32_16x16x32_bf16 v[236:239], a[8:11], a[240:243], v[236:239]
    s_waitcnt lgkmcnt(5)
    v_exp_f32 v198, v198
    v_mfma_f32_16x16x32_bf16 v[236:239], a[12:15], a[244:247], v[236:239]
    ds_write_b64 v249, v[232:233] offset:18688
    v_mfma_f32_16x16x32_bf16 v[236:239], a[16:19], a[216:219], v[236:239]
    s_waitcnt lgkmcnt(5)
    v_exp_f32 v199, v199
    v_mfma_f32_16x16x32_bf16 v[236:239], a[20:23], a[220:223], v[236:239]
    ds_read_b128 a[228:231], v243 offset:12288
    v_cvt_pk_bf16_f32 v181, v198, v199
    v_mfma_f32_16x16x32_bf16 v[228:231], a[28:31], a[236:239], v[228:231]
    ds_read_b128 v[196:199], v246 offset:128
    ds_read_b128 a[252:255], v252 offset:0
    v_mfma_f32_16x16x32_bf16 v[228:231], a[32:35], a[240:243], v[228:231]
    v_exp_f32 v202, v202
    v_mfma_f32_16x16x32_bf16 v[228:231], a[36:39], a[244:247], v[228:231]
    v_exp_f32 v203, v203
    v_mfma_f32_16x16x32_bf16 v[228:231], a[40:43], a[216:219], v[228:231]
    v_cvt_pk_bf16_f32 v182, v202, v203
    v_cvt_pk_bf16_f32 v144, v236, v237
    v_mfma_f32_16x16x32_bf16 v[228:231], a[44:47], a[220:223], v[228:231]
    ds_read_b128 v[200:203], v244 offset:0
    v_cvt_pk_bf16_f32 v145, v238, v239
    v_mfma_f32_16x16x32_bf16 v[212:215], v[20:23], v[180:183], v[212:215]
    v_exp_f32 v204, v204
    v_mfma_f32_16x16x32_bf16 v[216:219], v[50:53], v[180:183], v[216:219]
    v_exp_f32 v205, v205
    v_mfma_f32_16x16x32_bf16 v[220:223], v[80:83], v[180:183], v[220:223]
    s_waitcnt lgkmcnt(6)
    v_cvt_pk_bf16_f32 v146, v228, v229
    v_cvt_pk_bf16_f32 v147, v230, v231
    v_mfma_f32_16x16x32_bf16 v[224:227], a[248:251], v[180:183], v[224:227]
    ds_read_b64 v[254:255], v253 offset:256
    v_cvt_pk_bf16_f32 v186, v204, v205
    v_mfma_f32_16x16x32_bf16 v[208:211], v[120:123], v[168:171], v[208:211]
    ds_read_b128 v[204:207], v245 offset:0
    v_mfma_f32_16x16x32_bf16 v[208:211], v[122:125], v[170:173], v[208:211]
    v_mfma_f32_16x16x32_bf16 v[232:235], a[48:51], a[232:235], 0
    v_mfma_f32_16x16x32_bf16 v[232:235], a[52:55], a[236:239], v[232:235]
    v_mfma_f32_16x16x32_bf16 v[232:235], a[56:59], a[240:243], v[232:235]
    s_waitcnt lgkmcnt(4)
    v_mfma_f32_16x16x32_bf16 v[196:199], v[144:147], v[168:171], v[196:199]
    ds_read_b64 v[168:169], v247 offset:49152
    s_waitcnt lgkmcnt(4)
    v_mfma_f32_16x16x32_bf16 v[232:235], a[60:63], a[244:247], v[232:235]
    v_exp_f32 v208, v208
    v_mfma_f32_16x16x32_bf16 v[232:235], a[64:67], a[216:219], v[232:235]
    v_exp_f32 v209, v209
    v_mfma_f32_16x16x32_bf16 v[232:235], a[68:71], a[220:223], v[232:235]
    v_cvt_pk_bf16_f32 v184, v208, v209
    s_waitcnt lgkmcnt(3)
    v_mfma_f32_16x16x32_bf16 v[200:203], v[156:159], v[174:177], v[200:203]
    ds_read_b128 v[208:211], v246 offset:0
    v_mfma_f32_16x16x32_bf16 v[200:203], v[158:161], v[176:179], v[200:203]
    buffer_store_dwordx4 a[252:255], v250, s[20:23], s55 offen nt
    v_mfma_f32_16x16x32_bf16 v[236:239], a[232:235], a[72:75], 0
    v_mfma_f32_16x16x32_bf16 v[236:239], a[236:239], a[76:79], v[236:239]
    s_waitcnt lgkmcnt(3)
    v_cvt_pk_bf16_f32 v148, v232, v233
    v_cvt_pk_bf16_f32 v149, v234, v235
    v_mfma_f32_16x16x32_bf16 v[236:239], a[240:243], a[80:83], v[236:239]
    s_waitcnt lgkmcnt(2)
    v_exp_f32 v200, v200
    v_mfma_f32_16x16x32_bf16 v[196:199], v[146:149], v[170:173], v[196:199]
    v_exp_f32 v201, v201
    v_mfma_f32_16x16x32_bf16 v[204:207], v[114:117], v[174:177], v[204:207]
    v_exp_f32 v202, v202
    v_mfma_f32_16x16x32_bf16 v[204:207], v[116:119], v[176:179], v[204:207]
    v_exp_f32 v203, v203
    v_mfma_f32_16x16x32_bf16 v[236:239], a[244:247], a[84:87], v[236:239]
    v_cvt_pk_bf16_f32 v190, v200, v201
    v_cvt_pk_bf16_f32 v193, v202, v203
    v_mfma_f32_16x16x32_bf16 v[236:239], a[216:219], a[88:91], v[236:239]
    v_exp_f32 v196, v196
    v_mfma_f32_16x16x32_bf16 v[236:239], a[220:223], a[92:95], v[236:239]
    v_exp_f32 v197, v197
    v_mfma_f32_16x16x32_bf16 v[228:231], a[232:235], a[96:99], 0
    ds_read_b128 v[200:203], v245 offset:64
    v_cvt_pk_bf16_f32 v185, v196, v197
    v_mfma_f32_16x16x32_bf16 v[228:231], a[236:239], a[100:103], v[228:231]
    ds_read_b128 v[196:199], v244 offset:64
    s_waitcnt lgkmcnt(2)
    v_mfma_f32_16x16x32_bf16 v[224:227], a[248:251], v[184:187], v[224:227]
    v_cvt_pk_bf16_f32 v25, v236, v237
    v_cvt_pk_bf16_f32 v28, v238, v239
    v_mfma_f32_16x16x32_bf16 v[208:211], v[138:141], v[174:177], v[208:211]
    ds_read_b128 a[252:255], v252 offset:6144
    ds_read_b64 v[170:171], v247 offset:49280
    v_mfma_f32_16x16x32_bf16 v[212:215], v[24:27], v[184:187], v[212:215]
    buffer_store_dwordx2 v[254:255], v251, s[20:23], s55 offen offset:256 nt
    v_mfma_f32_16x16x32_bf16 v[208:211], v[140:143], v[176:179], v[208:211]
    ds_read_b64 v[254:255], v253 offset:6400
    ds_read_b64 v[172:173], v247 offset:49408
    v_mfma_f32_16x16x32_bf16 v[228:231], a[240:243], a[104:107], v[228:231]
    s_mul_i32 s55, s31, 3
    v_rcp_f32 v225, v224
    v_mfma_f32_16x16x32_bf16 v[228:231], a[244:247], a[108:111], v[228:231]
    s_add_u32 s54, s54, s55
    v_exp_f32 v204, v204
    v_mfma_f32_16x16x32_bf16 v[228:231], a[216:219], a[112:115], v[228:231]
    s_add_u32 s54, s54, s32
    v_exp_f32 v205, v205
    v_mfma_f32_16x16x32_bf16 v[228:231], a[220:223], a[116:119], v[228:231]
    s_add_u32 s55, s28, 7
    v_exp_f32 v206, v206
    v_mfma_f32_16x16x32_bf16 v[232:235], a[232:235], a[120:123], 0
    ds_read_b128 a[232:235], v242 offset:12416
    v_mul_f32 v212, v212, v225
    v_mfma_f32_16x16x32_bf16 v[232:235], a[236:239], a[124:127], v[232:235]
    ds_read_b128 a[236:239], v243 offset:12416
    v_mul_f32 v213, v213, v225
    v_mfma_f32_16x16x32_bf16 v[232:235], a[240:243], a[128:131], v[232:235]
    s_waitcnt lgkmcnt(6)
    v_cvt_pk_bf16_f32 v55, v228, v229
    v_cvt_pk_bf16_f32 v58, v230, v231
    v_mfma_f32_16x16x32_bf16 v[196:199], v[108:111], v[174:177], v[196:199]
    ds_read_b128 a[240:243], v242 offset:12544
    v_cvt_pk_bf16_f32 v188, v204, v205
    v_mfma_f32_16x16x32_bf16 v[216:219], v[54:57], v[184:187], v[216:219]
    s_mul_i32 s55, s55, s30
    v_exp_f32 v207, v207
    v_mfma_f32_16x16x32_bf16 v[196:199], v[110:113], v[176:179], v[196:199]
    v_exp_f32 v208, v208
    v_mfma_f32_16x16x32_bf16 v[200:203], v[120:123], v[174:177], v[200:203]
    s_waitcnt lgkmcnt(6)
    v_exp_f32 v209, v209
    v_mfma_f32_16x16x32_bf16 v[200:203], v[122:125], v[176:179], v[200:203]
    v_cvt_pk_bf16_f32 v191, v206, v207
    v_cvt_pk_bf16_f32 v189, v208, v209
    v_mfma_f32_16x16x32_bf16 v[232:235], a[244:247], a[132:135], v[232:235]
    ds_read_b128 a[244:247], v243 offset:12544
    v_mul_f32 v214, v214, v225
    v_mfma_f32_16x16x32_bf16 v[232:235], a[216:219], a[136:139], v[232:235]
    ds_read_b128 a[216:219], v242 offset:18432
    v_mul_f32 v215, v215, v225
    v_mfma_f32_16x16x32_bf16 v[232:235], a[220:223], a[140:143], v[232:235]
    ds_read_b128 a[220:223], v243 offset:18432
    v_cvt_pk_bf16_f32 v212, v212, v213
    v_mfma_f32_16x16x32_bf16 v[236:239], a[144:147], a[224:227], 0
    s_waitcnt lgkmcnt(6)
    v_cvt_pk_bf16_f32 v213, v214, v215
    v_mul_f32 v216, v216, v225
    v_mfma_f32_16x16x32_bf16 v[236:239], a[148:151], a[228:231], v[236:239]
    s_waitcnt lgkmcnt(5)
    v_cvt_pk_bf16_f32 v85, v232, v233
    v_cvt_pk_bf16_f32 v88, v234, v235
    v_mfma_f32_16x16x32_bf16 v[236:239], a[152:155], a[232:235], v[236:239]
    s_waitcnt lgkmcnt(4)
    v_mul_f32 v217, v217, v225
    v_mul_f32 v218, v218, v225
    v_mfma_f32_16x16x32_bf16 v[220:223], v[84:87], v[184:187], v[220:223]
    ds_write_b64 v247, v[212:213] offset:36864
    v_mfma_f32_16x16x32_bf16 v[212:215], v[18:21], v[188:191], 0
    v_mul_f32 v219, v219, v225
    v_cvt_pk_bf16_f32 v216, v216, v217
    v_mfma_f32_16x16x32_bf16 v[236:239], a[156:159], a[236:239], v[236:239]
    s_waitcnt lgkmcnt(4)
    v_cvt_pk_bf16_f32 v217, v218, v219
    v_max3_f32 v248, v248, v224, v225
    v_mfma_f32_16x16x32_bf16 v[236:239], a[160:163], a[240:243], v[236:239]
    s_waitcnt lgkmcnt(3)
    v_mul_f32 v220, v220, v225
    v_mul_f32 v221, v221, v225
    v_mfma_f32_16x16x32_bf16 v[236:239], a[164:167], a[244:247], v[236:239]
    ds_write_b64 v247, v[216:217] offset:36992
    v_mfma_f32_16x16x32_bf16 v[216:219], v[48:51], v[188:191], 0
    v_mul_f32 v222, v222, v225
    v_mul_f32 v223, v223, v225
    v_mfma_f32_16x16x32_bf16 v[224:227], a[248:251], v[188:191], 0
    ds_read_b128 v[204:207], v246 offset:64
    v_cvt_pk_bf16_f32 v220, v220, v221
    v_mfma_f32_16x16x32_bf16 v[228:231], a[168:171], a[224:227], 0
    v_cvt_pk_bf16_f32 v236, v236, v237
    v_cvt_pk_bf16_f32 v237, v238, v239
    v_mfma_f32_16x16x32_bf16 v[228:231], a[172:175], a[228:231], v[228:231]
    ds_write_b64 v249, v[236:237] offset:24576
    v_mfma_f32_16x16x32_bf16 v[228:231], a[176:179], a[232:235], v[228:231]
    s_waitcnt lgkmcnt(4)
    v_cvt_pk_bf16_f32 v221, v222, v223
    v_add_u32 v209, 0xfffff900, v245
    v_mfma_f32_16x16x32_bf16 v[228:231], a[180:183], a[236:239], v[228:231]
    ds_write_b64 v247, v[220:221] offset:37120
    v_mfma_f32_16x16x32_bf16 v[220:223], v[78:81], v[188:191], 0
    buffer_store_dwordx4 a[252:255], v250, s[20:23], s57 offen nt
    v_mfma_f32_16x16x32_bf16 v[228:231], a[184:187], a[240:243], v[228:231]
    v_exp_f32 v210, v210
L_h8:
    s_cbranch_execz L_hback
    v_mfma_f32_16x16x32_bf16 v[228:231], a[188:191], a[244:247], v[228:231]
    ds_read_b128 a[252:255], v252 offset:12288
    v_cndmask_b32 v209, v244, v209, vcc
    v_mfma_f32_16x16x32_bf16 v[232:235], a[192:195], a[224:227], 0
    ds_read_b128 a[224:227], v242 offset:18560
    v_mov_b32 v208, 0x237c0
    v_mfma_f32_16x16x32_bf16 v[232:235], a[196:199], a[228:231], v[232:235]
    ds_read_b128 a[228:231], v243 offset:18560
    v_mov_b32 v186, 0
    v_mfma_f32_16x16x32_bf16 v[232:235], a[200:203], a[232:235], v[232:235]
    ds_read_b128 a[232:235], v242 offset:18688
    v_cvt_pk_bf16_f32 v228, v228, v229
    v_mfma_f32_16x16x32_bf16 v[232:235], a[204:207], a[236:239], v[232:235]
    ds_read_b128 a[236:239], v243 offset:18688
    v_cvt_pk_bf16_f32 v229, v230, v231
    v_mfma_f32_16x16x32_bf16 v[232:235], a[208:211], a[240:243], v[232:235]
    ds_write_b64 v249, v[228:229] offset:24704
    v_mfma_f32_16x16x32_bf16 v[232:235], a[212:215], a[244:247], v[232:235]
    buffer_store_dwordx2 v[254:255], v251, s[20:23], s57 offen offset:256 nt
    v_mfma_f32_16x16x32_bf16 v[236:239], a[144:147], a[216:219], 0
    ds_read_b64 v[254:255], v253 offset:12544
    v_mov_b32 v189, 0
    v_mfma_f32_16x16x32_bf16 v[236:239], a[148:151], a[220:223], v[236:239]
    ds_read_b128 a[240:243], v242 offset:0
    ds_read_b128 a[244:247], v243 offset:0
    v_mfma_f32_16x16x32_bf16 v[228:231], a[168:171], a[216:219], 0
    s_waitcnt lgkmcnt(7)
    v_cvt_pk_bf16_f32 v232, v232, v233
    v_cvt_pk_bf16_f32 v233, v234, v235
    v_mfma_f32_16x16x32_bf16 v[204:207], v[144:147], v[174:177], v[204:207]
    ds_write_b64 v249, v[232:233] offset:24832
    v_mfma_f32_16x16x32_bf16 v[204:207], v[146:149], v[176:179], v[204:207]
    s_mov_b32 vcc_lo, 0xff00ff00
    v_exp_f32 v211, v211
    v_mfma_f32_16x16x32_bf16 v[236:239], a[152:155], a[224:227], v[236:239]
    s_waitcnt lgkmcnt(7)
    v_exp_f32 v200, v200
    v_mfma_f32_16x16x32_bf16 v[236:239], a[156:159], a[228:231], v[236:239]
    s_waitcnt lgkmcnt(6)
    v_exp_f32 v201, v201
    v_mfma_f32_16x16x32_bf16 v[236:239], a[160:163], a[232:235], v[236:239]
    s_waitcnt lgkmcnt(5)
    v_exp_f32 v204, v204
    v_mfma_f32_16x16x32_bf16 v[236:239], a[164:167], a[236:239], v[236:239]
    s_mov_b32 vcc_hi, 0xff00ff00
    v_exp_f32 v205, v205
    v_mfma_f32_16x16x32_bf16 v[228:231], a[172:175], a[220:223], v[228:231]
    s_mul_i32 s57, s31, 7
    v_cvt_pk_bf16_f32 v192, v210, v211
    v_cvt_pk_bf16_f32 v194, v200, v201
    v_mfma_f32_16x16x32_bf16 v[228:231], a[176:179], a[224:227], v[228:231]
    s_add_u32 s56, s56, s57
    v_cvt_pk_bf16_f32 v236, v236, v237
    v_cvt_pk_bf16_f32 v237, v238, v239
    v_mfma_f32_16x16x32_bf16 v[228:231], a[180:183], a[228:231], v[228:231]
    s_add_u32 s56, s56, s32
    v_cvt_pk_bf16_f32 v195, v204, v205
    v_add_u32 v210, 0xc0, v209
    v_mfma_f32_16x16x32_bf16 v[228:231], a[184:187], a[232:235], v[228:231]
    ds_read_b64 v[174:175], v247 offset:55296
    v_add_u32 v209, 0x340, v209
    v_mfma_f32_16x16x32_bf16 v[212:215], v[22:25], v[192:195], v[212:215]
    s_waitcnt lgkmcnt(4)
    v_cndmask_b32 v244, v210, v209, vcc
    v_add_u32 v245, 0x700, v244
    v_mfma_f32_16x16x32_bf16 v[216:219], v[52:55], v[192:195], v[216:219]
    s_mov_b32 vcc_lo, 0xf0f0
    v_exp_f32 v202, v202
    v_mfma_f32_16x16x32_bf16 v[220:223], v[82:85], v[192:195], v[220:223]
    s_mov_b32 vcc_hi, 0x0
    v_exp_f32 v203, v203
    v_mfma_f32_16x16x32_bf16 v[224:227], a[248:251], v[192:195], v[224:227]
    s_waitcnt lgkmcnt(1)
    s_barrier
    v_cndmask_b32 v244, v244, v208, vcc
    v_mfma_f32_16x16x32_bf16 v[228:231], a[188:191], a[236:239], v[228:231]
    ds_write_b64 v249, v[236:237] offset:0
    v_mfma_f32_16x16x32_bf16 v[232:235], a[192:195], a[216:219], 0
    ds_read_b128 a[216:219], v242 offset:128
    v_cvt_pk_bf16_f32 v181, v202, v203
    v_mfma_f32_16x16x32_bf16 v[232:235], a[196:199], a[220:223], v[232:235]
    ds_read_b128 a[220:223], v243 offset:128
    v_mov_b32 v192, 0
    v_mfma_f32_16x16x32_bf16 v[232:235], a[200:203], a[224:227], v[232:235]
    ds_read_b128 a[224:227], v242 offset:256
    v_cvt_pk_bf16_f32 v228, v228, v229
    v_mfma_f32_16x16x32_bf16 v[232:235], a[204:207], a[228:231], v[232:235]
    ds_read_b128 a[228:231], v243 offset:256
    v_cvt_pk_bf16_f32 v229, v230, v231
    v_mfma_f32_16x16x32_bf16 v[232:235], a[208:211], a[232:235], v[232:235]
    ds_write_b64 v249, v[228:229] offset:128
    v_mfma_f32_16x16x32_bf16 v[232:235], a[212:215], a[236:239], v[232:235]
    s_mov_b32 vcc_lo, 0x0
    v_exp_f32 v196, v196
    v_mfma_f32_16x16x32_bf16 v[236:239], a[144:147], a[240:243], 0
    s_mov_b32 vcc_hi, 0xf0f0000
    v_cndmask_b32 v245, v245, v208, vcc
    v_mov_b32 v195, 0
    v_mfma_f32_16x16x32_bf16 v[236:239], a[148:151], a[244:247], v[236:239]
    ds_read_b128 v[208:211], v244 offset:0
    v_cvt_pk_bf16_f32 v232, v232, v233
    v_mfma_f32_16x16x32_bf16 v[228:231], a[168:171], a[240:243], 0
    s_waitcnt lgkmcnt(5)
    v_exp_f32 v197, v197
    v_mfma_f32_16x16x32_bf16 v[236:239], a[152:155], a[216:219], v[236:239]
    s_waitcnt lgkmcnt(4)
    v_cvt_pk_bf16_f32 v233, v234, v235
    v_cvt_pk_bf16_f32 v180, v196, v197
    v_mfma_f32_16x16x32_bf16 v[236:239], a[156:159], a[220:223], v[236:239]
    s_waitcnt lgkmcnt(3)
    v_exp_f32 v198, v198
    v_mfma_f32_16x16x32_bf16 v[236:239], a[160:163], a[224:227], v[236:239]
    s_waitcnt lgkmcnt(2)
    v_exp_f32 v199, v199
    v_mfma_f32_16x16x32_bf16 v[236:239], a[164:167], a[228:231], v[236:239]
    ds_read_b128 v[200:203], v244 offset:64
    v_cvt_pk_bf16_f32 v183, v198, v199
    v_mfma_f32_16x16x32_bf16 v[228:231], a[172:175], a[244:247], v[228:231]
    ds_write_b64 v249, v[232:233] offset:256
    v_mfma_f32_16x16x32_bf16 v[228:231], a[176:179], a[216:219], v[228:231]
    s_mov_b32 vcc_lo, 0xff000f
    v_exp_f32 v206, v206
    v_mfma_f32_16x16x32_bf16 v[228:231], a[180:183], a[220:223], v[228:231]
    s_mov_b32 vcc_hi, 0xff00ff
    v_exp_f32 v207, v207
    v_mfma_f32_16x16x32_bf16 v[228:231], a[184:187], a[224:227], v[228:231]
    ds_read_b128 v[196:199], v245 offset:0
    v_cvt_pk_bf16_f32 v182, v206, v207
    v_mfma_f32_16x16x32_bf16 v[228:231], a[188:191], a[228:231], v[228:231]
    ds_read_b128 v[204:207], v245 offset:64
    v_cvt_pk_bf16_f32 v236, v236, v237
    v_mfma_f32_16x16x32_bf16 v[212:215], v[26:29], v[180:183], v[212:215]
    ds_read_b128 a[232:235], v242 offset:24576
    v_cvt_pk_bf16_f32 v237, v238, v239
    v_mfma_f32_16x16x32_bf16 v[216:219], v[56:59], v[180:183], v[216:219]
    ds_read_b128 a[236:239], v243 offset:24576
    ds_read_b64 v[176:177], v247 offset:55424
    v_mfma_f32_16x16x32_bf16 v[220:223], v[86:89], v[180:183], v[220:223]
    s_waitcnt lgkmcnt(7)
    v_cvt_pk_bf16_f32 v228, v228, v229
    v_cvt_pk_bf16_f32 v229, v230, v231
    v_mfma_f32_16x16x32_bf16 v[224:227], a[248:251], v[180:183], v[224:227]
    ds_write_b64 v249, v[236:237] offset:6144
    v_mfma_f32_16x16x32_bf16 v[208:211], v[90:93], v[168:171], v[208:211]
    ds_write_b64 v249, v[228:229] offset:6272
    v_mfma_f32_16x16x32_bf16 v[208:211], v[92:95], v[170:173], v[208:211]
    buffer_store_dwordx4 a[252:255], v250, s[20:23], s52 offen nt
    v_mfma_f32_16x16x32_bf16 v[232:235], a[192:195], a[240:243], 0
    s_waitcnt lgkmcnt(8)
    ds_read_b128 a[240:243], v242 offset:24704
    v_mfma_f32_16x16x32_bf16 v[200:203], v[96:99], v[168:171], v[200:203]
    s_add_u32 s57, s28, 11
    v_rcp_f32 v225, v224
    v_mfma_f32_16x16x32_bf16 v[200:203], v[98:101], v[170:173], v[200:203]
    s_mul_i32 s57, s57, s30
    v_exp_f32 v208, v208
    v_mfma_f32_16x16x32_bf16 v[232:235], a[196:199], a[244:247], v[232:235]
    s_waitcnt lgkmcnt(7)
    ds_read_b128 a[244:247], v243 offset:24704
    v_mfma_f32_16x16x32_bf16 v[196:199], v[126:129], v[168:171], v[196:199]
    v_exp_f32 v209, v209
    v_mfma_f32_16x16x32_bf16 v[196:199], v[128:131], v[170:173], v[196:199]
    s_waitcnt lgkmcnt(7)
    v_exp_f32 v210, v210
    v_mfma_f32_16x16x32_bf16 v[204:207], v[132:135], v[168:171], v[204:207]
    s_waitcnt lgkmcnt(6)
    v_exp_f32 v211, v211
    v_mfma_f32_16x16x32_bf16 v[204:207], v[134:137], v[170:173], v[204:207]
    v_cvt_pk_bf16_f32 v184, v208, v209
    v_cvt_pk_bf16_f32 v187, v210, v211
    v_mfma_f32_16x16x32_bf16 v[232:235], a[200:203], a[216:219], v[232:235]
    ds_read_b128 a[216:219], v242 offset:24832
    v_mul_f32 v212, v212, v225
    v_mfma_f32_16x16x32_bf16 v[232:235], a[204:207], a[220:223], v[232:235]
    ds_read_b128 a[220:223], v243 offset:24832
    v_mul_f32 v213, v213, v225
    v_mfma_f32_16x16x32_bf16 v[232:235], a[208:211], a[224:227], v[232:235]
    ds_read_b128 v[208:211], v244 offset:128
    v_mul_f32 v214, v214, v225
    v_mfma_f32_16x16x32_bf16 v[232:235], a[212:215], a[228:231], v[232:235]
    v_exp_f32 v196, v196
    v_mfma_f32_16x16x32_bf16 v[236:239], a[144:147], a[232:235], 0
    s_waitcnt lgkmcnt(5)
    v_exp_f32 v197, v197
    v_mfma_f32_16x16x32_bf16 v[236:239], a[148:151], a[236:239], v[236:239]
    s_waitcnt lgkmcnt(4)
    v_cvt_pk_bf16_f32 v185, v196, v197
    v_mul_f32 v215, v215, v225
    v_mfma_f32_16x16x32_bf16 v[236:239], a[152:155], a[240:243], v[236:239]
    s_waitcnt lgkmcnt(3)
    v_cvt_pk_bf16_f32 v212, v212, v213
    v_cvt_pk_bf16_f32 v213, v214, v215
    v_mfma_f32_16x16x32_bf16 v[236:239], a[156:159], a[244:247], v[236:239]
    ds_write_b64 v247, v[212:213] offset:43008
    v_mfma_f32_16x16x32_bf16 v[212:215], v[0:3], v[184:187], 0
    s_waitcnt lgkmcnt(3)
    v_mul_f32 v216, v216, v225
    v_mul_f32 v217, v217, v225
    v_mfma_f32_16x16x32_bf16 v[236:239], a[160:163], a[216:219], v[236:239]
    s_waitcnt lgkmcnt(2)
    v_mul_f32 v218, v218, v225
    v_mul_f32 v219, v219, v225
    v_mfma_f32_16x16x32_bf16 v[236:239], a[164:167], a[220:223], v[236:239]
    ds_read_b128 a[224:227], v242 offset:30720
    v_cvt_pk_bf16_f32 v216, v216, v217
    v_mfma_f32_16x16x32_bf16 v[228:231], a[168:171], a[232:235], 0
    v_cvt_pk_bf16_f32 v217, v218, v219
    v_cvt_pk_bf16_f32 v232, v232, v233
    v_mfma_f32_16x16x32_bf16 v[228:231], a[172:175], a[236:239], v[228:231]
    ds_write_b64 v247, v[216:217] offset:43136
    v_mfma_f32_16x16x32_bf16 v[216:219], v[30:33], v[184:187], 0
    ds_read_b128 a[228:231], v243 offset:30720
    v_cvt_pk_bf16_f32 v233, v234, v235
    v_mfma_f32_16x16x32_bf16 v[228:231], a[176:179], a[240:243], v[228:231]
    ds_write_b64 v249, v[232:233] offset:6400
    v_mfma_f32_16x16x32_bf16 v[228:231], a[180:183], a[244:247], v[228:231]
    s_waitcnt lgkmcnt(5)
    v_mul_f32 v220, v220, v225
    v_mul_f32 v221, v221, v225
    v_mfma_f32_16x16x32_bf16 v[208:211], v[162:165], v[168:171], v[208:211]
    v_mul_f32 v222, v222, v225
    v_mul_f32 v223, v223, v225
    v_mfma_f32_16x16x32_bf16 v[208:211], v[164:167], v[170:173], v[208:211]
    v_cvt_pk_bf16_f32 v220, v220, v221
    v_cvt_pk_bf16_f32 v221, v222, v223
    v_mfma_f32_16x16x32_bf16 v[228:231], a[184:187], a[216:219], v[228:231]
    ds_write_b64 v247, v[220:221] offset:43264
    v_mfma_f32_16x16x32_bf16 v[220:223], v[60:63], v[184:187], 0
    v_max3_f32 v248, v248, v224, v225
    v_cvt_pk_bf16_f32 v236, v236, v237
    v_mfma_f32_16x16x32_bf16 v[224:227], a[248:251], v[184:187], 0
    v_exp_f32 v198, v198
    v_mfma_f32_16x16x32_bf16 v[228:231], a[188:191], a[220:223], v[228:231]
    v_exp_f32 v199, v199
    v_mfma_f32_16x16x32_bf16 v[232:235], a[192:195], a[232:235], 0
    ds_read_b128 a[232:235], v242 offset:30848
    v_cvt_pk_bf16_f32 v188, v198, v199
    v_mfma_f32_16x16x32_bf16 v[232:235], a[196:199], a[236:239], v[232:235]
    ds_read_b128 a[236:239], v243 offset:30848
    ds_read_b128 v[196:199], v245 offset:128
    v_mfma_f32_16x16x32_bf16 v[232:235], a[200:203], a[240:243], v[232:235]
    ds_read_b128 a[240:243], v242 offset:30976
    v_cvt_pk_bf16_f32 v237, v238, v239
    v_mfma_f32_16x16x32_bf16 v[232:235], a[204:207], a[244:247], v[232:235]
    ds_read_b128 a[244:247], v243 offset:30976
    v_cvt_pk_bf16_f32 v228, v228, v229
    v_mfma_f32_16x16x32_bf16 v[232:235], a[208:211], a[216:219], v[232:235]
    ds_write_b64 v249, v[236:237] offset:12288
    v_mfma_f32_16x16x32_bf16 v[232:235], a[212:215], a[220:223], v[232:235]
    s_waitcnt lgkmcnt(7)
    v_cvt_pk_bf16_f32 v229, v230, v231
    v_mov_b32 v182, 0
    v_mfma_f32_16x16x32_bf16 v[236:239], a[144:147], a[224:227], 0
    ds_write_b64 v249, v[228:229] offset:12416
    v_mfma_f32_16x16x32_bf16 v[236:239], a[148:151], a[228:231], v[236:239]
    v_exp_f32 v200, v200
    v_mfma_f32_16x16x32_bf16 v[228:231], a[168:171], a[224:227], 0
    s_waitcnt lgkmcnt(6)
    v_exp_f32 v201, v201
    v_mfma_f32_16x16x32_bf16 v[236:239], a[152:155], a[232:235], v[236:239]
    s_waitcnt lgkmcnt(5)
    v_exp_f32 v204, v204
    v_mfma_f32_16x16x32_bf16 v[236:239], a[156:159], a[236:239], v[236:239]
    s_waitcnt lgkmcnt(4)
    v_exp_f32 v205, v205
    v_mfma_f32_16x16x32_bf16 v[196:199], v[102:105], v[168:171], v[196:199]
    s_waitcnt lgkmcnt(3)
    v_cvt_pk_bf16_f32 v190, v200, v201
    v_cvt_pk_bf16_f32 v191, v204, v205
    v_mfma_f32_16x16x32_bf16 v[196:199], v[104:107], v[170:173], v[196:199]
    v_exp_f32 v202, v202
    v_mfma_f32_16x16x32_bf16 v[212:215], v[4:7], v[188:191], v[212:215]
    v_exp_f32 v203, v203
    v_mfma_f32_16x16x32_bf16 v[216:219], v[34:37], v[188:191], v[216:219]
    v_cvt_pk_bf16_f32 v193, v202, v203
    v_cvt_pk_bf16_f32 v232, v232, v233
    v_mfma_f32_16x16x32_bf16 v[220:223], v[64:67], v[188:191], v[220:223]
    ds_read_b128 v[200:203], v244 offset:192
    v_cvt_pk_bf16_f32 v233, v234, v235
    v_mfma_f32_16x16x32_bf16 v[224:227], a[248:251], v[188:191], v[224:227]
    v_exp_f32 v206, v206
    v_mfma_f32_16x16x32_bf16 v[236:239], a[160:163], a[240:243], v[236:239]
    s_waitcnt lgkmcnt(3)
    v_exp_f32 v207, v207
    v_mfma_f32_16x16x32_bf16 v[236:239], a[164:167], a[244:247], v[236:239]
    ds_read_b128 a[252:255], v252 offset:18432
    v_cvt_pk_bf16_f32 v194, v206, v207
    v_mfma_f32_16x16x32_bf16 v[228:231], a[172:175], a[228:231], v[228:231]
    ds_read_b128 v[204:207], v245 offset:192
    v_mov_b32 v185, 0
    v_mfma_f32_16x16x32_bf16 v[212:215], v[8:11], v[192:195], v[212:215]
    ds_write_b64 v249, v[232:233] offset:12544
    v_mfma_f32_16x16x32_bf16 v[216:219], v[38:41], v[192:195], v[216:219]
    buffer_store_dwordx2 v[254:255], v251, s[20:23], s52 offen offset:256 nt
    v_mfma_f32_16x16x32_bf16 v[220:223], v[68:71], v[192:195], v[220:223]
    ds_read_b64 v[254:255], v253 offset:18688
    v_cvt_pk_bf16_f32 v236, v236, v237
    v_mfma_f32_16x16x32_bf16 v[224:227], a[248:251], v[192:195], v[224:227]
    s_mul_i32 s52, s31, 11
    v_exp_f32 v208, v208
    v_mfma_f32_16x16x32_bf16 v[228:231], a[176:179], a[232:235], v[228:231]
    s_add_u32 s51, s51, s52
    v_exp_f32 v209, v209
    v_mfma_f32_16x16x32_bf16 v[228:231], a[180:183], a[236:239], v[228:231]
    ds_read_b64 v[178:179], v247 offset:55552
    v_cvt_pk_bf16_f32 v180, v208, v209
    v_mfma_f32_16x16x32_bf16 v[228:231], a[184:187], a[240:243], v[228:231]
    s_waitcnt lgkmcnt(5)
    v_add_u32 v208, 0xffffff40, v244
    v_cndmask_b32 v244, v244, v208, vcc
    v_mfma_f32_16x16x32_bf16 v[200:203], v[114:117], v[168:171], v[200:203]
    s_mov_b32 vcc_lo, 0xff00ff
    v_exp_f32 v210, v210
    v_mfma_f32_16x16x32_bf16 v[200:203], v[116:119], v[170:173], v[200:203]
    s_mov_b32 vcc_hi, 0xf000ff
    v_exp_f32 v211, v211
    v_mfma_f32_16x16x32_bf16 v[228:231], a[188:191], a[244:247], v[228:231]
    s_add_u32 s51, s51, s32
    v_add_u32 v209, 0xffffff40, v245
    v_cvt_pk_bf16_f32 v183, v210, v211
    v_mfma_f32_16x16x32_bf16 v[232:235], a[192:195], a[224:227], 0
    ds_read_b128 a[216:219], v242 offset:36864
    v_cndmask_b32 v245, v245, v209, vcc
    v_mfma_f32_16x16x32_bf16 v[232:235], a[196:199], a[228:231], v[232:235]
    s_waitcnt lgkmcnt(4)
    v_exp_f32 v200, v200
    v_mfma_f32_16x16x32_bf16 v[204:207], v[138:141], v[168:171], v[204:207]
    s_add_u32 s52, s28, 11
    v_exp_f32 v201, v201
    v_mfma_f32_16x16x32_bf16 v[204:207], v[140:143], v[170:173], v[204:207]
    ds_read_b128 v[208:211], v244 offset:0
    v_cvt_pk_bf16_f32 v186, v200, v201
    v_mfma_f32_16x16x32_bf16 v[232:235], a[200:203], a[232:235], v[232:235]
    ds_read_b128 v[200:203], v244 offset:64
    v_cvt_pk_bf16_f32 v237, v238, v239
    v_mfma_f32_16x16x32_bf16 v[232:235], a[204:207], a[236:239], v[232:235]
    s_mul_i32 s52, s52, s30
    v_exp_f32 v196, v196
    v_mfma_f32_16x16x32_bf16 v[232:235], a[208:211], a[240:243], v[232:235]
    s_waitcnt lgkmcnt(4)
    v_exp_f32 v197, v197
    v_mfma_f32_16x16x32_bf16 v[232:235], a[212:215], a[244:247], v[232:235]
    v_cvt_pk_bf16_f32 v181, v196, v197
    v_cvt_pk_bf16_f32 v228, v228, v229
    buffer_store_dwordx4 a[252:255], v250, s[20:23], s54 offen nt
    v_mfma_f32_16x16x32_bf16 v[212:215], v[12:15], v[180:183], v[212:215]
    v_exp_f32 v198, v198
    v_mfma_f32_16x16x32_bf16 v[216:219], v[42:45], v[180:183], v[216:219]
    ds_read_b128 a[252:255], v252 offset:24576
    v_cvt_pk_bf16_f32 v229, v230, v231
    v_mfma_f32_16x16x32_bf16 v[220:223], v[72:75], v[180:183], v[220:223]
    buffer_store_dwordx2 v[254:255], v251, s[20:23], s54 offen offset:256 nt
    v_mfma_f32_16x16x32_bf16 v[224:227], a[248:251], v[180:183], v[224:227]
    s_waitcnt lgkmcnt(1)
    ds_read_b64 v[254:255], v253 offset:24832
    v_mfma_f32_16x16x32_bf16 v[208:211], v[162:165], v[174:177], v[208:211]
    s_mul_i32 s54, s31, 15
    v_exp_f32 v199, v199
    v_mfma_f32_16x16x32_bf16 v[208:211], v[164:167], v[176:179], v[208:211]
    ds_read_b128 a[220:223], v243 offset:36864
    v_cvt_pk_bf16_f32 v184, v198, v199
    v_mfma_f32_16x16x32_bf16 v[200:203], v[114:117], v[174:177], v[200:203]
    ds_read_b128 v[196:199], v245 offset:0
    ds_read_b128 a[224:227], v242 offset:36992
    v_mfma_f32_16x16x32_bf16 v[200:203], v[116:119], v[176:179], v[200:203]
    v_exp_f32 v204, v204
    v_exp_f32 v205, v205
    ds_read_b128 a[228:231], v243 offset:36992
    v_cvt_pk_bf16_f32 v187, v204, v205
    ds_read_b128 v[204:207], v245 offset:64
    ds_read_b128 a[232:235], v242 offset:37120
    v_mfma_f32_16x16x32_bf16 v[212:215], v[16:19], v[184:187], v[212:215]
    ds_read_b128 a[236:239], v243 offset:37120
    v_cvt_pk_bf16_f32 v232, v232, v233
    v_mfma_f32_16x16x32_bf16 v[216:219], v[46:49], v[184:187], v[216:219]
    s_waitcnt lgkmcnt(7)
    s_barrier
    v_cvt_pk_bf16_f32 v233, v234, v235
    v_mfma_f32_16x16x32_bf16 v[220:223], v[76:79], v[184:187], v[220:223]
    ds_write_b64 v249, v[236:237] offset:18432
    v_mfma_f32_16x16x32_bf16 v[224:227], a[248:251], v[184:187], v[224:227]
    ds_write_b64 v249, v[228:229] offset:18560
    v_mfma_f32_16x16x32_bf16 v[236:239], a[144:147], a[216:219], 0
    s_waitcnt lgkmcnt(7)
    v_exp_f32 v208, v208
    v_mfma_f32_16x16x32_bf16 v[196:199], v[102:105], v[174:177], v[196:199]
    s_add_u32 s53, s53, s54
    v_exp_f32 v209, v209
    v_mfma_f32_16x16x32_bf16 v[196:199], v[104:107], v[176:179], v[196:199]
    s_add_u32 s53, s53, s32
    v_exp_f32 v210, v210
    v_mfma_f32_16x16x32_bf16 v[236:239], a[148:151], a[220:223], v[236:239]
    s_waitcnt lgkmcnt(4)
    v_exp_f32 v211, v211
    v_mfma_f32_16x16x32_bf16 v[204:207], v[138:141], v[174:177], v[204:207]
    s_add_u32 s54, s28, 11
    v_cvt_pk_bf16_f32 v188, v208, v209
    v_cvt_pk_bf16_f32 v191, v210, v211
    v_mfma_f32_16x16x32_bf16 v[204:207], v[140:143], v[176:179], v[204:207]
    ds_read_b128 v[208:211], v244 offset:128
    v_mov_b32 v190, 0
    v_mfma_f32_16x16x32_bf16 v[236:239], a[152:155], a[224:227], v[236:239]
    buffer_store_dwordx4 a[252:255], v250, s[20:23], s56 offen nt
    v_mfma_f32_16x16x32_bf16 v[236:239], a[156:159], a[228:231], v[236:239]
    s_waitcnt lgkmcnt(4)
    v_exp_f32 v196, v196
    v_mfma_f32_16x16x32_bf16 v[236:239], a[160:163], a[232:235], v[236:239]
    s_waitcnt lgkmcnt(3)
    ds_read_b128 a[252:255], v252 offset:0
    v_mfma_f32_16x16x32_bf16 v[236:239], a[164:167], a[236:239], v[236:239]
    ds_write_b64 v249, v[232:233] offset:18688
    v_mfma_f32_16x16x32_bf16 v[228:231], a[168:171], a[216:219], 0
    s_mul_i32 s54, s54, s30
    v_exp_f32 v197, v197
    v_mfma_f32_16x16x32_bf16 v[228:231], a[172:175], a[220:223], v[228:231]
    v_exp_f32 v198, v198
    v_mfma_f32_16x16x32_bf16 v[228:231], a[176:179], a[224:227], v[228:231]
    v_exp_f32 v199, v199
    v_mfma_f32_16x16x32_bf16 v[228:231], a[180:183], a[228:231], v[228:231]
    v_cvt_pk_bf16_f32 v189, v196, v197
    v_cvt_pk_bf16_f32 v192, v198, v199
    v_mfma_f32_16x16x32_bf16 v[228:231], a[184:187], a[232:235], v[228:231]
    ds_read_b128 v[196:199], v245 offset:128
    v_cvt_pk_bf16_f32 v236, v236, v237
    v_mfma_f32_16x16x32_bf16 v[228:231], a[188:191], a[236:239], v[228:231]
    ds_read_b128 a[240:243], v242 offset:43008
    v_cvt_pk_bf16_f32 v237, v238, v239
    v_mfma_f32_16x16x32_bf16 v[232:235], a[192:195], a[216:219], 0
    ds_read_b128 a[244:247], v243 offset:43008
    v_mov_b32 v193, 0
    v_mfma_f32_16x16x32_bf16 v[232:235], a[196:199], a[220:223], v[232:235]
    s_waitcnt lgkmcnt(5)
    v_rcp_f32 v225, v224
    v_mfma_f32_16x16x32_bf16 v[208:211], v[120:123], v[174:177], v[208:211]
    buffer_store_dwordx2 v[254:255], v251, s[20:23], s56 offen offset:256 nt
    v_mfma_f32_16x16x32_bf16 v[208:211], v[122:125], v[176:179], v[208:211]
    s_waitcnt lgkmcnt(4)
    v_mul_f32 v212, v212, v225
    v_mul_f32 v213, v213, v225
    v_mfma_f32_16x16x32_bf16 v[232:235], a[200:203], a[224:227], v[232:235]
    s_mul_i32 s56, s31, 13
    v_mul_f32 v214, v214, v225
    v_mul_f32 v215, v215, v225
    v_mfma_f32_16x16x32_bf16 v[232:235], a[204:207], a[228:231], v[232:235]
    ds_read_b64 v[254:255], v253 offset:256
    v_cvt_pk_bf16_f32 v212, v212, v213
    v_mfma_f32_16x16x32_bf16 v[232:235], a[208:211], a[232:235], v[232:235]
    buffer_store_dwordx4 a[252:255], v250, s[20:23], s51 offen nt
    v_mfma_f32_16x16x32_bf16 v[232:235], a[212:215], a[236:239], v[232:235]
    s_waitcnt lgkmcnt(3)
    ds_read_b128 a[252:255], v252 offset:6144
    v_mfma_f32_16x16x32_bf16 v[196:199], v[144:147], v[174:177], v[196:199]
    s_add_u32 s55, s55, s56
    v_cvt_pk_bf16_f32 v213, v214, v215
    v_mul_f32 v216, v216, v225
    v_mfma_f32_16x16x32_bf16 v[196:199], v[146:149], v[176:179], v[196:199]
    ds_write_b64 v247, v[212:213] offset:49152
    v_mfma_f32_16x16x32_bf16 v[212:215], v[12:15], v[188:191], 0
    v_mul_f32 v217, v217, v225
    v_mul_f32 v218, v218, v225
    v_mul_f32 v219, v219, v225
    v_cvt_pk_bf16_f32 v216, v216, v217
    v_cvt_pk_bf16_f32 v217, v218, v219
    ds_write_b64 v247, v[216:217] offset:49280
    v_mfma_f32_16x16x32_bf16 v[216:219], v[42:45], v[188:191], 0
    v_mul_f32 v220, v220, v225
    v_mul_f32 v221, v221, v225
    v_mul_f32 v222, v222, v225
    v_mul_f32 v223, v223, v225
    v_cvt_pk_bf16_f32 v220, v220, v221
    v_cvt_pk_bf16_f32 v221, v222, v223
    ds_write_b64 v247, v[220:221] offset:49408
    v_mfma_f32_16x16x32_bf16 v[220:223], v[72:75], v[188:191], 0
    ds_read_b128 a[216:219], v242 offset:43136
    ds_read_b128 a[220:223], v243 offset:43136
    v_max3_f32 v248, v248, v224, v225
    v_mfma_f32_16x16x32_bf16 v[224:227], a[248:251], v[188:191], 0
    ds_write_b64 v249, v[236:237] offset:24576
    s_waitcnt lgkmcnt(6)
    v_mfma_f32_16x16x32_bf16 v[236:239], a[144:147], a[240:243], 0
    s_add_u32 s55, s55, s32
    v_exp_f32 v200, v200
    v_mfma_f32_16x16x32_bf16 v[236:239], a[148:151], a[244:247], v[236:239]
    v_exp_f32 v201, v201
    v_exp_f32 v204, v204
    v_exp_f32 v205, v205
    v_cvt_pk_bf16_f32 v194, v200, v201
    v_cvt_pk_bf16_f32 v195, v204, v205
    s_mov_b32 exec_hi, 0
    buffer_store_dwordx4 a[252:255], v250, s[20:23], s53 offen nt
    s_mov_b32 exec_hi, -1
    ds_read_b128 a[224:227], v242 offset:43264
    v_mfma_f32_16x16x32_bf16 v[212:215], v[16:19], v[192:195], v[212:215]
    s_add_u32 s56, s28, 11
    v_cvt_pk_bf16_f32 v228, v228, v229
    v_cvt_pk_bf16_f32 v232, v232, v233
    v_mfma_f32_16x16x32_bf16 v[216:219], v[46:49], v[192:195], v[216:219]
    s_waitcnt lgkmcnt(3)
    v_cvt_pk_bf16_f32 v229, v230, v231
    v_cvt_pk_bf16_f32 v233, v234, v235
    v_mfma_f32_16x16x32_bf16 v[220:223], v[76:79], v[192:195], v[220:223]
    s_mov_b32 exec_lo, 0
    buffer_store_dwordx4 a[252:255], v250, s[20:23], s55 offen nt
    s_mov_b32 exec_lo, -1
    v_mfma_f32_16x16x32_bf16 v[224:227], a[248:251], v[192:195], v[224:227]
    ds_write_b64 v249, v[228:229] offset:24704
    v_mfma_f32_16x16x32_bf16 v[236:239], a[152:155], a[216:219], v[236:239]
    ds_read_b128 a[252:255], v252 offset:12288
    s_waitcnt lgkmcnt(4)
    v_mfma_f32_16x16x32_bf16 v[236:239], a[156:159], a[220:223], v[236:239]
    buffer_store_dwordx2 v[254:255], v251, s[20:23], s51 offen offset:256 nt
    v_mfma_f32_16x16x32_bf16 v[228:231], a[168:171], a[240:243], 0
    ds_read_b64 v[254:255], v253 offset:6400
    ds_read_b128 a[228:231], v243 offset:43264
    v_mfma_f32_16x16x32_bf16 v[228:231], a[172:175], a[244:247], v[228:231]
    ds_write_b64 v249, v[232:233] offset:24832
    v_mfma_f32_16x16x32_bf16 v[228:231], a[176:179], a[216:219], v[228:231]
    s_waitcnt lgkmcnt(5)
    v_exp_f32 v202, v202
    v_mfma_f32_16x16x32_bf16 v[236:239], a[160:163], a[224:227], v[236:239]
    s_mul_i32 s51, s31, 3
    v_exp_f32 v203, v203
    v_mfma_f32_16x16x32_bf16 v[228:231], a[180:183], a[220:223], v[228:231]
    s_add_u32 s57, s57, s51
    v_exp_f32 v206, v206
    v_mfma_f32_16x16x32_bf16 v[228:231], a[184:187], a[224:227], v[228:231]
    s_add_u32 s57, s57, s32
    v_exp_f32 v207, v207
    v_mfma_f32_16x16x32_bf16 v[232:235], a[192:195], a[240:243], 0
    s_mul_i32 s56, s56, s30
    v_cvt_pk_bf16_f32 v181, v202, v203
    v_cvt_pk_bf16_f32 v182, v206, v207
    v_mfma_f32_16x16x32_bf16 v[232:235], a[196:199], a[244:247], v[232:235]
    s_and_b32 s51, s28, 1
    v_mov_b32 v180, 0
    v_mov_b32 v183, 0
    v_mfma_f32_16x16x32_bf16 v[232:235], a[200:203], a[216:219], v[232:235]
    s_waitcnt lgkmcnt(2)
    v_exp_f32 v208, v208
    v_mfma_f32_16x16x32_bf16 v[212:215], v[20:23], v[180:183], v[212:215]
    s_mov_b32 exec_hi, 0
    buffer_store_dwordx2 v[254:255], v251, s[20:23], s53 offen offset:256 nt
    s_mov_b32 exec_hi, -1
    v_mfma_f32_16x16x32_bf16 v[216:219], v[50:53], v[180:183], v[216:219]
    s_waitcnt lgkmcnt(1)
    s_waitcnt lgkmcnt(0)
    s_barrier
    v_mfma_f32_16x16x32_bf16 v[220:223], v[80:83], v[180:183], v[220:223]
    ds_read_b128 a[232:235], v242 offset:49152
    ds_read_b128 a[236:239], v243 offset:49152
    v_mfma_f32_16x16x32_bf16 v[224:227], a[248:251], v[180:183], v[224:227]
    ds_read_b128 a[240:243], v242 offset:49280
    ds_read_b128 a[244:247], v243 offset:49280
    v_mfma_f32_16x16x32_bf16 v[236:239], a[164:167], a[228:231], v[236:239]
    s_mov_b32 exec_lo, 0
    buffer_store_dwordx2 v[254:255], v251, s[20:23], s55 offen offset:256 nt
    s_mov_b32 exec_lo, -1
    v_mfma_f32_16x16x32_bf16 v[228:231], a[188:191], a[228:231], v[228:231]
    ds_read_b64 v[254:255], v253 offset:12544
    ds_read_b128 a[216:219], v242 offset:49408
    v_mfma_f32_16x16x32_bf16 v[232:235], a[204:207], a[220:223], v[232:235]
    ds_read_b128 a[220:223], v243 offset:49408
    v_mov_b32 v186, 0
    v_mfma_f32_16x16x32_bf16 v[232:235], a[208:211], a[224:227], v[232:235]
    s_mul_i32 s53, s31, 7
    v_exp_f32 v209, v209
    v_mfma_f32_16x16x32_bf16 v[232:235], a[212:215], a[228:231], v[232:235]
    buffer_store_dwordx4 a[252:255], v250, s[20:23], s57 offen nt
    v_exp_f32 v210, v210
    v_exp_f32 v211, v211
    ds_read_b128 a[252:255], v252 offset:18432
    v_exp_f32 v196, v196
    v_exp_f32 v197, v197
    v_exp_f32 v198, v198
    v_exp_f32 v199, v199
    v_cvt_pk_bf16_f32 v184, v208, v209
    v_cvt_pk_bf16_f32 v187, v210, v211
    v_cvt_pk_bf16_f32 v185, v196, v197
    v_cvt_pk_bf16_f32 v188, v198, v199
    v_mov_b32 v189, 0
    v_mfma_f32_16x16x32_bf16 v[212:215], v[24:27], v[184:187], v[212:215]
    s_waitcnt lgkmcnt(3)
    v_mov_b32 v191, 0
    v_cvt_pk_bf16_f32 v236, v236, v237
    v_mfma_f32_16x16x32_bf16 v[216:219], v[54:57], v[184:187], v[216:219]
    s_add_u32 s52, s52, s53
    v_cvt_pk_bf16_f32 v228, v228, v229
    v_cvt_pk_bf16_f32 v232, v232, v233
    v_mfma_f32_16x16x32_bf16 v[220:223], v[84:87], v[184:187], v[220:223]
    buffer_store_dwordx2 v[254:255], v251, s[20:23], s57 offen offset:256 nt
    v_mfma_f32_16x16x32_bf16 v[224:227], a[248:251], v[184:187], v[224:227]
    s_add_u32 s52, s52, s32
    v_cvt_pk_bf16_f32 v237, v238, v239
    v_cvt_pk_bf16_f32 v229, v230, v231
    v_mfma_f32_16x16x32_bf16 v[212:215], v[28:31], v[188:191], v[212:215]
    ds_read_b64 v[254:255], v253 offset:18688
    v_cvt_pk_bf16_f32 v233, v234, v235
    v_mfma_f32_16x16x32_bf16 v[216:219], v[58:61], v[188:191], v[216:219]
    ds_write_b64 v249, v[236:237] offset:0
    v_mfma_f32_16x16x32_bf16 v[220:223], v[88:91], v[188:191], v[220:223]
    ds_write_b64 v249, v[228:229] offset:128
    v_mfma_f32_16x16x32_bf16 v[224:227], a[248:251], v[188:191], v[224:227]
    ds_write_b64 v249, v[232:233] offset:256
    v_mfma_f32_16x16x32_bf16 v[236:239], a[144:147], a[232:235], 0
    s_waitcnt lgkmcnt(4)
    s_mul_i32 s55, s31, 11
    s_add_u32 s54, s54, s55
    v_mfma_f32_16x16x32_bf16 v[236:239], a[148:151], a[236:239], v[236:239]
    buffer_store_dwordx4 a[252:255], v250, s[20:23], s52 offen nt
    v_mfma_f32_16x16x32_bf16 v[236:239], a[152:155], a[240:243], v[236:239]
    s_add_u32 s54, s54, s32
    v_rcp_f32 v225, v224
    v_mfma_f32_16x16x32_bf16 v[236:239], a[156:159], a[244:247], v[236:239]
L_h9:
    s_cbranch_execz L_hback
    s_waitcnt lgkmcnt(3)
    v_max3_f32 v248, v248, v224, v225
    v_mov_b32 v226, 0x5d800000
    v_mfma_f32_16x16x32_bf16 v[236:239], a[160:163], a[216:219], v[236:239]
    s_mul_i32 s57, s31, 15
    v_cmp_gt_f32 vcc, v248, v226
    v_mul_f32 v212, v212, v225
    v_mfma_f32_16x16x32_bf16 v[236:239], a[164:167], a[220:223], v[236:239]
    s_cmp_lg_u64 vcc, 0
    s_cselect_b32 s66, 1, 0
    v_mul_f32 v213, v213, v225
    v_mul_f32 v214, v214, v225
    v_mfma_f32_16x16x32_bf16 v[228:231], a[168:171], a[232:235], 0
    s_add_u32 s56, s56, s57
    v_mul_f32 v215, v215, v225
    v_cvt_pk_bf16_f32 v212, v212, v213
    v_mfma_f32_16x16x32_bf16 v[228:231], a[172:175], a[236:239], v[228:231]
    s_add_u32 s56, s56, s32
    v_mul_f32 v216, v216, v225
    v_mul_f32 v217, v217, v225
    v_mfma_f32_16x16x32_bf16 v[228:231], a[176:179], a[240:243], v[228:231]
    s_add_u32 s51, s51, 15
    v_cvt_pk_bf16_f32 v213, v214, v215
    v_mul_f32 v218, v218, v225
    v_mfma_f32_16x16x32_bf16 v[228:231], a[180:183], a[244:247], v[228:231]
    s_mul_i32 s51, s51, s30
    v_mul_f32 v219, v219, v225
    v_cvt_pk_bf16_f32 v216, v216, v217
    v_mfma_f32_16x16x32_bf16 v[228:231], a[184:187], a[216:219], v[228:231]
    s_lshr_b32 s55, s28, 1
    v_mul_f32 v220, v220, v225
    v_mul_f32 v221, v221, v225
    v_mfma_f32_16x16x32_bf16 v[228:231], a[188:191], a[220:223], v[228:231]
    ds_write_b64 v247, v[212:213] offset:55296
    v_mfma_f32_16x16x32_bf16 v[232:235], a[192:195], a[232:235], 0
    s_lshl2_add_u32 s55, s55, 11
    v_cvt_pk_bf16_f32 v217, v218, v219
    v_mul_f32 v222, v222, v225
    v_mfma_f32_16x16x32_bf16 v[232:235], a[196:199], a[236:239], v[232:235]
    s_mul_i32 s55, s55, s31
    v_mul_f32 v223, v223, v225
    v_cvt_pk_bf16_f32 v220, v220, v221
    v_mfma_f32_16x16x32_bf16 v[232:235], a[200:203], a[240:243], v[232:235]
    s_lshr_b32 s53, s28, 1
    v_cvt_pk_bf16_f32 v236, v236, v237
    v_cvt_pk_bf16_f32 v228, v228, v229
    v_mfma_f32_16x16x32_bf16 v[232:235], a[204:207], a[244:247], v[232:235]
    ds_write_b64 v247, v[216:217] offset:55424
    v_mfma_f32_16x16x32_bf16 v[232:235], a[208:211], a[216:219], v[232:235]
    s_sub_u32 s53, s53, 1
    v_cvt_pk_bf16_f32 v221, v222, v223
    v_mov_b32 v225, s66
    v_mfma_f32_16x16x32_bf16 v[232:235], a[212:215], a[220:223], v[232:235]
    v_mov_b32 v226, s67
    v_cvt_pk_bf16_f32 v237, v238, v239
    v_cvt_pk_bf16_f32 v229, v230, v231
    ds_write_b64 v247, v[220:221] offset:55552
    ds_write_b32 v226, v225 offset:0
    ds_write_b64 v249, v[236:237] offset:6144
    ds_write_b64 v249, v[228:229] offset:6272
    ds_read_b128 a[252:255], v252 offset:24576
    v_cvt_pk_bf16_f32 v232, v232, v233
    v_cvt_pk_bf16_f32 v233, v234, v235
    ds_write_b64 v249, v[232:233] offset:6400
    buffer_store_dwordx2 v[254:255], v251, s[20:23], s52 offen offset:256 nt
    ds_read_b64 v[254:255], v253 offset:24832
    s_lshr_b32 s52, s28, 1
    s_lshl2_add_u32 s52, s52, 3
    s_mul_i32 s52, s52, s31
    s_add_u32 s51, s51, s52
    s_add_u32 s51, s51, s32
    v_mov_b32 v226, 0x23000
    s_waitcnt lgkmcnt(2)
    buffer_store_dwordx4 a[252:255], v250, s[20:23], s54 offen nt
    s_waitcnt lgkmcnt(1)
    s_barrier
    ds_read_b128 a[224:227], v242 offset:55296
    ds_read_b128 a[228:231], v243 offset:55296
    ds_read_b128 a[232:235], v242 offset:55424
    ds_read_b128 a[236:239], v243 offset:55424
    ds_read_b128 a[240:243], v242 offset:55552
    ds_read_b128 a[244:247], v243 offset:55552
    ds_read_b128 a[252:255], v252 offset:0
    s_waitcnt lgkmcnt(7)
    buffer_store_dwordx2 v[254:255], v251, s[20:23], s54 offen offset:256 nt
    ds_read_b64 v[254:255], v253 offset:256
    ds_read_b128 v[196:199], v226 offset:0
    s_and_b32 s54, s28, 1
    s_add_u32 s54, s54, 15
    s_mul_i32 s54, s54, s30
    s_add_u32 s54, s54, s55
    s_add_u32 s54, s54, s32
    s_waitcnt lgkmcnt(8)
    v_mfma_f32_16x16x32_bf16 v[236:239], a[144:147], a[224:227], 0
    v_mfma_f32_16x16x32_bf16 v[228:231], a[168:171], a[224:227], 0
    s_waitcnt lgkmcnt(7)
    v_mfma_f32_16x16x32_bf16 v[236:239], a[148:151], a[228:231], v[236:239]
    s_waitcnt lgkmcnt(6)
    v_mfma_f32_16x16x32_bf16 v[236:239], a[152:155], a[232:235], v[236:239]
    s_waitcnt lgkmcnt(5)
    v_mfma_f32_16x16x32_bf16 v[236:239], a[156:159], a[236:239], v[236:239]
    s_waitcnt lgkmcnt(4)
    v_mfma_f32_16x16x32_bf16 v[236:239], a[160:163], a[240:243], v[236:239]
    s_waitcnt lgkmcnt(3)
    v_mfma_f32_16x16x32_bf16 v[236:239], a[164:167], a[244:247], v[236:239]
    s_waitcnt lgkmcnt(1)
    v_mfma_f32_16x16x32_bf16 v[228:231], a[172:175], a[228:231], v[228:231]
    s_mov_b32 exec_hi, 0
    buffer_store_dwordx4 a[252:255], v250, s[20:23], s56 offen nt
    s_mov_b32 exec_hi, -1
    v_mfma_f32_16x16x32_bf16 v[228:231], a[176:179], a[232:235], v[228:231]
    v_mfma_f32_16x16x32_bf16 v[228:231], a[180:183], a[236:239], v[228:231]
    ds_read_b128 a[252:255], v252 offset:6144
    v_mfma_f32_16x16x32_bf16 v[228:231], a[184:187], a[240:243], v[228:231]
    s_mov_b32 exec_hi, 0
    buffer_store_dwordx2 v[254:255], v251, s[20:23], s56 offen offset:256 nt
    s_mov_b32 exec_hi, -1
    v_mfma_f32_16x16x32_bf16 v[228:231], a[188:191], a[244:247], v[228:231]
    ds_read_b64 v[254:255], v253 offset:6400
    v_cvt_pk_bf16_f32 v236, v236, v237
    v_mfma_f32_16x16x32_bf16 v[232:235], a[192:195], a[224:227], 0
    s_waitcnt lgkmcnt(2)
    v_cvt_pk_bf16_f32 v237, v238, v239
    v_or3_b32 v225, v196, v197, v198
    v_mfma_f32_16x16x32_bf16 v[232:235], a[196:199], a[228:231], v[232:235]
    ds_write_b64 v249, v[236:237] offset:12288
    v_mfma_f32_16x16x32_bf16 v[232:235], a[200:203], a[232:235], v[232:235]
    v_cvt_pk_bf16_f32 v228, v228, v229
    v_cvt_pk_bf16_f32 v229, v230, v231
    v_mfma_f32_16x16x32_bf16 v[232:235], a[204:207], a[236:239], v[232:235]
    ds_write_b64 v249, v[228:229] offset:12416
    v_mfma_f32_16x16x32_bf16 v[232:235], a[208:211], a[240:243], v[232:235]
    v_or_b32 v225, v225, v199
    s_waitcnt lgkmcnt(3)
    v_mfma_f32_16x16x32_bf16 v[232:235], a[212:215], a[244:247], v[232:235]
    buffer_store_dwordx4 a[252:255], v250, s[20:23], s51 offen nt
    v_readfirstlane_b32 s47, v225
    s_waitcnt lgkmcnt(2)
    s_nop 4
    v_cvt_pk_bf16_f32 v232, v232, v233
    v_cvt_pk_bf16_f32 v233, v234, v235
    ds_write_b64 v249, v[232:233] offset:12544
    buffer_store_dwordx2 v[254:255], v251, s[20:23], s51 offen offset:256 nt
    s_waitcnt lgkmcnt(0)
    s_barrier
    ds_read_b128 a[252:255], v252 offset:12288
    ds_read_b64 v[254:255], v253 offset:12544
    s_waitcnt lgkmcnt(1)
    s_mov_b32 exec_hi, s53
    buffer_store_dwordx4 a[252:255], v250, s[20:23], s54 offen nt
    s_mov_b32 exec_hi, -1
    s_waitcnt lgkmcnt(0)
    s_mov_b32 exec_hi, s53
    buffer_store_dwordx2 v[254:255], v251, s[20:23], s54 offen offset:256 nt
    s_mov_b32 exec_hi, -1
    s_nop 4
    s_cmp_lg_u32 s47, 0
    s_cbranch_scc1 L_safe
L_exit:
    s_endpgm
L_safe:
    s_waitcnt vmcnt(0) lgkmcnt(0)
    s_nop 7
    s_barrier
    v_mbcnt_lo_u32_b32 v1, -1, 0
    v_mbcnt_hi_u32_b32 v1, -1, v1
    s_lshl_b32 s51, s28, 1
    s_add_u32 s50, s31, 0xfffffe80
    s_mul_i32 s52, s36, 0x1d00
    v_lshrrev_b32 v2, 3, v1
    v_and_b32 v3, 7, v1
    v_xor_b32 v3, s51, v3
    v_lshl_add_u32 v4, v2, 7, s52
    v_mul_u32_u24 v8, 11, v2
    v_bfe_u32 v9, v8, 6, 1
    v_lshrrev_b32 v8, 5, v8
    v_xor_b32 v9, v3, v9
    v_mad_i32_i24 v8, v8, s50, v4
    v_lshl_add_u32 v168, v9, 4, v8
    v_add_u32 v8, 8, v2
    v_mul_u32_u24 v8, 11, v8
    v_bfe_u32 v9, v8, 6, 1
    v_lshrrev_b32 v8, 5, v8
    v_xor_b32 v9, v3, v9
    v_mad_i32_i24 v8, v8, s50, v4
    v_lshl_add_u32 v169, v9, 4, v8
    v_add_u32 v8, 16, v2
    v_mul_u32_u24 v8, 11, v8
    v_bfe_u32 v9, v8, 6, 1
    v_lshrrev_b32 v8, 5, v8
    v_xor_b32 v9, v3, v9
    v_mad_i32_i24 v8, v8, s50, v4
    v_lshl_add_u32 v170, v9, 4, v8
    s_movk_i32 s53, 0x480
    s_movk_i32 s54, -96
    v_lshrrev_b32 v10, 1, v1
    v_lshlrev_b32 v12, 4, v1
    v_mul_u32_u24 v8, 43, v10
    v_lshrrev_b32 v9, 8, v8
    v_lshrrev_b32 v8, 7, v8
    v_and_b32 v9, 4, v9
    v_xor_b32 v9, v8, v9
    v_mad_i32_i24 v8, v8, s54, v12
    v_mad_u32_u24 v172, v9, s53, v8
    v_add_u32 v8, 32, v10
    v_mul_u32_u24 v8, 43, v8
    v_lshrrev_b32 v9, 8, v8
    v_lshrrev_b32 v8, 7, v8
    v_and_b32 v9, 4, v9
    v_xor_b32 v9, v8, v9
    v_mad_i32_i24 v8, v8, s54, v12
    v_mad_u32_u24 v173, v9, s53, v8
    v_add_u32 v8, 64, v10
    v_mul_u32_u24 v8, 43, v8
    v_lshrrev_b32 v9, 8, v8
    v_lshrrev_b32 v8, 7, v8
    v_and_b32 v9, 4, v9
    v_xor_b32 v9, v8, v9
    v_mad_i32_i24 v8, v8, s54, v12
    v_mad_u32_u24 v174, v9, s53, v8
L_safe2:
    s_add_u32 s59, s40, s45
    s_add_u32 m0, s46, 0xc00
    s_add_u32 s60, s39, 0x180
    buffer_load_dwordx4 v168, s[4:7], s59 offen lds
    s_add_u32 m0, s29, 0
    s_add_u32 s52, s40, 0
    buffer_load_dwordx4 v172, s[8:11], s60 offen lds
    s_add_u32 m0, s46, 0xc00
    v_add_u32 v5, s52, v168
    buffer_load_dwordx4 v169, s[4:7], s59 offen offset:1024 lds
    s_add_u32 m0, s29, 0
    v_max_i32 v5, 0, v5
    buffer_load_dwordx4 v173, s[8:11], s60 offen offset:1024 lds
    s_add_u32 m0, s46, 0xc00
    s_add_u32 s53, s40, 0x400
    buffer_load_dwordx4 v170, s[4:7], s59 offen offset:2048 lds
    s_add_u32 m0, s29, 0
    v_add_u32 v6, s53, v169
    buffer_load_dwordx4 v174, s[8:11], s60 offen offset:2048 lds
    s_add_u32 m0, s46, 0
    v_max_i32 v6, 0, v6
    buffer_load_dwordx4 v5, s[4:7], 0 offen lds
    s_add_u32 m0, s46, 0x400
    s_add_u32 s54, s40, 0x800
    buffer_load_dwordx4 v6, s[4:7], 0 offen lds
    v_add_u32 v7, s54, v170
    v_max_i32 v7, 0, v7
    s_add_u32 m0, s46, 0x800
    s_add_u32 s61, s39, 0x9180
    buffer_load_dwordx4 v7, s[4:7], 0 offen lds
    s_add_u32 m0, s29, 0xc00
    s_add_u32 s62, s39, 0x12180
    buffer_load_dwordx4 v172, s[8:11], s61 offen lds
    buffer_load_dwordx4 v173, s[8:11], s61 offen offset:1024 lds
    buffer_load_dwordx4 v174, s[8:11], s61 offen offset:2048 lds
    s_add_u32 m0, s29, 0x1800
    s_add_u32 s63, s39, 0x1b180
    s_add_u32 s59, s41, s45
    s_add_u32 s60, s39, 0x24180
    s_add_u32 s61, s39, 0x2d180
    s_and_b32 s65, s48, 0xfff0
    s_lshl1_add_u32 s58, s45, s40
    v_and_b32 v13, 15, v1
    v_lshrrev_b32 v14, 4, v1
    v_lshrrev_b32 v15, 2, v13
    v_and_b32 v16, 3, v13
    v_and_b32 v17, 1, v14
    v_lshl_add_u32 v18, v14, 3, v15
    v_xor_b32 v19, 0, v17
    v_lshl_add_u32 v19, v19, 2, v18
    v_mul_u32_u24 v19, 0x60, v19
    v_lshl_add_u32 v19, v16, 3, v19
    v_add_u32 v249, s29, v19
    v_xor_b32 v19, 1, v17
    v_lshl_add_u32 v19, v19, 2, v18
    v_mul_u32_u24 v19, 0x60, v19
    v_lshl_add_u32 v19, v16, 3, v19
    v_add_u32 v250, s29, v19
    v_mov_b32 v17, v15
    v_and_b32 v18, 3, v17
    v_mul_u32_u24 v17, 0x1e00, v17
    v_lshlrev_b32 v18, 1, v18
    v_bfe_u32 v241, v16, 1, 1
    v_or_b32 v18, v18, v241
    v_xor_b32 v18, v18, v14
    v_lshl_add_u32 v17, v18, 4, v17
    v_mul_u32_u24 v18, 0x180, v16
    v_add_u32 v240, v17, v18
    v_xor_b32 v241, 64, v240
    s_add_u32 s55, s28, 3
    s_mul_i32 s56, s31, 3
    s_mul_i32 s55, s55, s30
    s_add_u32 s55, s55, s56
    s_add_u32 s55, s55, s32
    s_add_u32 s57, s28, 3
    s_mul_i32 s51, s31, 7
    s_mul_i32 s57, s57, s30
    s_add_u32 s57, s57, s51
    s_add_u32 s57, s57, s32
    s_add_u32 s52, s28, 3
    s_mul_i32 s53, s31, 11
    s_mul_i32 s52, s52, s30
    s_add_u32 s52, s52, s53
    s_add_u32 s52, s52, s32
    s_add_u32 s54, s28, 7
    s_mul_i32 s54, s54, s30
    s_add_u32 s56, s28, 7
    s_mul_i32 s56, s56, s30
    s_add_u32 s51, s28, 7
    s_mul_i32 s51, s51, s30
    s_add_u32 s53, s28, 3
    s_mul_i32 s53, s53, s30
    buffer_load_dwordx4 v172, s[8:11], s62 offen lds
    buffer_load_dwordx4 v173, s[8:11], s62 offen offset:1024 lds
    buffer_load_dwordx4 v174, s[8:11], s62 offen offset:2048 lds
    s_add_u32 m0, s46, 0x7800
    s_add_u32 s62, s39, 0x300
    buffer_load_dwordx4 v168, s[4:7], s41 offen lds
    buffer_load_dwordx4 v169, s[4:7], s41 offen offset:1024 lds
    s_waitcnt vmcnt(12)
    s_barrier
    ds_read_b128 a[216:219], v240 offset:3072
    ds_read_b128 a[220:223], v240 offset:4608
    ds_read_b128 a[240:243], v241 offset:3072
    ds_read_b128 a[244:247], v241 offset:4608
    buffer_load_dwordx4 v170, s[4:7], s41 offen offset:2048 lds
    s_add_u32 m0, s29, 0x2400
    s_waitcnt vmcnt(12)
    ds_read_b64_tr_b16 a[0:1], v249 offset:0
    ds_read_b64_tr_b16 a[2:3], v250 offset:0
    ds_read_b64_tr_b16 a[24:25], v249 offset:32
    ds_read_b64_tr_b16 a[26:27], v250 offset:32
    ds_read_b64_tr_b16 a[48:49], v249 offset:64
    ds_read_b64_tr_b16 a[50:51], v250 offset:64
    buffer_load_dwordx4 v172, s[8:11], s63 offen lds
    buffer_load_dwordx4 v173, s[8:11], s63 offen offset:1024 lds
    s_waitcnt lgkmcnt(4)
    v_mfma_f32_16x16x32_bf16 v[180:183], a[0:3], a[216:219], 0
    v_mfma_f32_16x16x32_bf16 v[192:195], a[0:3], a[220:223], 0
    s_waitcnt lgkmcnt(2)
    v_mfma_f32_16x16x32_bf16 v[184:187], a[24:27], a[216:219], 0
    s_waitcnt lgkmcnt(0)
    v_mfma_f32_16x16x32_bf16 v[188:191], a[48:51], a[216:219], 0
    buffer_load_dwordx4 v174, s[8:11], s63 offen offset:2048 lds
    s_add_u32 m0, s46, 0x8400
    v_mfma_f32_16x16x32_bf16 v[196:199], a[24:27], a[220:223], 0
    s_add_u32 s63, s39, 0x9300
    s_waitcnt vmcnt(12)
    s_barrier
    v_mfma_f32_16x16x32_bf16 v[200:203], a[48:51], a[220:223], 0
    ds_read_b128 a[224:227], v240 offset:0
    ds_read_b128 a[228:231], v240 offset:1536
    ds_read_b128 a[232:235], v241 offset:0
    ds_read_b128 a[236:239], v241 offset:1536
    ds_read_b128 a[216:219], v240 offset:128
    ds_read_b128 a[220:223], v240 offset:1664
    buffer_load_dwordx4 v168, s[4:7], s59 offen lds
    buffer_load_dwordx4 v169, s[4:7], s59 offen offset:1024 lds
    s_waitcnt lgkmcnt(5)
    v_mfma_f32_16x16x32_bf16 v[204:207], a[0:3], a[224:227], 0
    v_mfma_f32_16x16x32_bf16 v[208:211], a[24:27], a[224:227], 0
    s_waitcnt lgkmcnt(4)
    v_mfma_f32_16x16x32_bf16 v[212:215], a[48:51], a[224:227], 0
    ds_read_b128 a[224:227], v240 offset:3200
    buffer_load_dwordx4 v170, s[4:7], s59 offen offset:2048 lds
    v_mfma_f32_16x16x32_bf16 v[216:219], a[0:3], a[228:231], 0
    s_add_u32 m0, s29, 0
    s_add_u32 s59, s42, s45
    s_waitcnt vmcnt(12)
    v_mfma_f32_16x16x32_bf16 v[220:223], a[24:27], a[228:231], 0
    ds_read_b64_tr_b16 a[4:5], v249 offset:3072
    ds_read_b64_tr_b16 a[6:7], v250 offset:3072
    v_mfma_f32_16x16x32_bf16 v[224:227], a[48:51], a[228:231], 0
    ds_read_b64_tr_b16 a[28:29], v249 offset:3104
    ds_read_b64_tr_b16 a[30:31], v250 offset:3104
    ds_read_b64_tr_b16 a[52:53], v249 offset:3136
    ds_read_b64_tr_b16 a[54:55], v250 offset:3136
    ds_read_b128 a[228:231], v240 offset:4736
    buffer_load_dwordx4 v172, s[8:11], s60 offen lds
    buffer_load_dwordx4 v173, s[8:11], s60 offen offset:1024 lds
    s_waitcnt lgkmcnt(5)
    v_mfma_f32_16x16x32_bf16 v[204:207], a[4:7], a[232:235], v[204:207]
    v_mfma_f32_16x16x32_bf16 v[216:219], a[4:7], a[236:239], v[216:219]
    s_waitcnt lgkmcnt(3)
    v_mfma_f32_16x16x32_bf16 v[208:211], a[28:31], a[232:235], v[208:211]
    s_waitcnt lgkmcnt(1)
    v_mfma_f32_16x16x32_bf16 v[212:215], a[52:55], a[232:235], v[212:215]
    buffer_load_dwordx4 v174, s[8:11], s60 offen offset:2048 lds
    s_add_u32 m0, s29, 0xc00
    v_mfma_f32_16x16x32_bf16 v[220:223], a[28:31], a[236:239], v[220:223]
    s_add_u32 s60, s39, 0x12300
    s_waitcnt vmcnt(12)
    v_mfma_f32_16x16x32_bf16 v[224:227], a[52:55], a[236:239], v[224:227]
    ds_read_b64_tr_b16 a[8:9], v249 offset:6144
    ds_read_b64_tr_b16 a[10:11], v250 offset:6144
    v_mfma_f32_16x16x32_bf16 v[180:183], a[4:7], a[240:243], v[180:183]
    ds_read_b64_tr_b16 a[32:33], v249 offset:6176
    ds_read_b64_tr_b16 a[34:35], v250 offset:6176
    v_mfma_f32_16x16x32_bf16 v[184:187], a[28:31], a[240:243], v[184:187]
    buffer_load_dwordx4 v172, s[8:11], s61 offen lds
    ds_read_b64_tr_b16 a[56:57], v249 offset:6208
    v_mfma_f32_16x16x32_bf16 v[188:191], a[52:55], a[240:243], v[188:191]
    ds_read_b64_tr_b16 a[58:59], v250 offset:6208
    v_mfma_f32_16x16x32_bf16 v[192:195], a[4:7], a[244:247], v[192:195]
    v_mfma_f32_16x16x32_bf16 v[196:199], a[28:31], a[244:247], v[196:199]
    v_mfma_f32_16x16x32_bf16 v[200:203], a[52:55], a[244:247], v[200:203]
    buffer_load_dwordx4 v173, s[8:11], s61 offen offset:1024 lds
    s_waitcnt lgkmcnt(4)
    v_mfma_f32_16x16x32_bf16 v[204:207], a[8:11], a[216:219], v[204:207]
    v_mfma_f32_16x16x32_bf16 v[216:219], a[8:11], a[220:223], v[216:219]
    s_waitcnt lgkmcnt(2)
    v_mfma_f32_16x16x32_bf16 v[208:211], a[32:35], a[216:219], v[208:211]
    buffer_load_dwordx4 v174, s[8:11], s61 offen offset:2048 lds
    s_add_u32 m0, s37, 0xd80
    v_mfma_f32_16x16x32_bf16 v[220:223], a[32:35], a[220:223], v[220:223]
    s_add_u32 s61, s39, 0x1b300
    s_waitcnt vmcnt(12) lgkmcnt(0)
    s_barrier
    v_mfma_f32_16x16x32_bf16 v[212:215], a[56:59], a[216:219], v[212:215]
    ds_read_b128 a[232:235], v240 offset:30720
    ds_read_b128 a[236:239], v240 offset:32256
    v_mfma_f32_16x16x32_bf16 v[224:227], a[56:59], a[220:223], v[224:227]
    ds_read_b128 a[240:243], v241 offset:30720
    ds_read_b128 a[244:247], v241 offset:32256
    v_mfma_f32_16x16x32_bf16 v[180:183], a[8:11], a[224:227], v[180:183]
    buffer_load_dwordx4 v12, s[16:19], s65 offen lds
    s_add_u32 m0, s29, 0x1800
    v_mfma_f32_16x16x32_bf16 v[184:187], a[32:35], a[224:227], v[184:187]
    ds_read_b128 a[216:219], v240 offset:30848
    ds_read_b128 a[220:223], v240 offset:32384
    v_mfma_f32_16x16x32_bf16 v[188:191], a[56:59], a[224:227], v[188:191]
    ds_read_b128 a[224:227], v241 offset:128
    v_mfma_f32_16x16x32_bf16 v[192:195], a[8:11], a[228:231], v[192:195]
    v_mfma_f32_16x16x32_bf16 v[196:199], a[32:35], a[228:231], v[196:199]
    buffer_load_dwordx4 v172, s[8:11], s62 offen lds
    v_mfma_f32_16x16x32_bf16 v[200:203], a[56:59], a[228:231], v[200:203]
    ds_read_b128 a[228:231], v241 offset:1664
    s_waitcnt lgkmcnt(7)
    v_mfma_f32_16x16x32_bf16 v[228:231], a[0:3], a[232:235], 0
    v_mfma_f32_16x16x32_bf16 v[232:235], a[24:27], a[232:235], 0
    s_waitcnt lgkmcnt(6)
    v_mfma_f32_16x16x32_bf16 v[236:239], a[48:51], a[232:235], 0
    buffer_load_dwordx4 v173, s[8:11], s62 offen offset:1024 lds
    s_waitcnt vmcnt(12) lgkmcnt(5)
    v_mfma_f32_16x16x32_bf16 v[138:141], a[0:3], a[236:239], 0
    ds_read_b64_tr_b16 a[12:13], v249 offset:9216
    ds_read_b64_tr_b16 a[14:15], v250 offset:9216
    v_mfma_f32_16x16x32_bf16 v[142:145], a[24:27], a[236:239], 0
    ds_read_b64_tr_b16 a[36:37], v249 offset:9248
    ds_read_b64_tr_b16 a[38:39], v250 offset:9248
    v_mfma_f32_16x16x32_bf16 v[146:149], a[48:51], a[236:239], 0
    ds_read_b64_tr_b16 a[60:61], v249 offset:9280
    ds_read_b64_tr_b16 a[62:63], v250 offset:9280
    v_mfma_f32_16x16x32_bf16 v[228:231], a[4:7], a[240:243], v[228:231]
    ds_read_b128 a[232:235], v241 offset:3200
    buffer_load_dwordx4 v174, s[8:11], s62 offen offset:2048 lds
    v_mfma_f32_16x16x32_bf16 v[232:235], a[28:31], a[240:243], v[232:235]
    s_add_u32 m0, s46, 0xf000
    s_add_u32 s62, s39, 0x24300
    s_add_u32 s50, s31, 0xfffffe80
    v_mfma_f32_16x16x32_bf16 v[236:239], a[52:55], a[240:243], v[236:239]
    s_waitcnt lgkmcnt(10)
    ds_read_b128 a[236:239], v241 offset:4736
    v_mfma_f32_16x16x32_bf16 v[138:141], a[4:7], a[244:247], v[138:141]
    ds_read_b128 a[240:243], v241 offset:30848
    v_add_u32 v8, 4, v2
    v_mfma_f32_16x16x32_bf16 v[142:145], a[28:31], a[244:247], v[142:145]
    s_and_b32 s66, s28, 1
    v_mul_u32_u24 v8, 11, v8
    v_bfe_u32 v9, v8, 6, 1
    v_mfma_f32_16x16x32_bf16 v[146:149], a[52:55], a[244:247], v[146:149]
    buffer_load_dwordx4 v168, s[4:7], s42 offen lds
    s_add_u32 m0, s29, 0x2400
    v_mfma_f32_16x16x32_bf16 v[228:231], a[8:11], a[216:219], v[228:231]
    ds_read_b128 a[244:247], v241 offset:32384
    v_lshrrev_b32 v8, 5, v8
    v_mfma_f32_16x16x32_bf16 v[232:235], a[32:35], a[216:219], v[232:235]
    s_lshl_b32 s66, s66, 2
    v_xor_b32 v9, v3, v9
    s_waitcnt lgkmcnt(4)
    v_mfma_f32_16x16x32_bf16 v[236:239], a[56:59], a[216:219], v[236:239]
    s_lshr_b32 s67, s28, 1
    v_mad_i32_i24 v8, v8, s50, v4
    v_lshl_add_u32 v171, v9, 4, v8
    v_mfma_f32_16x16x32_bf16 v[138:141], a[8:11], a[220:223], v[138:141]
    buffer_load_dwordx4 v172, s[8:11], s63 offen lds
    s_add_u32 m0, s46, 0xf000
    v_mfma_f32_16x16x32_bf16 v[142:145], a[32:35], a[220:223], v[142:145]
    s_waitcnt vmcnt(12) lgkmcnt(3)
    s_barrier
    v_mbcnt_lo_u32_b32 v67, -1, 0
    v_mfma_f32_16x16x32_bf16 v[146:149], a[56:59], a[220:223], v[146:149]
    ds_read_b128 a[216:219], v240 offset:33792
    ds_read_b128 a[220:223], v240 offset:35328
    v_mfma_f32_16x16x32_bf16 v[204:207], a[12:15], a[224:227], v[204:207]
    s_lshl_b32 s67, s67, 3
    v_mbcnt_hi_u32_b32 v67, -1, v67
    v_lshrrev_b32 v68, 1, v67
    v_mfma_f32_16x16x32_bf16 v[208:211], a[36:39], a[224:227], v[208:211]
    s_mul_i32 s64, s35, 0xfc0
    buffer_load_dwordx4 v169, s[4:7], s42 offen offset:1024 lds
    v_mfma_f32_16x16x32_bf16 v[212:215], a[60:63], a[224:227], v[212:215]
    s_add_u32 m0, s29, 0x2400
    ds_read_b128 a[224:227], v241 offset:33792
    v_mfma_f32_16x16x32_bf16 v[216:219], a[12:15], a[228:231], v[216:219]
    s_add_u32 s64, s64, s37
    v_add_u32 v68, 0, v68
    v_mul_u32_u24 v69, 43, v68
    v_mfma_f32_16x16x32_bf16 v[220:223], a[36:39], a[228:231], v[220:223]
    s_waitcnt lgkmcnt(3)
    v_lshrrev_b32 v70, 8, v69
    v_lshrrev_b32 v69, 7, v69
    v_mfma_f32_16x16x32_bf16 v[224:227], a[60:63], a[228:231], v[224:227]
    ds_read_b128 a[228:231], v241 offset:35328
    buffer_load_dwordx4 v173, s[8:11], s63 offen offset:1024 lds
    v_mfma_f32_16x16x32_bf16 v[180:183], a[12:15], a[232:235], v[180:183]
    s_add_u32 m0, s46, 0xf000
    v_mad_i32_i24 v68, v69, -3, v68
    v_and_b32 v70, 4, v70
    v_mfma_f32_16x16x32_bf16 v[184:187], a[36:39], a[232:235], v[184:187]
    s_waitcnt lgkmcnt(3)
    v_xor_b32 v69, v69, v70
    v_and_b32 v70, 4, v69
    v_mfma_f32_16x16x32_bf16 v[188:191], a[60:63], a[232:235], v[188:191]
    ds_read_b128 a[232:235], v240 offset:33920
    v_mul_u32_u24 v252, 24, v70
    v_mfma_f32_16x16x32_bf16 v[192:195], a[12:15], a[236:239], v[192:195]
    s_waitcnt lgkmcnt(3)
    v_lshrrev_b32 v70, 3, v69
    v_lshl_add_u32 v252, v70, 2, v252
    v_mfma_f32_16x16x32_bf16 v[196:199], a[36:39], a[236:239], v[196:199]
    buffer_load_dwordx4 v170, s[4:7], s42 offen offset:2048 lds
    s_add_u32 m0, s29, 0x2400
    v_mfma_f32_16x16x32_bf16 v[200:203], a[60:63], a[236:239], v[200:203]
    s_waitcnt vmcnt(12)
    ds_read_b64_tr_b16 a[16:17], v249 offset:0
    v_mfma_f32_16x16x32_bf16 v[228:231], a[12:15], a[240:243], v[228:231]
    ds_read_b64_tr_b16 a[18:19], v250 offset:0
    ds_read_b64_tr_b16 a[40:41], v249 offset:32
    v_mfma_f32_16x16x32_bf16 v[232:235], a[36:39], a[240:243], v[232:235]
    ds_read_b64_tr_b16 a[42:43], v250 offset:32
    ds_read_b64_tr_b16 a[64:65], v249 offset:64
    v_mfma_f32_16x16x32_bf16 v[236:239], a[60:63], a[240:243], v[236:239]
    ds_read_b64_tr_b16 a[66:67], v250 offset:64
    buffer_load_dwordx4 v174, s[8:11], s63 offen offset:2048 lds
    v_mfma_f32_16x16x32_bf16 v[138:141], a[12:15], a[244:247], v[138:141]
    s_add_u32 m0, s46, 0xfc00
    s_add_u32 s63, s39, 0x2d300
    v_and_or_b32 v252, v69, 3, v252
    v_mfma_f32_16x16x32_bf16 v[142:145], a[36:39], a[244:247], v[142:145]
    ds_read_b128 a[236:239], v240 offset:35456
    ds_read_b128 a[240:243], v241 offset:33920
    v_mfma_f32_16x16x32_bf16 v[146:149], a[60:63], a[244:247], v[146:149]
    ds_read_b128 a[244:247], v241 offset:35456
    v_mad_u32_u24 v252, v252, 3, v68
    v_mfma_f32_16x16x32_bf16 v[150:153], a[0:3], a[216:219], 0
    s_waitcnt lgkmcnt(10)
    v_and_b32 v70, 1, v67
    v_lshl_add_u32 v252, v252, 3, v70
    v_mfma_f32_16x16x32_bf16 v[154:157], a[24:27], a[216:219], 0
    buffer_load_dwordx4 v168, s[4:7], s59 offen lds
    s_add_u32 m0, s29, 0
    v_mfma_f32_16x16x32_bf16 v[158:161], a[48:51], a[216:219], 0
    ds_read_b128 a[216:219], v240 offset:256
    v_lshlrev_b32 v252, 4, v252
    v_mfma_f32_16x16x32_bf16 v[162:165], a[0:3], a[220:223], 0
    v_lshrrev_b32 v68, 1, v67
    v_add_u32 v68, 32, v68
    v_mfma_f32_16x16x32_bf16 v[24:27], a[24:27], a[220:223], 0
    s_waitcnt lgkmcnt(4)
    v_mul_u32_u24 v69, 43, v68
    v_lshrrev_b32 v70, 8, v69
    v_mfma_f32_16x16x32_bf16 v[54:57], a[48:51], a[220:223], 0
    buffer_load_dwordx4 v172, s[8:11], s60 offen lds
    s_add_u32 m0, s46, 0xfc00
    v_mfma_f32_16x16x32_bf16 v[150:153], a[4:7], a[224:227], v[150:153]
    s_waitcnt vmcnt(12)
    ds_read_b64_tr_b16 a[20:21], v249 offset:3072
    v_mfma_f32_16x16x32_bf16 v[154:157], a[28:31], a[224:227], v[154:157]
    ds_read_b64_tr_b16 a[22:23], v250 offset:3072
    ds_read_b64_tr_b16 a[44:45], v249 offset:3104
    v_mfma_f32_16x16x32_bf16 v[158:161], a[52:55], a[224:227], v[158:161]
    ds_read_b64_tr_b16 a[46:47], v250 offset:3104
    ds_read_b64_tr_b16 a[68:69], v249 offset:3136
    v_mfma_f32_16x16x32_bf16 v[162:165], a[4:7], a[228:231], v[162:165]
    buffer_load_dwordx4 v169, s[4:7], s59 offen offset:1024 lds
    s_add_u32 m0, s29, 0
    v_mfma_f32_16x16x32_bf16 v[24:27], a[28:31], a[228:231], v[24:27]
    ds_read_b64_tr_b16 a[70:71], v250 offset:3136
    ds_read_b128 a[220:223], v240 offset:1792
    v_mfma_f32_16x16x32_bf16 v[54:57], a[52:55], a[228:231], v[54:57]
    ds_read_b128 a[224:227], v240 offset:3328
    ds_read_b128 a[228:231], v240 offset:4864
    v_mfma_f32_16x16x32_bf16 v[150:153], a[8:11], a[232:235], v[150:153]
    s_waitcnt lgkmcnt(9)
    v_lshrrev_b32 v69, 7, v69
    v_mad_i32_i24 v68, v69, -3, v68
    v_mfma_f32_16x16x32_bf16 v[154:157], a[32:35], a[232:235], v[154:157]
    v_and_b32 v70, 4, v70
    v_xor_b32 v69, v69, v70
    v_mfma_f32_16x16x32_bf16 v[158:161], a[56:59], a[232:235], v[158:161]
    buffer_load_dwordx4 v173, s[8:11], s60 offen offset:1024 lds
    s_add_u32 m0, s46, 0xfc00
    v_mfma_f32_16x16x32_bf16 v[162:165], a[8:11], a[236:239], v[162:165]
    ds_read_b128 a[232:235], v240 offset:30976
    v_and_b32 v70, 4, v69
    v_mfma_f32_16x16x32_bf16 v[24:27], a[32:35], a[236:239], v[24:27]
    v_mul_u32_u24 v253, 24, v70
    v_lshrrev_b32 v70, 3, v69
    v_mfma_f32_16x16x32_bf16 v[54:57], a[56:59], a[236:239], v[54:57]
    ds_read_b128 a[236:239], v240 offset:32512
    v_lshl_add_u32 v253, v70, 2, v253
    v_mfma_f32_16x16x32_bf16 v[150:153], a[12:15], a[240:243], v[150:153]
    buffer_load_dwordx4 v170, s[4:7], s59 offen offset:2048 lds
    s_add_u32 m0, s29, 0
    v_mfma_f32_16x16x32_bf16 v[154:157], a[36:39], a[240:243], v[154:157]
    s_add_u32 s59, s43, s45
    v_and_or_b32 v253, v69, 3, v253
    v_mad_u32_u24 v253, v253, 3, v68
    v_mfma_f32_16x16x32_bf16 v[158:161], a[60:63], a[240:243], v[158:161]
    ds_read_b128 a[240:243], v240 offset:34048
    v_and_b32 v70, 1, v67
    v_mfma_f32_16x16x32_bf16 v[162:165], a[12:15], a[244:247], v[162:165]
    s_waitcnt lgkmcnt(3)
    v_lshl_add_u32 v253, v253, 3, v70
    v_lshlrev_b32 v253, 4, v253
    v_mfma_f32_16x16x32_bf16 v[24:27], a[36:39], a[244:247], v[24:27]
    buffer_load_dwordx4 v174, s[8:11], s60 offen offset:2048 lds
    s_add_u32 m0, s29, 0xc00
    v_mfma_f32_16x16x32_bf16 v[54:57], a[60:63], a[244:247], v[54:57]
    s_add_u32 s60, s39, 0
    s_waitcnt vmcnt(12) lgkmcnt(2)
    v_add_u32 v253, 0xfffffc00, v253
    v_mfma_f32_16x16x32_bf16 v[204:207], a[16:19], a[216:219], v[204:207]
    ds_read_b64_tr_b16 a[72:73], v249 offset:6144
    ds_read_b64_tr_b16 a[74:75], v250 offset:6144
    v_mfma_f32_16x16x32_bf16 v[208:211], a[40:43], a[216:219], v[208:211]
    ds_read_b64_tr_b16 a[96:97], v249 offset:6176
    ds_read_b64_tr_b16 a[98:99], v250 offset:6176
    v_mfma_f32_16x16x32_bf16 v[212:215], a[64:67], a[216:219], v[212:215]
    ds_read_b64_tr_b16 a[120:121], v249 offset:6208
    buffer_load_dwordx4 v172, s[8:11], s61 offen lds
    v_mfma_f32_16x16x32_bf16 v[216:219], a[16:19], a[220:223], v[216:219]
    ds_read_b64_tr_b16 a[122:123], v250 offset:6208
    ds_read_b128 a[244:247], v240 offset:35584
    v_mfma_f32_16x16x32_bf16 v[220:223], a[40:43], a[220:223], v[220:223]
    ds_read_b128 a[216:219], v241 offset:256
    v_add_u32 v17, 3, v15
    v_mfma_f32_16x16x32_bf16 v[224:227], a[64:67], a[220:223], v[224:227]
    ds_read_b128 a[220:223], v241 offset:1792
    v_add_u32 v19, 3, v16
    v_mfma_f32_16x16x32_bf16 v[180:183], a[16:19], a[224:227], v[180:183]
    s_waitcnt lgkmcnt(9)
    v_and_b32 v18, 3, v17
    v_mul_u32_u24 v17, 0x1e00, v17
    v_mfma_f32_16x16x32_bf16 v[184:187], a[40:43], a[224:227], v[184:187]
    buffer_load_dwordx4 v173, s[8:11], s61 offen offset:1024 lds
    v_lshlrev_b32 v18, 1, v18
    v_mfma_f32_16x16x32_bf16 v[188:191], a[64:67], a[224:227], v[188:191]
    ds_read_b128 a[224:227], v241 offset:3328
    v_bfe_u32 v243, v19, 1, 1
    v_mfma_f32_16x16x32_bf16 v[192:195], a[16:19], a[228:231], v[192:195]
    v_or_b32 v18, v18, v243
    v_xor_b32 v18, v18, v14
    v_mfma_f32_16x16x32_bf16 v[196:199], a[40:43], a[228:231], v[196:199]
    v_lshl_add_u32 v17, v18, 4, v17
    v_mul_u32_u24 v18, 0x180, v19
    v_mfma_f32_16x16x32_bf16 v[200:203], a[64:67], a[228:231], v[200:203]
    buffer_load_dwordx4 v174, s[8:11], s61 offen offset:2048 lds
    s_add_u32 m0, s29, 0x1800
    v_mfma_f32_16x16x32_bf16 v[228:231], a[16:19], a[232:235], v[228:231]
    s_waitcnt lgkmcnt(4)
    s_add_u32 s61, s39, 0x9000
    v_add_u32 v242, v17, v18
    v_mfma_f32_16x16x32_bf16 v[232:235], a[40:43], a[232:235], v[232:235]
    ds_read_b128 a[228:231], v241 offset:4864
    v_xor_b32 v243, 64, v242
    v_mfma_f32_16x16x32_bf16 v[236:239], a[64:67], a[232:235], v[236:239]
    ds_read_b128 a[232:235], v241 offset:30976
    v_accvgpr_write_b32 a252, v168
    v_mfma_f32_16x16x32_bf16 v[138:141], a[16:19], a[236:239], v[138:141]
    s_waitcnt lgkmcnt(3)
    buffer_load_dwordx4 v172, s[8:11], s62 offen lds
    v_mfma_f32_16x16x32_bf16 v[142:145], a[40:43], a[236:239], v[142:145]
    v_accvgpr_read_b32 v254, a252
    v_accvgpr_write_b32 a253, v169
    v_mfma_f32_16x16x32_bf16 v[146:149], a[64:67], a[236:239], v[146:149]
    ds_read_b128 a[236:239], v241 offset:32512
    v_accvgpr_read_b32 v255, a253
    v_mfma_f32_16x16x32_bf16 v[150:153], a[16:19], a[240:243], v[150:153]
    s_waitcnt lgkmcnt(3)
    v_accvgpr_write_b32 a254, v170
    v_accvgpr_write_b32 a255, v171
    v_mfma_f32_16x16x32_bf16 v[154:157], a[40:43], a[240:243], v[154:157]
    v_mov_b32 v17, 0x3f803f80
    v_accvgpr_write_b32 a248, v17
    v_mfma_f32_16x16x32_bf16 v[158:161], a[64:67], a[240:243], v[158:161]
    buffer_load_dwordx4 v173, s[8:11], s62 offen offset:1024 lds
    ds_read_b128 a[240:243], v241 offset:34048
    v_mfma_f32_16x16x32_bf16 v[162:165], a[16:19], a[244:247], v[162:165]
    v_accvgpr_write_b32 a249, v17
    v_accvgpr_write_b32 a250, v17
    v_mfma_f32_16x16x32_bf16 v[24:27], a[40:43], a[244:247], v[24:27]
    s_waitcnt lgkmcnt(3)
    v_accvgpr_write_b32 a251, v17
    v_mov_b32 v248, 0
    v_mfma_f32_16x16x32_bf16 v[54:57], a[64:67], a[244:247], v[54:57]
    ds_read_b128 a[244:247], v241 offset:35584
    v_lshrrev_b32 v18, 1, v13
    v_mfma_f32_16x16x32_bf16 v[204:207], a[20:23], a[216:219], v[204:207]
    buffer_load_dwordx4 v174, s[8:11], s62 offen offset:2048 lds
    s_add_u32 m0, s29, 0x2400
    v_mfma_f32_16x16x32_bf16 v[208:211], a[44:47], a[216:219], v[208:211]
    s_add_u32 s62, s39, 0x12000
    s_waitcnt vmcnt(12) lgkmcnt(2)
    v_xor_b32 v18, v14, v18
    v_mfma_f32_16x16x32_bf16 v[212:215], a[68:71], a[216:219], v[212:215]
    ds_read_b64_tr_b16 a[76:77], v249 offset:9216
    ds_read_b64_tr_b16 a[78:79], v250 offset:9216
    v_mfma_f32_16x16x32_bf16 v[216:219], a[20:23], a[220:223], v[216:219]
    ds_read_b64_tr_b16 a[100:101], v249 offset:9248
    ds_read_b64_tr_b16 a[102:103], v250 offset:9248
    v_mfma_f32_16x16x32_bf16 v[220:223], a[44:47], a[220:223], v[220:223]
    ds_read_b64_tr_b16 a[124:125], v249 offset:9280
    ds_read_b64_tr_b16 a[126:127], v250 offset:9280
    v_mfma_f32_16x16x32_bf16 v[224:227], a[68:71], a[220:223], v[224:227]
    s_waitcnt lgkmcnt(7)
    v_cvt_pk_bf16_f32 v102, v204, v205
    v_cvt_pk_bf16_f32 v103, v206, v207
    v_mfma_f32_16x16x32_bf16 v[180:183], a[20:23], a[224:227], v[180:183]
    v_cvt_pk_bf16_f32 v104, v208, v209
    v_cvt_pk_bf16_f32 v105, v210, v211
    v_mfma_f32_16x16x32_bf16 v[184:187], a[44:47], a[224:227], v[184:187]
    s_waitcnt lgkmcnt(6)
    v_cvt_pk_bf16_f32 v106, v212, v213
    v_cvt_pk_bf16_f32 v107, v214, v215
    v_mfma_f32_16x16x32_bf16 v[188:191], a[68:71], a[224:227], v[188:191]
    v_cvt_pk_bf16_f32 v108, v216, v217
    v_cvt_pk_bf16_f32 v109, v218, v219
    v_mfma_f32_16x16x32_bf16 v[192:195], a[20:23], a[228:231], v[192:195]
    v_cvt_pk_bf16_f32 v110, v220, v221
    v_cvt_pk_bf16_f32 v111, v222, v223
    v_mfma_f32_16x16x32_bf16 v[196:199], a[44:47], a[228:231], v[196:199]
    v_cvt_pk_bf16_f32 v112, v224, v225
    v_cvt_pk_bf16_f32 v113, v226, v227
    v_mfma_f32_16x16x32_bf16 v[200:203], a[68:71], a[228:231], v[200:203]
    v_cvt_pk_bf16_f32 v90, v180, v181
    v_cvt_pk_bf16_f32 v91, v182, v183
    v_mfma_f32_16x16x32_bf16 v[228:231], a[20:23], a[232:235], v[228:231]
    v_cvt_pk_bf16_f32 v92, v184, v185
    v_cvt_pk_bf16_f32 v93, v186, v187
    v_mfma_f32_16x16x32_bf16 v[232:235], a[44:47], a[232:235], v[232:235]
    s_waitcnt vmcnt(9) lgkmcnt(0)
    buffer_load_dwordx4 v172, s[8:11], s63 offen lds
    v_mfma_f32_16x16x32_bf16 v[236:239], a[68:71], a[232:235], v[236:239]
    s_barrier
    v_cvt_pk_bf16_f32 v94, v188, v189
    v_cvt_pk_bf16_f32 v95, v190, v191
    v_mfma_f32_16x16x32_bf16 v[138:141], a[20:23], a[236:239], v[138:141]
    v_cvt_pk_bf16_f32 v96, v192, v193
    v_cvt_pk_bf16_f32 v97, v194, v195
    v_mfma_f32_16x16x32_bf16 v[142:145], a[44:47], a[236:239], v[142:145]
    v_cvt_pk_bf16_f32 v98, v196, v197
    v_cvt_pk_bf16_f32 v99, v198, v199
    v_mfma_f32_16x16x32_bf16 v[146:149], a[68:71], a[236:239], v[146:149]
    buffer_load_dwordx4 v173, s[8:11], s63 offen offset:1024 lds
    v_cvt_pk_bf16_f32 v100, v200, v201
    v_mfma_f32_16x16x32_bf16 v[150:153], a[20:23], a[240:243], v[150:153]
    v_cvt_pk_bf16_f32 v101, v202, v203
    v_cvt_pk_bf16_f32 v114, v228, v229
    v_mfma_f32_16x16x32_bf16 v[154:157], a[44:47], a[240:243], v[154:157]
    v_cvt_pk_bf16_f32 v115, v230, v231
    v_cvt_pk_bf16_f32 v116, v232, v233
    v_mfma_f32_16x16x32_bf16 v[158:161], a[68:71], a[240:243], v[158:161]
    v_cvt_pk_bf16_f32 v117, v234, v235
    v_cvt_pk_bf16_f32 v118, v236, v237
    v_mfma_f32_16x16x32_bf16 v[162:165], a[20:23], a[244:247], v[162:165]
    buffer_load_dwordx4 v174, s[8:11], s63 offen offset:2048 lds
    s_add_u32 m0, s29, 0
    v_mfma_f32_16x16x32_bf16 v[24:27], a[44:47], a[244:247], v[24:27]
    s_add_u32 s63, s39, 0x1b000
    v_cvt_pk_bf16_f32 v119, v238, v239
    v_cvt_pk_bf16_f32 v120, v138, v139
    v_mfma_f32_16x16x32_bf16 v[54:57], a[68:71], a[244:247], v[54:57]
    v_cvt_pk_bf16_f32 v121, v140, v141
    v_cvt_pk_bf16_f32 v122, v142, v143
    v_cvt_pk_bf16_f32 v123, v144, v145
    v_cvt_pk_bf16_f32 v124, v146, v147
    v_cvt_pk_bf16_f32 v125, v148, v149
    v_cvt_pk_bf16_f32 v126, v150, v151
    v_cvt_pk_bf16_f32 v127, v152, v153
    v_cvt_pk_bf16_f32 v128, v154, v155
    v_cvt_pk_bf16_f32 v129, v156, v157
    v_cvt_pk_bf16_f32 v130, v158, v159
    v_cvt_pk_bf16_f32 v131, v160, v161
    s_waitcnt vmcnt(9)
    ds_read_b64_tr_b16 a[80:81], v249 offset:0
    ds_read_b64_tr_b16 a[82:83], v250 offset:0
    ds_read_b64_tr_b16 a[104:105], v249 offset:32
    ds_read_b64_tr_b16 a[106:107], v250 offset:32
    ds_read_b64_tr_b16 a[128:129], v249 offset:64
    ds_read_b64_tr_b16 a[130:131], v250 offset:64
    v_cvt_pk_bf16_f32 v132, v162, v163
    v_cvt_pk_bf16_f32 v133, v164, v165
    v_cvt_pk_bf16_f32 v134, v24, v25
    v_cvt_pk_bf16_f32 v135, v26, v27
    v_cvt_pk_bf16_f32 v136, v54, v55
    v_cvt_pk_bf16_f32 v137, v56, v57
    ds_read_b128 a[216:219], v240 offset:0
    ds_read_b128 a[220:223], v240 offset:1536
    ds_read_b128 a[224:227], v240 offset:3072
    ds_read_b128 a[228:231], v240 offset:4608
    ds_read_b128 a[232:235], v240 offset:30720
    ds_read_b128 a[236:239], v240 offset:32256
    ds_read_b128 a[240:243], v240 offset:33792
    ds_read_b128 a[244:247], v240 offset:35328
    v_xor_b32 v18, s66, v18
    v_mul_u32_u24 v17, 0x180, v13
    v_lshl_add_u32 v17, v18, 4, v17
    v_add_u32 v17, s67, v17
    s_mul_i32 s67, s36, 3
    v_add_u32 v247, 0x7800, v17
    v_add_u32 v251, 0x1e000, v17
    v_sub_u32 v17, v14, v15
    v_mul_i32_i24 v17, 0x1c0, v17
    v_lshlrev_b32 v18, 4, v16
    v_sub_u32 v17, v17, v18
    v_add_u32 v17, s37, v17
    v_max_u32 v18, s33, v15
    v_sub_u32 v18, v14, v18
    v_add_u32 v244, 0, v18
    v_cmp_gt_u32 vcc, 7, v244
    v_add_u32 v244, 0xfffdc870, v17
    s_waitcnt lgkmcnt(8)
    buffer_load_dwordx4 v172, s[8:11], s60 offen lds
    v_cndmask_b32 v244, 0, v244, vcc
    v_add_u32 v244, 0x237c0, v244
    s_waitcnt lgkmcnt(7)
    v_mfma_f32_16x16x32_bf16 v[84:87], a[216:219], a[72:75], 0
    s_lshl_b32 s66, s36, 1
    v_add_u32 v245, 4, v18
    s_waitcnt vmcnt(7) lgkmcnt(6)
    v_mfma_f32_16x16x32_bf16 v[204:207], a[216:219], a[96:99], 0
    ds_read_b64_tr_b16 a[84:85], v249 offset:3072
    ds_read_b64_tr_b16 a[86:87], v250 offset:3072
    v_mfma_f32_16x16x32_bf16 v[208:211], a[216:219], a[120:123], 0
    ds_read_b64_tr_b16 a[108:109], v249 offset:3104
    ds_read_b64_tr_b16 a[110:111], v250 offset:3104
    v_mfma_f32_16x16x32_bf16 v[212:215], a[220:223], a[72:75], 0
    ds_read_b64_tr_b16 a[132:133], v249 offset:3136
    ds_read_b64_tr_b16 a[134:135], v250 offset:3136
    v_mfma_f32_16x16x32_bf16 v[216:219], a[220:223], a[96:99], 0
    ds_read_b128 a[216:219], v241 offset:0
    v_cmp_gt_u32 vcc, 7, v245
    v_mfma_f32_16x16x32_bf16 v[220:223], a[220:223], a[120:123], 0
    s_waitcnt lgkmcnt(9)
    buffer_load_dwordx4 v173, s[8:11], s60 offen offset:1024 lds
    v_mfma_f32_16x16x32_bf16 v[224:227], a[224:227], a[72:75], 0
    ds_read_b128 a[220:223], v241 offset:1536
    v_add_u32 v245, 0xfffdcf70, v17
    v_mfma_f32_16x16x32_bf16 v[180:183], a[224:227], a[96:99], 0
    s_sub_u32 s66, 1, s66
    v_cndmask_b32 v245, 0, v245, vcc
    v_add_u32 v245, 0x237c0, v245
    v_mfma_f32_16x16x32_bf16 v[184:187], a[224:227], a[120:123], 0
    ds_read_b128 a[224:227], v241 offset:3072
    v_add_u32 v246, 8, v18
    v_mfma_f32_16x16x32_bf16 v[188:191], a[228:231], a[72:75], 0
    s_waitcnt lgkmcnt(9)
    v_cmp_gt_u32 vcc, 7, v246
    v_add_u32 v246, 0xfffdd670, v17
    v_mfma_f32_16x16x32_bf16 v[192:195], a[228:231], a[96:99], 0
    v_cndmask_b32 v246, 0, v246, vcc
    v_add_u32 v246, 0x237c0, v246
    v_mfma_f32_16x16x32_bf16 v[196:199], a[228:231], a[120:123], 0
    ds_read_b128 a[228:231], v241 offset:4608
    v_min_u32 v20, 55, v1
    v_mfma_f32_16x16x32_bf16 v[200:203], a[232:235], a[72:75], 0
    buffer_load_dwordx4 v174, s[8:11], s60 offen offset:2048 lds
    s_add_u32 m0, s29, 0xc00
    v_mfma_f32_16x16x32_bf16 v[228:231], a[232:235], a[96:99], 0
    s_waitcnt lgkmcnt(3)
    s_add_u32 s60, s39, 0x24000
    s_waitcnt vmcnt(6)
    v_mfma_f32_16x16x32_bf16 v[232:235], a[232:235], a[120:123], 0
    ds_read_b64_tr_b16 a[88:89], v249 offset:6144
    ds_read_b64_tr_b16 a[90:91], v250 offset:6144
    v_mfma_f32_16x16x32_bf16 v[236:239], a[236:239], a[72:75], 0
    ds_read_b64_tr_b16 a[112:113], v249 offset:6176
    ds_read_b64_tr_b16 a[114:115], v250 offset:6176
    v_mfma_f32_16x16x32_bf16 v[138:141], a[236:239], a[96:99], 0
    ds_read_b64_tr_b16 a[136:137], v249 offset:6208
    ds_read_b64_tr_b16 a[138:139], v250 offset:6208
    v_mfma_f32_16x16x32_bf16 v[142:145], a[236:239], a[120:123], 0
    ds_read_b128 a[232:235], v241 offset:30720
    ds_read_b128 a[236:239], v241 offset:32256
    v_mfma_f32_16x16x32_bf16 v[146:149], a[240:243], a[72:75], 0
    s_waitcnt lgkmcnt(9)
    v_lshlrev_b32 v62, 3, v20
    v_add_u32 v62, s64, v62
    v_mfma_f32_16x16x32_bf16 v[150:153], a[240:243], a[96:99], 0
    buffer_load_dwordx4 v172, s[8:11], s61 offen lds
    v_lshrrev_b32 v21, 1, v20
    v_mfma_f32_16x16x32_bf16 v[154:157], a[240:243], a[120:123], 0
    ds_read_b128 a[240:243], v241 offset:33792
    v_and_b32 v20, 1, v20
    v_mfma_f32_16x16x32_bf16 v[158:161], a[244:247], a[72:75], 0
    s_and_b32 s64, s48, 15
    v_lshlrev_b32 v20, 1, v20
    v_add_u32 v22, -12, v21
    v_mfma_f32_16x16x32_bf16 v[162:165], a[244:247], a[96:99], 0
    s_add_u32 s64, s64, s37
    v_cmp_lt_u32 vcc, 11, v21
    v_mov_b32 v23, s34
    v_mfma_f32_16x16x32_bf16 v[24:27], a[244:247], a[120:123], 0
    ds_read_b128 a[244:247], v241 offset:35328
    v_cndmask_b32 v22, v21, v22, vcc
    v_mfma_f32_16x16x32_bf16 v[84:87], a[216:219], a[76:79], v[84:87]
    s_waitcnt lgkmcnt(10)
    v_cndmask_b32 v23, 0, v23, vcc
    v_add_u32 v63, 0, v20
    v_mfma_f32_16x16x32_bf16 v[204:207], a[216:219], a[100:103], v[204:207]
    v_add3_u32 v64, v22, v63, -6
    v_add_u32 v65, 3, v64
    v_mfma_f32_16x16x32_bf16 v[208:211], a[216:219], a[124:127], v[208:211]
    buffer_load_dwordx4 v173, s[8:11], s61 offen offset:1024 lds
    ds_read_b128 a[216:219], v240 offset:128
    v_mfma_f32_16x16x32_bf16 v[212:215], a[220:223], a[76:79], v[212:215]
    s_waitcnt lgkmcnt(3)
    v_and_b32 v66, 12, v22
    v_add3_u32 v66, v66, v63, -3
    v_mfma_f32_16x16x32_bf16 v[216:219], a[220:223], a[100:103], v[216:219]
    v_cmp_ne_u32 vcc, 0, v23
    v_mul_i32_i24 v64, s66, v64
    v_mfma_f32_16x16x32_bf16 v[220:223], a[220:223], a[124:127], v[220:223]
    ds_read_b128 a[220:223], v240 offset:1664
    v_cndmask_b32 v65, v65, v66, vcc
    v_mfma_f32_16x16x32_bf16 v[224:227], a[224:227], a[76:79], v[224:227]
    s_waitcnt lgkmcnt(3)
    v_cmp_gt_u32 vcc, 7, v65
    v_add_lshl_u32 v64, v64, 6, 1
    v_mfma_f32_16x16x32_bf16 v[180:183], a[224:227], a[100:103], v[180:183]
    v_cndmask_b32 v50, 0, v64, vcc
    v_mov_b32 v64, 0x3fb8aa3b
    v_mfma_f32_16x16x32_bf16 v[184:187], a[224:227], a[124:127], v[184:187]
    ds_read_b128 a[224:227], v240 offset:3200
    v_cndmask_b32 v52, 0, v64, vcc
    v_mfma_f32_16x16x32_bf16 v[188:191], a[228:231], a[76:79], v[188:191]
    buffer_load_dwordx4 v174, s[8:11], s61 offen offset:2048 lds
    s_add_u32 m0, s29, 0x1800
    v_mfma_f32_16x16x32_bf16 v[192:195], a[228:231], a[100:103], v[192:195]
    s_add_u32 s61, s39, 0x2d000
    s_waitcnt vmcnt(6) lgkmcnt(3)
    v_mov_b32 v64, 0
    v_mfma_f32_16x16x32_bf16 v[196:199], a[228:231], a[124:127], v[196:199]
    ds_read_b64_tr_b16 a[92:93], v249 offset:9216
    ds_read_b64_tr_b16 a[94:95], v250 offset:9216
    v_mfma_f32_16x16x32_bf16 v[200:203], a[232:235], a[76:79], v[200:203]
    ds_read_b64_tr_b16 a[116:117], v249 offset:9248
    ds_read_b64_tr_b16 a[118:119], v250 offset:9248
    v_mfma_f32_16x16x32_bf16 v[228:231], a[232:235], a[100:103], v[228:231]
    ds_read_b64_tr_b16 a[140:141], v249 offset:9280
    ds_read_b64_tr_b16 a[142:143], v250 offset:9280
    v_mfma_f32_16x16x32_bf16 v[232:235], a[232:235], a[124:127], v[232:235]
    ds_read_b128 a[228:231], v240 offset:4736
    ds_read_b128 a[232:235], v240 offset:30848
    v_mfma_f32_16x16x32_bf16 v[236:239], a[236:239], a[76:79], v[236:239]
    s_waitcnt lgkmcnt(9)
    v_mov_b32 v65, 0xf149f2ca
    v_cndmask_b32 v60, v65, v64, vcc
    v_mfma_f32_16x16x32_bf16 v[138:141], a[236:239], a[100:103], v[138:141]
    buffer_load_dwordx4 v172, s[8:11], s62 offen lds
    v_add_u32 v63, 1, v20
    v_mfma_f32_16x16x32_bf16 v[142:145], a[236:239], a[124:127], v[142:145]
    ds_read_b128 a[236:239], v240 offset:32384
    v_add3_u32 v64, v22, v63, -6
    v_mfma_f32_16x16x32_bf16 v[146:149], a[240:243], a[76:79], v[146:149]
    s_waitcnt lgkmcnt(9)
    v_add_u32 v65, 3, v64
    v_and_b32 v66, 12, v22
    v_mfma_f32_16x16x32_bf16 v[150:153], a[240:243], a[100:103], v[150:153]
    v_add3_u32 v66, v66, v63, -3
    v_cmp_ne_u32 vcc, 0, v23
    v_mfma_f32_16x16x32_bf16 v[154:157], a[240:243], a[124:127], v[154:157]
    ds_read_b128 a[240:243], v240 offset:33920
    v_cndmask_b32 v65, v65, v66, vcc
    v_mfma_f32_16x16x32_bf16 v[158:161], a[244:247], a[76:79], v[158:161]
    v_cmp_gt_u32 vcc, 7, v65
    v_mul_i32_i24 v64, s66, v64
    v_mfma_f32_16x16x32_bf16 v[162:165], a[244:247], a[100:103], v[162:165]
    s_mul_i32 s66, s28, 0xffffee00
    v_add_lshl_u32 v64, v64, 6, 1
    v_cndmask_b32 v51, 0, v64, vcc
    v_mfma_f32_16x16x32_bf16 v[24:27], a[244:247], a[124:127], v[24:27]
    buffer_load_dwordx4 v173, s[8:11], s62 offen offset:1024 lds
    ds_read_b128 a[244:247], v240 offset:35456
    v_mfma_f32_16x16x32_bf16 v[84:87], a[216:219], a[80:83], v[84:87]
    s_waitcnt lgkmcnt(3)
    v_mov_b32 v64, 0x3fb8aa3b
    v_cndmask_b32 v53, 0, v64, vcc
    v_mfma_f32_16x16x32_bf16 v[204:207], a[216:219], a[104:107], v[204:207]
    v_mov_b32 v64, 0
    v_mov_b32 v65, 0xf149f2ca
    v_mfma_f32_16x16x32_bf16 v[208:211], a[216:219], a[128:131], v[208:211]
    ds_read_b128 a[216:219], v241 offset:128
    v_cndmask_b32 v61, v65, v64, vcc
    v_mfma_f32_16x16x32_bf16 v[212:215], a[220:223], a[80:83], v[212:215]
    s_mov_b32 vcc_lo, 0xcccccccc
    s_mov_b32 vcc_hi, 0xcccccccc
    v_add_u32 v50, s64, v50
    v_mfma_f32_16x16x32_bf16 v[216:219], a[220:223], a[104:107], v[216:219]
    ds_read_u16 v30, v50 offset:3456
    v_add_u32 v51, s64, v51
    v_mfma_f32_16x16x32_bf16 v[220:223], a[220:223], a[128:131], v[220:223]
    ds_read_b128 a[220:223], v241 offset:1664
    ds_read_u16 v31, v51 offset:3456
    v_mfma_f32_16x16x32_bf16 v[224:227], a[224:227], a[80:83], v[224:227]
    buffer_load_dwordx4 v174, s[8:11], s62 offen offset:2048 lds
    s_add_u32 m0, s29, 0x2400
    v_mfma_f32_16x16x32_bf16 v[180:183], a[224:227], a[104:107], v[180:183]
    s_lshl_b32 s62, s28, 5
    s_add_u32 s62, s62, 0
    v_mov_b32 v64, 0xf149f2ca
    v_mfma_f32_16x16x32_bf16 v[184:187], a[224:227], a[128:131], v[184:187]
    ds_read_b128 a[224:227], v241 offset:3200
    ds_read_u16 v32, v50 offset:3482
    v_mfma_f32_16x16x32_bf16 v[188:191], a[228:231], a[80:83], v[188:191]
    ds_read_u16 v33, v51 offset:3482
    ds_read_u16 v34, v50 offset:3508
    v_mfma_f32_16x16x32_bf16 v[192:195], a[228:231], a[104:107], v[192:195]
    ds_read_u16 v35, v51 offset:3508
    ds_read_u16 v36, v50 offset:3534
    v_mfma_f32_16x16x32_bf16 v[196:199], a[228:231], a[128:131], v[196:199]
    ds_read_b128 a[228:231], v241 offset:4736
    ds_read_u16 v37, v51 offset:3534
    v_mfma_f32_16x16x32_bf16 v[200:203], a[232:235], a[80:83], v[200:203]
    ds_read_u16 v38, v50 offset:3560
    buffer_load_dwordx4 v172, s[8:11], s63 offen lds
    v_mfma_f32_16x16x32_bf16 v[228:231], a[232:235], a[104:107], v[228:231]
    s_waitcnt vmcnt(7) lgkmcnt(10)
    ds_read_b64_tr_b16 a[144:145], v249 offset:0
    v_mfma_f32_16x16x32_bf16 v[232:235], a[232:235], a[128:131], v[232:235]
    ds_read_b64_tr_b16 a[146:147], v250 offset:0
    ds_read_b64_tr_b16 a[168:169], v249 offset:32
    v_mfma_f32_16x16x32_bf16 v[236:239], a[236:239], a[80:83], v[236:239]
    ds_read_b64_tr_b16 a[170:171], v250 offset:32
    ds_read_b64_tr_b16 a[192:193], v249 offset:64
    v_mfma_f32_16x16x32_bf16 v[138:141], a[236:239], a[104:107], v[138:141]
    ds_read_b64_tr_b16 a[194:195], v250 offset:64
    ds_read_b128 a[232:235], v241 offset:30848
    v_mfma_f32_16x16x32_bf16 v[142:145], a[236:239], a[128:131], v[142:145]
    ds_read_b128 a[236:239], v241 offset:32384
    ds_read_u16 v39, v51 offset:3560
    v_mfma_f32_16x16x32_bf16 v[146:149], a[240:243], a[80:83], v[146:149]
    ds_read_u16 v40, v50 offset:3586
    ds_read_u16 v41, v51 offset:3586
    v_mfma_f32_16x16x32_bf16 v[150:153], a[240:243], a[104:107], v[150:153]
    buffer_load_dwordx4 v173, s[8:11], s63 offen offset:1024 lds
    ds_read_u16 v42, v50 offset:3612
    v_mfma_f32_16x16x32_bf16 v[154:157], a[240:243], a[128:131], v[154:157]
    ds_read_b128 a[240:243], v241 offset:33920
    ds_read_u16 v43, v51 offset:3612
    v_mfma_f32_16x16x32_bf16 v[158:161], a[244:247], a[80:83], v[158:161]
    ds_read_u16 v44, v50 offset:3638
    v_lshlrev_b32 v30, 16, v30
    v_mfma_f32_16x16x32_bf16 v[162:165], a[244:247], a[104:107], v[162:165]
    ds_read_u16 v45, v51 offset:3638
    ds_read_u16 v46, v50 offset:3664
    v_mfma_f32_16x16x32_bf16 v[24:27], a[244:247], a[128:131], v[24:27]
    ds_read_b128 a[244:247], v241 offset:35456
    ds_read_u16 v47, v51 offset:3664
    v_mfma_f32_16x16x32_bf16 v[84:87], a[216:219], a[84:87], v[84:87]
    ds_read_u16 v48, v50 offset:3690
    v_fma_f32 v30, v30, v52, v60
    v_mfma_f32_16x16x32_bf16 v[204:207], a[216:219], a[108:111], v[204:207]
    ds_read_u16 v49, v51 offset:3690
    buffer_load_dwordx4 v174, s[8:11], s63 offen offset:2048 lds
    v_mfma_f32_16x16x32_bf16 v[208:211], a[216:219], a[132:135], v[208:211]
    s_add_u32 m0, s29, 0
    s_waitcnt lgkmcnt(11)
    s_lshl_b32 s63, s28, 5
    v_mfma_f32_16x16x32_bf16 v[212:215], a[220:223], a[84:87], v[212:215]
    s_add_u32 s63, s63, 0x4800
    ds_read_b128 a[216:219], v240 offset:256
    v_mfma_f32_16x16x32_bf16 v[216:219], a[220:223], a[108:111], v[216:219]
    s_waitcnt lgkmcnt(10)
    v_lshlrev_b32 v31, 16, v31
    v_fma_f32 v31, v31, v53, v61
    v_mfma_f32_16x16x32_bf16 v[220:223], a[220:223], a[132:135], v[220:223]
    ds_read_b128 a[220:223], v240 offset:1792
    v_lshlrev_b32 v32, 16, v32
    v_mfma_f32_16x16x32_bf16 v[224:227], a[224:227], a[84:87], v[224:227]
    ds_write_b64 v62, v[30:31] offset:0
    v_mfma_f32_16x16x32_bf16 v[180:183], a[224:227], a[108:111], v[180:183]
    s_waitcnt lgkmcnt(6)
    v_add_u32 v62, s49, v62
    v_fma_f32 v32, v32, v52, v60
    v_mfma_f32_16x16x32_bf16 v[184:187], a[224:227], a[132:135], v[184:187]
    ds_read_b128 a[224:227], v240 offset:3328
    buffer_load_dwordx4 v172, s[8:11], s60 offen lds
    v_mfma_f32_16x16x32_bf16 v[188:191], a[228:231], a[84:87], v[188:191]
    s_waitcnt lgkmcnt(4)
    v_lshlrev_b32 v33, 16, v33
    s_waitcnt vmcnt(7)
    v_mfma_f32_16x16x32_bf16 v[192:195], a[228:231], a[108:111], v[192:195]
    ds_read_b64_tr_b16 a[148:149], v249 offset:3072
    ds_read_b64_tr_b16 a[150:151], v250 offset:3072
    v_mfma_f32_16x16x32_bf16 v[196:199], a[228:231], a[132:135], v[196:199]
    ds_read_b64_tr_b16 a[172:173], v249 offset:3104
    ds_read_b64_tr_b16 a[174:175], v250 offset:3104
    v_mfma_f32_16x16x32_bf16 v[200:203], a[232:235], a[84:87], v[200:203]
    ds_read_b64_tr_b16 a[196:197], v249 offset:3136
    ds_read_b64_tr_b16 a[198:199], v250 offset:3136
    v_mfma_f32_16x16x32_bf16 v[228:231], a[232:235], a[108:111], v[228:231]
    ds_read_b128 a[228:231], v240 offset:4864
    v_fma_f32 v33, v33, v53, v61
    v_mfma_f32_16x16x32_bf16 v[232:235], a[232:235], a[132:135], v[232:235]
    ds_read_b128 a[232:235], v240 offset:30976
    v_lshlrev_b32 v34, 16, v34
    v_mfma_f32_16x16x32_bf16 v[236:239], a[236:239], a[84:87], v[236:239]
    buffer_load_dwordx4 v173, s[8:11], s60 offen offset:1024 lds
    v_fma_f32 v34, v34, v52, v60
    v_mfma_f32_16x16x32_bf16 v[138:141], a[236:239], a[108:111], v[138:141]
    ds_write_b64 v62, v[32:33] offset:0
    v_mfma_f32_16x16x32_bf16 v[142:145], a[236:239], a[132:135], v[142:145]
    ds_read_b128 a[236:239], v240 offset:32512
    v_add_u32 v62, s49, v62
    v_mfma_f32_16x16x32_bf16 v[146:149], a[240:243], a[84:87], v[146:149]
    s_waitcnt lgkmcnt(10)
    v_lshlrev_b32 v35, 16, v35
    v_fma_f32 v35, v35, v53, v61
    v_mfma_f32_16x16x32_bf16 v[150:153], a[240:243], a[108:111], v[150:153]
    ds_write_b64 v62, v[34:35] offset:0
    v_mfma_f32_16x16x32_bf16 v[154:157], a[240:243], a[132:135], v[154:157]
    ds_read_b128 a[240:243], v240 offset:34048
    v_add_u32 v62, s49, v62
    v_mfma_f32_16x16x32_bf16 v[158:161], a[244:247], a[84:87], v[158:161]
    v_lshlrev_b32 v36, 16, v36
    v_fma_f32 v36, v36, v52, v60
    v_mfma_f32_16x16x32_bf16 v[162:165], a[244:247], a[108:111], v[162:165]
    buffer_load_dwordx4 v174, s[8:11], s60 offen offset:2048 lds
    s_add_u32 m0, s29, 0xc00
    v_mfma_f32_16x16x32_bf16 v[24:27], a[244:247], a[132:135], v[24:27]
    s_waitcnt lgkmcnt(4)
    s_lshl_b32 s60, s28, 5
    s_add_u32 s60, s60, 0x1800
    v_mfma_f32_16x16x32_bf16 v[84:87], a[216:219], a[88:91], v[84:87]
    ds_read_b128 a[244:247], v240 offset:35584
    v_lshlrev_b32 v37, 16, v37
    v_mfma_f32_16x16x32_bf16 v[204:207], a[216:219], a[112:115], v[204:207]
    s_waitcnt lgkmcnt(3)
    v_fma_f32 v37, v37, v53, v61
    v_lshlrev_b32 v38, 16, v38
    v_mfma_f32_16x16x32_bf16 v[208:211], a[216:219], a[136:139], v[208:211]
    ds_read_b128 a[216:219], v241 offset:256
    v_fma_f32 v38, v38, v52, v60
    v_mfma_f32_16x16x32_bf16 v[212:215], a[220:223], a[88:91], v[212:215]
    ds_write_b64 v62, v[36:37] offset:0
    v_mfma_f32_16x16x32_bf16 v[216:219], a[220:223], a[112:115], v[216:219]
    s_waitcnt lgkmcnt(3)
    v_add_u32 v62, s49, v62
    v_lshlrev_b32 v39, 16, v39
    v_mfma_f32_16x16x32_bf16 v[220:223], a[220:223], a[136:139], v[220:223]
    buffer_load_dwordx4 v172, s[8:11], s61 offen lds
    ds_read_b128 a[220:223], v241 offset:1792
    v_mfma_f32_16x16x32_bf16 v[224:227], a[224:227], a[88:91], v[224:227]
    s_waitcnt vmcnt(7)
    ds_read_b64_tr_b16 a[152:153], v249 offset:6144
    v_mfma_f32_16x16x32_bf16 v[180:183], a[224:227], a[112:115], v[180:183]
    ds_read_b64_tr_b16 a[154:155], v250 offset:6144
    ds_read_b64_tr_b16 a[176:177], v249 offset:6176
    v_mfma_f32_16x16x32_bf16 v[184:187], a[224:227], a[136:139], v[184:187]
    ds_read_b64_tr_b16 a[178:179], v250 offset:6176
    ds_read_b64_tr_b16 a[200:201], v249 offset:6208
    v_mfma_f32_16x16x32_bf16 v[188:191], a[228:231], a[88:91], v[188:191]
    ds_read_b64_tr_b16 a[202:203], v250 offset:6208
    ds_read_b128 a[224:227], v241 offset:3328
    v_mfma_f32_16x16x32_bf16 v[192:195], a[228:231], a[112:115], v[192:195]
    s_waitcnt lgkmcnt(9)
    v_fma_f32 v39, v39, v53, v61
    v_lshlrev_b32 v40, 16, v40
    v_mfma_f32_16x16x32_bf16 v[196:199], a[228:231], a[136:139], v[196:199]
    ds_read_b128 a[228:231], v241 offset:4864
    buffer_load_dwordx4 v173, s[8:11], s61 offen offset:1024 lds
    v_mfma_f32_16x16x32_bf16 v[200:203], a[232:235], a[88:91], v[200:203]
    ds_write_b64 v62, v[38:39] offset:0
    v_mfma_f32_16x16x32_bf16 v[228:231], a[232:235], a[112:115], v[228:231]
    s_waitcnt lgkmcnt(9)
    v_add_u32 v62, s49, v62
    v_fma_f32 v40, v40, v52, v60
    v_mfma_f32_16x16x32_bf16 v[232:235], a[232:235], a[136:139], v[232:235]
    ds_read_b128 a[232:235], v241 offset:30976
    v_lshlrev_b32 v41, 16, v41
    v_mfma_f32_16x16x32_bf16 v[236:239], a[236:239], a[88:91], v[236:239]
    v_fma_f32 v41, v41, v53, v61
    v_lshlrev_b32 v42, 16, v42
    v_mfma_f32_16x16x32_bf16 v[138:141], a[236:239], a[112:115], v[138:141]
    ds_write_b64 v62, v[40:41] offset:0
    v_mfma_f32_16x16x32_bf16 v[142:145], a[236:239], a[136:139], v[142:145]
    ds_read_b128 a[236:239], v241 offset:32512
    v_add_u32 v62, s49, v62
    v_mfma_f32_16x16x32_bf16 v[146:149], a[240:243], a[88:91], v[146:149]
    buffer_load_dwordx4 v174, s[8:11], s61 offen offset:2048 lds
    s_add_u32 m0, s46, 0x1800
    v_mfma_f32_16x16x32_bf16 v[150:153], a[240:243], a[112:115], v[150:153]
    s_lshl_b32 s61, s28, 5
    s_add_u32 s61, s61, 0x6000
    v_fma_f32 v42, v42, v52, v60
    v_mfma_f32_16x16x32_bf16 v[154:157], a[240:243], a[136:139], v[154:157]
    ds_read_b128 a[240:243], v241 offset:34048
    v_lshlrev_b32 v43, 16, v43
    v_mfma_f32_16x16x32_bf16 v[158:161], a[244:247], a[88:91], v[158:161]
    s_waitcnt lgkmcnt(5)
    v_fma_f32 v43, v43, v53, v61
    v_lshlrev_b32 v44, 16, v44
    v_mfma_f32_16x16x32_bf16 v[162:165], a[244:247], a[112:115], v[162:165]
    ds_write_b64 v62, v[42:43] offset:0
    v_mfma_f32_16x16x32_bf16 v[24:27], a[244:247], a[136:139], v[24:27]
    ds_read_b128 a[244:247], v241 offset:35584
    v_add_u32 v62, s49, v62
    v_mfma_f32_16x16x32_bf16 v[84:87], a[216:219], a[92:95], v[84:87]
    s_waitcnt lgkmcnt(5)
    v_fma_f32 v44, v44, v52, v60
    v_lshlrev_b32 v45, 16, v45
    v_mfma_f32_16x16x32_bf16 v[204:207], a[216:219], a[116:119], v[204:207]
    buffer_load_dwordx4 v168, s[4:7], s58 offen lds
    s_waitcnt vmcnt(7) lgkmcnt(3)
    v_mfma_f32_16x16x32_bf16 v[208:211], a[216:219], a[140:143], v[208:211]
    ds_read_b64_tr_b16 a[156:157], v249 offset:9216
    ds_read_b64_tr_b16 a[158:159], v250 offset:9216
    v_mfma_f32_16x16x32_bf16 v[212:215], a[220:223], a[92:95], v[212:215]
    ds_read_b64_tr_b16 a[180:181], v249 offset:9248
    ds_read_b64_tr_b16 a[182:183], v250 offset:9248
    v_mfma_f32_16x16x32_bf16 v[216:219], a[220:223], a[116:119], v[216:219]
    ds_read_b64_tr_b16 a[204:205], v249 offset:9280
    ds_read_b64_tr_b16 a[206:207], v250 offset:9280
    v_mfma_f32_16x16x32_bf16 v[220:223], a[220:223], a[140:143], v[220:223]
    buffer_load_dwordx4 v171, s[4:7], s58 offen offset:512 lds
    s_lshl1_add_u32 s58, s45, s41
    v_mfma_f32_16x16x32_bf16 v[224:227], a[224:227], a[92:95], v[224:227]
    s_add_u32 m0, s46, 0x9000
    v_cvt_pk_bf16_f32 v0, v84, v85
    v_cvt_pk_bf16_f32 v3, v86, v87
    v_mfma_f32_16x16x32_bf16 v[180:183], a[224:227], a[116:119], v[180:183]
    s_waitcnt lgkmcnt(6)
    v_cvt_pk_bf16_f32 v30, v204, v205
    v_cvt_pk_bf16_f32 v33, v206, v207
    v_mfma_f32_16x16x32_bf16 v[184:187], a[224:227], a[140:143], v[184:187]
    v_cvt_pk_bf16_f32 v6, v212, v213
    v_cvt_pk_bf16_f32 v9, v214, v215
    v_mfma_f32_16x16x32_bf16 v[188:191], a[228:231], a[92:95], v[188:191]
    buffer_load_dwordx4 v168, s[4:7], s58 offen lds
    v_cvt_pk_bf16_f32 v36, v216, v217
    v_mfma_f32_16x16x32_bf16 v[192:195], a[228:231], a[116:119], v[192:195]
    v_cvt_pk_bf16_f32 v39, v218, v219
    v_cvt_pk_bf16_f32 v66, v220, v221
    v_mfma_f32_16x16x32_bf16 v[196:199], a[228:231], a[140:143], v[196:199]
    v_cvt_pk_bf16_f32 v69, v222, v223
    v_cvt_pk_bf16_f32 v12, v224, v225
    v_mfma_f32_16x16x32_bf16 v[200:203], a[232:235], a[92:95], v[200:203]
    v_cvt_pk_bf16_f32 v15, v226, v227
    v_cvt_pk_bf16_f32 v42, v180, v181
    v_mfma_f32_16x16x32_bf16 v[228:231], a[232:235], a[116:119], v[228:231]
    buffer_load_dwordx4 v171, s[4:7], s58 offen offset:512 lds
    s_lshl1_add_u32 s58, s45, s42
    v_mfma_f32_16x16x32_bf16 v[232:235], a[232:235], a[140:143], v[232:235]
    s_add_u32 m0, s46, 0x10800
    v_cvt_pk_bf16_f32 v72, v184, v185
    v_cvt_pk_bf16_f32 v75, v186, v187
    v_mfma_f32_16x16x32_bf16 v[236:239], a[236:239], a[92:95], v[236:239]
    v_cvt_pk_bf16_f32 v18, v188, v189
    v_cvt_pk_bf16_f32 v21, v190, v191
    v_mfma_f32_16x16x32_bf16 v[138:141], a[236:239], a[116:119], v[138:141]
    v_cvt_pk_bf16_f32 v51, v194, v195
    v_cvt_pk_bf16_f32 v78, v196, v197
    v_mfma_f32_16x16x32_bf16 v[142:145], a[236:239], a[140:143], v[142:145]
    buffer_load_dwordx4 v168, s[4:7], s58 offen lds
    v_cvt_pk_bf16_f32 v81, v198, v199
    v_mfma_f32_16x16x32_bf16 v[146:149], a[240:243], a[92:95], v[146:149]
    v_cvt_pk_bf16_f32 v4, v202, v203
    v_cvt_pk_bf16_f32 v31, v228, v229
    v_mfma_f32_16x16x32_bf16 v[150:153], a[240:243], a[116:119], v[150:153]
    v_cvt_pk_bf16_f32 v34, v230, v231
    v_cvt_pk_bf16_f32 v7, v236, v237
    v_mfma_f32_16x16x32_bf16 v[154:157], a[240:243], a[140:143], v[154:157]
    v_cvt_pk_bf16_f32 v10, v238, v239
    v_cvt_pk_bf16_f32 v37, v138, v139
    v_mfma_f32_16x16x32_bf16 v[158:161], a[244:247], a[92:95], v[158:161]
    buffer_load_dwordx4 v171, s[4:7], s58 offen offset:512 lds
    v_cvt_pk_bf16_f32 v40, v140, v141
    v_mfma_f32_16x16x32_bf16 v[162:165], a[244:247], a[116:119], v[162:165]
    s_add_u32 m0, s46, 0x16800
    v_cvt_pk_bf16_f32 v67, v142, v143
    s_waitcnt vmcnt(9)
    v_mfma_f32_16x16x32_bf16 v[24:27], a[244:247], a[140:143], v[24:27]
    ds_read_b64_tr_b16 a[160:161], v249 offset:0
    ds_read_b64_tr_b16 a[162:163], v250 offset:0
    ds_read_b64_tr_b16 a[184:185], v249 offset:32
    ds_read_b64_tr_b16 a[186:187], v250 offset:32
    ds_read_b64_tr_b16 a[208:209], v249 offset:64
    ds_read_b64_tr_b16 a[210:211], v250 offset:64
    v_cvt_pk_bf16_f32 v70, v144, v145
    v_cvt_pk_bf16_f32 v13, v146, v147
    v_cvt_pk_bf16_f32 v16, v148, v149
    v_cvt_pk_bf16_f32 v43, v150, v151
    v_cvt_pk_bf16_f32 v73, v154, v155
    v_cvt_pk_bf16_f32 v76, v156, v157
    v_cvt_pk_bf16_f32 v19, v158, v159
    v_cvt_pk_bf16_f32 v22, v160, v161
    v_cvt_pk_bf16_f32 v79, v24, v25
    v_cvt_pk_bf16_f32 v82, v26, v27
    ds_read_b128 a[216:219], v240 offset:61440
    ds_read_b128 a[220:223], v241 offset:61440
    ds_read_b128 a[224:227], v240 offset:61568
    ds_read_b128 a[228:231], v241 offset:61568
    ds_read_b128 a[232:235], v240 offset:61696
    ds_read_b128 a[236:239], v241 offset:61696
    ds_read_b128 a[240:243], v240 offset:62976
    ds_read_b128 a[244:247], v241 offset:62976
    s_lshl1_add_u32 s58, s45, s43
    v_mov_b32 v195, 0
    v_fma_f32 v45, v45, v53, v61
    ds_write_b64 v62, v[44:45] offset:0
    v_cvt_pk_bf16_f32 v45, v182, v183
    v_add_u32 v62, s49, v62
    v_lshlrev_b32 v46, 16, v46
    v_fma_f32 v46, v46, v52, v60
    v_lshlrev_b32 v47, 16, v47
    v_fma_f32 v47, v47, v53, v61
    ds_write_b64 v62, v[46:47] offset:0
    v_cvt_pk_bf16_f32 v46, v152, v153
    v_add_u32 v62, s49, v62
    v_lshlrev_b32 v48, 16, v48
    s_waitcnt lgkmcnt(9)
    v_mfma_f32_16x16x32_bf16 v[228:231], a[0:3], a[216:219], 0
    v_fma_f32 v48, v48, v52, v60
    v_cvt_pk_bf16_f32 v60, v208, v209
    v_mfma_f32_16x16x32_bf16 v[236:239], a[48:51], a[216:219], 0
    s_waitcnt lgkmcnt(8)
    v_cvt_pk_bf16_f32 v52, v164, v165
    v_lshlrev_b32 v49, 16, v49
    v_mfma_f32_16x16x32_bf16 v[228:231], a[4:7], a[220:223], v[228:231]
    s_waitcnt lgkmcnt(7)
    v_fma_f32 v49, v49, v53, v61
    v_cvt_pk_bf16_f32 v61, v232, v233
    v_mfma_f32_16x16x32_bf16 v[228:231], a[8:11], a[224:227], v[228:231]
    ds_write_b64 v62, v[48:49] offset:0
    v_mfma_f32_16x16x32_bf16 v[236:239], a[52:55], a[220:223], v[236:239]
    s_waitcnt lgkmcnt(7)
    v_cvt_pk_bf16_f32 v48, v192, v193
    v_cvt_pk_bf16_f32 v49, v162, v163
    v_mfma_f32_16x16x32_bf16 v[228:231], a[12:15], a[228:231], v[228:231]
    s_waitcnt lgkmcnt(6)
    v_add_u32 v62, s49, v62
    v_mov_b32 v65, 0xf149f2ca
    v_mfma_f32_16x16x32_bf16 v[228:231], a[16:19], a[232:235], v[228:231]
    s_waitcnt lgkmcnt(5)
    v_lshlrev_b32 v63, 3, v1
    v_cvt_pk_bf16_f32 v1, v200, v201
    v_mfma_f32_16x16x32_bf16 v[228:231], a[20:23], a[236:239], v[228:231]
    s_waitcnt vmcnt(6)
    ds_read_b64_tr_b16 a[164:165], v249 offset:3072
    v_mfma_f32_16x16x32_bf16 v[236:239], a[56:59], a[224:227], v[236:239]
    ds_read_b64_tr_b16 a[166:167], v250 offset:3072
    ds_read_b64_tr_b16 a[188:189], v249 offset:3104
    v_mfma_f32_16x16x32_bf16 v[236:239], a[60:63], a[228:231], v[236:239]
    ds_read_b64_tr_b16 a[190:191], v250 offset:3104
    ds_read_b64_tr_b16 a[212:213], v249 offset:3136
    v_mfma_f32_16x16x32_bf16 v[236:239], a[64:67], a[232:235], v[236:239]
    ds_read_b64_tr_b16 a[214:215], v250 offset:3136
    v_cvt_pk_bf16_f32 v138, v228, v229
    v_mfma_f32_16x16x32_bf16 v[236:239], a[68:71], a[236:239], v[236:239]
    v_cvt_pk_bf16_f32 v139, v230, v231
    v_add_u32 v249, s66, v249
    v_mfma_f32_16x16x32_bf16 v[228:231], a[216:219], a[72:75], 0
    v_add_u32 v250, s66, v250
    s_lshl_b32 s66, s28, 1
    v_mfma_f32_16x16x32_bf16 v[228:231], a[220:223], a[76:79], v[228:231]
    v_add_u32 v63, 0x237c0, v63
    v_mfma_f32_16x16x32_bf16 v[228:231], a[224:227], a[80:83], v[228:231]
    v_cvt_pk_bf16_f32 v142, v236, v237
    v_cvt_pk_bf16_f32 v143, v238, v239
    v_mfma_f32_16x16x32_bf16 v[228:231], a[228:231], a[84:87], v[228:231]
    ds_write_b64 v63, v[64:65] offset:0
    v_mfma_f32_16x16x32_bf16 v[228:231], a[232:235], a[88:91], v[228:231]
    v_cvt_pk_bf16_f32 v63, v210, v211
    v_cvt_pk_bf16_f32 v64, v234, v235
    v_mfma_f32_16x16x32_bf16 v[232:235], a[24:27], a[216:219], 0
    ds_read_b128 v[196:199], v244 offset:192
    ds_read_b128 v[200:203], v245 offset:192
    v_mfma_f32_16x16x32_bf16 v[232:235], a[28:31], a[220:223], v[232:235]
    ds_read_b128 v[204:207], v246 offset:192
    ds_read_b128 v[208:211], v244 offset:256
    v_mfma_f32_16x16x32_bf16 v[232:235], a[32:35], a[224:227], v[232:235]
    v_mfma_f32_16x16x32_bf16 v[232:235], a[36:39], a[228:231], v[232:235]
    v_mfma_f32_16x16x32_bf16 v[232:235], a[40:43], a[232:235], v[232:235]
    v_mfma_f32_16x16x32_bf16 v[232:235], a[44:47], a[236:239], v[232:235]
    v_mfma_f32_16x16x32_bf16 v[228:231], a[236:239], a[92:95], v[228:231]
    v_mfma_f32_16x16x32_bf16 v[236:239], a[216:219], a[120:123], 0
    v_mfma_f32_16x16x32_bf16 v[236:239], a[220:223], a[124:127], v[236:239]
    v_mfma_f32_16x16x32_bf16 v[236:239], a[224:227], a[128:131], v[236:239]
    v_mfma_f32_16x16x32_bf16 v[236:239], a[228:231], a[132:135], v[236:239]
    v_mfma_f32_16x16x32_bf16 v[236:239], a[232:235], a[136:139], v[236:239]
    v_mfma_f32_16x16x32_bf16 v[236:239], a[236:239], a[140:143], v[236:239]
    s_nop 0
    v_cvt_pk_bf16_f32 v140, v232, v233
    v_cvt_pk_bf16_f32 v141, v234, v235
    v_mfma_f32_16x16x32_bf16 v[232:235], a[216:219], a[96:99], 0
    v_cvt_pk_bf16_f32 v2, v228, v229
    v_cvt_pk_bf16_f32 v5, v230, v231
    v_mfma_f32_16x16x32_bf16 v[232:235], a[220:223], a[100:103], v[232:235]
    ds_read_b128 a[216:219], v240 offset:63104
    v_cvt_pk_bf16_f32 v62, v236, v237
    v_mfma_f32_16x16x32_bf16 v[232:235], a[224:227], a[104:107], v[232:235]
    ds_read_b128 a[220:223], v241 offset:63104
    v_cvt_pk_bf16_f32 v65, v238, v239
    v_mfma_f32_16x16x32_bf16 v[232:235], a[228:231], a[108:111], v[232:235]
    ds_read_b128 a[224:227], v240 offset:63232
    ds_read_b128 a[228:231], v241 offset:63232
    v_mfma_f32_16x16x32_bf16 v[232:235], a[232:235], a[112:115], v[232:235]
    ds_read_b128 a[232:235], v240 offset:64512
    s_waitcnt lgkmcnt(5)
    v_mfma_f32_16x16x32_bf16 v[232:235], a[236:239], a[116:119], v[232:235]
    ds_read_b128 a[236:239], v241 offset:64512
    s_waitcnt vmcnt(0)
    v_mfma_f32_16x16x32_bf16 v[228:231], a[0:3], a[240:243], 0
    s_barrier
    buffer_load_dwordx4 v254, s[4:7], s43 offen lds
    v_mfma_f32_16x16x32_bf16 v[228:231], a[4:7], a[244:247], v[228:231]
    v_accvgpr_read_b32 v254, a254
    v_mfma_f32_16x16x32_bf16 v[236:239], a[48:51], a[240:243], 0
    v_cvt_pk_bf16_f32 v32, v232, v233
    v_cvt_pk_bf16_f32 v35, v234, v235
    v_mfma_f32_16x16x32_bf16 v[232:235], a[24:27], a[240:243], 0
    v_mfma_f32_16x16x32_bf16 v[232:235], a[28:31], a[244:247], v[232:235]
    buffer_load_dwordx4 v255, s[4:7], s43 offen offset:1024 lds
    v_accvgpr_read_b32 v255, a252
    v_mfma_f32_16x16x32_bf16 v[236:239], a[52:55], a[244:247], v[236:239]
    s_waitcnt lgkmcnt(5)
    v_mfma_f32_16x16x32_bf16 v[228:231], a[8:11], a[216:219], v[228:231]
    s_waitcnt lgkmcnt(4)
    v_mfma_f32_16x16x32_bf16 v[228:231], a[12:15], a[220:223], v[228:231]
    s_waitcnt lgkmcnt(3)
    v_mfma_f32_16x16x32_bf16 v[228:231], a[16:19], a[224:227], v[228:231]
    buffer_load_dwordx4 v254, s[4:7], s43 offen offset:2048 lds
    s_add_u32 m0, s46, 0x17400
    v_mfma_f32_16x16x32_bf16 v[232:235], a[32:35], a[216:219], v[232:235]
    s_waitcnt lgkmcnt(2)
    v_accvgpr_read_b32 v254, a253
    v_mfma_f32_16x16x32_bf16 v[228:231], a[20:23], a[228:231], v[228:231]
    v_mfma_f32_16x16x32_bf16 v[232:235], a[36:39], a[220:223], v[232:235]
    v_mfma_f32_16x16x32_bf16 v[232:235], a[40:43], a[224:227], v[232:235]
    buffer_load_dwordx4 v255, s[4:7], s59 offen lds
    v_accvgpr_read_b32 v255, a254
    v_mfma_f32_16x16x32_bf16 v[232:235], a[44:47], a[228:231], v[232:235]
    v_mfma_f32_16x16x32_bf16 v[236:239], a[56:59], a[216:219], v[236:239]
    v_mfma_f32_16x16x32_bf16 v[236:239], a[60:63], a[220:223], v[236:239]
    v_mfma_f32_16x16x32_bf16 v[236:239], a[64:67], a[224:227], v[236:239]
    v_cvt_pk_bf16_f32 v144, v228, v229
    v_cvt_pk_bf16_f32 v145, v230, v231
    v_mfma_f32_16x16x32_bf16 v[236:239], a[68:71], a[228:231], v[236:239]
    buffer_load_dwordx4 v254, s[4:7], s59 offen offset:1024 lds
    v_accvgpr_read_b32 v254, a252
    v_mfma_f32_16x16x32_bf16 v[228:231], a[240:243], a[72:75], 0
    v_cvt_pk_bf16_f32 v146, v232, v233
    v_cvt_pk_bf16_f32 v147, v234, v235
    v_mfma_f32_16x16x32_bf16 v[228:231], a[244:247], a[76:79], v[228:231]
    v_mfma_f32_16x16x32_bf16 v[228:231], a[216:219], a[80:83], v[228:231]
    v_mfma_f32_16x16x32_bf16 v[228:231], a[220:223], a[84:87], v[228:231]
    v_cvt_pk_bf16_f32 v148, v236, v237
    v_cvt_pk_bf16_f32 v149, v238, v239
    v_mfma_f32_16x16x32_bf16 v[228:231], a[224:227], a[88:91], v[228:231]
    buffer_load_dwordx4 v255, s[4:7], s59 offen offset:2048 lds
    s_add_u32 m0, s46, 0x18000
    v_mfma_f32_16x16x32_bf16 v[228:231], a[228:231], a[92:95], v[228:231]
    s_add_u32 s59, s44, s45
    v_accvgpr_read_b32 v255, a255
    v_mfma_f32_16x16x32_bf16 v[232:235], a[240:243], a[96:99], 0
    v_mfma_f32_16x16x32_bf16 v[232:235], a[244:247], a[100:103], v[232:235]
    v_mfma_f32_16x16x32_bf16 v[232:235], a[216:219], a[104:107], v[232:235]
    buffer_load_dwordx4 v254, s[4:7], s58 offen lds
    v_xor_b32 v254, 16, v242
    v_mfma_f32_16x16x32_bf16 v[232:235], a[220:223], a[108:111], v[232:235]
    v_cvt_pk_bf16_f32 v8, v228, v229
    v_cvt_pk_bf16_f32 v11, v230, v231
    v_mfma_f32_16x16x32_bf16 v[232:235], a[224:227], a[112:115], v[232:235]
    s_waitcnt lgkmcnt(0)
    v_add_u32 v254, 0x7500, v254
    v_cndmask_b32 v254, v242, v254, vcc
    v_mfma_f32_16x16x32_bf16 v[232:235], a[228:231], a[116:119], v[232:235]
    s_mov_b32 vcc_lo, 0x33333333
    s_mov_b32 vcc_hi, 0x33333333
    v_mfma_f32_16x16x32_bf16 v[236:239], a[240:243], a[120:123], 0
    ds_read_b128 a[240:243], v240 offset:64640
    buffer_load_dwordx4 v255, s[4:7], s58 offen offset:512 lds
    v_mfma_f32_16x16x32_bf16 v[236:239], a[244:247], a[124:127], v[236:239]
    ds_read_b128 a[244:247], v241 offset:64640
    v_xor_b32 v255, 64, v254
    v_mfma_f32_16x16x32_bf16 v[236:239], a[216:219], a[128:131], v[236:239]
    s_add_u32 m0, s46, 0
    v_cvt_pk_bf16_f32 v38, v232, v233
    v_cvt_pk_bf16_f32 v41, v234, v235
    v_mfma_f32_16x16x32_bf16 v[236:239], a[220:223], a[132:135], v[236:239]
    ds_read_b128 a[216:219], v240 offset:64768
    ds_read_b128 a[220:223], v241 offset:64768
    v_mfma_f32_16x16x32_bf16 v[236:239], a[224:227], a[136:139], v[236:239]
    ds_read_b128 a[224:227], v242 offset:0
    v_add_u32 v240, 0xf000, v240
    v_mfma_f32_16x16x32_bf16 v[236:239], a[228:231], a[140:143], v[236:239]
    ds_read_b128 a[228:231], v243 offset:0
    v_add_u32 v241, 0xf000, v241
    v_mfma_f32_16x16x32_bf16 v[228:231], a[0:3], a[232:235], 0
    s_lshl1_add_u32 s58, s45, s44
    v_mfma_f32_16x16x32_bf16 v[228:231], a[4:7], a[236:239], v[228:231]
    v_mfma_f32_16x16x32_bf16 v[232:235], a[24:27], a[232:235], 0
    s_waitcnt lgkmcnt(5)
    v_mfma_f32_16x16x32_bf16 v[228:231], a[8:11], a[240:243], v[228:231]
    v_cvt_pk_bf16_f32 v68, v236, v237
    v_cvt_pk_bf16_f32 v71, v238, v239
    v_mfma_f32_16x16x32_bf16 v[232:235], a[28:31], a[236:239], v[232:235]
    s_waitcnt lgkmcnt(4)
    v_mfma_f32_16x16x32_bf16 v[228:231], a[12:15], a[244:247], v[228:231]
    v_mfma_f32_16x16x32_bf16 v[232:235], a[32:35], a[240:243], v[232:235]
    s_waitcnt lgkmcnt(3)
    v_mfma_f32_16x16x32_bf16 v[228:231], a[16:19], a[216:219], v[228:231]
    s_waitcnt lgkmcnt(2)
    v_mfma_f32_16x16x32_bf16 v[228:231], a[20:23], a[220:223], v[228:231]
    v_mfma_f32_16x16x32_bf16 v[232:235], a[36:39], a[244:247], v[232:235]
    v_mfma_f32_16x16x32_bf16 v[232:235], a[40:43], a[216:219], v[232:235]
    v_mfma_f32_16x16x32_bf16 v[232:235], a[44:47], a[220:223], v[232:235]
    v_mfma_f32_16x16x32_bf16 v[236:239], a[48:51], a[232:235], 0
    v_mfma_f32_16x16x32_bf16 v[236:239], a[52:55], a[236:239], v[236:239]
    v_mfma_f32_16x16x32_bf16 v[236:239], a[56:59], a[240:243], v[236:239]
    v_mfma_f32_16x16x32_bf16 v[236:239], a[60:63], a[244:247], v[236:239]
    v_mfma_f32_16x16x32_bf16 v[236:239], a[64:67], a[216:219], v[236:239]
    v_cvt_pk_bf16_f32 v150, v228, v229
    v_cvt_pk_bf16_f32 v151, v230, v231
    v_mfma_f32_16x16x32_bf16 v[236:239], a[68:71], a[220:223], v[236:239]
    v_cvt_pk_bf16_f32 v152, v232, v233
    v_cvt_pk_bf16_f32 v153, v234, v235
    v_mfma_f32_16x16x32_bf16 v[228:231], a[232:235], a[72:75], 0
    v_mfma_f32_16x16x32_bf16 v[228:231], a[236:239], a[76:79], v[228:231]
    v_mfma_f32_16x16x32_bf16 v[228:231], a[240:243], a[80:83], v[228:231]
    v_mfma_f32_16x16x32_bf16 v[228:231], a[244:247], a[84:87], v[228:231]
    v_mfma_f32_16x16x32_bf16 v[228:231], a[216:219], a[88:91], v[228:231]
    v_mfma_f32_16x16x32_bf16 v[228:231], a[220:223], a[92:95], v[228:231]
    v_cvt_pk_bf16_f32 v154, v236, v237
    v_cvt_pk_bf16_f32 v155, v238, v239
    v_mfma_f32_16x16x32_bf16 v[232:235], a[232:235], a[96:99], 0
    v_mfma_f32_16x16x32_bf16 v[232:235], a[236:239], a[100:103], v[232:235]
    v_mfma_f32_16x16x32_bf16 v[232:235], a[240:243], a[104:107], v[232:235]
    v_mfma_f32_16x16x32_bf16 v[232:235], a[244:247], a[108:111], v[232:235]
    v_mfma_f32_16x16x32_bf16 v[232:235], a[216:219], a[112:115], v[232:235]
    v_mfma_f32_16x16x32_bf16 v[232:235], a[220:223], a[116:119], v[232:235]
    v_cvt_pk_bf16_f32 v14, v228, v229
    v_cvt_pk_bf16_f32 v17, v230, v231
    v_mfma_f32_16x16x32_bf16 v[236:239], a[232:235], a[120:123], 0
    ds_read_b128 a[232:235], v242 offset:128
    s_waitcnt lgkmcnt(1)
    v_mfma_f32_16x16x32_bf16 v[236:239], a[236:239], a[124:127], v[236:239]
    ds_read_b128 a[236:239], v243 offset:128
    v_mfma_f32_16x16x32_bf16 v[236:239], a[240:243], a[128:131], v[236:239]
    v_cvt_pk_bf16_f32 v44, v232, v233
    v_cvt_pk_bf16_f32 v47, v234, v235
    v_mfma_f32_16x16x32_bf16 v[236:239], a[244:247], a[132:135], v[236:239]
    ds_read_b128 a[240:243], v242 offset:256
    ds_read_b128 a[244:247], v243 offset:256
    v_mfma_f32_16x16x32_bf16 v[236:239], a[216:219], a[136:139], v[236:239]
    ds_read_b128 a[216:219], v240 offset:4608
    v_mfma_f32_16x16x32_bf16 v[236:239], a[220:223], a[140:143], v[236:239]
    ds_read_b128 a[220:223], v241 offset:4608
    v_mfma_f32_16x16x32_bf16 v[228:231], a[144:147], a[224:227], 0
    v_mfma_f32_16x16x32_bf16 v[228:231], a[148:151], a[228:231], v[228:231]
    v_mfma_f32_16x16x32_bf16 v[232:235], a[168:171], a[224:227], 0
    v_mfma_f32_16x16x32_bf16 v[232:235], a[172:175], a[228:231], v[232:235]
    s_waitcnt lgkmcnt(5)
    v_mfma_f32_16x16x32_bf16 v[228:231], a[152:155], a[232:235], v[228:231]
    s_waitcnt lgkmcnt(4)
    v_cvt_pk_bf16_f32 v74, v236, v237
    v_cvt_pk_bf16_f32 v77, v238, v239
    v_mfma_f32_16x16x32_bf16 v[228:231], a[156:159], a[236:239], v[228:231]
    v_mfma_f32_16x16x32_bf16 v[232:235], a[176:179], a[232:235], v[232:235]
    s_waitcnt lgkmcnt(3)
    v_mfma_f32_16x16x32_bf16 v[228:231], a[160:163], a[240:243], v[228:231]
    s_waitcnt lgkmcnt(2)
    v_mfma_f32_16x16x32_bf16 v[228:231], a[164:167], a[244:247], v[228:231]
    v_mfma_f32_16x16x32_bf16 v[232:235], a[180:183], a[236:239], v[232:235]
    v_mfma_f32_16x16x32_bf16 v[232:235], a[184:187], a[240:243], v[232:235]
    v_mfma_f32_16x16x32_bf16 v[232:235], a[188:191], a[244:247], v[232:235]
    v_mfma_f32_16x16x32_bf16 v[236:239], a[192:195], a[224:227], 0
    ds_read_b128 a[224:227], v240 offset:4736
    v_mfma_f32_16x16x32_bf16 v[236:239], a[196:199], a[228:231], v[236:239]
    ds_read_b128 a[228:231], v241 offset:4736
    v_mfma_f32_16x16x32_bf16 v[236:239], a[200:203], a[232:235], v[236:239]
    v_mul_f32 v228, s38, v228
    v_mul_f32 v229, s38, v229
    v_mfma_f32_16x16x32_bf16 v[236:239], a[204:207], a[236:239], v[236:239]
    v_mul_f32 v230, s38, v230
    v_mul_f32 v231, s38, v231
    v_mfma_f32_16x16x32_bf16 v[236:239], a[208:211], a[240:243], v[236:239]
    v_cvt_pk_bf16_f32 v168, v228, v229
    v_cvt_pk_bf16_f32 v169, v230, v231
    v_mfma_f32_16x16x32_bf16 v[236:239], a[212:215], a[244:247], v[236:239]
    s_waitcnt lgkmcnt(2)
    v_mul_f32 v232, s3, v232
    v_mul_f32 v233, s3, v233
    v_mfma_f32_16x16x32_bf16 v[228:231], a[0:3], a[216:219], 0
    v_mul_f32 v234, s3, v234
    v_mul_f32 v235, s3, v235
    v_mfma_f32_16x16x32_bf16 v[228:231], a[4:7], a[220:223], v[228:231]
    v_cvt_pk_bf16_f32 v170, v232, v233
    v_cvt_pk_bf16_f32 v171, v234, v235
    v_mfma_f32_16x16x32_bf16 v[232:235], a[24:27], a[216:219], 0
    v_mul_f32 v236, s38, v236
    v_mul_f32 v237, s38, v237
    v_mfma_f32_16x16x32_bf16 v[196:199], v[102:105], v[168:171], v[196:199]
    s_waitcnt lgkmcnt(1)
    v_mul_f32 v238, s38, v238
    v_mul_f32 v239, s38, v239
    v_mfma_f32_16x16x32_bf16 v[200:203], v[114:117], v[168:171], v[200:203]
    v_cvt_pk_bf16_f32 v172, v236, v237
    v_cvt_pk_bf16_f32 v173, v238, v239
    v_mfma_f32_16x16x32_bf16 v[204:207], v[138:141], v[168:171], v[204:207]
    ds_read_b128 a[232:235], v240 offset:4864
    ds_read_b128 a[236:239], v241 offset:4864
    v_mfma_f32_16x16x32_bf16 v[196:199], v[104:107], v[170:173], v[196:199]
    ds_read_b128 a[240:243], v242 offset:1536
    ds_read_b128 a[244:247], v243 offset:1536
    v_mfma_f32_16x16x32_bf16 v[200:203], v[116:119], v[170:173], v[200:203]
    v_add_u32 v240, 0xffff1000, v240
    v_add_u32 v241, 0xffff1000, v241
    v_mfma_f32_16x16x32_bf16 v[204:207], v[140:143], v[170:173], v[204:207]
    v_mfma_f32_16x16x32_bf16 v[208:211], v[108:111], v[168:171], v[208:211]
    v_mfma_f32_16x16x32_bf16 v[208:211], v[110:113], v[170:173], v[208:211]
    v_max_f32 v248, v196, v197
    v_max3_f32 v248, v248, v198, v199
    v_mfma_f32_16x16x32_bf16 v[228:231], a[8:11], a[224:227], v[228:231]
    ds_read_b128 v[196:199], v245 offset:256
    v_max3_f32 v248, v248, v200, v201
    v_mfma_f32_16x16x32_bf16 v[232:235], a[28:31], a[220:223], v[232:235]
    s_waitcnt lgkmcnt(5)
    v_max3_f32 v248, v248, v202, v203
    v_max3_f32 v248, v248, v204, v205
    v_mfma_f32_16x16x32_bf16 v[228:231], a[12:15], a[228:231], v[228:231]
    ds_read_b128 v[200:203], v246 offset:256
    v_max3_f32 v248, v248, v206, v207
    v_mfma_f32_16x16x32_bf16 v[232:235], a[32:35], a[224:227], v[232:235]
    ds_read_b128 v[204:207], v244 offset:320
    v_max3_f32 v248, v248, v208, v209
    v_mfma_f32_16x16x32_bf16 v[232:235], a[36:39], a[228:231], v[232:235]
    s_waitcnt lgkmcnt(6)
    v_max3_f32 v248, v248, v210, v211
    v_mfma_f32_16x16x32_bf16 v[228:231], a[16:19], a[232:235], v[228:231]
    ds_read_b128 v[208:211], v245 offset:320
    s_waitcnt lgkmcnt(6)
    v_mfma_f32_16x16x32_bf16 v[228:231], a[20:23], a[236:239], v[228:231]
    v_mfma_f32_16x16x32_bf16 v[232:235], a[40:43], a[232:235], v[232:235]
    v_mfma_f32_16x16x32_bf16 v[232:235], a[44:47], a[236:239], v[232:235]
    v_mfma_f32_16x16x32_bf16 v[236:239], a[48:51], a[216:219], 0
    s_waitcnt lgkmcnt(3)
    v_mfma_f32_16x16x32_bf16 v[196:199], v[120:123], v[168:171], v[196:199]
    v_mfma_f32_16x16x32_bf16 v[196:199], v[122:125], v[170:173], v[196:199]
    s_waitcnt lgkmcnt(2)
    s_waitcnt lgkmcnt(1)
    v_cvt_pk_bf16_f32 v156, v228, v229
    v_mfma_f32_16x16x32_bf16 v[200:203], v[144:147], v[168:171], v[200:203]
    v_cvt_pk_bf16_f32 v157, v230, v231
    v_cvt_pk_bf16_f32 v158, v232, v233
    v_mfma_f32_16x16x32_bf16 v[200:203], v[146:149], v[170:173], v[200:203]
    v_cvt_pk_bf16_f32 v159, v234, v235
    v_max3_f32 v248, v248, v196, v197
    v_mfma_f32_16x16x32_bf16 v[204:207], v[90:93], v[168:171], v[204:207]
    s_waitcnt lgkmcnt(0)
    v_max3_f32 v248, v248, v198, v199
    v_mfma_f32_16x16x32_bf16 v[204:207], v[92:95], v[170:173], v[204:207]
    ds_read_b128 v[196:199], v246 offset:320
    v_mfma_f32_16x16x32_bf16 v[208:211], v[126:129], v[168:171], v[208:211]
    v_max3_f32 v248, v248, v200, v201
    v_max3_f32 v248, v248, v202, v203
    v_mfma_f32_16x16x32_bf16 v[208:211], v[128:131], v[170:173], v[208:211]
    ds_read_b128 v[200:203], v244 offset:192
    v_mfma_f32_16x16x32_bf16 v[236:239], a[52:55], a[220:223], v[236:239]
    v_mfma_f32_16x16x32_bf16 v[236:239], a[56:59], a[224:227], v[236:239]
    v_max3_f32 v248, v248, v204, v205
    v_mfma_f32_16x16x32_bf16 v[236:239], a[60:63], a[228:231], v[236:239]
    ds_read_b128 v[204:207], v245 offset:192
    v_mfma_f32_16x16x32_bf16 v[236:239], a[64:67], a[232:235], v[236:239]
    v_mfma_f32_16x16x32_bf16 v[236:239], a[68:71], a[236:239], v[236:239]
    v_max3_f32 v248, v248, v208, v209
    v_mfma_f32_16x16x32_bf16 v[228:231], a[216:219], a[72:75], 0
    ds_read_b128 v[208:211], v246 offset:192
    s_waitcnt lgkmcnt(3)
    v_mfma_f32_16x16x32_bf16 v[196:199], v[150:153], v[168:171], v[196:199]
    v_mfma_f32_16x16x32_bf16 v[196:199], v[152:155], v[170:173], v[196:199]
    v_mfma_f32_16x16x32_bf16 v[228:231], a[220:223], a[76:79], v[228:231]
    s_waitcnt lgkmcnt(2)
    v_cvt_pk_bf16_f32 v160, v236, v237
    v_cvt_pk_bf16_f32 v161, v238, v239
    v_mfma_f32_16x16x32_bf16 v[200:203], v[102:105], v[168:171], v[200:203]
    v_mfma_f32_16x16x32_bf16 v[200:203], v[104:107], v[170:173], v[200:203]
    v_mfma_f32_16x16x32_bf16 v[228:231], a[224:227], a[80:83], v[228:231]
    s_waitcnt lgkmcnt(1)
    v_max3_f32 v248, v248, v196, v197
    v_mov_b32 v225, v248
    v_mfma_f32_16x16x32_bf16 v[204:207], v[114:117], v[168:171], v[204:207]
    ds_read_b128 v[196:199], v244 offset:256
    v_permlane16_swap_b32 v248, v225
    v_mfma_f32_16x16x32_bf16 v[204:207], v[116:119], v[170:173], v[204:207]
    v_max_f32 v248, v248, v225
    v_mov_b32 v225, v248
    v_mfma_f32_16x16x32_bf16 v[228:231], a[228:231], a[84:87], v[228:231]
    s_waitcnt lgkmcnt(1)
    v_permlane32_swap_b32 v248, v225
    v_max_f32 v248, v248, v225
    v_mfma_f32_16x16x32_bf16 v[208:211], v[138:141], v[168:171], v[208:211]
    v_sub_f32 v200, v200, v248
    v_sub_f32 v201, v201, v248
    v_mfma_f32_16x16x32_bf16 v[208:211], v[140:143], v[170:173], v[208:211]
    v_exp_f32 v200, v200
    v_mfma_f32_16x16x32_bf16 v[228:231], a[232:235], a[88:91], v[228:231]
    v_exp_f32 v201, v201
    v_mfma_f32_16x16x32_bf16 v[228:231], a[236:239], a[92:95], v[228:231]
    v_sub_f32 v202, v202, v248
    v_sub_f32 v203, v203, v248
    v_mfma_f32_16x16x32_bf16 v[232:235], a[216:219], a[96:99], 0
    v_exp_f32 v202, v202
    v_mfma_f32_16x16x32_bf16 v[232:235], a[220:223], a[100:103], v[232:235]
    v_exp_f32 v203, v203
    v_mfma_f32_16x16x32_bf16 v[232:235], a[224:227], a[104:107], v[232:235]
    s_waitcnt lgkmcnt(0)
    v_cvt_pk_bf16_f32 v20, v228, v229
    v_cvt_pk_bf16_f32 v23, v230, v231
    v_mfma_f32_16x16x32_bf16 v[196:199], v[108:111], v[168:171], v[196:199]
    v_cvt_pk_bf16_f32 v180, v200, v201
    v_cvt_pk_bf16_f32 v183, v202, v203
    v_mfma_f32_16x16x32_bf16 v[196:199], v[110:113], v[170:173], v[196:199]
    ds_read_b128 v[200:203], v245 offset:256
    v_sub_f32 v204, v204, v248
    v_mfma_f32_16x16x32_bf16 v[232:235], a[228:231], a[108:111], v[232:235]
    v_exp_f32 v204, v204
    v_mfma_f32_16x16x32_bf16 v[232:235], a[232:235], a[112:115], v[232:235]
    v_sub_f32 v205, v205, v248
    v_sub_f32 v206, v206, v248
    v_mfma_f32_16x16x32_bf16 v[232:235], a[236:239], a[116:119], v[232:235]
    v_exp_f32 v205, v205
    v_mfma_f32_16x16x32_bf16 v[236:239], a[216:219], a[120:123], 0
    ds_read_b128 a[216:219], v242 offset:1664
    v_sub_f32 v207, v207, v248
    v_mfma_f32_16x16x32_bf16 v[236:239], a[220:223], a[124:127], v[236:239]
    ds_read_b128 a[220:223], v243 offset:1664
    v_cvt_pk_bf16_f32 v181, v204, v205
    v_mfma_f32_16x16x32_bf16 v[236:239], a[224:227], a[128:131], v[236:239]
    v_cvt_pk_bf16_f32 v50, v232, v233
    v_cvt_pk_bf16_f32 v53, v234, v235
    v_mfma_f32_16x16x32_bf16 v[236:239], a[228:231], a[132:135], v[236:239]
    ds_read_b128 a[224:227], v242 offset:1792
    ds_read_b128 a[228:231], v243 offset:1792
    v_mfma_f32_16x16x32_bf16 v[236:239], a[232:235], a[136:139], v[236:239]
    ds_read_b128 a[232:235], v240 offset:6144
    v_sub_f32 v208, v208, v248
    v_mfma_f32_16x16x32_bf16 v[236:239], a[236:239], a[140:143], v[236:239]
    ds_read_b128 a[236:239], v241 offset:6144
    v_sub_f32 v209, v209, v248
    v_mfma_f32_16x16x32_bf16 v[228:231], a[144:147], a[240:243], 0
    s_waitcnt lgkmcnt(6)
    v_exp_f32 v206, v206
    v_mfma_f32_16x16x32_bf16 v[200:203], v[120:123], v[168:171], v[200:203]
    v_exp_f32 v207, v207
    v_mfma_f32_16x16x32_bf16 v[200:203], v[122:125], v[170:173], v[200:203]
    v_cvt_pk_bf16_f32 v80, v236, v237
    v_cvt_pk_bf16_f32 v83, v238, v239
    v_mfma_f32_16x16x32_bf16 v[228:231], a[148:151], a[244:247], v[228:231]
    s_waitcnt lgkmcnt(5)
    v_cvt_pk_bf16_f32 v184, v206, v207
    v_sub_f32 v210, v210, v248
    v_mfma_f32_16x16x32_bf16 v[228:231], a[152:155], a[216:219], v[228:231]
    ds_read_b128 v[204:207], v246 offset:256
    v_sub_f32 v211, v211, v248
    v_mfma_f32_16x16x32_bf16 v[232:235], a[168:171], a[240:243], 0
    s_waitcnt lgkmcnt(5)
    v_exp_f32 v208, v208
    v_mfma_f32_16x16x32_bf16 v[228:231], a[156:159], a[220:223], v[228:231]
    s_waitcnt lgkmcnt(4)
    v_exp_f32 v209, v209
    v_mfma_f32_16x16x32_bf16 v[228:231], a[160:163], a[224:227], v[228:231]
    s_waitcnt lgkmcnt(3)
    v_exp_f32 v210, v210
    v_mfma_f32_16x16x32_bf16 v[228:231], a[164:167], a[228:231], v[228:231]
    v_exp_f32 v211, v211
    v_mfma_f32_16x16x32_bf16 v[232:235], a[172:175], a[244:247], v[232:235]
    v_cvt_pk_bf16_f32 v182, v208, v209
    v_cvt_pk_bf16_f32 v185, v210, v211
    v_mfma_f32_16x16x32_bf16 v[232:235], a[176:179], a[216:219], v[232:235]
    ds_read_b128 v[208:211], v244 offset:320
    v_sub_f32 v196, v196, v248
    v_mfma_f32_16x16x32_bf16 v[212:215], v[0:3], v[180:183], 0
    v_mul_f32 v228, s38, v228
    v_mul_f32 v229, s38, v229
    v_mfma_f32_16x16x32_bf16 v[216:219], v[30:33], v[180:183], 0
    v_mul_f32 v230, s38, v230
    v_mul_f32 v231, s38, v231
    v_mfma_f32_16x16x32_bf16 v[220:223], v[60:63], v[180:183], 0
    s_waitcnt lgkmcnt(1)
    v_cvt_pk_bf16_f32 v174, v228, v229
    v_cvt_pk_bf16_f32 v175, v230, v231
    v_mfma_f32_16x16x32_bf16 v[224:227], a[248:251], v[180:183], 0
    v_exp_f32 v196, v196
    v_mfma_f32_16x16x32_bf16 v[204:207], v[144:147], v[168:171], v[204:207]
    v_sub_f32 v197, v197, v248
    v_sub_f32 v198, v198, v248
    v_mfma_f32_16x16x32_bf16 v[204:207], v[146:149], v[170:173], v[204:207]
    v_exp_f32 v197, v197
    v_mfma_f32_16x16x32_bf16 v[232:235], a[180:183], a[220:223], v[232:235]
    v_exp_f32 v198, v198
    v_mfma_f32_16x16x32_bf16 v[232:235], a[184:187], a[224:227], v[232:235]
    v_sub_f32 v199, v199, v248
    v_cvt_pk_bf16_f32 v186, v196, v197
    v_mfma_f32_16x16x32_bf16 v[232:235], a[188:191], a[228:231], v[232:235]
    s_waitcnt lgkmcnt(0)
    v_exp_f32 v199, v199
    v_mfma_f32_16x16x32_bf16 v[208:211], v[90:93], v[168:171], v[208:211]
    v_cvt_pk_bf16_f32 v189, v198, v199
    v_sub_f32 v200, v200, v248
    v_mfma_f32_16x16x32_bf16 v[208:211], v[92:95], v[170:173], v[208:211]
    ds_read_b128 v[196:199], v245 offset:320
    v_sub_f32 v201, v201, v248
    v_mfma_f32_16x16x32_bf16 v[236:239], a[192:195], a[240:243], 0
    v_mul_f32 v232, s3, v232
    v_mul_f32 v233, s3, v233
    v_mfma_f32_16x16x32_bf16 v[236:239], a[196:199], a[244:247], v[236:239]
    v_mul_f32 v234, s3, v234
    v_mul_f32 v235, s3, v235
    v_mfma_f32_16x16x32_bf16 v[236:239], a[200:203], a[216:219], v[236:239]
    v_cvt_pk_bf16_f32 v176, v232, v233
    v_cvt_pk_bf16_f32 v177, v234, v235
    v_mfma_f32_16x16x32_bf16 v[236:239], a[204:207], a[220:223], v[236:239]
    ds_read_b128 a[240:243], v240 offset:6272
    ds_read_b128 a[244:247], v241 offset:6272
    v_mfma_f32_16x16x32_bf16 v[236:239], a[208:211], a[224:227], v[236:239]
    ds_read_b128 a[216:219], v240 offset:6400
    ds_read_b128 a[220:223], v241 offset:6400
    v_mfma_f32_16x16x32_bf16 v[236:239], a[212:215], a[228:231], v[236:239]
    ds_read_b128 a[224:227], v240 offset:6144
    ds_read_b128 a[228:231], v241 offset:6144
    v_mfma_f32_16x16x32_bf16 v[228:231], a[0:3], a[232:235], 0
    v_exp_f32 v200, v200
    v_mfma_f32_16x16x32_bf16 v[228:231], a[4:7], a[236:239], v[228:231]
    s_waitcnt lgkmcnt(6)
    v_exp_f32 v201, v201
    v_mfma_f32_16x16x32_bf16 v[196:199], v[126:129], v[168:171], v[196:199]
    v_mul_f32 v236, s38, v236
    v_mul_f32 v237, s38, v237
    v_mfma_f32_16x16x32_bf16 v[196:199], v[128:131], v[170:173], v[196:199]
    v_mul_f32 v238, s38, v238
    v_mul_f32 v239, s38, v239
    v_mfma_f32_16x16x32_bf16 v[232:235], a[24:27], a[232:235], 0
    v_cvt_pk_bf16_f32 v178, v236, v237
    v_cvt_pk_bf16_f32 v179, v238, v239
    v_mfma_f32_16x16x32_bf16 v[232:235], a[28:31], a[236:239], v[232:235]
    s_waitcnt lgkmcnt(5)
    v_sub_f32 v202, v202, v248
    v_sub_f32 v203, v203, v248
    v_mfma_f32_16x16x32_bf16 v[228:231], a[8:11], a[240:243], v[228:231]
    s_waitcnt lgkmcnt(4)
    v_exp_f32 v202, v202
    v_mfma_f32_16x16x32_bf16 v[228:231], a[12:15], a[244:247], v[228:231]
    s_waitcnt lgkmcnt(3)
    v_exp_f32 v203, v203
    v_mfma_f32_16x16x32_bf16 v[228:231], a[16:19], a[216:219], v[228:231]
    s_waitcnt lgkmcnt(2)
    v_cvt_pk_bf16_f32 v187, v200, v201
    v_cvt_pk_bf16_f32 v190, v202, v203
    v_mfma_f32_16x16x32_bf16 v[228:231], a[20:23], a[220:223], v[228:231]
    ds_read_b128 v[200:203], v246 offset:320
    v_sub_f32 v204, v204, v248
    v_mfma_f32_16x16x32_bf16 v[212:215], v[4:7], v[184:187], v[212:215]
    v_exp_f32 v204, v204
    v_mfma_f32_16x16x32_bf16 v[216:219], v[34:37], v[184:187], v[216:219]
    v_sub_f32 v205, v205, v248
    v_sub_f32 v206, v206, v248
    v_mfma_f32_16x16x32_bf16 v[220:223], v[64:67], v[184:187], v[220:223]
    v_cvt_pk_bf16_f32 v162, v228, v229
    v_cvt_pk_bf16_f32 v163, v230, v231
    v_mfma_f32_16x16x32_bf16 v[224:227], a[248:251], v[184:187], v[224:227]
    s_waitcnt lgkmcnt(2)
    v_exp_f32 v205, v205
    v_mfma_f32_16x16x32_bf16 v[232:235], a[32:35], a[240:243], v[232:235]
    v_exp_f32 v206, v206
    v_mfma_f32_16x16x32_bf16 v[232:235], a[36:39], a[244:247], v[232:235]
    v_sub_f32 v207, v207, v248
    v_cvt_pk_bf16_f32 v188, v204, v205
    v_mfma_f32_16x16x32_bf16 v[232:235], a[40:43], a[216:219], v[232:235]
    v_exp_f32 v207, v207
    v_mfma_f32_16x16x32_bf16 v[232:235], a[44:47], a[220:223], v[232:235]
    v_cvt_pk_bf16_f32 v191, v206, v207
    v_sub_f32 v208, v208, v248
    v_mfma_f32_16x16x32_bf16 v[236:239], a[48:51], a[232:235], 0
    ds_read_b128 a[232:235], v240 offset:6272
    ds_read_b128 v[204:207], v244 offset:0
    v_mfma_f32_16x16x32_bf16 v[212:215], v[8:11], v[188:191], v[212:215]
    s_waitcnt lgkmcnt(2)
    v_exp_f32 v208, v208
    v_mfma_f32_16x16x32_bf16 v[216:219], v[38:41], v[188:191], v[216:219]
    v_cvt_pk_bf16_f32 v164, v232, v233
    v_cvt_pk_bf16_f32 v165, v234, v235
    v_mfma_f32_16x16x32_bf16 v[220:223], v[68:71], v[188:191], v[220:223]
    v_sub_f32 v209, v209, v248
    v_sub_f32 v196, v196, v248
    v_mfma_f32_16x16x32_bf16 v[224:227], a[248:251], v[188:191], v[224:227]
    v_exp_f32 v209, v209
    v_mfma_f32_16x16x32_bf16 v[200:203], v[150:153], v[168:171], v[200:203]
    v_cvt_pk_bf16_f32 v192, v208, v209
    v_sub_f32 v197, v197, v248
    v_mfma_f32_16x16x32_bf16 v[200:203], v[152:155], v[170:173], v[200:203]
    ds_read_b128 v[208:211], v245 offset:0
    v_mfma_f32_16x16x32_bf16 v[236:239], a[52:55], a[236:239], v[236:239]
    ds_read_b128 a[236:239], v241 offset:6272
    v_mfma_f32_16x16x32_bf16 v[236:239], a[56:59], a[240:243], v[236:239]
    ds_read_b128 a[240:243], v240 offset:6400
    v_mfma_f32_16x16x32_bf16 v[236:239], a[60:63], a[244:247], v[236:239]
    ds_read_b128 a[244:247], v241 offset:6400
    s_waitcnt lgkmcnt(4)
    v_mfma_f32_16x16x32_bf16 v[204:207], v[108:111], v[174:177], v[204:207]
    v_exp_f32 v196, v196
    v_mfma_f32_16x16x32_bf16 v[204:207], v[110:113], v[176:179], v[204:207]
    v_exp_f32 v197, v197
    v_mfma_f32_16x16x32_bf16 v[236:239], a[64:67], a[216:219], v[236:239]
    ds_read_b128 a[216:219], v240 offset:36864
    v_cvt_pk_bf16_f32 v193, v196, v197
    v_mfma_f32_16x16x32_bf16 v[236:239], a[68:71], a[220:223], v[236:239]
    ds_read_b128 a[220:223], v241 offset:36864
    ds_read_b128 v[196:199], v246 offset:0
    v_mfma_f32_16x16x32_bf16 v[228:231], a[224:227], a[72:75], 0
    v_sub_f32 v200, v200, v248
    v_sub_f32 v201, v201, v248
    v_mfma_f32_16x16x32_bf16 v[228:231], a[228:231], a[76:79], v[228:231]
    s_waitcnt lgkmcnt(6)
    v_exp_f32 v200, v200
    v_mfma_f32_16x16x32_bf16 v[208:211], v[120:123], v[174:177], v[208:211]
    v_cvt_pk_bf16_f32 v166, v236, v237
    v_cvt_pk_bf16_f32 v167, v238, v239
    v_mfma_f32_16x16x32_bf16 v[208:211], v[122:125], v[176:179], v[208:211]
    v_exp_f32 v201, v201
    v_mfma_f32_16x16x32_bf16 v[228:231], a[232:235], a[80:83], v[228:231]
    s_waitcnt lgkmcnt(5)
    v_cvt_pk_bf16_f32 v194, v200, v201
    v_max_f32 v248, v204, v205
    v_mfma_f32_16x16x32_bf16 v[228:231], a[236:239], a[84:87], v[228:231]
    ds_read_b128 v[200:203], v244 offset:64
    v_max3_f32 v248, v248, v206, v207
    v_mfma_f32_16x16x32_bf16 v[212:215], v[12:15], v[192:195], v[212:215]
    ds_read_b128 v[204:207], v245 offset:64
    v_max3_f32 v248, v248, v208, v209
    v_mfma_f32_16x16x32_bf16 v[216:219], v[42:45], v[192:195], v[216:219]
    s_waitcnt lgkmcnt(6)
    v_max3_f32 v248, v248, v210, v211
    v_mfma_f32_16x16x32_bf16 v[220:223], v[72:75], v[192:195], v[220:223]
    ds_read_b128 v[208:211], v246 offset:64
    s_waitcnt lgkmcnt(3)
    v_mfma_f32_16x16x32_bf16 v[224:227], a[248:251], v[192:195], v[224:227]
    v_mfma_f32_16x16x32_bf16 v[196:199], v[144:147], v[174:177], v[196:199]
    v_mfma_f32_16x16x32_bf16 v[196:199], v[146:149], v[176:179], v[196:199]
    v_mfma_f32_16x16x32_bf16 v[228:231], a[240:243], a[88:91], v[228:231]
    v_mfma_f32_16x16x32_bf16 v[228:231], a[244:247], a[92:95], v[228:231]
    v_mfma_f32_16x16x32_bf16 v[232:235], a[224:227], a[96:99], 0
    s_waitcnt lgkmcnt(2)
    s_waitcnt lgkmcnt(1)
    v_mfma_f32_16x16x32_bf16 v[200:203], v[90:93], v[174:177], v[200:203]
    v_rcp_f32 v225, v224
    v_mfma_f32_16x16x32_bf16 v[200:203], v[92:95], v[176:179], v[200:203]
    v_mul_f32 v212, v212, v225
    v_mul_f32 v213, v213, v225
    v_mfma_f32_16x16x32_bf16 v[204:207], v[126:129], v[174:177], v[204:207]
    s_waitcnt lgkmcnt(0)
    v_cvt_pk_bf16_f32 v24, v228, v229
    v_cvt_pk_bf16_f32 v27, v230, v231
    v_mfma_f32_16x16x32_bf16 v[204:207], v[128:131], v[176:179], v[204:207]
    v_mul_f32 v214, v214, v225
    v_mul_f32 v215, v215, v225
    v_mfma_f32_16x16x32_bf16 v[208:211], v[150:153], v[174:177], v[208:211]
    v_cvt_pk_bf16_f32 v212, v212, v213
    v_cvt_pk_bf16_f32 v213, v214, v215
    v_mfma_f32_16x16x32_bf16 v[208:211], v[152:155], v[176:179], v[208:211]
    ds_write_b64 v251, v[212:213] offset:0
    v_mfma_f32_16x16x32_bf16 v[232:235], a[228:231], a[100:103], v[232:235]
    v_mul_f32 v216, v216, v225
    v_mul_f32 v217, v217, v225
    v_mfma_f32_16x16x32_bf16 v[232:235], a[232:235], a[104:107], v[232:235]
    v_mul_f32 v218, v218, v225
    v_mul_f32 v219, v219, v225
    v_mfma_f32_16x16x32_bf16 v[232:235], a[236:239], a[108:111], v[232:235]
    v_cvt_pk_bf16_f32 v216, v216, v217
    v_cvt_pk_bf16_f32 v217, v218, v219
    v_mfma_f32_16x16x32_bf16 v[232:235], a[240:243], a[112:115], v[232:235]
    ds_write_b64 v251, v[216:217] offset:128
    v_mfma_f32_16x16x32_bf16 v[232:235], a[244:247], a[116:119], v[232:235]
    v_mul_f32 v220, v220, v225
    v_mul_f32 v221, v221, v225
    v_mfma_f32_16x16x32_bf16 v[236:239], a[224:227], a[120:123], 0
    ds_read_b128 a[224:227], v240 offset:36992
    v_mul_f32 v222, v222, v225
    v_mfma_f32_16x16x32_bf16 v[236:239], a[228:231], a[124:127], v[236:239]
    ds_read_b128 a[228:231], v241 offset:36992
    v_mul_f32 v223, v223, v225
    v_mfma_f32_16x16x32_bf16 v[236:239], a[232:235], a[128:131], v[236:239]
    v_cvt_pk_bf16_f32 v54, v232, v233
    v_cvt_pk_bf16_f32 v57, v234, v235
    v_mfma_f32_16x16x32_bf16 v[236:239], a[236:239], a[132:135], v[236:239]
    ds_read_b128 a[232:235], v240 offset:37120
    ds_read_b128 a[236:239], v241 offset:37120
    v_mfma_f32_16x16x32_bf16 v[236:239], a[240:243], a[136:139], v[236:239]
    ds_read_b128 a[240:243], v242 offset:3072
    v_add_u32 v240, 0xf000, v240
    v_mfma_f32_16x16x32_bf16 v[236:239], a[244:247], a[140:143], v[236:239]
    ds_read_b128 a[244:247], v243 offset:3072
    v_add_u32 v241, 0xf000, v241
    v_mfma_f32_16x16x32_bf16 v[228:231], a[0:3], a[216:219], 0
    v_cvt_pk_bf16_f32 v220, v220, v221
    v_cvt_pk_bf16_f32 v221, v222, v223
    v_mfma_f32_16x16x32_bf16 v[228:231], a[4:7], a[220:223], v[228:231]
    ds_write_b64 v251, v[220:221] offset:256
    v_mfma_f32_16x16x32_bf16 v[232:235], a[24:27], a[216:219], 0
    s_waitcnt lgkmcnt(6)
    v_cvt_pk_bf16_f32 v84, v236, v237
    v_cvt_pk_bf16_f32 v87, v238, v239
    v_mfma_f32_16x16x32_bf16 v[228:231], a[8:11], a[224:227], v[228:231]
    s_waitcnt lgkmcnt(5)
    v_max3_f32 v248, v248, v196, v197
    v_max3_f32 v248, v248, v198, v199
    v_mfma_f32_16x16x32_bf16 v[228:231], a[12:15], a[228:231], v[228:231]
    ds_read_b128 v[196:199], v244 offset:128
    v_max3_f32 v248, v248, v200, v201
    v_mfma_f32_16x16x32_bf16 v[232:235], a[28:31], a[220:223], v[232:235]
    s_waitcnt lgkmcnt(5)
    v_max3_f32 v248, v248, v202, v203
    v_max3_f32 v248, v248, v204, v205
    v_mfma_f32_16x16x32_bf16 v[228:231], a[16:19], a[232:235], v[228:231]
    ds_read_b128 v[200:203], v245 offset:128
    v_max3_f32 v248, v248, v206, v207
    v_mfma_f32_16x16x32_bf16 v[232:235], a[32:35], a[224:227], v[232:235]
    ds_read_b128 v[204:207], v246 offset:128
    v_max3_f32 v248, v248, v208, v209
    v_mfma_f32_16x16x32_bf16 v[232:235], a[36:39], a[228:231], v[232:235]
    s_waitcnt lgkmcnt(6)
    v_max3_f32 v248, v248, v210, v211
    v_mfma_f32_16x16x32_bf16 v[228:231], a[20:23], a[236:239], v[228:231]
    ds_read_b128 v[208:211], v244 offset:0
    v_mfma_f32_16x16x32_bf16 v[232:235], a[40:43], a[232:235], v[232:235]
    v_mfma_f32_16x16x32_bf16 v[232:235], a[44:47], a[236:239], v[232:235]
    v_mfma_f32_16x16x32_bf16 v[236:239], a[48:51], a[216:219], 0
    v_mfma_f32_16x16x32_bf16 v[236:239], a[52:55], a[220:223], v[236:239]
    s_waitcnt lgkmcnt(3)
    v_mfma_f32_16x16x32_bf16 v[196:199], v[96:99], v[174:177], v[196:199]
    v_mfma_f32_16x16x32_bf16 v[196:199], v[98:101], v[176:179], v[196:199]
    s_waitcnt lgkmcnt(2)
    v_cvt_pk_bf16_f32 v102, v228, v229
    v_cvt_pk_bf16_f32 v103, v230, v231
    v_mfma_f32_16x16x32_bf16 v[200:203], v[132:135], v[174:177], v[200:203]
    s_waitcnt lgkmcnt(1)
    v_cvt_pk_bf16_f32 v104, v232, v233
    v_cvt_pk_bf16_f32 v105, v234, v235
    v_mfma_f32_16x16x32_bf16 v[200:203], v[134:137], v[176:179], v[200:203]
    v_max3_f32 v248, v248, v196, v197
    s_waitcnt lgkmcnt(0)
    v_mfma_f32_16x16x32_bf16 v[204:207], v[156:159], v[174:177], v[204:207]
    ds_read_b128 v[196:199], v245 offset:0
    v_mfma_f32_16x16x32_bf16 v[204:207], v[158:161], v[176:179], v[204:207]
    v_mfma_f32_16x16x32_bf16 v[208:211], v[108:111], v[174:177], v[208:211]
    v_mfma_f32_16x16x32_bf16 v[208:211], v[110:113], v[176:179], v[208:211]
    v_mfma_f32_16x16x32_bf16 v[236:239], a[56:59], a[224:227], v[236:239]
    v_max3_f32 v248, v248, v200, v201
    v_mfma_f32_16x16x32_bf16 v[236:239], a[60:63], a[228:231], v[236:239]
    ds_read_b128 v[200:203], v246 offset:0
    v_mfma_f32_16x16x32_bf16 v[236:239], a[64:67], a[232:235], v[236:239]
    v_mfma_f32_16x16x32_bf16 v[236:239], a[68:71], a[236:239], v[236:239]
    v_max3_f32 v248, v248, v204, v205
    v_mov_b32 v225, v248
    v_mfma_f32_16x16x32_bf16 v[228:231], a[216:219], a[72:75], 0
    ds_read_b128 v[204:207], v244 offset:64
    v_permlane16_swap_b32 v248, v225
    v_mfma_f32_16x16x32_bf16 v[228:231], a[220:223], a[76:79], v[228:231]
    s_waitcnt lgkmcnt(2)
    v_max_f32 v248, v248, v225
    v_cvt_pk_bf16_f32 v106, v236, v237
    v_mfma_f32_16x16x32_bf16 v[196:199], v[120:123], v[174:177], v[196:199]
    v_cvt_pk_bf16_f32 v107, v238, v239
    v_mov_b32 v225, v248
    v_mfma_f32_16x16x32_bf16 v[196:199], v[122:125], v[176:179], v[196:199]
    v_mfma_f32_16x16x32_bf16 v[228:231], a[224:227], a[80:83], v[228:231]
    v_permlane32_swap_b32 v248, v225
    v_max_f32 v248, v248, v225
    v_mfma_f32_16x16x32_bf16 v[228:231], a[228:231], a[84:87], v[228:231]
    v_sub_f32 v208, v208, v248
    v_sub_f32 v209, v209, v248
    v_mfma_f32_16x16x32_bf16 v[228:231], a[232:235], a[88:91], v[228:231]
    s_waitcnt lgkmcnt(1)
    v_exp_f32 v208, v208
    v_mfma_f32_16x16x32_bf16 v[200:203], v[144:147], v[174:177], v[200:203]
    v_exp_f32 v209, v209
    v_mfma_f32_16x16x32_bf16 v[200:203], v[146:149], v[176:179], v[200:203]
    v_sub_f32 v210, v210, v248
    v_sub_f32 v211, v211, v248
    v_mfma_f32_16x16x32_bf16 v[228:231], a[236:239], a[92:95], v[228:231]
    s_waitcnt lgkmcnt(0)
    v_exp_f32 v210, v210
    v_mfma_f32_16x16x32_bf16 v[204:207], v[90:93], v[174:177], v[204:207]
    v_exp_f32 v211, v211
    v_mfma_f32_16x16x32_bf16 v[204:207], v[92:95], v[176:179], v[204:207]
    v_cvt_pk_bf16_f32 v180, v208, v209
    v_cvt_pk_bf16_f32 v183, v210, v211
    v_mfma_f32_16x16x32_bf16 v[232:235], a[216:219], a[96:99], 0
    v_cvt_pk_bf16_f32 v25, v228, v229
    v_cvt_pk_bf16_f32 v28, v230, v231
    v_mfma_f32_16x16x32_bf16 v[232:235], a[220:223], a[100:103], v[232:235]
    ds_read_b128 v[208:211], v245 offset:64
    v_sub_f32 v196, v196, v248
    v_mfma_f32_16x16x32_bf16 v[232:235], a[224:227], a[104:107], v[232:235]
    v_exp_f32 v196, v196
    v_mfma_f32_16x16x32_bf16 v[232:235], a[228:231], a[108:111], v[232:235]
    v_sub_f32 v197, v197, v248
    v_sub_f32 v198, v198, v248
    v_mfma_f32_16x16x32_bf16 v[232:235], a[232:235], a[112:115], v[232:235]
    v_exp_f32 v197, v197
    v_mfma_f32_16x16x32_bf16 v[232:235], a[236:239], a[116:119], v[232:235]
    v_exp_f32 v198, v198
    v_mfma_f32_16x16x32_bf16 v[236:239], a[216:219], a[120:123], 0
    ds_read_b128 a[216:219], v242 offset:3200
    v_sub_f32 v199, v199, v248
    v_mfma_f32_16x16x32_bf16 v[236:239], a[220:223], a[124:127], v[236:239]
    ds_read_b128 a[220:223], v243 offset:3200
    v_cvt_pk_bf16_f32 v181, v196, v197
    v_mfma_f32_16x16x32_bf16 v[236:239], a[224:227], a[128:131], v[236:239]
    v_cvt_pk_bf16_f32 v55, v232, v233
    v_cvt_pk_bf16_f32 v58, v234, v235
    v_mfma_f32_16x16x32_bf16 v[236:239], a[228:231], a[132:135], v[236:239]
    ds_read_b128 a[224:227], v242 offset:3328
    ds_read_b128 a[228:231], v243 offset:3328
    v_mfma_f32_16x16x32_bf16 v[236:239], a[232:235], a[136:139], v[236:239]
    ds_read_b128 a[232:235], v240 offset:6144
    v_sub_f32 v200, v200, v248
    v_mfma_f32_16x16x32_bf16 v[236:239], a[236:239], a[140:143], v[236:239]
    ds_read_b128 a[236:239], v241 offset:6144
    v_sub_f32 v201, v201, v248
    v_mfma_f32_16x16x32_bf16 v[228:231], a[144:147], a[240:243], 0
    s_waitcnt lgkmcnt(6)
    v_exp_f32 v199, v199
    v_mfma_f32_16x16x32_bf16 v[208:211], v[126:129], v[174:177], v[208:211]
    v_cvt_pk_bf16_f32 v184, v198, v199
    v_sub_f32 v202, v202, v248
    v_mfma_f32_16x16x32_bf16 v[208:211], v[128:131], v[176:179], v[208:211]
    v_cvt_pk_bf16_f32 v85, v236, v237
    v_cvt_pk_bf16_f32 v88, v238, v239
    v_mfma_f32_16x16x32_bf16 v[228:231], a[148:151], a[244:247], v[228:231]
    ds_read_b128 v[196:199], v246 offset:64
    v_sub_f32 v203, v203, v248
    v_mfma_f32_16x16x32_bf16 v[232:235], a[168:171], a[240:243], 0
    s_waitcnt lgkmcnt(6)
    v_exp_f32 v200, v200
    v_mfma_f32_16x16x32_bf16 v[228:231], a[152:155], a[216:219], v[228:231]
    s_waitcnt lgkmcnt(5)
    v_exp_f32 v201, v201
    v_mfma_f32_16x16x32_bf16 v[228:231], a[156:159], a[220:223], v[228:231]
    s_waitcnt lgkmcnt(4)
    v_exp_f32 v202, v202
    v_mfma_f32_16x16x32_bf16 v[228:231], a[160:163], a[224:227], v[228:231]
    s_waitcnt lgkmcnt(3)
    v_exp_f32 v203, v203
    v_mfma_f32_16x16x32_bf16 v[228:231], a[164:167], a[228:231], v[228:231]
    v_cvt_pk_bf16_f32 v182, v200, v201
    v_cvt_pk_bf16_f32 v185, v202, v203
    v_mfma_f32_16x16x32_bf16 v[232:235], a[172:175], a[244:247], v[232:235]
    ds_read_b128 v[200:203], v244 offset:128
    v_sub_f32 v204, v204, v248
    v_mfma_f32_16x16x32_bf16 v[212:215], v[6:9], v[180:183], 0
    v_exp_f32 v204, v204
    v_mfma_f32_16x16x32_bf16 v[216:219], v[36:39], v[180:183], 0
    v_mul_f32 v228, s38, v228
    v_mul_f32 v229, s38, v229
    v_mfma_f32_16x16x32_bf16 v[220:223], v[66:69], v[180:183], 0
    s_waitcnt lgkmcnt(1)
    v_mul_f32 v230, s38, v230
    v_mul_f32 v231, s38, v231
    v_mfma_f32_16x16x32_bf16 v[224:227], a[248:251], v[180:183], 0
    v_cvt_pk_bf16_f32 v168, v228, v229
    v_cvt_pk_bf16_f32 v169, v230, v231
    v_mfma_f32_16x16x32_bf16 v[196:199], v[150:153], v[174:177], v[196:199]
    v_sub_f32 v205, v205, v248
    v_sub_f32 v206, v206, v248
    v_mfma_f32_16x16x32_bf16 v[196:199], v[152:155], v[176:179], v[196:199]
    v_exp_f32 v205, v205
    v_mfma_f32_16x16x32_bf16 v[232:235], a[176:179], a[216:219], v[232:235]
    v_exp_f32 v206, v206
    v_mfma_f32_16x16x32_bf16 v[232:235], a[180:183], a[220:223], v[232:235]
    v_sub_f32 v207, v207, v248
    v_cvt_pk_bf16_f32 v186, v204, v205
    v_mfma_f32_16x16x32_bf16 v[232:235], a[184:187], a[224:227], v[232:235]
    s_waitcnt lgkmcnt(0)
    v_exp_f32 v207, v207
    v_mfma_f32_16x16x32_bf16 v[200:203], v[96:99], v[174:177], v[200:203]
    v_cvt_pk_bf16_f32 v189, v206, v207
    v_sub_f32 v208, v208, v248
    v_mfma_f32_16x16x32_bf16 v[200:203], v[98:101], v[176:179], v[200:203]
    ds_read_b128 v[204:207], v245 offset:128
    v_sub_f32 v209, v209, v248
    v_mfma_f32_16x16x32_bf16 v[232:235], a[188:191], a[228:231], v[232:235]
    v_exp_f32 v208, v208
    v_mfma_f32_16x16x32_bf16 v[236:239], a[192:195], a[240:243], 0
    ds_read_b128 a[240:243], v240 offset:6272
    v_sub_f32 v210, v210, v248
    v_mfma_f32_16x16x32_bf16 v[236:239], a[196:199], a[244:247], v[236:239]
    ds_read_b128 a[244:247], v241 offset:6272
    v_sub_f32 v211, v211, v248
    v_mfma_f32_16x16x32_bf16 v[236:239], a[200:203], a[216:219], v[236:239]
    v_mul_f32 v232, s3, v232
    v_mul_f32 v233, s3, v233
    v_mfma_f32_16x16x32_bf16 v[236:239], a[204:207], a[220:223], v[236:239]
    v_mul_f32 v234, s3, v234
    v_mul_f32 v235, s3, v235
    v_mfma_f32_16x16x32_bf16 v[236:239], a[208:211], a[224:227], v[236:239]
    v_cvt_pk_bf16_f32 v170, v232, v233
    v_cvt_pk_bf16_f32 v171, v234, v235
    v_mfma_f32_16x16x32_bf16 v[236:239], a[212:215], a[228:231], v[236:239]
    ds_read_b128 a[216:219], v240 offset:6400
    ds_read_b128 a[220:223], v241 offset:6400
    v_mfma_f32_16x16x32_bf16 v[228:231], a[0:3], a[232:235], 0
    ds_read_b128 a[224:227], v254 offset:4608
    ds_read_b128 a[228:231], v255 offset:4608
    v_mfma_f32_16x16x32_bf16 v[228:231], a[4:7], a[236:239], v[228:231]
    s_waitcnt lgkmcnt(6)
    v_exp_f32 v209, v209
    v_mfma_f32_16x16x32_bf16 v[204:207], v[132:135], v[174:177], v[204:207]
    s_waitcnt lgkmcnt(5)
    v_mul_f32 v236, s38, v236
    v_mul_f32 v237, s38, v237
    v_mfma_f32_16x16x32_bf16 v[204:207], v[134:137], v[176:179], v[204:207]
    v_mul_f32 v238, s38, v238
    v_mul_f32 v239, s38, v239
    v_mfma_f32_16x16x32_bf16 v[228:231], a[8:11], a[240:243], v[228:231]
    s_waitcnt lgkmcnt(4)
    v_cvt_pk_bf16_f32 v172, v236, v237
    v_cvt_pk_bf16_f32 v173, v238, v239
    v_mfma_f32_16x16x32_bf16 v[228:231], a[12:15], a[244:247], v[228:231]
    v_exp_f32 v210, v210
    v_mfma_f32_16x16x32_bf16 v[232:235], a[24:27], a[232:235], 0
    v_exp_f32 v211, v211
    v_mfma_f32_16x16x32_bf16 v[232:235], a[28:31], a[236:239], v[232:235]
    s_waitcnt lgkmcnt(3)
    v_cvt_pk_bf16_f32 v187, v208, v209
    v_cvt_pk_bf16_f32 v190, v210, v211
    v_mfma_f32_16x16x32_bf16 v[228:231], a[16:19], a[216:219], v[228:231]
    ds_read_b128 v[208:211], v246 offset:128
    v_sub_f32 v196, v196, v248
    v_mfma_f32_16x16x32_bf16 v[212:215], v[10:13], v[184:187], v[212:215]
    s_waitcnt lgkmcnt(3)
    v_exp_f32 v196, v196
    v_mfma_f32_16x16x32_bf16 v[216:219], v[40:43], v[184:187], v[216:219]
    v_sub_f32 v197, v197, v248
    v_sub_f32 v198, v198, v248
    v_mfma_f32_16x16x32_bf16 v[220:223], v[70:73], v[184:187], v[220:223]
    v_exp_f32 v197, v197
    v_mfma_f32_16x16x32_bf16 v[224:227], a[248:251], v[184:187], v[224:227]
    v_exp_f32 v198, v198
    v_mfma_f32_16x16x32_bf16 v[228:231], a[20:23], a[220:223], v[228:231]
    v_sub_f32 v199, v199, v248
    v_cvt_pk_bf16_f32 v188, v196, v197
    v_mfma_f32_16x16x32_bf16 v[232:235], a[32:35], a[240:243], v[232:235]
    v_exp_f32 v199, v199
    v_mfma_f32_16x16x32_bf16 v[232:235], a[36:39], a[244:247], v[232:235]
    v_cvt_pk_bf16_f32 v191, v198, v199
    v_sub_f32 v200, v200, v248
    v_mfma_f32_16x16x32_bf16 v[232:235], a[40:43], a[216:219], v[232:235]
    v_cvt_pk_bf16_f32 v108, v228, v229
    v_cvt_pk_bf16_f32 v109, v230, v231
    v_mfma_f32_16x16x32_bf16 v[212:215], v[14:17], v[188:191], v[212:215]
    ds_read_b128 v[196:199], v244 offset:0
    v_sub_f32 v201, v201, v248
    v_mfma_f32_16x16x32_bf16 v[216:219], v[44:47], v[188:191], v[216:219]
    s_waitcnt lgkmcnt(1)
    v_exp_f32 v200, v200
    v_mfma_f32_16x16x32_bf16 v[220:223], v[74:77], v[188:191], v[220:223]
    v_exp_f32 v201, v201
    v_mfma_f32_16x16x32_bf16 v[224:227], a[248:251], v[188:191], v[224:227]
    v_cvt_pk_bf16_f32 v192, v200, v201
    v_sub_f32 v204, v204, v248
    v_mfma_f32_16x16x32_bf16 v[208:211], v[156:159], v[174:177], v[208:211]
    ds_read_b128 v[200:203], v245 offset:0
    v_sub_f32 v205, v205, v248
    v_mfma_f32_16x16x32_bf16 v[208:211], v[158:161], v[176:179], v[208:211]
    v_exp_f32 v204, v204
    v_mfma_f32_16x16x32_bf16 v[232:235], a[44:47], a[220:223], v[232:235]
    v_exp_f32 v205, v205
    v_mfma_f32_16x16x32_bf16 v[236:239], a[48:51], a[232:235], 0
    v_cvt_pk_bf16_f32 v193, v204, v205
    v_mfma_f32_16x16x32_bf16 v[236:239], a[52:55], a[236:239], v[236:239]
    ds_read_b128 v[204:207], v246 offset:0
    s_waitcnt lgkmcnt(2)
    v_mfma_f32_16x16x32_bf16 v[196:199], v[90:93], v[168:171], v[196:199]
    v_sub_f32 v208, v208, v248
    v_cvt_pk_bf16_f32 v110, v232, v233
    v_mfma_f32_16x16x32_bf16 v[196:199], v[92:95], v[170:173], v[196:199]
    v_cvt_pk_bf16_f32 v111, v234, v235
    v_sub_f32 v209, v209, v248
    v_mfma_f32_16x16x32_bf16 v[236:239], a[56:59], a[240:243], v[236:239]
    v_exp_f32 v208, v208
    v_mfma_f32_16x16x32_bf16 v[236:239], a[60:63], a[244:247], v[236:239]
    v_exp_f32 v209, v209
    v_mfma_f32_16x16x32_bf16 v[236:239], a[64:67], a[216:219], v[236:239]
    s_waitcnt lgkmcnt(1)
    v_cvt_pk_bf16_f32 v194, v208, v209
    v_max_f32 v248, v196, v197
    v_mfma_f32_16x16x32_bf16 v[200:203], v[126:129], v[168:171], v[200:203]
    ds_read_b128 v[208:211], v244 offset:64
    v_max3_f32 v248, v248, v198, v199
    v_mfma_f32_16x16x32_bf16 v[212:215], v[18:21], v[192:195], v[212:215]
    ds_read_b128 v[196:199], v245 offset:64
    v_mfma_f32_16x16x32_bf16 v[216:219], v[48:51], v[192:195], v[216:219]
    v_mfma_f32_16x16x32_bf16 v[220:223], v[78:81], v[192:195], v[220:223]
    s_waitcnt lgkmcnt(2)
    v_mfma_f32_16x16x32_bf16 v[224:227], a[248:251], v[192:195], v[224:227]
    v_mfma_f32_16x16x32_bf16 v[200:203], v[128:131], v[170:173], v[200:203]
    v_mfma_f32_16x16x32_bf16 v[204:207], v[150:153], v[168:171], v[204:207]
    v_mfma_f32_16x16x32_bf16 v[204:207], v[152:155], v[170:173], v[204:207]
    v_mfma_f32_16x16x32_bf16 v[236:239], a[68:71], a[220:223], v[236:239]
    v_mfma_f32_16x16x32_bf16 v[228:231], a[232:235], a[72:75], 0
    s_waitcnt lgkmcnt(1)
    s_waitcnt lgkmcnt(0)
    v_mfma_f32_16x16x32_bf16 v[208:211], v[96:99], v[168:171], v[208:211]
    v_rcp_f32 v225, v224
    v_mfma_f32_16x16x32_bf16 v[208:211], v[98:101], v[170:173], v[208:211]
    v_mul_f32 v212, v212, v225
    v_mul_f32 v213, v213, v225
    v_mfma_f32_16x16x32_bf16 v[196:199], v[132:135], v[168:171], v[196:199]
    v_cvt_pk_bf16_f32 v112, v236, v237
    v_cvt_pk_bf16_f32 v113, v238, v239
    v_mfma_f32_16x16x32_bf16 v[196:199], v[134:137], v[170:173], v[196:199]
    v_mul_f32 v214, v214, v225
    v_mul_f32 v215, v215, v225
    v_mfma_f32_16x16x32_bf16 v[228:231], a[236:239], a[76:79], v[228:231]
    v_cvt_pk_bf16_f32 v212, v212, v213
    v_cvt_pk_bf16_f32 v213, v214, v215
    v_mfma_f32_16x16x32_bf16 v[228:231], a[240:243], a[80:83], v[228:231]
    ds_write_b64 v251, v[212:213] offset:6144
    v_mfma_f32_16x16x32_bf16 v[228:231], a[244:247], a[84:87], v[228:231]
    v_mul_f32 v216, v216, v225
    v_mul_f32 v217, v217, v225
    v_mfma_f32_16x16x32_bf16 v[228:231], a[216:219], a[88:91], v[228:231]
    v_mul_f32 v218, v218, v225
    v_mul_f32 v219, v219, v225
    v_mfma_f32_16x16x32_bf16 v[228:231], a[220:223], a[92:95], v[228:231]
    v_cvt_pk_bf16_f32 v216, v216, v217
    v_cvt_pk_bf16_f32 v217, v218, v219
    v_mfma_f32_16x16x32_bf16 v[232:235], a[232:235], a[96:99], 0
    ds_write_b64 v251, v[216:217] offset:6272
    v_mfma_f32_16x16x32_bf16 v[232:235], a[236:239], a[100:103], v[232:235]
    v_mul_f32 v220, v220, v225
    v_mul_f32 v221, v221, v225
    v_mfma_f32_16x16x32_bf16 v[232:235], a[240:243], a[104:107], v[232:235]
    v_cvt_pk_bf16_f32 v26, v228, v229
    v_cvt_pk_bf16_f32 v29, v230, v231
    v_mfma_f32_16x16x32_bf16 v[232:235], a[244:247], a[108:111], v[232:235]
    v_mul_f32 v222, v222, v225
    v_mul_f32 v223, v223, v225
    v_mfma_f32_16x16x32_bf16 v[232:235], a[216:219], a[112:115], v[232:235]
    v_cvt_pk_bf16_f32 v220, v220, v221
    v_cvt_pk_bf16_f32 v221, v222, v223
    v_mfma_f32_16x16x32_bf16 v[232:235], a[220:223], a[116:119], v[232:235]
    ds_write_b64 v251, v[220:221] offset:6400
    v_mfma_f32_16x16x32_bf16 v[236:239], a[232:235], a[120:123], 0
    ds_read_b128 a[232:235], v254 offset:4736
    v_max3_f32 v248, v248, v200, v201
    v_mfma_f32_16x16x32_bf16 v[236:239], a[236:239], a[124:127], v[236:239]
    ds_read_b128 a[236:239], v255 offset:4736
    v_max3_f32 v248, v248, v202, v203
    v_mfma_f32_16x16x32_bf16 v[236:239], a[240:243], a[128:131], v[236:239]
    v_cvt_pk_bf16_f32 v56, v232, v233
    v_cvt_pk_bf16_f32 v59, v234, v235
    v_mfma_f32_16x16x32_bf16 v[236:239], a[244:247], a[132:135], v[236:239]
    ds_read_b128 a[240:243], v254 offset:4864
    ds_read_b128 a[244:247], v255 offset:4864
    v_mfma_f32_16x16x32_bf16 v[236:239], a[216:219], a[136:139], v[236:239]
    ds_read_b128 v[200:203], v246 offset:64
    v_accvgpr_read_b32 v254, a252
    v_mfma_f32_16x16x32_bf16 v[236:239], a[220:223], a[140:143], v[236:239]
    buffer_load_dwordx4 v254, s[4:7], s44 offen lds
    v_accvgpr_read_b32 v255, a253
    v_mfma_f32_16x16x32_bf16 v[228:231], a[144:147], a[224:227], 0
    v_accvgpr_read_b32 v254, a254
    v_max3_f32 v248, v248, v204, v205
    v_mfma_f32_16x16x32_bf16 v[228:231], a[148:151], a[228:231], v[228:231]
    v_max3_f32 v248, v248, v206, v207
    v_max3_f32 v248, v248, v208, v209
    v_mfma_f32_16x16x32_bf16 v[232:235], a[168:171], a[224:227], 0
    v_cvt_pk_bf16_f32 v86, v236, v237
    v_cvt_pk_bf16_f32 v89, v238, v239
    v_mfma_f32_16x16x32_bf16 v[232:235], a[172:175], a[228:231], v[232:235]
    ds_read_b128 v[204:207], v244 offset:128
    v_max3_f32 v248, v248, v210, v211
    v_mfma_f32_16x16x32_bf16 v[236:239], a[192:195], a[224:227], 0
    ds_read_b128 v[208:211], v245 offset:128
    v_max3_f32 v248, v248, v196, v197
    v_mfma_f32_16x16x32_bf16 v[236:239], a[196:199], a[228:231], v[236:239]
    s_waitcnt lgkmcnt(6)
    v_max3_f32 v248, v248, v198, v199
    v_mfma_f32_16x16x32_bf16 v[228:231], a[152:155], a[232:235], v[228:231]
    ds_read_b128 v[196:199], v246 offset:128
    s_waitcnt vmcnt(6) lgkmcnt(4)
    v_mfma_f32_16x16x32_bf16 v[228:231], a[156:159], a[236:239], v[228:231]
    s_barrier
    ds_read_b128 a[216:219], v240 offset:30720
    v_mfma_f32_16x16x32_bf16 v[228:231], a[160:163], a[240:243], v[228:231]
    ds_read_b128 a[220:223], v241 offset:30720
    ds_read_b128 a[224:227], v240 offset:30848
    v_mfma_f32_16x16x32_bf16 v[228:231], a[164:167], a[244:247], v[228:231]
    ds_read_b128 a[228:231], v241 offset:30848
    buffer_load_dwordx4 v255, s[4:7], s44 offen offset:1024 lds
    v_mfma_f32_16x16x32_bf16 v[232:235], a[176:179], a[232:235], v[232:235]
    s_waitcnt lgkmcnt(7)
    v_accvgpr_read_b32 v255, a252
    v_mfma_f32_16x16x32_bf16 v[200:203], v[156:159], v[168:171], v[200:203]
    s_waitcnt lgkmcnt(6)
    v_mfma_f32_16x16x32_bf16 v[200:203], v[158:161], v[170:173], v[200:203]
    s_waitcnt lgkmcnt(5)
    v_mul_f32 v228, s38, v228
    v_mul_f32 v229, s38, v229
    v_mfma_f32_16x16x32_bf16 v[204:207], v[162:165], v[168:171], v[204:207]
    v_mul_f32 v230, s38, v230
    v_mul_f32 v231, s38, v231
    v_mfma_f32_16x16x32_bf16 v[204:207], v[164:167], v[170:173], v[204:207]
    s_waitcnt lgkmcnt(4)
    v_cvt_pk_bf16_f32 v174, v228, v229
    v_cvt_pk_bf16_f32 v175, v230, v231
    v_mfma_f32_16x16x32_bf16 v[208:211], v[102:105], v[168:171], v[208:211]
    ds_write_b64 v247, v[174:175] offset:0
    v_mfma_f32_16x16x32_bf16 v[208:211], v[104:107], v[170:173], v[208:211]
    buffer_load_dwordx4 v254, s[4:7], s44 offen offset:2048 lds
    s_add_u32 m0, s46, 0xc00
    v_mfma_f32_16x16x32_bf16 v[196:199], v[108:111], v[168:171], v[196:199]
    s_waitcnt lgkmcnt(4)
    v_accvgpr_read_b32 v254, a253
    v_max3_f32 v248, v248, v200, v201
    v_mfma_f32_16x16x32_bf16 v[196:199], v[110:113], v[170:173], v[196:199]
    v_max3_f32 v248, v248, v202, v203
    v_max3_f32 v248, v248, v204, v205
    v_mfma_f32_16x16x32_bf16 v[232:235], a[180:183], a[236:239], v[232:235]
    ds_read_b128 v[200:203], v244 offset:0
    ds_read_b128 v[204:207], v245 offset:0
    v_mfma_f32_16x16x32_bf16 v[232:235], a[184:187], a[240:243], v[232:235]
    buffer_load_dwordx4 v255, s[4:7], s59 offen lds
    v_accvgpr_read_b32 v255, a254
    v_mfma_f32_16x16x32_bf16 v[232:235], a[188:191], a[244:247], v[232:235]
    v_max3_f32 v248, v248, v208, v209
    v_max3_f32 v248, v248, v196, v197
    v_mfma_f32_16x16x32_bf16 v[236:239], a[200:203], a[232:235], v[236:239]
    ds_read_b128 a[232:235], v240 offset:30976
    ds_read_b128 v[208:211], v246 offset:0
    v_mfma_f32_16x16x32_bf16 v[236:239], a[204:207], a[236:239], v[236:239]
    ds_read_b128 a[236:239], v241 offset:30976
    ds_read_b128 v[196:199], v244 offset:64
    v_mfma_f32_16x16x32_bf16 v[236:239], a[208:211], a[240:243], v[236:239]
    v_mul_f32 v232, s3, v232
    v_mul_f32 v233, s3, v233
    v_mfma_f32_16x16x32_bf16 v[236:239], a[212:215], a[244:247], v[236:239]
    v_mul_f32 v234, s3, v234
    v_mul_f32 v235, s3, v235
    v_mfma_f32_16x16x32_bf16 v[228:231], a[0:3], a[216:219], 0
    s_waitcnt lgkmcnt(7)
    v_cvt_pk_bf16_f32 v176, v232, v233
    v_cvt_pk_bf16_f32 v177, v234, v235
    v_mfma_f32_16x16x32_bf16 v[228:231], a[4:7], a[220:223], v[228:231]
    ds_write_b64 v247, v[176:177] offset:128
    v_mfma_f32_16x16x32_bf16 v[228:231], a[8:11], a[224:227], v[228:231]
    s_waitcnt lgkmcnt(5)
    v_mul_f32 v236, s38, v236
    v_mul_f32 v237, s38, v237
    v_mfma_f32_16x16x32_bf16 v[200:203], v[90:93], v[168:171], v[200:203]
    v_mul_f32 v238, s38, v238
    v_mul_f32 v239, s38, v239
    v_mfma_f32_16x16x32_bf16 v[200:203], v[92:95], v[170:173], v[200:203]
    v_cvt_pk_bf16_f32 v178, v236, v237
    v_cvt_pk_bf16_f32 v179, v238, v239
    v_mfma_f32_16x16x32_bf16 v[204:207], v[126:129], v[168:171], v[204:207]
    ds_write_b64 v247, v[178:179] offset:256
    v_mfma_f32_16x16x32_bf16 v[204:207], v[128:131], v[170:173], v[204:207]
    ds_read_b128 a[240:243], v242 offset:30720
    ds_read_b128 a[244:247], v243 offset:30720
    v_mfma_f32_16x16x32_bf16 v[228:231], a[12:15], a[228:231], v[228:231]
    buffer_load_dwordx4 v254, s[4:7], s59 offen offset:1024 lds
    v_accvgpr_read_b32 v254, a252
    v_mfma_f32_16x16x32_bf16 v[232:235], a[24:27], a[216:219], 0
    s_waitcnt lgkmcnt(4)
    v_mov_b32 v225, v248
    v_mfma_f32_16x16x32_bf16 v[208:211], v[150:153], v[168:171], v[208:211]
    v_mfma_f32_16x16x32_bf16 v[208:211], v[152:155], v[170:173], v[208:211]
    v_permlane16_swap_b32 v248, v225
    v_max_f32 v248, v248, v225
    v_mfma_f32_16x16x32_bf16 v[196:199], v[96:99], v[168:171], v[196:199]
    buffer_load_dwordx4 v255, s[4:7], s59 offen offset:2048 lds
    s_add_u32 m0, s46, 0x1800
    v_mfma_f32_16x16x32_bf16 v[196:199], v[98:101], v[170:173], v[196:199]
    v_accvgpr_read_b32 v255, a255
    v_mov_b32 v225, v248
    v_mfma_f32_16x16x32_bf16 v[228:231], a[16:19], a[232:235], v[228:231]
    v_mfma_f32_16x16x32_bf16 v[228:231], a[20:23], a[236:239], v[228:231]
    v_permlane32_swap_b32 v248, v225
    v_max_f32 v248, v248, v225
    v_mfma_f32_16x16x32_bf16 v[232:235], a[28:31], a[220:223], v[232:235]
    buffer_load_dwordx4 v254, s[4:7], s58 offen lds
    v_sub_f32 v200, v200, v248
    v_mfma_f32_16x16x32_bf16 v[232:235], a[32:35], a[224:227], v[232:235]
    v_exp_f32 v200, v200
    v_mfma_f32_16x16x32_bf16 v[232:235], a[36:39], a[228:231], v[232:235]
    v_cvt_pk_bf16_f32 v90, v228, v229
    v_cvt_pk_bf16_f32 v91, v230, v231
    v_mfma_f32_16x16x32_bf16 v[232:235], a[40:43], a[232:235], v[232:235]
    v_sub_f32 v201, v201, v248
    v_sub_f32 v202, v202, v248
    v_mfma_f32_16x16x32_bf16 v[232:235], a[44:47], a[236:239], v[232:235]
    buffer_load_dwordx4 v255, s[4:7], s58 offen offset:512 lds
    s_add_u32 m0, s46, 0x16800
    v_mfma_f32_16x16x32_bf16 v[236:239], a[48:51], a[216:219], 0
    v_exp_f32 v201, v201
    v_mfma_f32_16x16x32_bf16 v[236:239], a[52:55], a[220:223], v[236:239]
    v_exp_f32 v202, v202
    v_mfma_f32_16x16x32_bf16 v[236:239], a[56:59], a[224:227], v[236:239]
    v_sub_f32 v203, v203, v248
    v_cvt_pk_bf16_f32 v92, v232, v233
    v_mfma_f32_16x16x32_bf16 v[236:239], a[60:63], a[228:231], v[236:239]
    v_cvt_pk_bf16_f32 v93, v234, v235
    v_cvt_pk_bf16_f32 v180, v200, v201
    v_mfma_f32_16x16x32_bf16 v[236:239], a[64:67], a[232:235], v[236:239]
    v_exp_f32 v203, v203
    v_mfma_f32_16x16x32_bf16 v[236:239], a[68:71], a[236:239], v[236:239]
    v_cvt_pk_bf16_f32 v183, v202, v203
    v_sub_f32 v204, v204, v248
    v_mfma_f32_16x16x32_bf16 v[228:231], a[216:219], a[72:75], 0
    ds_read_b128 v[200:203], v245 offset:64
    v_sub_f32 v205, v205, v248
    v_mfma_f32_16x16x32_bf16 v[228:231], a[220:223], a[76:79], v[228:231]
    v_exp_f32 v204, v204
    v_mfma_f32_16x16x32_bf16 v[228:231], a[224:227], a[80:83], v[228:231]
    v_cvt_pk_bf16_f32 v94, v236, v237
    v_cvt_pk_bf16_f32 v95, v238, v239
    v_mfma_f32_16x16x32_bf16 v[228:231], a[228:231], a[84:87], v[228:231]
    v_exp_f32 v205, v205
    v_mfma_f32_16x16x32_bf16 v[228:231], a[232:235], a[88:91], v[228:231]
    v_sub_f32 v206, v206, v248
    v_sub_f32 v207, v207, v248
    v_mfma_f32_16x16x32_bf16 v[228:231], a[236:239], a[92:95], v[228:231]
    v_exp_f32 v206, v206
    v_mfma_f32_16x16x32_bf16 v[232:235], a[216:219], a[96:99], 0
    v_exp_f32 v207, v207
    v_mfma_f32_16x16x32_bf16 v[232:235], a[220:223], a[100:103], v[232:235]
    v_cvt_pk_bf16_f32 v181, v204, v205
    v_cvt_pk_bf16_f32 v184, v206, v207
    v_mfma_f32_16x16x32_bf16 v[232:235], a[224:227], a[104:107], v[232:235]
    ds_read_b128 v[204:207], v246 offset:64
    v_cvt_pk_bf16_f32 v0, v228, v229
    v_mfma_f32_16x16x32_bf16 v[232:235], a[228:231], a[108:111], v[232:235]
    s_waitcnt lgkmcnt(1)
    v_cvt_pk_bf16_f32 v3, v230, v231
    v_sub_f32 v208, v208, v248
    v_mfma_f32_16x16x32_bf16 v[200:203], v[132:135], v[168:171], v[200:203]
    v_exp_f32 v208, v208
    v_mfma_f32_16x16x32_bf16 v[200:203], v[134:137], v[170:173], v[200:203]
    v_sub_f32 v209, v209, v248
    v_sub_f32 v210, v210, v248
    v_mfma_f32_16x16x32_bf16 v[232:235], a[232:235], a[112:115], v[232:235]
    v_exp_f32 v209, v209
    v_mfma_f32_16x16x32_bf16 v[232:235], a[236:239], a[116:119], v[232:235]
    v_exp_f32 v210, v210
    v_mfma_f32_16x16x32_bf16 v[236:239], a[216:219], a[120:123], 0
    ds_read_b128 a[216:219], v242 offset:30848
    v_sub_f32 v211, v211, v248
    v_mfma_f32_16x16x32_bf16 v[236:239], a[220:223], a[124:127], v[236:239]
    ds_read_b128 a[220:223], v243 offset:30848
    v_cvt_pk_bf16_f32 v182, v208, v209
    v_mfma_f32_16x16x32_bf16 v[236:239], a[224:227], a[128:131], v[236:239]
    v_cvt_pk_bf16_f32 v30, v232, v233
    v_cvt_pk_bf16_f32 v33, v234, v235
    v_mfma_f32_16x16x32_bf16 v[212:215], v[12:15], v[180:183], 0
    ds_read_b128 a[224:227], v242 offset:30976
    v_sub_f32 v196, v196, v248
    v_mfma_f32_16x16x32_bf16 v[216:219], v[42:45], v[180:183], 0
    s_waitcnt lgkmcnt(3)
    v_exp_f32 v211, v211
    v_mfma_f32_16x16x32_bf16 v[220:223], v[72:75], v[180:183], 0
    v_cvt_pk_bf16_f32 v185, v210, v211
    v_sub_f32 v197, v197, v248
    v_mfma_f32_16x16x32_bf16 v[224:227], a[248:251], v[180:183], 0
    ds_read_b128 v[208:211], v244 offset:128
    v_sub_f32 v198, v198, v248
    v_mfma_f32_16x16x32_bf16 v[204:207], v[156:159], v[168:171], v[204:207]
    v_exp_f32 v196, v196
    v_mfma_f32_16x16x32_bf16 v[204:207], v[158:161], v[170:173], v[204:207]
    v_exp_f32 v197, v197
    v_mfma_f32_16x16x32_bf16 v[236:239], a[228:231], a[132:135], v[236:239]
    ds_read_b128 a[228:231], v243 offset:30976
    v_sub_f32 v199, v199, v248
    v_mfma_f32_16x16x32_bf16 v[236:239], a[232:235], a[136:139], v[236:239]
    ds_read_b128 a[232:235], v240 offset:32256
    v_cvt_pk_bf16_f32 v186, v196, v197
    v_mfma_f32_16x16x32_bf16 v[236:239], a[236:239], a[140:143], v[236:239]
    ds_read_b128 a[236:239], v241 offset:32256
    v_sub_f32 v200, v200, v248
    v_mfma_f32_16x16x32_bf16 v[228:231], a[144:147], a[240:243], 0
    v_exp_f32 v198, v198
    v_mfma_f32_16x16x32_bf16 v[228:231], a[148:151], a[244:247], v[228:231]
    s_waitcnt lgkmcnt(6)
    v_exp_f32 v199, v199
    v_mfma_f32_16x16x32_bf16 v[228:231], a[152:155], a[216:219], v[228:231]
    s_waitcnt lgkmcnt(5)
    v_cvt_pk_bf16_f32 v60, v236, v237
    v_cvt_pk_bf16_f32 v63, v238, v239
    v_mfma_f32_16x16x32_bf16 v[228:231], a[156:159], a[220:223], v[228:231]
    s_waitcnt lgkmcnt(3)
    v_cvt_pk_bf16_f32 v189, v198, v199
    v_sub_f32 v201, v201, v248
    v_mfma_f32_16x16x32_bf16 v[208:211], v[162:165], v[168:171], v[208:211]
    ds_read_b128 v[196:199], v245 offset:128
    v_sub_f32 v202, v202, v248
    v_mfma_f32_16x16x32_bf16 v[208:211], v[164:167], v[170:173], v[208:211]
    v_exp_f32 v200, v200
    v_mfma_f32_16x16x32_bf16 v[228:231], a[160:163], a[224:227], v[228:231]
    s_waitcnt lgkmcnt(3)
    v_exp_f32 v201, v201
    v_mfma_f32_16x16x32_bf16 v[228:231], a[164:167], a[228:231], v[228:231]
    v_exp_f32 v202, v202
    v_mfma_f32_16x16x32_bf16 v[232:235], a[168:171], a[240:243], 0
    v_sub_f32 v203, v203, v248
    v_cvt_pk_bf16_f32 v187, v200, v201
    v_mfma_f32_16x16x32_bf16 v[232:235], a[172:175], a[244:247], v[232:235]
    v_exp_f32 v203, v203
    v_mfma_f32_16x16x32_bf16 v[212:215], v[16:19], v[184:187], v[212:215]
    v_cvt_pk_bf16_f32 v190, v202, v203
    v_mul_f32 v228, s38, v228
    v_mfma_f32_16x16x32_bf16 v[216:219], v[46:49], v[184:187], v[216:219]
    v_mul_f32 v229, s38, v229
    v_mul_f32 v230, s38, v230
    v_mfma_f32_16x16x32_bf16 v[220:223], v[76:79], v[184:187], v[220:223]
    ds_read_b128 v[200:203], v246 offset:128
    v_mul_f32 v231, s38, v231
    v_mfma_f32_16x16x32_bf16 v[224:227], a[248:251], v[184:187], v[224:227]
    s_waitcnt lgkmcnt(1)
    v_sub_f32 v204, v204, v248
    v_sub_f32 v205, v205, v248
    v_mfma_f32_16x16x32_bf16 v[196:199], v[102:105], v[168:171], v[196:199]
    v_exp_f32 v204, v204
    v_mfma_f32_16x16x32_bf16 v[196:199], v[104:107], v[170:173], v[196:199]
    v_exp_f32 v205, v205
    v_mfma_f32_16x16x32_bf16 v[232:235], a[176:179], a[216:219], v[232:235]
    v_sub_f32 v206, v206, v248
    v_sub_f32 v207, v207, v248
    v_mfma_f32_16x16x32_bf16 v[232:235], a[180:183], a[220:223], v[232:235]
    v_exp_f32 v206, v206
    v_mfma_f32_16x16x32_bf16 v[232:235], a[184:187], a[224:227], v[232:235]
    v_exp_f32 v207, v207
    v_mfma_f32_16x16x32_bf16 v[232:235], a[188:191], a[228:231], v[232:235]
    v_cvt_pk_bf16_f32 v188, v204, v205
    v_cvt_pk_bf16_f32 v191, v206, v207
    v_mfma_f32_16x16x32_bf16 v[236:239], a[192:195], a[240:243], 0
    ds_read_b128 a[240:243], v240 offset:32384
    ds_read_b128 v[204:207], v244 offset:0
    v_mfma_f32_16x16x32_bf16 v[212:215], v[20:23], v[188:191], v[212:215]
    s_waitcnt lgkmcnt(2)
    v_sub_f32 v208, v208, v248
    v_mul_f32 v232, s3, v232
    v_mfma_f32_16x16x32_bf16 v[216:219], v[50:53], v[188:191], v[216:219]
    v_mul_f32 v233, s3, v233
    v_mul_f32 v234, s3, v234
    v_mfma_f32_16x16x32_bf16 v[220:223], v[80:83], v[188:191], v[220:223]
    v_mul_f32 v235, s3, v235
    v_sub_f32 v209, v209, v248
    v_mfma_f32_16x16x32_bf16 v[224:227], a[248:251], v[188:191], v[224:227]
    v_exp_f32 v208, v208
    v_mfma_f32_16x16x32_bf16 v[200:203], v[108:111], v[168:171], v[200:203]
    v_cvt_pk_bf16_f32 v168, v228, v229
    v_cvt_pk_bf16_f32 v169, v230, v231
    v_mfma_f32_16x16x32_bf16 v[200:203], v[110:113], v[170:173], v[200:203]
    v_cvt_pk_bf16_f32 v170, v232, v233
    v_cvt_pk_bf16_f32 v171, v234, v235
    v_mfma_f32_16x16x32_bf16 v[236:239], a[196:199], a[244:247], v[236:239]
    ds_read_b128 a[244:247], v241 offset:32384
    v_sub_f32 v196, v196, v248
    v_mfma_f32_16x16x32_bf16 v[236:239], a[200:203], a[216:219], v[236:239]
    ds_read_b128 a[216:219], v240 offset:32512
    v_sub_f32 v197, v197, v248
    v_mfma_f32_16x16x32_bf16 v[236:239], a[204:207], a[220:223], v[236:239]
    ds_read_b128 a[220:223], v241 offset:32512
    v_sub_f32 v200, v200, v248
    v_mfma_f32_16x16x32_bf16 v[236:239], a[208:211], a[224:227], v[236:239]
    ds_read_b128 a[224:227], v242 offset:32256
    v_sub_f32 v201, v201, v248
    v_mfma_f32_16x16x32_bf16 v[236:239], a[212:215], a[228:231], v[236:239]
    ds_read_b128 a[228:231], v243 offset:32256
    s_waitcnt lgkmcnt(5)
    v_mfma_f32_16x16x32_bf16 v[204:207], v[96:99], v[174:177], v[204:207]
    v_exp_f32 v209, v209
    v_mfma_f32_16x16x32_bf16 v[204:207], v[98:101], v[176:179], v[204:207]
    v_exp_f32 v196, v196
    v_mfma_f32_16x16x32_bf16 v[228:231], a[0:3], a[232:235], 0
    v_exp_f32 v197, v197
    v_mfma_f32_16x16x32_bf16 v[228:231], a[4:7], a[236:239], v[228:231]
    v_mul_f32 v236, s38, v236
    v_mul_f32 v237, s38, v237
    v_mfma_f32_16x16x32_bf16 v[228:231], a[8:11], a[240:243], v[228:231]
    s_waitcnt lgkmcnt(4)
    v_mul_f32 v238, s38, v238
    v_mul_f32 v239, s38, v239
    v_mfma_f32_16x16x32_bf16 v[228:231], a[12:15], a[244:247], v[228:231]
    s_waitcnt lgkmcnt(3)
    v_cvt_pk_bf16_f32 v172, v236, v237
    v_cvt_pk_bf16_f32 v173, v238, v239
    v_mfma_f32_16x16x32_bf16 v[228:231], a[16:19], a[216:219], v[228:231]
    s_waitcnt lgkmcnt(2)
    v_cvt_pk_bf16_f32 v192, v208, v209
    v_cvt_pk_bf16_f32 v193, v196, v197
    v_mfma_f32_16x16x32_bf16 v[228:231], a[20:23], a[220:223], v[228:231]
    ds_read_b128 v[208:211], v245 offset:0
    ds_read_b128 v[196:199], v246 offset:0
    v_mfma_f32_16x16x32_bf16 v[232:235], a[24:27], a[232:235], 0
    v_exp_f32 v200, v200
    v_mfma_f32_16x16x32_bf16 v[232:235], a[28:31], a[236:239], v[232:235]
    v_exp_f32 v201, v201
    v_mfma_f32_16x16x32_bf16 v[232:235], a[32:35], a[240:243], v[232:235]
    v_cvt_pk_bf16_f32 v194, v200, v201
    v_max_f32 v248, v204, v205
    v_mfma_f32_16x16x32_bf16 v[232:235], a[36:39], a[244:247], v[232:235]
    ds_read_b128 v[200:203], v244 offset:64
    v_max3_f32 v248, v248, v206, v207
    v_mfma_f32_16x16x32_bf16 v[212:215], v[24:27], v[192:195], v[212:215]
    ds_read_b128 v[204:207], v245 offset:64
    v_mfma_f32_16x16x32_bf16 v[216:219], v[54:57], v[192:195], v[216:219]
    v_mfma_f32_16x16x32_bf16 v[220:223], v[84:87], v[192:195], v[220:223]
    v_mfma_f32_16x16x32_bf16 v[224:227], a[248:251], v[192:195], v[224:227]
    v_mfma_f32_16x16x32_bf16 v[232:235], a[40:43], a[216:219], v[232:235]
    s_waitcnt lgkmcnt(3)
    s_waitcnt lgkmcnt(2)
    v_mfma_f32_16x16x32_bf16 v[208:211], v[132:135], v[174:177], v[208:211]
    v_mfma_f32_16x16x32_bf16 v[208:211], v[134:137], v[176:179], v[208:211]
    v_mfma_f32_16x16x32_bf16 v[196:199], v[156:159], v[174:177], v[196:199]
    v_mfma_f32_16x16x32_bf16 v[196:199], v[158:161], v[176:179], v[196:199]
    s_waitcnt lgkmcnt(1)
    v_rcp_f32 v225, v224
    v_mfma_f32_16x16x32_bf16 v[200:203], v[162:165], v[174:177], v[200:203]
    s_waitcnt lgkmcnt(0)
    v_mul_f32 v212, v212, v225
    v_mul_f32 v213, v213, v225
    v_mfma_f32_16x16x32_bf16 v[200:203], v[164:167], v[176:179], v[200:203]
    v_mul_f32 v214, v214, v225
    v_mul_f32 v215, v215, v225
    v_mfma_f32_16x16x32_bf16 v[204:207], v[102:105], v[174:177], v[204:207]
    v_cvt_pk_bf16_f32 v212, v212, v213
    v_cvt_pk_bf16_f32 v213, v214, v215
    v_mfma_f32_16x16x32_bf16 v[204:207], v[104:107], v[176:179], v[204:207]
    ds_write_b64 v251, v[212:213] offset:12288
    v_mfma_f32_16x16x32_bf16 v[232:235], a[44:47], a[220:223], v[232:235]
    v_mul_f32 v216, v216, v225
    v_mul_f32 v217, v217, v225
    v_mfma_f32_16x16x32_bf16 v[236:239], a[48:51], a[232:235], 0
    v_mul_f32 v218, v218, v225
    v_mul_f32 v219, v219, v225
    v_mfma_f32_16x16x32_bf16 v[236:239], a[52:55], a[236:239], v[236:239]
    v_cvt_pk_bf16_f32 v216, v216, v217
    v_cvt_pk_bf16_f32 v217, v218, v219
    v_mfma_f32_16x16x32_bf16 v[236:239], a[56:59], a[240:243], v[236:239]
    ds_write_b64 v251, v[216:217] offset:12416
    v_mfma_f32_16x16x32_bf16 v[236:239], a[60:63], a[244:247], v[236:239]
    v_mul_f32 v220, v220, v225
    v_mul_f32 v221, v221, v225
    v_mfma_f32_16x16x32_bf16 v[236:239], a[64:67], a[216:219], v[236:239]
    v_mul_f32 v222, v222, v225
    v_mul_f32 v223, v223, v225
    v_mfma_f32_16x16x32_bf16 v[236:239], a[68:71], a[220:223], v[236:239]
    v_cvt_pk_bf16_f32 v220, v220, v221
    v_cvt_pk_bf16_f32 v221, v222, v223
    ds_write_b64 v251, v[220:221] offset:12544
    v_max3_f32 v248, v248, v208, v209
    v_max3_f32 v248, v248, v210, v211
    ds_read_b128 v[208:211], v246 offset:64
    v_max3_f32 v248, v248, v196, v197
    v_max3_f32 v248, v248, v198, v199
    ds_read_b128 v[196:199], v244 offset:0
    v_max3_f32 v248, v248, v200, v201
    v_max3_f32 v248, v248, v202, v203
    ds_read_b128 v[200:203], v245 offset:0
    v_max3_f32 v248, v248, v204, v205
    v_max3_f32 v248, v248, v206, v207
    ds_read_b128 v[204:207], v246 offset:0
    s_waitcnt lgkmcnt(3)
    v_mfma_f32_16x16x32_bf16 v[208:211], v[108:111], v[174:177], v[208:211]
    v_mfma_f32_16x16x32_bf16 v[208:211], v[110:113], v[176:179], v[208:211]
    s_waitcnt lgkmcnt(2)
    v_mfma_f32_16x16x32_bf16 v[196:199], v[96:99], v[174:177], v[196:199]
    s_waitcnt lgkmcnt(1)
    v_cvt_pk_bf16_f32 v96, v228, v229
    v_cvt_pk_bf16_f32 v97, v230, v231
    v_mfma_f32_16x16x32_bf16 v[196:199], v[98:101], v[176:179], v[196:199]
    v_cvt_pk_bf16_f32 v98, v232, v233
    v_cvt_pk_bf16_f32 v99, v234, v235
    v_mfma_f32_16x16x32_bf16 v[200:203], v[132:135], v[174:177], v[200:203]
    s_waitcnt lgkmcnt(0)
    v_cvt_pk_bf16_f32 v100, v236, v237
    v_cvt_pk_bf16_f32 v101, v238, v239
    v_mfma_f32_16x16x32_bf16 v[200:203], v[134:137], v[176:179], v[200:203]
    v_max3_f32 v248, v248, v208, v209
    v_max3_f32 v248, v248, v210, v211
    v_mfma_f32_16x16x32_bf16 v[204:207], v[156:159], v[174:177], v[204:207]
    ds_read_b128 v[208:211], v244 offset:64
    v_mov_b32 v225, v248
    v_mfma_f32_16x16x32_bf16 v[204:207], v[158:161], v[176:179], v[204:207]
    v_mfma_f32_16x16x32_bf16 v[228:231], a[232:235], a[72:75], 0
    v_permlane16_swap_b32 v248, v225
    v_max_f32 v248, v248, v225
    v_mfma_f32_16x16x32_bf16 v[228:231], a[236:239], a[76:79], v[228:231]
    v_mov_b32 v225, v248
    v_mfma_f32_16x16x32_bf16 v[228:231], a[240:243], a[80:83], v[228:231]
    v_mfma_f32_16x16x32_bf16 v[228:231], a[244:247], a[84:87], v[228:231]
    v_permlane32_swap_b32 v248, v225
    v_max_f32 v248, v248, v225
    v_mfma_f32_16x16x32_bf16 v[228:231], a[216:219], a[88:91], v[228:231]
    v_sub_f32 v196, v196, v248
    v_sub_f32 v197, v197, v248
    v_mfma_f32_16x16x32_bf16 v[228:231], a[220:223], a[92:95], v[228:231]
    v_exp_f32 v196, v196
    v_mfma_f32_16x16x32_bf16 v[232:235], a[232:235], a[96:99], 0
    v_exp_f32 v197, v197
    v_mfma_f32_16x16x32_bf16 v[232:235], a[236:239], a[100:103], v[232:235]
    s_waitcnt lgkmcnt(0)
    v_sub_f32 v198, v198, v248
    v_sub_f32 v199, v199, v248
    v_mfma_f32_16x16x32_bf16 v[208:211], v[162:165], v[174:177], v[208:211]
    v_cvt_pk_bf16_f32 v6, v228, v229
    v_cvt_pk_bf16_f32 v9, v230, v231
    v_mfma_f32_16x16x32_bf16 v[208:211], v[164:167], v[176:179], v[208:211]
    v_exp_f32 v198, v198
    v_mfma_f32_16x16x32_bf16 v[232:235], a[240:243], a[104:107], v[232:235]
    v_exp_f32 v199, v199
    v_mfma_f32_16x16x32_bf16 v[232:235], a[244:247], a[108:111], v[232:235]
    v_cvt_pk_bf16_f32 v180, v196, v197
    v_cvt_pk_bf16_f32 v183, v198, v199
    v_mfma_f32_16x16x32_bf16 v[232:235], a[216:219], a[112:115], v[232:235]
    ds_read_b128 v[196:199], v245 offset:64
    v_sub_f32 v200, v200, v248
    v_mfma_f32_16x16x32_bf16 v[232:235], a[220:223], a[116:119], v[232:235]
    v_exp_f32 v200, v200
    v_mfma_f32_16x16x32_bf16 v[236:239], a[232:235], a[120:123], 0
    ds_read_b128 a[232:235], v242 offset:32384
    v_sub_f32 v201, v201, v248
    v_mfma_f32_16x16x32_bf16 v[236:239], a[236:239], a[124:127], v[236:239]
    ds_read_b128 a[236:239], v243 offset:32384
    v_sub_f32 v202, v202, v248
    v_mfma_f32_16x16x32_bf16 v[236:239], a[240:243], a[128:131], v[236:239]
    v_cvt_pk_bf16_f32 v36, v232, v233
    v_cvt_pk_bf16_f32 v39, v234, v235
    v_mfma_f32_16x16x32_bf16 v[236:239], a[244:247], a[132:135], v[236:239]
    ds_read_b128 a[240:243], v242 offset:32512
    ds_read_b128 a[244:247], v243 offset:32512
    v_mfma_f32_16x16x32_bf16 v[236:239], a[216:219], a[136:139], v[236:239]
    ds_read_b128 a[216:219], v242 offset:33792
    v_sub_f32 v203, v203, v248
    v_mfma_f32_16x16x32_bf16 v[236:239], a[220:223], a[140:143], v[236:239]
    ds_read_b128 a[220:223], v243 offset:33792
    v_sub_f32 v204, v204, v248
    v_mfma_f32_16x16x32_bf16 v[228:231], a[144:147], a[224:227], 0
    v_exp_f32 v201, v201
    v_mfma_f32_16x16x32_bf16 v[228:231], a[148:151], a[228:231], v[228:231]
    s_waitcnt lgkmcnt(6)
    v_exp_f32 v202, v202
    v_mfma_f32_16x16x32_bf16 v[196:199], v[102:105], v[174:177], v[196:199]
    v_cvt_pk_bf16_f32 v66, v236, v237
    v_cvt_pk_bf16_f32 v69, v238, v239
    v_mfma_f32_16x16x32_bf16 v[196:199], v[104:107], v[176:179], v[196:199]
    s_waitcnt lgkmcnt(5)
    v_exp_f32 v203, v203
    v_mfma_f32_16x16x32_bf16 v[228:231], a[152:155], a[232:235], v[228:231]
    s_waitcnt lgkmcnt(4)
    v_cvt_pk_bf16_f32 v181, v200, v201
    v_cvt_pk_bf16_f32 v184, v202, v203
    v_mfma_f32_16x16x32_bf16 v[228:231], a[156:159], a[236:239], v[228:231]
    ds_read_b128 v[200:203], v246 offset:64
    v_sub_f32 v205, v205, v248
    v_mfma_f32_16x16x32_bf16 v[232:235], a[168:171], a[224:227], 0
    s_waitcnt lgkmcnt(4)
    v_exp_f32 v204, v204
    v_mfma_f32_16x16x32_bf16 v[228:231], a[160:163], a[240:243], v[228:231]
    s_waitcnt lgkmcnt(3)
    v_exp_f32 v205, v205
    v_mfma_f32_16x16x32_bf16 v[228:231], a[164:167], a[244:247], v[228:231]
    v_sub_f32 v206, v206, v248
    v_sub_f32 v207, v207, v248
    v_mfma_f32_16x16x32_bf16 v[232:235], a[172:175], a[228:231], v[232:235]
    v_exp_f32 v206, v206
    v_mfma_f32_16x16x32_bf16 v[232:235], a[176:179], a[232:235], v[232:235]
    v_exp_f32 v207, v207
    v_mfma_f32_16x16x32_bf16 v[232:235], a[180:183], a[236:239], v[232:235]
    v_cvt_pk_bf16_f32 v182, v204, v205
    v_mul_f32 v228, s38, v228
    v_mfma_f32_16x16x32_bf16 v[232:235], a[184:187], a[240:243], v[232:235]
    v_mul_f32 v229, s38, v229
    v_mul_f32 v230, s38, v230
    v_mfma_f32_16x16x32_bf16 v[212:215], v[18:21], v[180:183], 0
    v_mul_f32 v231, s38, v231
    v_cvt_pk_bf16_f32 v185, v206, v207
    v_mfma_f32_16x16x32_bf16 v[216:219], v[48:51], v[180:183], 0
    s_waitcnt lgkmcnt(0)
    v_sub_f32 v208, v208, v248
    v_sub_f32 v209, v209, v248
    v_mfma_f32_16x16x32_bf16 v[220:223], v[78:81], v[180:183], 0
    v_exp_f32 v208, v208
    v_mfma_f32_16x16x32_bf16 v[224:227], a[248:251], v[180:183], 0
    v_exp_f32 v209, v209
    v_mfma_f32_16x16x32_bf16 v[200:203], v[108:111], v[174:177], v[200:203]
    v_cvt_pk_bf16_f32 v174, v228, v229
    v_cvt_pk_bf16_f32 v175, v230, v231
    v_mfma_f32_16x16x32_bf16 v[200:203], v[110:113], v[176:179], v[200:203]
    v_sub_f32 v210, v210, v248
    v_sub_f32 v211, v211, v248
    v_mfma_f32_16x16x32_bf16 v[232:235], a[188:191], a[244:247], v[232:235]
    v_exp_f32 v210, v210
    v_mfma_f32_16x16x32_bf16 v[236:239], a[192:195], a[224:227], 0
    ds_read_b128 a[224:227], v242 offset:33920
    v_cvt_pk_bf16_f32 v186, v208, v209
    v_mfma_f32_16x16x32_bf16 v[236:239], a[196:199], a[228:231], v[236:239]
    ds_read_b128 a[228:231], v243 offset:33920
    v_sub_f32 v196, v196, v248
    v_mfma_f32_16x16x32_bf16 v[236:239], a[200:203], a[232:235], v[236:239]
    v_mul_f32 v232, s3, v232
    v_mul_f32 v233, s3, v233
    v_mfma_f32_16x16x32_bf16 v[236:239], a[204:207], a[236:239], v[236:239]
    v_mul_f32 v234, s3, v234
    v_mul_f32 v235, s3, v235
    v_mfma_f32_16x16x32_bf16 v[236:239], a[208:211], a[240:243], v[236:239]
    v_cvt_pk_bf16_f32 v176, v232, v233
    v_cvt_pk_bf16_f32 v177, v234, v235
    v_mfma_f32_16x16x32_bf16 v[236:239], a[212:215], a[244:247], v[236:239]
    ds_read_b128 a[232:235], v242 offset:34048
    ds_read_b128 a[236:239], v243 offset:34048
    v_mfma_f32_16x16x32_bf16 v[228:231], a[144:147], a[216:219], 0
    v_exp_f32 v211, v211
    v_mfma_f32_16x16x32_bf16 v[228:231], a[148:151], a[220:223], v[228:231]
    v_cvt_pk_bf16_f32 v189, v210, v211
    v_sub_f32 v197, v197, v248
    v_mfma_f32_16x16x32_bf16 v[232:235], a[168:171], a[216:219], 0
    v_mul_f32 v236, s38, v236
    v_mul_f32 v237, s38, v237
    v_mfma_f32_16x16x32_bf16 v[232:235], a[172:175], a[220:223], v[232:235]
    s_waitcnt lgkmcnt(3)
    v_mul_f32 v238, s38, v238
    v_mul_f32 v239, s38, v239
    v_mfma_f32_16x16x32_bf16 v[228:231], a[152:155], a[224:227], v[228:231]
    s_waitcnt lgkmcnt(2)
    v_cvt_pk_bf16_f32 v178, v236, v237
    v_cvt_pk_bf16_f32 v179, v238, v239
    v_mfma_f32_16x16x32_bf16 v[228:231], a[156:159], a[228:231], v[228:231]
    v_exp_f32 v196, v196
    v_mfma_f32_16x16x32_bf16 v[232:235], a[176:179], a[224:227], v[232:235]
    v_exp_f32 v197, v197
    v_mfma_f32_16x16x32_bf16 v[232:235], a[180:183], a[228:231], v[232:235]
    v_sub_f32 v198, v198, v248
    v_sub_f32 v199, v199, v248
    v_mfma_f32_16x16x32_bf16 v[236:239], a[192:195], a[216:219], 0
    s_waitcnt lgkmcnt(1)
    s_waitcnt vmcnt(8) lgkmcnt(0)
    s_barrier
    v_mfma_f32_16x16x32_bf16 v[228:231], a[160:163], a[232:235], v[228:231]
    ds_read_b128 a[240:243], v240 offset:33792
    ds_read_b128 a[244:247], v241 offset:33792
    v_mfma_f32_16x16x32_bf16 v[228:231], a[164:167], a[236:239], v[228:231]
    ds_read_b128 a[216:219], v240 offset:33920
    v_cvt_pk_bf16_f32 v187, v196, v197
    v_mfma_f32_16x16x32_bf16 v[232:235], a[184:187], a[232:235], v[232:235]
    v_exp_f32 v198, v198
    v_mfma_f32_16x16x32_bf16 v[212:215], v[22:25], v[184:187], v[212:215]
    v_exp_f32 v199, v199
    v_mfma_f32_16x16x32_bf16 v[216:219], v[52:55], v[184:187], v[216:219]
    v_cvt_pk_bf16_f32 v190, v198, v199
    v_mul_f32 v228, s38, v228
    v_mfma_f32_16x16x32_bf16 v[220:223], v[82:85], v[184:187], v[220:223]
    v_mul_f32 v229, s38, v229
    v_mul_f32 v230, s38, v230
    v_mfma_f32_16x16x32_bf16 v[224:227], a[248:251], v[184:187], v[224:227]
    v_mul_f32 v231, s38, v231
    v_cvt_pk_bf16_f32 v228, v228, v229
    v_mfma_f32_16x16x32_bf16 v[232:235], a[188:191], a[236:239], v[232:235]
    v_cvt_pk_bf16_f32 v229, v230, v231
    v_sub_f32 v200, v200, v248
    v_mfma_f32_16x16x32_bf16 v[236:239], a[196:199], a[220:223], v[236:239]
    ds_write_b64 v247, v[228:229] offset:18432
    v_mfma_f32_16x16x32_bf16 v[236:239], a[200:203], a[224:227], v[236:239]
    ds_read_b128 a[220:223], v241 offset:33920
    ds_read_b128 a[224:227], v240 offset:34048
    v_mfma_f32_16x16x32_bf16 v[236:239], a[204:207], a[228:231], v[236:239]
    s_waitcnt lgkmcnt(5)
    v_mul_f32 v232, s3, v232
    v_mul_f32 v233, s3, v233
    v_mfma_f32_16x16x32_bf16 v[236:239], a[208:211], a[232:235], v[236:239]
    v_mul_f32 v234, s3, v234
    v_mul_f32 v235, s3, v235
    v_mfma_f32_16x16x32_bf16 v[236:239], a[212:215], a[236:239], v[236:239]
    ds_read_b128 a[228:231], v241 offset:34048
    v_cvt_pk_bf16_f32 v232, v232, v233
    v_mfma_f32_16x16x32_bf16 v[228:231], a[0:3], a[240:243], 0
    s_waitcnt lgkmcnt(5)
    v_cvt_pk_bf16_f32 v233, v234, v235
    v_sub_f32 v201, v201, v248
    v_mfma_f32_16x16x32_bf16 v[228:231], a[4:7], a[244:247], v[228:231]
    s_waitcnt lgkmcnt(4)
    v_mul_f32 v236, s38, v236
    v_mul_f32 v237, s38, v237
    v_mfma_f32_16x16x32_bf16 v[228:231], a[8:11], a[216:219], v[228:231]
    ds_write_b64 v247, v[232:233] offset:18560
    v_mfma_f32_16x16x32_bf16 v[232:235], a[24:27], a[240:243], 0
    v_mul_f32 v238, s38, v238
    v_mul_f32 v239, s38, v239
    v_mfma_f32_16x16x32_bf16 v[232:235], a[28:31], a[244:247], v[232:235]
    ds_read_b128 a[232:235], v242 offset:61440
    v_cvt_pk_bf16_f32 v236, v236, v237
    v_mfma_f32_16x16x32_bf16 v[232:235], a[32:35], a[216:219], v[232:235]
    s_waitcnt lgkmcnt(4)
    v_cvt_pk_bf16_f32 v237, v238, v239
    v_sub_f32 v202, v202, v248
    v_mfma_f32_16x16x32_bf16 v[228:231], a[12:15], a[220:223], v[228:231]
    ds_write_b64 v247, v[236:237] offset:18688
    v_mfma_f32_16x16x32_bf16 v[232:235], a[36:39], a[220:223], v[232:235]
    ds_read_b128 a[236:239], v243 offset:61440
    v_sub_f32 v203, v203, v248
    v_mfma_f32_16x16x32_bf16 v[236:239], a[48:51], a[240:243], 0
    s_waitcnt lgkmcnt(5)
    v_exp_f32 v200, v200
    v_mfma_f32_16x16x32_bf16 v[228:231], a[16:19], a[224:227], v[228:231]
    s_waitcnt lgkmcnt(4)
    v_exp_f32 v201, v201
    v_mfma_f32_16x16x32_bf16 v[228:231], a[20:23], a[228:231], v[228:231]
    v_exp_f32 v202, v202
    v_mfma_f32_16x16x32_bf16 v[232:235], a[40:43], a[224:227], v[232:235]
    v_exp_f32 v203, v203
    v_mfma_f32_16x16x32_bf16 v[232:235], a[44:47], a[228:231], v[232:235]
    v_cvt_pk_bf16_f32 v188, v200, v201
    v_cvt_pk_bf16_f32 v191, v202, v203
    v_mfma_f32_16x16x32_bf16 v[236:239], a[52:55], a[244:247], v[236:239]
    v_mov_b32 v204, 0x237c0
    v_cvt_pk_bf16_f32 v162, v228, v229
    v_mfma_f32_16x16x32_bf16 v[212:215], v[26:29], v[188:191], v[212:215]
    v_cvt_pk_bf16_f32 v163, v230, v231
    v_add_u32 v205, 0xfffff900, v245
    v_mfma_f32_16x16x32_bf16 v[216:219], v[56:59], v[188:191], v[216:219]
    v_cvt_pk_bf16_f32 v164, v232, v233
    v_cvt_pk_bf16_f32 v165, v234, v235
    v_mfma_f32_16x16x32_bf16 v[220:223], v[86:89], v[188:191], v[220:223]
    v_add_u32 v246, 0x700, v245
    v_mfma_f32_16x16x32_bf16 v[224:227], a[248:251], v[188:191], v[224:227]
    v_mov_b32 v191, 0
    v_mfma_f32_16x16x32_bf16 v[236:239], a[56:59], a[216:219], v[236:239]
    v_mfma_f32_16x16x32_bf16 v[236:239], a[60:63], a[220:223], v[236:239]
    v_mfma_f32_16x16x32_bf16 v[236:239], a[64:67], a[224:227], v[236:239]
    v_mfma_f32_16x16x32_bf16 v[236:239], a[68:71], a[228:231], v[236:239]
    v_mfma_f32_16x16x32_bf16 v[228:231], a[240:243], a[72:75], 0
    v_mfma_f32_16x16x32_bf16 v[228:231], a[244:247], a[76:79], v[228:231]
    v_mfma_f32_16x16x32_bf16 v[228:231], a[216:219], a[80:83], v[228:231]
    v_rcp_f32 v225, v224
    v_mfma_f32_16x16x32_bf16 v[228:231], a[220:223], a[84:87], v[228:231]
    v_mov_b32 v226, 0x22e00
    v_cndmask_b32 v226, v226, v247, vcc
    v_mfma_f32_16x16x32_bf16 v[228:231], a[224:227], a[88:91], v[228:231]
    s_mov_b32 vcc_lo, 0x0
    v_cvt_pk_bf16_f32 v166, v236, v237
    v_cvt_pk_bf16_f32 v167, v238, v239
    v_mfma_f32_16x16x32_bf16 v[228:231], a[228:231], a[92:95], v[228:231]
    s_mov_b32 vcc_hi, 0xf0000
    v_mul_f32 v212, v212, v225
    v_mul_f32 v213, v213, v225
    v_mfma_f32_16x16x32_bf16 v[232:235], a[240:243], a[96:99], 0
    v_mul_f32 v214, v214, v225
    v_mul_f32 v215, v215, v225
    v_mfma_f32_16x16x32_bf16 v[232:235], a[244:247], a[100:103], v[232:235]
    v_cvt_pk_bf16_f32 v212, v212, v213
    v_cvt_pk_bf16_f32 v12, v228, v229
    v_mfma_f32_16x16x32_bf16 v[232:235], a[216:219], a[104:107], v[232:235]
    v_cvt_pk_bf16_f32 v15, v230, v231
    v_cvt_pk_bf16_f32 v213, v214, v215
    v_mfma_f32_16x16x32_bf16 v[232:235], a[220:223], a[108:111], v[232:235]
    ds_write_b64 v226, v[212:213] offset:0
    v_mfma_f32_16x16x32_bf16 v[232:235], a[224:227], a[112:115], v[232:235]
    s_waitcnt lgkmcnt(1)
    v_mul_f32 v216, v216, v225
    v_mul_f32 v217, v217, v225
    v_mfma_f32_16x16x32_bf16 v[232:235], a[228:231], a[116:119], v[232:235]
    v_mul_f32 v218, v218, v225
    v_mul_f32 v219, v219, v225
    v_mfma_f32_16x16x32_bf16 v[236:239], a[240:243], a[120:123], 0
    ds_read_b128 a[240:243], v242 offset:61568
    v_cvt_pk_bf16_f32 v216, v216, v217
    v_mfma_f32_16x16x32_bf16 v[236:239], a[244:247], a[124:127], v[236:239]
    ds_read_b128 a[244:247], v243 offset:61568
    v_cvt_pk_bf16_f32 v217, v218, v219
    v_mfma_f32_16x16x32_bf16 v[236:239], a[216:219], a[128:131], v[236:239]
    v_cvt_pk_bf16_f32 v42, v232, v233
    v_cvt_pk_bf16_f32 v45, v234, v235
    v_mfma_f32_16x16x32_bf16 v[236:239], a[220:223], a[132:135], v[236:239]
    ds_read_b128 a[216:219], v242 offset:61696
    ds_read_b128 a[220:223], v243 offset:61696
    v_mfma_f32_16x16x32_bf16 v[236:239], a[224:227], a[136:139], v[236:239]
    ds_read_b128 a[224:227], v242 offset:62976
    v_mul_f32 v220, v220, v225
    v_mfma_f32_16x16x32_bf16 v[236:239], a[228:231], a[140:143], v[236:239]
    ds_read_b128 a[228:231], v243 offset:62976
    v_mul_f32 v221, v221, v225
    v_mfma_f32_16x16x32_bf16 v[228:231], a[144:147], a[232:235], 0
    ds_write_b64 v226, v[216:217] offset:128
    v_mfma_f32_16x16x32_bf16 v[228:231], a[148:151], a[236:239], v[228:231]
    v_mul_f32 v222, v222, v225
    v_mul_f32 v223, v223, v225
    v_mfma_f32_16x16x32_bf16 v[232:235], a[168:171], a[232:235], 0
    s_waitcnt lgkmcnt(6)
    v_cvt_pk_bf16_f32 v72, v236, v237
    v_cvt_pk_bf16_f32 v75, v238, v239
    v_mfma_f32_16x16x32_bf16 v[228:231], a[152:155], a[240:243], v[228:231]
    s_waitcnt lgkmcnt(5)
    v_cvt_pk_bf16_f32 v220, v220, v221
    v_cvt_pk_bf16_f32 v221, v222, v223
    v_mfma_f32_16x16x32_bf16 v[228:231], a[156:159], a[244:247], v[228:231]
    ds_write_b64 v226, v[220:221] offset:256
    v_mfma_f32_16x16x32_bf16 v[232:235], a[172:175], a[236:239], v[232:235]
    s_waitcnt lgkmcnt(5)
    v_cndmask_b32 v244, v205, v244, vcc
    v_cndmask_b32 v245, v245, v204, vcc
    v_mfma_f32_16x16x32_bf16 v[228:231], a[160:163], a[216:219], v[228:231]
    ds_read_b128 v[208:211], v245 offset:192
    s_waitcnt vmcnt(0) lgkmcnt(5)
    v_mfma_f32_16x16x32_bf16 v[228:231], a[164:167], a[220:223], v[228:231]
    s_barrier
    s_mov_b32 vcc_lo, 0xff00fff0
    s_mov_b32 vcc_hi, 0xf000
    v_mfma_f32_16x16x32_bf16 v[232:235], a[176:179], a[240:243], v[232:235]
    v_cndmask_b32 v244, v244, v204, vcc
    s_mov_b32 vcc_lo, 0xfff00ff
    v_mfma_f32_16x16x32_bf16 v[232:235], a[180:183], a[244:247], v[232:235]
    ds_read_b128 v[200:203], v244 offset:256
    v_mul_f32 v228, s38, v228
    v_mfma_f32_16x16x32_bf16 v[232:235], a[184:187], a[216:219], v[232:235]
    s_mov_b32 vcc_hi, 0xffffffff
    v_mul_f32 v229, s38, v229
    v_mul_f32 v230, s38, v230
    v_mfma_f32_16x16x32_bf16 v[232:235], a[188:191], a[220:223], v[232:235]
    v_mul_f32 v231, s38, v231
    v_cvt_pk_bf16_f32 v228, v228, v229
    v_mfma_f32_16x16x32_bf16 v[236:239], a[192:195], a[232:235], 0
    ds_read_b128 a[232:235], v242 offset:63104
    v_cvt_pk_bf16_f32 v229, v230, v231
    v_mfma_f32_16x16x32_bf16 v[236:239], a[196:199], a[236:239], v[236:239]
    ds_write_b64 v247, v[228:229] offset:24576
    v_mfma_f32_16x16x32_bf16 v[236:239], a[200:203], a[240:243], v[236:239]
    s_waitcnt lgkmcnt(3)
    v_mul_f32 v232, s3, v232
    v_mul_f32 v233, s3, v233
    v_mfma_f32_16x16x32_bf16 v[208:211], v[138:141], v[168:171], v[208:211]
    v_mul_f32 v234, s3, v234
    v_mul_f32 v235, s3, v235
    v_mfma_f32_16x16x32_bf16 v[208:211], v[140:143], v[170:173], v[208:211]
    ds_read_b128 a[236:239], v243 offset:63104
    v_cvt_pk_bf16_f32 v232, v232, v233
    v_mfma_f32_16x16x32_bf16 v[236:239], a[204:207], a[244:247], v[236:239]
    ds_read_b128 a[240:243], v242 offset:63232
    v_cvt_pk_bf16_f32 v233, v234, v235
    v_mfma_f32_16x16x32_bf16 v[236:239], a[208:211], a[216:219], v[236:239]
    ds_write_b64 v247, v[232:233] offset:24704
    v_mfma_f32_16x16x32_bf16 v[236:239], a[212:215], a[220:223], v[236:239]
    ds_read_b128 a[244:247], v243 offset:63232
    ds_read_b128 a[216:219], v240 offset:35328
    v_mfma_f32_16x16x32_bf16 v[228:231], a[144:147], a[224:227], 0
    ds_read_b128 a[220:223], v241 offset:35328
    v_cndmask_b32 v246, v246, v204, vcc
    v_mfma_f32_16x16x32_bf16 v[228:231], a[148:151], a[228:231], v[228:231]
    ds_read_b128 v[204:207], v244 offset:192
    ds_read_b128 v[196:199], v246 offset:192
    v_mfma_f32_16x16x32_bf16 v[232:235], a[168:171], a[224:227], 0
    s_mov_b32 vcc_lo, 0xff00ff00
    v_mul_f32 v236, s38, v236
    v_mul_f32 v237, s38, v237
    v_mfma_f32_16x16x32_bf16 v[232:235], a[172:175], a[228:231], v[232:235]
    s_waitcnt lgkmcnt(9)
    v_mul_f32 v238, s38, v238
    v_mul_f32 v239, s38, v239
    v_mfma_f32_16x16x32_bf16 v[200:203], v[120:123], v[168:171], v[200:203]
    s_mov_b32 vcc_hi, 0xff00ff00
    v_cvt_pk_bf16_f32 v236, v236, v237
    v_cvt_pk_bf16_f32 v237, v238, v239
    v_mfma_f32_16x16x32_bf16 v[200:203], v[122:125], v[170:173], v[200:203]
    ds_write_b64 v247, v[236:237] offset:24832
    v_mfma_f32_16x16x32_bf16 v[228:231], a[152:155], a[232:235], v[228:231]
    s_waitcnt lgkmcnt(8)
    v_mfma_f32_16x16x32_bf16 v[228:231], a[156:159], a[236:239], v[228:231]
    s_waitcnt lgkmcnt(7)
    v_mfma_f32_16x16x32_bf16 v[228:231], a[160:163], a[240:243], v[228:231]
    s_waitcnt lgkmcnt(5)
    v_mfma_f32_16x16x32_bf16 v[228:231], a[164:167], a[244:247], v[228:231]
    v_mfma_f32_16x16x32_bf16 v[232:235], a[176:179], a[232:235], v[232:235]
    s_waitcnt lgkmcnt(2)
    v_mfma_f32_16x16x32_bf16 v[204:207], v[114:117], v[168:171], v[204:207]
    s_waitcnt lgkmcnt(1)
    v_mfma_f32_16x16x32_bf16 v[204:207], v[116:119], v[170:173], v[204:207]
    v_mfma_f32_16x16x32_bf16 v[196:199], v[90:93], v[168:171], v[196:199]
    v_mfma_f32_16x16x32_bf16 v[196:199], v[92:95], v[170:173], v[196:199]
    v_mfma_f32_16x16x32_bf16 v[232:235], a[180:183], a[236:239], v[232:235]
    v_mul_f32 v228, s38, v228
    v_mul_f32 v229, s38, v229
    v_mfma_f32_16x16x32_bf16 v[232:235], a[184:187], a[240:243], v[232:235]
    v_mul_f32 v230, s38, v230
    v_mul_f32 v231, s38, v231
    v_mfma_f32_16x16x32_bf16 v[232:235], a[188:191], a[244:247], v[232:235]
    v_cvt_pk_bf16_f32 v228, v228, v229
    v_cvt_pk_bf16_f32 v229, v230, v231
    v_mfma_f32_16x16x32_bf16 v[236:239], a[192:195], a[224:227], 0
    ds_write_b64 v247, v[228:229] offset:30720
    v_mfma_f32_16x16x32_bf16 v[236:239], a[196:199], a[228:231], v[236:239]
    ds_read_b128 a[224:227], v240 offset:35456
    ds_read_b128 a[228:231], v241 offset:35456
    v_mfma_f32_16x16x32_bf16 v[236:239], a[200:203], a[232:235], v[236:239]
    v_mul_f32 v232, s3, v232
    v_mul_f32 v233, s3, v233
    v_mfma_f32_16x16x32_bf16 v[236:239], a[204:207], a[236:239], v[236:239]
    v_mul_f32 v234, s3, v234
    v_mul_f32 v235, s3, v235
    v_mfma_f32_16x16x32_bf16 v[236:239], a[208:211], a[240:243], v[236:239]
    ds_read_b128 a[232:235], v240 offset:35584
    v_cvt_pk_bf16_f32 v232, v232, v233
    v_mfma_f32_16x16x32_bf16 v[236:239], a[212:215], a[244:247], v[236:239]
    ds_read_b128 a[236:239], v241 offset:35584
    v_cvt_pk_bf16_f32 v233, v234, v235
    v_mfma_f32_16x16x32_bf16 v[228:231], a[0:3], a[216:219], 0
    ds_write_b64 v247, v[232:233] offset:30848
    v_mfma_f32_16x16x32_bf16 v[228:231], a[4:7], a[220:223], v[228:231]
    ds_read_b128 a[240:243], v242 offset:64512
    ds_read_b128 a[244:247], v243 offset:64512
    v_mfma_f32_16x16x32_bf16 v[232:235], a[24:27], a[216:219], 0
    v_mul_f32 v236, s38, v236
    v_mul_f32 v237, s38, v237
    v_mfma_f32_16x16x32_bf16 v[232:235], a[28:31], a[220:223], v[232:235]
    s_waitcnt lgkmcnt(6)
    v_mul_f32 v238, s38, v238
    v_mul_f32 v239, s38, v239
    v_mfma_f32_16x16x32_bf16 v[228:231], a[8:11], a[224:227], v[228:231]
    s_waitcnt lgkmcnt(5)
    v_cvt_pk_bf16_f32 v236, v236, v237
    v_cvt_pk_bf16_f32 v237, v238, v239
    v_mfma_f32_16x16x32_bf16 v[228:231], a[12:15], a[228:231], v[228:231]
    ds_write_b64 v247, v[236:237] offset:30976
    v_mfma_f32_16x16x32_bf16 v[232:235], a[32:35], a[224:227], v[232:235]
    s_waitcnt lgkmcnt(5)
    v_max_f32 v248, v204, v205
    v_max3_f32 v248, v248, v206, v207
    v_mfma_f32_16x16x32_bf16 v[228:231], a[16:19], a[232:235], v[228:231]
    ds_read_b128 v[204:207], v245 offset:256
    v_max3_f32 v248, v248, v208, v209
    v_mfma_f32_16x16x32_bf16 v[232:235], a[36:39], a[228:231], v[232:235]
    s_waitcnt lgkmcnt(5)
    v_max3_f32 v248, v248, v210, v211
    v_max3_f32 v248, v248, v196, v197
    v_mfma_f32_16x16x32_bf16 v[228:231], a[20:23], a[236:239], v[228:231]
    ds_read_b128 v[208:211], v246 offset:256
    v_max3_f32 v248, v248, v198, v199
    v_mfma_f32_16x16x32_bf16 v[232:235], a[40:43], a[232:235], v[232:235]
    ds_read_b128 v[196:199], v244 offset:320
    v_max3_f32 v248, v248, v200, v201
    v_mfma_f32_16x16x32_bf16 v[232:235], a[44:47], a[236:239], v[232:235]
    v_max3_f32 v248, v248, v202, v203
    v_mfma_f32_16x16x32_bf16 v[236:239], a[48:51], a[216:219], 0
    ds_read_b128 v[200:203], v245 offset:320
    v_mfma_f32_16x16x32_bf16 v[236:239], a[52:55], a[220:223], v[236:239]
    v_mfma_f32_16x16x32_bf16 v[236:239], a[56:59], a[224:227], v[236:239]
    v_mfma_f32_16x16x32_bf16 v[236:239], a[60:63], a[228:231], v[236:239]
    v_mfma_f32_16x16x32_bf16 v[236:239], a[64:67], a[232:235], v[236:239]
    s_waitcnt lgkmcnt(3)
    v_mfma_f32_16x16x32_bf16 v[204:207], v[144:147], v[168:171], v[204:207]
    v_mfma_f32_16x16x32_bf16 v[204:207], v[146:149], v[170:173], v[204:207]
    s_waitcnt lgkmcnt(2)
    s_waitcnt lgkmcnt(1)
    v_mfma_f32_16x16x32_bf16 v[208:211], v[96:99], v[168:171], v[208:211]
    v_mfma_f32_16x16x32_bf16 v[208:211], v[98:101], v[170:173], v[208:211]
    v_mfma_f32_16x16x32_bf16 v[196:199], v[126:129], v[168:171], v[196:199]
    s_waitcnt lgkmcnt(0)
    v_mfma_f32_16x16x32_bf16 v[196:199], v[128:131], v[170:173], v[196:199]
    v_mfma_f32_16x16x32_bf16 v[200:203], v[150:153], v[168:171], v[200:203]
    v_max3_f32 v248, v248, v204, v205
    v_max3_f32 v248, v248, v206, v207
    v_mfma_f32_16x16x32_bf16 v[200:203], v[152:155], v[170:173], v[200:203]
    ds_read_b128 v[204:207], v246 offset:320
    v_max3_f32 v248, v248, v208, v209
    v_mfma_f32_16x16x32_bf16 v[236:239], a[68:71], a[236:239], v[236:239]
    v_max3_f32 v248, v248, v210, v211
    ds_read_b128 v[208:211], v244 offset:192
    v_max3_f32 v248, v248, v196, v197
    ds_read_b128 v[196:199], v245 offset:192
    s_nop 0
    v_max3_f32 v248, v248, v200, v201
    ds_read_b128 v[200:203], v246 offset:192
    s_waitcnt lgkmcnt(3)
    v_mfma_f32_16x16x32_bf16 v[204:207], v[162:165], v[168:171], v[204:207]
    v_mfma_f32_16x16x32_bf16 v[204:207], v[164:167], v[170:173], v[204:207]
    s_nop 7
    s_waitcnt lgkmcnt(1)
    v_mfma_f32_16x16x32_bf16 v[208:211], v[114:117], v[168:171], v[208:211]
    s_waitcnt lgkmcnt(0)
    v_cvt_pk_bf16_f32 v114, v228, v229
    v_cvt_pk_bf16_f32 v115, v230, v231
    v_mfma_f32_16x16x32_bf16 v[208:211], v[116:119], v[170:173], v[208:211]
    v_cvt_pk_bf16_f32 v116, v232, v233
    v_cvt_pk_bf16_f32 v117, v234, v235
    v_mfma_f32_16x16x32_bf16 v[196:199], v[138:141], v[168:171], v[196:199]
    v_cvt_pk_bf16_f32 v118, v236, v237
    v_cvt_pk_bf16_f32 v119, v238, v239
    v_mfma_f32_16x16x32_bf16 v[196:199], v[140:143], v[170:173], v[196:199]
    v_max3_f32 v248, v248, v204, v205
    v_mov_b32 v225, v248
    v_mfma_f32_16x16x32_bf16 v[200:203], v[90:93], v[168:171], v[200:203]
    ds_read_b128 v[204:207], v244 offset:256
    v_permlane16_swap_b32 v248, v225
    v_mfma_f32_16x16x32_bf16 v[200:203], v[92:95], v[170:173], v[200:203]
    v_max_f32 v248, v248, v225
    v_mov_b32 v225, v248
    v_mfma_f32_16x16x32_bf16 v[228:231], a[216:219], a[72:75], 0
    v_mfma_f32_16x16x32_bf16 v[228:231], a[220:223], a[76:79], v[228:231]
    v_permlane32_swap_b32 v248, v225
    v_max_f32 v248, v248, v225
    v_mfma_f32_16x16x32_bf16 v[228:231], a[224:227], a[80:83], v[228:231]
    v_sub_f32 v208, v208, v248
    v_sub_f32 v209, v209, v248
    v_mfma_f32_16x16x32_bf16 v[228:231], a[228:231], a[84:87], v[228:231]
    v_exp_f32 v208, v208
    v_mfma_f32_16x16x32_bf16 v[228:231], a[232:235], a[88:91], v[228:231]
    v_exp_f32 v209, v209
    v_mfma_f32_16x16x32_bf16 v[228:231], a[236:239], a[92:95], v[228:231]
    v_sub_f32 v210, v210, v248
    v_sub_f32 v211, v211, v248
    v_mfma_f32_16x16x32_bf16 v[232:235], a[216:219], a[96:99], 0
    v_exp_f32 v210, v210
    v_mfma_f32_16x16x32_bf16 v[232:235], a[220:223], a[100:103], v[232:235]
    s_waitcnt lgkmcnt(0)
    v_exp_f32 v211, v211
    v_mfma_f32_16x16x32_bf16 v[204:207], v[120:123], v[168:171], v[204:207]
    v_cvt_pk_bf16_f32 v18, v228, v229
    v_cvt_pk_bf16_f32 v21, v230, v231
    v_mfma_f32_16x16x32_bf16 v[204:207], v[122:125], v[170:173], v[204:207]
    v_cvt_pk_bf16_f32 v193, v208, v209
    v_cvt_pk_bf16_f32 v180, v210, v211
    v_mfma_f32_16x16x32_bf16 v[232:235], a[224:227], a[104:107], v[232:235]
    ds_read_b128 v[208:211], v245 offset:256
    v_sub_f32 v196, v196, v248
    v_mfma_f32_16x16x32_bf16 v[232:235], a[228:231], a[108:111], v[232:235]
    v_exp_f32 v196, v196
    v_mfma_f32_16x16x32_bf16 v[232:235], a[232:235], a[112:115], v[232:235]
    v_sub_f32 v197, v197, v248
    v_sub_f32 v198, v198, v248
    v_mfma_f32_16x16x32_bf16 v[232:235], a[236:239], a[116:119], v[232:235]
    v_exp_f32 v197, v197
    v_mfma_f32_16x16x32_bf16 v[236:239], a[216:219], a[120:123], 0
    ds_read_b128 a[216:219], v242 offset:64640
    v_sub_f32 v199, v199, v248
    v_mfma_f32_16x16x32_bf16 v[236:239], a[220:223], a[124:127], v[236:239]
    ds_read_b128 a[220:223], v243 offset:64640
    v_cvt_pk_bf16_f32 v194, v196, v197
    v_mfma_f32_16x16x32_bf16 v[236:239], a[224:227], a[128:131], v[236:239]
    v_cvt_pk_bf16_f32 v48, v232, v233
    v_cvt_pk_bf16_f32 v51, v234, v235
    v_mfma_f32_16x16x32_bf16 v[236:239], a[228:231], a[132:135], v[236:239]
    ds_read_b128 a[224:227], v242 offset:64768
    ds_read_b128 a[228:231], v243 offset:64768
    v_mfma_f32_16x16x32_bf16 v[236:239], a[232:235], a[136:139], v[236:239]
    v_add_u32 v242, 0xf000, v242
    v_add_u32 v243, 0xf000, v243
    v_mfma_f32_16x16x32_bf16 v[236:239], a[236:239], a[140:143], v[236:239]
    ds_read_b128 a[232:235], v242 offset:4608
    ds_read_b128 a[236:239], v243 offset:4608
    v_mfma_f32_16x16x32_bf16 v[228:231], a[144:147], a[240:243], 0
    s_waitcnt lgkmcnt(6)
    v_exp_f32 v198, v198
    v_mfma_f32_16x16x32_bf16 v[208:211], v[144:147], v[168:171], v[208:211]
    v_exp_f32 v199, v199
    v_mfma_f32_16x16x32_bf16 v[208:211], v[146:149], v[170:173], v[208:211]
    v_cvt_pk_bf16_f32 v78, v236, v237
    v_cvt_pk_bf16_f32 v81, v238, v239
    v_mfma_f32_16x16x32_bf16 v[228:231], a[148:151], a[244:247], v[228:231]
    s_waitcnt lgkmcnt(5)
    v_cvt_pk_bf16_f32 v181, v198, v199
    v_sub_f32 v200, v200, v248
    v_mfma_f32_16x16x32_bf16 v[228:231], a[152:155], a[216:219], v[228:231]
    ds_read_b128 v[196:199], v246 offset:256
    v_sub_f32 v201, v201, v248
    v_mfma_f32_16x16x32_bf16 v[232:235], a[168:171], a[240:243], 0
    s_waitcnt lgkmcnt(5)
    v_exp_f32 v200, v200
    v_mfma_f32_16x16x32_bf16 v[228:231], a[156:159], a[220:223], v[228:231]
    s_waitcnt lgkmcnt(4)
    v_exp_f32 v201, v201
    v_mfma_f32_16x16x32_bf16 v[228:231], a[160:163], a[224:227], v[228:231]
    s_waitcnt lgkmcnt(3)
    v_sub_f32 v202, v202, v248
    v_sub_f32 v203, v203, v248
    v_mfma_f32_16x16x32_bf16 v[228:231], a[164:167], a[228:231], v[228:231]
    v_exp_f32 v202, v202
    v_mfma_f32_16x16x32_bf16 v[232:235], a[172:175], a[244:247], v[232:235]
    v_exp_f32 v203, v203
    v_mfma_f32_16x16x32_bf16 v[232:235], a[176:179], a[216:219], v[232:235]
    v_cvt_pk_bf16_f32 v192, v200, v201
    v_cvt_pk_bf16_f32 v195, v202, v203
    v_mfma_f32_16x16x32_bf16 v[232:235], a[180:183], a[220:223], v[232:235]
    ds_read_b128 v[200:203], v244 offset:320
    v_mul_f32 v228, s38, v228
    v_mfma_f32_16x16x32_bf16 v[212:215], v[0:3], v[192:195], 0
    v_mul_f32 v229, s38, v229
    v_mul_f32 v230, s38, v230
    v_mfma_f32_16x16x32_bf16 v[216:219], v[30:33], v[192:195], 0
    s_waitcnt lgkmcnt(1)
    v_mul_f32 v231, s38, v231
    v_cvt_pk_bf16_f32 v228, v228, v229
    v_mfma_f32_16x16x32_bf16 v[220:223], v[60:63], v[192:195], 0
    v_cvt_pk_bf16_f32 v229, v230, v231
    v_sub_f32 v204, v204, v248
    v_mfma_f32_16x16x32_bf16 v[224:227], a[248:251], v[192:195], 0
    ds_write_b64 v247, v[228:229] offset:36864
    v_mfma_f32_16x16x32_bf16 v[196:199], v[96:99], v[168:171], v[196:199]
    v_exp_f32 v204, v204
    v_mfma_f32_16x16x32_bf16 v[196:199], v[98:101], v[170:173], v[196:199]
    v_sub_f32 v205, v205, v248
    v_sub_f32 v206, v206, v248
    v_mfma_f32_16x16x32_bf16 v[232:235], a[184:187], a[224:227], v[232:235]
    v_exp_f32 v205, v205
    v_mfma_f32_16x16x32_bf16 v[232:235], a[188:191], a[228:231], v[232:235]
    s_waitcnt lgkmcnt(1)
    v_exp_f32 v206, v206
    v_mfma_f32_16x16x32_bf16 v[200:203], v[126:129], v[168:171], v[200:203]
    v_sub_f32 v207, v207, v248
    v_cvt_pk_bf16_f32 v183, v204, v205
    v_mfma_f32_16x16x32_bf16 v[200:203], v[128:131], v[170:173], v[200:203]
    v_exp_f32 v207, v207
    v_mfma_f32_16x16x32_bf16 v[236:239], a[192:195], a[240:243], 0
    v_mul_f32 v232, s3, v232
    v_mul_f32 v233, s3, v233
    v_mfma_f32_16x16x32_bf16 v[236:239], a[196:199], a[244:247], v[236:239]
    v_mul_f32 v234, s3, v234
    v_mul_f32 v235, s3, v235
    v_mfma_f32_16x16x32_bf16 v[236:239], a[200:203], a[216:219], v[236:239]
    ds_read_b128 a[240:243], v242 offset:4736
    v_cvt_pk_bf16_f32 v232, v232, v233
    v_mfma_f32_16x16x32_bf16 v[236:239], a[204:207], a[220:223], v[236:239]
    ds_read_b128 a[244:247], v243 offset:4736
    v_cvt_pk_bf16_f32 v233, v234, v235
    v_mfma_f32_16x16x32_bf16 v[236:239], a[208:211], a[224:227], v[236:239]
    ds_write_b64 v247, v[232:233] offset:36992
    v_mfma_f32_16x16x32_bf16 v[236:239], a[212:215], a[228:231], v[236:239]
    ds_read_b128 a[216:219], v242 offset:4864
    ds_read_b128 a[220:223], v243 offset:4864
    v_mfma_f32_16x16x32_bf16 v[228:231], a[144:147], a[232:235], 0
    v_add_u32 v242, 0x7800, v242
    v_add_u32 v243, 0x4200, v243
    v_mfma_f32_16x16x32_bf16 v[228:231], a[148:151], a[236:239], v[228:231]
    v_cndmask_b32 v242, v242, v243, vcc
    v_add_u32 v243, 0xfffe2000, v242
    v_mfma_f32_16x16x32_bf16 v[232:235], a[168:171], a[232:235], 0
    s_mov_b32 vcc_lo, 0xf0f0f0f0
    v_mul_f32 v236, s38, v236
    v_mul_f32 v237, s38, v237
    v_mfma_f32_16x16x32_bf16 v[232:235], a[172:175], a[236:239], v[232:235]
    v_mul_f32 v238, s38, v238
    v_mul_f32 v239, s38, v239
    v_cvt_pk_bf16_f32 v236, v236, v237
    s_waitcnt lgkmcnt(4)
    v_mfma_f32_16x16x32_bf16 v[228:231], a[152:155], a[240:243], v[228:231]
    s_mov_b32 vcc_hi, 0xf0f0f0f0
    v_cvt_pk_bf16_f32 v237, v238, v239
    v_cndmask_b32 v242, v242, v243, vcc
    v_mfma_f32_16x16x32_bf16 v[232:235], a[176:179], a[240:243], v[232:235]
    s_waitcnt lgkmcnt(3)
    ds_read_b128 a[224:227], v242 offset:0
    v_mfma_f32_16x16x32_bf16 v[228:231], a[156:159], a[244:247], v[228:231]
    ds_write_b64 v247, v[236:237] offset:37120
    v_mfma_f32_16x16x32_bf16 v[232:235], a[180:183], a[244:247], v[232:235]
    s_mov_b32 vcc_lo, 0xcccccccc
    v_xor_b32 v243, 64, v242
    v_cvt_pk_bf16_f32 v186, v206, v207
    v_mfma_f32_16x16x32_bf16 v[236:239], a[192:195], a[232:235], 0
    ds_read_b128 a[228:231], v243 offset:0
    ds_read_b128 a[232:235], v242 offset:128
    v_mfma_f32_16x16x32_bf16 v[236:239], a[196:199], a[236:239], v[236:239]
    ds_read_b128 a[236:239], v243 offset:128
    ds_read_b128 v[204:207], v245 offset:320
    v_mfma_f32_16x16x32_bf16 v[236:239], a[200:203], a[240:243], v[236:239]
    ds_read_b128 a[240:243], v242 offset:256
    v_sub_f32 v208, v208, v248
    v_mfma_f32_16x16x32_bf16 v[236:239], a[204:207], a[244:247], v[236:239]
    s_waitcnt lgkmcnt(8)
    ds_read_b128 a[244:247], v243 offset:256
    v_mfma_f32_16x16x32_bf16 v[228:231], a[160:163], a[216:219], v[228:231]
    s_mov_b32 vcc_hi, 0xcccccccc
    v_exp_f32 v208, v208
    v_mfma_f32_16x16x32_bf16 v[232:235], a[184:187], a[216:219], v[232:235]
    s_waitcnt lgkmcnt(8)
    v_sub_f32 v209, v209, v248
    v_sub_f32 v210, v210, v248
    v_mfma_f32_16x16x32_bf16 v[228:231], a[164:167], a[220:223], v[228:231]
    v_exp_f32 v209, v209
    v_mfma_f32_16x16x32_bf16 v[232:235], a[188:191], a[220:223], v[232:235]
    v_exp_f32 v210, v210
    v_mfma_f32_16x16x32_bf16 v[236:239], a[208:211], a[216:219], v[236:239]
    ds_read_b128 a[216:219], v240 offset:36864
    v_sub_f32 v211, v211, v248
    v_mfma_f32_16x16x32_bf16 v[236:239], a[212:215], a[220:223], v[236:239]
    ds_read_b128 a[220:223], v241 offset:36864
    v_mul_f32 v228, s38, v228
    v_mul_f32 v229, s38, v229
    v_mul_f32 v230, s38, v230
    v_mul_f32 v231, s38, v231
    v_cvt_pk_bf16_f32 v228, v228, v229
    v_cvt_pk_bf16_f32 v229, v230, v231
    s_waitcnt lgkmcnt(4)
    v_mfma_f32_16x16x32_bf16 v[204:207], v[150:153], v[168:171], v[204:207]
    ds_write_b64 v247, v[228:229] offset:43008
    v_mfma_f32_16x16x32_bf16 v[204:207], v[152:155], v[170:173], v[204:207]
    v_mul_f32 v232, s3, v232
    v_mul_f32 v233, s3, v233
    v_mfma_f32_16x16x32_bf16 v[228:231], a[144:147], a[224:227], 0
    v_mul_f32 v234, s3, v234
    v_mul_f32 v235, s3, v235
    v_mfma_f32_16x16x32_bf16 v[228:231], a[148:151], a[228:231], v[228:231]
    v_cvt_pk_bf16_f32 v232, v232, v233
    v_cvt_pk_bf16_f32 v233, v234, v235
    v_mfma_f32_16x16x32_bf16 v[228:231], a[152:155], a[232:235], v[228:231]
    ds_write_b64 v247, v[232:233] offset:43136
    v_mfma_f32_16x16x32_bf16 v[228:231], a[156:159], a[236:239], v[228:231]
    s_waitcnt lgkmcnt(5)
    v_mul_f32 v236, s38, v236
    v_mul_f32 v237, s38, v237
    v_mfma_f32_16x16x32_bf16 v[228:231], a[160:163], a[240:243], v[228:231]
    s_waitcnt lgkmcnt(4)
    v_mul_f32 v238, s38, v238
    v_mul_f32 v239, s38, v239
    v_mfma_f32_16x16x32_bf16 v[228:231], a[164:167], a[244:247], v[228:231]
    v_cvt_pk_bf16_f32 v236, v236, v237
    v_cvt_pk_bf16_f32 v237, v238, v239
    v_mfma_f32_16x16x32_bf16 v[232:235], a[168:171], a[224:227], 0
    ds_write_b64 v247, v[236:237] offset:43264
    v_mfma_f32_16x16x32_bf16 v[232:235], a[172:175], a[228:231], v[232:235]
    v_exp_f32 v211, v211
    v_mfma_f32_16x16x32_bf16 v[232:235], a[176:179], a[232:235], v[232:235]
    v_cvt_pk_bf16_f32 v184, v208, v209
    v_mul_f32 v228, s38, v228
    v_mfma_f32_16x16x32_bf16 v[232:235], a[180:183], a[236:239], v[232:235]
    v_mul_f32 v229, s38, v229
    v_mul_f32 v230, s38, v230
    v_mfma_f32_16x16x32_bf16 v[232:235], a[184:187], a[240:243], v[232:235]
    v_mul_f32 v231, s38, v231
    v_cvt_pk_bf16_f32 v228, v228, v229
    v_mfma_f32_16x16x32_bf16 v[232:235], a[188:191], a[244:247], v[232:235]
    v_cvt_pk_bf16_f32 v229, v230, v231
    v_cvt_pk_bf16_f32 v187, v210, v211
    v_mfma_f32_16x16x32_bf16 v[236:239], a[192:195], a[224:227], 0
    ds_write_b64 v247, v[228:229] offset:49152
    v_mfma_f32_16x16x32_bf16 v[236:239], a[196:199], a[228:231], v[236:239]
    ds_read_b128 a[224:227], v240 offset:36992
    ds_read_b128 a[228:231], v241 offset:36992
    v_mfma_f32_16x16x32_bf16 v[236:239], a[200:203], a[232:235], v[236:239]
    s_waitcnt lgkmcnt(5)
    v_mul_f32 v232, s3, v232
    v_mul_f32 v233, s3, v233
    v_mfma_f32_16x16x32_bf16 v[236:239], a[204:207], a[236:239], v[236:239]
    v_mul_f32 v234, s3, v234
    v_mul_f32 v235, s3, v235
    v_mfma_f32_16x16x32_bf16 v[236:239], a[208:211], a[240:243], v[236:239]
    ds_read_b128 a[232:235], v240 offset:37120
    v_cvt_pk_bf16_f32 v232, v232, v233
    v_mfma_f32_16x16x32_bf16 v[236:239], a[212:215], a[244:247], v[236:239]
    ds_read_b128 a[236:239], v241 offset:37120
    v_cvt_pk_bf16_f32 v233, v234, v235
    v_mfma_f32_16x16x32_bf16 v[228:231], a[0:3], a[216:219], 0
    ds_write_b64 v247, v[232:233] offset:49280
    v_mfma_f32_16x16x32_bf16 v[228:231], a[4:7], a[220:223], v[228:231]
    ds_read_b128 a[240:243], v242 offset:3072
    ds_read_b128 a[244:247], v243 offset:3072
    v_mfma_f32_16x16x32_bf16 v[232:235], a[24:27], a[216:219], 0
    v_mul_f32 v236, s38, v236
    v_mul_f32 v237, s38, v237
    v_mfma_f32_16x16x32_bf16 v[232:235], a[28:31], a[220:223], v[232:235]
    s_waitcnt lgkmcnt(6)
    v_mul_f32 v238, s38, v238
    v_mul_f32 v239, s38, v239
    v_mfma_f32_16x16x32_bf16 v[228:231], a[8:11], a[224:227], v[228:231]
    s_waitcnt lgkmcnt(5)
    v_cvt_pk_bf16_f32 v236, v236, v237
    v_cvt_pk_bf16_f32 v237, v238, v239
    v_mfma_f32_16x16x32_bf16 v[228:231], a[12:15], a[228:231], v[228:231]
    ds_write_b64 v247, v[236:237] offset:49408
    v_mfma_f32_16x16x32_bf16 v[232:235], a[32:35], a[224:227], v[232:235]
    s_waitcnt lgkmcnt(5)
    v_add_u32 v240, 0xffff1000, v240
    v_add_u32 v241, 0xffff1000, v241
    v_mfma_f32_16x16x32_bf16 v[228:231], a[16:19], a[232:235], v[228:231]
    ds_read_b128 v[208:211], v246 offset:320
    v_sub_f32 v196, v196, v248
    v_mfma_f32_16x16x32_bf16 v[232:235], a[36:39], a[228:231], v[232:235]
    s_waitcnt lgkmcnt(5)
    v_exp_f32 v196, v196
    v_mfma_f32_16x16x32_bf16 v[228:231], a[20:23], a[236:239], v[228:231]
    v_sub_f32 v197, v197, v248
    v_sub_f32 v198, v198, v248
    v_mfma_f32_16x16x32_bf16 v[232:235], a[40:43], a[232:235], v[232:235]
    v_exp_f32 v197, v197
    v_mfma_f32_16x16x32_bf16 v[232:235], a[44:47], a[236:239], v[232:235]
    v_exp_f32 v198, v198
    v_mfma_f32_16x16x32_bf16 v[236:239], a[48:51], a[216:219], 0
    v_sub_f32 v199, v199, v248
    v_cvt_pk_bf16_f32 v182, v196, v197
    v_mfma_f32_16x16x32_bf16 v[236:239], a[52:55], a[220:223], v[236:239]
    v_exp_f32 v199, v199
    v_mfma_f32_16x16x32_bf16 v[212:215], v[4:7], v[180:183], v[212:215]
    v_cvt_pk_bf16_f32 v185, v198, v199
    v_sub_f32 v200, v200, v248
    v_mfma_f32_16x16x32_bf16 v[216:219], v[34:37], v[180:183], v[216:219]
    ds_read_b128 v[196:199], v244 offset:0
    v_sub_f32 v201, v201, v248
    v_mfma_f32_16x16x32_bf16 v[220:223], v[64:67], v[180:183], v[220:223]
    s_waitcnt lgkmcnt(1)
    v_exp_f32 v200, v200
    v_mfma_f32_16x16x32_bf16 v[224:227], a[248:251], v[180:183], v[224:227]
    v_exp_f32 v201, v201
    v_mfma_f32_16x16x32_bf16 v[212:215], v[8:11], v[184:187], v[212:215]
    v_cvt_pk_bf16_f32 v189, v200, v201
    v_sub_f32 v204, v204, v248
    v_mfma_f32_16x16x32_bf16 v[216:219], v[38:41], v[184:187], v[216:219]
    ds_read_b128 v[200:203], v245 offset:0
    v_sub_f32 v205, v205, v248
    v_mfma_f32_16x16x32_bf16 v[220:223], v[68:71], v[184:187], v[220:223]
    v_exp_f32 v204, v204
    v_mfma_f32_16x16x32_bf16 v[224:227], a[248:251], v[184:187], v[224:227]
    v_exp_f32 v205, v205
    v_mfma_f32_16x16x32_bf16 v[208:211], v[162:165], v[168:171], v[208:211]
    ds_read_b64 v[168:169], v247 offset:18432
    v_cvt_pk_bf16_f32 v190, v204, v205
    v_mfma_f32_16x16x32_bf16 v[208:211], v[164:167], v[170:173], v[208:211]
    ds_read_b128 v[204:207], v246 offset:0
    ds_read_b64 v[170:171], v247 offset:18560
    v_mfma_f32_16x16x32_bf16 v[236:239], a[56:59], a[224:227], v[236:239]
    ds_read_b64 v[172:173], v247 offset:18688
    s_waitcnt lgkmcnt(5)
    v_mfma_f32_16x16x32_bf16 v[196:199], v[120:123], v[174:177], v[196:199]
    v_mfma_f32_16x16x32_bf16 v[196:199], v[122:125], v[176:179], v[196:199]
    v_mfma_f32_16x16x32_bf16 v[236:239], a[60:63], a[228:231], v[236:239]
    v_sub_f32 v208, v208, v248
    v_sub_f32 v209, v209, v248
    v_mfma_f32_16x16x32_bf16 v[236:239], a[64:67], a[232:235], v[236:239]
    s_waitcnt lgkmcnt(4)
    v_exp_f32 v208, v208
    v_mfma_f32_16x16x32_bf16 v[200:203], v[144:147], v[174:177], v[200:203]
    v_exp_f32 v209, v209
    v_mfma_f32_16x16x32_bf16 v[200:203], v[146:149], v[176:179], v[200:203]
    v_cvt_pk_bf16_f32 v188, v208, v209
    v_max_f32 v248, v196, v197
    v_mfma_f32_16x16x32_bf16 v[236:239], a[68:71], a[236:239], v[236:239]
    ds_read_b128 v[208:211], v244 offset:64
    v_max3_f32 v248, v248, v198, v199
    v_mfma_f32_16x16x32_bf16 v[212:215], v[12:15], v[188:191], v[212:215]
    ds_read_b128 v[196:199], v245 offset:64
    s_waitcnt lgkmcnt(4)
    v_mfma_f32_16x16x32_bf16 v[216:219], v[42:45], v[188:191], v[216:219]
    v_max3_f32 v248, v248, v200, v201
    v_max3_f32 v248, v248, v202, v203
    v_mfma_f32_16x16x32_bf16 v[220:223], v[72:75], v[188:191], v[220:223]
    ds_read_b128 v[200:203], v246 offset:64
    v_mfma_f32_16x16x32_bf16 v[224:227], a[248:251], v[188:191], v[224:227]
    v_mfma_f32_16x16x32_bf16 v[204:207], v[96:99], v[174:177], v[204:207]
    v_mfma_f32_16x16x32_bf16 v[204:207], v[98:101], v[176:179], v[204:207]
    s_nop 5
    v_rcp_f32 v225, v224
    s_nop 0
    s_waitcnt lgkmcnt(2)
    v_mfma_f32_16x16x32_bf16 v[208:211], v[126:129], v[174:177], v[208:211]
    v_mul_f32 v212, v212, v225
    v_mul_f32 v213, v213, v225
    v_mfma_f32_16x16x32_bf16 v[208:211], v[128:131], v[176:179], v[208:211]
    s_waitcnt lgkmcnt(1)
    v_mul_f32 v214, v214, v225
    v_mul_f32 v215, v215, v225
    v_mfma_f32_16x16x32_bf16 v[196:199], v[150:153], v[174:177], v[196:199]
    v_cvt_pk_bf16_f32 v212, v212, v213
    v_cvt_pk_bf16_f32 v213, v214, v215
    v_mfma_f32_16x16x32_bf16 v[196:199], v[152:155], v[176:179], v[196:199]
    s_waitcnt lgkmcnt(0)
    v_mul_f32 v216, v216, v225
    v_mul_f32 v217, v217, v225
    v_mfma_f32_16x16x32_bf16 v[200:203], v[162:165], v[174:177], v[200:203]
    ds_write_b64 v247, v[212:213] offset:6144
    v_mfma_f32_16x16x32_bf16 v[200:203], v[164:167], v[176:179], v[200:203]
    v_mul_f32 v218, v218, v225
    v_mul_f32 v219, v219, v225
    v_cvt_pk_bf16_f32 v216, v216, v217
    v_cvt_pk_bf16_f32 v217, v218, v219
    ds_write_b64 v247, v[216:217] offset:6272
    v_mul_f32 v220, v220, v225
    v_mul_f32 v221, v221, v225
    v_mul_f32 v222, v222, v225
    v_mul_f32 v223, v223, v225
    v_cvt_pk_bf16_f32 v220, v220, v221
    v_cvt_pk_bf16_f32 v221, v222, v223
    ds_write_b64 v247, v[220:221] offset:6400
    v_max3_f32 v248, v248, v204, v205
    v_max3_f32 v248, v248, v206, v207
    ds_read_b128 v[204:207], v244 offset:128
    v_max3_f32 v248, v248, v208, v209
    v_max3_f32 v248, v248, v210, v211
    ds_read_b128 v[208:211], v245 offset:128
    v_max3_f32 v248, v248, v196, v197
    v_max3_f32 v248, v248, v198, v199
    ds_read_b128 v[196:199], v246 offset:128
    v_max3_f32 v248, v248, v200, v201
    v_max3_f32 v248, v248, v202, v203
    ds_read_b128 v[200:203], v244 offset:0
    s_waitcnt lgkmcnt(3)
    v_mfma_f32_16x16x32_bf16 v[204:207], v[132:135], v[174:177], v[204:207]
    v_mfma_f32_16x16x32_bf16 v[204:207], v[134:137], v[176:179], v[204:207]
    s_waitcnt lgkmcnt(2)
    v_mfma_f32_16x16x32_bf16 v[208:211], v[156:159], v[174:177], v[208:211]
    s_waitcnt lgkmcnt(1)
    v_mfma_f32_16x16x32_bf16 v[208:211], v[158:161], v[176:179], v[208:211]
    v_mfma_f32_16x16x32_bf16 v[196:199], v[114:117], v[174:177], v[196:199]
    s_waitcnt lgkmcnt(0)
    v_mfma_f32_16x16x32_bf16 v[196:199], v[116:119], v[176:179], v[196:199]
    v_mfma_f32_16x16x32_bf16 v[200:203], v[120:123], v[174:177], v[200:203]
    v_cvt_pk_bf16_f32 v120, v228, v229
    v_cvt_pk_bf16_f32 v121, v230, v231
    v_mfma_f32_16x16x32_bf16 v[200:203], v[122:125], v[176:179], v[200:203]
    v_cvt_pk_bf16_f32 v122, v232, v233
    v_cvt_pk_bf16_f32 v123, v234, v235
    v_mfma_f32_16x16x32_bf16 v[228:231], a[216:219], a[72:75], 0
    v_cvt_pk_bf16_f32 v124, v236, v237
    v_cvt_pk_bf16_f32 v125, v238, v239
    v_mfma_f32_16x16x32_bf16 v[228:231], a[220:223], a[76:79], v[228:231]
    v_max3_f32 v248, v248, v204, v205
    v_max3_f32 v248, v248, v208, v209
    v_mfma_f32_16x16x32_bf16 v[228:231], a[224:227], a[80:83], v[228:231]
    ds_read_b128 v[204:207], v245 offset:0
    ds_read_b128 v[208:211], v246 offset:0
    v_mfma_f32_16x16x32_bf16 v[228:231], a[228:231], a[84:87], v[228:231]
    v_max3_f32 v248, v248, v196, v197
    v_mov_b32 v225, v248
    v_mfma_f32_16x16x32_bf16 v[228:231], a[232:235], a[88:91], v[228:231]
    ds_read_b128 v[196:199], v244 offset:64
    v_permlane16_swap_b32 v248, v225
    v_mfma_f32_16x16x32_bf16 v[228:231], a[236:239], a[92:95], v[228:231]
    v_max_f32 v248, v248, v225
    v_mov_b32 v225, v248
    v_mfma_f32_16x16x32_bf16 v[232:235], a[216:219], a[96:99], 0
    v_mfma_f32_16x16x32_bf16 v[232:235], a[220:223], a[100:103], v[232:235]
    v_permlane32_swap_b32 v248, v225
    v_max_f32 v248, v248, v225
    v_mfma_f32_16x16x32_bf16 v[232:235], a[224:227], a[104:107], v[232:235]
    v_sub_f32 v200, v200, v248
    v_cvt_pk_bf16_f32 v24, v228, v229
    v_mfma_f32_16x16x32_bf16 v[232:235], a[228:231], a[108:111], v[232:235]
    v_cvt_pk_bf16_f32 v27, v230, v231
    v_mbcnt_lo_u32_b32 v228, -1, 0
    v_mfma_f32_16x16x32_bf16 v[232:235], a[232:235], a[112:115], v[232:235]
    v_mbcnt_hi_u32_b32 v228, -1, v228
    v_lshrrev_b32 v229, 1, v228
    v_mfma_f32_16x16x32_bf16 v[232:235], a[236:239], a[116:119], v[232:235]
    s_waitcnt lgkmcnt(2)
    v_add_u32 v229, 64, v229
    v_mul_u32_u24 v230, 43, v229
    v_mfma_f32_16x16x32_bf16 v[204:207], v[144:147], v[174:177], v[204:207]
    s_waitcnt lgkmcnt(1)
    v_lshrrev_b32 v231, 8, v230
    v_lshrrev_b32 v230, 7, v230
    v_mfma_f32_16x16x32_bf16 v[204:207], v[146:149], v[176:179], v[204:207]
    s_waitcnt lgkmcnt(0)
    v_cvt_pk_bf16_f32 v54, v232, v233
    v_cvt_pk_bf16_f32 v57, v234, v235
    v_mfma_f32_16x16x32_bf16 v[208:211], v[96:99], v[174:177], v[208:211]
    v_mad_i32_i24 v229, v230, -3, v229
    v_and_b32 v231, 4, v231
    v_mfma_f32_16x16x32_bf16 v[208:211], v[98:101], v[176:179], v[208:211]
    v_xor_b32 v230, v230, v231
    v_and_b32 v231, 4, v230
    v_mfma_f32_16x16x32_bf16 v[196:199], v[126:129], v[174:177], v[196:199]
    v_mul_u32_u24 v251, 24, v231
    v_lshrrev_b32 v231, 3, v230
    v_mfma_f32_16x16x32_bf16 v[196:199], v[128:131], v[176:179], v[196:199]
    v_lshl_add_u32 v251, v231, 2, v251
    v_and_or_b32 v251, v230, 3, v251
    v_mfma_f32_16x16x32_bf16 v[236:239], a[216:219], a[120:123], 0
    ds_read_b128 a[216:219], v242 offset:3200
    v_mad_u32_u24 v251, v251, 3, v229
    v_mfma_f32_16x16x32_bf16 v[236:239], a[220:223], a[124:127], v[236:239]
    ds_read_b128 a[220:223], v243 offset:3200
    v_and_b32 v231, 1, v228
    v_mfma_f32_16x16x32_bf16 v[236:239], a[224:227], a[128:131], v[236:239]
    ds_read_b128 a[224:227], v242 offset:3328
    v_lshl_add_u32 v251, v251, 3, v231
    v_mfma_f32_16x16x32_bf16 v[236:239], a[228:231], a[132:135], v[236:239]
    ds_read_b128 a[228:231], v243 offset:3328
    v_lshlrev_b32 v251, 4, v251
    v_mfma_f32_16x16x32_bf16 v[236:239], a[232:235], a[136:139], v[236:239]
    ds_read_b128 a[232:235], v240 offset:0
    v_add_u32 v251, 0xfffff800, v251
    v_mfma_f32_16x16x32_bf16 v[236:239], a[236:239], a[140:143], v[236:239]
    ds_read_b128 a[236:239], v241 offset:0
    v_sub_f32 v201, v201, v248
    v_mfma_f32_16x16x32_bf16 v[232:235], a[144:147], a[240:243], 0
    v_exp_f32 v200, v200
    v_mfma_f32_16x16x32_bf16 v[232:235], a[148:151], a[244:247], v[232:235]
    v_exp_f32 v201, v201
    v_mfma_f32_16x16x32_bf16 v[228:231], a[192:195], a[240:243], 0
    v_sub_f32 v202, v202, v248
    v_cvt_pk_bf16_f32 v84, v236, v237
    v_mfma_f32_16x16x32_bf16 v[228:231], a[196:199], a[244:247], v[228:231]
    s_waitcnt lgkmcnt(5)
    v_cvt_pk_bf16_f32 v87, v238, v239
    v_sub_f32 v203, v203, v248
    v_mfma_f32_16x16x32_bf16 v[232:235], a[152:155], a[216:219], v[232:235]
    s_waitcnt lgkmcnt(4)
    v_exp_f32 v202, v202
    v_mfma_f32_16x16x32_bf16 v[232:235], a[156:159], a[220:223], v[232:235]
    s_waitcnt lgkmcnt(3)
    s_waitcnt lgkmcnt(2)
    s_barrier
    v_mfma_f32_16x16x32_bf16 v[232:235], a[160:163], a[224:227], v[232:235]
    buffer_load_dwordx4 v252, s[12:15], s62 offen lds
    v_cvt_pk_bf16_f32 v193, v200, v201
    v_mfma_f32_16x16x32_bf16 v[232:235], a[164:167], a[228:231], v[232:235]
    v_exp_f32 v203, v203
    v_mfma_f32_16x16x32_bf16 v[236:239], a[168:171], a[240:243], 0
    ds_read_b128 a[240:243], v240 offset:128
    v_cvt_pk_bf16_f32 v180, v202, v203
    v_mfma_f32_16x16x32_bf16 v[236:239], a[172:175], a[244:247], v[236:239]
    ds_read_b128 a[244:247], v241 offset:128
    ds_read_b128 v[200:203], v245 offset:64
    v_mfma_f32_16x16x32_bf16 v[236:239], a[176:179], a[216:219], v[236:239]
    buffer_load_dwordx4 v253, s[12:15], s62 offen offset:1024 lds
    v_mul_f32 v232, s38, v232
    v_mfma_f32_16x16x32_bf16 v[236:239], a[180:183], a[220:223], v[236:239]
    v_mul_f32 v233, s38, v233
    v_mul_f32 v234, s38, v234
    v_mfma_f32_16x16x32_bf16 v[236:239], a[184:187], a[224:227], v[236:239]
    v_mul_f32 v235, s38, v235
    v_cvt_pk_bf16_f32 v232, v232, v233
    v_mfma_f32_16x16x32_bf16 v[236:239], a[188:191], a[228:231], v[236:239]
    v_cvt_pk_bf16_f32 v233, v234, v235
    v_sub_f32 v204, v204, v248
    v_mfma_f32_16x16x32_bf16 v[228:231], a[200:203], a[216:219], v[228:231]
    buffer_load_dwordx4 v251, s[12:15], s62 offen offset:2048 lds
    s_add_u32 m0, s46, 0x17400
    v_mfma_f32_16x16x32_bf16 v[228:231], a[204:207], a[220:223], v[228:231]
    s_lshl_b32 s62, s28, 5
    s_add_u32 s62, s62, 0x3000
    v_mul_f32 v236, s3, v236
    v_mfma_f32_16x16x32_bf16 v[228:231], a[208:211], a[224:227], v[228:231]
    ds_write_b64 v247, v[232:233] offset:55296
    v_mfma_f32_16x16x32_bf16 v[228:231], a[212:215], a[228:231], v[228:231]
    s_waitcnt lgkmcnt(4)
    v_mul_f32 v237, s3, v237
    v_mul_f32 v238, s3, v238
    v_mfma_f32_16x16x32_bf16 v[232:235], a[0:3], a[232:235], 0
    buffer_load_dwordx4 v252, s[12:15], s63 offen lds
    v_mul_f32 v239, s3, v239
    v_mfma_f32_16x16x32_bf16 v[232:235], a[4:7], a[236:239], v[232:235]
    s_waitcnt lgkmcnt(1)
    v_cvt_pk_bf16_f32 v236, v236, v237
    v_cvt_pk_bf16_f32 v237, v238, v239
    v_mfma_f32_16x16x32_bf16 v[200:203], v[150:153], v[174:177], v[200:203]
    ds_write_b64 v247, v[236:237] offset:55424
    v_mfma_f32_16x16x32_bf16 v[200:203], v[152:155], v[176:179], v[200:203]
    v_mul_f32 v228, s38, v228
    v_mul_f32 v229, s38, v229
    v_mfma_f32_16x16x32_bf16 v[232:235], a[8:11], a[240:243], v[232:235]
    buffer_load_dwordx4 v253, s[12:15], s63 offen offset:1024 lds
    v_mul_f32 v230, s38, v230
    v_mfma_f32_16x16x32_bf16 v[232:235], a[12:15], a[244:247], v[232:235]
    v_mul_f32 v231, s38, v231
    v_cvt_pk_bf16_f32 v228, v228, v229
    v_mfma_f32_16x16x32_bf16 v[236:239], a[24:27], a[232:235], 0
    ds_read_b128 a[216:219], v240 offset:256
    v_cvt_pk_bf16_f32 v229, v230, v231
    v_mfma_f32_16x16x32_bf16 v[236:239], a[28:31], a[236:239], v[236:239]
    ds_write_b64 v247, v[228:229] offset:55552
    v_mfma_f32_16x16x32_bf16 v[236:239], a[32:35], a[240:243], v[236:239]
    buffer_load_dwordx4 v251, s[12:15], s63 offen offset:2048 lds
    s_add_u32 m0, s46, 0x16800
    v_mfma_f32_16x16x32_bf16 v[236:239], a[36:39], a[244:247], v[236:239]
    s_lshl_b32 s63, s28, 5
    s_add_u32 s63, s63, 0x7800
    v_sub_f32 v205, v205, v248
    v_mfma_f32_16x16x32_bf16 v[228:231], a[48:51], a[232:235], 0
    ds_read_b128 a[220:223], v241 offset:256
    ds_read_b128 a[224:227], v240 offset:1536
    v_mfma_f32_16x16x32_bf16 v[228:231], a[52:55], a[236:239], v[228:231]
    ds_read_b128 a[228:231], v241 offset:1536
    v_sub_f32 v206, v206, v248
    v_mfma_f32_16x16x32_bf16 v[228:231], a[56:59], a[240:243], v[228:231]
    v_exp_f32 v204, v204
    v_mfma_f32_16x16x32_bf16 v[228:231], a[60:63], a[244:247], v[228:231]
    v_exp_f32 v205, v205
    v_exp_f32 v206, v206
    s_waitcnt lgkmcnt(4)
    v_mfma_f32_16x16x32_bf16 v[232:235], a[16:19], a[216:219], v[232:235]
    v_sub_f32 v207, v207, v248
    v_cvt_pk_bf16_f32 v194, v204, v205
    v_mfma_f32_16x16x32_bf16 v[236:239], a[40:43], a[216:219], v[236:239]
    v_exp_f32 v207, v207
    v_mfma_f32_16x16x32_bf16 v[228:231], a[64:67], a[216:219], v[228:231]
    v_cvt_pk_bf16_f32 v181, v206, v207
    ds_read_b128 v[204:207], v246 offset:64
    v_sub_f32 v208, v208, v248
    s_waitcnt lgkmcnt(3)
    v_mfma_f32_16x16x32_bf16 v[232:235], a[20:23], a[220:223], v[232:235]
    v_exp_f32 v208, v208
    v_mfma_f32_16x16x32_bf16 v[236:239], a[44:47], a[220:223], v[236:239]
    v_sub_f32 v209, v209, v248
    v_sub_f32 v210, v210, v248
    v_mfma_f32_16x16x32_bf16 v[228:231], a[68:71], a[220:223], v[228:231]
    v_exp_f32 v209, v209
    v_exp_f32 v210, v210
    v_sub_f32 v211, v211, v248
    v_exp_f32 v211, v211
    v_cvt_pk_bf16_f32 v192, v208, v209
    v_cvt_pk_bf16_f32 v195, v210, v211
    ds_read_b128 v[208:211], v244 offset:128
    v_sub_f32 v196, v196, v248
    v_mfma_f32_16x16x32_bf16 v[212:215], v[6:9], v[192:195], 0
    v_exp_f32 v196, v196
    v_mfma_f32_16x16x32_bf16 v[216:219], v[36:39], v[192:195], 0
    v_sub_f32 v197, v197, v248
    v_sub_f32 v198, v198, v248
    v_mfma_f32_16x16x32_bf16 v[220:223], v[66:69], v[192:195], 0
    s_waitcnt lgkmcnt(1)
    v_exp_f32 v197, v197
    v_mfma_f32_16x16x32_bf16 v[224:227], a[248:251], v[192:195], 0
    v_exp_f32 v198, v198
    v_mfma_f32_16x16x32_bf16 v[204:207], v[162:165], v[174:177], v[204:207]
    v_sub_f32 v199, v199, v248
    v_cvt_pk_bf16_f32 v183, v196, v197
    v_mfma_f32_16x16x32_bf16 v[204:207], v[164:167], v[176:179], v[204:207]
    v_exp_f32 v199, v199
    v_sub_f32 v200, v200, v248
    v_cvt_pk_bf16_f32 v186, v198, v199
    ds_read_b128 v[196:199], v245 offset:128
    v_exp_f32 v200, v200
    s_waitcnt lgkmcnt(1)
    v_mfma_f32_16x16x32_bf16 v[208:211], v[132:135], v[174:177], v[208:211]
    v_sub_f32 v201, v201, v248
    v_sub_f32 v202, v202, v248
    v_mfma_f32_16x16x32_bf16 v[208:211], v[134:137], v[176:179], v[208:211]
    v_exp_f32 v201, v201
    v_exp_f32 v202, v202
    v_sub_f32 v203, v203, v248
    v_exp_f32 v203, v203
    v_cvt_pk_bf16_f32 v184, v200, v201
    v_cvt_pk_bf16_f32 v187, v202, v203
    ds_read_b128 v[200:203], v246 offset:128
    v_sub_f32 v204, v204, v248
    v_exp_f32 v204, v204
    v_sub_f32 v205, v205, v248
    v_exp_f32 v205, v205
    v_sub_f32 v206, v206, v248
    v_exp_f32 v206, v206
    v_sub_f32 v207, v207, v248
    s_waitcnt lgkmcnt(1)
    v_mfma_f32_16x16x32_bf16 v[196:199], v[156:159], v[174:177], v[196:199]
    v_exp_f32 v207, v207
    v_mfma_f32_16x16x32_bf16 v[196:199], v[158:161], v[176:179], v[196:199]
    v_cvt_pk_bf16_f32 v182, v204, v205
    v_cvt_pk_bf16_f32 v185, v206, v207
    ds_read_b128 v[204:207], v244 offset:0
    v_mfma_f32_16x16x32_bf16 v[212:215], v[10:13], v[180:183], v[212:215]
    v_sub_f32 v208, v208, v248
    v_sub_f32 v209, v209, v248
    v_mfma_f32_16x16x32_bf16 v[216:219], v[40:43], v[180:183], v[216:219]
    v_exp_f32 v208, v208
    v_mfma_f32_16x16x32_bf16 v[220:223], v[70:73], v[180:183], v[220:223]
    s_waitcnt lgkmcnt(1)
    v_exp_f32 v209, v209
    v_mfma_f32_16x16x32_bf16 v[224:227], a[248:251], v[180:183], v[224:227]
    v_cvt_pk_bf16_f32 v189, v208, v209
    s_waitcnt vmcnt(3)
    v_mfma_f32_16x16x32_bf16 v[212:215], v[14:17], v[184:187], v[212:215]
    ds_read_b64_tr_b16 a[144:145], v249 offset:0
    ds_read_b64_tr_b16 a[146:147], v250 offset:0
    v_mfma_f32_16x16x32_bf16 v[216:219], v[44:47], v[184:187], v[216:219]
    ds_read_b64_tr_b16 a[168:169], v249 offset:32
    ds_read_b64_tr_b16 a[170:171], v250 offset:32
    v_mfma_f32_16x16x32_bf16 v[220:223], v[74:77], v[184:187], v[220:223]
    ds_read_b64_tr_b16 a[192:193], v249 offset:64
    ds_read_b64_tr_b16 a[194:195], v250 offset:64
    v_mfma_f32_16x16x32_bf16 v[224:227], a[248:251], v[184:187], v[224:227]
    ds_read_b128 v[208:211], v245 offset:0
    v_sub_f32 v196, v196, v248
    v_mfma_f32_16x16x32_bf16 v[200:203], v[114:117], v[174:177], v[200:203]
    ds_read_b64 v[174:175], v247 offset:0
    v_sub_f32 v197, v197, v248
    v_mfma_f32_16x16x32_bf16 v[200:203], v[116:119], v[176:179], v[200:203]
    s_waitcnt lgkmcnt(8)
    ds_read_b64 v[176:177], v247 offset:128
    v_mfma_f32_16x16x32_bf16 v[204:207], v[126:129], v[168:171], v[204:207]
    ds_read_b64 v[178:179], v247 offset:256
    v_mfma_f32_16x16x32_bf16 v[204:207], v[128:131], v[170:173], v[204:207]
    v_exp_f32 v196, v196
    v_exp_f32 v197, v197
    s_nop 0
    v_cvt_pk_bf16_f32 v190, v196, v197
    ds_read_b128 v[196:199], v246 offset:0
    v_sub_f32 v200, v200, v248
    v_exp_f32 v200, v200
    v_sub_f32 v201, v201, v248
    v_exp_f32 v201, v201
    s_waitcnt lgkmcnt(5)
    buffer_load_dwordx4 v252, s[12:15], s60 offen lds
    s_waitcnt lgkmcnt(4)
    v_mfma_f32_16x16x32_bf16 v[208:211], v[150:153], v[168:171], v[208:211]
    v_cvt_pk_bf16_f32 v188, v200, v201
    s_waitcnt vmcnt(1)
    v_mfma_f32_16x16x32_bf16 v[208:211], v[152:155], v[170:173], v[208:211]
    ds_read_b64_tr_b16 a[148:149], v249 offset:3072
    ds_read_b64_tr_b16 a[150:151], v250 offset:3072
    v_mfma_f32_16x16x32_bf16 v[212:215], v[18:21], v[188:191], v[212:215]
    ds_read_b64_tr_b16 a[172:173], v249 offset:3104
    ds_read_b64_tr_b16 a[174:175], v250 offset:3104
    v_mfma_f32_16x16x32_bf16 v[216:219], v[48:51], v[188:191], v[216:219]
    buffer_load_dwordx4 v253, s[12:15], s60 offen offset:1024 lds
    ds_read_b64_tr_b16 a[196:197], v249 offset:3136
    v_mfma_f32_16x16x32_bf16 v[220:223], v[78:81], v[188:191], v[220:223]
    ds_read_b64_tr_b16 a[198:199], v250 offset:3136
    ds_read_b128 v[200:203], v244 offset:64
    v_mfma_f32_16x16x32_bf16 v[224:227], a[248:251], v[188:191], v[224:227]
    s_waitcnt lgkmcnt(7)
    v_max_f32 v248, v204, v205
    v_max3_f32 v248, v248, v206, v207
    v_mfma_f32_16x16x32_bf16 v[196:199], v[162:165], v[168:171], v[196:199]
    ds_read_b128 v[204:207], v245 offset:64
    v_max3_f32 v248, v248, v208, v209
    v_mfma_f32_16x16x32_bf16 v[196:199], v[164:167], v[170:173], v[196:199]
    buffer_load_dwordx4 v251, s[12:15], s60 offen offset:2048 lds
    s_add_u32 m0, s46, 0x17400
    v_rcp_f32 v225, v224
    v_max3_f32 v248, v248, v210, v211
    ds_read_b128 v[208:211], v246 offset:64
    v_mul_f32 v212, v212, v225
    v_mul_f32 v213, v213, v225
    v_mul_f32 v214, v214, v225
    v_mul_f32 v215, v215, v225
    v_cvt_pk_bf16_f32 v212, v212, v213
    v_cvt_pk_bf16_f32 v213, v214, v215
    ds_write_b64 v247, v[212:213] offset:12288
    v_mul_f32 v216, v216, v225
    s_waitcnt lgkmcnt(4)
    buffer_load_dwordx4 v252, s[12:15], s61 offen lds
    v_mul_f32 v217, v217, v225
    s_waitcnt lgkmcnt(3)
    v_mfma_f32_16x16x32_bf16 v[200:203], v[132:135], v[168:171], v[200:203]
    v_mul_f32 v218, v218, v225
    v_mul_f32 v219, v219, v225
    v_mfma_f32_16x16x32_bf16 v[200:203], v[134:137], v[170:173], v[200:203]
    s_waitcnt lgkmcnt(2)
    v_cvt_pk_bf16_f32 v216, v216, v217
    v_cvt_pk_bf16_f32 v217, v218, v219
    v_mfma_f32_16x16x32_bf16 v[204:207], v[156:159], v[168:171], v[204:207]
    ds_write_b64 v247, v[216:217] offset:12416
    v_mfma_f32_16x16x32_bf16 v[204:207], v[158:161], v[170:173], v[204:207]
    s_waitcnt lgkmcnt(2)
    buffer_load_dwordx4 v253, s[12:15], s61 offen offset:1024 lds
    v_mfma_f32_16x16x32_bf16 v[208:211], v[114:117], v[168:171], v[208:211]
    v_mul_f32 v220, v220, v225
    v_mul_f32 v221, v221, v225
    v_mfma_f32_16x16x32_bf16 v[208:211], v[116:119], v[170:173], v[208:211]
    v_mul_f32 v222, v222, v225
    v_mul_f32 v223, v223, v225
    v_cvt_pk_bf16_f32 v220, v220, v221
    v_cvt_pk_bf16_f32 v221, v222, v223
    ds_write_b64 v247, v[220:221] offset:12544
    buffer_load_dwordx4 v251, s[12:15], s61 offen offset:2048 lds
    s_add_u32 m0, s46, 0x16800
    v_max3_f32 v248, v248, v196, v197
    v_max3_f32 v248, v248, v198, v199
    ds_read_b128 v[196:199], v244 offset:128
    v_max3_f32 v248, v248, v200, v201
    v_max3_f32 v248, v248, v202, v203
    ds_read_b128 v[200:203], v245 offset:128
    v_max3_f32 v248, v248, v204, v205
    v_max3_f32 v248, v248, v206, v207
    ds_read_b128 v[204:207], v246 offset:128
    v_max3_f32 v248, v248, v208, v209
    v_max3_f32 v248, v248, v210, v211
    ds_read_b128 v[208:211], v244 offset:0
    s_waitcnt lgkmcnt(3)
    v_mfma_f32_16x16x32_bf16 v[196:199], v[102:105], v[168:171], v[196:199]
    v_mfma_f32_16x16x32_bf16 v[196:199], v[104:107], v[170:173], v[196:199]
    s_waitcnt lgkmcnt(2)
    v_mfma_f32_16x16x32_bf16 v[200:203], v[108:111], v[168:171], v[200:203]
    s_waitcnt lgkmcnt(1)
    v_mfma_f32_16x16x32_bf16 v[200:203], v[110:113], v[170:173], v[200:203]
    v_mfma_f32_16x16x32_bf16 v[204:207], v[120:123], v[168:171], v[204:207]
    s_waitcnt lgkmcnt(0)
    v_mfma_f32_16x16x32_bf16 v[204:207], v[122:125], v[170:173], v[204:207]
    v_mfma_f32_16x16x32_bf16 v[208:211], v[126:129], v[168:171], v[208:211]
    v_cvt_pk_bf16_f32 v126, v232, v233
    v_cvt_pk_bf16_f32 v127, v234, v235
    v_mfma_f32_16x16x32_bf16 v[208:211], v[128:131], v[170:173], v[208:211]
    v_cvt_pk_bf16_f32 v128, v236, v237
    v_cvt_pk_bf16_f32 v129, v238, v239
    v_mfma_f32_16x16x32_bf16 v[232:235], a[232:235], a[72:75], 0
    v_cvt_pk_bf16_f32 v130, v228, v229
    v_cvt_pk_bf16_f32 v131, v230, v231
    v_mfma_f32_16x16x32_bf16 v[232:235], a[236:239], a[76:79], v[232:235]
    v_max3_f32 v248, v248, v196, v197
    v_max3_f32 v248, v248, v200, v201
    v_mfma_f32_16x16x32_bf16 v[232:235], a[240:243], a[80:83], v[232:235]
    ds_read_b128 v[196:199], v245 offset:0
    ds_read_b128 v[200:203], v246 offset:0
    v_mfma_f32_16x16x32_bf16 v[232:235], a[244:247], a[84:87], v[232:235]
    v_max3_f32 v248, v248, v204, v205
    v_mov_b32 v225, v248
    v_mfma_f32_16x16x32_bf16 v[232:235], a[216:219], a[88:91], v[232:235]
    ds_read_b128 v[204:207], v244 offset:64
    v_permlane16_swap_b32 v248, v225
    v_mfma_f32_16x16x32_bf16 v[232:235], a[220:223], a[92:95], v[232:235]
    v_max_f32 v248, v248, v225
    v_mov_b32 v225, v248
    v_mfma_f32_16x16x32_bf16 v[236:239], a[232:235], a[96:99], 0
    v_mfma_f32_16x16x32_bf16 v[236:239], a[236:239], a[100:103], v[236:239]
    v_permlane32_swap_b32 v248, v225
    v_max_f32 v248, v248, v225
    v_mfma_f32_16x16x32_bf16 v[236:239], a[240:243], a[104:107], v[236:239]
    v_sub_f32 v208, v208, v248
    v_cvt_pk_bf16_f32 v1, v232, v233
    v_mfma_f32_16x16x32_bf16 v[236:239], a[244:247], a[108:111], v[236:239]
    v_cvt_pk_bf16_f32 v4, v234, v235
    v_sub_f32 v209, v209, v248
    v_mfma_f32_16x16x32_bf16 v[236:239], a[216:219], a[112:115], v[236:239]
    v_exp_f32 v208, v208
    v_mfma_f32_16x16x32_bf16 v[236:239], a[220:223], a[116:119], v[236:239]
    s_waitcnt lgkmcnt(2)
    v_exp_f32 v209, v209
    v_mfma_f32_16x16x32_bf16 v[196:199], v[150:153], v[168:171], v[196:199]
    s_waitcnt lgkmcnt(1)
    v_sub_f32 v210, v210, v248
    v_sub_f32 v211, v211, v248
    v_mfma_f32_16x16x32_bf16 v[196:199], v[152:155], v[170:173], v[196:199]
    s_waitcnt lgkmcnt(0)
    v_cvt_pk_bf16_f32 v31, v236, v237
    v_cvt_pk_bf16_f32 v34, v238, v239
    v_mfma_f32_16x16x32_bf16 v[200:203], v[162:165], v[168:171], v[200:203]
    v_exp_f32 v210, v210
    v_mfma_f32_16x16x32_bf16 v[200:203], v[164:167], v[170:173], v[200:203]
    v_exp_f32 v211, v211
    v_mfma_f32_16x16x32_bf16 v[204:207], v[132:135], v[168:171], v[204:207]
    v_cvt_pk_bf16_f32 v193, v208, v209
    v_cvt_pk_bf16_f32 v180, v210, v211
    v_mfma_f32_16x16x32_bf16 v[204:207], v[134:137], v[170:173], v[204:207]
    ds_read_b128 v[208:211], v245 offset:64
    v_sub_f32 v196, v196, v248
    v_mfma_f32_16x16x32_bf16 v[228:231], a[232:235], a[120:123], 0
    s_waitcnt vmcnt(3)
    ds_read_b64_tr_b16 a[152:153], v249 offset:0
    v_mfma_f32_16x16x32_bf16 v[228:231], a[236:239], a[124:127], v[228:231]
    ds_read_b64_tr_b16 a[154:155], v250 offset:0
    ds_read_b64_tr_b16 a[176:177], v249 offset:32
    v_mfma_f32_16x16x32_bf16 v[228:231], a[240:243], a[128:131], v[228:231]
    ds_read_b64_tr_b16 a[178:179], v250 offset:32
    ds_read_b64_tr_b16 a[200:201], v249 offset:64
    v_mfma_f32_16x16x32_bf16 v[228:231], a[244:247], a[132:135], v[228:231]
    ds_read_b64_tr_b16 a[202:203], v250 offset:64
    ds_read_b128 a[232:235], v240 offset:1664
    v_mfma_f32_16x16x32_bf16 v[228:231], a[216:219], a[136:139], v[228:231]
    ds_read_b128 a[236:239], v241 offset:1664
    ds_read_b128 a[240:243], v240 offset:1792
    v_mfma_f32_16x16x32_bf16 v[228:231], a[220:223], a[140:143], v[228:231]
    ds_read_b128 a[244:247], v241 offset:1792
    ds_read_b128 a[216:219], v240 offset:3072
    v_mfma_f32_16x16x32_bf16 v[232:235], a[0:3], a[224:227], 0
    ds_read_b128 a[220:223], v241 offset:3072
    v_sub_f32 v197, v197, v248
    v_mfma_f32_16x16x32_bf16 v[232:235], a[4:7], a[228:231], v[232:235]
    s_waitcnt lgkmcnt(12)
    v_exp_f32 v196, v196
    v_mfma_f32_16x16x32_bf16 v[208:211], v[156:159], v[168:171], v[208:211]
    v_cvt_pk_bf16_f32 v61, v228, v229
    v_cvt_pk_bf16_f32 v64, v230, v231
    v_mfma_f32_16x16x32_bf16 v[208:211], v[158:161], v[170:173], v[208:211]
    v_exp_f32 v197, v197
    v_mfma_f32_16x16x32_bf16 v[236:239], a[24:27], a[224:227], 0
    v_sub_f32 v198, v198, v248
    v_sub_f32 v199, v199, v248
    v_mfma_f32_16x16x32_bf16 v[236:239], a[28:31], a[228:231], v[236:239]
    s_waitcnt lgkmcnt(6)
    buffer_load_dwordx4 v252, s[12:15], s62 offen lds
    v_mfma_f32_16x16x32_bf16 v[228:231], a[48:51], a[224:227], 0
    s_waitcnt lgkmcnt(5)
    v_exp_f32 v198, v198
    v_mfma_f32_16x16x32_bf16 v[232:235], a[8:11], a[232:235], v[232:235]
    s_waitcnt lgkmcnt(4)
    v_exp_f32 v199, v199
    v_mfma_f32_16x16x32_bf16 v[232:235], a[12:15], a[236:239], v[232:235]
    s_waitcnt vmcnt(1) lgkmcnt(3)
    ds_read_b64_tr_b16 a[156:157], v249 offset:3072
    v_mfma_f32_16x16x32_bf16 v[232:235], a[16:19], a[240:243], v[232:235]
    buffer_load_dwordx4 v253, s[12:15], s62 offen offset:1024 lds
    ds_read_b64_tr_b16 a[158:159], v250 offset:3072
    v_mfma_f32_16x16x32_bf16 v[236:239], a[32:35], a[232:235], v[236:239]
    ds_read_b64_tr_b16 a[180:181], v249 offset:3104
    ds_read_b64_tr_b16 a[182:183], v250 offset:3104
    v_mfma_f32_16x16x32_bf16 v[236:239], a[36:39], a[236:239], v[236:239]
    ds_read_b64_tr_b16 a[204:205], v249 offset:3136
    ds_read_b64_tr_b16 a[206:207], v250 offset:3136
    v_mfma_f32_16x16x32_bf16 v[236:239], a[40:43], a[240:243], v[236:239]
    s_waitcnt lgkmcnt(8)
    v_cvt_pk_bf16_f32 v194, v196, v197
    v_cvt_pk_bf16_f32 v181, v198, v199
    v_mfma_f32_16x16x32_bf16 v[232:235], a[20:23], a[244:247], v[232:235]
    buffer_load_dwordx4 v251, s[12:15], s62 offen offset:2048 lds
    s_add_u32 m0, s46, 0x17400
    v_mfma_f32_16x16x32_bf16 v[236:239], a[44:47], a[244:247], v[236:239]
    ds_read_b128 v[196:199], v246 offset:64
    v_sub_f32 v200, v200, v248
    v_mfma_f32_16x16x32_bf16 v[228:231], a[52:55], a[228:231], v[228:231]
    v_exp_f32 v200, v200
    v_mfma_f32_16x16x32_bf16 v[228:231], a[56:59], a[232:235], v[228:231]
    v_sub_f32 v201, v201, v248
    v_sub_f32 v202, v202, v248
    v_mfma_f32_16x16x32_bf16 v[228:231], a[60:63], a[236:239], v[228:231]
    v_exp_f32 v201, v201
    v_mfma_f32_16x16x32_bf16 v[228:231], a[64:67], a[240:243], v[228:231]
    v_exp_f32 v202, v202
    v_mfma_f32_16x16x32_bf16 v[228:231], a[68:71], a[244:247], v[228:231]
    v_sub_f32 v203, v203, v248
    v_exp_f32 v203, v203
    s_waitcnt lgkmcnt(1)
    buffer_load_dwordx4 v252, s[12:15], s63 offen lds
    v_cvt_pk_bf16_f32 v192, v200, v201
    v_cvt_pk_bf16_f32 v195, v202, v203
    ds_read_b128 v[200:203], v244 offset:128
    v_sub_f32 v204, v204, v248
    v_mfma_f32_16x16x32_bf16 v[212:215], v[12:15], v[192:195], 0
    s_waitcnt lgkmcnt(1)
    v_exp_f32 v204, v204
    v_mfma_f32_16x16x32_bf16 v[216:219], v[42:45], v[192:195], 0
    v_sub_f32 v205, v205, v248
    v_sub_f32 v206, v206, v248
    v_mfma_f32_16x16x32_bf16 v[220:223], v[72:75], v[192:195], 0
    buffer_load_dwordx4 v253, s[12:15], s63 offen offset:1024 lds
    v_sub_f32 v207, v207, v248
    v_mfma_f32_16x16x32_bf16 v[224:227], a[248:251], v[192:195], 0
    v_exp_f32 v205, v205
    v_mfma_f32_16x16x32_bf16 v[196:199], v[114:117], v[168:171], v[196:199]
    v_exp_f32 v206, v206
    v_mfma_f32_16x16x32_bf16 v[196:199], v[116:119], v[170:173], v[196:199]
    v_exp_f32 v207, v207
    buffer_load_dwordx4 v251, s[12:15], s63 offen offset:2048 lds
    v_cvt_pk_bf16_f32 v183, v204, v205
    v_cvt_pk_bf16_f32 v186, v206, v207
    ds_read_b128 v[204:207], v245 offset:128
    s_waitcnt lgkmcnt(1)
    v_mfma_f32_16x16x32_bf16 v[200:203], v[102:105], v[168:171], v[200:203]
    v_sub_f32 v208, v208, v248
    v_sub_f32 v209, v209, v248
    v_mfma_f32_16x16x32_bf16 v[200:203], v[104:107], v[170:173], v[200:203]
    v_exp_f32 v208, v208
    v_exp_f32 v209, v209
    v_sub_f32 v210, v210, v248
    v_exp_f32 v210, v210
    v_sub_f32 v211, v211, v248
    v_exp_f32 v211, v211
    v_cvt_pk_bf16_f32 v184, v208, v209
    v_cvt_pk_bf16_f32 v187, v210, v211
    ds_read_b128 v[208:211], v246 offset:128
    v_sub_f32 v196, v196, v248
    v_exp_f32 v196, v196
    v_sub_f32 v197, v197, v248
    v_exp_f32 v197, v197
    v_sub_f32 v198, v198, v248
    v_exp_f32 v198, v198
    s_waitcnt lgkmcnt(1)
    v_mfma_f32_16x16x32_bf16 v[204:207], v[108:111], v[168:171], v[204:207]
    v_sub_f32 v199, v199, v248
    v_cvt_pk_bf16_f32 v182, v196, v197
    v_mfma_f32_16x16x32_bf16 v[204:207], v[110:113], v[170:173], v[204:207]
    v_exp_f32 v199, v199
    v_mfma_f32_16x16x32_bf16 v[212:215], v[16:19], v[180:183], v[212:215]
    v_cvt_pk_bf16_f32 v185, v198, v199
    v_sub_f32 v200, v200, v248
    v_mfma_f32_16x16x32_bf16 v[216:219], v[46:49], v[180:183], v[216:219]
    ds_read_b128 v[196:199], v244 offset:32
    v_sub_f32 v201, v201, v248
    v_mfma_f32_16x16x32_bf16 v[220:223], v[76:79], v[180:183], v[220:223]
    v_exp_f32 v200, v200
    v_mfma_f32_16x16x32_bf16 v[224:227], a[248:251], v[180:183], v[224:227]
    s_waitcnt lgkmcnt(1)
    v_exp_f32 v201, v201
    v_mfma_f32_16x16x32_bf16 v[212:215], v[20:23], v[184:187], v[212:215]
    v_cvt_pk_bf16_f32 v189, v200, v201
    v_sub_f32 v204, v204, v248
    v_mfma_f32_16x16x32_bf16 v[216:219], v[50:53], v[184:187], v[216:219]
    ds_read_b128 v[200:203], v245 offset:32
    v_sub_f32 v205, v205, v248
    v_mfma_f32_16x16x32_bf16 v[220:223], v[80:83], v[184:187], v[220:223]
    v_exp_f32 v204, v204
    v_mfma_f32_16x16x32_bf16 v[224:227], a[248:251], v[184:187], v[224:227]
    v_exp_f32 v205, v205
    v_mfma_f32_16x16x32_bf16 v[208:211], v[120:123], v[168:171], v[208:211]
    ds_read_b64 v[168:169], v247 offset:24576
    v_cvt_pk_bf16_f32 v190, v204, v205
    v_mfma_f32_16x16x32_bf16 v[208:211], v[122:125], v[170:173], v[208:211]
    ds_read_b128 v[204:207], v246 offset:32
    s_waitcnt lgkmcnt(3)
    v_mfma_f32_16x16x32_bf16 v[196:199], v[132:135], v[174:177], v[196:199]
    ds_read_b64 v[170:171], v247 offset:24704
    ds_read_b64 v[172:173], v247 offset:24832
    v_mfma_f32_16x16x32_bf16 v[196:199], v[134:137], v[176:179], v[196:199]
    s_nop 1
    v_sub_f32 v208, v208, v248
    v_exp_f32 v208, v208
    v_sub_f32 v209, v209, v248
    v_exp_f32 v209, v209
    s_nop 0
    s_waitcnt lgkmcnt(4)
    v_mfma_f32_16x16x32_bf16 v[200:203], v[156:159], v[174:177], v[200:203]
    v_cvt_pk_bf16_f32 v188, v208, v209
    v_max_f32 v248, v196, v197
    v_mfma_f32_16x16x32_bf16 v[200:203], v[158:161], v[176:179], v[200:203]
    ds_read_b128 v[208:211], v244 offset:96
    v_max3_f32 v248, v248, v198, v199
    v_mfma_f32_16x16x32_bf16 v[212:215], v[24:27], v[188:191], v[212:215]
    ds_read_b128 v[196:199], v245 offset:96
    v_mfma_f32_16x16x32_bf16 v[216:219], v[54:57], v[188:191], v[216:219]
    v_mfma_f32_16x16x32_bf16 v[220:223], v[84:87], v[188:191], v[220:223]
    s_waitcnt lgkmcnt(4)
    v_mfma_f32_16x16x32_bf16 v[224:227], a[248:251], v[188:191], v[224:227]
    v_max3_f32 v248, v248, v200, v201
    v_max3_f32 v248, v248, v202, v203
    v_mfma_f32_16x16x32_bf16 v[204:207], v[114:117], v[174:177], v[204:207]
    ds_read_b128 v[200:203], v246 offset:96
    v_mfma_f32_16x16x32_bf16 v[204:207], v[116:119], v[176:179], v[204:207]
    s_nop 2
    v_rcp_f32 v225, v224
    s_nop 0
    v_mul_f32 v212, v212, v225
    v_mul_f32 v213, v213, v225
    v_mul_f32 v214, v214, v225
    s_waitcnt lgkmcnt(2)
    v_mfma_f32_16x16x32_bf16 v[208:211], v[102:105], v[174:177], v[208:211]
    s_waitcnt vmcnt(3)
    ds_read_b64_tr_b16 a[160:161], v249 offset:0
    v_mfma_f32_16x16x32_bf16 v[208:211], v[104:107], v[176:179], v[208:211]
    s_waitcnt lgkmcnt(2)
    ds_read_b64_tr_b16 a[162:163], v250 offset:0
    v_mfma_f32_16x16x32_bf16 v[196:199], v[108:111], v[174:177], v[196:199]
    ds_read_b64_tr_b16 a[184:185], v249 offset:32
    ds_read_b64_tr_b16 a[186:187], v250 offset:32
    v_mfma_f32_16x16x32_bf16 v[196:199], v[110:113], v[176:179], v[196:199]
    ds_read_b64_tr_b16 a[208:209], v249 offset:64
    ds_read_b64_tr_b16 a[210:211], v250 offset:64
    v_mul_f32 v215, v215, v225
    v_cvt_pk_bf16_f32 v212, v212, v213
    s_waitcnt lgkmcnt(6)
    v_mfma_f32_16x16x32_bf16 v[200:203], v[120:123], v[174:177], v[200:203]
    v_cvt_pk_bf16_f32 v213, v214, v215
    v_mul_f32 v216, v216, v225
    v_mfma_f32_16x16x32_bf16 v[200:203], v[122:125], v[176:179], v[200:203]
    ds_write_b64 v247, v[212:213] offset:18432
    v_mul_f32 v217, v217, v225
    v_mul_f32 v218, v218, v225
    v_mul_f32 v219, v219, v225
    v_cvt_pk_bf16_f32 v216, v216, v217
    v_cvt_pk_bf16_f32 v217, v218, v219
    ds_write_b64 v247, v[216:217] offset:18560
    v_mul_f32 v220, v220, v225
    v_mul_f32 v221, v221, v225
    v_mul_f32 v222, v222, v225
    v_mul_f32 v223, v223, v225
    v_cvt_pk_bf16_f32 v220, v220, v221
    v_cvt_pk_bf16_f32 v221, v222, v223
    ds_write_b64 v247, v[220:221] offset:18688
    v_max3_f32 v248, v248, v204, v205
    v_max3_f32 v248, v248, v206, v207
    ds_read_b128 v[204:207], v244 offset:32
    v_max3_f32 v248, v248, v208, v209
    v_max3_f32 v248, v248, v210, v211
    ds_read_b128 v[208:211], v245 offset:32
    v_max3_f32 v248, v248, v196, v197
    v_max3_f32 v248, v248, v198, v199
    s_waitcnt vmcnt(0)
    ds_read_b64_tr_b16 a[164:165], v249 offset:3072
    ds_read_b64_tr_b16 a[166:167], v250 offset:3072
    ds_read_b64_tr_b16 a[188:189], v249 offset:3104
    ds_read_b64_tr_b16 a[190:191], v250 offset:3104
    ds_read_b64_tr_b16 a[212:213], v249 offset:3136
    ds_read_b64_tr_b16 a[214:215], v250 offset:3136
    ds_read_b128 v[196:199], v246 offset:32
    v_max3_f32 v248, v248, v200, v201
    v_max3_f32 v248, v248, v202, v203
    ds_read_b128 v[200:203], v244 offset:96
    v_mov_b32 v225, v248
    s_nop 1
    v_permlane16_swap_b32 v248, v225
    v_max_f32 v248, v248, v225
    v_mov_b32 v225, v248
    s_nop 1
    s_waitcnt lgkmcnt(9)
    v_mfma_f32_16x16x32_bf16 v[204:207], v[132:135], v[174:177], v[204:207]
    v_cvt_pk_bf16_f32 v132, v232, v233
    v_cvt_pk_bf16_f32 v133, v234, v235
    v_mfma_f32_16x16x32_bf16 v[204:207], v[134:137], v[176:179], v[204:207]
    s_waitcnt lgkmcnt(8)
    v_cvt_pk_bf16_f32 v134, v236, v237
    v_cvt_pk_bf16_f32 v135, v238, v239
    v_mfma_f32_16x16x32_bf16 v[208:211], v[156:159], v[174:177], v[208:211]
    v_cvt_pk_bf16_f32 v136, v228, v229
    v_cvt_pk_bf16_f32 v137, v230, v231
    v_mfma_f32_16x16x32_bf16 v[208:211], v[158:161], v[176:179], v[208:211]
    v_permlane32_swap_b32 v248, v225
    v_max_f32 v248, v248, v225
    v_mfma_f32_16x16x32_bf16 v[232:235], a[224:227], a[72:75], 0
    v_sub_f32 v204, v204, v248
    s_waitcnt lgkmcnt(2)
    v_mfma_f32_16x16x32_bf16 v[232:235], a[228:231], a[76:79], v[232:235]
    s_barrier
    v_exp_f32 v204, v204
    v_mfma_f32_16x16x32_bf16 v[232:235], a[232:235], a[80:83], v[232:235]
    s_waitcnt lgkmcnt(1)
    v_sub_f32 v205, v205, v248
    v_sub_f32 v206, v206, v248
    v_mfma_f32_16x16x32_bf16 v[196:199], v[114:117], v[174:177], v[196:199]
    s_waitcnt lgkmcnt(0)
    v_exp_f32 v205, v205
    v_mfma_f32_16x16x32_bf16 v[196:199], v[116:119], v[176:179], v[196:199]
    v_exp_f32 v206, v206
    v_mfma_f32_16x16x32_bf16 v[200:203], v[102:105], v[174:177], v[200:203]
    v_sub_f32 v207, v207, v248
    v_cvt_pk_bf16_f32 v193, v204, v205
    v_mfma_f32_16x16x32_bf16 v[200:203], v[104:107], v[176:179], v[200:203]
    v_exp_f32 v207, v207
    v_mfma_f32_16x16x32_bf16 v[232:235], a[236:239], a[84:87], v[232:235]
    v_cvt_pk_bf16_f32 v180, v206, v207
    v_sub_f32 v208, v208, v248
    v_mfma_f32_16x16x32_bf16 v[232:235], a[240:243], a[88:91], v[232:235]
    ds_read_b128 v[204:207], v245 offset:96
    v_sub_f32 v209, v209, v248
    v_mfma_f32_16x16x32_bf16 v[232:235], a[244:247], a[92:95], v[232:235]
    v_exp_f32 v208, v208
    v_mfma_f32_16x16x32_bf16 v[236:239], a[224:227], a[96:99], 0
    v_exp_f32 v209, v209
    v_mfma_f32_16x16x32_bf16 v[236:239], a[228:231], a[100:103], v[236:239]
    v_sub_f32 v210, v210, v248
    v_sub_f32 v211, v211, v248
    v_mfma_f32_16x16x32_bf16 v[236:239], a[232:235], a[104:107], v[236:239]
    v_exp_f32 v210, v210
    v_mfma_f32_16x16x32_bf16 v[236:239], a[236:239], a[108:111], v[236:239]
    v_cvt_pk_bf16_f32 v7, v232, v233
    v_cvt_pk_bf16_f32 v10, v234, v235
    v_mfma_f32_16x16x32_bf16 v[236:239], a[240:243], a[112:115], v[236:239]
    v_exp_f32 v211, v211
    v_mfma_f32_16x16x32_bf16 v[236:239], a[244:247], a[116:119], v[236:239]
    v_cvt_pk_bf16_f32 v194, v208, v209
    v_cvt_pk_bf16_f32 v181, v210, v211
    v_mfma_f32_16x16x32_bf16 v[228:231], a[224:227], a[120:123], 0
    ds_read_b128 a[224:227], v240 offset:3200
    ds_read_b128 v[208:211], v246 offset:96
    v_mfma_f32_16x16x32_bf16 v[228:231], a[228:231], a[124:127], v[228:231]
    ds_read_b128 a[228:231], v241 offset:3200
    v_sub_f32 v196, v196, v248
    v_mfma_f32_16x16x32_bf16 v[228:231], a[232:235], a[128:131], v[228:231]
    s_waitcnt lgkmcnt(3)
    v_cvt_pk_bf16_f32 v37, v236, v237
    v_cvt_pk_bf16_f32 v40, v238, v239
    v_mfma_f32_16x16x32_bf16 v[204:207], v[108:111], v[174:177], v[204:207]
    ds_read_b128 a[232:235], v240 offset:3328
    v_sub_f32 v197, v197, v248
    v_mfma_f32_16x16x32_bf16 v[204:207], v[110:113], v[176:179], v[204:207]
    v_exp_f32 v196, v196
    v_mfma_f32_16x16x32_bf16 v[228:231], a[236:239], a[132:135], v[228:231]
    ds_read_b128 a[236:239], v241 offset:3328
    v_sub_f32 v198, v198, v248
    v_mfma_f32_16x16x32_bf16 v[228:231], a[240:243], a[136:139], v[228:231]
    ds_read_b128 a[240:243], v240 offset:4608
    v_sub_f32 v199, v199, v248
    v_mfma_f32_16x16x32_bf16 v[228:231], a[244:247], a[140:143], v[228:231]
    ds_read_b128 a[244:247], v241 offset:4608
    v_sub_f32 v200, v200, v248
    v_mfma_f32_16x16x32_bf16 v[232:235], a[0:3], a[216:219], 0
    v_exp_f32 v197, v197
    v_mfma_f32_16x16x32_bf16 v[232:235], a[4:7], a[220:223], v[232:235]
    s_waitcnt lgkmcnt(6)
    v_exp_f32 v198, v198
    v_mfma_f32_16x16x32_bf16 v[232:235], a[8:11], a[224:227], v[232:235]
    s_waitcnt lgkmcnt(5)
    v_cvt_pk_bf16_f32 v67, v228, v229
    v_cvt_pk_bf16_f32 v70, v230, v231
    v_mfma_f32_16x16x32_bf16 v[208:211], v[120:123], v[174:177], v[208:211]
    ds_read_b64 v[174:175], v247 offset:30720
    v_cvt_pk_bf16_f32 v192, v196, v197
    v_mfma_f32_16x16x32_bf16 v[208:211], v[122:125], v[176:179], v[208:211]
    ds_read_b64 v[176:177], v247 offset:30848
    ds_read_b64 v[178:179], v247 offset:30976
    v_mfma_f32_16x16x32_bf16 v[236:239], a[24:27], a[216:219], 0
    s_waitcnt lgkmcnt(7)
    v_exp_f32 v199, v199
    v_mfma_f32_16x16x32_bf16 v[232:235], a[12:15], a[228:231], v[232:235]
    s_waitcnt lgkmcnt(6)
    v_cvt_pk_bf16_f32 v195, v198, v199
    v_sub_f32 v201, v201, v248
    v_mfma_f32_16x16x32_bf16 v[232:235], a[16:19], a[232:235], v[232:235]
    ds_read_b128 v[196:199], v244 offset:192
    v_sub_f32 v202, v202, v248
    v_mfma_f32_16x16x32_bf16 v[212:215], v[18:21], v[192:195], 0
    s_waitcnt lgkmcnt(6)
    v_exp_f32 v200, v200
    v_mfma_f32_16x16x32_bf16 v[216:219], v[48:51], v[192:195], 0
    v_exp_f32 v201, v201
    v_mfma_f32_16x16x32_bf16 v[220:223], v[78:81], v[192:195], 0
    v_exp_f32 v202, v202
    v_mfma_f32_16x16x32_bf16 v[224:227], a[248:251], v[192:195], 0
    v_sub_f32 v203, v203, v248
    v_cvt_pk_bf16_f32 v183, v200, v201
    v_mfma_f32_16x16x32_bf16 v[232:235], a[20:23], a[236:239], v[232:235]
    v_exp_f32 v203, v203
    v_mfma_f32_16x16x32_bf16 v[236:239], a[28:31], a[220:223], v[236:239]
    v_cvt_pk_bf16_f32 v186, v202, v203
    v_sub_f32 v204, v204, v248
    v_mfma_f32_16x16x32_bf16 v[236:239], a[32:35], a[224:227], v[236:239]
    ds_read_b128 v[200:203], v245 offset:192
    v_sub_f32 v205, v205, v248
    v_mfma_f32_16x16x32_bf16 v[236:239], a[36:39], a[228:231], v[236:239]
    v_cvt_pk_bf16_f32 v102, v232, v233
    v_cvt_pk_bf16_f32 v103, v234, v235
    v_mfma_f32_16x16x32_bf16 v[236:239], a[40:43], a[232:235], v[236:239]
    s_waitcnt lgkmcnt(1)
    v_exp_f32 v204, v204
    v_mfma_f32_16x16x32_bf16 v[196:199], v[138:141], v[168:171], v[196:199]
    v_exp_f32 v205, v205
    v_mfma_f32_16x16x32_bf16 v[196:199], v[140:143], v[170:173], v[196:199]
    v_sub_f32 v206, v206, v248
    v_sub_f32 v207, v207, v248
    v_mfma_f32_16x16x32_bf16 v[236:239], a[44:47], a[236:239], v[236:239]
    v_exp_f32 v206, v206
    v_mfma_f32_16x16x32_bf16 v[228:231], a[48:51], a[216:219], 0
    v_exp_f32 v207, v207
    v_mfma_f32_16x16x32_bf16 v[228:231], a[52:55], a[220:223], v[228:231]
    v_cvt_pk_bf16_f32 v184, v204, v205
    v_cvt_pk_bf16_f32 v187, v206, v207
    v_mfma_f32_16x16x32_bf16 v[228:231], a[56:59], a[224:227], v[228:231]
    ds_read_b128 v[204:207], v246 offset:192
    v_cvt_pk_bf16_f32 v104, v236, v237
    v_mfma_f32_16x16x32_bf16 v[228:231], a[60:63], a[228:231], v[228:231]
    s_waitcnt lgkmcnt(1)
    v_cvt_pk_bf16_f32 v105, v238, v239
    v_sub_f32 v208, v208, v248
    v_mfma_f32_16x16x32_bf16 v[200:203], v[90:93], v[168:171], v[200:203]
    v_exp_f32 v208, v208
    v_mfma_f32_16x16x32_bf16 v[200:203], v[92:95], v[170:173], v[200:203]
    v_sub_f32 v209, v209, v248
    v_sub_f32 v210, v210, v248
    v_mfma_f32_16x16x32_bf16 v[228:231], a[64:67], a[232:235], v[228:231]
    v_exp_f32 v209, v209
    v_mfma_f32_16x16x32_bf16 v[228:231], a[68:71], a[236:239], v[228:231]
    v_exp_f32 v210, v210
    v_mfma_f32_16x16x32_bf16 v[232:235], a[216:219], a[72:75], 0
    v_sub_f32 v211, v211, v248
    v_cvt_pk_bf16_f32 v182, v208, v209
    v_mfma_f32_16x16x32_bf16 v[232:235], a[220:223], a[76:79], v[232:235]
    v_exp_f32 v211, v211
    v_mfma_f32_16x16x32_bf16 v[212:215], v[22:25], v[180:183], v[212:215]
    v_cvt_pk_bf16_f32 v185, v210, v211
    v_cvt_pk_bf16_f32 v106, v228, v229
    v_mfma_f32_16x16x32_bf16 v[216:219], v[52:55], v[180:183], v[216:219]
    ds_read_b128 v[208:211], v244 offset:256
    v_cvt_pk_bf16_f32 v107, v230, v231
    v_mfma_f32_16x16x32_bf16 v[220:223], v[82:85], v[180:183], v[220:223]
    s_waitcnt lgkmcnt(1)
    v_max_f32 v248, v196, v197
    v_max3_f32 v248, v248, v198, v199
    v_mfma_f32_16x16x32_bf16 v[224:227], a[248:251], v[180:183], v[224:227]
    ds_read_b128 v[196:199], v245 offset:256
    v_max3_f32 v248, v248, v200, v201
    v_mfma_f32_16x16x32_bf16 v[212:215], v[26:29], v[184:187], v[212:215]
    v_max3_f32 v248, v248, v202, v203
    v_mfma_f32_16x16x32_bf16 v[216:219], v[56:59], v[184:187], v[216:219]
    ds_read_b128 v[200:203], v246 offset:256
    v_mfma_f32_16x16x32_bf16 v[220:223], v[86:89], v[184:187], v[220:223]
    v_mfma_f32_16x16x32_bf16 v[224:227], a[248:251], v[184:187], v[224:227]
    v_mov_b32 v187, 0
    v_mfma_f32_16x16x32_bf16 v[204:207], v[126:129], v[168:171], v[204:207]
    v_mfma_f32_16x16x32_bf16 v[204:207], v[128:131], v[170:173], v[204:207]
    v_mfma_f32_16x16x32_bf16 v[232:235], a[224:227], a[80:83], v[232:235]
    s_waitcnt lgkmcnt(2)
    v_mfma_f32_16x16x32_bf16 v[208:211], v[144:147], v[168:171], v[208:211]
    v_mfma_f32_16x16x32_bf16 v[208:211], v[146:149], v[170:173], v[208:211]
    s_waitcnt lgkmcnt(1)
    v_rcp_f32 v225, v224
    v_mfma_f32_16x16x32_bf16 v[196:199], v[96:99], v[168:171], v[196:199]
    v_mov_b32 v226, 0x22e00
    v_cndmask_b32 v226, v226, v247, vcc
    v_mfma_f32_16x16x32_bf16 v[196:199], v[98:101], v[170:173], v[196:199]
    s_mov_b32 vcc_lo, 0xff00fff0
    v_mul_f32 v212, v212, v225
    v_mul_f32 v213, v213, v225
    v_mfma_f32_16x16x32_bf16 v[232:235], a[228:231], a[84:87], v[232:235]
    s_mov_b32 vcc_hi, 0xf000
    v_mul_f32 v214, v214, v225
    v_mul_f32 v215, v215, v225
    v_mfma_f32_16x16x32_bf16 v[232:235], a[232:235], a[88:91], v[232:235]
    s_waitcnt lgkmcnt(0)
    v_cvt_pk_bf16_f32 v212, v212, v213
    v_cvt_pk_bf16_f32 v213, v214, v215
    v_mfma_f32_16x16x32_bf16 v[200:203], v[132:135], v[168:171], v[200:203]
    ds_write_b64 v226, v[212:213] offset:0
    v_mfma_f32_16x16x32_bf16 v[200:203], v[134:137], v[170:173], v[200:203]
    v_mul_f32 v216, v216, v225
    v_mul_f32 v217, v217, v225
    v_mfma_f32_16x16x32_bf16 v[232:235], a[236:239], a[92:95], v[232:235]
    v_mul_f32 v218, v218, v225
    v_mul_f32 v219, v219, v225
    v_mfma_f32_16x16x32_bf16 v[236:239], a[216:219], a[96:99], 0
    v_cvt_pk_bf16_f32 v216, v216, v217
    v_cvt_pk_bf16_f32 v217, v218, v219
    v_mfma_f32_16x16x32_bf16 v[236:239], a[220:223], a[100:103], v[236:239]
    ds_write_b64 v226, v[216:217] offset:128
    v_mfma_f32_16x16x32_bf16 v[236:239], a[224:227], a[104:107], v[236:239]
    v_cvt_pk_bf16_f32 v13, v232, v233
    v_cvt_pk_bf16_f32 v16, v234, v235
    v_mfma_f32_16x16x32_bf16 v[236:239], a[228:231], a[108:111], v[236:239]
    v_mul_f32 v220, v220, v225
    v_mul_f32 v221, v221, v225
    v_mfma_f32_16x16x32_bf16 v[236:239], a[232:235], a[112:115], v[236:239]
    v_mul_f32 v222, v222, v225
    v_mul_f32 v223, v223, v225
    v_mfma_f32_16x16x32_bf16 v[236:239], a[236:239], a[116:119], v[236:239]
    v_cvt_pk_bf16_f32 v220, v220, v221
    v_cvt_pk_bf16_f32 v221, v222, v223
    v_mfma_f32_16x16x32_bf16 v[228:231], a[216:219], a[120:123], 0
    ds_read_b128 a[216:219], v240 offset:4736
    v_max3_f32 v248, v248, v204, v205
    v_mfma_f32_16x16x32_bf16 v[228:231], a[220:223], a[124:127], v[228:231]
    ds_read_b128 a[220:223], v241 offset:4736
    v_max3_f32 v248, v248, v206, v207
    v_mfma_f32_16x16x32_bf16 v[228:231], a[224:227], a[128:131], v[228:231]
    v_cvt_pk_bf16_f32 v43, v236, v237
    v_cvt_pk_bf16_f32 v46, v238, v239
    v_mfma_f32_16x16x32_bf16 v[228:231], a[228:231], a[132:135], v[228:231]
    ds_read_b128 a[224:227], v240 offset:4864
    ds_read_b128 a[228:231], v241 offset:4864
    v_mfma_f32_16x16x32_bf16 v[228:231], a[232:235], a[136:139], v[228:231]
    ds_read_b128 v[204:207], v244 offset:320
    v_max3_f32 v248, v248, v208, v209
    v_mfma_f32_16x16x32_bf16 v[228:231], a[236:239], a[140:143], v[228:231]
    ds_write_b64 v226, v[220:221] offset:256
    v_mfma_f32_16x16x32_bf16 v[232:235], a[0:3], a[240:243], 0
    v_max3_f32 v248, v248, v210, v211
    v_max3_f32 v248, v248, v196, v197
    v_mfma_f32_16x16x32_bf16 v[232:235], a[4:7], a[244:247], v[232:235]
    ds_read_b128 v[208:211], v245 offset:320
    v_max3_f32 v248, v248, v198, v199
    v_mfma_f32_16x16x32_bf16 v[236:239], a[24:27], a[240:243], 0
    s_waitcnt lgkmcnt(6)
    v_cvt_pk_bf16_f32 v73, v228, v229
    v_cvt_pk_bf16_f32 v76, v230, v231
    v_mfma_f32_16x16x32_bf16 v[232:235], a[8:11], a[216:219], v[232:235]
    ds_read_b128 v[196:199], v246 offset:320
    v_max3_f32 v248, v248, v200, v201
    v_mfma_f32_16x16x32_bf16 v[236:239], a[28:31], a[244:247], v[236:239]
    s_waitcnt lgkmcnt(6)
    v_max3_f32 v248, v248, v202, v203
    v_mfma_f32_16x16x32_bf16 v[232:235], a[12:15], a[220:223], v[232:235]
    ds_read_b128 v[200:203], v244 offset:192
    s_waitcnt lgkmcnt(6)
    v_mfma_f32_16x16x32_bf16 v[232:235], a[16:19], a[224:227], v[232:235]
    s_waitcnt lgkmcnt(5)
    v_mfma_f32_16x16x32_bf16 v[232:235], a[20:23], a[228:231], v[232:235]
    s_waitcnt lgkmcnt(4)
    v_mfma_f32_16x16x32_bf16 v[204:207], v[150:153], v[168:171], v[204:207]
    v_mfma_f32_16x16x32_bf16 v[204:207], v[152:155], v[170:173], v[204:207]
    v_mfma_f32_16x16x32_bf16 v[236:239], a[32:35], a[216:219], v[236:239]
    s_waitcnt lgkmcnt(2)
    v_mfma_f32_16x16x32_bf16 v[208:211], v[162:165], v[168:171], v[208:211]
    v_mfma_f32_16x16x32_bf16 v[208:211], v[164:167], v[170:173], v[208:211]
    s_waitcnt lgkmcnt(1)
    v_mfma_f32_16x16x32_bf16 v[196:199], v[102:105], v[168:171], v[196:199]
    v_mfma_f32_16x16x32_bf16 v[196:199], v[104:107], v[170:173], v[196:199]
    s_waitcnt lgkmcnt(0)
    v_max3_f32 v248, v248, v204, v205
    v_mfma_f32_16x16x32_bf16 v[200:203], v[138:141], v[168:171], v[200:203]
    v_cvt_pk_bf16_f32 v138, v232, v233
    v_cvt_pk_bf16_f32 v139, v234, v235
    v_mfma_f32_16x16x32_bf16 v[200:203], v[140:143], v[170:173], v[200:203]
    ds_read_b128 v[204:207], v245 offset:192
    v_max3_f32 v248, v248, v208, v209
    v_mfma_f32_16x16x32_bf16 v[236:239], a[36:39], a[220:223], v[236:239]
    ds_read_b128 v[208:211], v246 offset:192
    v_max3_f32 v248, v248, v196, v197
    v_mfma_f32_16x16x32_bf16 v[236:239], a[40:43], a[224:227], v[236:239]
    ds_read_b128 v[196:199], v244 offset:256
    v_mov_b32 v225, v248
    v_mfma_f32_16x16x32_bf16 v[236:239], a[44:47], a[228:231], v[236:239]
    v_mfma_f32_16x16x32_bf16 v[228:231], a[48:51], a[240:243], 0
    v_permlane16_swap_b32 v248, v225
    v_max_f32 v248, v248, v225
    v_mfma_f32_16x16x32_bf16 v[228:231], a[52:55], a[244:247], v[228:231]
    v_mov_b32 v225, v248
    v_mfma_f32_16x16x32_bf16 v[228:231], a[56:59], a[216:219], v[228:231]
    v_mfma_f32_16x16x32_bf16 v[228:231], a[60:63], a[220:223], v[228:231]
    v_permlane32_swap_b32 v248, v225
    v_cvt_pk_bf16_f32 v140, v236, v237
    v_mfma_f32_16x16x32_bf16 v[228:231], a[64:67], a[224:227], v[228:231]
    v_cvt_pk_bf16_f32 v141, v238, v239
    v_max_f32 v248, v248, v225
    v_mfma_f32_16x16x32_bf16 v[228:231], a[68:71], a[228:231], v[228:231]
    s_waitcnt lgkmcnt(2)
    v_sub_f32 v200, v200, v248
    v_sub_f32 v201, v201, v248
    v_mfma_f32_16x16x32_bf16 v[204:207], v[90:93], v[168:171], v[204:207]
    s_waitcnt lgkmcnt(1)
    v_exp_f32 v200, v200
    v_mfma_f32_16x16x32_bf16 v[204:207], v[92:95], v[170:173], v[204:207]
    s_waitcnt lgkmcnt(0)
    v_cvt_pk_bf16_f32 v142, v228, v229
    v_cvt_pk_bf16_f32 v143, v230, v231
    v_mfma_f32_16x16x32_bf16 v[208:211], v[126:129], v[168:171], v[208:211]
    v_exp_f32 v201, v201
    v_mfma_f32_16x16x32_bf16 v[208:211], v[128:131], v[170:173], v[208:211]
    v_sub_f32 v202, v202, v248
    v_sub_f32 v203, v203, v248
    v_mfma_f32_16x16x32_bf16 v[196:199], v[144:147], v[168:171], v[196:199]
    v_exp_f32 v202, v202
    v_mfma_f32_16x16x32_bf16 v[196:199], v[146:149], v[170:173], v[196:199]
    v_exp_f32 v203, v203
    v_mfma_f32_16x16x32_bf16 v[232:235], a[240:243], a[72:75], 0
    v_cvt_pk_bf16_f32 v190, v200, v201
    v_cvt_pk_bf16_f32 v193, v202, v203
    v_mfma_f32_16x16x32_bf16 v[232:235], a[244:247], a[76:79], v[232:235]
    ds_read_b128 v[200:203], v245 offset:256
    v_sub_f32 v204, v204, v248
    v_mfma_f32_16x16x32_bf16 v[232:235], a[216:219], a[80:83], v[232:235]
    v_exp_f32 v204, v204
    v_mfma_f32_16x16x32_bf16 v[232:235], a[220:223], a[84:87], v[232:235]
    v_sub_f32 v205, v205, v248
    v_sub_f32 v206, v206, v248
    v_mfma_f32_16x16x32_bf16 v[232:235], a[224:227], a[88:91], v[232:235]
    v_exp_f32 v205, v205
    v_mfma_f32_16x16x32_bf16 v[232:235], a[228:231], a[92:95], v[232:235]
    v_exp_f32 v206, v206
    v_mfma_f32_16x16x32_bf16 v[236:239], a[240:243], a[96:99], 0
    v_sub_f32 v207, v207, v248
    v_cvt_pk_bf16_f32 v188, v204, v205
    v_mfma_f32_16x16x32_bf16 v[236:239], a[244:247], a[100:103], v[236:239]
    v_exp_f32 v207, v207
    v_mfma_f32_16x16x32_bf16 v[236:239], a[216:219], a[104:107], v[236:239]
    v_cvt_pk_bf16_f32 v191, v206, v207
    v_cvt_pk_bf16_f32 v19, v232, v233
    v_mfma_f32_16x16x32_bf16 v[236:239], a[220:223], a[108:111], v[236:239]
    ds_read_b128 v[204:207], v246 offset:256
    v_cvt_pk_bf16_f32 v22, v234, v235
    v_mfma_f32_16x16x32_bf16 v[236:239], a[224:227], a[112:115], v[236:239]
    s_waitcnt lgkmcnt(1)
    v_mbcnt_lo_u32_b32 v232, -1, 0
    v_mbcnt_hi_u32_b32 v232, -1, v232
    v_mfma_f32_16x16x32_bf16 v[200:203], v[96:99], v[168:171], v[200:203]
    v_and_b32 v233, 15, v232
    v_lshrrev_b32 v232, 4, v232
    v_mfma_f32_16x16x32_bf16 v[200:203], v[98:101], v[170:173], v[200:203]
    v_lshrrev_b32 v234, 1, v233
    v_mul_u32_u24 v235, 0x180, v233
    v_mfma_f32_16x16x32_bf16 v[236:239], a[228:231], a[116:119], v[236:239]
    v_xor_b32 v243, v232, v234
    v_lshl_add_u32 v242, v243, 4, v235
    v_mfma_f32_16x16x32_bf16 v[228:231], a[240:243], a[120:123], 0
    v_xor_b32 v243, 64, v242
    v_add_u32 v242, 0x1e000, v242
    v_mfma_f32_16x16x32_bf16 v[228:231], a[244:247], a[124:127], v[228:231]
    ds_read_b128 a[232:235], v242 offset:0
    v_add_u32 v243, 0x1e000, v243
    v_mfma_f32_16x16x32_bf16 v[228:231], a[216:219], a[128:131], v[228:231]
    v_cvt_pk_bf16_f32 v49, v236, v237
    v_cvt_pk_bf16_f32 v52, v238, v239
    v_mfma_f32_16x16x32_bf16 v[228:231], a[220:223], a[132:135], v[228:231]
    ds_read_b128 a[236:239], v243 offset:0
    ds_read_b128 a[240:243], v242 offset:128
    v_mfma_f32_16x16x32_bf16 v[228:231], a[224:227], a[136:139], v[228:231]
    ds_read_b128 a[244:247], v243 offset:128
    ds_read_b128 a[216:219], v242 offset:256
    v_mfma_f32_16x16x32_bf16 v[228:231], a[228:231], a[140:143], v[228:231]
    s_waitcnt lgkmcnt(5)
    ds_read_b128 a[220:223], v243 offset:256
    v_mfma_f32_16x16x32_bf16 v[204:207], v[132:135], v[168:171], v[204:207]
    ds_read_b128 a[224:227], v242 offset:6144
    ds_read_b128 a[228:231], v243 offset:6144
    v_mfma_f32_16x16x32_bf16 v[204:207], v[134:137], v[170:173], v[204:207]
    v_lshrrev_b32 v249, 1, v232
    v_or_b32 v249, s66, v249
    v_cvt_pk_bf16_f32 v79, v228, v229
    v_cvt_pk_bf16_f32 v82, v230, v231
    v_mov_b32 v253, v249
    v_xor_b32 v249, v249, v234
    v_lshl_add_u32 v249, v249, 4, v235
    s_waitcnt lgkmcnt(7)
    v_mfma_f32_16x16x32_bf16 v[236:239], a[144:147], a[232:235], 0
    v_and_b32 v235, 1, v232
    v_lshl_add_u32 v249, v235, 3, v249
    v_mfma_f32_16x16x32_bf16 v[228:231], a[168:171], a[232:235], 0
    v_add_u32 v249, 0x16800, v249
    s_waitcnt lgkmcnt(6)
    v_mfma_f32_16x16x32_bf16 v[236:239], a[148:151], a[236:239], v[236:239]
    v_xor_b32 v250, s67, v232
    v_mul_u32_u24 v250, 0x300, v250
    v_mfma_f32_16x16x32_bf16 v[228:231], a[172:175], a[236:239], v[228:231]
    s_waitcnt lgkmcnt(5)
    s_mul_i32 s67, s28, 0x600
    s_add_u32 s67, s67, 0x16800
    v_mfma_f32_16x16x32_bf16 v[236:239], a[152:155], a[240:243], v[236:239]
    s_waitcnt lgkmcnt(4)
    v_mul_u32_u24 v232, 0x180, v232
    v_add_u32 v232, s67, v232
    v_mfma_f32_16x16x32_bf16 v[236:239], a[156:159], a[244:247], v[236:239]
    s_waitcnt lgkmcnt(3)
    v_lshlrev_b32 v235, 3, v235
    v_xor_b32 v252, v233, v235
    v_mfma_f32_16x16x32_bf16 v[236:239], a[160:163], a[216:219], v[236:239]
    s_waitcnt lgkmcnt(2)
    v_xor_b32 v252, v252, v253
    v_lshl_add_u32 v252, v252, 4, v232
    v_mfma_f32_16x16x32_bf16 v[236:239], a[164:167], a[220:223], v[236:239]
    v_xor_b32 v253, v253, v234
    v_lshl_add_u32 v253, v253, 4, v232
    v_mfma_f32_16x16x32_bf16 v[228:231], a[176:179], a[240:243], v[228:231]
    v_and_b32 v234, 1, v233
    v_lshl_add_u32 v253, v234, 3, v253
    v_mfma_f32_16x16x32_bf16 v[228:231], a[180:183], a[244:247], v[228:231]
    v_lshl_add_u32 v251, v233, 3, v250
    v_xor_b32 v233, v233, v235
    v_mfma_f32_16x16x32_bf16 v[228:231], a[184:187], a[216:219], v[228:231]
    v_cvt_pk_bf16_f32 v236, v236, v237
    v_cvt_pk_bf16_f32 v237, v238, v239
    v_mfma_f32_16x16x32_bf16 v[228:231], a[188:191], a[220:223], v[228:231]
    ds_write_b64 v249, v[236:237] offset:0
    s_waitcnt lgkmcnt(2)
    v_mfma_f32_16x16x32_bf16 v[236:239], a[144:147], a[224:227], 0
    s_waitcnt lgkmcnt(1)
    v_lshl_add_u32 v250, v233, 4, v250
    v_sub_f32 v208, v208, v248
    v_mfma_f32_16x16x32_bf16 v[232:235], a[192:195], a[232:235], 0
    ds_read_b128 a[232:235], v242 offset:6272
    v_cvt_pk_bf16_f32 v228, v228, v229
    v_mfma_f32_16x16x32_bf16 v[232:235], a[196:199], a[236:239], v[232:235]
    ds_read_b128 a[236:239], v243 offset:6272
    v_cvt_pk_bf16_f32 v229, v230, v231
    v_mfma_f32_16x16x32_bf16 v[232:235], a[200:203], a[240:243], v[232:235]
    ds_write_b64 v249, v[228:229] offset:128
    v_mfma_f32_16x16x32_bf16 v[232:235], a[204:207], a[244:247], v[232:235]
    ds_read_b128 a[240:243], v242 offset:6400
    ds_read_b128 a[244:247], v243 offset:6400
    v_mfma_f32_16x16x32_bf16 v[232:235], a[208:211], a[216:219], v[232:235]
    ds_read_b128 a[216:219], v242 offset:12288
    v_sub_f32 v209, v209, v248
    v_mfma_f32_16x16x32_bf16 v[232:235], a[212:215], a[220:223], v[232:235]
    ds_read_b128 a[220:223], v243 offset:12288
    v_sub_f32 v210, v210, v248
    v_mfma_f32_16x16x32_bf16 v[236:239], a[148:151], a[228:231], v[236:239]
    v_exp_f32 v208, v208
    v_mfma_f32_16x16x32_bf16 v[228:231], a[168:171], a[224:227], 0
    v_exp_f32 v209, v209
    v_mfma_f32_16x16x32_bf16 v[228:231], a[172:175], a[228:231], v[228:231]
    s_waitcnt lgkmcnt(6)
    v_cvt_pk_bf16_f32 v232, v232, v233
    v_cvt_pk_bf16_f32 v233, v234, v235
    v_mfma_f32_16x16x32_bf16 v[236:239], a[152:155], a[232:235], v[236:239]
    ds_write_b64 v249, v[232:233] offset:256
    v_mfma_f32_16x16x32_bf16 v[228:231], a[176:179], a[232:235], v[228:231]
    s_waitcnt lgkmcnt(6)
    v_exp_f32 v210, v210
    v_mfma_f32_16x16x32_bf16 v[236:239], a[156:159], a[236:239], v[236:239]
    v_sub_f32 v211, v211, v248
    v_cvt_pk_bf16_f32 v189, v208, v209
    v_mfma_f32_16x16x32_bf16 v[228:231], a[180:183], a[236:239], v[228:231]
    s_waitcnt lgkmcnt(4)
    v_exp_f32 v211, v211
    v_mfma_f32_16x16x32_bf16 v[212:215], v[0:3], v[188:191], 0
    v_cvt_pk_bf16_f32 v192, v210, v211
    v_sub_f32 v196, v196, v248
    v_mfma_f32_16x16x32_bf16 v[216:219], v[30:33], v[188:191], 0
    ds_read_b128 v[208:211], v244 offset:320
    v_sub_f32 v197, v197, v248
    v_mfma_f32_16x16x32_bf16 v[220:223], v[60:63], v[188:191], 0
    v_exp_f32 v196, v196
    v_mfma_f32_16x16x32_bf16 v[224:227], a[248:251], v[188:191], 0
    v_exp_f32 v197, v197
    v_mfma_f32_16x16x32_bf16 v[236:239], a[160:163], a[240:243], v[236:239]
    s_waitcnt lgkmcnt(4)
    v_sub_f32 v198, v198, v248
    v_sub_f32 v199, v199, v248
    v_mfma_f32_16x16x32_bf16 v[236:239], a[164:167], a[244:247], v[236:239]
    v_exp_f32 v198, v198
    v_mfma_f32_16x16x32_bf16 v[228:231], a[184:187], a[240:243], v[228:231]
    v_exp_f32 v199, v199
    v_mfma_f32_16x16x32_bf16 v[228:231], a[188:191], a[244:247], v[228:231]
    v_cvt_pk_bf16_f32 v180, v196, v197
    v_cvt_pk_bf16_f32 v183, v198, v199
    v_mfma_f32_16x16x32_bf16 v[232:235], a[192:195], a[224:227], 0
    ds_read_b128 a[224:227], v242 offset:12416
    v_cvt_pk_bf16_f32 v236, v236, v237
    v_mfma_f32_16x16x32_bf16 v[232:235], a[196:199], a[228:231], v[232:235]
    ds_read_b128 a[228:231], v243 offset:12416
    v_cvt_pk_bf16_f32 v237, v238, v239
    v_mfma_f32_16x16x32_bf16 v[232:235], a[200:203], a[232:235], v[232:235]
    ds_write_b64 v249, v[236:237] offset:6144
    v_mfma_f32_16x16x32_bf16 v[232:235], a[204:207], a[236:239], v[232:235]
    ds_read_b128 a[232:235], v242 offset:12544
    v_cvt_pk_bf16_f32 v228, v228, v229
    v_mfma_f32_16x16x32_bf16 v[232:235], a[208:211], a[240:243], v[232:235]
    ds_read_b128 a[236:239], v243 offset:12544
    v_cvt_pk_bf16_f32 v229, v230, v231
    v_mfma_f32_16x16x32_bf16 v[232:235], a[212:215], a[244:247], v[232:235]
    s_waitcnt lgkmcnt(5)
    v_add_u32 v242, 0xfffe9800, v242
    v_add_u32 v243, 0xfffe9800, v243
    v_mfma_f32_16x16x32_bf16 v[208:211], v[150:153], v[168:171], v[208:211]
    ds_write_b64 v249, v[228:229] offset:6272
    v_mfma_f32_16x16x32_bf16 v[208:211], v[152:155], v[170:173], v[208:211]
    ds_read_b128 a[240:243], v242 offset:6144
    ds_read_b128 a[244:247], v243 offset:6144
    v_mfma_f32_16x16x32_bf16 v[236:239], a[144:147], a[216:219], 0
    ds_read_b128 v[196:199], v245 offset:320
    v_cvt_pk_bf16_f32 v232, v232, v233
    v_mfma_f32_16x16x32_bf16 v[236:239], a[148:151], a[220:223], v[236:239]
    s_waitcnt lgkmcnt(8)
    v_cvt_pk_bf16_f32 v233, v234, v235
    v_sub_f32 v200, v200, v248
    v_mfma_f32_16x16x32_bf16 v[236:239], a[152:155], a[224:227], v[236:239]
    ds_write_b64 v249, v[232:233] offset:6400
    v_mfma_f32_16x16x32_bf16 v[228:231], a[168:171], a[216:219], 0
    s_waitcnt lgkmcnt(8)
    v_exp_f32 v200, v200
    v_mfma_f32_16x16x32_bf16 v[236:239], a[156:159], a[228:231], v[236:239]
    s_waitcnt lgkmcnt(6)
    v_sub_f32 v201, v201, v248
    v_sub_f32 v202, v202, v248
    v_mfma_f32_16x16x32_bf16 v[236:239], a[160:163], a[232:235], v[236:239]
    s_waitcnt lgkmcnt(5)
    v_exp_f32 v201, v201
    v_mfma_f32_16x16x32_bf16 v[236:239], a[164:167], a[236:239], v[236:239]
    v_exp_f32 v202, v202
    v_mfma_f32_16x16x32_bf16 v[228:231], a[172:175], a[220:223], v[228:231]
    v_sub_f32 v203, v203, v248
    v_cvt_pk_bf16_f32 v194, v200, v201
    v_mfma_f32_16x16x32_bf16 v[228:231], a[176:179], a[224:227], v[228:231]
    v_exp_f32 v203, v203
    v_mfma_f32_16x16x32_bf16 v[228:231], a[180:183], a[228:231], v[228:231]
    s_waitcnt lgkmcnt(1)
    v_cvt_pk_bf16_f32 v236, v236, v237
    v_cvt_pk_bf16_f32 v237, v238, v239
    v_mfma_f32_16x16x32_bf16 v[196:199], v[162:165], v[168:171], v[196:199]
    ds_write_b64 v249, v[236:237] offset:12288
    v_mfma_f32_16x16x32_bf16 v[196:199], v[164:167], v[170:173], v[196:199]
    v_cvt_pk_bf16_f32 v181, v202, v203
    v_sub_f32 v204, v204, v248
    v_mfma_f32_16x16x32_bf16 v[228:231], a[184:187], a[232:235], v[228:231]
    ds_read_b128 v[200:203], v246 offset:320
    v_sub_f32 v205, v205, v248
    v_mfma_f32_16x16x32_bf16 v[228:231], a[188:191], a[236:239], v[228:231]
    v_exp_f32 v204, v204
    v_mfma_f32_16x16x32_bf16 v[232:235], a[192:195], a[216:219], 0
    ds_read_b128 a[216:219], v242 offset:6272
    v_sub_f32 v206, v206, v248
    v_mfma_f32_16x16x32_bf16 v[232:235], a[196:199], a[220:223], v[232:235]
    ds_read_b128 a[220:223], v243 offset:6272
    v_sub_f32 v207, v207, v248
    v_mfma_f32_16x16x32_bf16 v[232:235], a[200:203], a[224:227], v[232:235]
    ds_read_b128 a[224:227], v242 offset:6400
    v_cvt_pk_bf16_f32 v228, v228, v229
    v_mfma_f32_16x16x32_bf16 v[232:235], a[204:207], a[228:231], v[232:235]
    ds_read_b128 a[228:231], v243 offset:6400
    v_cvt_pk_bf16_f32 v229, v230, v231
    v_mfma_f32_16x16x32_bf16 v[232:235], a[208:211], a[232:235], v[232:235]
    ds_write_b64 v249, v[228:229] offset:12416
    v_mfma_f32_16x16x32_bf16 v[232:235], a[212:215], a[236:239], v[232:235]
    ds_read_b128 a[232:235], v240 offset:6144
    ds_read_b128 a[236:239], v241 offset:6144
    v_mfma_f32_16x16x32_bf16 v[236:239], a[144:147], a[240:243], 0
    s_waitcnt lgkmcnt(7)
    v_exp_f32 v205, v205
    v_mfma_f32_16x16x32_bf16 v[200:203], v[102:105], v[168:171], v[200:203]
    ds_read_b64 v[168:169], v247 offset:36864
    v_cvt_pk_bf16_f32 v195, v204, v205
    v_mfma_f32_16x16x32_bf16 v[200:203], v[104:107], v[170:173], v[200:203]
    ds_read_b64 v[170:171], v247 offset:36992
    v_cvt_pk_bf16_f32 v232, v232, v233
    v_mfma_f32_16x16x32_bf16 v[212:215], v[4:7], v[192:195], v[212:215]
    ds_read_b64 v[172:173], v247 offset:37120
    v_cvt_pk_bf16_f32 v233, v234, v235
    v_mfma_f32_16x16x32_bf16 v[216:219], v[34:37], v[192:195], v[216:219]
    ds_write_b64 v249, v[232:233] offset:12544
    v_mfma_f32_16x16x32_bf16 v[220:223], v[64:67], v[192:195], v[220:223]
    v_exp_f32 v206, v206
    v_mfma_f32_16x16x32_bf16 v[224:227], a[248:251], v[192:195], v[224:227]
    v_exp_f32 v207, v207
    v_mfma_f32_16x16x32_bf16 v[236:239], a[148:151], a[244:247], v[236:239]
    s_waitcnt lgkmcnt(10)
    v_cvt_pk_bf16_f32 v182, v206, v207
    v_sub_f32 v208, v208, v248
    v_mfma_f32_16x16x32_bf16 v[236:239], a[152:155], a[216:219], v[236:239]
    ds_read_b128 v[204:207], v244 offset:0
    v_sub_f32 v209, v209, v248
    v_mfma_f32_16x16x32_bf16 v[212:215], v[8:11], v[180:183], v[212:215]
    s_waitcnt lgkmcnt(9)
    v_exp_f32 v208, v208
    v_mfma_f32_16x16x32_bf16 v[216:219], v[38:41], v[180:183], v[216:219]
    v_exp_f32 v209, v209
    v_mfma_f32_16x16x32_bf16 v[220:223], v[68:71], v[180:183], v[220:223]
    v_cvt_pk_bf16_f32 v186, v208, v209
    v_sub_f32 v196, v196, v248
    v_mfma_f32_16x16x32_bf16 v[224:227], a[248:251], v[180:183], v[224:227]
    ds_read_b128 v[208:211], v245 offset:0
    s_waitcnt lgkmcnt(2)
    v_mfma_f32_16x16x32_bf16 v[236:239], a[156:159], a[220:223], v[236:239]
    s_barrier
    ds_read_b128 a[252:255], v252 offset:0
    v_mfma_f32_16x16x32_bf16 v[236:239], a[160:163], a[224:227], v[236:239]
    ds_read_b64 v[254:255], v253 offset:256
    v_sub_f32 v197, v197, v248
    v_mfma_f32_16x16x32_bf16 v[236:239], a[164:167], a[228:231], v[236:239]
    v_exp_f32 v196, v196
    v_mfma_f32_16x16x32_bf16 v[228:231], a[168:171], a[240:243], 0
    v_exp_f32 v197, v197
    v_mfma_f32_16x16x32_bf16 v[228:231], a[172:175], a[244:247], v[228:231]
    s_waitcnt lgkmcnt(3)
    v_cvt_pk_bf16_f32 v184, v196, v197
    v_sub_f32 v200, v200, v248
    v_mfma_f32_16x16x32_bf16 v[204:207], v[144:147], v[174:177], v[204:207]
    ds_read_b128 v[196:199], v246 offset:0
    v_cvt_pk_bf16_f32 v236, v236, v237
    v_mfma_f32_16x16x32_bf16 v[204:207], v[146:149], v[176:179], v[204:207]
    v_cvt_pk_bf16_f32 v237, v238, v239
    v_sub_f32 v201, v201, v248
    v_mfma_f32_16x16x32_bf16 v[228:231], a[176:179], a[216:219], v[228:231]
    ds_write_b64 v249, v[236:237] offset:18432
    v_mfma_f32_16x16x32_bf16 v[228:231], a[180:183], a[220:223], v[228:231]
    s_waitcnt lgkmcnt(4)
    s_waitcnt lgkmcnt(3)
    v_mfma_f32_16x16x32_bf16 v[208:211], v[96:99], v[174:177], v[208:211]
    buffer_store_dwordx4 a[252:255], v250, s[20:23], s55 offen nt
    v_mfma_f32_16x16x32_bf16 v[208:211], v[98:101], v[176:179], v[208:211]
    s_waitcnt lgkmcnt(2)
    ds_read_b128 a[252:255], v252 offset:6144
    v_mfma_f32_16x16x32_bf16 v[228:231], a[184:187], a[224:227], v[228:231]
    v_exp_f32 v200, v200
    v_mfma_f32_16x16x32_bf16 v[228:231], a[188:191], a[228:231], v[228:231]
    buffer_store_dwordx2 v[254:255], v251, s[20:23], s55 offen offset:256 nt
    v_mfma_f32_16x16x32_bf16 v[232:235], a[192:195], a[240:243], 0
    ds_read_b128 a[240:243], v240 offset:6272
    ds_read_b64 v[254:255], v253 offset:6400
    v_mfma_f32_16x16x32_bf16 v[232:235], a[196:199], a[244:247], v[232:235]
    ds_read_b128 a[244:247], v241 offset:6272
    s_mul_i32 s55, s31, 3
    v_mfma_f32_16x16x32_bf16 v[232:235], a[200:203], a[216:219], v[232:235]
    ds_read_b128 a[216:219], v240 offset:6400
    v_cvt_pk_bf16_f32 v228, v228, v229
    v_mfma_f32_16x16x32_bf16 v[232:235], a[204:207], a[220:223], v[232:235]
    ds_read_b128 a[220:223], v241 offset:6400
    v_cvt_pk_bf16_f32 v229, v230, v231
    v_mfma_f32_16x16x32_bf16 v[232:235], a[208:211], a[224:227], v[232:235]
    ds_write_b64 v249, v[228:229] offset:18560
    v_mfma_f32_16x16x32_bf16 v[232:235], a[212:215], a[228:231], v[232:235]
    ds_read_b128 a[224:227], v242 offset:12288
    ds_read_b128 a[228:231], v243 offset:12288
    v_mfma_f32_16x16x32_bf16 v[236:239], a[0:3], a[232:235], 0
    s_waitcnt lgkmcnt(8)
    s_add_u32 s54, s54, s55
    s_add_u32 s54, s54, s32
    v_mfma_f32_16x16x32_bf16 v[196:199], v[132:135], v[174:177], v[196:199]
    buffer_store_dwordx4 a[252:255], v250, s[20:23], s57 offen nt
    v_mfma_f32_16x16x32_bf16 v[196:199], v[134:137], v[176:179], v[196:199]
    s_waitcnt lgkmcnt(6)
    v_cvt_pk_bf16_f32 v232, v232, v233
    v_cvt_pk_bf16_f32 v233, v234, v235
    v_mfma_f32_16x16x32_bf16 v[236:239], a[4:7], a[236:239], v[236:239]
    ds_write_b64 v249, v[232:233] offset:18688
    v_mfma_f32_16x16x32_bf16 v[236:239], a[8:11], a[240:243], v[236:239]
    buffer_store_dwordx2 v[254:255], v251, s[20:23], s57 offen offset:256 nt
    v_mfma_f32_16x16x32_bf16 v[228:231], a[24:27], a[232:235], 0
    ds_read_b128 a[252:255], v252 offset:12288
    ds_read_b64 v[254:255], v253 offset:12544
    v_mfma_f32_16x16x32_bf16 v[228:231], a[28:31], a[236:239], v[228:231]
    s_mul_i32 s57, s31, 7
    s_add_u32 s56, s56, s57
    s_add_u32 s56, s56, s32
    v_mfma_f32_16x16x32_bf16 v[228:231], a[32:35], a[240:243], v[228:231]
    s_add_u32 s55, s28, 7
    s_mul_i32 s55, s55, s30
    s_add_u32 s57, s28, 11
    v_mfma_f32_16x16x32_bf16 v[232:235], a[48:51], a[232:235], 0
    s_mul_i32 s57, s57, s30
    v_exp_f32 v201, v201
    v_mfma_f32_16x16x32_bf16 v[232:235], a[52:55], a[236:239], v[232:235]
    s_waitcnt lgkmcnt(6)
    v_cvt_pk_bf16_f32 v185, v200, v201
    v_max_f32 v248, v204, v205
    v_mfma_f32_16x16x32_bf16 v[236:239], a[12:15], a[244:247], v[236:239]
    ds_read_b128 v[200:203], v244 offset:64
    v_max3_f32 v248, v248, v206, v207
    v_mfma_f32_16x16x32_bf16 v[212:215], v[12:15], v[184:187], v[212:215]
    ds_read_b128 v[204:207], v245 offset:64
    v_max3_f32 v248, v248, v208, v209
    v_mfma_f32_16x16x32_bf16 v[216:219], v[42:45], v[184:187], v[216:219]
    v_max3_f32 v248, v248, v210, v211
    v_max3_f32 v248, v248, v196, v197
    v_mfma_f32_16x16x32_bf16 v[220:223], v[72:75], v[184:187], v[220:223]
    ds_read_b128 v[208:211], v246 offset:64
    s_waitcnt lgkmcnt(4)
    v_mfma_f32_16x16x32_bf16 v[224:227], a[248:251], v[184:187], v[224:227]
    buffer_store_dwordx4 a[252:255], v250, s[20:23], s52 offen nt
    v_mfma_f32_16x16x32_bf16 v[236:239], a[16:19], a[216:219], v[236:239]
    s_waitcnt lgkmcnt(3)
    v_max3_f32 v248, v248, v198, v199
    v_mfma_f32_16x16x32_bf16 v[236:239], a[20:23], a[220:223], v[236:239]
    ds_read_b128 v[196:199], v244 offset:128
    v_mfma_f32_16x16x32_bf16 v[228:231], a[36:39], a[244:247], v[228:231]
    buffer_store_dwordx2 v[254:255], v251, s[20:23], s52 offen offset:256 nt
    v_mfma_f32_16x16x32_bf16 v[228:231], a[40:43], a[216:219], v[228:231]
    s_mul_i32 s52, s31, 11
    s_add_u32 s51, s51, s52
    s_add_u32 s51, s51, s32
    v_mfma_f32_16x16x32_bf16 v[228:231], a[44:47], a[220:223], v[228:231]
    s_add_u32 s52, s28, 11
    s_mul_i32 s52, s52, s30
    s_waitcnt lgkmcnt(2)
    v_mfma_f32_16x16x32_bf16 v[200:203], v[150:153], v[174:177], v[200:203]
    v_rcp_f32 v225, v224
    v_mfma_f32_16x16x32_bf16 v[200:203], v[152:155], v[176:179], v[200:203]
    s_waitcnt lgkmcnt(1)
    v_mul_f32 v212, v212, v225
    v_mul_f32 v213, v213, v225
    v_mfma_f32_16x16x32_bf16 v[204:207], v[162:165], v[174:177], v[204:207]
    v_mul_f32 v214, v214, v225
    v_mul_f32 v215, v215, v225
    v_mfma_f32_16x16x32_bf16 v[204:207], v[164:167], v[176:179], v[204:207]
    v_cvt_pk_bf16_f32 v212, v212, v213
    v_cvt_pk_bf16_f32 v213, v214, v215
    v_mfma_f32_16x16x32_bf16 v[208:211], v[102:105], v[174:177], v[208:211]
    ds_write_b64 v247, v[212:213] offset:24576
    v_mfma_f32_16x16x32_bf16 v[208:211], v[104:107], v[176:179], v[208:211]
    s_waitcnt lgkmcnt(1)
    v_mul_f32 v216, v216, v225
    v_mul_f32 v217, v217, v225
    v_mfma_f32_16x16x32_bf16 v[196:199], v[156:159], v[174:177], v[196:199]
    v_mul_f32 v218, v218, v225
    v_mul_f32 v219, v219, v225
    v_mfma_f32_16x16x32_bf16 v[196:199], v[158:161], v[176:179], v[196:199]
    v_cvt_pk_bf16_f32 v216, v216, v217
    v_cvt_pk_bf16_f32 v217, v218, v219
    v_mfma_f32_16x16x32_bf16 v[232:235], a[56:59], a[240:243], v[232:235]
    ds_write_b64 v247, v[216:217] offset:24704
    v_mfma_f32_16x16x32_bf16 v[232:235], a[60:63], a[244:247], v[232:235]
    v_mul_f32 v220, v220, v225
    v_mul_f32 v221, v221, v225
    v_mfma_f32_16x16x32_bf16 v[232:235], a[64:67], a[216:219], v[232:235]
    v_mul_f32 v222, v222, v225
    v_mul_f32 v223, v223, v225
    v_mfma_f32_16x16x32_bf16 v[232:235], a[68:71], a[220:223], v[232:235]
    v_cvt_pk_bf16_f32 v220, v220, v221
    v_cvt_pk_bf16_f32 v221, v222, v223
    ds_write_b64 v247, v[220:221] offset:24832
    v_max3_f32 v248, v248, v200, v201
    v_max3_f32 v248, v248, v202, v203
    ds_read_b128 v[200:203], v245 offset:128
    v_max3_f32 v248, v248, v204, v205
    v_max3_f32 v248, v248, v206, v207
    ds_read_b128 v[204:207], v246 offset:128
    v_max3_f32 v248, v248, v208, v209
    v_max3_f32 v248, v248, v210, v211
    ds_read_b128 v[208:211], v244 offset:0
    v_max3_f32 v248, v248, v196, v197
    ds_read_b128 v[196:199], v245 offset:0
    s_waitcnt lgkmcnt(3)
    v_mfma_f32_16x16x32_bf16 v[200:203], v[114:117], v[174:177], v[200:203]
    v_mfma_f32_16x16x32_bf16 v[200:203], v[116:119], v[176:179], v[200:203]
    s_waitcnt lgkmcnt(2)
    v_mfma_f32_16x16x32_bf16 v[204:207], v[138:141], v[174:177], v[204:207]
    s_waitcnt lgkmcnt(1)
    v_mfma_f32_16x16x32_bf16 v[204:207], v[140:143], v[176:179], v[204:207]
    s_waitcnt lgkmcnt(0)
    v_mfma_f32_16x16x32_bf16 v[208:211], v[144:147], v[174:177], v[208:211]
    v_cvt_pk_bf16_f32 v144, v236, v237
    v_cvt_pk_bf16_f32 v145, v238, v239
    v_mfma_f32_16x16x32_bf16 v[208:211], v[146:149], v[176:179], v[208:211]
    v_cvt_pk_bf16_f32 v146, v228, v229
    v_cvt_pk_bf16_f32 v147, v230, v231
    v_mfma_f32_16x16x32_bf16 v[196:199], v[96:99], v[174:177], v[196:199]
    v_cvt_pk_bf16_f32 v148, v232, v233
    v_cvt_pk_bf16_f32 v149, v234, v235
    v_mfma_f32_16x16x32_bf16 v[196:199], v[98:101], v[176:179], v[196:199]
    v_max3_f32 v248, v248, v200, v201
    v_max3_f32 v248, v248, v204, v205
    v_mfma_f32_16x16x32_bf16 v[236:239], a[232:235], a[72:75], 0
    ds_read_b128 v[200:203], v246 offset:0
    ds_read_b128 v[204:207], v244 offset:64
    v_mfma_f32_16x16x32_bf16 v[236:239], a[236:239], a[76:79], v[236:239]
    v_mov_b32 v225, v248
    v_mfma_f32_16x16x32_bf16 v[236:239], a[240:243], a[80:83], v[236:239]
    v_mfma_f32_16x16x32_bf16 v[236:239], a[244:247], a[84:87], v[236:239]
    v_permlane16_swap_b32 v248, v225
    v_max_f32 v248, v248, v225
    v_mfma_f32_16x16x32_bf16 v[236:239], a[216:219], a[88:91], v[236:239]
    v_mov_b32 v225, v248
    v_mfma_f32_16x16x32_bf16 v[236:239], a[220:223], a[92:95], v[236:239]
    v_mfma_f32_16x16x32_bf16 v[228:231], a[232:235], a[96:99], 0
    v_permlane32_swap_b32 v248, v225
    v_max_f32 v248, v248, v225
    v_mfma_f32_16x16x32_bf16 v[228:231], a[236:239], a[100:103], v[228:231]
    v_sub_f32 v208, v208, v248
    v_sub_f32 v209, v209, v248
    v_mfma_f32_16x16x32_bf16 v[228:231], a[240:243], a[104:107], v[228:231]
    v_exp_f32 v208, v208
    v_mfma_f32_16x16x32_bf16 v[228:231], a[244:247], a[108:111], v[228:231]
    s_waitcnt lgkmcnt(1)
    v_cvt_pk_bf16_f32 v25, v236, v237
    v_cvt_pk_bf16_f32 v28, v238, v239
    v_mfma_f32_16x16x32_bf16 v[200:203], v[132:135], v[174:177], v[200:203]
    s_waitcnt lgkmcnt(0)
    v_exp_f32 v209, v209
    v_mfma_f32_16x16x32_bf16 v[200:203], v[134:137], v[176:179], v[200:203]
    v_sub_f32 v210, v210, v248
    v_sub_f32 v211, v211, v248
    v_mfma_f32_16x16x32_bf16 v[204:207], v[150:153], v[174:177], v[204:207]
    v_exp_f32 v210, v210
    v_mfma_f32_16x16x32_bf16 v[204:207], v[152:155], v[176:179], v[204:207]
    v_exp_f32 v211, v211
    v_mfma_f32_16x16x32_bf16 v[228:231], a[216:219], a[112:115], v[228:231]
    v_cvt_pk_bf16_f32 v190, v208, v209
    v_cvt_pk_bf16_f32 v193, v210, v211
    v_mfma_f32_16x16x32_bf16 v[228:231], a[220:223], a[116:119], v[228:231]
    ds_read_b128 v[208:211], v245 offset:64
    v_sub_f32 v196, v196, v248
    v_mfma_f32_16x16x32_bf16 v[232:235], a[232:235], a[120:123], 0
    ds_read_b128 a[232:235], v242 offset:12416
    v_sub_f32 v197, v197, v248
    v_mfma_f32_16x16x32_bf16 v[232:235], a[236:239], a[124:127], v[232:235]
    ds_read_b128 a[236:239], v243 offset:12416
    v_sub_f32 v198, v198, v248
    v_mfma_f32_16x16x32_bf16 v[232:235], a[240:243], a[128:131], v[232:235]
    v_cvt_pk_bf16_f32 v55, v228, v229
    v_cvt_pk_bf16_f32 v58, v230, v231
    v_mfma_f32_16x16x32_bf16 v[232:235], a[244:247], a[132:135], v[232:235]
    ds_read_b128 a[240:243], v242 offset:12544
    ds_read_b128 a[244:247], v243 offset:12544
    v_mfma_f32_16x16x32_bf16 v[232:235], a[216:219], a[136:139], v[232:235]
    ds_read_b128 a[216:219], v242 offset:18432
    v_sub_f32 v199, v199, v248
    v_mfma_f32_16x16x32_bf16 v[232:235], a[220:223], a[140:143], v[232:235]
    ds_read_b128 a[220:223], v243 offset:18432
    v_sub_f32 v200, v200, v248
    v_mfma_f32_16x16x32_bf16 v[236:239], a[144:147], a[224:227], 0
    v_exp_f32 v196, v196
    v_mfma_f32_16x16x32_bf16 v[236:239], a[148:151], a[228:231], v[236:239]
    v_exp_f32 v197, v197
    v_mfma_f32_16x16x32_bf16 v[228:231], a[168:171], a[224:227], 0
    s_waitcnt lgkmcnt(6)
    v_cvt_pk_bf16_f32 v85, v232, v233
    v_cvt_pk_bf16_f32 v88, v234, v235
    v_mfma_f32_16x16x32_bf16 v[208:211], v[162:165], v[174:177], v[208:211]
    s_waitcnt lgkmcnt(5)
    v_exp_f32 v198, v198
    v_mfma_f32_16x16x32_bf16 v[208:211], v[164:167], v[176:179], v[208:211]
    v_exp_f32 v199, v199
    v_mfma_f32_16x16x32_bf16 v[236:239], a[152:155], a[232:235], v[236:239]
    s_waitcnt lgkmcnt(4)
    v_cvt_pk_bf16_f32 v188, v196, v197
    v_cvt_pk_bf16_f32 v191, v198, v199
    v_mfma_f32_16x16x32_bf16 v[236:239], a[156:159], a[236:239], v[236:239]
    ds_read_b128 v[196:199], v246 offset:64
    v_sub_f32 v201, v201, v248
    v_mfma_f32_16x16x32_bf16 v[228:231], a[172:175], a[228:231], v[228:231]
    s_waitcnt lgkmcnt(4)
    v_exp_f32 v200, v200
    v_mfma_f32_16x16x32_bf16 v[236:239], a[160:163], a[240:243], v[236:239]
    s_waitcnt lgkmcnt(3)
    v_exp_f32 v201, v201
    v_mfma_f32_16x16x32_bf16 v[236:239], a[164:167], a[244:247], v[236:239]
    v_sub_f32 v202, v202, v248
    v_sub_f32 v203, v203, v248
    v_mfma_f32_16x16x32_bf16 v[228:231], a[176:179], a[232:235], v[228:231]
    v_exp_f32 v202, v202
    v_mfma_f32_16x16x32_bf16 v[228:231], a[180:183], a[236:239], v[228:231]
    v_exp_f32 v203, v203
    v_mfma_f32_16x16x32_bf16 v[228:231], a[184:187], a[240:243], v[228:231]
    v_cvt_pk_bf16_f32 v189, v200, v201
    v_cvt_pk_bf16_f32 v236, v236, v237
    v_mfma_f32_16x16x32_bf16 v[228:231], a[188:191], a[244:247], v[228:231]
    v_cvt_pk_bf16_f32 v237, v238, v239
    v_cvt_pk_bf16_f32 v192, v202, v203
    v_mfma_f32_16x16x32_bf16 v[212:215], v[6:9], v[188:191], 0
    ds_write_b64 v249, v[236:237] offset:24576
    v_mfma_f32_16x16x32_bf16 v[216:219], v[36:39], v[188:191], 0
    ds_read_b128 v[200:203], v244 offset:128
    v_sub_f32 v204, v204, v248
    v_mfma_f32_16x16x32_bf16 v[220:223], v[66:69], v[188:191], 0
    s_waitcnt lgkmcnt(2)
    v_cvt_pk_bf16_f32 v228, v228, v229
    v_cvt_pk_bf16_f32 v229, v230, v231
    v_mfma_f32_16x16x32_bf16 v[224:227], a[248:251], v[188:191], 0
    ds_write_b64 v249, v[228:229] offset:24704
    v_mfma_f32_16x16x32_bf16 v[196:199], v[102:105], v[174:177], v[196:199]
    v_exp_f32 v204, v204
    v_mfma_f32_16x16x32_bf16 v[196:199], v[104:107], v[176:179], v[196:199]
    v_sub_f32 v205, v205, v248
    v_sub_f32 v206, v206, v248
    v_mfma_f32_16x16x32_bf16 v[232:235], a[192:195], a[224:227], 0
    ds_read_b128 a[224:227], v242 offset:18560
    v_sub_f32 v207, v207, v248
    v_mfma_f32_16x16x32_bf16 v[232:235], a[196:199], a[228:231], v[232:235]
    ds_read_b128 a[228:231], v243 offset:18560
    v_sub_f32 v208, v208, v248
    v_mfma_f32_16x16x32_bf16 v[232:235], a[200:203], a[232:235], v[232:235]
    ds_read_b128 a[232:235], v242 offset:18688
    v_sub_f32 v209, v209, v248
    v_mfma_f32_16x16x32_bf16 v[232:235], a[204:207], a[236:239], v[232:235]
    ds_read_b128 a[236:239], v243 offset:18688
    v_sub_f32 v210, v210, v248
    v_mfma_f32_16x16x32_bf16 v[232:235], a[208:211], a[240:243], v[232:235]
    ds_read_b128 a[240:243], v242 offset:0
    v_sub_f32 v211, v211, v248
    v_mfma_f32_16x16x32_bf16 v[232:235], a[212:215], a[244:247], v[232:235]
    ds_read_b128 a[244:247], v243 offset:0
    v_sub_f32 v196, v196, v248
    v_mfma_f32_16x16x32_bf16 v[236:239], a[144:147], a[216:219], 0
    s_waitcnt lgkmcnt(7)
    v_exp_f32 v205, v205
    v_mfma_f32_16x16x32_bf16 v[200:203], v[156:159], v[174:177], v[200:203]
    v_exp_f32 v206, v206
    v_mfma_f32_16x16x32_bf16 v[200:203], v[158:161], v[176:179], v[200:203]
    v_cvt_pk_bf16_f32 v232, v232, v233
    v_cvt_pk_bf16_f32 v233, v234, v235
    v_mfma_f32_16x16x32_bf16 v[236:239], a[148:151], a[220:223], v[236:239]
    ds_write_b64 v249, v[232:233] offset:24832
    v_mfma_f32_16x16x32_bf16 v[228:231], a[168:171], a[216:219], 0
    s_waitcnt lgkmcnt(6)
    v_exp_f32 v207, v207
    v_mfma_f32_16x16x32_bf16 v[236:239], a[152:155], a[224:227], v[236:239]
    s_waitcnt lgkmcnt(5)
    v_cvt_pk_bf16_f32 v180, v204, v205
    v_cvt_pk_bf16_f32 v183, v206, v207
    v_mfma_f32_16x16x32_bf16 v[236:239], a[156:159], a[228:231], v[236:239]
    ds_read_b128 v[204:207], v245 offset:128
    v_sub_f32 v197, v197, v248
    v_mfma_f32_16x16x32_bf16 v[228:231], a[172:175], a[220:223], v[228:231]
    s_waitcnt lgkmcnt(5)
    v_exp_f32 v208, v208
    v_mfma_f32_16x16x32_bf16 v[236:239], a[160:163], a[232:235], v[236:239]
    s_waitcnt lgkmcnt(4)
    v_exp_f32 v209, v209
    v_mfma_f32_16x16x32_bf16 v[236:239], a[164:167], a[236:239], v[236:239]
    v_exp_f32 v210, v210
    v_mfma_f32_16x16x32_bf16 v[228:231], a[176:179], a[224:227], v[228:231]
    v_exp_f32 v211, v211
    v_mfma_f32_16x16x32_bf16 v[228:231], a[180:183], a[228:231], v[228:231]
    s_waitcnt lgkmcnt(1)
    s_barrier
    v_cvt_pk_bf16_f32 v194, v208, v209
    v_mfma_f32_16x16x32_bf16 v[228:231], a[184:187], a[232:235], v[228:231]
    ds_read_b128 a[252:255], v252 offset:18432
    v_cvt_pk_bf16_f32 v236, v236, v237
    v_mfma_f32_16x16x32_bf16 v[228:231], a[188:191], a[236:239], v[228:231]
    ds_read_b64 v[254:255], v253 offset:18688
    v_cvt_pk_bf16_f32 v237, v238, v239
    v_mfma_f32_16x16x32_bf16 v[232:235], a[192:195], a[216:219], 0
    ds_write_b64 v249, v[236:237] offset:0
    v_mfma_f32_16x16x32_bf16 v[232:235], a[196:199], a[220:223], v[232:235]
    ds_read_b128 a[216:219], v242 offset:128
    ds_read_b128 a[220:223], v243 offset:128
    v_mfma_f32_16x16x32_bf16 v[232:235], a[200:203], a[224:227], v[232:235]
    ds_read_b128 a[224:227], v242 offset:256
    v_cvt_pk_bf16_f32 v228, v228, v229
    v_mfma_f32_16x16x32_bf16 v[232:235], a[204:207], a[228:231], v[232:235]
    ds_read_b128 a[228:231], v243 offset:256
    v_cvt_pk_bf16_f32 v229, v230, v231
    v_mfma_f32_16x16x32_bf16 v[232:235], a[208:211], a[232:235], v[232:235]
    ds_write_b64 v249, v[228:229] offset:128
    v_mfma_f32_16x16x32_bf16 v[232:235], a[212:215], a[236:239], v[232:235]
    ds_read_b128 a[232:235], v242 offset:24576
    ds_read_b128 a[236:239], v243 offset:24576
    v_mfma_f32_16x16x32_bf16 v[236:239], a[144:147], a[240:243], 0
    s_waitcnt lgkmcnt(9)
    v_cvt_pk_bf16_f32 v181, v210, v211
    s_waitcnt lgkmcnt(8)
    v_mfma_f32_16x16x32_bf16 v[204:207], v[114:117], v[174:177], v[204:207]
    ds_read_b128 v[208:211], v246 offset:128
    v_cvt_pk_bf16_f32 v232, v232, v233
    v_mfma_f32_16x16x32_bf16 v[204:207], v[116:119], v[176:179], v[204:207]
    v_cvt_pk_bf16_f32 v233, v234, v235
    v_sub_f32 v198, v198, v248
    v_mfma_f32_16x16x32_bf16 v[236:239], a[148:151], a[244:247], v[236:239]
    ds_write_b64 v249, v[232:233] offset:256
    v_mfma_f32_16x16x32_bf16 v[228:231], a[168:171], a[240:243], 0
    buffer_store_dwordx4 a[252:255], v250, s[20:23], s54 offen nt
    v_mfma_f32_16x16x32_bf16 v[228:231], a[172:175], a[244:247], v[228:231]
    s_waitcnt lgkmcnt(8)
    ds_read_b128 a[252:255], v252 offset:24576
    v_mfma_f32_16x16x32_bf16 v[236:239], a[152:155], a[216:219], v[236:239]
    s_waitcnt lgkmcnt(8)
    v_exp_f32 v196, v196
    v_mfma_f32_16x16x32_bf16 v[236:239], a[156:159], a[220:223], v[236:239]
    buffer_store_dwordx2 v[254:255], v251, s[20:23], s54 offen offset:256 nt
    v_mfma_f32_16x16x32_bf16 v[228:231], a[176:179], a[216:219], v[228:231]
    ds_read_b64 v[254:255], v253 offset:24832
    s_mul_i32 s54, s31, 15
    v_mfma_f32_16x16x32_bf16 v[228:231], a[180:183], a[220:223], v[228:231]
    s_add_u32 s53, s53, s54
    s_add_u32 s53, s53, s32
    s_add_u32 s54, s28, 11
    v_mfma_f32_16x16x32_bf16 v[232:235], a[192:195], a[240:243], 0
    ds_read_b128 a[240:243], v242 offset:24704
    s_mul_i32 s54, s54, s30
    v_mfma_f32_16x16x32_bf16 v[232:235], a[196:199], a[244:247], v[232:235]
    ds_read_b128 a[244:247], v243 offset:24704
    v_sub_f32 v199, v199, v248
    v_mfma_f32_16x16x32_bf16 v[232:235], a[200:203], a[216:219], v[232:235]
    ds_read_b128 a[216:219], v242 offset:24832
    v_sub_f32 v200, v200, v248
    v_mfma_f32_16x16x32_bf16 v[232:235], a[204:207], a[220:223], v[232:235]
    s_waitcnt lgkmcnt(6)
    ds_read_b128 a[220:223], v243 offset:24832
    v_mfma_f32_16x16x32_bf16 v[208:211], v[138:141], v[174:177], v[208:211]
    s_waitcnt lgkmcnt(5)
    ds_read_b64 v[174:175], v247 offset:43008
    v_mfma_f32_16x16x32_bf16 v[208:211], v[140:143], v[176:179], v[208:211]
    buffer_store_dwordx4 a[252:255], v250, s[20:23], s56 offen nt
    v_mfma_f32_16x16x32_bf16 v[236:239], a[160:163], a[224:227], v[236:239]
    s_waitcnt lgkmcnt(5)
    ds_read_b64 v[176:177], v247 offset:43136
    v_mfma_f32_16x16x32_bf16 v[236:239], a[164:167], a[228:231], v[236:239]
    ds_read_b64 v[178:179], v247 offset:43264
    v_sub_f32 v201, v201, v248
    v_mfma_f32_16x16x32_bf16 v[228:231], a[184:187], a[224:227], v[228:231]
    buffer_store_dwordx2 v[254:255], v251, s[20:23], s56 offen offset:256 nt
    v_mfma_f32_16x16x32_bf16 v[228:231], a[188:191], a[228:231], v[228:231]
    s_mul_i32 s56, s31, 13
    s_add_u32 s55, s55, s56
    s_add_u32 s55, s55, s32
    v_mfma_f32_16x16x32_bf16 v[232:235], a[208:211], a[224:227], v[232:235]
    s_add_u32 s56, s28, 11
    v_cvt_pk_bf16_f32 v236, v236, v237
    v_cvt_pk_bf16_f32 v237, v238, v239
    v_mfma_f32_16x16x32_bf16 v[232:235], a[212:215], a[228:231], v[232:235]
    ds_write_b64 v249, v[236:237] offset:6144
    v_cvt_pk_bf16_f32 v228, v228, v229
    v_cvt_pk_bf16_f32 v229, v230, v231
    ds_write_b64 v249, v[228:229] offset:6272
    s_mul_i32 s56, s56, s30
    v_exp_f32 v197, v197
    v_exp_f32 v198, v198
    v_exp_f32 v199, v199
    v_cvt_pk_bf16_f32 v232, v232, v233
    v_cvt_pk_bf16_f32 v233, v234, v235
    ds_write_b64 v249, v[232:233] offset:6400
    v_cvt_pk_bf16_f32 v195, v196, v197
    v_cvt_pk_bf16_f32 v182, v198, v199
    ds_read_b128 v[196:199], v244 offset:0
    v_mfma_f32_16x16x32_bf16 v[212:215], v[10:13], v[192:195], v[212:215]
    v_exp_f32 v200, v200
    v_mfma_f32_16x16x32_bf16 v[216:219], v[40:43], v[192:195], v[216:219]
    v_exp_f32 v201, v201
    v_mfma_f32_16x16x32_bf16 v[220:223], v[70:73], v[192:195], v[220:223]
    v_cvt_pk_bf16_f32 v186, v200, v201
    v_sub_f32 v204, v204, v248
    v_mfma_f32_16x16x32_bf16 v[224:227], a[248:251], v[192:195], v[224:227]
    ds_read_b128 v[200:203], v245 offset:0
    v_sub_f32 v205, v205, v248
    v_mfma_f32_16x16x32_bf16 v[212:215], v[14:17], v[180:183], v[212:215]
    v_exp_f32 v204, v204
    v_mfma_f32_16x16x32_bf16 v[216:219], v[44:47], v[180:183], v[216:219]
    v_exp_f32 v205, v205
    v_mfma_f32_16x16x32_bf16 v[220:223], v[74:77], v[180:183], v[220:223]
    v_cvt_pk_bf16_f32 v184, v204, v205
    v_sub_f32 v208, v208, v248
    v_mfma_f32_16x16x32_bf16 v[224:227], a[248:251], v[180:183], v[224:227]
    ds_read_b128 v[204:207], v246 offset:0
    s_waitcnt lgkmcnt(2)
    v_mfma_f32_16x16x32_bf16 v[196:199], v[150:153], v[168:171], v[196:199]
    v_exp_f32 v208, v208
    v_mfma_f32_16x16x32_bf16 v[196:199], v[152:155], v[170:173], v[196:199]
    v_sub_f32 v209, v209, v248
    v_exp_f32 v209, v209
    s_nop 0
    v_cvt_pk_bf16_f32 v185, v208, v209
    ds_read_b128 v[208:211], v244 offset:64
    s_waitcnt lgkmcnt(2)
    v_mfma_f32_16x16x32_bf16 v[212:215], v[18:21], v[184:187], v[212:215]
    v_mfma_f32_16x16x32_bf16 v[216:219], v[48:51], v[184:187], v[216:219]
    v_max_f32 v248, v196, v197
    v_max3_f32 v248, v248, v198, v199
    v_mfma_f32_16x16x32_bf16 v[220:223], v[78:81], v[184:187], v[220:223]
    ds_read_b128 v[196:199], v245 offset:64
    v_mfma_f32_16x16x32_bf16 v[224:227], a[248:251], v[184:187], v[224:227]
    v_mfma_f32_16x16x32_bf16 v[200:203], v[162:165], v[168:171], v[200:203]
    s_waitcnt lgkmcnt(2)
    v_mfma_f32_16x16x32_bf16 v[200:203], v[164:167], v[170:173], v[200:203]
    v_mfma_f32_16x16x32_bf16 v[204:207], v[102:105], v[168:171], v[204:207]
    v_mfma_f32_16x16x32_bf16 v[204:207], v[104:107], v[170:173], v[204:207]
    s_nop 2
    s_waitcnt lgkmcnt(1)
    v_mfma_f32_16x16x32_bf16 v[208:211], v[156:159], v[168:171], v[208:211]
    v_rcp_f32 v225, v224
    v_mfma_f32_16x16x32_bf16 v[208:211], v[158:161], v[170:173], v[208:211]
    v_mul_f32 v212, v212, v225
    v_mul_f32 v213, v213, v225
    v_mul_f32 v214, v214, v225
    s_waitcnt lgkmcnt(0)
    v_mfma_f32_16x16x32_bf16 v[196:199], v[114:117], v[168:171], v[196:199]
    v_mul_f32 v215, v215, v225
    v_cvt_pk_bf16_f32 v212, v212, v213
    v_mfma_f32_16x16x32_bf16 v[196:199], v[116:119], v[170:173], v[196:199]
    v_cvt_pk_bf16_f32 v213, v214, v215
    ds_write_b64 v247, v[212:213] offset:30720
    v_mul_f32 v216, v216, v225
    v_mul_f32 v217, v217, v225
    v_mul_f32 v218, v218, v225
    v_mul_f32 v219, v219, v225
    v_cvt_pk_bf16_f32 v216, v216, v217
    v_cvt_pk_bf16_f32 v217, v218, v219
    ds_write_b64 v247, v[216:217] offset:30848
    v_mul_f32 v220, v220, v225
    v_mul_f32 v221, v221, v225
    v_mul_f32 v222, v222, v225
    v_mul_f32 v223, v223, v225
    v_cvt_pk_bf16_f32 v220, v220, v221
    v_cvt_pk_bf16_f32 v221, v222, v223
    ds_write_b64 v247, v[220:221] offset:30976
    v_max3_f32 v248, v248, v200, v201
    v_max3_f32 v248, v248, v202, v203
    ds_read_b128 v[200:203], v246 offset:64
    v_max3_f32 v248, v248, v204, v205
    v_max3_f32 v248, v248, v206, v207
    ds_read_b128 v[204:207], v244 offset:128
    v_max3_f32 v248, v248, v208, v209
    v_max3_f32 v248, v248, v210, v211
    ds_read_b128 v[208:211], v245 offset:128
    v_max3_f32 v248, v248, v196, v197
    v_max3_f32 v248, v248, v198, v199
    ds_read_b128 v[196:199], v246 offset:128
    s_waitcnt lgkmcnt(3)
    v_mfma_f32_16x16x32_bf16 v[200:203], v[138:141], v[168:171], v[200:203]
    v_mfma_f32_16x16x32_bf16 v[200:203], v[140:143], v[170:173], v[200:203]
    s_waitcnt lgkmcnt(2)
    v_mfma_f32_16x16x32_bf16 v[204:207], v[108:111], v[168:171], v[204:207]
    s_waitcnt lgkmcnt(1)
    v_mfma_f32_16x16x32_bf16 v[204:207], v[110:113], v[170:173], v[204:207]
    v_mfma_f32_16x16x32_bf16 v[208:211], v[120:123], v[168:171], v[208:211]
    s_waitcnt lgkmcnt(0)
    v_mfma_f32_16x16x32_bf16 v[208:211], v[122:125], v[170:173], v[208:211]
    v_mfma_f32_16x16x32_bf16 v[196:199], v[144:147], v[168:171], v[196:199]
    v_max3_f32 v248, v248, v200, v201
    v_max3_f32 v248, v248, v202, v203
    v_mfma_f32_16x16x32_bf16 v[196:199], v[146:149], v[170:173], v[196:199]
    ds_read_b128 v[200:203], v244 offset:0
    v_max3_f32 v248, v248, v204, v205
    ds_read_b128 v[204:207], v245 offset:0
    s_nop 0
    v_max3_f32 v248, v248, v208, v209
    ds_read_b128 v[208:211], v246 offset:0
    s_nop 1
    v_max3_f32 v248, v248, v196, v197
    ds_read_b128 v[196:199], v244 offset:64
    v_mov_b32 v225, v248
    s_nop 1
    v_permlane16_swap_b32 v248, v225
    v_max_f32 v248, v248, v225
    v_mov_b32 v225, v248
    s_nop 1
    v_permlane32_swap_b32 v248, v225
    v_max_f32 v248, v248, v225
    s_waitcnt lgkmcnt(3)
    v_mfma_f32_16x16x32_bf16 v[200:203], v[150:153], v[168:171], v[200:203]
    v_mfma_f32_16x16x32_bf16 v[200:203], v[152:155], v[170:173], v[200:203]
    s_waitcnt lgkmcnt(2)
    v_mfma_f32_16x16x32_bf16 v[204:207], v[162:165], v[168:171], v[204:207]
    s_waitcnt lgkmcnt(1)
    v_mfma_f32_16x16x32_bf16 v[204:207], v[164:167], v[170:173], v[204:207]
    v_mfma_f32_16x16x32_bf16 v[208:211], v[102:105], v[168:171], v[208:211]
    s_waitcnt lgkmcnt(0)
    v_mfma_f32_16x16x32_bf16 v[208:211], v[104:107], v[170:173], v[208:211]
    v_mfma_f32_16x16x32_bf16 v[196:199], v[156:159], v[168:171], v[196:199]
    v_sub_f32 v200, v200, v248
    v_sub_f32 v201, v201, v248
    v_mfma_f32_16x16x32_bf16 v[196:199], v[158:161], v[170:173], v[196:199]
    v_exp_f32 v200, v200
    v_exp_f32 v201, v201
    v_sub_f32 v202, v202, v248
    v_exp_f32 v202, v202
    v_sub_f32 v203, v203, v248
    v_exp_f32 v203, v203
    v_cvt_pk_bf16_f32 v190, v200, v201
    v_cvt_pk_bf16_f32 v193, v202, v203
    ds_read_b128 v[200:203], v245 offset:64
    v_sub_f32 v204, v204, v248
    v_exp_f32 v204, v204
    v_sub_f32 v205, v205, v248
    v_exp_f32 v205, v205
    v_sub_f32 v206, v206, v248
    v_exp_f32 v206, v206
    v_sub_f32 v207, v207, v248
    v_exp_f32 v207, v207
    v_cvt_pk_bf16_f32 v188, v204, v205
    v_cvt_pk_bf16_f32 v191, v206, v207
    ds_read_b128 v[204:207], v246 offset:64
    v_sub_f32 v208, v208, v248
    v_exp_f32 v208, v208
    v_sub_f32 v209, v209, v248
    v_exp_f32 v209, v209
    v_sub_f32 v210, v210, v248
    v_exp_f32 v210, v210
    v_sub_f32 v211, v211, v248
    v_exp_f32 v211, v211
    v_cvt_pk_bf16_f32 v189, v208, v209
    v_cvt_pk_bf16_f32 v192, v210, v211
    s_waitcnt lgkmcnt(1)
    v_mfma_f32_16x16x32_bf16 v[212:215], v[12:15], v[188:191], 0
    ds_read_b128 v[208:211], v244 offset:128
    v_sub_f32 v196, v196, v248
    v_mfma_f32_16x16x32_bf16 v[216:219], v[42:45], v[188:191], 0
    v_exp_f32 v196, v196
    v_mfma_f32_16x16x32_bf16 v[220:223], v[72:75], v[188:191], 0
    v_sub_f32 v197, v197, v248
    v_sub_f32 v198, v198, v248
    v_mfma_f32_16x16x32_bf16 v[224:227], a[248:251], v[188:191], 0
    v_exp_f32 v197, v197
    v_mfma_f32_16x16x32_bf16 v[200:203], v[114:117], v[168:171], v[200:203]
    s_waitcnt lgkmcnt(1)
    v_exp_f32 v198, v198
    v_mfma_f32_16x16x32_bf16 v[200:203], v[116:119], v[170:173], v[200:203]
    v_sub_f32 v199, v199, v248
    v_cvt_pk_bf16_f32 v180, v196, v197
    v_mfma_f32_16x16x32_bf16 v[204:207], v[138:141], v[168:171], v[204:207]
    v_exp_f32 v199, v199
    v_mfma_f32_16x16x32_bf16 v[204:207], v[140:143], v[170:173], v[204:207]
    v_cvt_pk_bf16_f32 v183, v198, v199
    ds_read_b128 v[196:199], v245 offset:128
    s_waitcnt lgkmcnt(1)
    v_mfma_f32_16x16x32_bf16 v[208:211], v[108:111], v[168:171], v[208:211]
    v_sub_f32 v200, v200, v248
    v_sub_f32 v201, v201, v248
    v_mfma_f32_16x16x32_bf16 v[208:211], v[110:113], v[170:173], v[208:211]
    v_exp_f32 v200, v200
    v_exp_f32 v201, v201
    v_sub_f32 v202, v202, v248
    v_exp_f32 v202, v202
    v_sub_f32 v203, v203, v248
    v_exp_f32 v203, v203
    v_cvt_pk_bf16_f32 v194, v200, v201
    v_cvt_pk_bf16_f32 v181, v202, v203
    ds_read_b128 v[200:203], v246 offset:128
    v_sub_f32 v204, v204, v248
    v_exp_f32 v204, v204
    v_sub_f32 v205, v205, v248
    v_exp_f32 v205, v205
    v_sub_f32 v206, v206, v248
    v_exp_f32 v206, v206
    s_waitcnt lgkmcnt(1)
    v_mfma_f32_16x16x32_bf16 v[196:199], v[120:123], v[168:171], v[196:199]
    v_sub_f32 v207, v207, v248
    v_cvt_pk_bf16_f32 v195, v204, v205
    v_mfma_f32_16x16x32_bf16 v[196:199], v[122:125], v[170:173], v[196:199]
    v_exp_f32 v207, v207
    v_mfma_f32_16x16x32_bf16 v[212:215], v[16:19], v[192:195], v[212:215]
    v_cvt_pk_bf16_f32 v182, v206, v207
    v_sub_f32 v208, v208, v248
    v_mfma_f32_16x16x32_bf16 v[216:219], v[46:49], v[192:195], v[216:219]
    ds_read_b128 v[204:207], v244 offset:0
    v_sub_f32 v209, v209, v248
    v_mfma_f32_16x16x32_bf16 v[220:223], v[76:79], v[192:195], v[220:223]
    v_exp_f32 v208, v208
    v_mfma_f32_16x16x32_bf16 v[224:227], a[248:251], v[192:195], v[224:227]
    s_waitcnt lgkmcnt(1)
    v_exp_f32 v209, v209
    v_mfma_f32_16x16x32_bf16 v[212:215], v[20:23], v[180:183], v[212:215]
    v_cvt_pk_bf16_f32 v186, v208, v209
    v_sub_f32 v196, v196, v248
    v_mfma_f32_16x16x32_bf16 v[216:219], v[50:53], v[180:183], v[216:219]
    ds_read_b128 v[208:211], v245 offset:0
    v_sub_f32 v197, v197, v248
    v_mfma_f32_16x16x32_bf16 v[220:223], v[80:83], v[180:183], v[220:223]
    v_exp_f32 v196, v196
    v_mfma_f32_16x16x32_bf16 v[224:227], a[248:251], v[180:183], v[224:227]
    v_exp_f32 v197, v197
    v_mfma_f32_16x16x32_bf16 v[200:203], v[144:147], v[168:171], v[200:203]
    ds_read_b64 v[168:169], v247 offset:49152
    v_cvt_pk_bf16_f32 v184, v196, v197
    v_mfma_f32_16x16x32_bf16 v[200:203], v[146:149], v[170:173], v[200:203]
    ds_read_b128 v[196:199], v246 offset:0
    s_waitcnt lgkmcnt(3)
    v_mfma_f32_16x16x32_bf16 v[204:207], v[156:159], v[174:177], v[204:207]
    ds_read_b64 v[170:171], v247 offset:49280
    ds_read_b64 v[172:173], v247 offset:49408
    v_mfma_f32_16x16x32_bf16 v[204:207], v[158:161], v[176:179], v[204:207]
    s_nop 1
    v_sub_f32 v200, v200, v248
    v_exp_f32 v200, v200
    v_sub_f32 v201, v201, v248
    v_exp_f32 v201, v201
    s_nop 0
    s_waitcnt lgkmcnt(4)
    v_mfma_f32_16x16x32_bf16 v[208:211], v[114:117], v[174:177], v[208:211]
    v_cvt_pk_bf16_f32 v185, v200, v201
    v_max_f32 v248, v204, v205
    v_mfma_f32_16x16x32_bf16 v[208:211], v[116:119], v[176:179], v[208:211]
    ds_read_b128 v[200:203], v244 offset:64
    v_max3_f32 v248, v248, v206, v207
    v_mfma_f32_16x16x32_bf16 v[212:215], v[24:27], v[184:187], v[212:215]
    ds_read_b128 v[204:207], v245 offset:64
    v_mfma_f32_16x16x32_bf16 v[216:219], v[54:57], v[184:187], v[216:219]
    v_mfma_f32_16x16x32_bf16 v[220:223], v[84:87], v[184:187], v[220:223]
    s_waitcnt lgkmcnt(4)
    v_mfma_f32_16x16x32_bf16 v[224:227], a[248:251], v[184:187], v[224:227]
    v_max3_f32 v248, v248, v208, v209
    v_max3_f32 v248, v248, v210, v211
    v_mfma_f32_16x16x32_bf16 v[196:199], v[138:141], v[174:177], v[196:199]
    ds_read_b128 v[208:211], v246 offset:64
    v_mov_b32 v186, 0
    v_mfma_f32_16x16x32_bf16 v[196:199], v[140:143], v[176:179], v[196:199]
    s_nop 1
    v_rcp_f32 v225, v224
    s_nop 0
    v_mul_f32 v212, v212, v225
    v_mul_f32 v213, v213, v225
    v_mul_f32 v214, v214, v225
    v_mul_f32 v215, v215, v225
    s_waitcnt lgkmcnt(2)
    v_mfma_f32_16x16x32_bf16 v[200:203], v[108:111], v[174:177], v[200:203]
    v_cvt_pk_bf16_f32 v212, v212, v213
    v_cvt_pk_bf16_f32 v213, v214, v215
    v_mfma_f32_16x16x32_bf16 v[200:203], v[110:113], v[176:179], v[200:203]
    s_waitcnt lgkmcnt(1)
    v_mul_f32 v216, v216, v225
    v_mul_f32 v217, v217, v225
    v_mfma_f32_16x16x32_bf16 v[204:207], v[120:123], v[174:177], v[204:207]
    ds_write_b64 v247, v[212:213] offset:36864
    v_mfma_f32_16x16x32_bf16 v[204:207], v[122:125], v[176:179], v[204:207]
    v_mul_f32 v218, v218, v225
    v_mul_f32 v219, v219, v225
    v_cvt_pk_bf16_f32 v216, v216, v217
    v_cvt_pk_bf16_f32 v217, v218, v219
    s_waitcnt lgkmcnt(1)
    v_mfma_f32_16x16x32_bf16 v[208:211], v[144:147], v[174:177], v[208:211]
    ds_write_b64 v247, v[216:217] offset:36992
    v_mfma_f32_16x16x32_bf16 v[208:211], v[146:149], v[176:179], v[208:211]
    v_mul_f32 v220, v220, v225
    v_mul_f32 v221, v221, v225
    v_mul_f32 v222, v222, v225
    v_mul_f32 v223, v223, v225
    v_cvt_pk_bf16_f32 v220, v220, v221
    v_cvt_pk_bf16_f32 v221, v222, v223
    ds_write_b64 v247, v[220:221] offset:37120
    v_max3_f32 v248, v248, v196, v197
    v_max3_f32 v248, v248, v198, v199
    ds_read_b128 v[196:199], v244 offset:0
    v_max3_f32 v248, v248, v200, v201
    v_max3_f32 v248, v248, v202, v203
    ds_read_b128 v[200:203], v245 offset:0
    v_max3_f32 v248, v248, v204, v205
    v_max3_f32 v248, v248, v206, v207
    ds_read_b128 v[204:207], v246 offset:0
    v_max3_f32 v248, v248, v208, v209
    v_max3_f32 v248, v248, v210, v211
    ds_read_b128 v[208:211], v244 offset:64
    v_mov_b32 v225, v248
    s_nop 1
    v_permlane16_swap_b32 v248, v225
    v_max_f32 v248, v248, v225
    v_mov_b32 v225, v248
    s_nop 1
    v_permlane32_swap_b32 v248, v225
    v_max_f32 v248, v248, v225
    s_waitcnt lgkmcnt(3)
    v_mfma_f32_16x16x32_bf16 v[196:199], v[156:159], v[174:177], v[196:199]
    v_mfma_f32_16x16x32_bf16 v[196:199], v[158:161], v[176:179], v[196:199]
    s_waitcnt lgkmcnt(2)
    v_mfma_f32_16x16x32_bf16 v[200:203], v[114:117], v[174:177], v[200:203]
    s_waitcnt lgkmcnt(1)
    v_mfma_f32_16x16x32_bf16 v[200:203], v[116:119], v[176:179], v[200:203]
    v_mfma_f32_16x16x32_bf16 v[204:207], v[138:141], v[174:177], v[204:207]
    s_waitcnt lgkmcnt(0)
    v_mfma_f32_16x16x32_bf16 v[204:207], v[140:143], v[176:179], v[204:207]
    v_mfma_f32_16x16x32_bf16 v[208:211], v[108:111], v[174:177], v[208:211]
    v_sub_f32 v196, v196, v248
    v_sub_f32 v197, v197, v248
    v_mfma_f32_16x16x32_bf16 v[208:211], v[110:113], v[176:179], v[208:211]
    v_exp_f32 v196, v196
    v_exp_f32 v197, v197
    v_sub_f32 v198, v198, v248
    v_exp_f32 v198, v198
    v_sub_f32 v199, v199, v248
    v_exp_f32 v199, v199
    v_cvt_pk_bf16_f32 v190, v196, v197
    v_cvt_pk_bf16_f32 v193, v198, v199
    ds_read_b128 v[196:199], v245 offset:64
    v_sub_f32 v200, v200, v248
    v_exp_f32 v200, v200
    v_sub_f32 v201, v201, v248
    v_exp_f32 v201, v201
    v_sub_f32 v202, v202, v248
    v_exp_f32 v202, v202
    v_sub_f32 v203, v203, v248
    v_exp_f32 v203, v203
    v_cvt_pk_bf16_f32 v188, v200, v201
    v_cvt_pk_bf16_f32 v191, v202, v203
    ds_read_b128 v[200:203], v246 offset:64
    v_sub_f32 v204, v204, v248
    v_exp_f32 v204, v204
    v_sub_f32 v205, v205, v248
    v_exp_f32 v205, v205
    v_sub_f32 v206, v206, v248
    v_exp_f32 v206, v206
    v_sub_f32 v207, v207, v248
    v_exp_f32 v207, v207
    v_cvt_pk_bf16_f32 v189, v204, v205
    v_cvt_pk_bf16_f32 v192, v206, v207
    s_waitcnt lgkmcnt(1)
    v_mfma_f32_16x16x32_bf16 v[212:215], v[18:21], v[188:191], 0
    v_sub_f32 v208, v208, v248
    v_sub_f32 v209, v209, v248
    v_mfma_f32_16x16x32_bf16 v[216:219], v[48:51], v[188:191], 0
    v_exp_f32 v208, v208
    v_mfma_f32_16x16x32_bf16 v[220:223], v[78:81], v[188:191], 0
    v_exp_f32 v209, v209
    v_mfma_f32_16x16x32_bf16 v[224:227], a[248:251], v[188:191], 0
    v_sub_f32 v210, v210, v248
    v_sub_f32 v211, v211, v248
    v_mfma_f32_16x16x32_bf16 v[196:199], v[120:123], v[174:177], v[196:199]
    s_waitcnt lgkmcnt(0)
    v_exp_f32 v210, v210
    v_mfma_f32_16x16x32_bf16 v[196:199], v[122:125], v[176:179], v[196:199]
    v_exp_f32 v211, v211
    v_mfma_f32_16x16x32_bf16 v[200:203], v[144:147], v[174:177], v[200:203]
    ds_read_b64 v[174:175], v247 offset:55296
    v_cvt_pk_bf16_f32 v180, v208, v209
    v_mfma_f32_16x16x32_bf16 v[200:203], v[146:149], v[176:179], v[200:203]
    ds_read_b64 v[176:177], v247 offset:55424
    ds_read_b64 v[178:179], v247 offset:55552
    v_cvt_pk_bf16_f32 v183, v210, v211
    v_sub_f32 v196, v196, v248
    v_exp_f32 v196, v196
    v_sub_f32 v197, v197, v248
    v_exp_f32 v197, v197
    v_sub_f32 v198, v198, v248
    v_exp_f32 v198, v198
    v_sub_f32 v199, v199, v248
    v_exp_f32 v199, v199
    v_cvt_pk_bf16_f32 v194, v196, v197
    v_cvt_pk_bf16_f32 v181, v198, v199
    v_sub_f32 v200, v200, v248
    v_exp_f32 v200, v200
    v_sub_f32 v201, v201, v248
    v_exp_f32 v201, v201
    v_sub_f32 v202, v202, v248
    v_exp_f32 v202, v202
    v_sub_f32 v203, v203, v248
    v_exp_f32 v203, v203
    v_cvt_pk_bf16_f32 v195, v200, v201
    v_cvt_pk_bf16_f32 v182, v202, v203
    v_mov_b32 v204, 0x237c0
    v_mfma_f32_16x16x32_bf16 v[212:215], v[22:25], v[192:195], v[212:215]
    v_add_u32 v205, 0xfffff900, v245
    v_cndmask_b32 v205, v244, v205, vcc
    v_mfma_f32_16x16x32_bf16 v[216:219], v[52:55], v[192:195], v[216:219]
    s_mov_b32 vcc_lo, 0xff00ff00
    v_add_u32 v206, 0xc0, v205
    v_add_u32 v205, 0x340, v205
    v_mfma_f32_16x16x32_bf16 v[220:223], v[82:85], v[192:195], v[220:223]
    s_mov_b32 vcc_hi, 0xff00ff00
    v_cndmask_b32 v244, v206, v205, vcc
    v_add_u32 v245, 0x700, v244
    v_mfma_f32_16x16x32_bf16 v[224:227], a[248:251], v[192:195], v[224:227]
    s_mov_b32 vcc_lo, 0xf0f0
    s_mov_b32 vcc_hi, 0x0
    v_cndmask_b32 v244, v244, v204, vcc
    v_mfma_f32_16x16x32_bf16 v[212:215], v[26:29], v[180:183], v[212:215]
    ds_read_b128 v[196:199], v244 offset:64
    s_mov_b32 vcc_lo, 0x0
    v_mfma_f32_16x16x32_bf16 v[216:219], v[56:59], v[180:183], v[216:219]
    s_mov_b32 vcc_hi, 0xf0f0000
    v_cndmask_b32 v245, v245, v204, vcc
    v_mov_b32 v189, 0
    v_mfma_f32_16x16x32_bf16 v[220:223], v[86:89], v[180:183], v[220:223]
    ds_read_b128 v[204:207], v244 offset:0
    ds_read_b128 v[208:211], v245 offset:0
    v_mfma_f32_16x16x32_bf16 v[224:227], a[248:251], v[180:183], v[224:227]
    ds_read_b128 v[200:203], v245 offset:64
    v_mov_b32 v192, 0
    v_mov_b32 v195, 0
    v_mov_b32 v182, 0
    s_mov_b32 vcc_lo, 0xff000f
    s_mov_b32 vcc_hi, 0xff00ff
    s_nop 1
    v_rcp_f32 v225, v224
    s_nop 0
    v_mul_f32 v212, v212, v225
    v_mul_f32 v213, v213, v225
    v_mul_f32 v214, v214, v225
    v_mul_f32 v215, v215, v225
    v_cvt_pk_bf16_f32 v212, v212, v213
    v_cvt_pk_bf16_f32 v213, v214, v215
    ds_write_b64 v247, v[212:213] offset:43008
    s_waitcnt lgkmcnt(4)
    v_mfma_f32_16x16x32_bf16 v[196:199], v[96:99], v[168:171], v[196:199]
    v_mul_f32 v216, v216, v225
    v_mul_f32 v217, v217, v225
    v_mfma_f32_16x16x32_bf16 v[196:199], v[98:101], v[170:173], v[196:199]
    s_waitcnt lgkmcnt(3)
    v_mul_f32 v218, v218, v225
    v_mul_f32 v219, v219, v225
    v_mfma_f32_16x16x32_bf16 v[204:207], v[90:93], v[168:171], v[204:207]
    s_waitcnt lgkmcnt(2)
    v_cvt_pk_bf16_f32 v216, v216, v217
    v_cvt_pk_bf16_f32 v217, v218, v219
    v_mfma_f32_16x16x32_bf16 v[204:207], v[92:95], v[170:173], v[204:207]
    ds_write_b64 v247, v[216:217] offset:43136
    v_mfma_f32_16x16x32_bf16 v[208:211], v[126:129], v[168:171], v[208:211]
    s_waitcnt lgkmcnt(2)
    v_mul_f32 v220, v220, v225
    v_mul_f32 v221, v221, v225
    v_mfma_f32_16x16x32_bf16 v[208:211], v[128:131], v[170:173], v[208:211]
    v_mul_f32 v222, v222, v225
    v_mul_f32 v223, v223, v225
    v_mfma_f32_16x16x32_bf16 v[200:203], v[132:135], v[168:171], v[200:203]
    v_cvt_pk_bf16_f32 v220, v220, v221
    v_cvt_pk_bf16_f32 v221, v222, v223
    v_mfma_f32_16x16x32_bf16 v[200:203], v[134:137], v[170:173], v[200:203]
    ds_write_b64 v247, v[220:221] offset:43264
    v_mfma_f32_16x16x32_bf16 v[236:239], a[144:147], a[232:235], 0
    v_max_f32 v248, v204, v205
    v_max3_f32 v248, v248, v206, v207
    v_mfma_f32_16x16x32_bf16 v[236:239], a[148:151], a[236:239], v[236:239]
    ds_read_b128 v[204:207], v244 offset:128
    v_max3_f32 v248, v248, v208, v209
    v_mfma_f32_16x16x32_bf16 v[236:239], a[152:155], a[240:243], v[236:239]
    v_max3_f32 v248, v248, v210, v211
    v_max3_f32 v248, v248, v196, v197
    v_mfma_f32_16x16x32_bf16 v[236:239], a[156:159], a[244:247], v[236:239]
    ds_read_b128 v[208:211], v245 offset:128
    v_max3_f32 v248, v248, v198, v199
    v_mfma_f32_16x16x32_bf16 v[236:239], a[160:163], a[216:219], v[236:239]
    ds_read_b128 v[196:199], v244 offset:192
    v_max3_f32 v248, v248, v200, v201
    v_mfma_f32_16x16x32_bf16 v[236:239], a[164:167], a[220:223], v[236:239]
    v_max3_f32 v248, v248, v202, v203
    v_mfma_f32_16x16x32_bf16 v[228:231], a[168:171], a[232:235], 0
    ds_read_b128 v[200:203], v245 offset:192
    v_mfma_f32_16x16x32_bf16 v[228:231], a[172:175], a[236:239], v[228:231]
    v_mfma_f32_16x16x32_bf16 v[228:231], a[176:179], a[240:243], v[228:231]
    v_mfma_f32_16x16x32_bf16 v[228:231], a[180:183], a[244:247], v[228:231]
    v_mfma_f32_16x16x32_bf16 v[228:231], a[184:187], a[216:219], v[228:231]
    s_waitcnt lgkmcnt(3)
    v_cvt_pk_bf16_f32 v236, v236, v237
    v_cvt_pk_bf16_f32 v237, v238, v239
    v_mfma_f32_16x16x32_bf16 v[204:207], v[162:165], v[168:171], v[204:207]
    ds_write_b64 v249, v[236:237] offset:12288
    v_mfma_f32_16x16x32_bf16 v[204:207], v[164:167], v[170:173], v[204:207]
    s_waitcnt lgkmcnt(2)
    v_mfma_f32_16x16x32_bf16 v[208:211], v[102:105], v[168:171], v[208:211]
    v_mfma_f32_16x16x32_bf16 v[208:211], v[104:107], v[170:173], v[208:211]
    s_waitcnt lgkmcnt(1)
    v_mfma_f32_16x16x32_bf16 v[196:199], v[114:117], v[168:171], v[196:199]
    v_mfma_f32_16x16x32_bf16 v[196:199], v[116:119], v[170:173], v[196:199]
    v_mfma_f32_16x16x32_bf16 v[200:203], v[138:141], v[168:171], v[200:203]
    v_mfma_f32_16x16x32_bf16 v[200:203], v[140:143], v[170:173], v[200:203]
    v_max3_f32 v248, v248, v204, v205
    v_max3_f32 v248, v248, v206, v207
    v_mfma_f32_16x16x32_bf16 v[228:231], a[188:191], a[220:223], v[228:231]
    ds_read_b128 v[204:207], v244 offset:0
    v_max3_f32 v248, v248, v208, v209
    v_mfma_f32_16x16x32_bf16 v[232:235], a[192:195], a[232:235], 0
    v_max3_f32 v248, v248, v210, v211
    v_max3_f32 v248, v248, v196, v197
    v_mfma_f32_16x16x32_bf16 v[232:235], a[196:199], a[236:239], v[232:235]
    ds_read_b128 v[208:211], v245 offset:0
    ds_read_b128 v[196:199], v244 offset:64
    v_mfma_f32_16x16x32_bf16 v[232:235], a[200:203], a[240:243], v[232:235]
    v_cvt_pk_bf16_f32 v228, v228, v229
    v_cvt_pk_bf16_f32 v229, v230, v231
    v_mfma_f32_16x16x32_bf16 v[232:235], a[204:207], a[244:247], v[232:235]
    ds_write_b64 v249, v[228:229] offset:12416
    v_mfma_f32_16x16x32_bf16 v[232:235], a[208:211], a[216:219], v[232:235]
    v_max3_f32 v248, v248, v200, v201
    v_mov_b32 v225, v248
    v_mfma_f32_16x16x32_bf16 v[232:235], a[212:215], a[220:223], v[232:235]
    ds_read_b128 v[200:203], v245 offset:64
    v_permlane16_swap_b32 v248, v225
    v_max_f32 v248, v248, v225
    v_mov_b32 v225, v248
    s_nop 1
    v_permlane32_swap_b32 v248, v225
    s_waitcnt lgkmcnt(4)
    v_mfma_f32_16x16x32_bf16 v[204:207], v[90:93], v[168:171], v[204:207]
    v_cvt_pk_bf16_f32 v232, v232, v233
    v_cvt_pk_bf16_f32 v233, v234, v235
    v_mfma_f32_16x16x32_bf16 v[204:207], v[92:95], v[170:173], v[204:207]
    ds_write_b64 v249, v[232:233] offset:12544
    s_waitcnt lgkmcnt(4)
    v_mfma_f32_16x16x32_bf16 v[208:211], v[126:129], v[168:171], v[208:211]
    s_waitcnt lgkmcnt(3)
    v_max_f32 v248, v248, v225
    v_mfma_f32_16x16x32_bf16 v[208:211], v[128:131], v[170:173], v[208:211]
    v_mfma_f32_16x16x32_bf16 v[196:199], v[96:99], v[168:171], v[196:199]
    v_mfma_f32_16x16x32_bf16 v[196:199], v[98:101], v[170:173], v[196:199]
    v_sub_f32 v204, v204, v248
    s_waitcnt lgkmcnt(1)
    v_mfma_f32_16x16x32_bf16 v[200:203], v[132:135], v[168:171], v[200:203]
    v_exp_f32 v204, v204
    v_mfma_f32_16x16x32_bf16 v[200:203], v[134:137], v[170:173], v[200:203]
    v_sub_f32 v205, v205, v248
    v_exp_f32 v205, v205
    v_sub_f32 v206, v206, v248
    v_exp_f32 v206, v206
    s_waitcnt lgkmcnt(0)
    s_barrier
    ds_read_b128 a[224:227], v242 offset:30720
    ds_read_b128 a[228:231], v243 offset:30720
    ds_read_b128 a[232:235], v242 offset:30848
    ds_read_b128 a[236:239], v243 offset:30848
    ds_read_b128 a[240:243], v242 offset:30976
    ds_read_b128 a[244:247], v243 offset:30976
    ds_read_b128 a[216:219], v242 offset:36864
    ds_read_b128 a[220:223], v243 offset:36864
    ds_read_b128 a[252:255], v252 offset:0
    ds_read_b64 v[254:255], v253 offset:256
    v_sub_f32 v207, v207, v248
    v_exp_f32 v207, v207
    v_cvt_pk_bf16_f32 v184, v204, v205
    v_cvt_pk_bf16_f32 v187, v206, v207
    ds_read_b128 v[204:207], v244 offset:128
    v_sub_f32 v208, v208, v248
    v_exp_f32 v208, v208
    v_sub_f32 v209, v209, v248
    v_exp_f32 v209, v209
    v_sub_f32 v210, v210, v248
    v_exp_f32 v210, v210
    v_sub_f32 v211, v211, v248
    v_exp_f32 v211, v211
    s_waitcnt lgkmcnt(10)
    v_mfma_f32_16x16x32_bf16 v[236:239], a[144:147], a[224:227], 0
    v_cvt_pk_bf16_f32 v185, v208, v209
    v_cvt_pk_bf16_f32 v188, v210, v211
    v_mfma_f32_16x16x32_bf16 v[228:231], a[168:171], a[224:227], 0
    ds_read_b128 v[208:211], v245 offset:128
    v_sub_f32 v196, v196, v248
    v_mfma_f32_16x16x32_bf16 v[212:215], v[0:3], v[184:187], 0
    s_waitcnt lgkmcnt(10)
    v_exp_f32 v196, v196
    v_mfma_f32_16x16x32_bf16 v[216:219], v[30:33], v[184:187], 0
    v_sub_f32 v197, v197, v248
    v_sub_f32 v198, v198, v248
    v_mfma_f32_16x16x32_bf16 v[220:223], v[60:63], v[184:187], 0
    v_exp_f32 v197, v197
    v_mfma_f32_16x16x32_bf16 v[224:227], a[248:251], v[184:187], 0
    v_exp_f32 v198, v198
    v_mfma_f32_16x16x32_bf16 v[236:239], a[148:151], a[228:231], v[236:239]
    s_waitcnt lgkmcnt(9)
    v_sub_f32 v199, v199, v248
    v_cvt_pk_bf16_f32 v190, v196, v197
    v_mfma_f32_16x16x32_bf16 v[236:239], a[152:155], a[232:235], v[236:239]
    s_waitcnt lgkmcnt(8)
    v_exp_f32 v199, v199
    v_mfma_f32_16x16x32_bf16 v[236:239], a[156:159], a[236:239], v[236:239]
    s_waitcnt lgkmcnt(2)
    v_cvt_pk_bf16_f32 v193, v198, v199
    v_sub_f32 v200, v200, v248
    v_mfma_f32_16x16x32_bf16 v[236:239], a[160:163], a[240:243], v[236:239]
    ds_read_b128 v[196:199], v244 offset:192
    v_sub_f32 v201, v201, v248
    v_mfma_f32_16x16x32_bf16 v[236:239], a[164:167], a[244:247], v[236:239]
    buffer_store_dwordx4 a[252:255], v250, s[20:23], s51 offen nt
    v_mfma_f32_16x16x32_bf16 v[228:231], a[172:175], a[228:231], v[228:231]
    s_waitcnt lgkmcnt(1)
    ds_read_b128 a[252:255], v252 offset:6144
    v_mfma_f32_16x16x32_bf16 v[204:207], v[162:165], v[168:171], v[204:207]
    v_exp_f32 v200, v200
    v_mfma_f32_16x16x32_bf16 v[204:207], v[164:167], v[170:173], v[204:207]
    buffer_store_dwordx2 v[254:255], v251, s[20:23], s51 offen offset:256 nt
    v_mfma_f32_16x16x32_bf16 v[208:211], v[102:105], v[168:171], v[208:211]
    ds_read_b64 v[254:255], v253 offset:6400
    v_cvt_pk_bf16_f32 v236, v236, v237
    v_mfma_f32_16x16x32_bf16 v[208:211], v[104:107], v[170:173], v[208:211]
    s_mul_i32 s51, s31, 3
    v_cvt_pk_bf16_f32 v237, v238, v239
    s_add_u32 s57, s57, s51
    v_mfma_f32_16x16x32_bf16 v[228:231], a[176:179], a[232:235], v[228:231]
    ds_write_b64 v249, v[236:237] offset:18432
    v_mfma_f32_16x16x32_bf16 v[228:231], a[180:183], a[236:239], v[228:231]
    s_add_u32 s57, s57, s32
    s_and_b32 s51, s28, 1
    s_add_u32 s51, s51, 15
    v_mfma_f32_16x16x32_bf16 v[228:231], a[184:187], a[240:243], v[228:231]
    s_mul_i32 s51, s51, s30
    v_exp_f32 v201, v201
    v_mfma_f32_16x16x32_bf16 v[228:231], a[188:191], a[244:247], v[228:231]
    s_waitcnt lgkmcnt(2)
    v_sub_f32 v202, v202, v248
    v_sub_f32 v203, v203, v248
    v_mfma_f32_16x16x32_bf16 v[196:199], v[114:117], v[168:171], v[196:199]
    s_mov_b32 exec_hi, 0
    buffer_store_dwordx4 a[252:255], v250, s[20:23], s53 offen nt
    s_mov_b32 exec_hi, -1
    v_mfma_f32_16x16x32_bf16 v[196:199], v[116:119], v[170:173], v[196:199]
    v_exp_f32 v202, v202
    v_mfma_f32_16x16x32_bf16 v[232:235], a[192:195], a[224:227], 0
    ds_read_b128 a[224:227], v242 offset:36992
    v_cvt_pk_bf16_f32 v228, v228, v229
    v_mfma_f32_16x16x32_bf16 v[232:235], a[196:199], a[228:231], v[232:235]
    ds_read_b128 a[228:231], v243 offset:36992
    v_cvt_pk_bf16_f32 v229, v230, v231
    v_mfma_f32_16x16x32_bf16 v[232:235], a[200:203], a[232:235], v[232:235]
    ds_write_b64 v249, v[228:229] offset:18560
    v_mfma_f32_16x16x32_bf16 v[232:235], a[204:207], a[236:239], v[232:235]
    ds_read_b128 a[232:235], v242 offset:37120
    ds_read_b128 a[236:239], v243 offset:37120
    v_mfma_f32_16x16x32_bf16 v[232:235], a[208:211], a[240:243], v[232:235]
    ds_read_b128 a[240:243], v242 offset:43008
    s_waitcnt lgkmcnt(7)
    v_mfma_f32_16x16x32_bf16 v[232:235], a[212:215], a[244:247], v[232:235]
    ds_read_b128 a[244:247], v243 offset:43008
    s_mov_b32 exec_hi, 0
    buffer_store_dwordx2 v[254:255], v251, s[20:23], s53 offen offset:256 nt
    s_mov_b32 exec_hi, -1
    s_mul_i32 s53, s31, 7
    s_add_u32 s52, s52, s53
    s_add_u32 s52, s52, s32
    s_lshr_b32 s53, s28, 1
    s_sub_u32 s53, s53, 1
    v_exp_f32 v203, v203
    v_cvt_pk_bf16_f32 v232, v232, v233
    v_cvt_pk_bf16_f32 v233, v234, v235
    ds_write_b64 v249, v[232:233] offset:18688
    s_mov_b32 exec_lo, 0
    buffer_store_dwordx4 a[252:255], v250, s[20:23], s55 offen nt
    s_mov_b32 exec_lo, -1
    v_cvt_pk_bf16_f32 v191, v200, v201
    v_cvt_pk_bf16_f32 v194, v202, v203
    ds_read_b128 v[200:203], v245 offset:192
    v_mfma_f32_16x16x32_bf16 v[212:215], v[4:7], v[188:191], v[212:215]
    ds_read_b128 a[252:255], v252 offset:12288
    v_sub_f32 v204, v204, v248
    v_mfma_f32_16x16x32_bf16 v[216:219], v[34:37], v[188:191], v[216:219]
    s_mov_b32 exec_lo, 0
    buffer_store_dwordx2 v[254:255], v251, s[20:23], s55 offen offset:256 nt
    s_mov_b32 exec_lo, -1
    v_mfma_f32_16x16x32_bf16 v[220:223], v[64:67], v[188:191], v[220:223]
    ds_read_b64 v[254:255], v253 offset:12544
    s_mul_i32 s55, s31, 11
    v_mfma_f32_16x16x32_bf16 v[224:227], a[248:251], v[188:191], v[224:227]
    s_add_u32 s54, s54, s55
    s_add_u32 s54, s54, s32
    s_lshr_b32 s55, s28, 1
    v_mfma_f32_16x16x32_bf16 v[212:215], v[8:11], v[192:195], v[212:215]
    s_lshl2_add_u32 s55, s55, 11
    s_mul_i32 s55, s55, s31
    v_sub_f32 v205, v205, v248
    v_mfma_f32_16x16x32_bf16 v[216:219], v[38:41], v[192:195], v[216:219]
    v_exp_f32 v204, v204
    v_mfma_f32_16x16x32_bf16 v[220:223], v[68:71], v[192:195], v[220:223]
    v_exp_f32 v205, v205
    v_mfma_f32_16x16x32_bf16 v[224:227], a[248:251], v[192:195], v[224:227]
    v_sub_f32 v206, v206, v248
    s_waitcnt lgkmcnt(2)
    v_mfma_f32_16x16x32_bf16 v[200:203], v[138:141], v[168:171], v[200:203]
    v_exp_f32 v206, v206
    v_mfma_f32_16x16x32_bf16 v[200:203], v[140:143], v[170:173], v[200:203]
    s_waitcnt lgkmcnt(1)
    buffer_store_dwordx4 a[252:255], v250, s[20:23], s57 offen nt
    s_waitcnt lgkmcnt(0)
    v_sub_f32 v207, v207, v248
    v_exp_f32 v207, v207
    v_cvt_pk_bf16_f32 v180, v204, v205
    v_cvt_pk_bf16_f32 v183, v206, v207
    v_sub_f32 v208, v208, v248
    v_exp_f32 v208, v208
    buffer_store_dwordx2 v[254:255], v251, s[20:23], s57 offen offset:256 nt
    s_mul_i32 s57, s31, 15
    s_add_u32 s56, s56, s57
    s_add_u32 s56, s56, s32
    v_sub_f32 v209, v209, v248
    v_exp_f32 v209, v209
    v_sub_f32 v210, v210, v248
    v_exp_f32 v210, v210
    v_sub_f32 v211, v211, v248
    v_exp_f32 v211, v211
    v_cvt_pk_bf16_f32 v181, v208, v209
    v_cvt_pk_bf16_f32 v184, v210, v211
    v_sub_f32 v196, v196, v248
    v_mfma_f32_16x16x32_bf16 v[212:215], v[12:15], v[180:183], v[212:215]
    v_exp_f32 v196, v196
    v_mfma_f32_16x16x32_bf16 v[216:219], v[42:45], v[180:183], v[216:219]
    v_sub_f32 v197, v197, v248
    v_sub_f32 v200, v200, v248
    v_mfma_f32_16x16x32_bf16 v[220:223], v[72:75], v[180:183], v[220:223]
    v_exp_f32 v197, v197
    v_mfma_f32_16x16x32_bf16 v[224:227], a[248:251], v[180:183], v[224:227]
    v_cvt_pk_bf16_f32 v186, v196, v197
    v_exp_f32 v200, v200
    v_sub_f32 v201, v201, v248
    v_exp_f32 v201, v201
    v_mov_b32 v185, 0
    v_cvt_pk_bf16_f32 v187, v200, v201
    v_add_u32 v204, 0xffffff40, v244
    v_cndmask_b32 v244, v244, v204, vcc
    v_mfma_f32_16x16x32_bf16 v[212:215], v[16:19], v[184:187], v[212:215]
    ds_read_b128 v[196:199], v244 offset:64
    v_add_u32 v205, 0xffffff40, v245
    v_mfma_f32_16x16x32_bf16 v[216:219], v[46:49], v[184:187], v[216:219]
    s_mov_b32 vcc_lo, 0xff00ff
    s_mov_b32 vcc_hi, 0xf000ff
    v_cndmask_b32 v245, v245, v205, vcc
    v_mfma_f32_16x16x32_bf16 v[220:223], v[76:79], v[184:187], v[220:223]
    ds_read_b128 v[204:207], v244 offset:0
    ds_read_b128 v[208:211], v245 offset:0
    v_mfma_f32_16x16x32_bf16 v[224:227], a[248:251], v[184:187], v[224:227]
    ds_read_b128 v[200:203], v245 offset:64
    v_mov_b32 v190, 0
    v_mov_b32 v193, 0
    v_mov_b32 v180, 0
    v_mov_b32 v183, 0
    v_mov_b32 v186, 0
    s_nop 1
    v_rcp_f32 v225, v224
    s_nop 0
    v_mul_f32 v212, v212, v225
    v_mul_f32 v213, v213, v225
    v_mul_f32 v214, v214, v225
    v_mul_f32 v215, v215, v225
    v_cvt_pk_bf16_f32 v212, v212, v213
    v_cvt_pk_bf16_f32 v213, v214, v215
    ds_write_b64 v247, v[212:213] offset:49152
    s_waitcnt lgkmcnt(4)
    v_mfma_f32_16x16x32_bf16 v[196:199], v[114:117], v[174:177], v[196:199]
    v_mul_f32 v216, v216, v225
    v_mul_f32 v217, v217, v225
    v_mfma_f32_16x16x32_bf16 v[196:199], v[116:119], v[176:179], v[196:199]
    s_waitcnt lgkmcnt(3)
    v_mul_f32 v218, v218, v225
    v_mul_f32 v219, v219, v225
    v_mfma_f32_16x16x32_bf16 v[204:207], v[162:165], v[174:177], v[204:207]
    s_waitcnt lgkmcnt(2)
    v_cvt_pk_bf16_f32 v216, v216, v217
    v_cvt_pk_bf16_f32 v217, v218, v219
    v_mfma_f32_16x16x32_bf16 v[204:207], v[164:167], v[176:179], v[204:207]
    ds_write_b64 v247, v[216:217] offset:49280
    v_mfma_f32_16x16x32_bf16 v[208:211], v[102:105], v[174:177], v[208:211]
    s_waitcnt lgkmcnt(2)
    v_mul_f32 v220, v220, v225
    v_mul_f32 v221, v221, v225
    v_mfma_f32_16x16x32_bf16 v[208:211], v[104:107], v[176:179], v[208:211]
    v_mul_f32 v222, v222, v225
    v_mul_f32 v223, v223, v225
    v_mfma_f32_16x16x32_bf16 v[200:203], v[138:141], v[174:177], v[200:203]
    v_cvt_pk_bf16_f32 v220, v220, v221
    v_cvt_pk_bf16_f32 v221, v222, v223
    v_mfma_f32_16x16x32_bf16 v[200:203], v[140:143], v[176:179], v[200:203]
    ds_write_b64 v247, v[220:221] offset:49408
    v_mfma_f32_16x16x32_bf16 v[236:239], a[144:147], a[216:219], 0
    v_max_f32 v248, v204, v205
    v_max3_f32 v248, v248, v206, v207
    v_mfma_f32_16x16x32_bf16 v[236:239], a[148:151], a[220:223], v[236:239]
    ds_read_b128 v[204:207], v244 offset:128
    v_max3_f32 v248, v248, v208, v209
    v_mfma_f32_16x16x32_bf16 v[236:239], a[152:155], a[224:227], v[236:239]
    v_max3_f32 v248, v248, v210, v211
    v_max3_f32 v248, v248, v196, v197
    v_mfma_f32_16x16x32_bf16 v[236:239], a[156:159], a[228:231], v[236:239]
    ds_read_b128 v[208:211], v245 offset:128
    v_max3_f32 v248, v248, v198, v199
    v_mfma_f32_16x16x32_bf16 v[236:239], a[160:163], a[232:235], v[236:239]
    ds_read_b128 v[196:199], v244 offset:0
    v_max3_f32 v248, v248, v200, v201
    v_mfma_f32_16x16x32_bf16 v[236:239], a[164:167], a[236:239], v[236:239]
    v_max3_f32 v248, v248, v202, v203
    v_mfma_f32_16x16x32_bf16 v[228:231], a[168:171], a[216:219], 0
    ds_read_b128 v[200:203], v245 offset:0
    v_mfma_f32_16x16x32_bf16 v[228:231], a[172:175], a[220:223], v[228:231]
    v_mfma_f32_16x16x32_bf16 v[228:231], a[176:179], a[224:227], v[228:231]
    v_mfma_f32_16x16x32_bf16 v[228:231], a[180:183], a[228:231], v[228:231]
    v_mfma_f32_16x16x32_bf16 v[228:231], a[184:187], a[232:235], v[228:231]
    s_waitcnt lgkmcnt(3)
    v_cvt_pk_bf16_f32 v236, v236, v237
    v_cvt_pk_bf16_f32 v237, v238, v239
    v_mfma_f32_16x16x32_bf16 v[204:207], v[120:123], v[174:177], v[204:207]
    ds_write_b64 v249, v[236:237] offset:24576
    v_mfma_f32_16x16x32_bf16 v[204:207], v[122:125], v[176:179], v[204:207]
    s_waitcnt lgkmcnt(2)
    v_mfma_f32_16x16x32_bf16 v[208:211], v[144:147], v[174:177], v[208:211]
    v_mfma_f32_16x16x32_bf16 v[208:211], v[146:149], v[176:179], v[208:211]
    s_waitcnt lgkmcnt(1)
    v_mfma_f32_16x16x32_bf16 v[196:199], v[162:165], v[174:177], v[196:199]
    v_mfma_f32_16x16x32_bf16 v[196:199], v[164:167], v[176:179], v[196:199]
    v_mfma_f32_16x16x32_bf16 v[200:203], v[102:105], v[174:177], v[200:203]
    v_mfma_f32_16x16x32_bf16 v[200:203], v[104:107], v[176:179], v[200:203]
    v_max3_f32 v248, v248, v204, v205
    v_max3_f32 v248, v248, v206, v207
    v_mfma_f32_16x16x32_bf16 v[228:231], a[188:191], a[236:239], v[228:231]
    ds_read_b128 v[204:207], v244 offset:64
    v_max3_f32 v248, v248, v208, v209
    v_mfma_f32_16x16x32_bf16 v[232:235], a[192:195], a[216:219], 0
    ds_read_b128 a[216:219], v242 offset:43136
    v_max3_f32 v248, v248, v210, v211
    v_mfma_f32_16x16x32_bf16 v[232:235], a[196:199], a[220:223], v[232:235]
    ds_read_b128 a[220:223], v243 offset:43136
    ds_read_b128 v[208:211], v245 offset:64
    v_mfma_f32_16x16x32_bf16 v[232:235], a[200:203], a[224:227], v[232:235]
    ds_read_b128 a[224:227], v242 offset:43264
    v_cvt_pk_bf16_f32 v228, v228, v229
    v_mfma_f32_16x16x32_bf16 v[232:235], a[204:207], a[228:231], v[232:235]
    ds_read_b128 a[228:231], v243 offset:43264
    v_cvt_pk_bf16_f32 v229, v230, v231
    v_mfma_f32_16x16x32_bf16 v[232:235], a[208:211], a[232:235], v[232:235]
    ds_write_b64 v249, v[228:229] offset:24704
    v_mfma_f32_16x16x32_bf16 v[232:235], a[212:215], a[236:239], v[232:235]
    v_mov_b32 v225, v248
    v_mfma_f32_16x16x32_bf16 v[236:239], a[144:147], a[240:243], 0
    v_mfma_f32_16x16x32_bf16 v[236:239], a[148:151], a[244:247], v[236:239]
    s_waitcnt lgkmcnt(6)
    v_permlane16_swap_b32 v248, v225
    v_max_f32 v248, v248, v225
    v_mfma_f32_16x16x32_bf16 v[204:207], v[114:117], v[174:177], v[204:207]
    s_waitcnt lgkmcnt(5)
    v_cvt_pk_bf16_f32 v232, v232, v233
    v_cvt_pk_bf16_f32 v233, v234, v235
    v_mfma_f32_16x16x32_bf16 v[204:207], v[116:119], v[176:179], v[204:207]
    ds_write_b64 v249, v[232:233] offset:24832
    v_mfma_f32_16x16x32_bf16 v[236:239], a[152:155], a[216:219], v[236:239]
    s_waitcnt lgkmcnt(4)
    v_mov_b32 v225, v248
    v_mfma_f32_16x16x32_bf16 v[208:211], v[138:141], v[174:177], v[208:211]
    v_mfma_f32_16x16x32_bf16 v[208:211], v[140:143], v[176:179], v[208:211]
    v_permlane32_swap_b32 v248, v225
    v_max_f32 v248, v248, v225
    v_mfma_f32_16x16x32_bf16 v[236:239], a[156:159], a[220:223], v[236:239]
    s_waitcnt lgkmcnt(3)
    v_sub_f32 v196, v196, v248
    v_sub_f32 v197, v197, v248
    v_mfma_f32_16x16x32_bf16 v[236:239], a[160:163], a[224:227], v[236:239]
    s_waitcnt lgkmcnt(2)
    v_exp_f32 v196, v196
    v_mfma_f32_16x16x32_bf16 v[236:239], a[164:167], a[228:231], v[236:239]
    v_exp_f32 v197, v197
    v_mfma_f32_16x16x32_bf16 v[228:231], a[168:171], a[240:243], 0
    v_sub_f32 v198, v198, v248
    v_sub_f32 v199, v199, v248
    v_mfma_f32_16x16x32_bf16 v[228:231], a[172:175], a[244:247], v[228:231]
    s_waitcnt lgkmcnt(0)
    s_barrier
    v_cvt_pk_bf16_f32 v188, v196, v197
    v_mfma_f32_16x16x32_bf16 v[228:231], a[176:179], a[216:219], v[228:231]
    ds_read_b128 a[232:235], v242 offset:49152
    v_cvt_pk_bf16_f32 v236, v236, v237
    v_mfma_f32_16x16x32_bf16 v[228:231], a[180:183], a[220:223], v[228:231]
    ds_read_b128 a[236:239], v243 offset:49152
    v_cvt_pk_bf16_f32 v237, v238, v239
    v_mfma_f32_16x16x32_bf16 v[228:231], a[184:187], a[224:227], v[228:231]
    ds_write_b64 v249, v[236:237] offset:0
    v_mfma_f32_16x16x32_bf16 v[228:231], a[188:191], a[228:231], v[228:231]
    ds_read_b128 a[252:255], v252 offset:18432
    ds_read_b64 v[254:255], v253 offset:18688
    v_mfma_f32_16x16x32_bf16 v[232:235], a[192:195], a[240:243], 0
    ds_read_b128 a[240:243], v242 offset:49280
    v_sub_f32 v200, v200, v248
    v_mfma_f32_16x16x32_bf16 v[232:235], a[196:199], a[244:247], v[232:235]
    ds_read_b128 a[244:247], v243 offset:49280
    v_sub_f32 v201, v201, v248
    v_mfma_f32_16x16x32_bf16 v[232:235], a[200:203], a[216:219], v[232:235]
    ds_read_b128 a[216:219], v242 offset:49408
    v_cvt_pk_bf16_f32 v228, v228, v229
    v_mfma_f32_16x16x32_bf16 v[232:235], a[204:207], a[220:223], v[232:235]
    ds_read_b128 a[220:223], v243 offset:49408
    v_cvt_pk_bf16_f32 v229, v230, v231
    v_mfma_f32_16x16x32_bf16 v[232:235], a[208:211], a[224:227], v[232:235]
    ds_write_b64 v249, v[228:229] offset:128
    v_mfma_f32_16x16x32_bf16 v[232:235], a[212:215], a[228:231], v[232:235]
    s_waitcnt lgkmcnt(9)
    v_exp_f32 v198, v198
    v_mfma_f32_16x16x32_bf16 v[236:239], a[144:147], a[232:235], 0
    s_waitcnt lgkmcnt(8)
    v_exp_f32 v199, v199
    v_mfma_f32_16x16x32_bf16 v[236:239], a[148:151], a[236:239], v[236:239]
    v_cvt_pk_bf16_f32 v191, v198, v199
    s_waitcnt lgkmcnt(6)
    v_mfma_f32_16x16x32_bf16 v[228:231], a[168:171], a[232:235], 0
    ds_read_b128 v[196:199], v244 offset:128
    v_cvt_pk_bf16_f32 v232, v232, v233
    v_mfma_f32_16x16x32_bf16 v[228:231], a[172:175], a[236:239], v[228:231]
    s_waitcnt lgkmcnt(5)
    v_cvt_pk_bf16_f32 v233, v234, v235
    v_sub_f32 v202, v202, v248
    v_mfma_f32_16x16x32_bf16 v[236:239], a[152:155], a[240:243], v[236:239]
    ds_write_b64 v249, v[232:233] offset:256
    v_mfma_f32_16x16x32_bf16 v[228:231], a[176:179], a[240:243], v[228:231]
    buffer_store_dwordx4 a[252:255], v250, s[20:23], s52 offen nt
    v_mfma_f32_16x16x32_bf16 v[232:235], a[192:195], a[232:235], 0
    s_waitcnt lgkmcnt(5)
    ds_read_b128 a[252:255], v252 offset:24576
    v_mfma_f32_16x16x32_bf16 v[236:239], a[156:159], a[244:247], v[236:239]
    s_waitcnt lgkmcnt(5)
    v_exp_f32 v200, v200
    v_mfma_f32_16x16x32_bf16 v[236:239], a[160:163], a[216:219], v[236:239]
    buffer_store_dwordx2 v[254:255], v251, s[20:23], s52 offen offset:256 nt
    v_mfma_f32_16x16x32_bf16 v[228:231], a[180:183], a[244:247], v[228:231]
    ds_read_b64 v[254:255], v253 offset:24832
    s_lshr_b32 s52, s28, 1
    v_mfma_f32_16x16x32_bf16 v[228:231], a[184:187], a[216:219], v[228:231]
    s_lshl2_add_u32 s52, s52, 3
    s_mul_i32 s52, s52, s31
    s_add_u32 s51, s51, s52
    v_mfma_f32_16x16x32_bf16 v[232:235], a[196:199], a[236:239], v[232:235]
    s_add_u32 s51, s51, s32
    v_exp_f32 v201, v201
    v_mfma_f32_16x16x32_bf16 v[232:235], a[200:203], a[240:243], v[232:235]
    s_waitcnt lgkmcnt(3)
    v_exp_f32 v202, v202
    v_mfma_f32_16x16x32_bf16 v[196:199], v[120:123], v[174:177], v[196:199]
    v_sub_f32 v203, v203, v248
    v_cvt_pk_bf16_f32 v189, v200, v201
    v_mfma_f32_16x16x32_bf16 v[196:199], v[122:125], v[176:179], v[196:199]
    v_exp_f32 v203, v203
    v_mfma_f32_16x16x32_bf16 v[212:215], v[12:15], v[188:191], 0
    s_waitcnt lgkmcnt(1)
    v_cvt_pk_bf16_f32 v192, v202, v203
    v_sub_f32 v204, v204, v248
    v_mfma_f32_16x16x32_bf16 v[216:219], v[42:45], v[188:191], 0
    ds_read_b128 v[200:203], v245 offset:128
    v_sub_f32 v205, v205, v248
    v_mfma_f32_16x16x32_bf16 v[220:223], v[72:75], v[188:191], 0
    buffer_store_dwordx4 a[252:255], v250, s[20:23], s54 offen nt
    v_mfma_f32_16x16x32_bf16 v[224:227], a[248:251], v[188:191], 0
    s_waitcnt lgkmcnt(1)
    v_exp_f32 v204, v204
    v_mfma_f32_16x16x32_bf16 v[236:239], a[164:167], a[220:223], v[236:239]
    v_exp_f32 v205, v205
    v_mfma_f32_16x16x32_bf16 v[228:231], a[188:191], a[220:223], v[228:231]
    buffer_store_dwordx2 v[254:255], v251, s[20:23], s54 offen offset:256 nt
    v_mfma_f32_16x16x32_bf16 v[232:235], a[204:207], a[244:247], v[232:235]
    s_and_b32 s54, s28, 1
    s_add_u32 s54, s54, 15
    s_mul_i32 s54, s54, s30
    v_mfma_f32_16x16x32_bf16 v[232:235], a[208:211], a[216:219], v[232:235]
    s_add_u32 s54, s54, s55
    v_cvt_pk_bf16_f32 v236, v236, v237
    v_cvt_pk_bf16_f32 v237, v238, v239
    v_mfma_f32_16x16x32_bf16 v[232:235], a[212:215], a[220:223], v[232:235]
    ds_write_b64 v249, v[236:237] offset:6144
    s_waitcnt lgkmcnt(1)
    v_mfma_f32_16x16x32_bf16 v[200:203], v[144:147], v[174:177], v[200:203]
    s_add_u32 s54, s54, s32
    v_cvt_pk_bf16_f32 v228, v228, v229
    v_cvt_pk_bf16_f32 v229, v230, v231
    v_mfma_f32_16x16x32_bf16 v[200:203], v[146:149], v[176:179], v[200:203]
    ds_write_b64 v249, v[228:229] offset:6272
    v_cvt_pk_bf16_f32 v232, v232, v233
    v_cvt_pk_bf16_f32 v233, v234, v235
    ds_write_b64 v249, v[232:233] offset:6400
    v_sub_f32 v206, v206, v248
    v_exp_f32 v206, v206
    v_sub_f32 v207, v207, v248
    v_exp_f32 v207, v207
    v_cvt_pk_bf16_f32 v194, v204, v205
    v_cvt_pk_bf16_f32 v181, v206, v207
    v_sub_f32 v208, v208, v248
    v_exp_f32 v208, v208
    v_sub_f32 v209, v209, v248
    v_exp_f32 v209, v209
    v_sub_f32 v210, v210, v248
    v_exp_f32 v210, v210
    v_sub_f32 v211, v211, v248
    v_exp_f32 v211, v211
    v_cvt_pk_bf16_f32 v195, v208, v209
    v_cvt_pk_bf16_f32 v182, v210, v211
    v_sub_f32 v196, v196, v248
    v_mfma_f32_16x16x32_bf16 v[212:215], v[16:19], v[192:195], v[212:215]
    v_exp_f32 v196, v196
    v_mfma_f32_16x16x32_bf16 v[216:219], v[46:49], v[192:195], v[216:219]
    v_sub_f32 v197, v197, v248
    v_sub_f32 v198, v198, v248
    v_mfma_f32_16x16x32_bf16 v[220:223], v[76:79], v[192:195], v[220:223]
    v_exp_f32 v197, v197
    v_mfma_f32_16x16x32_bf16 v[224:227], a[248:251], v[192:195], v[224:227]
    v_exp_f32 v198, v198
    v_mfma_f32_16x16x32_bf16 v[212:215], v[20:23], v[180:183], v[212:215]
    v_sub_f32 v199, v199, v248
    v_cvt_pk_bf16_f32 v184, v196, v197
    v_mfma_f32_16x16x32_bf16 v[216:219], v[50:53], v[180:183], v[216:219]
    v_exp_f32 v199, v199
    v_mfma_f32_16x16x32_bf16 v[220:223], v[80:83], v[180:183], v[220:223]
    v_cvt_pk_bf16_f32 v187, v198, v199
    v_sub_f32 v200, v200, v248
    v_mfma_f32_16x16x32_bf16 v[224:227], a[248:251], v[180:183], v[224:227]
    v_exp_f32 v200, v200
    v_sub_f32 v201, v201, v248
    v_exp_f32 v201, v201
    v_sub_f32 v202, v202, v248
    v_exp_f32 v202, v202
    v_sub_f32 v203, v203, v248
    v_exp_f32 v203, v203
    v_cvt_pk_bf16_f32 v185, v200, v201
    v_cvt_pk_bf16_f32 v188, v202, v203
    v_mov_b32 v189, 0
    v_mfma_f32_16x16x32_bf16 v[212:215], v[24:27], v[184:187], v[212:215]
    v_mov_b32 v191, 0
    v_mfma_f32_16x16x32_bf16 v[216:219], v[54:57], v[184:187], v[216:219]
    v_mfma_f32_16x16x32_bf16 v[220:223], v[84:87], v[184:187], v[220:223]
    v_mfma_f32_16x16x32_bf16 v[224:227], a[248:251], v[184:187], v[224:227]
    v_mfma_f32_16x16x32_bf16 v[212:215], v[28:31], v[188:191], v[212:215]
    v_mfma_f32_16x16x32_bf16 v[216:219], v[58:61], v[188:191], v[216:219]
    v_mfma_f32_16x16x32_bf16 v[220:223], v[88:91], v[188:191], v[220:223]
    v_mfma_f32_16x16x32_bf16 v[224:227], a[248:251], v[188:191], v[224:227]
    s_nop 7
    v_rcp_f32 v225, v224
    s_nop 0
    v_mul_f32 v212, v212, v225
    v_mul_f32 v213, v213, v225
    v_mul_f32 v214, v214, v225
    v_mul_f32 v215, v215, v225
    v_cvt_pk_bf16_f32 v212, v212, v213
    v_cvt_pk_bf16_f32 v213, v214, v215
    ds_write_b64 v247, v[212:213] offset:55296
    v_mul_f32 v216, v216, v225
    v_mul_f32 v217, v217, v225
    v_mul_f32 v218, v218, v225
    v_mul_f32 v219, v219, v225
    v_cvt_pk_bf16_f32 v216, v216, v217
    v_cvt_pk_bf16_f32 v217, v218, v219
    ds_write_b64 v247, v[216:217] offset:55424
    v_mul_f32 v220, v220, v225
    v_mul_f32 v221, v221, v225
    v_mul_f32 v222, v222, v225
    v_mul_f32 v223, v223, v225
    v_cvt_pk_bf16_f32 v220, v220, v221
    v_cvt_pk_bf16_f32 v221, v222, v223
    ds_write_b64 v247, v[220:221] offset:55552
    s_waitcnt lgkmcnt(0)
    s_barrier
    ds_read_b128 a[224:227], v242 offset:55296
    ds_read_b128 a[228:231], v243 offset:55296
    ds_read_b128 a[232:235], v242 offset:55424
    ds_read_b128 a[236:239], v243 offset:55424
    ds_read_b128 a[240:243], v242 offset:55552
    ds_read_b128 a[244:247], v243 offset:55552
    ds_read_b128 a[252:255], v252 offset:0
    ds_read_b64 v[254:255], v253 offset:256
    s_waitcnt lgkmcnt(7)
    v_mfma_f32_16x16x32_bf16 v[236:239], a[144:147], a[224:227], 0
    v_mfma_f32_16x16x32_bf16 v[228:231], a[168:171], a[224:227], 0
    s_waitcnt lgkmcnt(6)
    v_mfma_f32_16x16x32_bf16 v[236:239], a[148:151], a[228:231], v[236:239]
    s_waitcnt lgkmcnt(5)
    v_mfma_f32_16x16x32_bf16 v[236:239], a[152:155], a[232:235], v[236:239]
    s_waitcnt lgkmcnt(4)
    v_mfma_f32_16x16x32_bf16 v[236:239], a[156:159], a[236:239], v[236:239]
    s_waitcnt lgkmcnt(3)
    v_mfma_f32_16x16x32_bf16 v[236:239], a[160:163], a[240:243], v[236:239]
    s_waitcnt lgkmcnt(2)
    v_mfma_f32_16x16x32_bf16 v[236:239], a[164:167], a[244:247], v[236:239]
    s_waitcnt lgkmcnt(0)
    v_mfma_f32_16x16x32_bf16 v[228:231], a[172:175], a[228:231], v[228:231]
    s_mov_b32 exec_hi, 0
    buffer_store_dwordx4 a[252:255], v250, s[20:23], s56 offen nt
    s_mov_b32 exec_hi, -1
    v_mfma_f32_16x16x32_bf16 v[228:231], a[176:179], a[232:235], v[228:231]
    v_mfma_f32_16x16x32_bf16 v[228:231], a[180:183], a[236:239], v[228:231]
    ds_read_b128 a[252:255], v252 offset:6144
    v_mfma_f32_16x16x32_bf16 v[228:231], a[184:187], a[240:243], v[228:231]
    s_mov_b32 exec_hi, 0
    buffer_store_dwordx2 v[254:255], v251, s[20:23], s56 offen offset:256 nt
    s_mov_b32 exec_hi, -1
    v_mfma_f32_16x16x32_bf16 v[228:231], a[188:191], a[244:247], v[228:231]
    ds_read_b64 v[254:255], v253 offset:6400
    v_cvt_pk_bf16_f32 v236, v236, v237
    v_mfma_f32_16x16x32_bf16 v[232:235], a[192:195], a[224:227], 0
    v_cvt_pk_bf16_f32 v237, v238, v239
    v_mfma_f32_16x16x32_bf16 v[232:235], a[196:199], a[228:231], v[232:235]
    ds_write_b64 v249, v[236:237] offset:12288
    v_mfma_f32_16x16x32_bf16 v[232:235], a[200:203], a[232:235], v[232:235]
    v_mfma_f32_16x16x32_bf16 v[232:235], a[204:207], a[236:239], v[232:235]
    v_cvt_pk_bf16_f32 v228, v228, v229
    v_cvt_pk_bf16_f32 v229, v230, v231
    v_mfma_f32_16x16x32_bf16 v[232:235], a[208:211], a[240:243], v[232:235]
    ds_write_b64 v249, v[228:229] offset:12416
    v_mfma_f32_16x16x32_bf16 v[232:235], a[212:215], a[244:247], v[232:235]
    s_waitcnt lgkmcnt(3)
    buffer_store_dwordx4 a[252:255], v250, s[20:23], s51 offen nt
    s_waitcnt lgkmcnt(2)
    s_nop 4
    v_cvt_pk_bf16_f32 v232, v232, v233
    v_cvt_pk_bf16_f32 v233, v234, v235
    ds_write_b64 v249, v[232:233] offset:12544
    buffer_store_dwordx2 v[254:255], v251, s[20:23], s51 offen offset:256 nt
    s_waitcnt lgkmcnt(0)
    s_barrier
    ds_read_b128 a[252:255], v252 offset:12288
    ds_read_b64 v[254:255], v253 offset:12544
    s_waitcnt lgkmcnt(1)
    s_mov_b32 exec_hi, s53
    buffer_store_dwordx4 a[252:255], v250, s[20:23], s54 offen nt
    s_mov_b32 exec_hi, -1
    s_waitcnt lgkmcnt(0)
    s_mov_b32 exec_hi, s53
    buffer_store_dwordx2 v[254:255], v251, s[20:23], s54 offen offset:256 nt
    s_mov_b32 exec_hi, -1
    s_endpgm
.section .rodata,"a"
.p2align 6
.amdhsa_kernel standalone__neighborhood_dinat__vision_kernel
  .amdhsa_next_free_vgpr 512
  .amdhsa_next_free_sgpr 102
  .amdhsa_accum_offset 256
  .amdhsa_group_segment_fixed_size 0
  .amdhsa_kernarg_size 56
  .amdhsa_user_sgpr_count 2
  .amdhsa_user_sgpr_kernarg_segment_ptr 1
  .amdhsa_system_sgpr_workgroup_id_x 1
.end_amdhsa_kernel
```

```asm
; @launch grid=(256,1,1) block=(256,1,1) lds=163840
.amdgcn_target "amdgcn-amd-amdhsa--gfx950"
.text
.globl standalone__neighborhood_dinat__vision_kernel
.p2align 12
.p2align 8
.type standalone__neighborhood_dinat__vision_kernel,@function
standalone__neighborhood_dinat__vision_kernel:
    s_cmpk_ge_u32 s2, 0x100
    s_cbranch_scc1 L_exit
    s_load_dwordx2 s[4:5], s[0:1], 0
    s_load_dwordx2 s[8:9], s[0:1], 8
    s_load_dwordx2 s[12:13], s[0:1], 16
    s_load_dwordx2 s[16:17], s[0:1], 24
    s_load_dwordx2 s[20:21], s[0:1], 32
    s_getpc_b64 s[68:69]
    v_lshrrev_b32 v4, 6, v0
    s_bfe_u32 s65, s2, 0x30003
    v_readfirstlane_b32 s28, v4
    s_lshl_b32 s66, s65, 13
    v_lshl_add_u32 v0, v0, 5, s66
    global_load_dword v11, v0, s[68:69]
    s_lshr_b32 s66, s2, 6
    s_and_b32 s67, s2, 1
    s_lshl2_add_u32 s64, s67, s66
    s_mov_b32 s30, 0x2a000
    s_mul_i32 s66, s64, 14
    s_bitcmp1_b32 s64, 0
    s_cselect_b32 s67, 16, -3
    s_cselect_b32 s35, -1, 1
    s_add_u32 s66, s66, s67
    s_mul_i32 s32, s66, s30
    s_mul_i32 s40, s30, 0x6f
    s_mul_i32 s30, s30, s35
    s_mul_i32 s66, s65, 28
    s_cmp_eq_u32 s65, 7
    s_cselect_b32 s36, 1, 0
    s_cselect_b32 s67, 18, -6
    s_cselect_b32 s31, -3, 3
    s_add_u32 s66, s66, s67
    s_bfe_u32 s67, s2, 0x10001
    s_add_u32 s66, s66, s67
    s_bfe_u32 s67, s2, 0x10002
    s_mulk_i32 s67, 0xe0
    s_add_u32 s66, s66, s67
    s_mulk_i32 s66, 0x180
    s_lshl_b32 s67, s36, 11
    s_sub_u32 s66, s66, s67
    s_lshl_b32 s45, s31, 11
    s_lshl_b32 s31, s31, 8
    s_mul_i32 s67, s30, s28
    s_add_u32 s67, s67, s32
    s_add_u32 s32, s32, s66
    s_min_i32 s40, s40, s67
    s_max_i32 s40, s40, 0
    s_add_u32 s40, s40, s66
    s_add_u32 s67, s67, s66
    s_lshl2_add_u32 s41, s30, s67
    s_mul_i32 s46, s28, 0x1e00
    s_mul_i32 s29, s28, 0x3000
    s_add_u32 s29, s29, 0x16800
    s_mul_i32 s39, s28, 0x60
    s_mov_b32 s6, 0x1260000
    s_mov_b32 s7, 0x20000
    s_mov_b32 s10, 0x36000
    s_mov_b32 s11, 0x20000
    v_mbcnt_lo_u32_b32 v1, -1, 0
    v_mbcnt_hi_u32_b32 v1, -1, v1
    s_lshl_b32 s51, s28, 1
    s_add_u32 s50, s31, 0xfffffe80
    s_mul_i32 s52, s36, 0x1d00
    v_lshrrev_b32 v2, 3, v1
    v_and_b32 v3, 7, v1
    v_xor_b32 v3, s51, v3
    v_lshl_add_u32 v4, v2, 7, s52
    v_mul_u32_u24 v8, 11, v2
    v_bfe_u32 v9, v8, 6, 1
    v_lshrrev_b32 v8, 5, v8
    v_xor_b32 v9, v3, v9
    v_mad_i32_i24 v8, v8, s50, v4
    v_lshl_add_u32 v168, v9, 4, v8
    v_add_u32 v8, 8, v2
    v_mul_u32_u24 v8, 11, v8
    v_bfe_u32 v9, v8, 6, 1
    v_lshrrev_b32 v8, 5, v8
    v_xor_b32 v9, v3, v9
    v_mad_i32_i24 v8, v8, s50, v4
    v_lshl_add_u32 v169, v9, 4, v8
    v_add_u32 v8, 16, v2
    v_mul_u32_u24 v8, 11, v8
    v_bfe_u32 v9, v8, 6, 1
    v_lshrrev_b32 v8, 5, v8
    v_xor_b32 v9, v3, v9
    v_mad_i32_i24 v8, v8, s50, v4
    v_lshl_add_u32 v170, v9, 4, v8
    s_movk_i32 s53, 0x480
    s_movk_i32 s54, -96
    v_lshrrev_b32 v10, 1, v1
    v_lshlrev_b32 v12, 4, v1
    v_mul_u32_u24 v8, 43, v10
    v_lshrrev_b32 v9, 8, v8
    v_lshrrev_b32 v8, 7, v8
    v_and_b32 v9, 4, v9
    v_xor_b32 v9, v8, v9
    v_mad_i32_i24 v8, v8, s54, v12
    v_mad_u32_u24 v172, v9, s53, v8
    v_add_u32 v8, 32, v10
    v_mul_u32_u24 v8, 43, v8
    v_lshrrev_b32 v9, 8, v8
    v_lshrrev_b32 v8, 7, v8
    v_and_b32 v9, 4, v9
    v_xor_b32 v9, v8, v9
    v_mad_i32_i24 v8, v8, s54, v12
    v_mad_u32_u24 v173, v9, s53, v8
    v_add_u32 v8, 64, v10
    v_mul_u32_u24 v8, 43, v8
    v_lshrrev_b32 v9, 8, v8
    v_lshrrev_b32 v8, 7, v8
    v_and_b32 v9, 4, v9
    v_xor_b32 v9, v8, v9
    v_mad_i32_i24 v8, v8, s54, v12
    v_mad_u32_u24 v174, v9, s53, v8
    s_waitcnt lgkmcnt(0)
    s_add_u32 m0, s46, 0xc00
    s_add_u32 s59, s40, s45
    buffer_load_dwordx4 v168, s[4:7], s59 offen lds
    s_add_u32 m0, s29, 0
    s_add_u32 s60, s39, 0x180
    buffer_load_dwordx4 v172, s[8:11], s60 offen lds
    s_add_u32 m0, s46, 0xc00
    s_lshr_b32 s52, s2, 3
    buffer_load_dwordx4 v169, s[4:7], s59 offen offset:1024 lds
    s_add_u32 m0, s29, 0
    s_lshl2_add_u32 s52, s52, s28
    buffer_load_dwordx4 v173, s[8:11], s60 offen offset:1024 lds
    s_add_u32 m0, s46, 0xc00
    s_mul_i32 s52, s52, 0x6c0
    buffer_load_dwordx4 v170, s[4:7], s59 offen offset:2048 lds
    s_add_u32 m0, s29, 0
    v_lshlrev_b32 v10, 5, v1
    buffer_load_dwordx4 v174, s[8:11], s60 offen offset:2048 lds
    buffer_load_dword v11, v10, s[8:11], s52 offen
    s_add_u32 s53, s40, 0
    s_add_u32 m0, s46, 0
    v_add_u32 v5, s53, v168
    v_max_i32 v5, 0, v5
    buffer_load_dwordx4 v5, s[4:7], 0 offen lds
    s_add_u32 s54, s40, 0x400
    s_add_u32 m0, s46, 0x400
    v_add_u32 v6, s54, v169
    v_max_i32 v6, 0, v6
    buffer_load_dwordx4 v6, s[4:7], 0 offen lds
    s_add_u32 s55, s40, 0x800
    s_add_u32 m0, s46, 0x800
    v_add_u32 v7, s55, v170
    v_max_i32 v7, 0, v7
    buffer_load_dwordx4 v7, s[4:7], 0 offen lds
    s_add_u32 m0, s29, 0xc00
    s_add_u32 s61, s39, 0x9180
    buffer_load_dwordx4 v172, s[8:11], s61 offen lds
    buffer_load_dwordx4 v173, s[8:11], s61 offen offset:1024 lds
    s_mov_b32 s33, 0
    s_add_u32 s66, s64, 1
    s_and_b32 s66, s66, 6
    s_cselect_b32 s33, 0, 3
    s_add_u32 s66, s65, 1
    s_and_b32 s66, s66, 6
    s_cselect_b32 s34, 0, 1
    s_cmp_lt_i32 s30, 0
    s_cselect_b32 s35, 1, 0
    s_cselect_b32 s49, -1, 1
    s_mul_i32 s49, s49, 0x1c0
    s_cselect_b32 s48, 0, 0x4e
    s_mul_i32 s66, s28, 0x152
    s_add_u32 s48, s48, s66
    s_lshl2_add_u32 s42, s30, s41
    s_lshl2_add_u32 s43, s30, s42
    s_lshl2_add_u32 s44, s30, s43
    s_mul_i32 s66, s36, 0x1400
    s_add_u32 s32, s32, s66
    s_mul_i32 s37, s28, 0x1180
    s_add_u32 s37, s37, 0x239c0
    s_mov_b32 s38, 0x3e553b95
    s_mov_b32 s3, 0x3dd53b95
    s_mov_b32 s14, 0x12000
    s_mov_b32 s15, 0x20000
    s_mov_b32 s18, 0x548
    s_mov_b32 s19, 0x20000
    s_mov_b32 s22, 0x1260000
    s_mov_b32 s23, 0x20000
    s_mov_b32 s26, 0x1000000
    s_mov_b32 s27, 0x20000
    s_add_u32 s62, s39, 0x12180
    s_add_u32 s63, s39, 0x1b180
    v_and_b32 v13, 15, v1
    v_lshrrev_b32 v14, 4, v1
    v_lshrrev_b32 v15, 2, v13
    v_and_b32 v17, 1, v14
    v_lshl_add_u32 v18, v14, 3, v15
    v_xor_b32 v19, 0, v17
    v_lshl_add_u32 v19, v19, 2, v18
    v_and_b32 v16, 3, v13
    v_mul_u32_u24 v19, 0x60, v19
    v_lshl_add_u32 v19, v16, 3, v19
    v_add_u32 v249, s29, v19
    v_xor_b32 v19, 1, v17
    v_lshl_add_u32 v19, v19, 2, v18
    v_mov_b32 v17, v15
    v_and_b32 v18, 3, v17
    v_lshlrev_b32 v18, 1, v18
    v_bfe_u32 v241, v16, 1, 1
    v_or_b32 v18, v18, v241
    v_mul_u32_u24 v17, 0x1e00, v17
    v_xor_b32 v18, v18, v14
    v_lshl_add_u32 v17, v18, 4, v17
    v_mul_u32_u24 v19, 0x60, v19
    v_mul_u32_u24 v18, 0x180, v16
    v_lshl_add_u32 v19, v16, 3, v19
    v_add_u32 v240, v17, v18
    v_add_u32 v250, s29, v19
    v_xor_b32 v241, 64, v240
    s_add_u32 s59, s41, s45
    s_add_u32 s60, s39, 0x24180
    s_and_b32 s65, s48, 0xfff0
    s_lshr_b32 s56, s2, 3
    s_lshl2_add_u32 s56, s56, s28
    s_mul_i32 s56, s56, 0x240
    s_lshl1_add_u32 s58, s45, s40
    s_add_u32 s57, s28, 3
    s_mul_i32 s51, s31, 3
    s_mul_i32 s57, s57, s30
    s_add_u32 s57, s57, s51
    s_add_u32 s57, s57, s32
    s_add_u32 s52, s28, 3
    s_mul_i32 s53, s31, 7
    s_mul_i32 s52, s52, s30
    s_add_u32 s52, s52, s53
    s_add_u32 s52, s52, s32
    s_add_u32 s54, s28, 3
    s_mul_i32 s55, s31, 11
    s_mul_i32 s54, s54, s30
    s_add_u32 s54, s54, s55
    s_add_u32 s54, s54, s32
    s_add_u32 s51, s28, 7
    s_mul_i32 s51, s51, s30
    s_add_u32 s53, s28, 7
    s_mul_i32 s53, s53, s30
    s_add_u32 s55, s28, 3
    s_mul_i32 s55, s55, s30
    buffer_load_dwordx4 v174, s[8:11], s61 offen offset:2048 lds
    s_add_u32 m0, s29, 0x1800
    s_add_u32 s61, s39, 0x2d180
    buffer_load_dwordx4 v172, s[8:11], s62 offen lds
    buffer_load_dwordx4 v173, s[8:11], s62 offen offset:1024 lds
    buffer_load_dwordx4 v174, s[8:11], s62 offen offset:2048 lds
    s_add_u32 m0, s46, 0x7800
    s_add_u32 s62, s39, 0x300
    buffer_load_dwordx4 v168, s[4:7], s41 offen lds
    s_waitcnt vmcnt(12)
    s_barrier
    ds_read_b128 a[216:219], v240 offset:3072
    ds_read_b128 a[220:223], v240 offset:4608
    ds_read_b128 a[240:243], v241 offset:3072
    ds_read_b128 a[244:247], v241 offset:4608
    buffer_load_dwordx4 v169, s[4:7], s41 offen offset:1024 lds
    s_waitcnt vmcnt(12)
    ds_read_b64_tr_b16 a[0:1], v249 offset:0
    ds_read_b64_tr_b16 a[2:3], v250 offset:0
    ds_read_b64_tr_b16 a[24:25], v249 offset:32
    ds_read_b64_tr_b16 a[26:27], v250 offset:32
    ds_read_b64_tr_b16 a[48:49], v249 offset:64
    ds_read_b64_tr_b16 a[50:51], v250 offset:64
    buffer_load_dwordx4 v170, s[4:7], s41 offen offset:2048 lds
    s_add_u32 m0, s29, 0x2400
    s_nop 0
    buffer_load_dwordx4 v172, s[8:11], s63 offen lds
    s_waitcnt lgkmcnt(4)
    v_mfma_f32_16x16x32_bf16 v[180:183], a[0:3], a[216:219], 0
    v_mfma_f32_16x16x32_bf16 v[192:195], a[0:3], a[220:223], 0
    s_waitcnt lgkmcnt(2)
    v_mfma_f32_16x16x32_bf16 v[184:187], a[24:27], a[216:219], 0
    s_waitcnt lgkmcnt(0)
    v_mfma_f32_16x16x32_bf16 v[188:191], a[48:51], a[216:219], 0
    v_mfma_f32_16x16x32_bf16 v[196:199], a[24:27], a[220:223], 0
    buffer_load_dwordx4 v173, s[8:11], s63 offen offset:1024 lds
    v_mfma_f32_16x16x32_bf16 v[200:203], a[48:51], a[220:223], 0
    s_mov_b64 exec, 0
    s_cmp_eq_u32 s28, 0
    s_cbranch_scc1 L_h1
    s_cmp_eq_u32 s28, 1
    s_cbranch_scc1 L_h2
    s_cmp_eq_u32 s28, 2
    s_cbranch_scc1 L_h3
    s_branch L_h4
    L_hback:
    s_mov_b64 exec, -1
    s_waitcnt vmcnt(11)
    buffer_load_dwordx4 v174, s[8:11], s63 offen offset:2048 lds
    s_barrier
    s_add_u32 m0, s46, 0x8400
    ds_read_b128 a[224:227], v240 offset:0
    ds_read_b128 a[228:231], v240 offset:1536
    ds_read_b128 a[232:235], v241 offset:0
    ds_read_b128 a[236:239], v241 offset:1536
    ds_read_b128 a[216:219], v240 offset:128
    ds_read_b128 a[220:223], v240 offset:1664
    s_add_u32 s63, s39, 0x9300
    buffer_load_dwordx4 v168, s[4:7], s59 offen lds
    buffer_load_dwordx4 v169, s[4:7], s59 offen offset:1024 lds
    s_waitcnt lgkmcnt(5)
    v_mfma_f32_16x16x32_bf16 v[204:207], a[0:3], a[224:227], 0
    v_mfma_f32_16x16x32_bf16 v[208:211], a[24:27], a[224:227], 0
    s_waitcnt lgkmcnt(4)
    v_mfma_f32_16x16x32_bf16 v[212:215], a[48:51], a[224:227], 0
    ds_read_b128 a[224:227], v240 offset:3200
    v_mfma_f32_16x16x32_bf16 v[216:219], a[0:3], a[228:231], 0
    v_mfma_f32_16x16x32_bf16 v[220:223], a[24:27], a[228:231], 0
    s_waitcnt vmcnt(11)
    ds_read_b64_tr_b16 a[4:5], v249 offset:3072
    v_mfma_f32_16x16x32_bf16 v[224:227], a[48:51], a[228:231], 0
    ds_read_b64_tr_b16 a[6:7], v250 offset:3072
    ds_read_b64_tr_b16 a[28:29], v249 offset:3104
    ds_read_b64_tr_b16 a[30:31], v250 offset:3104
    ds_read_b64_tr_b16 a[52:53], v249 offset:3136
    ds_read_b64_tr_b16 a[54:55], v250 offset:3136
    buffer_load_dwordx4 v170, s[4:7], s59 offen offset:2048 lds
    s_add_u32 m0, s29, 0
    ds_read_b128 a[228:231], v240 offset:4736
    s_add_u32 s59, s42, s45
    buffer_load_dwordx4 v172, s[8:11], s60 offen lds
    s_waitcnt lgkmcnt(5)
    v_mfma_f32_16x16x32_bf16 v[204:207], a[4:7], a[232:235], v[204:207]
    v_mfma_f32_16x16x32_bf16 v[216:219], a[4:7], a[236:239], v[216:219]
    s_waitcnt lgkmcnt(3)
    buffer_load_dwordx4 v173, s[8:11], s60 offen offset:1024 lds
    v_mfma_f32_16x16x32_bf16 v[208:211], a[28:31], a[232:235], v[208:211]
    s_waitcnt lgkmcnt(1)
    v_mfma_f32_16x16x32_bf16 v[212:215], a[52:55], a[232:235], v[212:215]
    s_waitcnt vmcnt(11)
    ds_read_b64_tr_b16 a[8:9], v249 offset:6144
    v_mfma_f32_16x16x32_bf16 v[220:223], a[28:31], a[236:239], v[220:223]
    ds_read_b64_tr_b16 a[10:11], v250 offset:6144
    ds_read_b64_tr_b16 a[32:33], v249 offset:6176
    v_mfma_f32_16x16x32_bf16 v[224:227], a[52:55], a[236:239], v[224:227]
    ds_read_b64_tr_b16 a[34:35], v250 offset:6176
    ds_read_b64_tr_b16 a[56:57], v249 offset:6208
    v_mfma_f32_16x16x32_bf16 v[180:183], a[4:7], a[240:243], v[180:183]
    ds_read_b64_tr_b16 a[58:59], v250 offset:6208
    buffer_load_dwordx4 v174, s[8:11], s60 offen offset:2048 lds
    v_mfma_f32_16x16x32_bf16 v[184:187], a[28:31], a[240:243], v[184:187]
    s_add_u32 m0, s29, 0xc00
    s_add_u32 s60, s39, 0x12300
    v_mfma_f32_16x16x32_bf16 v[188:191], a[52:55], a[240:243], v[188:191]
    v_mfma_f32_16x16x32_bf16 v[192:195], a[4:7], a[244:247], v[192:195]
    v_mfma_f32_16x16x32_bf16 v[196:199], a[28:31], a[244:247], v[196:199]
    buffer_load_dwordx4 v172, s[8:11], s61 offen lds
    v_mfma_f32_16x16x32_bf16 v[200:203], a[52:55], a[244:247], v[200:203]
    s_waitcnt lgkmcnt(4)
    v_mfma_f32_16x16x32_bf16 v[204:207], a[8:11], a[216:219], v[204:207]
    v_mfma_f32_16x16x32_bf16 v[216:219], a[8:11], a[220:223], v[216:219]
    s_waitcnt lgkmcnt(2)
    v_mfma_f32_16x16x32_bf16 v[208:211], a[32:35], a[216:219], v[208:211]
    s_waitcnt lgkmcnt(0)
    buffer_load_dwordx4 v173, s[8:11], s61 offen offset:1024 lds
    v_mfma_f32_16x16x32_bf16 v[212:215], a[56:59], a[216:219], v[212:215]
    v_mfma_f32_16x16x32_bf16 v[220:223], a[32:35], a[220:223], v[220:223]
    s_waitcnt vmcnt(11)
    s_barrier
    v_add_u32 v8, 4, v2
    v_mfma_f32_16x16x32_bf16 v[224:227], a[56:59], a[220:223], v[224:227]
    ds_read_b128 a[232:235], v240 offset:30720
    ds_read_b128 a[236:239], v240 offset:32256
    v_mfma_f32_16x16x32_bf16 v[180:183], a[8:11], a[224:227], v[180:183]
    ds_read_b128 a[240:243], v241 offset:30720
    v_mul_u32_u24 v8, 11, v8
    v_mfma_f32_16x16x32_bf16 v[184:187], a[32:35], a[224:227], v[184:187]
    ds_read_b128 a[244:247], v241 offset:32256
    v_bfe_u32 v9, v8, 6, 1
    v_mfma_f32_16x16x32_bf16 v[188:191], a[56:59], a[224:227], v[188:191]
    ds_read_b128 a[216:219], v240 offset:30848
    v_lshrrev_b32 v8, 5, v8
    v_mfma_f32_16x16x32_bf16 v[192:195], a[8:11], a[228:231], v[192:195]
    buffer_load_dwordx4 v174, s[8:11], s61 offen offset:2048 lds
    v_xor_b32 v9, v3, v9
    v_mfma_f32_16x16x32_bf16 v[196:199], a[32:35], a[228:231], v[196:199]
    ds_read_b128 a[220:223], v240 offset:32384
    v_add_u32 v17, 3, v15
    v_mfma_f32_16x16x32_bf16 v[200:203], a[56:59], a[228:231], v[200:203]
    s_add_u32 m0, s37, 0xd80
    ds_read_b128 a[224:227], v241 offset:128
    ds_read_b128 a[228:231], v241 offset:1664
    s_add_u32 s61, s39, 0x1b300
    s_add_u32 s50, s31, 0xfffffe80
    v_mad_i32_i24 v8, v8, s50, v4
    buffer_load_dwordx4 v12, s[16:19], s65 offen lds
    s_waitcnt lgkmcnt(7)
    v_mfma_f32_16x16x32_bf16 v[228:231], a[0:3], a[232:235], 0
    s_waitcnt lgkmcnt(6)
    v_lshl_add_u32 v171, v9, 4, v8
    v_add_u32 v19, 3, v16
    v_mfma_f32_16x16x32_bf16 v[232:235], a[24:27], a[232:235], 0
    s_add_u32 m0, s29, 0x1800
    v_and_b32 v18, 3, v17
    v_lshlrev_b32 v18, 1, v18
    v_mfma_f32_16x16x32_bf16 v[236:239], a[48:51], a[232:235], 0
    ds_read_b128 a[232:235], v241 offset:3200
    v_bfe_u32 v243, v19, 1, 1
    v_mfma_f32_16x16x32_bf16 v[138:141], a[0:3], a[236:239], 0
    s_waitcnt lgkmcnt(6)
    v_or_b32 v18, v18, v243
    v_mul_u32_u24 v17, 0x1e00, v17
    v_mfma_f32_16x16x32_bf16 v[142:145], a[24:27], a[236:239], 0
    buffer_load_dword v11, v12, s[12:15], s56 offen
    v_xor_b32 v18, v18, v14
    v_mfma_f32_16x16x32_bf16 v[146:149], a[48:51], a[236:239], 0
    ds_read_b128 a[236:239], v241 offset:4736
    v_lshl_add_u32 v17, v18, 4, v17
    v_mfma_f32_16x16x32_bf16 v[228:231], a[4:7], a[240:243], v[228:231]
    s_waitcnt vmcnt(11) lgkmcnt(6)
    ds_read_b64_tr_b16 a[12:13], v249 offset:9216
    v_mfma_f32_16x16x32_bf16 v[232:235], a[28:31], a[240:243], v[232:235]
    ds_read_b64_tr_b16 a[14:15], v250 offset:9216
    ds_read_b64_tr_b16 a[36:37], v249 offset:9248
    v_mfma_f32_16x16x32_bf16 v[236:239], a[52:55], a[240:243], v[236:239]
    ds_read_b64_tr_b16 a[38:39], v250 offset:9248
    ds_read_b64_tr_b16 a[60:61], v249 offset:9280
    v_mfma_f32_16x16x32_bf16 v[138:141], a[4:7], a[244:247], v[138:141]
    ds_read_b64_tr_b16 a[62:63], v250 offset:9280
    s_waitcnt lgkmcnt(10)
    v_mfma_f32_16x16x32_bf16 v[142:145], a[28:31], a[244:247], v[142:145]
    buffer_load_dwordx4 v172, s[8:11], s62 offen lds
    v_mul_u32_u24 v18, 0x180, v19
    v_mfma_f32_16x16x32_bf16 v[146:149], a[52:55], a[244:247], v[146:149]
    ds_read_b128 a[240:243], v241 offset:30848
    v_add_u32 v242, v17, v18
    v_mfma_f32_16x16x32_bf16 v[228:231], a[8:11], a[216:219], v[228:231]
    ds_read_b128 a[244:247], v241 offset:32384
    v_mov_b32 v17, 0x3f803f80
    v_mfma_f32_16x16x32_bf16 v[232:235], a[32:35], a[216:219], v[232:235]
    s_and_b32 s66, s28, 1
    v_lshrrev_b32 v18, 1, v13
    v_accvgpr_write_b32 a248, v17
    v_mfma_f32_16x16x32_bf16 v[236:239], a[56:59], a[216:219], v[236:239]
    buffer_load_dwordx4 v173, s[8:11], s62 offen offset:1024 lds
    v_accvgpr_write_b32 a249, v17
    v_mfma_f32_16x16x32_bf16 v[138:141], a[8:11], a[220:223], v[138:141]
    s_waitcnt lgkmcnt(6)
    v_accvgpr_write_b32 a250, v17
    v_accvgpr_write_b32 a251, v17
    v_mfma_f32_16x16x32_bf16 v[142:145], a[32:35], a[220:223], v[142:145]
    s_lshl_b32 s66, s66, 2
    s_waitcnt lgkmcnt(4)
    v_xor_b32 v18, v14, v18
    v_mfma_f32_16x16x32_bf16 v[146:149], a[56:59], a[220:223], v[146:149]
    s_lshr_b32 s67, s28, 1
    s_waitcnt lgkmcnt(2)
    v_xor_b32 v18, s66, v18
    v_mfma_f32_16x16x32_bf16 v[204:207], a[12:15], a[224:227], v[204:207]
    buffer_load_dwordx4 v174, s[8:11], s62 offen offset:2048 lds
    v_mul_u32_u24 v17, 0x180, v13
    v_mfma_f32_16x16x32_bf16 v[208:211], a[36:39], a[224:227], v[208:211]
    s_add_u32 m0, s29, 0x2400
    v_lshl_add_u32 v17, v18, 4, v17
    v_lshlrev_b32 v18, 4, v16
    v_mfma_f32_16x16x32_bf16 v[212:215], a[60:63], a[224:227], v[212:215]
    s_add_u32 s62, s39, 0x24300
    v_min_u32 v20, 55, v1
    v_lshrrev_b32 v21, 1, v20
    v_mfma_f32_16x16x32_bf16 v[216:219], a[12:15], a[228:231], v[216:219]
    s_lshl_b32 s67, s67, 3
    v_add_u32 v17, s67, v17
    v_add_u32 v247, 0x7800, v17
    v_mfma_f32_16x16x32_bf16 v[220:223], a[36:39], a[228:231], v[220:223]
    buffer_load_dwordx4 v172, s[8:11], s63 offen lds
    v_add_u32 v251, 0x1e000, v17
    v_mfma_f32_16x16x32_bf16 v[224:227], a[60:63], a[228:231], v[224:227]
    s_waitcnt vmcnt(12)
    s_barrier
    v_sub_u32 v17, v14, v15
    v_mfma_f32_16x16x32_bf16 v[180:183], a[12:15], a[232:235], v[180:183]
    ds_read_b128 a[216:219], v240 offset:33792
    s_waitcnt lgkmcnt(2)
    v_mfma_f32_16x16x32_bf16 v[184:187], a[36:39], a[232:235], v[184:187]
    ds_read_b128 a[220:223], v240 offset:35328
    v_mul_i32_i24 v17, 0x1c0, v17
    v_mfma_f32_16x16x32_bf16 v[188:191], a[60:63], a[232:235], v[188:191]
    s_waitcnt lgkmcnt(2)
    v_sub_u32 v17, v17, v18
    v_max_u32 v18, s33, v15
    v_mfma_f32_16x16x32_bf16 v[192:195], a[12:15], a[236:239], v[192:195]
    ds_read_b128 a[224:227], v241 offset:33792
    v_sub_u32 v18, v14, v18
    v_mfma_f32_16x16x32_bf16 v[196:199], a[36:39], a[236:239], v[196:199]
    buffer_load_dwordx4 v173, s[8:11], s63 offen offset:1024 lds
    v_add_u32 v244, 0, v18
    v_mfma_f32_16x16x32_bf16 v[200:203], a[60:63], a[236:239], v[200:203]
    ds_read_b128 a[228:231], v241 offset:35328
    v_cmp_gt_u32 vcc, 7, v244
    v_mfma_f32_16x16x32_bf16 v[228:231], a[12:15], a[240:243], v[228:231]
    ds_read_b128 a[232:235], v240 offset:33920
    v_add_u32 v17, s37, v17
    v_mfma_f32_16x16x32_bf16 v[232:235], a[36:39], a[240:243], v[232:235]
    ds_read_b128 a[236:239], v240 offset:35456
    v_add_u32 v244, 0xfffdc870, v17
    v_mfma_f32_16x16x32_bf16 v[236:239], a[60:63], a[240:243], v[236:239]
    buffer_load_dwordx4 v174, s[8:11], s63 offen offset:2048 lds
    v_cndmask_b32 v244, 0, v244, vcc
    v_mfma_f32_16x16x32_bf16 v[138:141], a[12:15], a[244:247], v[138:141]
    s_waitcnt lgkmcnt(5)
    v_add_u32 v245, 4, v18
    v_cmp_gt_u32 vcc, 7, v245
    v_mfma_f32_16x16x32_bf16 v[142:145], a[36:39], a[244:247], v[142:145]
    ds_read_b128 a[240:243], v241 offset:33920
    v_add_u32 v245, 0xfffdcf70, v17
    v_mfma_f32_16x16x32_bf16 v[146:149], a[60:63], a[244:247], v[146:149]
    ds_read_b128 a[244:247], v241 offset:35456
    v_cndmask_b32 v245, 0, v245, vcc
    v_mfma_f32_16x16x32_bf16 v[150:153], a[0:3], a[216:219], 0
    s_waitcnt lgkmcnt(6)
    v_add_u32 v246, 8, v18
    v_cmp_gt_u32 vcc, 7, v246
    v_mfma_f32_16x16x32_bf16 v[154:157], a[24:27], a[216:219], 0
    s_add_u32 m0, s29, 0
    v_add_u32 v246, 0xfffdd670, v17
    v_cndmask_b32 v246, 0, v246, vcc
    v_mfma_f32_16x16x32_bf16 v[158:161], a[48:51], a[216:219], 0
    ds_read_b128 a[216:219], v240 offset:256
    v_cmp_lt_u32 vcc, 11, v21
    v_mfma_f32_16x16x32_bf16 v[162:165], a[0:3], a[220:223], 0
    s_waitcnt lgkmcnt(6)
    v_lshlrev_b32 v62, 3, v20
    v_add_u32 v22, -12, v21
    v_mfma_f32_16x16x32_bf16 v[24:27], a[24:27], a[220:223], 0
    s_add_u32 s63, s39, 0x2d300
    v_mov_b32 v23, s34
    v_and_b32 v20, 1, v20
    v_mfma_f32_16x16x32_bf16 v[54:57], a[48:51], a[220:223], 0
    ds_read_b128 a[220:223], v240 offset:1792
    v_cndmask_b32 v22, v21, v22, vcc
    v_mfma_f32_16x16x32_bf16 v[150:153], a[4:7], a[224:227], v[150:153]
    s_waitcnt lgkmcnt(6)
    v_cndmask_b32 v23, 0, v23, vcc
    v_lshlrev_b32 v20, 1, v20
    v_mfma_f32_16x16x32_bf16 v[154:157], a[28:31], a[224:227], v[154:157]
    s_lshl_b32 s66, s36, 1
L_h1:
    s_cbranch_execz L_h5
    s_waitcnt lgkmcnt(5)
    v_cmp_ne_u32 vcc, 0, v23
    v_mfma_f32_16x16x32_bf16 v[158:161], a[52:55], a[224:227], v[158:161]
    ds_read_b128 a[224:227], v240 offset:3328
    v_add_u32 v63, 0, v20
    v_mfma_f32_16x16x32_bf16 v[162:165], a[4:7], a[228:231], v[162:165]
    s_waitcnt lgkmcnt(5)
    v_add3_u32 v64, v22, v63, -6
    v_and_b32 v66, 12, v22
    v_mfma_f32_16x16x32_bf16 v[24:27], a[28:31], a[228:231], v[24:27]
    s_sub_u32 s66, 1, s66
    v_add_u32 v65, 3, v64
    v_add3_u32 v66, v66, v63, -3
    v_mfma_f32_16x16x32_bf16 v[54:57], a[52:55], a[228:231], v[54:57]
    ds_read_b128 a[228:231], v240 offset:4864
    v_cndmask_b32 v65, v65, v66, vcc
    v_mfma_f32_16x16x32_bf16 v[150:153], a[8:11], a[232:235], v[150:153]
    s_waitcnt vmcnt(11) lgkmcnt(5)
    ds_read_b64_tr_b16 a[16:17], v249 offset:0
    v_mfma_f32_16x16x32_bf16 v[154:157], a[32:35], a[232:235], v[154:157]
    ds_read_b64_tr_b16 a[18:19], v250 offset:0
    ds_read_b64_tr_b16 a[40:41], v249 offset:32
    v_mfma_f32_16x16x32_bf16 v[158:161], a[56:59], a[232:235], v[158:161]
    ds_read_b64_tr_b16 a[42:43], v250 offset:32
    ds_read_b64_tr_b16 a[64:65], v249 offset:64
    v_mfma_f32_16x16x32_bf16 v[162:165], a[8:11], a[236:239], v[162:165]
    ds_read_b64_tr_b16 a[66:67], v250 offset:64
    s_waitcnt lgkmcnt(9)
    v_mfma_f32_16x16x32_bf16 v[24:27], a[32:35], a[236:239], v[24:27]
    ds_read_b128 a[232:235], v240 offset:30976
    v_cmp_gt_u32 vcc, 7, v65
    v_mfma_f32_16x16x32_bf16 v[54:57], a[56:59], a[236:239], v[54:57]
    ds_read_b128 a[236:239], v240 offset:32512
    v_mul_i32_i24 v64, s66, v64
    v_mfma_f32_16x16x32_bf16 v[150:153], a[12:15], a[240:243], v[150:153]
    s_mul_i32 s64, s35, 0xfc0
    v_add_lshl_u32 v64, v64, 6, 1
    v_cndmask_b32 v50, 0, v64, vcc
    v_mfma_f32_16x16x32_bf16 v[154:157], a[36:39], a[240:243], v[154:157]
    s_add_u32 s64, s64, s37
    v_mov_b32 v64, 0x3fb8aa3b
    v_cndmask_b32 v52, 0, v64, vcc
    v_mfma_f32_16x16x32_bf16 v[158:161], a[60:63], a[240:243], v[158:161]
    ds_read_b128 a[240:243], v240 offset:34048
    v_mov_b32 v64, 0
    v_mfma_f32_16x16x32_bf16 v[162:165], a[12:15], a[244:247], v[162:165]
    s_waitcnt lgkmcnt(7)
    v_mov_b32 v65, 0xf149f2ca
    v_cndmask_b32 v60, v65, v64, vcc
    v_mfma_f32_16x16x32_bf16 v[24:27], a[36:39], a[244:247], v[24:27]
    s_mul_i32 s67, s36, 3
    s_waitcnt lgkmcnt(5)
    v_cmp_ne_u32 vcc, 0, v23
    v_mfma_f32_16x16x32_bf16 v[54:57], a[60:63], a[244:247], v[54:57]
    ds_read_b128 a[244:247], v240 offset:35584
    s_waitcnt lgkmcnt(4)
    v_mfma_f32_16x16x32_bf16 v[204:207], a[16:19], a[216:219], v[204:207]
    buffer_load_dwordx4 v172, s[8:11], s60 offen lds
    v_add_u32 v63, 1, v20
    v_mfma_f32_16x16x32_bf16 v[208:211], a[40:43], a[216:219], v[208:211]
    s_add_u32 s56, s28, 7
    v_add3_u32 v64, v22, v63, -6
    v_and_b32 v66, 12, v22
    v_mfma_f32_16x16x32_bf16 v[212:215], a[64:67], a[216:219], v[212:215]
    ds_read_b128 a[216:219], v241 offset:256
    v_add_u32 v65, 3, v64
    v_mfma_f32_16x16x32_bf16 v[216:219], a[16:19], a[220:223], v[216:219]
    s_mul_i32 s56, s56, s30
    v_add3_u32 v66, v66, v63, -3
    v_cndmask_b32 v65, v65, v66, vcc
    v_mfma_f32_16x16x32_bf16 v[220:223], a[40:43], a[220:223], v[220:223]
    buffer_load_dwordx4 v173, s[8:11], s60 offen offset:1024 lds
    v_cmp_gt_u32 vcc, 7, v65
    v_mfma_f32_16x16x32_bf16 v[224:227], a[64:67], a[220:223], v[224:227]
    s_waitcnt vmcnt(10)
    ds_read_b64_tr_b16 a[20:21], v249 offset:3072
    v_mfma_f32_16x16x32_bf16 v[180:183], a[16:19], a[224:227], v[180:183]
    ds_read_b64_tr_b16 a[22:23], v250 offset:3072
    ds_read_b64_tr_b16 a[44:45], v249 offset:3104
    v_mfma_f32_16x16x32_bf16 v[184:187], a[40:43], a[224:227], v[184:187]
    ds_read_b64_tr_b16 a[46:47], v250 offset:3104
    ds_read_b64_tr_b16 a[68:69], v249 offset:3136
    v_mfma_f32_16x16x32_bf16 v[188:191], a[64:67], a[224:227], v[188:191]
    ds_read_b64_tr_b16 a[70:71], v250 offset:3136
    s_waitcnt lgkmcnt(9)
    v_mfma_f32_16x16x32_bf16 v[192:195], a[16:19], a[228:231], v[192:195]
    buffer_load_dwordx4 v174, s[8:11], s60 offen offset:2048 lds
    v_add_u32 v62, s64, v62
    v_mfma_f32_16x16x32_bf16 v[196:199], a[40:43], a[228:231], v[196:199]
    s_add_u32 m0, s29, 0xc00
    v_mul_i32_i24 v64, s66, v64
    v_add_lshl_u32 v64, v64, 6, 1
    v_mfma_f32_16x16x32_bf16 v[200:203], a[64:67], a[228:231], v[200:203]
    s_waitcnt lgkmcnt(8)
    v_cndmask_b32 v51, 0, v64, vcc
    v_mov_b32 v64, 0x3fb8aa3b
    v_mfma_f32_16x16x32_bf16 v[228:231], a[16:19], a[232:235], v[228:231]
    ds_read_b128 a[220:223], v241 offset:1792
    v_cndmask_b32 v53, 0, v64, vcc
    v_mfma_f32_16x16x32_bf16 v[232:235], a[40:43], a[232:235], v[232:235]
    s_waitcnt lgkmcnt(8)
    v_mov_b32 v64, 0
    v_mov_b32 v65, 0xf149f2ca
    v_mfma_f32_16x16x32_bf16 v[236:239], a[64:67], a[232:235], v[236:239]
    ds_read_b128 a[224:227], v241 offset:3328
    v_cndmask_b32 v61, v65, v64, vcc
    v_mfma_f32_16x16x32_bf16 v[138:141], a[16:19], a[236:239], v[138:141]
    ds_read_b128 a[228:231], v241 offset:4864
    v_lshlrev_b32 v63, 3, v1
    v_mfma_f32_16x16x32_bf16 v[142:145], a[40:43], a[236:239], v[142:145]
    ds_read_b128 a[232:235], v241 offset:30976
    s_waitcnt lgkmcnt(4)
    v_mfma_f32_16x16x32_bf16 v[146:149], a[64:67], a[236:239], v[146:149]
    buffer_load_dwordx4 v172, s[8:11], s61 offen lds
    v_mov_b32 v64, 0xf149f2ca
    v_mfma_f32_16x16x32_bf16 v[150:153], a[16:19], a[240:243], v[150:153]
    s_waitcnt vmcnt(7)
    ds_read_b64_tr_b16 a[72:73], v249 offset:6144
    v_mfma_f32_16x16x32_bf16 v[154:157], a[40:43], a[240:243], v[154:157]
    ds_read_b64_tr_b16 a[74:75], v250 offset:6144
    ds_read_b64_tr_b16 a[96:97], v249 offset:6176
    v_mfma_f32_16x16x32_bf16 v[158:161], a[64:67], a[240:243], v[158:161]
    ds_read_b64_tr_b16 a[98:99], v250 offset:6176
    ds_read_b64_tr_b16 a[120:121], v249 offset:6208
    v_mfma_f32_16x16x32_bf16 v[162:165], a[16:19], a[244:247], v[162:165]
    ds_read_b64_tr_b16 a[122:123], v250 offset:6208
    buffer_load_dwordx4 v173, s[8:11], s61 offen offset:1024 lds
    v_mfma_f32_16x16x32_bf16 v[24:27], a[40:43], a[244:247], v[24:27]
    ds_read_b128 a[236:239], v241 offset:32512
    v_mov_b32 v65, 0xf149f2ca
    v_mfma_f32_16x16x32_bf16 v[54:57], a[64:67], a[244:247], v[54:57]
    ds_read_b128 a[240:243], v241 offset:34048
    v_add_u32 v63, 0x237c0, v63
    v_mfma_f32_16x16x32_bf16 v[204:207], a[20:23], a[216:219], v[204:207]
    s_waitcnt lgkmcnt(11)
    v_mbcnt_lo_u32_b32 v67, -1, 0
    v_mbcnt_hi_u32_b32 v67, -1, v67
    v_mfma_f32_16x16x32_bf16 v[208:211], a[44:47], a[216:219], v[208:211]
    buffer_load_dwordx4 v174, s[8:11], s61 offen offset:2048 lds
    s_add_u32 m0, s29, 0x1800
    v_mfma_f32_16x16x32_bf16 v[212:215], a[68:71], a[216:219], v[212:215]
    ds_read_b128 a[244:247], v241 offset:35584
    v_cvt_pk_bf16_f32 v102, v204, v205
    v_mfma_f32_16x16x32_bf16 v[216:219], a[20:23], a[220:223], v[216:219]
    s_waitcnt lgkmcnt(11)
    v_cvt_pk_bf16_f32 v103, v206, v207
    v_cvt_pk_bf16_f32 v104, v208, v209
    v_mfma_f32_16x16x32_bf16 v[220:223], a[44:47], a[220:223], v[220:223]
    s_waitcnt lgkmcnt(10)
    v_cvt_pk_bf16_f32 v105, v210, v211
    v_cvt_pk_bf16_f32 v106, v212, v213
    v_mfma_f32_16x16x32_bf16 v[224:227], a[68:71], a[220:223], v[224:227]
    s_waitcnt lgkmcnt(9)
    s_waitcnt lgkmcnt(3)
    v_cvt_pk_bf16_f32 v107, v214, v215
    v_mfma_f32_16x16x32_bf16 v[180:183], a[20:23], a[224:227], v[180:183]
    buffer_load_dwordx4 v172, s[8:11], s62 offen lds
    v_cvt_pk_bf16_f32 v108, v216, v217
    v_mfma_f32_16x16x32_bf16 v[184:187], a[44:47], a[224:227], v[184:187]
    s_waitcnt vmcnt(7)
    ds_read_b64_tr_b16 a[76:77], v249 offset:9216
    v_mfma_f32_16x16x32_bf16 v[188:191], a[68:71], a[224:227], v[188:191]
    ds_read_b64_tr_b16 a[78:79], v250 offset:9216
    ds_read_b64_tr_b16 a[100:101], v249 offset:9248
    v_mfma_f32_16x16x32_bf16 v[192:195], a[20:23], a[228:231], v[192:195]
    ds_read_b64_tr_b16 a[102:103], v250 offset:9248
    ds_read_b64_tr_b16 a[124:125], v249 offset:9280
    v_mfma_f32_16x16x32_bf16 v[196:199], a[44:47], a[228:231], v[196:199]
    ds_read_b64_tr_b16 a[126:127], v250 offset:9280
    buffer_load_dwordx4 v173, s[8:11], s62 offen offset:1024 lds
    v_mfma_f32_16x16x32_bf16 v[200:203], a[68:71], a[228:231], v[200:203]
    s_waitcnt lgkmcnt(8)
    ds_read_b128 a[216:219], v240 offset:0
    v_mfma_f32_16x16x32_bf16 v[228:231], a[20:23], a[232:235], v[228:231]
    s_waitcnt lgkmcnt(8)
    v_cvt_pk_bf16_f32 v109, v218, v219
    v_cvt_pk_bf16_f32 v110, v220, v221
    v_mfma_f32_16x16x32_bf16 v[232:235], a[44:47], a[232:235], v[232:235]
    ds_read_b128 a[220:223], v240 offset:1536
    v_cvt_pk_bf16_f32 v111, v222, v223
    v_mfma_f32_16x16x32_bf16 v[236:239], a[68:71], a[232:235], v[236:239]
    buffer_load_dwordx4 v174, s[8:11], s62 offen offset:2048 lds
    s_add_u32 m0, s29, 0x2400
    v_mfma_f32_16x16x32_bf16 v[138:141], a[20:23], a[236:239], v[138:141]
    s_waitcnt lgkmcnt(8)
    v_cvt_pk_bf16_f32 v112, v224, v225
    v_cvt_pk_bf16_f32 v113, v226, v227
    v_mfma_f32_16x16x32_bf16 v[142:145], a[44:47], a[236:239], v[142:145]
    ds_read_b128 a[224:227], v240 offset:3072
    v_cvt_pk_bf16_f32 v90, v180, v181
    v_mfma_f32_16x16x32_bf16 v[146:149], a[68:71], a[236:239], v[146:149]
    ds_read_b128 a[228:231], v240 offset:4608
    v_cvt_pk_bf16_f32 v91, v182, v183
    v_mfma_f32_16x16x32_bf16 v[150:153], a[20:23], a[240:243], v[150:153]
    ds_read_b128 a[232:235], v240 offset:30720
    s_waitcnt lgkmcnt(5)
    v_mfma_f32_16x16x32_bf16 v[154:157], a[44:47], a[240:243], v[154:157]
    buffer_load_dwordx4 v172, s[8:11], s63 offen lds
    v_cvt_pk_bf16_f32 v92, v184, v185
    v_mfma_f32_16x16x32_bf16 v[158:161], a[68:71], a[240:243], v[158:161]
    ds_read_b128 a[236:239], v240 offset:32256
    v_cvt_pk_bf16_f32 v93, v186, v187
    v_mfma_f32_16x16x32_bf16 v[162:165], a[20:23], a[244:247], v[162:165]
    s_waitcnt lgkmcnt(5)
    v_cvt_pk_bf16_f32 v94, v188, v189
    v_cvt_pk_bf16_f32 v95, v190, v191
    v_mfma_f32_16x16x32_bf16 v[24:27], a[44:47], a[244:247], v[24:27]
    ds_read_b128 a[240:243], v240 offset:33792
    v_cvt_pk_bf16_f32 v96, v192, v193
    v_mfma_f32_16x16x32_bf16 v[54:57], a[68:71], a[244:247], v[54:57]
    buffer_load_dwordx4 v173, s[8:11], s63 offen offset:1024 lds
    v_cvt_pk_bf16_f32 v97, v194, v195
    v_mfma_f32_16x16x32_bf16 v[84:87], a[216:219], a[72:75], 0
    s_waitcnt lgkmcnt(5)
    v_cvt_pk_bf16_f32 v98, v196, v197
    v_cvt_pk_bf16_f32 v99, v198, v199
    v_mfma_f32_16x16x32_bf16 v[204:207], a[216:219], a[96:99], 0
    ds_read_b128 a[244:247], v240 offset:35328
    v_cvt_pk_bf16_f32 v100, v200, v201
    v_mfma_f32_16x16x32_bf16 v[208:211], a[216:219], a[120:123], 0
    s_add_u32 s60, s39, 0
    v_cvt_pk_bf16_f32 v101, v202, v203
    v_cvt_pk_bf16_f32 v114, v228, v229
    v_mfma_f32_16x16x32_bf16 v[212:215], a[220:223], a[72:75], 0
    buffer_load_dwordx4 v174, s[8:11], s63 offen offset:2048 lds
    s_waitcnt lgkmcnt(5)
    v_mfma_f32_16x16x32_bf16 v[216:219], a[220:223], a[96:99], 0
    s_add_u32 m0, s46, 0x1800
    v_cvt_pk_bf16_f32 v115, v230, v231
    v_cvt_pk_bf16_f32 v116, v232, v233
    v_mfma_f32_16x16x32_bf16 v[220:223], a[220:223], a[120:123], 0
    ds_read_b128 a[216:219], v241 offset:0
    v_cvt_pk_bf16_f32 v117, v234, v235
    v_mfma_f32_16x16x32_bf16 v[224:227], a[224:227], a[72:75], 0
    s_waitcnt lgkmcnt(5)
    v_cvt_pk_bf16_f32 v118, v236, v237
    v_cvt_pk_bf16_f32 v119, v238, v239
    v_mfma_f32_16x16x32_bf16 v[180:183], a[224:227], a[96:99], 0
    buffer_load_dwordx4 v168, s[4:7], s58 offen lds
    s_waitcnt lgkmcnt(4)
    v_mfma_f32_16x16x32_bf16 v[184:187], a[224:227], a[120:123], 0
    s_and_b32 s64, s48, 15
    v_cvt_pk_bf16_f32 v120, v138, v139
    v_cvt_pk_bf16_f32 v121, v140, v141
    v_mfma_f32_16x16x32_bf16 v[188:191], a[228:231], a[72:75], 0
    s_add_u32 s64, s64, s37
    s_waitcnt lgkmcnt(3)
    v_cvt_pk_bf16_f32 v122, v142, v143
    v_mfma_f32_16x16x32_bf16 v[192:195], a[228:231], a[96:99], 0
    ds_read_b128 a[220:223], v241 offset:1536
    v_cvt_pk_bf16_f32 v123, v144, v145
    v_mfma_f32_16x16x32_bf16 v[196:199], a[228:231], a[120:123], 0
    buffer_load_dwordx4 v171, s[4:7], s58 offen offset:512 lds
    v_cvt_pk_bf16_f32 v124, v146, v147
    v_mfma_f32_16x16x32_bf16 v[200:203], a[232:235], a[72:75], 0
    s_add_u32 m0, s46, 0x9000
    v_cvt_pk_bf16_f32 v125, v148, v149
    s_waitcnt lgkmcnt(3)
    v_mfma_f32_16x16x32_bf16 v[228:231], a[232:235], a[96:99], 0
    s_lshl1_add_u32 s58, s45, s41
    v_cvt_pk_bf16_f32 v126, v150, v151
    v_cvt_pk_bf16_f32 v127, v152, v153
    v_mfma_f32_16x16x32_bf16 v[232:235], a[232:235], a[120:123], 0
    s_add_u32 s61, s39, 0x9000
    v_cvt_pk_bf16_f32 v128, v154, v155
    v_cvt_pk_bf16_f32 v129, v156, v157
    v_mfma_f32_16x16x32_bf16 v[236:239], a[236:239], a[72:75], 0
    buffer_load_dwordx4 v168, s[4:7], s58 offen lds
    v_cvt_pk_bf16_f32 v130, v158, v159
    v_mfma_f32_16x16x32_bf16 v[138:141], a[236:239], a[96:99], 0
    ds_read_b128 a[224:227], v241 offset:3072
    v_cvt_pk_bf16_f32 v131, v160, v161
    v_mfma_f32_16x16x32_bf16 v[142:145], a[236:239], a[120:123], 0
    s_waitcnt lgkmcnt(3)
    v_cvt_pk_bf16_f32 v132, v162, v163
    v_cvt_pk_bf16_f32 v133, v164, v165
    v_mfma_f32_16x16x32_bf16 v[146:149], a[240:243], a[72:75], 0
    s_add_u32 s62, s39, 0x12000
    v_cvt_pk_bf16_f32 v134, v24, v25
    v_cvt_pk_bf16_f32 v135, v26, v27
    v_mfma_f32_16x16x32_bf16 v[150:153], a[240:243], a[96:99], 0
    buffer_load_dwordx4 v171, s[4:7], s58 offen offset:512 lds
    s_waitcnt lgkmcnt(2)
    v_mfma_f32_16x16x32_bf16 v[154:157], a[240:243], a[120:123], 0
    ds_read_b128 a[228:231], v241 offset:4608
    v_add_u32 v50, s64, v50
    v_mfma_f32_16x16x32_bf16 v[158:161], a[244:247], a[72:75], 0
    s_add_u32 m0, s46, 0xf000
    v_add_u32 v51, s64, v51
    v_lshrrev_b32 v68, 1, v67
    v_mfma_f32_16x16x32_bf16 v[162:165], a[244:247], a[96:99], 0
    ds_read_b128 a[232:235], v241 offset:30720
    v_add_u32 v68, 0, v68
    v_mfma_f32_16x16x32_bf16 v[24:27], a[244:247], a[120:123], 0
    ds_read_b128 a[236:239], v241 offset:32256
    s_waitcnt lgkmcnt(4)
    v_mfma_f32_16x16x32_bf16 v[84:87], a[216:219], a[76:79], v[84:87]
    buffer_load_dwordx4 v168, s[4:7], s42 offen lds
    v_mul_u32_u24 v69, 43, v68
    v_mfma_f32_16x16x32_bf16 v[204:207], a[216:219], a[100:103], v[204:207]
    ds_read_b128 a[240:243], v241 offset:33792
    v_lshrrev_b32 v70, 8, v69
    v_mfma_f32_16x16x32_bf16 v[208:211], a[216:219], a[124:127], v[208:211]
    ds_read_b128 a[244:247], v241 offset:35328
    v_lshrrev_b32 v69, 7, v69
    v_mfma_f32_16x16x32_bf16 v[212:215], a[220:223], a[76:79], v[212:215]
    s_waitcnt lgkmcnt(5)
    v_mad_i32_i24 v68, v69, -3, v68
    v_and_b32 v70, 4, v70
    v_mfma_f32_16x16x32_bf16 v[216:219], a[220:223], a[100:103], v[216:219]
    buffer_load_dwordx4 v169, s[4:7], s42 offen offset:1024 lds
    v_xor_b32 v69, v69, v70
    v_mfma_f32_16x16x32_bf16 v[220:223], a[220:223], a[124:127], v[220:223]
    ds_read_b128 a[216:219], v240 offset:128
    v_and_b32 v70, 4, v69
    v_mfma_f32_16x16x32_bf16 v[224:227], a[224:227], a[76:79], v[224:227]
    s_waitcnt lgkmcnt(5)
    v_mul_u32_u24 v252, 24, v70
    v_lshrrev_b32 v70, 3, v69
    v_mfma_f32_16x16x32_bf16 v[180:183], a[224:227], a[100:103], v[180:183]
    ds_read_b128 a[220:223], v240 offset:1664
    v_lshl_add_u32 v252, v70, 2, v252
    v_mfma_f32_16x16x32_bf16 v[184:187], a[224:227], a[124:127], v[184:187]
    buffer_load_dwordx4 v170, s[4:7], s42 offen offset:2048 lds
    v_and_or_b32 v252, v69, 3, v252
    v_mfma_f32_16x16x32_bf16 v[188:191], a[228:231], a[76:79], v[188:191]
    s_waitcnt lgkmcnt(5)
    v_mad_u32_u24 v252, v252, 3, v68
    v_lshrrev_b32 v68, 1, v67
    v_mfma_f32_16x16x32_bf16 v[192:195], a[228:231], a[100:103], v[192:195]
    s_add_u32 m0, s46, 0xfc00
    v_and_b32 v70, 1, v67
    v_add_u32 v68, 32, v68
    v_mfma_f32_16x16x32_bf16 v[196:199], a[228:231], a[124:127], v[196:199]
    ds_read_b128 a[224:227], v240 offset:3200
    v_lshl_add_u32 v252, v252, 3, v70
    v_mfma_f32_16x16x32_bf16 v[200:203], a[232:235], a[76:79], v[200:203]
    s_waitcnt vmcnt(16) lgkmcnt(5)
    ds_read_b64_tr_b16 a[80:81], v249 offset:0
    v_mfma_f32_16x16x32_bf16 v[228:231], a[232:235], a[100:103], v[228:231]
    ds_read_b64_tr_b16 a[82:83], v250 offset:0
    buffer_load_dwordx4 v168, s[4:7], s59 offen lds
    v_mfma_f32_16x16x32_bf16 v[232:235], a[232:235], a[124:127], v[232:235]
    ds_read_b64_tr_b16 a[104:105], v249 offset:32
    ds_read_b64_tr_b16 a[106:107], v250 offset:32
    v_mfma_f32_16x16x32_bf16 v[236:239], a[236:239], a[76:79], v[236:239]
    ds_read_b64_tr_b16 a[128:129], v249 offset:64
    ds_read_b64_tr_b16 a[130:131], v250 offset:64
    v_mfma_f32_16x16x32_bf16 v[138:141], a[236:239], a[100:103], v[138:141]
    s_waitcnt lgkmcnt(9)
    v_mul_u32_u24 v69, 43, v68
    v_lshrrev_b32 v70, 8, v69
    v_mfma_f32_16x16x32_bf16 v[142:145], a[236:239], a[124:127], v[142:145]
    buffer_load_dwordx4 v169, s[4:7], s59 offen offset:1024 lds
    v_lshrrev_b32 v69, 7, v69
    v_mfma_f32_16x16x32_bf16 v[146:149], a[240:243], a[76:79], v[146:149]
    ds_read_b128 a[228:231], v240 offset:4736
    v_mad_i32_i24 v68, v69, -3, v68
    v_mfma_f32_16x16x32_bf16 v[150:153], a[240:243], a[100:103], v[150:153]
    ds_read_b128 a[232:235], v240 offset:30848
    v_and_b32 v70, 4, v70
    v_mfma_f32_16x16x32_bf16 v[154:157], a[240:243], a[124:127], v[154:157]
    ds_read_b128 a[236:239], v240 offset:32384
    v_xor_b32 v69, v69, v70
    v_mfma_f32_16x16x32_bf16 v[158:161], a[244:247], a[76:79], v[158:161]
    s_waitcnt lgkmcnt(7)
    v_and_b32 v70, 4, v69
    v_mul_u32_u24 v253, 24, v70
    v_mfma_f32_16x16x32_bf16 v[162:165], a[244:247], a[100:103], v[162:165]
    ds_read_b128 a[240:243], v240 offset:33920
    s_waitcnt lgkmcnt(6)
    v_mfma_f32_16x16x32_bf16 v[24:27], a[244:247], a[124:127], v[24:27]
    ds_read_b128 a[244:247], v240 offset:35456
    v_lshrrev_b32 v70, 3, v69
    v_mfma_f32_16x16x32_bf16 v[84:87], a[216:219], a[80:83], v[84:87]
    s_waitcnt lgkmcnt(5)
    v_lshl_add_u32 v253, v70, 2, v253
    v_and_b32 v70, 1, v67
    v_mfma_f32_16x16x32_bf16 v[204:207], a[216:219], a[104:107], v[204:207]
    buffer_load_dwordx4 v170, s[4:7], s59 offen offset:2048 lds
    v_cvt_pk_bf16_f32 v136, v54, v55
    v_mfma_f32_16x16x32_bf16 v[208:211], a[216:219], a[128:131], v[208:211]
    ds_read_b128 a[216:219], v241 offset:128
    v_cvt_pk_bf16_f32 v137, v56, v57
    v_mfma_f32_16x16x32_bf16 v[212:215], a[220:223], a[80:83], v[212:215]
    s_add_u32 m0, s46, 0x10800
    v_and_or_b32 v253, v69, 3, v253
    v_mad_u32_u24 v253, v253, 3, v68
    v_mfma_f32_16x16x32_bf16 v[216:219], a[220:223], a[104:107], v[216:219]
    s_lshl1_add_u32 s58, s45, s42
    v_lshl_add_u32 v253, v253, 3, v70
    v_xor_b32 v243, 64, v242
    v_mfma_f32_16x16x32_bf16 v[220:223], a[220:223], a[128:131], v[220:223]
    ds_read_b128 a[220:223], v241 offset:1664
    v_add_u32 v244, 0x237c0, v244
    v_mfma_f32_16x16x32_bf16 v[224:227], a[224:227], a[80:83], v[224:227]
    s_waitcnt lgkmcnt(6)
    v_add_u32 v245, 0x237c0, v245
    v_add_u32 v246, 0x237c0, v246
    v_mfma_f32_16x16x32_bf16 v[180:183], a[224:227], a[104:107], v[180:183]
    buffer_load_dwordx4 v168, s[4:7], s58 offen lds
    v_accvgpr_write_b32 a252, v168
    v_mfma_f32_16x16x32_bf16 v[184:187], a[224:227], a[128:131], v[184:187]
    ds_read_b128 a[224:227], v241 offset:3200
    s_waitcnt lgkmcnt(6)
    v_mfma_f32_16x16x32_bf16 v[188:191], a[228:231], a[80:83], v[188:191]
    ds_read_u16 v30, v50 offset:3456
    s_waitcnt lgkmcnt(6)
    v_mfma_f32_16x16x32_bf16 v[192:195], a[228:231], a[104:107], v[192:195]
    ds_read_u16 v31, v51 offset:3456
    v_accvgpr_write_b32 a253, v169
    v_mfma_f32_16x16x32_bf16 v[196:199], a[228:231], a[128:131], v[196:199]
    ds_read_b128 a[228:231], v241 offset:4736
    v_accvgpr_write_b32 a254, v170
    v_mfma_f32_16x16x32_bf16 v[200:203], a[232:235], a[80:83], v[200:203]
    s_waitcnt vmcnt(17) lgkmcnt(7)
    ds_read_b64_tr_b16 a[84:85], v249 offset:3072
    v_mfma_f32_16x16x32_bf16 v[228:231], a[232:235], a[104:107], v[228:231]
    ds_read_b64_tr_b16 a[86:87], v250 offset:3072
    ds_read_b64_tr_b16 a[108:109], v249 offset:3104
    v_mfma_f32_16x16x32_bf16 v[232:235], a[232:235], a[128:131], v[232:235]
    ds_read_b64_tr_b16 a[110:111], v250 offset:3104
    ds_read_b64_tr_b16 a[132:133], v249 offset:3136
    v_mfma_f32_16x16x32_bf16 v[236:239], a[236:239], a[80:83], v[236:239]
    ds_read_b64_tr_b16 a[134:135], v250 offset:3136
    s_waitcnt lgkmcnt(11)
    v_mfma_f32_16x16x32_bf16 v[138:141], a[236:239], a[104:107], v[138:141]
    ds_read_b128 a[232:235], v241 offset:30848
    v_accvgpr_write_b32 a255, v171
    v_mfma_f32_16x16x32_bf16 v[142:145], a[236:239], a[128:131], v[142:145]
    ds_read_b128 a[236:239], v241 offset:32384
    v_accvgpr_read_b32 v254, a252
    v_mfma_f32_16x16x32_bf16 v[146:149], a[240:243], a[80:83], v[146:149]
    buffer_load_dwordx4 v171, s[4:7], s58 offen offset:512 lds
    v_accvgpr_read_b32 v255, a253
    v_mfma_f32_16x16x32_bf16 v[150:153], a[240:243], a[104:107], v[150:153]
    s_add_u32 m0, s29, 0
    v_mov_b32 v248, 0
    v_lshlrev_b32 v252, 4, v252
    v_mfma_f32_16x16x32_bf16 v[154:157], a[240:243], a[128:131], v[154:157]
    ds_read_b128 a[240:243], v241 offset:33920
    v_lshlrev_b32 v253, 4, v253
    v_mfma_f32_16x16x32_bf16 v[158:161], a[244:247], a[80:83], v[158:161]
    s_waitcnt lgkmcnt(7)
    v_lshlrev_b32 v30, 16, v30
    v_lshlrev_b32 v31, 16, v31
    v_mfma_f32_16x16x32_bf16 v[162:165], a[244:247], a[104:107], v[162:165]
    buffer_load_dwordx4 v172, s[8:11], s60 offen lds
    s_waitcnt lgkmcnt(5)
    v_mfma_f32_16x16x32_bf16 v[24:27], a[244:247], a[128:131], v[24:27]
    ds_read_b128 a[244:247], v241 offset:35456
    s_waitcnt lgkmcnt(4)
    v_mfma_f32_16x16x32_bf16 v[84:87], a[216:219], a[84:87], v[84:87]
    ds_read_u16 v32, v50 offset:3482
    v_fma_f32 v30, v30, v52, v60
    v_mfma_f32_16x16x32_bf16 v[204:207], a[216:219], a[108:111], v[204:207]
    ds_read_u16 v33, v51 offset:3482
    v_fma_f32 v31, v31, v53, v61
    v_mfma_f32_16x16x32_bf16 v[208:211], a[216:219], a[132:135], v[208:211]
    ds_read_b128 a[216:219], v240 offset:256
    v_add_u32 v253, 0xfffffc00, v253
    v_mfma_f32_16x16x32_bf16 v[212:215], a[220:223], a[84:87], v[212:215]
    ds_read_u16 v34, v50 offset:3508
    ds_read_u16 v35, v51 offset:3508
    v_mfma_f32_16x16x32_bf16 v[216:219], a[220:223], a[108:111], v[216:219]
    ds_read_u16 v37, v51 offset:3534
    ds_read_u16 v39, v51 offset:3560
    v_mfma_f32_16x16x32_bf16 v[220:223], a[220:223], a[132:135], v[220:223]
    s_waitcnt lgkmcnt(10)
    ds_read_b128 a[220:223], v240 offset:1792
    v_mfma_f32_16x16x32_bf16 v[224:227], a[224:227], a[84:87], v[224:227]
    s_waitcnt lgkmcnt(10)
    buffer_load_dwordx4 v173, s[8:11], s60 offen offset:1024 lds
    v_mfma_f32_16x16x32_bf16 v[180:183], a[224:227], a[108:111], v[180:183]
    ds_read_u16 v41, v51 offset:3586
    ds_read_u16 v43, v51 offset:3612
    v_mfma_f32_16x16x32_bf16 v[184:187], a[224:227], a[132:135], v[184:187]
    ds_read_b128 a[224:227], v240 offset:3328
    ds_read_u16 v45, v51 offset:3638
    v_mfma_f32_16x16x32_bf16 v[188:191], a[228:231], a[84:87], v[188:191]
    s_waitcnt lgkmcnt(13)
    ds_read_u16 v47, v51 offset:3664
    v_mfma_f32_16x16x32_bf16 v[192:195], a[228:231], a[108:111], v[192:195]
    ds_read_u16 v49, v51 offset:3690
    ds_read_u16 v36, v50 offset:3534
    v_mfma_f32_16x16x32_bf16 v[196:199], a[228:231], a[132:135], v[196:199]
    ds_read_b128 a[228:231], v240 offset:4864
    ds_read_u16 v38, v50 offset:3560
    v_mfma_f32_16x16x32_bf16 v[200:203], a[232:235], a[84:87], v[200:203]
    s_waitcnt vmcnt(17)
    ds_read_b64_tr_b16 a[88:89], v249 offset:6144
    v_mfma_f32_16x16x32_bf16 v[228:231], a[232:235], a[108:111], v[228:231]
    ds_read_b64_tr_b16 a[90:91], v250 offset:6144
    ds_read_b64_tr_b16 a[112:113], v249 offset:6176
    v_mfma_f32_16x16x32_bf16 v[232:235], a[232:235], a[132:135], v[232:235]
    ds_read_b64_tr_b16 a[114:115], v250 offset:6176
    ds_read_b64_tr_b16 a[136:137], v249 offset:6208
    v_mfma_f32_16x16x32_bf16 v[236:239], a[236:239], a[84:87], v[236:239]
    ds_read_b64_tr_b16 a[138:139], v250 offset:6208
    ds_read_b128 a[232:235], v240 offset:30976
    v_mfma_f32_16x16x32_bf16 v[138:141], a[236:239], a[108:111], v[138:141]
    buffer_load_dwordx4 v174, s[8:11], s60 offen offset:2048 lds
    s_add_u32 m0, s29, 0xc00
    v_mfma_f32_16x16x32_bf16 v[142:145], a[236:239], a[132:135], v[142:145]
    ds_read_b128 a[236:239], v240 offset:32512
    ds_read_u16 v40, v50 offset:3586
    v_mfma_f32_16x16x32_bf16 v[146:149], a[240:243], a[84:87], v[146:149]
    ds_read_u16 v42, v50 offset:3612
    ds_read_u16 v44, v50 offset:3638
    v_mfma_f32_16x16x32_bf16 v[150:153], a[240:243], a[108:111], v[150:153]
    ds_read_u16 v46, v50 offset:3664
    ds_read_u16 v48, v50 offset:3690
    v_mfma_f32_16x16x32_bf16 v[154:157], a[240:243], a[132:135], v[154:157]
    s_waitcnt vmcnt(11) lgkmcnt(13)
    v_lshlrev_b32 v32, 16, v32
    v_lshlrev_b32 v33, 16, v33
    v_mfma_f32_16x16x32_bf16 v[158:161], a[244:247], a[84:87], v[158:161]
    s_waitcnt lgkmcnt(11)
    v_fma_f32 v32, v32, v52, v60
    v_fma_f32 v33, v33, v53, v61
    v_mfma_f32_16x16x32_bf16 v[162:165], a[244:247], a[108:111], v[162:165]
    s_waitcnt lgkmcnt(9)
    v_lshlrev_b32 v34, 16, v34
    v_lshlrev_b32 v35, 16, v35
    v_mfma_f32_16x16x32_bf16 v[24:27], a[244:247], a[132:135], v[24:27]
    s_waitcnt lgkmcnt(7)
    v_fma_f32 v34, v34, v52, v60
    v_fma_f32 v35, v35, v53, v61
    v_mfma_f32_16x16x32_bf16 v[84:87], a[216:219], a[88:91], v[84:87]
    ds_read_b128 a[240:243], v240 offset:34048
    v_lshlrev_b32 v37, 16, v37
    v_mfma_f32_16x16x32_bf16 v[204:207], a[216:219], a[112:115], v[204:207]
    ds_read_b128 a[244:247], v240 offset:35584
    v_lshlrev_b32 v39, 16, v39
    v_mfma_f32_16x16x32_bf16 v[208:211], a[216:219], a[136:139], v[208:211]
    ds_read_b64_tr_b16 a[92:93], v249 offset:9216
    v_lshlrev_b32 v41, 16, v41
    v_mfma_f32_16x16x32_bf16 v[212:215], a[220:223], a[88:91], v[212:215]
    ds_read_b64_tr_b16 a[94:95], v250 offset:9216
    v_lshlrev_b32 v43, 16, v43
    v_mfma_f32_16x16x32_bf16 v[216:219], a[220:223], a[112:115], v[216:219]
    ds_read_b128 a[216:219], v241 offset:256
    v_lshlrev_b32 v45, 16, v45
    v_mfma_f32_16x16x32_bf16 v[220:223], a[220:223], a[136:139], v[220:223]
    s_waitcnt lgkmcnt(11)
    v_lshlrev_b32 v47, 16, v47
    v_lshlrev_b32 v49, 16, v49
    v_mfma_f32_16x16x32_bf16 v[224:227], a[224:227], a[88:91], v[224:227]
    s_waitcnt lgkmcnt(10)
    v_fma_f32 v37, v37, v53, v61
    v_fma_f32 v39, v39, v53, v61
    v_mfma_f32_16x16x32_bf16 v[180:183], a[224:227], a[112:115], v[180:183]
    ds_read_b64_tr_b16 a[116:117], v249 offset:9248
    v_fma_f32 v41, v41, v53, v61
    v_mfma_f32_16x16x32_bf16 v[184:187], a[224:227], a[136:139], v[184:187]
    ds_read_b64_tr_b16 a[118:119], v250 offset:9248
    v_fma_f32 v43, v43, v53, v61
    v_mfma_f32_16x16x32_bf16 v[188:191], a[228:231], a[88:91], v[188:191]
    ds_read_b64_tr_b16 a[140:141], v249 offset:9280
    v_fma_f32 v45, v45, v53, v61
    v_mfma_f32_16x16x32_bf16 v[192:195], a[228:231], a[112:115], v[192:195]
    ds_read_b64_tr_b16 a[142:143], v250 offset:9280
    v_fma_f32 v47, v47, v53, v61
    v_mfma_f32_16x16x32_bf16 v[196:199], a[228:231], a[136:139], v[196:199]
    ds_read_b128 a[220:223], v241 offset:1792
    v_fma_f32 v49, v49, v53, v61
    v_mfma_f32_16x16x32_bf16 v[200:203], a[232:235], a[88:91], v[200:203]
    ds_read_b128 a[224:227], v241 offset:3328
    v_lshlrev_b32 v36, 16, v36
    v_mfma_f32_16x16x32_bf16 v[228:231], a[232:235], a[112:115], v[228:231]
    ds_read_b128 a[228:231], v241 offset:4864
    s_waitcnt lgkmcnt(11)
    v_mfma_f32_16x16x32_bf16 v[232:235], a[232:235], a[136:139], v[232:235]
    ds_read_b128 a[232:235], v241 offset:30976
    v_fma_f32 v36, v36, v52, v60
    v_mfma_f32_16x16x32_bf16 v[236:239], a[236:239], a[88:91], v[236:239]
    s_waitcnt lgkmcnt(11)
    v_lshlrev_b32 v38, 16, v38
    v_fma_f32 v38, v38, v52, v60
    v_mfma_f32_16x16x32_bf16 v[138:141], a[236:239], a[112:115], v[138:141]
    s_barrier
    v_lshlrev_b32 v40, 16, v40
L_h2:
    s_cbranch_execz L_h6
    v_fma_f32 v40, v40, v52, v60
    v_mfma_f32_16x16x32_bf16 v[142:145], a[236:239], a[136:139], v[142:145]
    ds_read_b128 a[236:239], v241 offset:32512
    v_lshlrev_b32 v42, 16, v42
    v_mfma_f32_16x16x32_bf16 v[146:149], a[240:243], a[88:91], v[146:149]
    s_waitcnt lgkmcnt(9)
    v_fma_f32 v42, v42, v52, v60
    v_lshlrev_b32 v44, 16, v44
    v_mfma_f32_16x16x32_bf16 v[150:153], a[240:243], a[112:115], v[150:153]
    buffer_load_dwordx4 v172, s[8:11], s61 offen lds
    v_fma_f32 v44, v44, v52, v60
    v_mfma_f32_16x16x32_bf16 v[154:157], a[240:243], a[136:139], v[154:157]
    ds_read_b128 a[240:243], v241 offset:34048
    v_lshlrev_b32 v46, 16, v46
    v_mfma_f32_16x16x32_bf16 v[158:161], a[244:247], a[88:91], v[158:161]
    ds_write_b64 v62, v[30:31] offset:0
    v_mfma_f32_16x16x32_bf16 v[162:165], a[244:247], a[112:115], v[162:165]
    s_waitcnt lgkmcnt(8)
    v_add_u32 v62, s49, v62
    v_fma_f32 v46, v46, v52, v60
    v_mfma_f32_16x16x32_bf16 v[24:27], a[244:247], a[136:139], v[24:27]
    s_waitcnt lgkmcnt(7)
    v_lshlrev_b32 v48, 16, v48
    v_fma_f32 v48, v48, v52, v60
    v_mfma_f32_16x16x32_bf16 v[84:87], a[216:219], a[92:95], v[84:87]
    s_waitcnt lgkmcnt(6)
    ds_read_b128 a[244:247], v241 offset:35584
    v_mfma_f32_16x16x32_bf16 v[204:207], a[216:219], a[116:119], v[204:207]
    s_waitcnt lgkmcnt(6)
    s_add_u32 s63, s39, 0x1b000
    s_add_u32 s60, s39, 0x24000
    v_mfma_f32_16x16x32_bf16 v[208:211], a[216:219], a[140:143], v[208:211]
    s_waitcnt lgkmcnt(5)
    v_cvt_pk_bf16_f32 v0, v84, v85
    v_cvt_pk_bf16_f32 v3, v86, v87
    v_mfma_f32_16x16x32_bf16 v[212:215], a[220:223], a[92:95], v[212:215]
    s_waitcnt lgkmcnt(4)
    v_cvt_pk_bf16_f32 v30, v204, v205
    s_add_u32 s59, s43, s45
    v_mfma_f32_16x16x32_bf16 v[216:219], a[220:223], a[116:119], v[216:219]
    ds_read_b128 a[216:219], v240 offset:6144
    v_cvt_pk_bf16_f32 v60, v208, v209
    v_mfma_f32_16x16x32_bf16 v[220:223], a[220:223], a[140:143], v[220:223]
    ds_read_b128 a[220:223], v241 offset:6144
    v_cvt_pk_bf16_f32 v6, v212, v213
    v_mfma_f32_16x16x32_bf16 v[224:227], a[224:227], a[92:95], v[224:227]
    s_waitcnt lgkmcnt(5)
    v_cvt_pk_bf16_f32 v9, v214, v215
    s_lshl1_add_u32 s58, s45, s43
    v_mfma_f32_16x16x32_bf16 v[180:183], a[224:227], a[116:119], v[180:183]
    ds_write_b64 v62, v[32:33] offset:0
    v_mfma_f32_16x16x32_bf16 v[184:187], a[224:227], a[140:143], v[184:187]
    ds_read_b128 a[224:227], v240 offset:6272
    v_add_u32 v62, s49, v62
    v_mfma_f32_16x16x32_bf16 v[188:191], a[228:231], a[92:95], v[188:191]
    s_waitcnt lgkmcnt(6)
    v_cvt_pk_bf16_f32 v33, v206, v207
    v_cvt_pk_bf16_f32 v66, v220, v221
    v_mfma_f32_16x16x32_bf16 v[192:195], a[228:231], a[116:119], v[192:195]
    ds_write_b64 v62, v[34:35] offset:0
    v_mfma_f32_16x16x32_bf16 v[196:199], a[228:231], a[140:143], v[196:199]
    ds_read_b128 a[228:231], v241 offset:6272
    v_add_u32 v62, s49, v62
    v_mfma_f32_16x16x32_bf16 v[200:203], a[232:235], a[92:95], v[200:203]
    ds_write_b64 v63, v[64:65] offset:0
    v_mfma_f32_16x16x32_bf16 v[228:231], a[232:235], a[116:119], v[228:231]
    s_waitcnt lgkmcnt(7)
    v_cvt_pk_bf16_f32 v63, v210, v211
    v_cvt_pk_bf16_f32 v72, v184, v185
    v_mfma_f32_16x16x32_bf16 v[232:235], a[232:235], a[140:143], v[232:235]
    ds_read_b128 a[232:235], v240 offset:6400
    v_cvt_pk_bf16_f32 v78, v196, v197
    v_mfma_f32_16x16x32_bf16 v[236:239], a[236:239], a[92:95], v[236:239]
    ds_write_b64 v62, v[36:37] offset:0
    v_mfma_f32_16x16x32_bf16 v[138:141], a[236:239], a[116:119], v[138:141]
    s_mov_b32 vcc_lo, 0xcccccccc
    v_cvt_pk_bf16_f32 v31, v228, v229
    v_cvt_pk_bf16_f32 v34, v230, v231
    v_mfma_f32_16x16x32_bf16 v[142:145], a[236:239], a[140:143], v[142:145]
    ds_read_b128 a[236:239], v241 offset:6400
    v_cvt_pk_bf16_f32 v61, v232, v233
    v_mfma_f32_16x16x32_bf16 v[146:149], a[240:243], a[92:95], v[146:149]
    s_waitcnt lgkmcnt(8)
    v_cvt_pk_bf16_f32 v64, v234, v235
    v_cvt_pk_bf16_f32 v7, v236, v237
    v_mfma_f32_16x16x32_bf16 v[150:153], a[240:243], a[116:119], v[150:153]
    s_mov_b32 vcc_hi, 0xcccccccc
    v_cvt_pk_bf16_f32 v10, v238, v239
    v_cvt_pk_bf16_f32 v37, v138, v139
    v_mfma_f32_16x16x32_bf16 v[154:157], a[240:243], a[140:143], v[154:157]
    ds_read_b128 a[240:243], v240 offset:36864
    v_add_u32 v62, s49, v62
    v_mfma_f32_16x16x32_bf16 v[158:161], a[244:247], a[92:95], v[158:161]
    ds_write_b64 v62, v[38:39] offset:0
    v_mfma_f32_16x16x32_bf16 v[162:165], a[244:247], a[116:119], v[162:165]
    s_mul_i32 s66, s28, 0xffffee00
    v_add_u32 v62, s49, v62
    v_cvt_pk_bf16_f32 v67, v142, v143
    v_mfma_f32_16x16x32_bf16 v[24:27], a[244:247], a[140:143], v[24:27]
    ds_write_b64 v62, v[40:41] offset:0
    v_mfma_f32_16x16x32_bf16 v[228:231], a[0:3], a[216:219], 0
    ds_read_b128 a[244:247], v241 offset:36864
    v_cvt_pk_bf16_f32 v40, v140, v141
    v_mfma_f32_16x16x32_bf16 v[228:231], a[4:7], a[220:223], v[228:231]
    s_waitcnt lgkmcnt(7)
    v_add_u32 v62, s49, v62
    v_cvt_pk_bf16_f32 v70, v144, v145
    v_mfma_f32_16x16x32_bf16 v[228:231], a[8:11], a[224:227], v[228:231]
    v_cvt_pk_bf16_f32 v79, v24, v25
    v_cvt_pk_bf16_f32 v82, v26, v27
    v_mfma_f32_16x16x32_bf16 v[228:231], a[12:15], a[228:231], v[228:231]
    s_waitcnt lgkmcnt(6)
    v_cvt_pk_bf16_f32 v13, v146, v147
    v_cvt_pk_bf16_f32 v16, v148, v149
    v_mfma_f32_16x16x32_bf16 v[228:231], a[16:19], a[232:235], v[228:231]
    ds_write_b64 v62, v[42:43] offset:0
    v_mfma_f32_16x16x32_bf16 v[232:235], a[24:27], a[216:219], 0
    s_waitcnt lgkmcnt(5)
    v_add_u32 v62, s49, v62
    v_cvt_pk_bf16_f32 v43, v150, v151
    v_mfma_f32_16x16x32_bf16 v[228:231], a[20:23], a[236:239], v[228:231]
    ds_write_b64 v62, v[44:45] offset:0
    v_mfma_f32_16x16x32_bf16 v[232:235], a[28:31], a[220:223], v[232:235]
    v_add_u32 v62, s49, v62
    v_cvt_pk_bf16_f32 v73, v154, v155
    v_mfma_f32_16x16x32_bf16 v[232:235], a[32:35], a[224:227], v[232:235]
    ds_write_b64 v62, v[46:47] offset:0
    v_mfma_f32_16x16x32_bf16 v[232:235], a[36:39], a[228:231], v[232:235]
    v_add_u32 v62, s49, v62
    v_cvt_pk_bf16_f32 v138, v228, v229
    v_mfma_f32_16x16x32_bf16 v[232:235], a[40:43], a[232:235], v[232:235]
    v_cvt_pk_bf16_f32 v139, v230, v231
    v_cvt_pk_bf16_f32 v46, v152, v153
    v_mfma_f32_16x16x32_bf16 v[232:235], a[44:47], a[236:239], v[232:235]
    ds_write_b64 v62, v[48:49] offset:0
    v_mfma_f32_16x16x32_bf16 v[236:239], a[48:51], a[216:219], 0
    v_add_u32 v62, s49, v62
    v_cvt_pk_bf16_f32 v76, v156, v157
    v_mfma_f32_16x16x32_bf16 v[236:239], a[52:55], a[220:223], v[236:239]
    v_cvt_pk_bf16_f32 v19, v158, v159
    v_cvt_pk_bf16_f32 v22, v160, v161
    v_mfma_f32_16x16x32_bf16 v[236:239], a[56:59], a[224:227], v[236:239]
    v_cvt_pk_bf16_f32 v140, v232, v233
    v_cvt_pk_bf16_f32 v141, v234, v235
    v_mfma_f32_16x16x32_bf16 v[236:239], a[60:63], a[228:231], v[236:239]
    v_cvt_pk_bf16_f32 v81, v198, v199
    v_cvt_pk_bf16_f32 v1, v200, v201
    v_mfma_f32_16x16x32_bf16 v[236:239], a[64:67], a[232:235], v[236:239]
    ds_read_b128 v[196:199], v244 offset:192
    v_cvt_pk_bf16_f32 v4, v202, v203
    v_mfma_f32_16x16x32_bf16 v[236:239], a[68:71], a[236:239], v[236:239]
    ds_read_b128 v[200:203], v245 offset:192
    v_cvt_pk_bf16_f32 v42, v180, v181
    v_mfma_f32_16x16x32_bf16 v[228:231], a[216:219], a[72:75], 0
    ds_read_b128 v[204:207], v246 offset:192
    v_cvt_pk_bf16_f32 v45, v182, v183
    v_mfma_f32_16x16x32_bf16 v[228:231], a[220:223], a[76:79], v[228:231]
    ds_read_b128 v[208:211], v244 offset:256
    v_cvt_pk_bf16_f32 v36, v216, v217
    v_mfma_f32_16x16x32_bf16 v[228:231], a[224:227], a[80:83], v[228:231]
    v_cvt_pk_bf16_f32 v142, v236, v237
    v_cvt_pk_bf16_f32 v143, v238, v239
    v_mfma_f32_16x16x32_bf16 v[228:231], a[228:231], a[84:87], v[228:231]
    v_cvt_pk_bf16_f32 v39, v218, v219
    v_cvt_pk_bf16_f32 v69, v222, v223
    v_mfma_f32_16x16x32_bf16 v[228:231], a[232:235], a[88:91], v[228:231]
    v_cvt_pk_bf16_f32 v12, v224, v225
    v_cvt_pk_bf16_f32 v15, v226, v227
    v_mfma_f32_16x16x32_bf16 v[228:231], a[236:239], a[92:95], v[228:231]
    v_cvt_pk_bf16_f32 v49, v162, v163
    v_cvt_pk_bf16_f32 v75, v186, v187
    v_mfma_f32_16x16x32_bf16 v[232:235], a[216:219], a[96:99], 0
    v_cvt_pk_bf16_f32 v52, v164, v165
    v_cvt_pk_bf16_f32 v18, v188, v189
    v_mfma_f32_16x16x32_bf16 v[232:235], a[220:223], a[100:103], v[232:235]
    v_cvt_pk_bf16_f32 v21, v190, v191
    v_cvt_pk_bf16_f32 v48, v192, v193
    v_mfma_f32_16x16x32_bf16 v[232:235], a[224:227], a[104:107], v[232:235]
    v_cvt_pk_bf16_f32 v24, v228, v229
    v_cvt_pk_bf16_f32 v27, v230, v231
    v_mfma_f32_16x16x32_bf16 v[232:235], a[228:231], a[108:111], v[232:235]
    s_waitcnt lgkmcnt(4)
    v_cvt_pk_bf16_f32 v51, v194, v195
    v_mov_b32 v195, 0
    v_mfma_f32_16x16x32_bf16 v[232:235], a[232:235], a[112:115], v[232:235]
    v_mfma_f32_16x16x32_bf16 v[232:235], a[236:239], a[116:119], v[232:235]
    v_mfma_f32_16x16x32_bf16 v[236:239], a[216:219], a[120:123], 0
    ds_read_b128 a[216:219], v240 offset:36992
    v_mfma_f32_16x16x32_bf16 v[236:239], a[220:223], a[124:127], v[236:239]
    ds_read_b128 a[220:223], v241 offset:36992
    v_mfma_f32_16x16x32_bf16 v[236:239], a[224:227], a[128:131], v[236:239]
    ds_read_b128 a[224:227], v240 offset:37120
    buffer_load_dwordx4 v173, s[8:11], s61 offen offset:1024 lds
    v_mfma_f32_16x16x32_bf16 v[236:239], a[228:231], a[132:135], v[236:239]
    ds_read_b128 a[228:231], v241 offset:37120
    v_cvt_pk_bf16_f32 v54, v232, v233
    v_mfma_f32_16x16x32_bf16 v[236:239], a[232:235], a[136:139], v[236:239]
    v_cvt_pk_bf16_f32 v57, v234, v235
    v_mfma_f32_16x16x32_bf16 v[236:239], a[236:239], a[140:143], v[236:239]
    v_mfma_f32_16x16x32_bf16 v[228:231], a[0:3], a[240:243], 0
    v_mfma_f32_16x16x32_bf16 v[228:231], a[4:7], a[244:247], v[228:231]
    v_mfma_f32_16x16x32_bf16 v[232:235], a[24:27], a[240:243], 0
    v_mfma_f32_16x16x32_bf16 v[232:235], a[28:31], a[244:247], v[232:235]
    s_waitcnt lgkmcnt(3)
    buffer_load_dwordx4 v174, s[8:11], s61 offen offset:2048 lds
    v_mfma_f32_16x16x32_bf16 v[228:231], a[8:11], a[216:219], v[228:231]
    s_add_u32 m0, s29, 0x1800
    s_waitcnt lgkmcnt(2)
    v_cvt_pk_bf16_f32 v84, v236, v237
    v_mfma_f32_16x16x32_bf16 v[228:231], a[12:15], a[220:223], v[228:231]
    s_waitcnt lgkmcnt(1)
    v_cvt_pk_bf16_f32 v87, v238, v239
    s_add_u32 s61, s39, 0x2d000
    v_mfma_f32_16x16x32_bf16 v[228:231], a[16:19], a[224:227], v[228:231]
    s_waitcnt lgkmcnt(0)
    v_mfma_f32_16x16x32_bf16 v[228:231], a[20:23], a[228:231], v[228:231]
    v_mfma_f32_16x16x32_bf16 v[232:235], a[32:35], a[216:219], v[232:235]
    v_mfma_f32_16x16x32_bf16 v[232:235], a[36:39], a[220:223], v[232:235]
    v_mfma_f32_16x16x32_bf16 v[232:235], a[40:43], a[224:227], v[232:235]
    buffer_load_dwordx4 v172, s[8:11], s62 offen lds
    v_mfma_f32_16x16x32_bf16 v[232:235], a[44:47], a[228:231], v[232:235]
    v_mfma_f32_16x16x32_bf16 v[236:239], a[48:51], a[240:243], 0
    v_mfma_f32_16x16x32_bf16 v[236:239], a[52:55], a[244:247], v[236:239]
    v_mfma_f32_16x16x32_bf16 v[236:239], a[56:59], a[216:219], v[236:239]
    v_cvt_pk_bf16_f32 v144, v228, v229
    v_cvt_pk_bf16_f32 v145, v230, v231
    v_mfma_f32_16x16x32_bf16 v[236:239], a[60:63], a[220:223], v[236:239]
    v_mfma_f32_16x16x32_bf16 v[236:239], a[64:67], a[224:227], v[236:239]
    v_mfma_f32_16x16x32_bf16 v[236:239], a[68:71], a[228:231], v[236:239]
    buffer_load_dwordx4 v173, s[8:11], s62 offen offset:1024 lds
    v_cvt_pk_bf16_f32 v146, v232, v233
    v_mfma_f32_16x16x32_bf16 v[228:231], a[240:243], a[72:75], 0
    v_cvt_pk_bf16_f32 v147, v234, v235
    v_mfma_f32_16x16x32_bf16 v[228:231], a[244:247], a[76:79], v[228:231]
    v_mfma_f32_16x16x32_bf16 v[228:231], a[216:219], a[80:83], v[228:231]
    v_mfma_f32_16x16x32_bf16 v[228:231], a[220:223], a[84:87], v[228:231]
    v_mfma_f32_16x16x32_bf16 v[228:231], a[224:227], a[88:91], v[228:231]
    v_cvt_pk_bf16_f32 v148, v236, v237
    v_cvt_pk_bf16_f32 v149, v238, v239
    v_mfma_f32_16x16x32_bf16 v[228:231], a[228:231], a[92:95], v[228:231]
    s_waitcnt vmcnt(11)
    s_barrier
    v_mfma_f32_16x16x32_bf16 v[232:235], a[240:243], a[96:99], 0
    buffer_load_dwordx4 v174, s[8:11], s62 offen offset:2048 lds
    s_add_u32 m0, s29, 0x2400
    v_mfma_f32_16x16x32_bf16 v[232:235], a[244:247], a[100:103], v[232:235]
    ds_read_b128 a[232:235], v240 offset:61440
    ds_read_b128 a[236:239], v241 offset:61440
    v_mfma_f32_16x16x32_bf16 v[232:235], a[216:219], a[104:107], v[232:235]
    s_lshl_b32 s62, s28, 5
    v_cvt_pk_bf16_f32 v25, v228, v229
    v_cvt_pk_bf16_f32 v28, v230, v231
    v_mfma_f32_16x16x32_bf16 v[232:235], a[220:223], a[108:111], v[232:235]
    s_add_u32 s62, s62, 0
    v_mfma_f32_16x16x32_bf16 v[232:235], a[224:227], a[112:115], v[232:235]
    v_mfma_f32_16x16x32_bf16 v[232:235], a[228:231], a[116:119], v[232:235]
    v_mfma_f32_16x16x32_bf16 v[236:239], a[240:243], a[120:123], 0
    ds_read_b128 a[240:243], v240 offset:61568
    v_mfma_f32_16x16x32_bf16 v[236:239], a[244:247], a[124:127], v[236:239]
    buffer_load_dwordx4 v172, s[8:11], s63 offen lds
    ds_read_b128 a[244:247], v241 offset:61568
    v_mfma_f32_16x16x32_bf16 v[236:239], a[216:219], a[128:131], v[236:239]
    ds_read_b128 a[216:219], v240 offset:61696
    v_mfma_f32_16x16x32_bf16 v[236:239], a[220:223], a[132:135], v[236:239]
    s_waitcnt lgkmcnt(4)
    ds_read_b128 a[220:223], v241 offset:61696
    v_mfma_f32_16x16x32_bf16 v[236:239], a[224:227], a[136:139], v[236:239]
    v_cvt_pk_bf16_f32 v55, v232, v233
    v_cvt_pk_bf16_f32 v58, v234, v235
    v_mfma_f32_16x16x32_bf16 v[236:239], a[228:231], a[140:143], v[236:239]
    ds_read_b128 a[224:227], v240 offset:62976
    ds_read_b128 a[228:231], v241 offset:62976
    v_mfma_f32_16x16x32_bf16 v[228:231], a[0:3], a[232:235], 0
    s_waitcnt lgkmcnt(6)
    v_mfma_f32_16x16x32_bf16 v[228:231], a[4:7], a[236:239], v[228:231]
    v_mfma_f32_16x16x32_bf16 v[232:235], a[24:27], a[232:235], 0
    buffer_load_dwordx4 v173, s[8:11], s63 offen offset:1024 lds
    s_waitcnt lgkmcnt(5)
    v_mfma_f32_16x16x32_bf16 v[228:231], a[8:11], a[240:243], v[228:231]
    v_cvt_pk_bf16_f32 v85, v236, v237
    s_waitcnt lgkmcnt(4)
    v_mfma_f32_16x16x32_bf16 v[228:231], a[12:15], a[244:247], v[228:231]
    v_cvt_pk_bf16_f32 v88, v238, v239
    s_waitcnt lgkmcnt(3)
    v_mfma_f32_16x16x32_bf16 v[228:231], a[16:19], a[216:219], v[228:231]
    v_mfma_f32_16x16x32_bf16 v[232:235], a[28:31], a[236:239], v[232:235]
    s_waitcnt lgkmcnt(2)
    v_mfma_f32_16x16x32_bf16 v[228:231], a[20:23], a[220:223], v[228:231]
    v_mfma_f32_16x16x32_bf16 v[232:235], a[32:35], a[240:243], v[232:235]
    s_waitcnt vmcnt(8)
    ds_read_b64_tr_b16 a[144:145], v249 offset:0
    v_mfma_f32_16x16x32_bf16 v[232:235], a[36:39], a[244:247], v[232:235]
    ds_read_b64_tr_b16 a[146:147], v250 offset:0
    ds_read_b64_tr_b16 a[168:169], v249 offset:32
    v_mfma_f32_16x16x32_bf16 v[232:235], a[40:43], a[216:219], v[232:235]
    ds_read_b64_tr_b16 a[170:171], v250 offset:32
    ds_read_b64_tr_b16 a[192:193], v249 offset:64
    v_mfma_f32_16x16x32_bf16 v[232:235], a[44:47], a[220:223], v[232:235]
    ds_read_b64_tr_b16 a[194:195], v250 offset:64
    buffer_load_dwordx4 v174, s[8:11], s63 offen offset:2048 lds
    v_mfma_f32_16x16x32_bf16 v[236:239], a[48:51], a[232:235], 0
    s_add_u32 m0, s29, 0
    v_cvt_pk_bf16_f32 v150, v228, v229
    v_cvt_pk_bf16_f32 v151, v230, v231
    v_mfma_f32_16x16x32_bf16 v[236:239], a[52:55], a[236:239], v[236:239]
    s_lshl_b32 s63, s28, 5
    v_cvt_pk_bf16_f32 v152, v232, v233
    v_cvt_pk_bf16_f32 v153, v234, v235
    v_mfma_f32_16x16x32_bf16 v[236:239], a[56:59], a[240:243], v[236:239]
    s_add_u32 s63, s63, 0x4800
    v_mfma_f32_16x16x32_bf16 v[236:239], a[60:63], a[244:247], v[236:239]
    v_mfma_f32_16x16x32_bf16 v[236:239], a[64:67], a[216:219], v[236:239]
    v_mfma_f32_16x16x32_bf16 v[236:239], a[68:71], a[220:223], v[236:239]
    v_mfma_f32_16x16x32_bf16 v[228:231], a[232:235], a[72:75], 0
    v_mfma_f32_16x16x32_bf16 v[228:231], a[236:239], a[76:79], v[228:231]
    v_mfma_f32_16x16x32_bf16 v[228:231], a[240:243], a[80:83], v[228:231]
    s_waitcnt lgkmcnt(0)
    buffer_load_dwordx4 v172, s[8:11], s60 offen lds
    v_mfma_f32_16x16x32_bf16 v[228:231], a[244:247], a[84:87], v[228:231]
    s_waitcnt vmcnt(7)
    ds_read_b64_tr_b16 a[148:149], v249 offset:3072
    v_mfma_f32_16x16x32_bf16 v[228:231], a[216:219], a[88:91], v[228:231]
    ds_read_b64_tr_b16 a[150:151], v250 offset:3072
    ds_read_b64_tr_b16 a[172:173], v249 offset:3104
    v_mfma_f32_16x16x32_bf16 v[228:231], a[220:223], a[92:95], v[228:231]
    ds_read_b64_tr_b16 a[174:175], v250 offset:3104
    ds_read_b64_tr_b16 a[196:197], v249 offset:3136
    v_mfma_f32_16x16x32_bf16 v[232:235], a[232:235], a[96:99], 0
    ds_read_b64_tr_b16 a[198:199], v250 offset:3136
    v_cvt_pk_bf16_f32 v154, v236, v237
    v_mfma_f32_16x16x32_bf16 v[232:235], a[236:239], a[100:103], v[232:235]
    v_cvt_pk_bf16_f32 v155, v238, v239
    v_mfma_f32_16x16x32_bf16 v[232:235], a[240:243], a[104:107], v[232:235]
    v_cvt_pk_bf16_f32 v2, v228, v229
    v_cvt_pk_bf16_f32 v5, v230, v231
    v_mfma_f32_16x16x32_bf16 v[232:235], a[244:247], a[108:111], v[232:235]
    buffer_load_dwordx4 v173, s[8:11], s60 offen offset:1024 lds
    v_mfma_f32_16x16x32_bf16 v[232:235], a[216:219], a[112:115], v[232:235]
    v_mfma_f32_16x16x32_bf16 v[232:235], a[220:223], a[116:119], v[232:235]
    v_mfma_f32_16x16x32_bf16 v[236:239], a[232:235], a[120:123], 0
    ds_read_b128 a[232:235], v240 offset:63104
    v_mfma_f32_16x16x32_bf16 v[236:239], a[236:239], a[124:127], v[236:239]
    ds_read_b128 a[236:239], v241 offset:63104
    v_mfma_f32_16x16x32_bf16 v[236:239], a[240:243], a[128:131], v[236:239]
    ds_read_b128 a[240:243], v240 offset:63232
    v_mfma_f32_16x16x32_bf16 v[236:239], a[244:247], a[132:135], v[236:239]
    ds_read_b128 a[244:247], v241 offset:63232
    v_cvt_pk_bf16_f32 v32, v232, v233
    v_mfma_f32_16x16x32_bf16 v[236:239], a[216:219], a[136:139], v[236:239]
    buffer_load_dwordx4 v174, s[8:11], s60 offen offset:2048 lds
    s_add_u32 m0, s29, 0xc00
    v_mfma_f32_16x16x32_bf16 v[236:239], a[220:223], a[140:143], v[236:239]
    s_waitcnt lgkmcnt(4)
    v_cvt_pk_bf16_f32 v35, v234, v235
    s_lshl_b32 s60, s28, 5
    v_mfma_f32_16x16x32_bf16 v[228:231], a[0:3], a[224:227], 0
    ds_read_b128 a[216:219], v242 offset:0
    ds_read_b128 a[220:223], v243 offset:0
    v_mfma_f32_16x16x32_bf16 v[228:231], a[4:7], a[228:231], v[228:231]
    s_add_u32 s60, s60, 0x1800
    v_cvt_pk_bf16_f32 v62, v236, v237
    v_cvt_pk_bf16_f32 v65, v238, v239
    v_mfma_f32_16x16x32_bf16 v[232:235], a[24:27], a[224:227], 0
    v_mfma_f32_16x16x32_bf16 v[232:235], a[28:31], a[228:231], v[232:235]
    s_waitcnt lgkmcnt(5)
    v_mfma_f32_16x16x32_bf16 v[228:231], a[8:11], a[232:235], v[228:231]
    s_waitcnt lgkmcnt(4)
    v_mfma_f32_16x16x32_bf16 v[228:231], a[12:15], a[236:239], v[228:231]
    buffer_load_dwordx4 v172, s[8:11], s61 offen lds
    s_waitcnt lgkmcnt(3)
    v_mfma_f32_16x16x32_bf16 v[228:231], a[16:19], a[240:243], v[228:231]
    s_waitcnt lgkmcnt(2)
    v_mfma_f32_16x16x32_bf16 v[228:231], a[20:23], a[244:247], v[228:231]
    v_mfma_f32_16x16x32_bf16 v[232:235], a[32:35], a[232:235], v[232:235]
    v_mfma_f32_16x16x32_bf16 v[232:235], a[36:39], a[236:239], v[232:235]
    v_mfma_f32_16x16x32_bf16 v[232:235], a[40:43], a[240:243], v[232:235]
    v_mfma_f32_16x16x32_bf16 v[232:235], a[44:47], a[244:247], v[232:235]
    v_mfma_f32_16x16x32_bf16 v[236:239], a[48:51], a[224:227], 0
    buffer_load_dwordx4 v173, s[8:11], s61 offen offset:1024 lds
    v_mfma_f32_16x16x32_bf16 v[236:239], a[52:55], a[228:231], v[236:239]
    v_mfma_f32_16x16x32_bf16 v[236:239], a[56:59], a[232:235], v[236:239]
    v_cvt_pk_bf16_f32 v156, v228, v229
    v_cvt_pk_bf16_f32 v157, v230, v231
    v_mfma_f32_16x16x32_bf16 v[236:239], a[60:63], a[236:239], v[236:239]
    v_mfma_f32_16x16x32_bf16 v[236:239], a[64:67], a[240:243], v[236:239]
    v_cvt_pk_bf16_f32 v158, v232, v233
    v_cvt_pk_bf16_f32 v159, v234, v235
    v_mfma_f32_16x16x32_bf16 v[236:239], a[68:71], a[244:247], v[236:239]
    v_mfma_f32_16x16x32_bf16 v[228:231], a[224:227], a[72:75], 0
    v_mfma_f32_16x16x32_bf16 v[228:231], a[228:231], a[76:79], v[228:231]
    buffer_load_dwordx4 v174, s[8:11], s61 offen offset:2048 lds
    s_add_u32 m0, s46, 0x16800
    v_mfma_f32_16x16x32_bf16 v[228:231], a[232:235], a[80:83], v[228:231]
    s_lshl_b32 s61, s28, 5
    s_add_u32 s61, s61, 0x6000
    v_mfma_f32_16x16x32_bf16 v[228:231], a[236:239], a[84:87], v[228:231]
    v_cvt_pk_bf16_f32 v160, v236, v237
    v_cvt_pk_bf16_f32 v161, v238, v239
    v_mfma_f32_16x16x32_bf16 v[228:231], a[240:243], a[88:91], v[228:231]
    v_mfma_f32_16x16x32_bf16 v[228:231], a[244:247], a[92:95], v[228:231]
    v_mfma_f32_16x16x32_bf16 v[232:235], a[224:227], a[96:99], 0
    v_mfma_f32_16x16x32_bf16 v[232:235], a[228:231], a[100:103], v[232:235]
    v_mfma_f32_16x16x32_bf16 v[232:235], a[232:235], a[104:107], v[232:235]
    v_mfma_f32_16x16x32_bf16 v[232:235], a[236:239], a[108:111], v[232:235]
    s_waitcnt vmcnt(9)
    ds_read_b64_tr_b16 a[152:153], v249 offset:6144
    v_mfma_f32_16x16x32_bf16 v[232:235], a[240:243], a[112:115], v[232:235]
    ds_read_b64_tr_b16 a[154:155], v250 offset:6144
    ds_read_b64_tr_b16 a[176:177], v249 offset:6176
    v_mfma_f32_16x16x32_bf16 v[232:235], a[244:247], a[116:119], v[232:235]
    s_waitcnt vmcnt(6)
    ds_read_b64_tr_b16 a[156:157], v249 offset:9216
    v_mfma_f32_16x16x32_bf16 v[236:239], a[224:227], a[120:123], 0
    ds_read_b128 a[224:227], v242 offset:128
    ds_read_b64_tr_b16 a[158:159], v250 offset:9216
    v_mfma_f32_16x16x32_bf16 v[236:239], a[228:231], a[124:127], v[236:239]
    ds_read_b128 a[228:231], v243 offset:128
    ds_read_b64_tr_b16 a[178:179], v250 offset:6176
    v_mfma_f32_16x16x32_bf16 v[236:239], a[232:235], a[128:131], v[236:239]
    ds_read_b64_tr_b16 a[180:181], v249 offset:9248
    ds_read_b64_tr_b16 a[182:183], v250 offset:9248
    v_mfma_f32_16x16x32_bf16 v[236:239], a[236:239], a[132:135], v[236:239]
    v_cvt_pk_bf16_f32 v8, v228, v229
    v_cvt_pk_bf16_f32 v11, v230, v231
    v_mfma_f32_16x16x32_bf16 v[236:239], a[240:243], a[136:139], v[236:239]
    s_waitcnt lgkmcnt(10)
    ds_read_b64_tr_b16 a[200:201], v249 offset:6208
    v_mfma_f32_16x16x32_bf16 v[236:239], a[244:247], a[140:143], v[236:239]
    ds_read_b64_tr_b16 a[202:203], v250 offset:6208
    ds_read_b64_tr_b16 a[204:205], v249 offset:9280
    v_mfma_f32_16x16x32_bf16 v[228:231], a[144:147], a[216:219], 0
    ds_read_b64_tr_b16 a[206:207], v250 offset:9280
    v_cvt_pk_bf16_f32 v38, v232, v233
    v_mfma_f32_16x16x32_bf16 v[228:231], a[148:151], a[220:223], v[228:231]
    v_cvt_pk_bf16_f32 v41, v234, v235
    v_mfma_f32_16x16x32_bf16 v[232:235], a[168:171], a[216:219], 0
    ds_read_b128 a[232:235], v242 offset:256
    s_waitcnt lgkmcnt(10)
    v_mfma_f32_16x16x32_bf16 v[228:231], a[152:155], a[224:227], v[228:231]
    ds_read_b128 a[236:239], v243 offset:256
    v_cvt_pk_bf16_f32 v68, v236, v237
    v_mfma_f32_16x16x32_bf16 v[232:235], a[172:175], a[220:223], v[232:235]
    s_waitcnt lgkmcnt(9)
    s_waitcnt lgkmcnt(8)
    v_cvt_pk_bf16_f32 v71, v238, v239
    v_mfma_f32_16x16x32_bf16 v[228:231], a[156:159], a[228:231], v[228:231]
    ds_read_b128 a[240:243], v240 offset:64512
    ds_read_b128 a[244:247], v241 offset:64512
    v_mfma_f32_16x16x32_bf16 v[232:235], a[176:179], a[224:227], v[232:235]
    s_waitcnt lgkmcnt(8)
    v_mfma_f32_16x16x32_bf16 v[232:235], a[180:183], a[228:231], v[232:235]
    v_mfma_f32_16x16x32_bf16 v[236:239], a[192:195], a[216:219], 0
    ds_read_b128 a[216:219], v240 offset:64640
    v_mfma_f32_16x16x32_bf16 v[236:239], a[196:199], a[220:223], v[236:239]
    s_waitcnt lgkmcnt(7)
    ds_read_b128 a[220:223], v241 offset:64640
    v_mfma_f32_16x16x32_bf16 v[236:239], a[200:203], a[224:227], v[236:239]
    s_waitcnt lgkmcnt(6)
    ds_read_b128 a[224:227], v240 offset:64768
    v_mfma_f32_16x16x32_bf16 v[236:239], a[204:207], a[228:231], v[236:239]
    ds_read_b128 a[228:231], v241 offset:64768
    v_add_u32 v240, 0xf000, v240
    s_waitcnt vmcnt(3)
    ds_read_b64_tr_b16 a[160:161], v249 offset:0
    ds_read_b64_tr_b16 a[162:163], v250 offset:0
    ds_read_b64_tr_b16 a[184:185], v249 offset:32
    ds_read_b64_tr_b16 a[186:187], v250 offset:32
    ds_read_b64_tr_b16 a[208:209], v249 offset:64
    ds_read_b64_tr_b16 a[210:211], v250 offset:64
    v_add_u32 v241, 0xf000, v241
    s_waitcnt lgkmcnt(4)
    v_mfma_f32_16x16x32_bf16 v[228:231], a[160:163], a[232:235], v[228:231]
    s_waitcnt lgkmcnt(2)
    v_mfma_f32_16x16x32_bf16 v[232:235], a[184:187], a[232:235], v[232:235]
    s_waitcnt lgkmcnt(0)
    v_mfma_f32_16x16x32_bf16 v[236:239], a[208:211], a[232:235], v[236:239]
    ds_read_b128 a[232:235], v242 offset:1536
    s_waitcnt vmcnt(0)
    ds_read_b64_tr_b16 a[164:165], v249 offset:3072
    ds_read_b64_tr_b16 a[166:167], v250 offset:3072
    ds_read_b64_tr_b16 a[188:189], v249 offset:3104
    ds_read_b64_tr_b16 a[190:191], v250 offset:3104
    ds_read_b64_tr_b16 a[212:213], v249 offset:3136
    ds_read_b64_tr_b16 a[214:215], v250 offset:3136
    v_add_u32 v249, s66, v249
    v_add_u32 v250, s66, v250
    s_lshl_b32 s66, s28, 1
    s_waitcnt lgkmcnt(4)
    v_mfma_f32_16x16x32_bf16 v[228:231], a[164:167], a[236:239], v[228:231]
    s_nop 7
    s_waitcnt lgkmcnt(0)
    v_mfma_f32_16x16x32_bf16 v[232:235], a[188:191], a[236:239], v[232:235]
    s_barrier
    v_mul_f32 v228, s38, v228
    v_mul_f32 v229, s38, v229
    v_mfma_f32_16x16x32_bf16 v[236:239], a[212:215], a[236:239], v[236:239]
    v_mul_f32 v230, s38, v230
    v_mul_f32 v231, s38, v231
    v_cvt_pk_bf16_f32 v168, v228, v229
    v_cvt_pk_bf16_f32 v169, v230, v231
    v_mfma_f32_16x16x32_bf16 v[228:231], a[0:3], a[240:243], 0
    v_mul_f32 v232, s3, v232
    v_mul_f32 v233, s3, v233
    v_mfma_f32_16x16x32_bf16 v[228:231], a[4:7], a[244:247], v[228:231]
    v_mul_f32 v234, s3, v234
    v_mul_f32 v235, s3, v235
    v_mfma_f32_16x16x32_bf16 v[228:231], a[8:11], a[216:219], v[228:231]
    v_cvt_pk_bf16_f32 v170, v232, v233
    v_cvt_pk_bf16_f32 v171, v234, v235
    v_mfma_f32_16x16x32_bf16 v[228:231], a[12:15], a[220:223], v[228:231]
    v_mul_f32 v236, s38, v236
    v_mul_f32 v237, s38, v237
    v_mfma_f32_16x16x32_bf16 v[196:199], v[102:105], v[168:171], v[196:199]
    v_mul_f32 v238, s38, v238
    v_mul_f32 v239, s38, v239
    v_mfma_f32_16x16x32_bf16 v[200:203], v[114:117], v[168:171], v[200:203]
    v_cvt_pk_bf16_f32 v172, v236, v237
    v_cvt_pk_bf16_f32 v173, v238, v239
    v_mfma_f32_16x16x32_bf16 v[204:207], v[150:153], v[168:171], v[204:207]
    ds_read_b128 a[236:239], v243 offset:1536
    buffer_load_dwordx4 v254, s[4:7], s43 offen lds
    v_mfma_f32_16x16x32_bf16 v[196:199], v[104:107], v[170:173], v[196:199]
    v_accvgpr_read_b32 v254, a254
    v_mfma_f32_16x16x32_bf16 v[200:203], v[116:119], v[170:173], v[200:203]
    v_mfma_f32_16x16x32_bf16 v[204:207], v[152:155], v[170:173], v[204:207]
    v_mfma_f32_16x16x32_bf16 v[208:211], v[108:111], v[168:171], v[208:211]
    buffer_load_dwordx4 v255, s[4:7], s43 offen offset:1024 lds
    v_accvgpr_read_b32 v255, a252
    v_mfma_f32_16x16x32_bf16 v[208:211], v[110:113], v[170:173], v[208:211]
    v_mfma_f32_16x16x32_bf16 v[228:231], a[16:19], a[224:227], v[228:231]
    v_exp_f32 v196, v196
    v_mfma_f32_16x16x32_bf16 v[228:231], a[20:23], a[228:231], v[228:231]
    v_exp_f32 v197, v197
    v_mfma_f32_16x16x32_bf16 v[232:235], a[24:27], a[240:243], 0
    v_exp_f32 v198, v198
    v_mfma_f32_16x16x32_bf16 v[232:235], a[28:31], a[244:247], v[232:235]
    v_exp_f32 v199, v199
    v_mfma_f32_16x16x32_bf16 v[232:235], a[32:35], a[216:219], v[232:235]
    v_cvt_pk_bf16_f32 v180, v196, v197
    v_cvt_pk_bf16_f32 v183, v198, v199
    v_mfma_f32_16x16x32_bf16 v[232:235], a[36:39], a[220:223], v[232:235]
    ds_read_b128 v[196:199], v245 offset:256
    v_cvt_pk_bf16_f32 v162, v228, v229
    v_mfma_f32_16x16x32_bf16 v[232:235], a[40:43], a[224:227], v[232:235]
    v_exp_f32 v200, v200
    v_mfma_f32_16x16x32_bf16 v[232:235], a[44:47], a[228:231], v[232:235]
    v_exp_f32 v201, v201
    v_mfma_f32_16x16x32_bf16 v[236:239], a[48:51], a[240:243], 0
    v_exp_f32 v204, v204
    v_mfma_f32_16x16x32_bf16 v[236:239], a[52:55], a[244:247], v[236:239]
    v_exp_f32 v205, v205
    v_mfma_f32_16x16x32_bf16 v[236:239], a[56:59], a[216:219], v[236:239]
    v_cvt_pk_bf16_f32 v181, v200, v201
    v_cvt_pk_bf16_f32 v182, v204, v205
    v_mfma_f32_16x16x32_bf16 v[236:239], a[60:63], a[220:223], v[236:239]
    v_exp_f32 v202, v202
    v_mfma_f32_16x16x32_bf16 v[212:215], v[0:3], v[180:183], 0
    v_exp_f32 v203, v203
    v_mfma_f32_16x16x32_bf16 v[216:219], v[30:33], v[180:183], 0
    v_cvt_pk_bf16_f32 v184, v202, v203
    s_waitcnt lgkmcnt(0)
    v_mfma_f32_16x16x32_bf16 v[220:223], v[60:63], v[180:183], 0
    ds_read_b128 v[200:203], v246 offset:256
    v_cvt_pk_bf16_f32 v163, v230, v231
    v_mfma_f32_16x16x32_bf16 v[224:227], a[248:251], v[180:183], 0
L_h3:
    s_cbranch_execz L_h7
    v_exp_f32 v206, v206
    v_mfma_f32_16x16x32_bf16 v[196:199], v[120:123], v[168:171], v[196:199]
    v_exp_f32 v207, v207
    v_mfma_f32_16x16x32_bf16 v[196:199], v[122:125], v[170:173], v[196:199]
    v_cvt_pk_bf16_f32 v185, v206, v207
    v_cvt_pk_bf16_f32 v164, v232, v233
    v_mfma_f32_16x16x32_bf16 v[236:239], a[64:67], a[224:227], v[236:239]
    ds_read_b128 v[204:207], v244 offset:320
    v_cvt_pk_bf16_f32 v165, v234, v235
    v_mfma_f32_16x16x32_bf16 v[236:239], a[68:71], a[228:231], v[236:239]
    v_exp_f32 v208, v208
    v_mfma_f32_16x16x32_bf16 v[228:231], a[240:243], a[72:75], 0
    v_exp_f32 v209, v209
    v_mfma_f32_16x16x32_bf16 v[228:231], a[244:247], a[76:79], v[228:231]
    v_exp_f32 v196, v196
    v_mfma_f32_16x16x32_bf16 v[228:231], a[216:219], a[80:83], v[228:231]
    v_exp_f32 v197, v197
    v_mfma_f32_16x16x32_bf16 v[228:231], a[220:223], a[84:87], v[228:231]
    s_waitcnt lgkmcnt(1)
    v_cvt_pk_bf16_f32 v186, v208, v209
    v_cvt_pk_bf16_f32 v187, v196, v197
    v_mfma_f32_16x16x32_bf16 v[200:203], v[156:159], v[168:171], v[200:203]
    v_exp_f32 v210, v210
    v_mfma_f32_16x16x32_bf16 v[212:215], v[4:7], v[184:187], v[212:215]
    v_exp_f32 v211, v211
    v_mfma_f32_16x16x32_bf16 v[216:219], v[34:37], v[184:187], v[216:219]
    v_cvt_pk_bf16_f32 v189, v210, v211
    v_cvt_pk_bf16_f32 v166, v236, v237
    v_mfma_f32_16x16x32_bf16 v[220:223], v[64:67], v[184:187], v[220:223]
    ds_read_b128 v[208:211], v245 offset:320
    v_cvt_pk_bf16_f32 v167, v238, v239
    v_mfma_f32_16x16x32_bf16 v[224:227], a[248:251], v[184:187], v[224:227]
    v_exp_f32 v198, v198
    v_mfma_f32_16x16x32_bf16 v[200:203], v[158:161], v[170:173], v[200:203]
    v_exp_f32 v199, v199
    v_mfma_f32_16x16x32_bf16 v[228:231], a[224:227], a[88:91], v[228:231]
    buffer_load_dwordx4 v254, s[4:7], s43 offen offset:2048 lds
    v_cvt_pk_bf16_f32 v190, v198, v199
    v_mfma_f32_16x16x32_bf16 v[228:231], a[228:231], a[92:95], v[228:231]
    s_waitcnt lgkmcnt(1)
    v_accvgpr_read_b32 v254, a253
    s_add_u32 m0, s46, 0x17400
    v_mfma_f32_16x16x32_bf16 v[204:207], v[90:93], v[168:171], v[204:207]
    ds_read_b128 v[196:199], v246 offset:320
    v_mfma_f32_16x16x32_bf16 v[204:207], v[92:95], v[170:173], v[204:207]
    v_exp_f32 v200, v200
    v_mfma_f32_16x16x32_bf16 v[232:235], a[240:243], a[96:99], 0
    v_exp_f32 v201, v201
    v_mfma_f32_16x16x32_bf16 v[232:235], a[244:247], a[100:103], v[232:235]
    v_exp_f32 v202, v202
    v_mfma_f32_16x16x32_bf16 v[232:235], a[216:219], a[104:107], v[232:235]
    v_exp_f32 v203, v203
    v_mfma_f32_16x16x32_bf16 v[232:235], a[220:223], a[108:111], v[232:235]
    v_cvt_pk_bf16_f32 v188, v200, v201
    v_cvt_pk_bf16_f32 v191, v202, v203
    v_mfma_f32_16x16x32_bf16 v[232:235], a[224:227], a[112:115], v[232:235]
    v_cvt_pk_bf16_f32 v14, v228, v229
    v_cvt_pk_bf16_f32 v17, v230, v231
    v_mfma_f32_16x16x32_bf16 v[212:215], v[8:11], v[188:191], v[212:215]
    v_exp_f32 v204, v204
    v_mfma_f32_16x16x32_bf16 v[216:219], v[38:41], v[188:191], v[216:219]
    v_exp_f32 v205, v205
    v_mfma_f32_16x16x32_bf16 v[220:223], v[68:71], v[188:191], v[220:223]
    s_waitcnt lgkmcnt(1)
    v_cvt_pk_bf16_f32 v192, v204, v205
    v_mfma_f32_16x16x32_bf16 v[224:227], a[248:251], v[188:191], v[224:227]
    ds_read_b128 v[200:203], v244 offset:0
    ds_read_b128 v[204:207], v245 offset:0
    v_mfma_f32_16x16x32_bf16 v[208:211], v[126:129], v[168:171], v[208:211]
    buffer_load_dwordx4 v255, s[4:7], s59 offen lds
    v_accvgpr_read_b32 v255, a254
    v_mfma_f32_16x16x32_bf16 v[208:211], v[128:131], v[170:173], v[208:211]
    s_waitcnt lgkmcnt(2)
    v_mfma_f32_16x16x32_bf16 v[196:199], v[162:165], v[168:171], v[196:199]
    v_mfma_f32_16x16x32_bf16 v[196:199], v[164:167], v[170:173], v[196:199]
    v_mfma_f32_16x16x32_bf16 v[232:235], a[228:231], a[116:119], v[232:235]
    buffer_load_dwordx4 v254, s[4:7], s59 offen offset:1024 lds
    v_accvgpr_read_b32 v254, a252
    v_mfma_f32_16x16x32_bf16 v[236:239], a[240:243], a[120:123], 0
    ds_read_b128 a[240:243], v242 offset:1664
    v_mfma_f32_16x16x32_bf16 v[236:239], a[244:247], a[124:127], v[236:239]
    ds_read_b128 a[244:247], v243 offset:1664
    v_mfma_f32_16x16x32_bf16 v[236:239], a[216:219], a[128:131], v[236:239]
    ds_read_b128 a[216:219], v242 offset:1792
    v_cvt_pk_bf16_f32 v44, v232, v233
    v_mfma_f32_16x16x32_bf16 v[236:239], a[220:223], a[132:135], v[236:239]
    ds_read_b128 a[220:223], v243 offset:1792
    v_cvt_pk_bf16_f32 v47, v234, v235
    v_mfma_f32_16x16x32_bf16 v[236:239], a[224:227], a[136:139], v[236:239]
    v_exp_f32 v208, v208
    v_mfma_f32_16x16x32_bf16 v[236:239], a[228:231], a[140:143], v[236:239]
    v_exp_f32 v209, v209
    v_mfma_f32_16x16x32_bf16 v[228:231], a[144:147], a[232:235], 0
    v_exp_f32 v196, v196
    v_mfma_f32_16x16x32_bf16 v[228:231], a[148:151], a[236:239], v[228:231]
    v_exp_f32 v197, v197
    v_mfma_f32_16x16x32_bf16 v[232:235], a[168:171], a[232:235], 0
    v_cvt_pk_bf16_f32 v193, v208, v209
    s_waitcnt lgkmcnt(3)
    v_mfma_f32_16x16x32_bf16 v[228:231], a[152:155], a[240:243], v[228:231]
    v_cvt_pk_bf16_f32 v194, v196, v197
    v_cvt_pk_bf16_f32 v74, v236, v237
    v_mfma_f32_16x16x32_bf16 v[232:235], a[172:175], a[236:239], v[232:235]
    ds_read_b128 v[208:211], v246 offset:0
    v_cvt_pk_bf16_f32 v77, v238, v239
    v_mfma_f32_16x16x32_bf16 v[212:215], v[12:15], v[192:195], v[212:215]
    s_waitcnt lgkmcnt(3)
    ds_read_b128 v[196:199], v244 offset:64
    v_mfma_f32_16x16x32_bf16 v[216:219], v[42:45], v[192:195], v[216:219]
    ds_read_b128 a[224:227], v240 offset:4608
    ds_read_b128 a[228:231], v241 offset:4608
    v_mfma_f32_16x16x32_bf16 v[220:223], v[72:75], v[192:195], v[220:223]
    buffer_load_dwordx4 v255, s[4:7], s59 offen offset:2048 lds
    v_accvgpr_read_b32 v255, a255
    v_mfma_f32_16x16x32_bf16 v[224:227], a[248:251], v[192:195], v[224:227]
    s_add_u32 m0, s46, 0x18000
    s_add_u32 s59, s44, s45
    v_mfma_f32_16x16x32_bf16 v[228:231], a[156:159], a[244:247], v[228:231]
    s_waitcnt lgkmcnt(5)
    v_mfma_f32_16x16x32_bf16 v[228:231], a[160:163], a[216:219], v[228:231]
    s_waitcnt lgkmcnt(4)
    v_mfma_f32_16x16x32_bf16 v[228:231], a[164:167], a[220:223], v[228:231]
    buffer_load_dwordx4 v254, s[4:7], s58 offen lds
    v_xor_b32 v254, 16, v242
    v_mfma_f32_16x16x32_bf16 v[232:235], a[176:179], a[240:243], v[232:235]
    v_rcp_f32 v225, v224
    v_mfma_f32_16x16x32_bf16 v[232:235], a[180:183], a[244:247], v[232:235]
    v_mul_f32 v212, v212, v225
    v_mul_f32 v213, v213, v225
    v_mfma_f32_16x16x32_bf16 v[232:235], a[184:187], a[216:219], v[232:235]
    v_mul_f32 v228, s38, v228
    v_mul_f32 v229, s38, v229
    v_mfma_f32_16x16x32_bf16 v[232:235], a[188:191], a[220:223], v[232:235]
    v_mul_f32 v230, s38, v230
    v_mul_f32 v231, s38, v231
    v_mfma_f32_16x16x32_bf16 v[236:239], a[192:195], a[232:235], 0
    v_cvt_pk_bf16_f32 v174, v228, v229
    v_cvt_pk_bf16_f32 v175, v230, v231
    v_mfma_f32_16x16x32_bf16 v[236:239], a[196:199], a[236:239], v[236:239]
    ds_read_b128 a[232:235], v240 offset:4736
    v_mul_f32 v214, v214, v225
    v_mfma_f32_16x16x32_bf16 v[236:239], a[200:203], a[240:243], v[236:239]
    v_mul_f32 v232, s3, v232
    v_mul_f32 v233, s3, v233
    v_mfma_f32_16x16x32_bf16 v[236:239], a[204:207], a[244:247], v[236:239]
    v_mul_f32 v234, s3, v234
    v_mul_f32 v235, s3, v235
    v_mfma_f32_16x16x32_bf16 v[236:239], a[208:211], a[216:219], v[236:239]
    s_waitcnt lgkmcnt(2)
    v_cvt_pk_bf16_f32 v176, v232, v233
    v_cvt_pk_bf16_f32 v177, v234, v235
    v_mfma_f32_16x16x32_bf16 v[236:239], a[212:215], a[220:223], v[236:239]
    ds_read_b128 a[236:239], v241 offset:4736
    ds_read_b128 a[240:243], v240 offset:4864
    v_mfma_f32_16x16x32_bf16 v[200:203], v[108:111], v[174:177], v[200:203]
    ds_read_b128 a[244:247], v241 offset:4864
    v_mul_f32 v215, v215, v225
    v_mfma_f32_16x16x32_bf16 v[204:207], v[120:123], v[174:177], v[204:207]
    v_cvt_pk_bf16_f32 v212, v212, v213
    v_cvt_pk_bf16_f32 v213, v214, v215
    v_mfma_f32_16x16x32_bf16 v[208:211], v[156:159], v[174:177], v[208:211]
    v_mul_f32 v236, s38, v236
    v_mul_f32 v237, s38, v237
    v_mfma_f32_16x16x32_bf16 v[196:199], v[90:93], v[174:177], v[196:199]
    v_mul_f32 v238, s38, v238
    v_mul_f32 v239, s38, v239
    v_mfma_f32_16x16x32_bf16 v[228:231], a[0:3], a[224:227], 0
    s_waitcnt lgkmcnt(4)
    v_cvt_pk_bf16_f32 v178, v236, v237
    v_cvt_pk_bf16_f32 v179, v238, v239
    v_mfma_f32_16x16x32_bf16 v[228:231], a[4:7], a[228:231], v[228:231]
    ds_write_b64 v251, v[212:213] offset:0
    v_mfma_f32_16x16x32_bf16 v[200:203], v[110:113], v[176:179], v[200:203]
    v_mul_f32 v216, v216, v225
    v_mul_f32 v217, v217, v225
    v_mfma_f32_16x16x32_bf16 v[204:207], v[122:125], v[176:179], v[204:207]
    s_waitcnt lgkmcnt(4)
    v_mul_f32 v218, v218, v225
    v_mul_f32 v219, v219, v225
    v_mfma_f32_16x16x32_bf16 v[208:211], v[158:161], v[176:179], v[208:211]
    v_cvt_pk_bf16_f32 v216, v216, v217
    v_cvt_pk_bf16_f32 v217, v218, v219
    v_mfma_f32_16x16x32_bf16 v[196:199], v[92:95], v[176:179], v[196:199]
    v_exp_f32 v200, v200
    v_mfma_f32_16x16x32_bf16 v[228:231], a[8:11], a[232:235], v[228:231]
    s_waitcnt lgkmcnt(3)
    v_exp_f32 v201, v201
    v_mfma_f32_16x16x32_bf16 v[228:231], a[12:15], a[236:239], v[228:231]
    s_waitcnt lgkmcnt(2)
    v_exp_f32 v202, v202
    v_mfma_f32_16x16x32_bf16 v[228:231], a[16:19], a[240:243], v[228:231]
    s_waitcnt lgkmcnt(1)
    v_exp_f32 v203, v203
    v_mfma_f32_16x16x32_bf16 v[228:231], a[20:23], a[244:247], v[228:231]
    v_cvt_pk_bf16_f32 v180, v200, v201
    v_cvt_pk_bf16_f32 v183, v202, v203
    v_mfma_f32_16x16x32_bf16 v[232:235], a[24:27], a[224:227], 0
    ds_read_b128 v[200:203], v245 offset:64
    v_mul_f32 v220, v220, v225
    v_mfma_f32_16x16x32_bf16 v[232:235], a[28:31], a[228:231], v[232:235]
    v_exp_f32 v204, v204
    v_mfma_f32_16x16x32_bf16 v[232:235], a[32:35], a[232:235], v[232:235]
    v_exp_f32 v205, v205
    v_mfma_f32_16x16x32_bf16 v[232:235], a[36:39], a[236:239], v[232:235]
    v_exp_f32 v208, v208
    v_mfma_f32_16x16x32_bf16 v[232:235], a[40:43], a[240:243], v[232:235]
    v_exp_f32 v209, v209
    v_mfma_f32_16x16x32_bf16 v[232:235], a[44:47], a[244:247], v[232:235]
    v_cvt_pk_bf16_f32 v181, v204, v205
    v_cvt_pk_bf16_f32 v182, v208, v209
    v_mfma_f32_16x16x32_bf16 v[236:239], a[48:51], a[224:227], 0
    ds_write_b64 v251, v[216:217] offset:128
    v_mfma_f32_16x16x32_bf16 v[212:215], v[6:9], v[180:183], 0
    v_mul_f32 v221, v221, v225
    v_mul_f32 v222, v222, v225
    v_mfma_f32_16x16x32_bf16 v[216:219], v[36:39], v[180:183], 0
    v_mul_f32 v223, v223, v225
    v_cvt_pk_bf16_f32 v220, v220, v221
    v_mfma_f32_16x16x32_bf16 v[236:239], a[52:55], a[228:231], v[236:239]
    v_cvt_pk_bf16_f32 v221, v222, v223
    v_max3_f32 v248, v248, v224, v225
    v_mfma_f32_16x16x32_bf16 v[224:227], a[248:251], v[180:183], 0
    ds_write_b64 v251, v[220:221] offset:256
    v_mfma_f32_16x16x32_bf16 v[220:223], v[66:69], v[180:183], 0
    s_waitcnt lgkmcnt(2)
    v_exp_f32 v206, v206
    v_mfma_f32_16x16x32_bf16 v[200:203], v[126:129], v[174:177], v[200:203]
    v_exp_f32 v207, v207
    v_mfma_f32_16x16x32_bf16 v[200:203], v[128:131], v[176:179], v[200:203]
    v_cvt_pk_bf16_f32 v184, v206, v207
    v_cvt_pk_bf16_f32 v102, v228, v229
    v_mfma_f32_16x16x32_bf16 v[236:239], a[56:59], a[232:235], v[236:239]
    ds_read_b128 v[204:207], v246 offset:64
    v_cvt_pk_bf16_f32 v103, v230, v231
    v_mfma_f32_16x16x32_bf16 v[236:239], a[60:63], a[236:239], v[236:239]
    v_cvt_pk_bf16_f32 v104, v232, v233
    v_cvt_pk_bf16_f32 v105, v234, v235
    v_mfma_f32_16x16x32_bf16 v[236:239], a[64:67], a[240:243], v[236:239]
    v_exp_f32 v210, v210
    v_mfma_f32_16x16x32_bf16 v[236:239], a[68:71], a[244:247], v[236:239]
    v_exp_f32 v211, v211
    v_mfma_f32_16x16x32_bf16 v[228:231], a[224:227], a[72:75], 0
    ds_read_b128 a[216:219], v242 offset:3072
    v_cvt_pk_bf16_f32 v185, v210, v211
    v_mfma_f32_16x16x32_bf16 v[228:231], a[228:231], a[76:79], v[228:231]
    ds_read_b128 v[208:211], v244 offset:128
    v_add_u32 v254, 0x7500, v254
    v_mfma_f32_16x16x32_bf16 v[228:231], a[232:235], a[80:83], v[228:231]
    v_exp_f32 v196, v196
    v_mfma_f32_16x16x32_bf16 v[228:231], a[236:239], a[84:87], v[228:231]
    v_exp_f32 v197, v197
    v_mfma_f32_16x16x32_bf16 v[228:231], a[240:243], a[88:91], v[228:231]
    v_exp_f32 v200, v200
    v_mfma_f32_16x16x32_bf16 v[228:231], a[244:247], a[92:95], v[228:231]
    s_waitcnt lgkmcnt(2)
    v_exp_f32 v201, v201
    v_mfma_f32_16x16x32_bf16 v[204:207], v[162:165], v[174:177], v[204:207]
    v_cvt_pk_bf16_f32 v186, v196, v197
    v_cvt_pk_bf16_f32 v187, v200, v201
    v_mfma_f32_16x16x32_bf16 v[204:207], v[164:167], v[176:179], v[204:207]
    v_exp_f32 v198, v198
    v_mfma_f32_16x16x32_bf16 v[212:215], v[10:13], v[184:187], v[212:215]
    v_exp_f32 v199, v199
    v_mfma_f32_16x16x32_bf16 v[216:219], v[40:43], v[184:187], v[216:219]
    ds_read_b128 a[220:223], v243 offset:3072
    v_cvt_pk_bf16_f32 v189, v198, v199
    v_mfma_f32_16x16x32_bf16 v[220:223], v[70:73], v[184:187], v[220:223]
    ds_read_b128 v[196:199], v245 offset:128
    v_cvt_pk_bf16_f32 v106, v236, v237
    v_mfma_f32_16x16x32_bf16 v[224:227], a[248:251], v[184:187], v[224:227]
    v_exp_f32 v202, v202
    v_mfma_f32_16x16x32_bf16 v[232:235], a[224:227], a[96:99], 0
    v_exp_f32 v203, v203
    v_mfma_f32_16x16x32_bf16 v[232:235], a[228:231], a[100:103], v[232:235]
    v_cvt_pk_bf16_f32 v190, v202, v203
    v_cvt_pk_bf16_f32 v107, v238, v239
    v_mfma_f32_16x16x32_bf16 v[232:235], a[232:235], a[104:107], v[232:235]
    ds_read_b128 v[200:203], v246 offset:128
    s_waitcnt lgkmcnt(3)
    v_mfma_f32_16x16x32_bf16 v[208:211], v[96:99], v[174:177], v[208:211]
    v_exp_f32 v204, v204
    v_mfma_f32_16x16x32_bf16 v[208:211], v[98:101], v[176:179], v[208:211]
    v_exp_f32 v205, v205
    v_mfma_f32_16x16x32_bf16 v[232:235], a[236:239], a[108:111], v[232:235]
    v_exp_f32 v206, v206
    v_mfma_f32_16x16x32_bf16 v[232:235], a[240:243], a[112:115], v[232:235]
    v_exp_f32 v207, v207
    v_mfma_f32_16x16x32_bf16 v[232:235], a[244:247], a[116:119], v[232:235]
    v_cvt_pk_bf16_f32 v188, v204, v205
    v_cvt_pk_bf16_f32 v191, v206, v207
    v_mfma_f32_16x16x32_bf16 v[236:239], a[224:227], a[120:123], 0
    ds_read_b128 a[224:227], v242 offset:3200
    v_cvt_pk_bf16_f32 v20, v228, v229
    v_mfma_f32_16x16x32_bf16 v[212:215], v[14:17], v[188:191], v[212:215]
    s_waitcnt lgkmcnt(2)
    v_cvt_pk_bf16_f32 v23, v230, v231
    v_cvt_pk_bf16_f32 v50, v232, v233
    v_mfma_f32_16x16x32_bf16 v[216:219], v[44:47], v[188:191], v[216:219]
    ds_read_b128 v[204:207], v244 offset:0
    v_cvt_pk_bf16_f32 v53, v234, v235
    v_mfma_f32_16x16x32_bf16 v[220:223], v[74:77], v[188:191], v[220:223]
    v_exp_f32 v208, v208
    v_mfma_f32_16x16x32_bf16 v[224:227], a[248:251], v[188:191], v[224:227]
    s_waitcnt lgkmcnt(2)
    v_exp_f32 v209, v209
    v_mfma_f32_16x16x32_bf16 v[196:199], v[132:135], v[174:177], v[196:199]
    v_cvt_pk_bf16_f32 v192, v208, v209
    v_cndmask_b32 v254, v242, v254, vcc
    v_mfma_f32_16x16x32_bf16 v[196:199], v[134:137], v[176:179], v[196:199]
    ds_read_b128 v[208:211], v245 offset:0
    buffer_load_dwordx4 v255, s[4:7], s58 offen offset:512 lds
    v_mfma_f32_16x16x32_bf16 v[200:203], v[102:105], v[174:177], v[200:203]
    s_mov_b32 vcc_lo, 0x33333333
    v_xor_b32 v255, 64, v254
    s_mov_b32 vcc_hi, 0x33333333
    v_mfma_f32_16x16x32_bf16 v[200:203], v[104:107], v[176:179], v[200:203]
    s_add_u32 m0, s46, 0
    v_exp_f32 v196, v196
    v_mfma_f32_16x16x32_bf16 v[236:239], a[228:231], a[124:127], v[236:239]
    ds_read_b128 a[228:231], v243 offset:3200
    s_lshl1_add_u32 s58, s45, s44
    v_mfma_f32_16x16x32_bf16 v[236:239], a[232:235], a[128:131], v[236:239]
    ds_read_b128 a[232:235], v242 offset:3328
    v_mfma_f32_16x16x32_bf16 v[236:239], a[236:239], a[132:135], v[236:239]
    ds_read_b128 a[236:239], v243 offset:3328
    v_mfma_f32_16x16x32_bf16 v[236:239], a[240:243], a[136:139], v[236:239]
    v_exp_f32 v197, v197
    v_mfma_f32_16x16x32_bf16 v[236:239], a[244:247], a[140:143], v[236:239]
    v_exp_f32 v200, v200
    v_mfma_f32_16x16x32_bf16 v[228:231], a[144:147], a[216:219], 0
    v_exp_f32 v201, v201
    v_mfma_f32_16x16x32_bf16 v[228:231], a[148:151], a[220:223], v[228:231]
    s_waitcnt lgkmcnt(5)
    v_cvt_pk_bf16_f32 v193, v196, v197
    v_cvt_pk_bf16_f32 v194, v200, v201
    v_mfma_f32_16x16x32_bf16 v[228:231], a[152:155], a[224:227], v[228:231]
    ds_read_b128 v[196:199], v246 offset:0
    v_cvt_pk_bf16_f32 v80, v236, v237
    v_mfma_f32_16x16x32_bf16 v[212:215], v[18:21], v[192:195], v[212:215]
    ds_read_b128 v[200:203], v244 offset:64
    s_waitcnt lgkmcnt(4)
    v_mfma_f32_16x16x32_bf16 v[216:219], v[48:51], v[192:195], v[216:219]
    ds_read_b128 a[240:243], v240 offset:6144
    v_cvt_pk_bf16_f32 v83, v238, v239
    v_mfma_f32_16x16x32_bf16 v[220:223], v[78:81], v[192:195], v[220:223]
    ds_read_b128 a[244:247], v241 offset:6144
    v_mfma_f32_16x16x32_bf16 v[224:227], a[248:251], v[192:195], v[224:227]
    v_mfma_f32_16x16x32_bf16 v[228:231], a[156:159], a[228:231], v[228:231]
    s_waitcnt lgkmcnt(5)
    v_mfma_f32_16x16x32_bf16 v[228:231], a[160:163], a[232:235], v[228:231]
    s_waitcnt lgkmcnt(4)
    v_mfma_f32_16x16x32_bf16 v[228:231], a[164:167], a[236:239], v[228:231]
    v_mfma_f32_16x16x32_bf16 v[232:235], a[168:171], a[216:219], 0
    v_mfma_f32_16x16x32_bf16 v[232:235], a[172:175], a[220:223], v[232:235]
    v_mfma_f32_16x16x32_bf16 v[232:235], a[176:179], a[224:227], v[232:235]
    v_rcp_f32 v225, v224
    v_mfma_f32_16x16x32_bf16 v[232:235], a[180:183], a[228:231], v[232:235]
    v_mul_f32 v212, v212, v225
    v_mul_f32 v213, v213, v225
    v_mfma_f32_16x16x32_bf16 v[232:235], a[184:187], a[232:235], v[232:235]
    v_mul_f32 v228, s38, v228
    v_mul_f32 v229, s38, v229
    v_mfma_f32_16x16x32_bf16 v[232:235], a[188:191], a[236:239], v[232:235]
    v_mul_f32 v230, s38, v230
    v_mul_f32 v231, s38, v231
    v_mfma_f32_16x16x32_bf16 v[236:239], a[192:195], a[216:219], 0
    v_cvt_pk_bf16_f32 v168, v228, v229
    v_cvt_pk_bf16_f32 v169, v230, v231
    v_mfma_f32_16x16x32_bf16 v[236:239], a[196:199], a[220:223], v[236:239]
    ds_read_b128 a[216:219], v240 offset:6272
    v_mul_f32 v214, v214, v225
    v_mfma_f32_16x16x32_bf16 v[236:239], a[200:203], a[224:227], v[236:239]
    s_waitcnt lgkmcnt(2)
    v_mul_f32 v232, s3, v232
    v_mul_f32 v233, s3, v233
    v_mfma_f32_16x16x32_bf16 v[236:239], a[204:207], a[228:231], v[236:239]
    v_mul_f32 v234, s3, v234
    v_mul_f32 v235, s3, v235
    v_mfma_f32_16x16x32_bf16 v[236:239], a[208:211], a[232:235], v[236:239]
    v_cvt_pk_bf16_f32 v170, v232, v233
    v_cvt_pk_bf16_f32 v171, v234, v235
    v_mfma_f32_16x16x32_bf16 v[236:239], a[212:215], a[236:239], v[236:239]
    ds_read_b128 a[220:223], v241 offset:6272
    ds_read_b128 a[224:227], v240 offset:6400
    v_mfma_f32_16x16x32_bf16 v[204:207], v[90:93], v[168:171], v[204:207]
    ds_read_b128 a[228:231], v241 offset:6400
    v_mul_f32 v215, v215, v225
    v_mfma_f32_16x16x32_bf16 v[208:211], v[126:129], v[168:171], v[208:211]
    v_cvt_pk_bf16_f32 v212, v212, v213
    v_cvt_pk_bf16_f32 v213, v214, v215
    v_mfma_f32_16x16x32_bf16 v[196:199], v[162:165], v[168:171], v[196:199]
    v_mul_f32 v236, s38, v236
    v_mul_f32 v237, s38, v237
    v_mfma_f32_16x16x32_bf16 v[200:203], v[96:99], v[168:171], v[200:203]
    v_mul_f32 v238, s38, v238
    v_mul_f32 v239, s38, v239
    v_mfma_f32_16x16x32_bf16 v[228:231], a[0:3], a[240:243], 0
    s_waitcnt lgkmcnt(4)
    v_cvt_pk_bf16_f32 v172, v236, v237
    v_cvt_pk_bf16_f32 v173, v238, v239
    v_mfma_f32_16x16x32_bf16 v[228:231], a[4:7], a[244:247], v[228:231]
    ds_write_b64 v251, v[212:213] offset:6144
    v_mfma_f32_16x16x32_bf16 v[204:207], v[92:95], v[170:173], v[204:207]
    v_mul_f32 v216, v216, v225
    v_mul_f32 v217, v217, v225
    v_mfma_f32_16x16x32_bf16 v[208:211], v[128:131], v[170:173], v[208:211]
    s_waitcnt lgkmcnt(4)
    v_mul_f32 v218, v218, v225
    v_mul_f32 v219, v219, v225
    v_mfma_f32_16x16x32_bf16 v[196:199], v[164:167], v[170:173], v[196:199]
    v_cvt_pk_bf16_f32 v216, v216, v217
    v_cvt_pk_bf16_f32 v217, v218, v219
    v_mfma_f32_16x16x32_bf16 v[200:203], v[98:101], v[170:173], v[200:203]
    v_exp_f32 v204, v204
    v_mfma_f32_16x16x32_bf16 v[228:231], a[8:11], a[216:219], v[228:231]
    s_waitcnt lgkmcnt(3)
    v_exp_f32 v205, v205
    v_mfma_f32_16x16x32_bf16 v[228:231], a[12:15], a[220:223], v[228:231]
    s_waitcnt lgkmcnt(2)
    v_exp_f32 v206, v206
    v_mfma_f32_16x16x32_bf16 v[228:231], a[16:19], a[224:227], v[228:231]
    s_waitcnt lgkmcnt(1)
    v_exp_f32 v207, v207
    v_mfma_f32_16x16x32_bf16 v[228:231], a[20:23], a[228:231], v[228:231]
    v_cvt_pk_bf16_f32 v180, v204, v205
    v_cvt_pk_bf16_f32 v183, v206, v207
    v_mfma_f32_16x16x32_bf16 v[232:235], a[24:27], a[240:243], 0
    ds_read_b128 v[204:207], v245 offset:64
    v_max3_f32 v248, v248, v224, v225
    v_mfma_f32_16x16x32_bf16 v[232:235], a[28:31], a[244:247], v[232:235]
    v_exp_f32 v208, v208
    v_mfma_f32_16x16x32_bf16 v[232:235], a[32:35], a[216:219], v[232:235]
    v_exp_f32 v209, v209
    v_mfma_f32_16x16x32_bf16 v[232:235], a[36:39], a[220:223], v[232:235]
    v_exp_f32 v210, v210
    v_mfma_f32_16x16x32_bf16 v[232:235], a[40:43], a[224:227], v[232:235]
    v_exp_f32 v211, v211
    v_mfma_f32_16x16x32_bf16 v[232:235], a[44:47], a[228:231], v[232:235]
    v_cvt_pk_bf16_f32 v181, v208, v209
    v_cvt_pk_bf16_f32 v184, v210, v211
    v_mfma_f32_16x16x32_bf16 v[236:239], a[48:51], a[240:243], 0
    v_exp_f32 v196, v196
    v_mfma_f32_16x16x32_bf16 v[236:239], a[52:55], a[244:247], v[236:239]
    v_exp_f32 v197, v197
    v_mfma_f32_16x16x32_bf16 v[236:239], a[56:59], a[216:219], v[236:239]
    ds_read_b128 v[208:211], v246 offset:64
    v_cvt_pk_bf16_f32 v108, v228, v229
    v_mfma_f32_16x16x32_bf16 v[236:239], a[60:63], a[220:223], v[236:239]
    v_cvt_pk_bf16_f32 v109, v230, v231
    v_cvt_pk_bf16_f32 v182, v196, v197
    v_mfma_f32_16x16x32_bf16 v[236:239], a[64:67], a[224:227], v[236:239]
    ds_write_b64 v251, v[216:217] offset:6272
    v_mfma_f32_16x16x32_bf16 v[212:215], v[12:15], v[180:183], 0
    s_waitcnt lgkmcnt(2)
    v_exp_f32 v198, v198
    v_mfma_f32_16x16x32_bf16 v[216:219], v[42:45], v[180:183], 0
    v_exp_f32 v199, v199
    v_mfma_f32_16x16x32_bf16 v[204:207], v[132:135], v[168:171], v[204:207]
    v_cvt_pk_bf16_f32 v185, v198, v199
    v_mul_f32 v220, v220, v225
    v_mfma_f32_16x16x32_bf16 v[204:207], v[134:137], v[170:173], v[204:207]
    ds_read_b128 v[196:199], v244 offset:128
    v_mul_f32 v221, v221, v225
    v_mfma_f32_16x16x32_bf16 v[236:239], a[68:71], a[228:231], v[236:239]
    v_mul_f32 v222, v222, v225
    v_mul_f32 v223, v223, v225
    v_mfma_f32_16x16x32_bf16 v[224:227], a[248:251], v[180:183], 0
    v_cvt_pk_bf16_f32 v220, v220, v221
    v_cvt_pk_bf16_f32 v221, v222, v223
    v_mfma_f32_16x16x32_bf16 v[228:231], a[240:243], a[72:75], 0
    ds_write_b64 v251, v[220:221] offset:6400
    v_mfma_f32_16x16x32_bf16 v[220:223], v[72:75], v[180:183], 0
    s_waitcnt lgkmcnt(3)
    v_cvt_pk_bf16_f32 v110, v232, v233
    v_cvt_pk_bf16_f32 v111, v234, v235
    v_mfma_f32_16x16x32_bf16 v[208:211], v[102:105], v[168:171], v[208:211]
    v_cvt_pk_bf16_f32 v112, v236, v237
    v_cvt_pk_bf16_f32 v113, v238, v239
    v_mfma_f32_16x16x32_bf16 v[208:211], v[104:107], v[170:173], v[208:211]
    ds_read_b128 a[232:235], v254 offset:4608
    ds_read_b128 a[236:239], v255 offset:4608
    v_mfma_f32_16x16x32_bf16 v[228:231], a[244:247], a[76:79], v[228:231]
    v_exp_f32 v200, v200
    v_mfma_f32_16x16x32_bf16 v[228:231], a[216:219], a[80:83], v[228:231]
    v_exp_f32 v201, v201
    v_mfma_f32_16x16x32_bf16 v[228:231], a[220:223], a[84:87], v[228:231]
    v_exp_f32 v202, v202
    v_mfma_f32_16x16x32_bf16 v[228:231], a[224:227], a[88:91], v[228:231]
    v_exp_f32 v203, v203
    v_mfma_f32_16x16x32_bf16 v[228:231], a[228:231], a[92:95], v[228:231]
    v_cvt_pk_bf16_f32 v186, v200, v201
    v_cvt_pk_bf16_f32 v189, v202, v203
    v_mfma_f32_16x16x32_bf16 v[232:235], a[240:243], a[96:99], 0
    ds_read_b128 v[200:203], v245 offset:128
    v_mfma_f32_16x16x32_bf16 v[232:235], a[244:247], a[100:103], v[232:235]
    s_waitcnt lgkmcnt(4)
    v_exp_f32 v204, v204
    v_mfma_f32_16x16x32_bf16 v[196:199], v[138:141], v[168:171], v[196:199]
    v_exp_f32 v205, v205
    v_mfma_f32_16x16x32_bf16 v[196:199], v[140:143], v[170:173], v[196:199]
    v_cvt_pk_bf16_f32 v187, v204, v205
    v_cvt_pk_bf16_f32 v26, v228, v229
    v_mfma_f32_16x16x32_bf16 v[232:235], a[216:219], a[104:107], v[232:235]
    v_exp_f32 v206, v206
    v_mfma_f32_16x16x32_bf16 v[212:215], v[16:19], v[184:187], v[212:215]
    v_exp_f32 v207, v207
    v_mfma_f32_16x16x32_bf16 v[216:219], v[46:49], v[184:187], v[216:219]
    v_cvt_pk_bf16_f32 v29, v230, v231
    v_cvt_pk_bf16_f32 v190, v206, v207
    v_mfma_f32_16x16x32_bf16 v[220:223], v[76:79], v[184:187], v[220:223]
    ds_read_b128 v[204:207], v246 offset:128
    s_waitcnt lgkmcnt(3)
    v_mfma_f32_16x16x32_bf16 v[224:227], a[248:251], v[184:187], v[224:227]
    v_exp_f32 v208, v208
    v_mfma_f32_16x16x32_bf16 v[232:235], a[220:223], a[108:111], v[232:235]
    v_exp_f32 v209, v209
    v_mfma_f32_16x16x32_bf16 v[232:235], a[224:227], a[112:115], v[232:235]
    v_exp_f32 v210, v210
    v_mfma_f32_16x16x32_bf16 v[232:235], a[228:231], a[116:119], v[232:235]
    v_exp_f32 v211, v211
    v_mfma_f32_16x16x32_bf16 v[236:239], a[240:243], a[120:123], 0
    ds_read_b128 a[240:243], v254 offset:4736
    v_cvt_pk_bf16_f32 v188, v208, v209
    v_mfma_f32_16x16x32_bf16 v[236:239], a[244:247], a[124:127], v[236:239]
    ds_read_b128 a[244:247], v255 offset:4736
    s_waitcnt lgkmcnt(3)
    v_mfma_f32_16x16x32_bf16 v[200:203], v[144:147], v[168:171], v[200:203]
    v_cvt_pk_bf16_f32 v191, v210, v211
    v_cvt_pk_bf16_f32 v56, v232, v233
    v_mfma_f32_16x16x32_bf16 v[200:203], v[146:149], v[170:173], v[200:203]
    ds_read_b128 v[208:211], v244 offset:0
    v_cvt_pk_bf16_f32 v59, v234, v235
    v_mfma_f32_16x16x32_bf16 v[212:215], v[20:23], v[188:191], v[212:215]
    v_exp_f32 v196, v196
    v_mfma_f32_16x16x32_bf16 v[216:219], v[50:53], v[188:191], v[216:219]
    v_exp_f32 v197, v197
    v_mfma_f32_16x16x32_bf16 v[220:223], v[80:83], v[188:191], v[220:223]
    v_cvt_pk_bf16_f32 v192, v196, v197
    v_mfma_f32_16x16x32_bf16 v[224:227], a[248:251], v[188:191], v[224:227]
    ds_read_b128 v[196:199], v245 offset:0
    v_mfma_f32_16x16x32_bf16 v[236:239], a[216:219], a[128:131], v[236:239]
    ds_read_b128 a[216:219], v254 offset:4864
    v_accvgpr_read_b32 v254, a252
    v_mfma_f32_16x16x32_bf16 v[236:239], a[220:223], a[132:135], v[236:239]
    ds_read_b128 a[220:223], v255 offset:4864
    v_accvgpr_read_b32 v255, a253
    v_mfma_f32_16x16x32_bf16 v[236:239], a[224:227], a[136:139], v[236:239]
    s_waitcnt lgkmcnt(6)
    v_exp_f32 v200, v200
    v_mfma_f32_16x16x32_bf16 v[204:207], v[108:111], v[168:171], v[204:207]
    v_exp_f32 v201, v201
    v_mfma_f32_16x16x32_bf16 v[204:207], v[110:113], v[170:173], v[204:207]
    buffer_load_dwordx4 v254, s[4:7], s44 offen lds
    v_cvt_pk_bf16_f32 v193, v200, v201
    v_mfma_f32_16x16x32_bf16 v[236:239], a[228:231], a[140:143], v[236:239]
    ds_read_b128 v[200:203], v246 offset:0
    v_accvgpr_read_b32 v254, a254
    v_mfma_f32_16x16x32_bf16 v[228:231], a[144:147], a[232:235], 0
    v_mfma_f32_16x16x32_bf16 v[228:231], a[148:151], a[236:239], v[228:231]
    s_waitcnt lgkmcnt(5)
    v_exp_f32 v204, v204
    v_mfma_f32_16x16x32_bf16 v[228:231], a[152:155], a[240:243], v[228:231]
    v_exp_f32 v205, v205
    v_mfma_f32_16x16x32_bf16 v[228:231], a[156:159], a[244:247], v[228:231]
    s_waitcnt lgkmcnt(2)
    v_cvt_pk_bf16_f32 v86, v236, v237
    v_cvt_pk_bf16_f32 v89, v238, v239
    v_mfma_f32_16x16x32_bf16 v[228:231], a[160:163], a[216:219], v[228:231]
    s_waitcnt lgkmcnt(1)
    v_cvt_pk_bf16_f32 v194, v204, v205
    s_waitcnt vmcnt(6)
    v_mfma_f32_16x16x32_bf16 v[228:231], a[164:167], a[220:223], v[228:231]
    s_barrier
    ds_read_b128 a[224:227], v240 offset:30720
    v_mfma_f32_16x16x32_bf16 v[212:215], v[24:27], v[192:195], v[212:215]
    ds_read_b128 a[228:231], v241 offset:30720
    ds_read_b128 v[204:207], v244 offset:64
    v_mfma_f32_16x16x32_bf16 v[216:219], v[54:57], v[192:195], v[216:219]
    buffer_load_dwordx4 v255, s[4:7], s44 offen offset:1024 lds
    v_accvgpr_read_b32 v255, a252
    v_mfma_f32_16x16x32_bf16 v[220:223], v[84:87], v[192:195], v[220:223]
    v_mul_f32 v228, s38, v228
    v_mul_f32 v229, s38, v229
    v_mfma_f32_16x16x32_bf16 v[224:227], a[248:251], v[192:195], v[224:227]
    v_mul_f32 v230, s38, v230
    v_mul_f32 v231, s38, v231
    v_mfma_f32_16x16x32_bf16 v[232:235], a[168:171], a[232:235], 0
    v_cvt_pk_bf16_f32 v174, v228, v229
    v_cvt_pk_bf16_f32 v175, v230, v231
    v_mfma_f32_16x16x32_bf16 v[232:235], a[172:175], a[236:239], v[232:235]
    ds_write_b64 v247, v[174:175] offset:0
    v_mfma_f32_16x16x32_bf16 v[232:235], a[176:179], a[240:243], v[232:235]
    v_rcp_f32 v225, v224
    v_mfma_f32_16x16x32_bf16 v[232:235], a[180:183], a[244:247], v[232:235]
    v_mul_f32 v212, v212, v225
    v_mul_f32 v213, v213, v225
    v_mfma_f32_16x16x32_bf16 v[232:235], a[184:187], a[216:219], v[232:235]
    v_mul_f32 v214, v214, v225
    v_mul_f32 v215, v215, v225
    v_mfma_f32_16x16x32_bf16 v[232:235], a[188:191], a[220:223], v[232:235]
    v_cvt_pk_bf16_f32 v212, v212, v213
    v_cvt_pk_bf16_f32 v213, v214, v215
    v_mfma_f32_16x16x32_bf16 v[236:239], a[192:195], a[232:235], 0
    ds_read_b128 a[232:235], v240 offset:30848
    v_mul_f32 v216, v216, v225
    v_mfma_f32_16x16x32_bf16 v[236:239], a[196:199], a[236:239], v[236:239]
    ds_read_b128 a[236:239], v241 offset:30848
    v_mul_f32 v217, v217, v225
    v_mfma_f32_16x16x32_bf16 v[236:239], a[200:203], a[240:243], v[236:239]
L_h4:
    s_cbranch_execz L_h8
    v_mul_f32 v232, s3, v232
    v_mul_f32 v233, s3, v233
    v_mfma_f32_16x16x32_bf16 v[236:239], a[204:207], a[244:247], v[236:239]
    s_waitcnt lgkmcnt(5)
    v_mul_f32 v234, s3, v234
    v_mul_f32 v235, s3, v235
    v_mfma_f32_16x16x32_bf16 v[236:239], a[208:211], a[216:219], v[236:239]
    v_cvt_pk_bf16_f32 v176, v232, v233
    v_cvt_pk_bf16_f32 v177, v234, v235
    v_mfma_f32_16x16x32_bf16 v[236:239], a[212:215], a[220:223], v[236:239]
    ds_read_b128 a[240:243], v240 offset:30976
    v_mul_f32 v218, v218, v225
    v_mfma_f32_16x16x32_bf16 v[208:211], v[96:99], v[174:177], v[208:211]
    ds_read_b128 a[244:247], v241 offset:30976
    v_mul_f32 v219, v219, v225
    v_mfma_f32_16x16x32_bf16 v[196:199], v[132:135], v[174:177], v[196:199]
    s_waitcnt lgkmcnt(5)
    v_cvt_pk_bf16_f32 v216, v216, v217
    v_mul_f32 v236, s38, v236
    v_mfma_f32_16x16x32_bf16 v[200:203], v[102:105], v[174:177], v[200:203]
    v_mul_f32 v237, s38, v237
    v_mul_f32 v238, s38, v238
    v_mfma_f32_16x16x32_bf16 v[204:207], v[138:141], v[174:177], v[204:207]
    v_mul_f32 v239, s38, v239
    v_cvt_pk_bf16_f32 v178, v236, v237
    v_mfma_f32_16x16x32_bf16 v[228:231], a[0:3], a[224:227], 0
    v_cvt_pk_bf16_f32 v179, v238, v239
    v_cvt_pk_bf16_f32 v217, v218, v219
    v_mfma_f32_16x16x32_bf16 v[228:231], a[4:7], a[228:231], v[228:231]
    s_waitcnt lgkmcnt(3)
    v_max3_f32 v248, v248, v224, v225
    v_mul_f32 v220, v220, v225
    v_mfma_f32_16x16x32_bf16 v[208:211], v[98:101], v[176:179], v[208:211]
    ds_write_b64 v251, v[212:213] offset:12288
    v_mfma_f32_16x16x32_bf16 v[196:199], v[134:137], v[176:179], v[196:199]
    ds_write_b64 v251, v[216:217] offset:12416
    v_mfma_f32_16x16x32_bf16 v[200:203], v[104:107], v[176:179], v[200:203]
    v_mul_f32 v221, v221, v225
    v_mul_f32 v222, v222, v225
    v_mfma_f32_16x16x32_bf16 v[204:207], v[140:143], v[176:179], v[204:207]
    v_mul_f32 v223, v223, v225
    v_cvt_pk_bf16_f32 v220, v220, v221
    v_mfma_f32_16x16x32_bf16 v[228:231], a[8:11], a[232:235], v[228:231]
    s_waitcnt lgkmcnt(4)
    v_exp_f32 v208, v208
    v_mfma_f32_16x16x32_bf16 v[228:231], a[12:15], a[236:239], v[228:231]
    s_waitcnt lgkmcnt(3)
    v_exp_f32 v209, v209
    v_mfma_f32_16x16x32_bf16 v[228:231], a[16:19], a[240:243], v[228:231]
    s_waitcnt lgkmcnt(2)
    v_exp_f32 v210, v210
    v_mfma_f32_16x16x32_bf16 v[228:231], a[20:23], a[244:247], v[228:231]
    v_exp_f32 v211, v211
    v_mfma_f32_16x16x32_bf16 v[232:235], a[24:27], a[224:227], 0
    v_cvt_pk_bf16_f32 v180, v208, v209
    v_cvt_pk_bf16_f32 v183, v210, v211
    v_mfma_f32_16x16x32_bf16 v[232:235], a[28:31], a[228:231], v[232:235]
    ds_read_b128 v[208:211], v245 offset:64
    v_cvt_pk_bf16_f32 v221, v222, v223
    v_mfma_f32_16x16x32_bf16 v[232:235], a[32:35], a[232:235], v[232:235]
    v_cvt_pk_bf16_f32 v90, v228, v229
    v_cvt_pk_bf16_f32 v91, v230, v231
    v_mfma_f32_16x16x32_bf16 v[232:235], a[36:39], a[236:239], v[232:235]
    v_exp_f32 v196, v196
    v_mfma_f32_16x16x32_bf16 v[232:235], a[40:43], a[240:243], v[232:235]
    v_exp_f32 v197, v197
    v_mfma_f32_16x16x32_bf16 v[232:235], a[44:47], a[244:247], v[232:235]
    v_exp_f32 v200, v200
    v_mfma_f32_16x16x32_bf16 v[236:239], a[48:51], a[224:227], 0
    v_exp_f32 v201, v201
    v_mfma_f32_16x16x32_bf16 v[236:239], a[52:55], a[228:231], v[236:239]
    v_exp_f32 v198, v198
    v_mfma_f32_16x16x32_bf16 v[236:239], a[56:59], a[232:235], v[236:239]
    v_exp_f32 v199, v199
    v_mfma_f32_16x16x32_bf16 v[236:239], a[60:63], a[236:239], v[236:239]
    v_cvt_pk_bf16_f32 v181, v196, v197
    v_cvt_pk_bf16_f32 v182, v200, v201
    v_mfma_f32_16x16x32_bf16 v[236:239], a[64:67], a[240:243], v[236:239]
    v_cvt_pk_bf16_f32 v184, v198, v199
    v_cvt_pk_bf16_f32 v92, v232, v233
    v_mfma_f32_16x16x32_bf16 v[212:215], v[18:21], v[180:183], 0
    ds_read_b128 v[196:199], v246 offset:64
    v_cvt_pk_bf16_f32 v93, v234, v235
    v_mfma_f32_16x16x32_bf16 v[216:219], v[48:51], v[180:183], 0
    ds_write_b64 v251, v[220:221] offset:12544
    v_mfma_f32_16x16x32_bf16 v[220:223], v[78:81], v[180:183], 0
    v_exp_f32 v202, v202
    v_mfma_f32_16x16x32_bf16 v[224:227], a[248:251], v[180:183], 0
    s_waitcnt lgkmcnt(2)
    v_exp_f32 v203, v203
    v_mfma_f32_16x16x32_bf16 v[208:211], v[144:147], v[174:177], v[208:211]
    v_exp_f32 v204, v204
    v_mfma_f32_16x16x32_bf16 v[208:211], v[146:149], v[176:179], v[208:211]
    v_exp_f32 v205, v205
    v_mfma_f32_16x16x32_bf16 v[236:239], a[68:71], a[244:247], v[236:239]
    v_cvt_pk_bf16_f32 v185, v202, v203
    v_cvt_pk_bf16_f32 v186, v204, v205
    v_mfma_f32_16x16x32_bf16 v[228:231], a[224:227], a[72:75], 0
    ds_read_b128 a[216:219], v242 offset:30720
    v_mov_b32 v200, 0x237c0
    v_mfma_f32_16x16x32_bf16 v[228:231], a[228:231], a[76:79], v[228:231]
    v_exp_f32 v208, v208
    v_mfma_f32_16x16x32_bf16 v[228:231], a[232:235], a[80:83], v[228:231]
    v_exp_f32 v209, v209
    v_mfma_f32_16x16x32_bf16 v[228:231], a[236:239], a[84:87], v[228:231]
    v_cvt_pk_bf16_f32 v94, v236, v237
    v_cvt_pk_bf16_f32 v95, v238, v239
    v_mfma_f32_16x16x32_bf16 v[228:231], a[240:243], a[88:91], v[228:231]
    s_waitcnt lgkmcnt(2)
    v_cvt_pk_bf16_f32 v187, v208, v209
    v_add_u32 v201, 0xfffff900, v245
    v_mfma_f32_16x16x32_bf16 v[196:199], v[108:111], v[174:177], v[196:199]
    ds_read_b128 a[220:223], v243 offset:30720
    v_add_u32 v246, 0x700, v245
    v_mfma_f32_16x16x32_bf16 v[212:215], v[22:25], v[184:187], v[212:215]
    v_exp_f32 v206, v206
    v_mfma_f32_16x16x32_bf16 v[216:219], v[52:55], v[184:187], v[216:219]
    v_exp_f32 v207, v207
    v_mfma_f32_16x16x32_bf16 v[220:223], v[82:85], v[184:187], v[220:223]
    v_exp_f32 v210, v210
    v_mfma_f32_16x16x32_bf16 v[224:227], a[248:251], v[184:187], v[224:227]
    v_exp_f32 v211, v211
    v_mfma_f32_16x16x32_bf16 v[196:199], v[110:113], v[176:179], v[196:199]
    v_cvt_pk_bf16_f32 v189, v206, v207
    v_cvt_pk_bf16_f32 v190, v210, v211
    v_mfma_f32_16x16x32_bf16 v[228:231], a[244:247], a[92:95], v[228:231]
    ds_write_b64 v247, v[176:177] offset:128
    v_mfma_f32_16x16x32_bf16 v[232:235], a[224:227], a[96:99], 0
    ds_write_b64 v247, v[178:179] offset:256
    v_mfma_f32_16x16x32_bf16 v[232:235], a[228:231], a[100:103], v[232:235]
    buffer_load_dwordx4 v254, s[4:7], s44 offen offset:2048 lds
    v_accvgpr_read_b32 v254, a253
    v_mfma_f32_16x16x32_bf16 v[232:235], a[232:235], a[104:107], v[232:235]
    s_add_u32 m0, s46, 0xc00
    v_cvt_pk_bf16_f32 v0, v228, v229
    v_cvt_pk_bf16_f32 v3, v230, v231
    v_mfma_f32_16x16x32_bf16 v[232:235], a[236:239], a[108:111], v[232:235]
    s_waitcnt lgkmcnt(3)
    v_exp_f32 v196, v196
    v_mfma_f32_16x16x32_bf16 v[232:235], a[240:243], a[112:115], v[232:235]
    v_exp_f32 v197, v197
    v_mfma_f32_16x16x32_bf16 v[232:235], a[244:247], a[116:119], v[232:235]
    v_exp_f32 v198, v198
    v_mfma_f32_16x16x32_bf16 v[236:239], a[224:227], a[120:123], 0
    ds_read_b128 a[224:227], v242 offset:30848
    v_cvt_pk_bf16_f32 v188, v196, v197
    v_mfma_f32_16x16x32_bf16 v[236:239], a[228:231], a[124:127], v[236:239]
    ds_read_b128 a[228:231], v243 offset:30848
    buffer_load_dwordx4 v255, s[4:7], s59 offen lds
    v_mfma_f32_16x16x32_bf16 v[236:239], a[232:235], a[128:131], v[236:239]
    ds_read_b128 a[232:235], v242 offset:30976
    v_cvt_pk_bf16_f32 v30, v232, v233
    v_mfma_f32_16x16x32_bf16 v[236:239], a[236:239], a[132:135], v[236:239]
    ds_read_b128 a[236:239], v243 offset:30976
    v_cvt_pk_bf16_f32 v33, v234, v235
    v_mfma_f32_16x16x32_bf16 v[236:239], a[240:243], a[136:139], v[236:239]
    v_exp_f32 v199, v199
    v_mfma_f32_16x16x32_bf16 v[236:239], a[244:247], a[140:143], v[236:239]
    ds_read_b128 a[240:243], v240 offset:32256
    v_cvt_pk_bf16_f32 v191, v198, v199
    v_mfma_f32_16x16x32_bf16 v[228:231], a[144:147], a[216:219], 0
    s_waitcnt lgkmcnt(6)
    v_accvgpr_read_b32 v255, a254
    v_mfma_f32_16x16x32_bf16 v[212:215], v[26:29], v[188:191], v[212:215]
    ds_read_b128 a[244:247], v241 offset:32256
    buffer_load_dwordx4 v254, s[4:7], s59 offen offset:1024 lds
    v_mfma_f32_16x16x32_bf16 v[216:219], v[56:59], v[188:191], v[216:219]
    v_cvt_pk_bf16_f32 v60, v236, v237
    v_cvt_pk_bf16_f32 v63, v238, v239
    v_mfma_f32_16x16x32_bf16 v[220:223], v[86:89], v[188:191], v[220:223]
    v_accvgpr_read_b32 v254, a252
    v_mfma_f32_16x16x32_bf16 v[224:227], a[248:251], v[188:191], v[224:227]
    v_mov_b32 v191, 0
    v_mfma_f32_16x16x32_bf16 v[228:231], a[148:151], a[220:223], v[228:231]
    s_waitcnt lgkmcnt(5)
    buffer_load_dwordx4 v255, s[4:7], s59 offen offset:2048 lds
    v_mfma_f32_16x16x32_bf16 v[228:231], a[152:155], a[224:227], v[228:231]
    s_waitcnt lgkmcnt(4)
    v_accvgpr_read_b32 v255, a255
    s_add_u32 m0, s46, 0x1800
    v_mfma_f32_16x16x32_bf16 v[228:231], a[156:159], a[228:231], v[228:231]
    s_waitcnt lgkmcnt(3)
    v_mov_b32 v226, 0x22e00
    v_cndmask_b32 v226, v226, v247, vcc
    v_mfma_f32_16x16x32_bf16 v[228:231], a[160:163], a[232:235], v[228:231]
    s_waitcnt lgkmcnt(2)
    v_rcp_f32 v225, v224
    v_mfma_f32_16x16x32_bf16 v[228:231], a[164:167], a[236:239], v[228:231]
    s_mov_b32 vcc_lo, 0x0
    v_mul_f32 v212, v212, v225
    v_mul_f32 v213, v213, v225
    v_mfma_f32_16x16x32_bf16 v[232:235], a[168:171], a[216:219], 0
    s_mov_b32 vcc_hi, 0xf0000
    v_cndmask_b32 v245, v245, v200, vcc
    v_cndmask_b32 v244, v201, v244, vcc
    v_mfma_f32_16x16x32_bf16 v[232:235], a[172:175], a[220:223], v[232:235]
    s_mov_b32 vcc_lo, 0xff00fff0
    v_mul_f32 v228, s38, v228
    v_mul_f32 v229, s38, v229
    v_mfma_f32_16x16x32_bf16 v[232:235], a[176:179], a[224:227], v[232:235]
    s_mov_b32 vcc_hi, 0xf000
    v_mul_f32 v230, s38, v230
    v_mul_f32 v231, s38, v231
    v_mfma_f32_16x16x32_bf16 v[232:235], a[180:183], a[228:231], v[232:235]
    v_cvt_pk_bf16_f32 v168, v228, v229
    v_cvt_pk_bf16_f32 v169, v230, v231
    v_mfma_f32_16x16x32_bf16 v[232:235], a[184:187], a[232:235], v[232:235]
    s_waitcnt lgkmcnt(1)
    v_cndmask_b32 v244, v244, v200, vcc
    v_mul_f32 v214, v214, v225
    v_mfma_f32_16x16x32_bf16 v[232:235], a[188:191], a[236:239], v[232:235]
    ds_read_b128 v[204:207], v245 offset:192
    v_mul_f32 v215, v215, v225
    v_mfma_f32_16x16x32_bf16 v[236:239], a[192:195], a[216:219], 0
    ds_read_b128 a[216:219], v240 offset:32384
    v_cvt_pk_bf16_f32 v212, v212, v213
    v_mfma_f32_16x16x32_bf16 v[236:239], a[196:199], a[220:223], v[236:239]
    ds_read_b128 a[220:223], v241 offset:32384
    v_cvt_pk_bf16_f32 v213, v214, v215
    v_mfma_f32_16x16x32_bf16 v[236:239], a[200:203], a[224:227], v[236:239]
    ds_read_b128 a[224:227], v240 offset:32512
    v_mul_f32 v232, s3, v232
    v_mfma_f32_16x16x32_bf16 v[236:239], a[204:207], a[228:231], v[236:239]
    ds_read_b128 a[228:231], v241 offset:32512
    v_mul_f32 v233, s3, v233
    v_mfma_f32_16x16x32_bf16 v[236:239], a[208:211], a[232:235], v[236:239]
    s_mov_b32 vcc_lo, 0xfff00ff
    v_mul_f32 v234, s3, v234
    v_mul_f32 v235, s3, v235
    v_mfma_f32_16x16x32_bf16 v[236:239], a[212:215], a[236:239], v[236:239]
    s_mov_b32 vcc_hi, 0xffffffff
    v_cvt_pk_bf16_f32 v170, v232, v233
    v_cvt_pk_bf16_f32 v171, v234, v235
    v_mfma_f32_16x16x32_bf16 v[228:231], a[0:3], a[240:243], 0
    s_waitcnt lgkmcnt(5)
    v_cndmask_b32 v246, v246, v200, vcc
    v_mul_f32 v216, v216, v225
    v_mfma_f32_16x16x32_bf16 v[228:231], a[4:7], a[244:247], v[228:231]
    s_mov_b32 vcc_lo, 0xff00ff00
    v_mul_f32 v236, s38, v236
    v_mul_f32 v237, s38, v237
    v_mfma_f32_16x16x32_bf16 v[232:235], a[24:27], a[240:243], 0
    s_mov_b32 vcc_hi, 0xff00ff00
    s_waitcnt lgkmcnt(3)
    v_mul_f32 v238, s38, v238
    v_mfma_f32_16x16x32_bf16 v[204:207], v[150:153], v[168:171], v[204:207]
    v_mul_f32 v239, s38, v239
    v_cvt_pk_bf16_f32 v172, v236, v237
    v_mfma_f32_16x16x32_bf16 v[228:231], a[8:11], a[216:219], v[228:231]
    s_waitcnt lgkmcnt(2)
    v_cvt_pk_bf16_f32 v173, v238, v239
    v_mul_f32 v217, v217, v225
    v_mfma_f32_16x16x32_bf16 v[228:231], a[12:15], a[220:223], v[228:231]
    s_waitcnt lgkmcnt(1)
    v_mul_f32 v218, v218, v225
    v_mul_f32 v219, v219, v225
    v_mfma_f32_16x16x32_bf16 v[204:207], v[152:155], v[170:173], v[204:207]
    ds_read_b128 v[196:199], v244 offset:256
    v_cvt_pk_bf16_f32 v216, v216, v217
    v_mfma_f32_16x16x32_bf16 v[228:231], a[16:19], a[224:227], v[228:231]
    s_waitcnt lgkmcnt(1)
    v_cvt_pk_bf16_f32 v217, v218, v219
    v_mul_f32 v220, v220, v225
    v_mfma_f32_16x16x32_bf16 v[228:231], a[20:23], a[228:231], v[228:231]
    ds_read_b128 v[200:203], v244 offset:192
    v_mul_f32 v221, v221, v225
    v_mfma_f32_16x16x32_bf16 v[232:235], a[28:31], a[244:247], v[232:235]
    ds_read_b128 v[208:211], v246 offset:192
    v_mul_f32 v222, v222, v225
    v_mfma_f32_16x16x32_bf16 v[232:235], a[32:35], a[216:219], v[232:235]
    ds_read_b128 a[232:235], v242 offset:32256
    v_mul_f32 v223, v223, v225
    v_mfma_f32_16x16x32_bf16 v[232:235], a[36:39], a[220:223], v[232:235]
    v_cvt_pk_bf16_f32 v96, v228, v229
    v_cvt_pk_bf16_f32 v97, v230, v231
    v_mfma_f32_16x16x32_bf16 v[232:235], a[40:43], a[224:227], v[232:235]
    ds_read_b128 a[236:239], v243 offset:32256
    v_cvt_pk_bf16_f32 v220, v220, v221
    v_mfma_f32_16x16x32_bf16 v[232:235], a[44:47], a[228:231], v[232:235]
    v_exp_f32 v204, v204
    v_mfma_f32_16x16x32_bf16 v[236:239], a[48:51], a[240:243], 0
    v_exp_f32 v205, v205
    v_mfma_f32_16x16x32_bf16 v[236:239], a[52:55], a[244:247], v[236:239]
    v_exp_f32 v206, v206
    v_mfma_f32_16x16x32_bf16 v[236:239], a[56:59], a[216:219], v[236:239]
    v_exp_f32 v207, v207
    v_mfma_f32_16x16x32_bf16 v[236:239], a[60:63], a[220:223], v[236:239]
    v_cvt_pk_bf16_f32 v98, v232, v233
    v_cvt_pk_bf16_f32 v99, v234, v235
    v_mfma_f32_16x16x32_bf16 v[236:239], a[64:67], a[224:227], v[236:239]
    v_cvt_pk_bf16_f32 v194, v204, v205
    v_cvt_pk_bf16_f32 v181, v206, v207
    v_mfma_f32_16x16x32_bf16 v[236:239], a[68:71], a[228:231], v[236:239]
    ds_read_b128 v[204:207], v246 offset:256
    s_waitcnt lgkmcnt(5)
    v_mfma_f32_16x16x32_bf16 v[196:199], v[120:123], v[168:171], v[196:199]
    ds_write_b64 v226, v[212:213] offset:0
    v_mfma_f32_16x16x32_bf16 v[196:199], v[122:125], v[170:173], v[196:199]
    s_waitcnt lgkmcnt(5)
    v_cvt_pk_bf16_f32 v221, v222, v223
    v_max3_f32 v248, v248, v224, v225
    v_mfma_f32_16x16x32_bf16 v[200:203], v[114:117], v[168:171], v[200:203]
    s_waitcnt lgkmcnt(4)
    v_cvt_pk_bf16_f32 v100, v236, v237
    v_cvt_pk_bf16_f32 v101, v238, v239
    v_mfma_f32_16x16x32_bf16 v[200:203], v[116:119], v[170:173], v[200:203]
    ds_write_b64 v226, v[216:217] offset:128
    v_mfma_f32_16x16x32_bf16 v[208:211], v[90:93], v[168:171], v[208:211]
    ds_write_b64 v226, v[220:221] offset:256
    v_mfma_f32_16x16x32_bf16 v[208:211], v[92:95], v[170:173], v[208:211]
    v_exp_f32 v196, v196
    v_mfma_f32_16x16x32_bf16 v[228:231], a[240:243], a[72:75], 0
    v_exp_f32 v197, v197
    v_mfma_f32_16x16x32_bf16 v[228:231], a[244:247], a[76:79], v[228:231]
    v_exp_f32 v200, v200
    v_mfma_f32_16x16x32_bf16 v[228:231], a[216:219], a[80:83], v[228:231]
    v_exp_f32 v201, v201
    v_mfma_f32_16x16x32_bf16 v[228:231], a[220:223], a[84:87], v[228:231]
    v_exp_f32 v208, v208
    v_mfma_f32_16x16x32_bf16 v[228:231], a[224:227], a[88:91], v[228:231]
    v_exp_f32 v209, v209
    v_mfma_f32_16x16x32_bf16 v[228:231], a[228:231], a[92:95], v[228:231]
    v_exp_f32 v210, v210
    v_mfma_f32_16x16x32_bf16 v[232:235], a[240:243], a[96:99], 0
    s_waitcnt lgkmcnt(3)
    v_exp_f32 v211, v211
    v_mfma_f32_16x16x32_bf16 v[204:207], v[96:99], v[168:171], v[204:207]
    v_cvt_pk_bf16_f32 v193, v200, v201
    v_cvt_pk_bf16_f32 v192, v208, v209
    v_mfma_f32_16x16x32_bf16 v[204:207], v[98:101], v[170:173], v[204:207]
    v_cvt_pk_bf16_f32 v6, v228, v229
    v_cvt_pk_bf16_f32 v9, v230, v231
    v_mfma_f32_16x16x32_bf16 v[232:235], a[244:247], a[100:103], v[232:235]
    v_cvt_pk_bf16_f32 v195, v210, v211
    v_cvt_pk_bf16_f32 v183, v196, v197
    v_mfma_f32_16x16x32_bf16 v[232:235], a[216:219], a[104:107], v[232:235]
    v_exp_f32 v202, v202
    v_mfma_f32_16x16x32_bf16 v[212:215], v[0:3], v[192:195], 0
    v_exp_f32 v203, v203
    v_mfma_f32_16x16x32_bf16 v[216:219], v[30:33], v[192:195], 0
    ds_read_b128 v[208:211], v244 offset:320
    v_cvt_pk_bf16_f32 v180, v202, v203
    v_mfma_f32_16x16x32_bf16 v[220:223], v[60:63], v[192:195], 0
    ds_read_b128 v[200:203], v245 offset:256
    buffer_load_dwordx4 v254, s[4:7], s58 offen lds
    v_mfma_f32_16x16x32_bf16 v[224:227], a[248:251], v[192:195], 0
    v_exp_f32 v204, v204
    v_mfma_f32_16x16x32_bf16 v[232:235], a[220:223], a[108:111], v[232:235]
    v_exp_f32 v205, v205
    v_mfma_f32_16x16x32_bf16 v[232:235], a[224:227], a[112:115], v[232:235]
    v_exp_f32 v198, v198
    v_mfma_f32_16x16x32_bf16 v[232:235], a[228:231], a[116:119], v[232:235]
    buffer_load_dwordx4 v255, s[4:7], s58 offen offset:512 lds
    v_cvt_pk_bf16_f32 v182, v204, v205
    v_mfma_f32_16x16x32_bf16 v[236:239], a[240:243], a[120:123], 0
    ds_read_b128 a[240:243], v242 offset:32384
    s_add_u32 m0, s46, 0x16800
    v_mfma_f32_16x16x32_bf16 v[212:215], v[4:7], v[180:183], v[212:215]
    v_exp_f32 v199, v199
    v_mfma_f32_16x16x32_bf16 v[224:227], a[248:251], v[180:183], v[224:227]
    v_cvt_pk_bf16_f32 v36, v232, v233
    v_cvt_pk_bf16_f32 v39, v234, v235
    v_mfma_f32_16x16x32_bf16 v[236:239], a[244:247], a[124:127], v[236:239]
    ds_read_b128 a[244:247], v243 offset:32384
    v_cvt_pk_bf16_f32 v186, v198, v199
    v_mfma_f32_16x16x32_bf16 v[216:219], v[34:37], v[180:183], v[216:219]
    ds_read_b128 v[196:199], v245 offset:320
    v_mfma_f32_16x16x32_bf16 v[236:239], a[216:219], a[128:131], v[236:239]
    ds_read_b128 a[216:219], v242 offset:32512
    v_mfma_f32_16x16x32_bf16 v[236:239], a[220:223], a[132:135], v[236:239]
    ds_read_b128 a[220:223], v243 offset:32512
    v_mfma_f32_16x16x32_bf16 v[236:239], a[224:227], a[136:139], v[236:239]
    ds_read_b128 a[224:227], v242 offset:33792
    s_waitcnt lgkmcnt(7)
    v_mfma_f32_16x16x32_bf16 v[208:211], v[126:129], v[168:171], v[208:211]
    v_exp_f32 v206, v206
    v_mfma_f32_16x16x32_bf16 v[208:211], v[128:131], v[170:173], v[208:211]
    s_waitcnt lgkmcnt(6)
    v_exp_f32 v207, v207
    v_mfma_f32_16x16x32_bf16 v[200:203], v[156:159], v[168:171], v[200:203]
    v_cvt_pk_bf16_f32 v185, v206, v207
    v_mfma_f32_16x16x32_bf16 v[200:203], v[158:161], v[170:173], v[200:203]
    ds_read_b128 v[204:207], v244 offset:0
    v_mfma_f32_16x16x32_bf16 v[236:239], a[228:231], a[140:143], v[236:239]
    ds_read_b128 a[228:231], v243 offset:33792
    v_mfma_f32_16x16x32_bf16 v[228:231], a[144:147], a[232:235], 0
    v_exp_f32 v208, v208
    v_mfma_f32_16x16x32_bf16 v[228:231], a[148:151], a[236:239], v[228:231]
    s_waitcnt lgkmcnt(7)
    v_exp_f32 v209, v209
    v_mfma_f32_16x16x32_bf16 v[228:231], a[152:155], a[240:243], v[228:231]
    s_waitcnt lgkmcnt(6)
    v_cvt_pk_bf16_f32 v66, v236, v237
    v_cvt_pk_bf16_f32 v69, v238, v239
    v_mfma_f32_16x16x32_bf16 v[228:231], a[156:159], a[244:247], v[228:231]
    s_waitcnt lgkmcnt(4)
    v_exp_f32 v200, v200
    v_mfma_f32_16x16x32_bf16 v[220:223], v[64:67], v[180:183], v[220:223]
    v_exp_f32 v201, v201
    v_mfma_f32_16x16x32_bf16 v[196:199], v[162:165], v[168:171], v[196:199]
    v_exp_f32 v202, v202
    v_mfma_f32_16x16x32_bf16 v[196:199], v[164:167], v[170:173], v[196:199]
    v_exp_f32 v203, v203
    v_mfma_f32_16x16x32_bf16 v[228:231], a[160:163], a[216:219], v[228:231]
    s_waitcnt lgkmcnt(3)
    v_cvt_pk_bf16_f32 v184, v200, v201
    v_cvt_pk_bf16_f32 v187, v202, v203
    v_mfma_f32_16x16x32_bf16 v[228:231], a[164:167], a[220:223], v[228:231]
    ds_read_b128 v[200:203], v246 offset:320
    v_cvt_pk_bf16_f32 v189, v208, v209
    v_mfma_f32_16x16x32_bf16 v[212:215], v[8:11], v[184:187], v[212:215]
    ds_read_b128 v[208:211], v245 offset:0
    v_mfma_f32_16x16x32_bf16 v[216:219], v[38:41], v[184:187], v[216:219]
    v_exp_f32 v196, v196
    v_mfma_f32_16x16x32_bf16 v[220:223], v[68:71], v[184:187], v[220:223]
    v_exp_f32 v197, v197
    v_mfma_f32_16x16x32_bf16 v[224:227], a[248:251], v[184:187], v[224:227]
    v_mul_f32 v228, s38, v228
    v_mul_f32 v229, s38, v229
    v_mfma_f32_16x16x32_bf16 v[232:235], a[168:171], a[232:235], 0
    v_mul_f32 v230, s38, v230
    v_mul_f32 v231, s38, v231
    v_mfma_f32_16x16x32_bf16 v[232:235], a[172:175], a[236:239], v[232:235]
    v_cvt_pk_bf16_f32 v174, v228, v229
    v_cvt_pk_bf16_f32 v175, v230, v231
    v_mfma_f32_16x16x32_bf16 v[232:235], a[176:179], a[240:243], v[232:235]
    s_waitcnt lgkmcnt(2)
    v_cvt_pk_bf16_f32 v190, v196, v197
    v_mfma_f32_16x16x32_bf16 v[232:235], a[180:183], a[244:247], v[232:235]
    ds_read_b128 v[196:199], v246 offset:0
    v_mfma_f32_16x16x32_bf16 v[232:235], a[184:187], a[216:219], v[232:235]
    v_mfma_f32_16x16x32_bf16 v[232:235], a[188:191], a[220:223], v[232:235]
    v_mfma_f32_16x16x32_bf16 v[236:239], a[192:195], a[232:235], 0
    ds_read_b128 a[232:235], v242 offset:33920
    v_mfma_f32_16x16x32_bf16 v[236:239], a[196:199], a[236:239], v[236:239]
    ds_read_b128 a[236:239], v243 offset:33920
    v_mfma_f32_16x16x32_bf16 v[236:239], a[200:203], a[240:243], v[236:239]
    ds_read_b128 a[240:243], v242 offset:34048
    v_mfma_f32_16x16x32_bf16 v[236:239], a[204:207], a[244:247], v[236:239]
    ds_read_b128 a[244:247], v243 offset:34048
    v_mul_f32 v232, s3, v232
    v_mfma_f32_16x16x32_bf16 v[236:239], a[208:211], a[216:219], v[236:239]
    v_mul_f32 v233, s3, v233
    v_mul_f32 v234, s3, v234
    v_mfma_f32_16x16x32_bf16 v[236:239], a[212:215], a[220:223], v[236:239]
    v_mul_f32 v235, s3, v235
    v_cvt_pk_bf16_f32 v176, v232, v233
    v_mfma_f32_16x16x32_bf16 v[228:231], a[144:147], a[224:227], 0
    v_cvt_pk_bf16_f32 v177, v234, v235
    s_waitcnt lgkmcnt(5)
    v_mfma_f32_16x16x32_bf16 v[228:231], a[148:151], a[228:231], v[228:231]
    v_mfma_f32_16x16x32_bf16 v[204:207], v[120:123], v[174:177], v[204:207]
    v_mfma_f32_16x16x32_bf16 v[208:211], v[156:159], v[174:177], v[208:211]
    s_waitcnt lgkmcnt(3)
    v_mul_f32 v236, s38, v236
    v_mul_f32 v237, s38, v237
    v_mfma_f32_16x16x32_bf16 v[196:199], v[96:99], v[174:177], v[196:199]
    v_mul_f32 v238, s38, v238
    v_mul_f32 v239, s38, v239
    v_mfma_f32_16x16x32_bf16 v[228:231], a[152:155], a[232:235], v[228:231]
    s_waitcnt lgkmcnt(2)
    v_cvt_pk_bf16_f32 v178, v236, v237
    v_cvt_pk_bf16_f32 v179, v238, v239
    v_mfma_f32_16x16x32_bf16 v[228:231], a[156:159], a[236:239], v[228:231]
    s_waitcnt lgkmcnt(1)
    v_mfma_f32_16x16x32_bf16 v[204:207], v[122:125], v[176:179], v[204:207]
    v_mfma_f32_16x16x32_bf16 v[208:211], v[158:161], v[176:179], v[208:211]
    v_mfma_f32_16x16x32_bf16 v[196:199], v[98:101], v[176:179], v[196:199]
    s_waitcnt vmcnt(8) lgkmcnt(0)
    s_barrier
    v_mfma_f32_16x16x32_bf16 v[228:231], a[160:163], a[240:243], v[228:231]
    ds_read_b128 a[216:219], v240 offset:33792
    ds_read_b128 a[220:223], v241 offset:33792
    v_mfma_f32_16x16x32_bf16 v[228:231], a[164:167], a[244:247], v[228:231]
    v_exp_f32 v204, v204
    v_mfma_f32_16x16x32_bf16 v[232:235], a[168:171], a[224:227], 0
    v_exp_f32 v205, v205
    v_mfma_f32_16x16x32_bf16 v[232:235], a[172:175], a[228:231], v[232:235]
    v_exp_f32 v206, v206
    v_mfma_f32_16x16x32_bf16 v[232:235], a[176:179], a[232:235], v[232:235]
    v_exp_f32 v207, v207
    v_mfma_f32_16x16x32_bf16 v[232:235], a[180:183], a[236:239], v[232:235]
    v_mul_f32 v228, s38, v228
    v_mul_f32 v229, s38, v229
    v_mfma_f32_16x16x32_bf16 v[232:235], a[184:187], a[240:243], v[232:235]
    v_mul_f32 v230, s38, v230
    v_mul_f32 v231, s38, v231
    v_mfma_f32_16x16x32_bf16 v[232:235], a[188:191], a[244:247], v[232:235]
    v_cvt_pk_bf16_f32 v228, v228, v229
    v_cvt_pk_bf16_f32 v229, v230, v231
    v_mfma_f32_16x16x32_bf16 v[236:239], a[192:195], a[224:227], 0
    ds_read_b128 a[224:227], v240 offset:33920
    v_cvt_pk_bf16_f32 v193, v204, v205
    v_mfma_f32_16x16x32_bf16 v[236:239], a[196:199], a[228:231], v[236:239]
    ds_read_b128 a[228:231], v241 offset:33920
    v_cvt_pk_bf16_f32 v180, v206, v207
    v_mfma_f32_16x16x32_bf16 v[236:239], a[200:203], a[232:235], v[236:239]
    ds_read_b128 a[232:235], v240 offset:34048
    v_mul_f32 v232, s3, v232
    v_mfma_f32_16x16x32_bf16 v[236:239], a[204:207], a[236:239], v[236:239]
    ds_read_b128 a[236:239], v241 offset:34048
    v_mul_f32 v233, s3, v233
    v_mfma_f32_16x16x32_bf16 v[236:239], a[208:211], a[240:243], v[236:239]
    ds_write_b64 v247, v[228:229] offset:18432
    v_mfma_f32_16x16x32_bf16 v[236:239], a[212:215], a[244:247], v[236:239]
    s_waitcnt lgkmcnt(6)
    v_mul_f32 v234, s3, v234
    v_mul_f32 v235, s3, v235
    v_mfma_f32_16x16x32_bf16 v[228:231], a[0:3], a[216:219], 0
    s_waitcnt lgkmcnt(5)
    v_cvt_pk_bf16_f32 v232, v232, v233
    v_cvt_pk_bf16_f32 v233, v234, v235
    v_mfma_f32_16x16x32_bf16 v[228:231], a[4:7], a[220:223], v[228:231]
    ds_write_b64 v247, v[232:233] offset:18560
    v_mfma_f32_16x16x32_bf16 v[232:235], a[24:27], a[216:219], 0
    s_waitcnt lgkmcnt(5)
    v_mul_f32 v236, s38, v236
    v_mul_f32 v237, s38, v237
    v_mfma_f32_16x16x32_bf16 v[228:231], a[8:11], a[224:227], v[228:231]
    s_waitcnt lgkmcnt(4)
    v_mul_f32 v238, s38, v238
    v_mul_f32 v239, s38, v239
    v_mfma_f32_16x16x32_bf16 v[228:231], a[12:15], a[228:231], v[228:231]
    s_waitcnt lgkmcnt(3)
    v_cvt_pk_bf16_f32 v236, v236, v237
    v_cvt_pk_bf16_f32 v237, v238, v239
    v_mfma_f32_16x16x32_bf16 v[228:231], a[16:19], a[232:235], v[228:231]
    s_waitcnt lgkmcnt(2)
    v_exp_f32 v208, v208
    v_mfma_f32_16x16x32_bf16 v[228:231], a[20:23], a[236:239], v[228:231]
    ds_write_b64 v247, v[236:237] offset:18688
    v_mfma_f32_16x16x32_bf16 v[232:235], a[28:31], a[220:223], v[232:235]
    ds_read_b128 v[204:207], v245 offset:64
    ds_read_b128 a[240:243], v242 offset:61440
    v_mfma_f32_16x16x32_bf16 v[232:235], a[32:35], a[224:227], v[232:235]
    v_exp_f32 v209, v209
    v_mfma_f32_16x16x32_bf16 v[232:235], a[36:39], a[228:231], v[232:235]
    v_exp_f32 v210, v210
    v_mfma_f32_16x16x32_bf16 v[232:235], a[40:43], a[232:235], v[232:235]
    v_cvt_pk_bf16_f32 v138, v228, v229
    v_cvt_pk_bf16_f32 v139, v230, v231
    v_mfma_f32_16x16x32_bf16 v[232:235], a[44:47], a[236:239], v[232:235]
    v_exp_f32 v211, v211
    v_mfma_f32_16x16x32_bf16 v[236:239], a[48:51], a[216:219], 0
    v_cvt_pk_bf16_f32 v194, v208, v209
    v_cvt_pk_bf16_f32 v181, v210, v211
    v_mfma_f32_16x16x32_bf16 v[236:239], a[52:55], a[220:223], v[236:239]
    ds_read_b128 v[208:211], v246 offset:64
    ds_read_b128 a[244:247], v243 offset:61440
    v_mfma_f32_16x16x32_bf16 v[236:239], a[56:59], a[224:227], v[236:239]
    v_cvt_pk_bf16_f32 v140, v232, v233
    v_cvt_pk_bf16_f32 v141, v234, v235
    v_mfma_f32_16x16x32_bf16 v[236:239], a[60:63], a[228:231], v[236:239]
    v_exp_f32 v196, v196
    v_mfma_f32_16x16x32_bf16 v[200:203], v[138:141], v[168:171], v[200:203]
    v_exp_f32 v197, v197
    v_mfma_f32_16x16x32_bf16 v[236:239], a[64:67], a[232:235], v[236:239]
    v_exp_f32 v198, v198
    v_mfma_f32_16x16x32_bf16 v[236:239], a[68:71], a[236:239], v[236:239]
    v_exp_f32 v199, v199
    v_mfma_f32_16x16x32_bf16 v[228:231], a[216:219], a[72:75], 0
    s_waitcnt lgkmcnt(3)
    v_cvt_pk_bf16_f32 v192, v196, v197
    v_cvt_pk_bf16_f32 v195, v198, v199
    v_mfma_f32_16x16x32_bf16 v[204:207], v[162:165], v[174:177], v[204:207]
    ds_read_b128 v[196:199], v244 offset:128
    ds_read_b64 v[168:169], v247 offset:18432
    v_mfma_f32_16x16x32_bf16 v[204:207], v[164:167], v[176:179], v[204:207]
    v_cvt_pk_bf16_f32 v142, v236, v237
    v_cvt_pk_bf16_f32 v143, v238, v239
    v_mfma_f32_16x16x32_bf16 v[228:231], a[220:223], a[76:79], v[228:231]
    v_mfma_f32_16x16x32_bf16 v[228:231], a[224:227], a[80:83], v[228:231]
    v_mfma_f32_16x16x32_bf16 v[200:203], v[140:143], v[170:173], v[200:203]
    ds_read_b64 v[170:171], v247 offset:18560
    ds_read_b64 v[172:173], v247 offset:18688
    v_mfma_f32_16x16x32_bf16 v[228:231], a[228:231], a[84:87], v[228:231]
    v_exp_f32 v204, v204
    v_mfma_f32_16x16x32_bf16 v[228:231], a[232:235], a[88:91], v[228:231]
    s_waitcnt lgkmcnt(5)
    v_exp_f32 v205, v205
    v_mfma_f32_16x16x32_bf16 v[208:211], v[138:141], v[174:177], v[208:211]
    v_exp_f32 v200, v200
    v_mfma_f32_16x16x32_bf16 v[208:211], v[140:143], v[176:179], v[208:211]
    v_exp_f32 v201, v201
    v_mfma_f32_16x16x32_bf16 v[228:231], a[236:239], a[92:95], v[228:231]
    v_cvt_pk_bf16_f32 v188, v200, v201
    v_cvt_pk_bf16_f32 v184, v204, v205
    v_mfma_f32_16x16x32_bf16 v[232:235], a[216:219], a[96:99], 0
    ds_read_b128 v[200:203], v244 offset:64
    v_mfma_f32_16x16x32_bf16 v[224:227], a[248:251], v[188:191], v[224:227]
    v_exp_f32 v206, v206
    v_mfma_f32_16x16x32_bf16 v[232:235], a[220:223], a[100:103], v[232:235]
    v_exp_f32 v208, v208
    v_mfma_f32_16x16x32_bf16 v[232:235], a[224:227], a[104:107], v[232:235]
    s_waitcnt lgkmcnt(4)
    v_cvt_pk_bf16_f32 v12, v228, v229
    v_cvt_pk_bf16_f32 v15, v230, v231
    v_mfma_f32_16x16x32_bf16 v[196:199], v[132:135], v[174:177], v[196:199]
    v_rcp_f32 v225, v224
    v_mfma_f32_16x16x32_bf16 v[212:215], v[12:15], v[188:191], v[212:215]
L_h5:
    s_cbranch_execz L_h9
    v_exp_f32 v209, v209
    v_mfma_f32_16x16x32_bf16 v[196:199], v[134:137], v[176:179], v[196:199]
    v_max3_f32 v248, v248, v224, v225
    v_cvt_pk_bf16_f32 v182, v208, v209
    v_mfma_f32_16x16x32_bf16 v[232:235], a[228:231], a[108:111], v[232:235]
    v_exp_f32 v207, v207
    v_mfma_f32_16x16x32_bf16 v[232:235], a[232:235], a[112:115], v[232:235]
    v_exp_f32 v210, v210
    v_mfma_f32_16x16x32_bf16 v[232:235], a[236:239], a[116:119], v[232:235]
    s_waitcnt lgkmcnt(0)
    v_mul_f32 v212, v212, v225
    v_mul_f32 v213, v213, v225
    v_mfma_f32_16x16x32_bf16 v[200:203], v[126:129], v[174:177], v[200:203]
    v_mul_f32 v214, v214, v225
    v_mul_f32 v215, v215, v225
    v_mfma_f32_16x16x32_bf16 v[200:203], v[128:131], v[176:179], v[200:203]
    v_cvt_pk_bf16_f32 v212, v212, v213
    v_cvt_pk_bf16_f32 v42, v232, v233
    v_mfma_f32_16x16x32_bf16 v[236:239], a[216:219], a[120:123], 0
    ds_read_b128 a[216:219], v242 offset:61568
    v_cvt_pk_bf16_f32 v45, v234, v235
    v_mfma_f32_16x16x32_bf16 v[236:239], a[220:223], a[124:127], v[236:239]
    ds_read_b128 a[220:223], v243 offset:61568
    v_cvt_pk_bf16_f32 v213, v214, v215
    v_mfma_f32_16x16x32_bf16 v[216:219], v[42:45], v[188:191], v[216:219]
    ds_write_b64 v247, v[212:213] offset:6144
    v_mfma_f32_16x16x32_bf16 v[212:215], v[6:9], v[192:195], 0
    v_exp_f32 v200, v200
    v_mfma_f32_16x16x32_bf16 v[236:239], a[224:227], a[128:131], v[236:239]
    ds_read_b128 a[224:227], v242 offset:61696
    v_cvt_pk_bf16_f32 v187, v206, v207
    v_mfma_f32_16x16x32_bf16 v[236:239], a[228:231], a[132:135], v[236:239]
    ds_read_b128 a[228:231], v243 offset:61696
    v_mul_f32 v216, v216, v225
    v_mfma_f32_16x16x32_bf16 v[236:239], a[232:235], a[136:139], v[236:239]
    v_mul_f32 v217, v217, v225
    v_mul_f32 v218, v218, v225
    v_mfma_f32_16x16x32_bf16 v[236:239], a[236:239], a[140:143], v[236:239]
    v_mul_f32 v219, v219, v225
    v_cvt_pk_bf16_f32 v216, v216, v217
    v_mfma_f32_16x16x32_bf16 v[228:231], a[144:147], a[240:243], 0
    ds_read_b128 a[232:235], v242 offset:62976
    v_cvt_pk_bf16_f32 v217, v218, v219
    v_mfma_f32_16x16x32_bf16 v[228:231], a[148:151], a[244:247], v[228:231]
    s_waitcnt lgkmcnt(5)
    v_exp_f32 v201, v201
    v_mfma_f32_16x16x32_bf16 v[228:231], a[152:155], a[216:219], v[228:231]
    s_waitcnt lgkmcnt(4)
    v_cvt_pk_bf16_f32 v72, v236, v237
    v_cvt_pk_bf16_f32 v75, v238, v239
    v_mfma_f32_16x16x32_bf16 v[228:231], a[156:159], a[220:223], v[228:231]
    ds_write_b64 v247, v[216:217] offset:6272
    v_mfma_f32_16x16x32_bf16 v[220:223], v[72:75], v[188:191], v[220:223]
    s_waitcnt lgkmcnt(3)
    v_exp_f32 v202, v202
    v_mfma_f32_16x16x32_bf16 v[216:219], v[36:39], v[192:195], 0
    ds_read_b128 a[236:239], v243 offset:62976
    v_cvt_pk_bf16_f32 v183, v200, v201
    v_mfma_f32_16x16x32_bf16 v[228:231], a[160:163], a[224:227], v[228:231]
    s_waitcnt lgkmcnt(3)
    v_exp_f32 v203, v203
    v_mfma_f32_16x16x32_bf16 v[212:215], v[10:13], v[180:183], v[212:215]
    v_mul_f32 v220, v220, v225
    v_mul_f32 v221, v221, v225
    v_mfma_f32_16x16x32_bf16 v[216:219], v[40:43], v[180:183], v[216:219]
    v_mul_f32 v222, v222, v225
    v_mul_f32 v223, v223, v225
    v_mfma_f32_16x16x32_bf16 v[224:227], a[248:251], v[192:195], 0
    v_cvt_pk_bf16_f32 v220, v220, v221
    v_cvt_pk_bf16_f32 v221, v222, v223
    v_mfma_f32_16x16x32_bf16 v[224:227], a[248:251], v[180:183], v[224:227]
    ds_write_b64 v247, v[220:221] offset:6400
    v_mfma_f32_16x16x32_bf16 v[220:223], v[66:69], v[192:195], 0
    ds_read_b128 v[204:207], v246 offset:128
    v_cvt_pk_bf16_f32 v186, v202, v203
    v_mfma_f32_16x16x32_bf16 v[220:223], v[70:73], v[180:183], v[220:223]
    ds_read_b128 v[200:203], v245 offset:128
    v_mfma_f32_16x16x32_bf16 v[228:231], a[164:167], a[228:231], v[228:231]
    v_exp_f32 v211, v211
    v_mfma_f32_16x16x32_bf16 v[232:235], a[168:171], a[240:243], 0
    v_exp_f32 v196, v196
    v_mfma_f32_16x16x32_bf16 v[232:235], a[172:175], a[244:247], v[232:235]
    v_exp_f32 v197, v197
    v_mfma_f32_16x16x32_bf16 v[232:235], a[176:179], a[216:219], v[232:235]
    v_cvt_pk_bf16_f32 v185, v210, v211
    v_cvt_pk_bf16_f32 v189, v196, v197
    v_mfma_f32_16x16x32_bf16 v[232:235], a[180:183], a[220:223], v[232:235]
    v_mul_f32 v228, s38, v228
    v_mul_f32 v229, s38, v229
    v_mfma_f32_16x16x32_bf16 v[212:215], v[14:17], v[184:187], v[212:215]
    v_mul_f32 v230, s38, v230
    v_mul_f32 v231, s38, v231
    v_mfma_f32_16x16x32_bf16 v[216:219], v[44:47], v[184:187], v[216:219]
    ds_read_b128 v[208:211], v244 offset:0
    v_cvt_pk_bf16_f32 v228, v228, v229
    v_mfma_f32_16x16x32_bf16 v[220:223], v[74:77], v[184:187], v[220:223]
    ds_read_b128 v[196:199], v245 offset:0
    v_cvt_pk_bf16_f32 v229, v230, v231
    v_mfma_f32_16x16x32_bf16 v[224:227], a[248:251], v[184:187], v[224:227]
    ds_write_b64 v247, v[228:229] offset:24576
    v_mfma_f32_16x16x32_bf16 v[232:235], a[184:187], a[224:227], v[232:235]
    s_waitcnt lgkmcnt(6)
    v_mfma_f32_16x16x32_bf16 v[232:235], a[188:191], a[228:231], v[232:235]
    v_mfma_f32_16x16x32_bf16 v[236:239], a[192:195], a[240:243], 0
    ds_read_b128 a[240:243], v242 offset:63104
    v_mfma_f32_16x16x32_bf16 v[236:239], a[196:199], a[244:247], v[236:239]
    ds_read_b128 a[244:247], v243 offset:63104
    s_waitcnt lgkmcnt(5)
    v_mfma_f32_16x16x32_bf16 v[200:203], v[102:105], v[174:177], v[200:203]
    v_mfma_f32_16x16x32_bf16 v[200:203], v[104:107], v[176:179], v[200:203]
    v_mfma_f32_16x16x32_bf16 v[236:239], a[200:203], a[216:219], v[236:239]
    ds_read_b128 a[216:219], v242 offset:63232
    v_mul_f32 v232, s3, v232
    v_mfma_f32_16x16x32_bf16 v[236:239], a[204:207], a[220:223], v[236:239]
    ds_read_b128 a[220:223], v243 offset:63232
    v_mul_f32 v233, s3, v233
    v_mfma_f32_16x16x32_bf16 v[236:239], a[208:211], a[224:227], v[236:239]
    v_mul_f32 v234, s3, v234
    v_mul_f32 v235, s3, v235
    v_mfma_f32_16x16x32_bf16 v[236:239], a[212:215], a[228:231], v[236:239]
    ds_read_b128 a[224:227], v240 offset:35328
    v_cvt_pk_bf16_f32 v232, v232, v233
    v_mfma_f32_16x16x32_bf16 v[228:231], a[144:147], a[232:235], 0
    ds_read_b128 a[228:231], v241 offset:35328
    v_cvt_pk_bf16_f32 v233, v234, v235
    v_mfma_f32_16x16x32_bf16 v[228:231], a[148:151], a[236:239], v[228:231]
    s_waitcnt lgkmcnt(5)
    v_exp_f32 v200, v200
    v_mfma_f32_16x16x32_bf16 v[208:211], v[126:129], v[168:171], v[208:211]
    ds_write_b64 v247, v[232:233] offset:24704
    v_mfma_f32_16x16x32_bf16 v[208:211], v[128:131], v[170:173], v[208:211]
    v_mul_f32 v236, s38, v236
    v_mul_f32 v237, s38, v237
    v_mfma_f32_16x16x32_bf16 v[196:199], v[162:165], v[168:171], v[196:199]
    v_mul_f32 v238, s38, v238
    v_mul_f32 v239, s38, v239
    v_mfma_f32_16x16x32_bf16 v[196:199], v[164:167], v[170:173], v[196:199]
    v_cvt_pk_bf16_f32 v236, v236, v237
    v_cvt_pk_bf16_f32 v237, v238, v239
    v_mfma_f32_16x16x32_bf16 v[228:231], a[152:155], a[240:243], v[228:231]
    s_waitcnt lgkmcnt(5)
    v_exp_f32 v201, v201
    v_mfma_f32_16x16x32_bf16 v[228:231], a[156:159], a[244:247], v[228:231]
    s_waitcnt lgkmcnt(4)
    v_exp_f32 v208, v208
    v_mfma_f32_16x16x32_bf16 v[228:231], a[160:163], a[216:219], v[228:231]
    s_waitcnt lgkmcnt(3)
    v_exp_f32 v209, v209
    v_mfma_f32_16x16x32_bf16 v[228:231], a[164:167], a[220:223], v[228:231]
    ds_write_b64 v247, v[236:237] offset:24832
    v_mfma_f32_16x16x32_bf16 v[232:235], a[168:171], a[232:235], 0
    v_cvt_pk_bf16_f32 v190, v200, v201
    v_cvt_pk_bf16_f32 v193, v208, v209
    v_mfma_f32_16x16x32_bf16 v[232:235], a[172:175], a[236:239], v[232:235]
    ds_read_b128 v[200:203], v246 offset:0
    v_mfma_f32_16x16x32_bf16 v[232:235], a[176:179], a[240:243], v[232:235]
    v_exp_f32 v210, v210
    v_mfma_f32_16x16x32_bf16 v[232:235], a[180:183], a[244:247], v[232:235]
    v_mul_f32 v228, s38, v228
    v_mul_f32 v229, s38, v229
    v_mfma_f32_16x16x32_bf16 v[232:235], a[184:187], a[216:219], v[232:235]
    v_mul_f32 v230, s38, v230
    v_mul_f32 v231, s38, v231
    v_mfma_f32_16x16x32_bf16 v[232:235], a[188:191], a[220:223], v[232:235]
    v_cvt_pk_bf16_f32 v228, v228, v229
    v_cvt_pk_bf16_f32 v229, v230, v231
    v_mfma_f32_16x16x32_bf16 v[236:239], a[192:195], a[232:235], 0
    ds_read_b128 a[232:235], v240 offset:35456
    v_mfma_f32_16x16x32_bf16 v[236:239], a[196:199], a[236:239], v[236:239]
    ds_read_b128 a[236:239], v241 offset:35456
    v_mfma_f32_16x16x32_bf16 v[236:239], a[200:203], a[240:243], v[236:239]
    ds_read_b128 a[240:243], v240 offset:35584
    v_mul_f32 v232, s3, v232
    v_mfma_f32_16x16x32_bf16 v[236:239], a[204:207], a[244:247], v[236:239]
    ds_read_b128 a[244:247], v241 offset:35584
    v_mul_f32 v233, s3, v233
    v_mfma_f32_16x16x32_bf16 v[236:239], a[208:211], a[216:219], v[236:239]
    ds_write_b64 v247, v[228:229] offset:30720
    v_mfma_f32_16x16x32_bf16 v[236:239], a[212:215], a[220:223], v[236:239]
    s_waitcnt vmcnt(0) lgkmcnt(5)
    v_mul_f32 v234, s3, v234
    v_mul_f32 v235, s3, v235
    v_mfma_f32_16x16x32_bf16 v[200:203], v[138:141], v[168:171], v[200:203]
    ds_read_b128 a[216:219], v242 offset:64512
    v_cvt_pk_bf16_f32 v232, v232, v233
    v_mfma_f32_16x16x32_bf16 v[200:203], v[140:143], v[170:173], v[200:203]
    ds_read_b128 a[220:223], v243 offset:64512
    v_cvt_pk_bf16_f32 v233, v234, v235
    v_mfma_f32_16x16x32_bf16 v[228:231], a[0:3], a[224:227], 0
    ds_write_b64 v247, v[232:233] offset:30848
    v_mfma_f32_16x16x32_bf16 v[228:231], a[4:7], a[228:231], v[228:231]
    s_waitcnt lgkmcnt(7)
    v_mul_f32 v236, s38, v236
    v_mul_f32 v237, s38, v237
    v_mfma_f32_16x16x32_bf16 v[228:231], a[8:11], a[232:235], v[228:231]
    s_waitcnt lgkmcnt(6)
    v_mul_f32 v238, s38, v238
    v_mul_f32 v239, s38, v239
    v_mfma_f32_16x16x32_bf16 v[228:231], a[12:15], a[236:239], v[228:231]
    s_waitcnt lgkmcnt(5)
    v_cvt_pk_bf16_f32 v236, v236, v237
    v_cvt_pk_bf16_f32 v237, v238, v239
    v_mfma_f32_16x16x32_bf16 v[228:231], a[16:19], a[240:243], v[228:231]
    s_waitcnt lgkmcnt(4)
    v_exp_f32 v211, v211
    v_mfma_f32_16x16x32_bf16 v[228:231], a[20:23], a[244:247], v[228:231]
    ds_write_b64 v247, v[236:237] offset:30976
    v_mfma_f32_16x16x32_bf16 v[232:235], a[24:27], a[224:227], 0
    s_barrier
    v_exp_f32 v196, v196
    v_mfma_f32_16x16x32_bf16 v[232:235], a[28:31], a[228:231], v[232:235]
    v_exp_f32 v197, v197
    v_mfma_f32_16x16x32_bf16 v[232:235], a[32:35], a[232:235], v[232:235]
    v_cvt_pk_bf16_f32 v180, v210, v211
    v_cvt_pk_bf16_f32 v114, v228, v229
    v_mfma_f32_16x16x32_bf16 v[232:235], a[36:39], a[236:239], v[232:235]
    ds_read_b128 v[208:211], v245 offset:64
    v_cvt_pk_bf16_f32 v115, v230, v231
    v_mfma_f32_16x16x32_bf16 v[232:235], a[40:43], a[240:243], v[232:235]
    v_exp_f32 v198, v198
    v_mfma_f32_16x16x32_bf16 v[232:235], a[44:47], a[244:247], v[232:235]
    v_exp_f32 v199, v199
    v_mfma_f32_16x16x32_bf16 v[236:239], a[48:51], a[224:227], 0
    v_cvt_pk_bf16_f32 v194, v196, v197
    v_cvt_pk_bf16_f32 v181, v198, v199
    v_mfma_f32_16x16x32_bf16 v[236:239], a[52:55], a[228:231], v[236:239]
    ds_read_b128 v[196:199], v246 offset:64
    v_mfma_f32_16x16x32_bf16 v[236:239], a[56:59], a[232:235], v[236:239]
    v_exp_f32 v200, v200
    v_mfma_f32_16x16x32_bf16 v[236:239], a[60:63], a[236:239], v[236:239]
    v_cvt_pk_bf16_f32 v116, v232, v233
    v_cvt_pk_bf16_f32 v117, v234, v235
    v_mfma_f32_16x16x32_bf16 v[236:239], a[64:67], a[240:243], v[236:239]
    v_exp_f32 v201, v201
    v_mfma_f32_16x16x32_bf16 v[204:207], v[114:117], v[174:177], v[204:207]
    v_exp_f32 v202, v202
    v_mfma_f32_16x16x32_bf16 v[236:239], a[68:71], a[244:247], v[236:239]
    v_exp_f32 v203, v203
    v_mfma_f32_16x16x32_bf16 v[228:231], a[224:227], a[72:75], 0
    v_cvt_pk_bf16_f32 v192, v200, v201
    v_cvt_pk_bf16_f32 v195, v202, v203
    v_mfma_f32_16x16x32_bf16 v[228:231], a[228:231], a[76:79], v[228:231]
    ds_read_b128 v[200:203], v244 offset:128
    ds_read_b64 v[174:175], v247 offset:0
    v_mfma_f32_16x16x32_bf16 v[228:231], a[232:235], a[80:83], v[228:231]
    v_cvt_pk_bf16_f32 v118, v236, v237
    v_cvt_pk_bf16_f32 v119, v238, v239
    v_mfma_f32_16x16x32_bf16 v[228:231], a[236:239], a[84:87], v[228:231]
    v_mfma_f32_16x16x32_bf16 v[228:231], a[240:243], a[88:91], v[228:231]
    s_waitcnt lgkmcnt(3)
    v_mfma_f32_16x16x32_bf16 v[204:207], v[116:119], v[176:179], v[204:207]
    ds_read_b64 v[176:177], v247 offset:128
    ds_read_b64 v[178:179], v247 offset:256
    v_mfma_f32_16x16x32_bf16 v[208:211], v[102:105], v[168:171], v[208:211]
    v_mfma_f32_16x16x32_bf16 v[208:211], v[104:107], v[170:173], v[208:211]
    s_waitcnt lgkmcnt(4)
    v_mfma_f32_16x16x32_bf16 v[196:199], v[114:117], v[168:171], v[196:199]
    v_mfma_f32_16x16x32_bf16 v[196:199], v[116:119], v[170:173], v[196:199]
    v_mfma_f32_16x16x32_bf16 v[228:231], a[244:247], a[92:95], v[228:231]
    v_exp_f32 v204, v204
    v_mfma_f32_16x16x32_bf16 v[232:235], a[224:227], a[96:99], 0
    v_exp_f32 v205, v205
    v_mfma_f32_16x16x32_bf16 v[232:235], a[228:231], a[100:103], v[232:235]
    v_cvt_pk_bf16_f32 v188, v204, v205
    v_mfma_f32_16x16x32_bf16 v[232:235], a[232:235], a[104:107], v[232:235]
    ds_read_b128 v[204:207], v244 offset:64
    v_mfma_f32_16x16x32_bf16 v[224:227], a[248:251], v[188:191], v[224:227]
    s_waitcnt lgkmcnt(4)
    v_cvt_pk_bf16_f32 v18, v228, v229
    v_cvt_pk_bf16_f32 v21, v230, v231
    v_mfma_f32_16x16x32_bf16 v[200:203], v[144:147], v[168:171], v[200:203]
    v_exp_f32 v196, v196
    v_mfma_f32_16x16x32_bf16 v[212:215], v[18:21], v[188:191], v[212:215]
    v_exp_f32 v197, v197
    v_mfma_f32_16x16x32_bf16 v[200:203], v[146:149], v[170:173], v[200:203]
    v_rcp_f32 v225, v224
    v_mfma_f32_16x16x32_bf16 v[232:235], a[236:239], a[108:111], v[232:235]
    v_max3_f32 v248, v248, v224, v225
    v_cvt_pk_bf16_f32 v182, v196, v197
    v_mfma_f32_16x16x32_bf16 v[232:235], a[240:243], a[112:115], v[232:235]
    v_exp_f32 v208, v208
    v_mfma_f32_16x16x32_bf16 v[232:235], a[244:247], a[116:119], v[232:235]
    v_mul_f32 v212, v212, v225
    v_mul_f32 v213, v213, v225
    v_mfma_f32_16x16x32_bf16 v[236:239], a[224:227], a[120:123], 0
    ds_read_b128 a[224:227], v242 offset:64640
    s_waitcnt lgkmcnt(1)
    v_mfma_f32_16x16x32_bf16 v[204:207], v[132:135], v[168:171], v[204:207]
    v_mul_f32 v214, v214, v225
    v_mul_f32 v215, v215, v225
    v_mfma_f32_16x16x32_bf16 v[204:207], v[134:137], v[170:173], v[204:207]
    v_cvt_pk_bf16_f32 v48, v232, v233
    v_cvt_pk_bf16_f32 v51, v234, v235
    v_mfma_f32_16x16x32_bf16 v[236:239], a[228:231], a[124:127], v[236:239]
    ds_read_b128 a[228:231], v243 offset:64640
    v_cvt_pk_bf16_f32 v212, v212, v213
    v_mfma_f32_16x16x32_bf16 v[216:219], v[48:51], v[188:191], v[216:219]
    v_exp_f32 v209, v209
    v_mfma_f32_16x16x32_bf16 v[236:239], a[232:235], a[128:131], v[236:239]
    ds_read_b128 a[232:235], v242 offset:64768
    v_cvt_pk_bf16_f32 v213, v214, v215
    v_mfma_f32_16x16x32_bf16 v[236:239], a[236:239], a[132:135], v[236:239]
    ds_read_b128 a[236:239], v243 offset:64768
    v_add_u32 v242, 0xf000, v242
    v_mfma_f32_16x16x32_bf16 v[236:239], a[240:243], a[136:139], v[236:239]
    ds_write_b64 v247, v[212:213] offset:12288
    v_mfma_f32_16x16x32_bf16 v[212:215], v[12:15], v[192:195], 0
    v_mul_f32 v216, v216, v225
    v_mul_f32 v217, v217, v225
    v_mfma_f32_16x16x32_bf16 v[236:239], a[244:247], a[140:143], v[236:239]
    v_mul_f32 v218, v218, v225
    v_mul_f32 v219, v219, v225
    v_mfma_f32_16x16x32_bf16 v[228:231], a[144:147], a[216:219], 0
    ds_read_b128 a[240:243], v242 offset:4608
    v_cvt_pk_bf16_f32 v216, v216, v217
    v_mfma_f32_16x16x32_bf16 v[228:231], a[148:151], a[220:223], v[228:231]
    s_waitcnt lgkmcnt(5)
    v_cvt_pk_bf16_f32 v217, v218, v219
    v_cvt_pk_bf16_f32 v78, v236, v237
    v_mfma_f32_16x16x32_bf16 v[228:231], a[152:155], a[224:227], v[228:231]
    s_waitcnt lgkmcnt(4)
    v_cvt_pk_bf16_f32 v81, v238, v239
    v_add_u32 v243, 0xf000, v243
    v_mfma_f32_16x16x32_bf16 v[228:231], a[156:159], a[228:231], v[228:231]
    ds_write_b64 v247, v[216:217] offset:12416
    v_mfma_f32_16x16x32_bf16 v[220:223], v[78:81], v[188:191], v[220:223]
    s_waitcnt lgkmcnt(4)
    v_exp_f32 v204, v204
    v_mfma_f32_16x16x32_bf16 v[216:219], v[42:45], v[192:195], 0
    ds_read_b128 a[244:247], v243 offset:4608
    v_cvt_pk_bf16_f32 v184, v208, v209
    v_mfma_f32_16x16x32_bf16 v[228:231], a[160:163], a[232:235], v[228:231]
    s_waitcnt lgkmcnt(4)
    v_exp_f32 v205, v205
    v_mfma_f32_16x16x32_bf16 v[228:231], a[164:167], a[236:239], v[228:231]
    v_mul_f32 v220, v220, v225
    v_mul_f32 v221, v221, v225
    v_mfma_f32_16x16x32_bf16 v[232:235], a[168:171], a[216:219], 0
    v_mul_f32 v222, v222, v225
    v_mul_f32 v223, v223, v225
    v_mfma_f32_16x16x32_bf16 v[224:227], a[248:251], v[192:195], 0
    v_cvt_pk_bf16_f32 v220, v220, v221
    v_cvt_pk_bf16_f32 v221, v222, v223
    v_mfma_f32_16x16x32_bf16 v[232:235], a[172:175], a[220:223], v[232:235]
    ds_write_b64 v247, v[220:221] offset:12544
    v_mfma_f32_16x16x32_bf16 v[220:223], v[72:75], v[192:195], 0
    v_exp_f32 v206, v206
    v_mfma_f32_16x16x32_bf16 v[232:235], a[176:179], a[224:227], v[232:235]
    v_exp_f32 v207, v207
    v_mfma_f32_16x16x32_bf16 v[232:235], a[180:183], a[228:231], v[232:235]
    v_cvt_pk_bf16_f32 v183, v204, v205
    v_cvt_pk_bf16_f32 v186, v206, v207
    v_mfma_f32_16x16x32_bf16 v[232:235], a[184:187], a[232:235], v[232:235]
    ds_read_b128 v[204:207], v245 offset:128
    v_mul_f32 v228, s38, v228
    v_mfma_f32_16x16x32_bf16 v[212:215], v[16:19], v[180:183], v[212:215]
    v_mul_f32 v229, s38, v229
    v_mul_f32 v230, s38, v230
    v_mfma_f32_16x16x32_bf16 v[216:219], v[46:49], v[180:183], v[216:219]
    v_mul_f32 v231, s38, v231
    v_cvt_pk_bf16_f32 v228, v228, v229
    v_mfma_f32_16x16x32_bf16 v[220:223], v[76:79], v[180:183], v[220:223]
    v_exp_f32 v210, v210
    v_mfma_f32_16x16x32_bf16 v[224:227], a[248:251], v[180:183], v[224:227]
    v_exp_f32 v211, v211
    v_mfma_f32_16x16x32_bf16 v[232:235], a[188:191], a[236:239], v[232:235]
    v_cvt_pk_bf16_f32 v229, v230, v231
    v_cvt_pk_bf16_f32 v187, v210, v211
    v_mfma_f32_16x16x32_bf16 v[236:239], a[192:195], a[216:219], 0
    ds_read_b128 a[216:219], v242 offset:4736
    ds_read_b128 v[208:211], v246 offset:128
    v_mfma_f32_16x16x32_bf16 v[236:239], a[196:199], a[220:223], v[236:239]
    ds_read_b128 a[220:223], v243 offset:4736
    v_mfma_f32_16x16x32_bf16 v[236:239], a[200:203], a[224:227], v[236:239]
    ds_read_b128 a[224:227], v242 offset:4864
    v_mul_f32 v232, s3, v232
    v_mfma_f32_16x16x32_bf16 v[236:239], a[204:207], a[228:231], v[236:239]
    ds_read_b128 a[228:231], v243 offset:4864
    v_mul_f32 v233, s3, v233
    v_mfma_f32_16x16x32_bf16 v[236:239], a[208:211], a[232:235], v[236:239]
    ds_write_b64 v247, v[228:229] offset:36864
    v_mfma_f32_16x16x32_bf16 v[236:239], a[212:215], a[236:239], v[236:239]
    s_waitcnt lgkmcnt(6)
    v_mul_f32 v234, s3, v234
    v_mul_f32 v235, s3, v235
    v_mfma_f32_16x16x32_bf16 v[204:207], v[108:111], v[168:171], v[204:207]
    v_cvt_pk_bf16_f32 v232, v232, v233
    v_cvt_pk_bf16_f32 v233, v234, v235
    v_mfma_f32_16x16x32_bf16 v[204:207], v[110:113], v[170:173], v[204:207]
    ds_write_b64 v247, v[232:233] offset:36992
    v_mfma_f32_16x16x32_bf16 v[228:231], a[144:147], a[240:243], 0
    v_add_u32 v242, 0x7800, v242
    v_add_u32 v243, 0x4200, v243
    v_mfma_f32_16x16x32_bf16 v[228:231], a[148:151], a[244:247], v[228:231]
    s_waitcnt lgkmcnt(6)
    v_cndmask_b32 v242, v242, v243, vcc
    s_mov_b32 vcc_lo, 0xf0f0f0f0
    v_mfma_f32_16x16x32_bf16 v[228:231], a[152:155], a[216:219], v[228:231]
    s_waitcnt lgkmcnt(4)
    v_add_u32 v243, 0xfffe2000, v242
    s_mov_b32 vcc_hi, 0xf0f0f0f0
    v_mfma_f32_16x16x32_bf16 v[228:231], a[156:159], a[220:223], v[228:231]
    s_waitcnt lgkmcnt(3)
    v_cndmask_b32 v242, v242, v243, vcc
    v_xor_b32 v243, 64, v242
    v_mfma_f32_16x16x32_bf16 v[228:231], a[160:163], a[224:227], v[228:231]
    s_waitcnt lgkmcnt(2)
    ds_read_b128 a[232:235], v242 offset:0
    v_mfma_f32_16x16x32_bf16 v[228:231], a[164:167], a[228:231], v[228:231]
    ds_read_b128 a[236:239], v243 offset:0
    v_mul_f32 v236, s38, v236
    v_mfma_f32_16x16x32_bf16 v[232:235], a[168:171], a[240:243], 0
    s_mov_b32 vcc_lo, 0xcccccccc
    v_mul_f32 v237, s38, v237
    v_mul_f32 v238, s38, v238
    v_mfma_f32_16x16x32_bf16 v[232:235], a[172:175], a[244:247], v[232:235]
    s_mov_b32 vcc_hi, 0xcccccccc
    v_mul_f32 v239, s38, v239
    v_cvt_pk_bf16_f32 v236, v236, v237
    v_mfma_f32_16x16x32_bf16 v[232:235], a[176:179], a[216:219], v[232:235]
    v_cvt_pk_bf16_f32 v237, v238, v239
    v_mul_f32 v228, s38, v228
    v_mfma_f32_16x16x32_bf16 v[232:235], a[180:183], a[220:223], v[232:235]
    ds_write_b64 v247, v[236:237] offset:37120
    v_mfma_f32_16x16x32_bf16 v[232:235], a[184:187], a[224:227], v[232:235]
    v_mul_f32 v229, s38, v229
    v_mul_f32 v230, s38, v230
    v_mfma_f32_16x16x32_bf16 v[232:235], a[188:191], a[228:231], v[232:235]
    v_mul_f32 v231, s38, v231
    v_cvt_pk_bf16_f32 v228, v228, v229
    v_mfma_f32_16x16x32_bf16 v[236:239], a[192:195], a[240:243], 0
    ds_read_b128 a[240:243], v242 offset:128
    v_cvt_pk_bf16_f32 v229, v230, v231
    v_mfma_f32_16x16x32_bf16 v[236:239], a[196:199], a[244:247], v[236:239]
    ds_read_b128 a[244:247], v243 offset:128
    v_mfma_f32_16x16x32_bf16 v[236:239], a[200:203], a[216:219], v[236:239]
    ds_read_b128 a[216:219], v242 offset:256
    v_mul_f32 v232, s3, v232
    v_mfma_f32_16x16x32_bf16 v[236:239], a[204:207], a[220:223], v[236:239]
    ds_read_b128 a[220:223], v243 offset:256
    v_mul_f32 v233, s3, v233
    v_mfma_f32_16x16x32_bf16 v[236:239], a[208:211], a[224:227], v[236:239]
    ds_write_b64 v247, v[228:229] offset:43008
    v_mfma_f32_16x16x32_bf16 v[236:239], a[212:215], a[228:231], v[236:239]
    s_waitcnt lgkmcnt(7)
    v_mul_f32 v234, s3, v234
    v_mul_f32 v235, s3, v235
    v_mfma_f32_16x16x32_bf16 v[228:231], a[144:147], a[232:235], 0
    s_waitcnt lgkmcnt(6)
    v_cvt_pk_bf16_f32 v232, v232, v233
    v_cvt_pk_bf16_f32 v233, v234, v235
    v_mfma_f32_16x16x32_bf16 v[228:231], a[148:151], a[236:239], v[228:231]
    ds_write_b64 v247, v[232:233] offset:43136
    v_mfma_f32_16x16x32_bf16 v[232:235], a[168:171], a[232:235], 0
    s_waitcnt lgkmcnt(5)
    ds_read_b128 a[224:227], v240 offset:36864
    v_mfma_f32_16x16x32_bf16 v[228:231], a[152:155], a[240:243], v[228:231]
    s_waitcnt lgkmcnt(5)
    ds_read_b128 a[228:231], v241 offset:36864
    v_mfma_f32_16x16x32_bf16 v[228:231], a[156:159], a[244:247], v[228:231]
    s_waitcnt lgkmcnt(5)
    v_mul_f32 v236, s38, v236
    v_mul_f32 v237, s38, v237
    v_mfma_f32_16x16x32_bf16 v[228:231], a[160:163], a[216:219], v[228:231]
    s_waitcnt lgkmcnt(4)
    v_mul_f32 v238, s38, v238
    v_mul_f32 v239, s38, v239
    v_mfma_f32_16x16x32_bf16 v[228:231], a[164:167], a[220:223], v[228:231]
    v_cvt_pk_bf16_f32 v236, v236, v237
    v_cvt_pk_bf16_f32 v237, v238, v239
    v_mfma_f32_16x16x32_bf16 v[232:235], a[172:175], a[236:239], v[232:235]
    ds_write_b64 v247, v[236:237] offset:43264
    v_mfma_f32_16x16x32_bf16 v[232:235], a[176:179], a[240:243], v[232:235]
    v_exp_f32 v198, v198
    v_mfma_f32_16x16x32_bf16 v[232:235], a[180:183], a[244:247], v[232:235]
    v_exp_f32 v199, v199
    v_mfma_f32_16x16x32_bf16 v[232:235], a[184:187], a[216:219], v[232:235]
    v_mul_f32 v228, s38, v228
    v_mul_f32 v229, s38, v229
    v_mfma_f32_16x16x32_bf16 v[232:235], a[188:191], a[220:223], v[232:235]
    v_mul_f32 v230, s38, v230
    v_mul_f32 v231, s38, v231
    v_mfma_f32_16x16x32_bf16 v[236:239], a[192:195], a[232:235], 0
    ds_read_b128 a[232:235], v240 offset:36992
    v_cvt_pk_bf16_f32 v228, v228, v229
    v_mfma_f32_16x16x32_bf16 v[236:239], a[196:199], a[236:239], v[236:239]
    ds_read_b128 a[236:239], v241 offset:36992
    v_cvt_pk_bf16_f32 v229, v230, v231
    v_mfma_f32_16x16x32_bf16 v[236:239], a[200:203], a[240:243], v[236:239]
    ds_read_b128 a[240:243], v240 offset:37120
    v_mul_f32 v232, s3, v232
    v_mfma_f32_16x16x32_bf16 v[236:239], a[204:207], a[244:247], v[236:239]
    ds_read_b128 a[244:247], v241 offset:37120
    v_mul_f32 v233, s3, v233
    v_mfma_f32_16x16x32_bf16 v[236:239], a[208:211], a[216:219], v[236:239]
    ds_write_b64 v247, v[228:229] offset:49152
    v_mfma_f32_16x16x32_bf16 v[236:239], a[212:215], a[220:223], v[236:239]
    s_waitcnt lgkmcnt(6)
    v_mul_f32 v234, s3, v234
    v_mul_f32 v235, s3, v235
    v_mfma_f32_16x16x32_bf16 v[228:231], a[0:3], a[224:227], 0
    v_cvt_pk_bf16_f32 v232, v232, v233
    v_cvt_pk_bf16_f32 v233, v234, v235
    v_mfma_f32_16x16x32_bf16 v[228:231], a[4:7], a[228:231], v[228:231]
    ds_write_b64 v247, v[232:233] offset:49280
    v_mfma_f32_16x16x32_bf16 v[232:235], a[24:27], a[224:227], 0
    s_waitcnt lgkmcnt(5)
    v_mul_f32 v236, s38, v236
    v_mul_f32 v237, s38, v237
    v_mfma_f32_16x16x32_bf16 v[228:231], a[8:11], a[232:235], v[228:231]
    s_waitcnt lgkmcnt(4)
    v_mul_f32 v238, s38, v238
    v_mul_f32 v239, s38, v239
    v_mfma_f32_16x16x32_bf16 v[228:231], a[12:15], a[236:239], v[228:231]
    s_waitcnt lgkmcnt(3)
    v_cvt_pk_bf16_f32 v236, v236, v237
    v_cvt_pk_bf16_f32 v237, v238, v239
    v_mfma_f32_16x16x32_bf16 v[228:231], a[16:19], a[240:243], v[228:231]
    s_waitcnt lgkmcnt(2)
    v_cvt_pk_bf16_f32 v185, v198, v199
    v_add_u32 v240, 0xffff1000, v240
    v_mfma_f32_16x16x32_bf16 v[228:231], a[20:23], a[244:247], v[228:231]
    ds_write_b64 v247, v[236:237] offset:49408
    v_mfma_f32_16x16x32_bf16 v[212:215], v[20:23], v[184:187], v[212:215]
    ds_read_b128 v[196:199], v244 offset:32
    v_add_u32 v241, 0xffff1000, v241
    v_mfma_f32_16x16x32_bf16 v[216:219], v[50:53], v[184:187], v[216:219]
    v_exp_f32 v200, v200
    v_mfma_f32_16x16x32_bf16 v[220:223], v[80:83], v[184:187], v[220:223]
    v_exp_f32 v201, v201
    v_mfma_f32_16x16x32_bf16 v[224:227], a[248:251], v[184:187], v[224:227]
    v_cvt_pk_bf16_f32 v120, v228, v229
    v_cvt_pk_bf16_f32 v121, v230, v231
    v_mfma_f32_16x16x32_bf16 v[232:235], a[28:31], a[228:231], v[232:235]
    ds_read_b128 a[216:219], v242 offset:3072
    v_cvt_pk_bf16_f32 v189, v200, v201
    v_mfma_f32_16x16x32_bf16 v[232:235], a[32:35], a[232:235], v[232:235]
    ds_read_b128 v[200:203], v245 offset:32
    ds_read_b128 a[220:223], v243 offset:3072
    v_mfma_f32_16x16x32_bf16 v[232:235], a[36:39], a[236:239], v[232:235]
    v_exp_f32 v204, v204
    v_mfma_f32_16x16x32_bf16 v[232:235], a[40:43], a[240:243], v[232:235]
    v_exp_f32 v205, v205
    v_mfma_f32_16x16x32_bf16 v[232:235], a[44:47], a[244:247], v[232:235]
    v_cvt_pk_bf16_f32 v190, v204, v205
    v_mfma_f32_16x16x32_bf16 v[236:239], a[48:51], a[224:227], 0
    ds_read_b128 v[204:207], v246 offset:32
    v_mfma_f32_16x16x32_bf16 v[236:239], a[52:55], a[228:231], v[236:239]
    v_mfma_f32_16x16x32_bf16 v[236:239], a[56:59], a[232:235], v[236:239]
    v_mfma_f32_16x16x32_bf16 v[236:239], a[60:63], a[236:239], v[236:239]
    v_mfma_f32_16x16x32_bf16 v[236:239], a[64:67], a[240:243], v[236:239]
    v_mfma_f32_16x16x32_bf16 v[236:239], a[68:71], a[244:247], v[236:239]
    s_waitcnt lgkmcnt(4)
    v_cvt_pk_bf16_f32 v122, v232, v233
    v_cvt_pk_bf16_f32 v123, v234, v235
    v_mfma_f32_16x16x32_bf16 v[196:199], v[132:135], v[174:177], v[196:199]
    v_mfma_f32_16x16x32_bf16 v[196:199], v[134:137], v[176:179], v[196:199]
    v_mfma_f32_16x16x32_bf16 v[208:211], v[120:123], v[168:171], v[208:211]
    ds_read_b64 v[168:169], v247 offset:24576
    v_mfma_f32_16x16x32_bf16 v[228:231], a[224:227], a[72:75], 0
    v_cvt_pk_bf16_f32 v124, v236, v237
    v_cvt_pk_bf16_f32 v125, v238, v239
    v_mfma_f32_16x16x32_bf16 v[228:231], a[228:231], a[76:79], v[228:231]
    s_waitcnt lgkmcnt(3)
    v_mfma_f32_16x16x32_bf16 v[208:211], v[122:125], v[170:173], v[208:211]
    v_exp_f32 v196, v196
    v_mfma_f32_16x16x32_bf16 v[200:203], v[102:105], v[174:177], v[200:203]
    v_exp_f32 v197, v197
    v_mfma_f32_16x16x32_bf16 v[200:203], v[104:107], v[176:179], v[200:203]
    v_exp_f32 v198, v198
    v_mfma_f32_16x16x32_bf16 v[228:231], a[232:235], a[80:83], v[228:231]
    s_waitcnt lgkmcnt(1)
    v_exp_f32 v199, v199
    v_mfma_f32_16x16x32_bf16 v[204:207], v[114:117], v[174:177], v[204:207]
    v_exp_f32 v208, v208
    v_mfma_f32_16x16x32_bf16 v[204:207], v[116:119], v[176:179], v[204:207]
    v_exp_f32 v209, v209
    v_mfma_f32_16x16x32_bf16 v[228:231], a[236:239], a[84:87], v[228:231]
    v_cvt_pk_bf16_f32 v188, v208, v209
    v_cvt_pk_bf16_f32 v193, v196, v197
    v_mfma_f32_16x16x32_bf16 v[228:231], a[240:243], a[88:91], v[228:231]
    ds_read_b128 v[208:211], v244 offset:96
    v_cvt_pk_bf16_f32 v180, v198, v199
    v_mfma_f32_16x16x32_bf16 v[224:227], a[248:251], v[188:191], v[224:227]
    ds_read_b128 v[196:199], v245 offset:96
    ds_read_b64 v[170:171], v247 offset:24704
    v_mfma_f32_16x16x32_bf16 v[228:231], a[244:247], a[92:95], v[228:231]
    v_exp_f32 v200, v200
    v_mfma_f32_16x16x32_bf16 v[232:235], a[224:227], a[96:99], 0
    v_exp_f32 v201, v201
    v_mfma_f32_16x16x32_bf16 v[232:235], a[228:231], a[100:103], v[232:235]
    v_exp_f32 v202, v202
    v_mfma_f32_16x16x32_bf16 v[232:235], a[232:235], a[104:107], v[232:235]
    v_exp_f32 v203, v203
    v_mfma_f32_16x16x32_bf16 v[232:235], a[236:239], a[108:111], v[232:235]
    v_cvt_pk_bf16_f32 v24, v228, v229
    v_cvt_pk_bf16_f32 v27, v230, v231
    v_mfma_f32_16x16x32_bf16 v[232:235], a[240:243], a[112:115], v[232:235]
    v_mbcnt_lo_u32_b32 v228, -1, 0
    v_mbcnt_hi_u32_b32 v228, -1, v228
    v_mfma_f32_16x16x32_bf16 v[212:215], v[24:27], v[188:191], v[212:215]
    v_lshrrev_b32 v229, 1, v228
    v_add_u32 v229, 64, v229
    v_mfma_f32_16x16x32_bf16 v[232:235], a[244:247], a[116:119], v[232:235]
L_h6:
    s_cbranch_execz L_hback
    v_mul_u32_u24 v230, 43, v229
    v_lshrrev_b32 v231, 8, v230
    v_mfma_f32_16x16x32_bf16 v[236:239], a[224:227], a[120:123], 0
    ds_read_b128 a[224:227], v242 offset:3200
    v_lshrrev_b32 v230, 7, v230
    v_mfma_f32_16x16x32_bf16 v[236:239], a[228:231], a[124:127], v[236:239]
    ds_read_b128 a[228:231], v243 offset:3200
    v_mad_i32_i24 v229, v230, -3, v229
    v_mfma_f32_16x16x32_bf16 v[236:239], a[232:235], a[128:131], v[236:239]
    ds_read_b128 a[232:235], v242 offset:3328
    v_cvt_pk_bf16_f32 v54, v232, v233
    v_mfma_f32_16x16x32_bf16 v[236:239], a[236:239], a[132:135], v[236:239]
    ds_read_b128 a[236:239], v243 offset:3328
    v_cvt_pk_bf16_f32 v57, v234, v235
    v_mfma_f32_16x16x32_bf16 v[236:239], a[240:243], a[136:139], v[236:239]
    s_waitcnt lgkmcnt(6)
    v_and_b32 v231, 4, v231
    v_xor_b32 v230, v230, v231
    v_mfma_f32_16x16x32_bf16 v[216:219], v[54:57], v[188:191], v[216:219]
    ds_read_b128 a[240:243], v240 offset:0
    v_and_b32 v231, 4, v230
    v_mfma_f32_16x16x32_bf16 v[208:211], v[144:147], v[174:177], v[208:211]
    s_waitcnt lgkmcnt(5)
    v_mul_u32_u24 v251, 24, v231
    v_lshrrev_b32 v231, 3, v230
    v_mfma_f32_16x16x32_bf16 v[208:211], v[146:149], v[176:179], v[208:211]
    v_lshl_add_u32 v251, v231, 2, v251
    v_and_or_b32 v251, v230, 3, v251
    v_mfma_f32_16x16x32_bf16 v[196:199], v[108:111], v[174:177], v[196:199]
    v_mad_u32_u24 v251, v251, 3, v229
    v_and_b32 v231, 1, v228
    v_mfma_f32_16x16x32_bf16 v[196:199], v[110:113], v[176:179], v[196:199]
    v_lshl_add_u32 v251, v251, 3, v231
    v_lshlrev_b32 v251, 4, v251
    v_mfma_f32_16x16x32_bf16 v[236:239], a[244:247], a[140:143], v[236:239]
    ds_read_b128 a[244:247], v241 offset:0
    v_add_u32 v251, 0xfffff800, v251
    v_mfma_f32_16x16x32_bf16 v[232:235], a[144:147], a[216:219], 0
    v_cvt_pk_bf16_f32 v194, v200, v201
    s_waitcnt lgkmcnt(2)
    v_mfma_f32_16x16x32_bf16 v[232:235], a[148:151], a[220:223], v[232:235]
    s_barrier
    buffer_load_dwordx4 v252, s[12:15], s62 offen lds
    v_mfma_f32_16x16x32_bf16 v[232:235], a[152:155], a[224:227], v[232:235]
    v_cvt_pk_bf16_f32 v84, v236, v237
    v_cvt_pk_bf16_f32 v87, v238, v239
    v_mfma_f32_16x16x32_bf16 v[232:235], a[156:159], a[228:231], v[232:235]
    ds_read_b64 v[172:173], v247 offset:24832
    v_cvt_pk_bf16_f32 v181, v202, v203
    v_mfma_f32_16x16x32_bf16 v[220:223], v[84:87], v[188:191], v[220:223]
    ds_read_b128 v[200:203], v246 offset:96
    v_mfma_f32_16x16x32_bf16 v[232:235], a[160:163], a[232:235], v[232:235]
    buffer_load_dwordx4 v253, s[12:15], s62 offen offset:1024 lds
    v_mfma_f32_16x16x32_bf16 v[232:235], a[164:167], a[236:239], v[232:235]
    v_rcp_f32 v225, v224
    v_mfma_f32_16x16x32_bf16 v[236:239], a[168:171], a[216:219], 0
    v_exp_f32 v204, v204
    v_mfma_f32_16x16x32_bf16 v[236:239], a[172:175], a[220:223], v[236:239]
    v_exp_f32 v205, v205
    v_mfma_f32_16x16x32_bf16 v[236:239], a[176:179], a[224:227], v[236:239]
    buffer_load_dwordx4 v251, s[12:15], s62 offen offset:2048 lds
    s_add_u32 m0, s46, 0x17400
    v_mfma_f32_16x16x32_bf16 v[236:239], a[180:183], a[228:231], v[236:239]
    s_lshl_b32 s62, s28, 5
    v_mul_f32 v232, s38, v232
    v_mul_f32 v233, s38, v233
    v_mfma_f32_16x16x32_bf16 v[236:239], a[184:187], a[232:235], v[236:239]
    s_add_u32 s62, s62, 0x3000
    v_mul_f32 v234, s38, v234
    v_mul_f32 v235, s38, v235
    v_mfma_f32_16x16x32_bf16 v[236:239], a[188:191], a[236:239], v[236:239]
    v_cvt_pk_bf16_f32 v232, v232, v233
    v_cvt_pk_bf16_f32 v233, v234, v235
    v_mfma_f32_16x16x32_bf16 v[228:231], a[192:195], a[216:219], 0
    buffer_load_dwordx4 v252, s[12:15], s63 offen lds
    ds_read_b128 a[216:219], v240 offset:128
    v_mfma_f32_16x16x32_bf16 v[228:231], a[196:199], a[220:223], v[228:231]
    ds_read_b128 a[220:223], v241 offset:128
    v_mul_f32 v212, v212, v225
    v_mfma_f32_16x16x32_bf16 v[228:231], a[200:203], a[224:227], v[228:231]
    ds_read_b128 a[224:227], v240 offset:256
    v_mul_f32 v236, s3, v236
    v_mfma_f32_16x16x32_bf16 v[228:231], a[204:207], a[228:231], v[228:231]
    ds_read_b128 a[228:231], v241 offset:256
    v_mul_f32 v237, s3, v237
    v_mfma_f32_16x16x32_bf16 v[228:231], a[208:211], a[232:235], v[228:231]
    buffer_load_dwordx4 v253, s[12:15], s63 offen offset:1024 lds
    v_mul_f32 v238, s3, v238
    v_mfma_f32_16x16x32_bf16 v[228:231], a[212:215], a[236:239], v[228:231]
    s_waitcnt lgkmcnt(4)
    v_mul_f32 v239, s3, v239
    v_cvt_pk_bf16_f32 v236, v236, v237
    v_mfma_f32_16x16x32_bf16 v[200:203], v[120:123], v[174:177], v[200:203]
    ds_write_b64 v247, v[232:233] offset:55296
    v_mfma_f32_16x16x32_bf16 v[200:203], v[122:125], v[176:179], v[200:203]
    v_cvt_pk_bf16_f32 v237, v238, v239
    v_mul_f32 v213, v213, v225
    v_mfma_f32_16x16x32_bf16 v[232:235], a[0:3], a[240:243], 0
    buffer_load_dwordx4 v251, s[12:15], s63 offen offset:2048 lds
    v_mul_f32 v228, s38, v228
    v_mfma_f32_16x16x32_bf16 v[232:235], a[4:7], a[244:247], v[232:235]
    s_waitcnt lgkmcnt(4)
    v_mul_f32 v229, s38, v229
    v_mul_f32 v230, s38, v230
    v_mfma_f32_16x16x32_bf16 v[232:235], a[8:11], a[216:219], v[232:235]
    s_waitcnt lgkmcnt(3)
    v_mul_f32 v231, s38, v231
    v_cvt_pk_bf16_f32 v228, v228, v229
    v_mfma_f32_16x16x32_bf16 v[232:235], a[12:15], a[220:223], v[232:235]
    s_waitcnt lgkmcnt(2)
    v_cvt_pk_bf16_f32 v229, v230, v231
    v_cvt_pk_bf16_f32 v192, v204, v205
    v_mfma_f32_16x16x32_bf16 v[232:235], a[16:19], a[224:227], v[232:235]
    s_waitcnt lgkmcnt(1)
    v_exp_f32 v206, v206
    v_mfma_f32_16x16x32_bf16 v[232:235], a[20:23], a[228:231], v[232:235]
    ds_write_b64 v247, v[236:237] offset:55424
    v_mfma_f32_16x16x32_bf16 v[236:239], a[24:27], a[240:243], 0
    ds_write_b64 v247, v[228:229] offset:55552
    v_mfma_f32_16x16x32_bf16 v[236:239], a[28:31], a[244:247], v[236:239]
    s_add_u32 m0, s46, 0x16800
    v_exp_f32 v207, v207
    v_mfma_f32_16x16x32_bf16 v[236:239], a[32:35], a[216:219], v[236:239]
    s_lshl_b32 s63, s28, 5
    v_cvt_pk_bf16_f32 v126, v232, v233
    v_cvt_pk_bf16_f32 v127, v234, v235
    v_mfma_f32_16x16x32_bf16 v[236:239], a[36:39], a[220:223], v[236:239]
    s_add_u32 s63, s63, 0x7800
    v_cvt_pk_bf16_f32 v195, v206, v207
    v_mul_f32 v214, v214, v225
    v_mfma_f32_16x16x32_bf16 v[236:239], a[40:43], a[224:227], v[236:239]
    v_mul_f32 v215, v215, v225
    v_cvt_pk_bf16_f32 v212, v212, v213
    v_mfma_f32_16x16x32_bf16 v[236:239], a[44:47], a[228:231], v[236:239]
    ds_read_b128 v[204:207], v244 offset:192
    v_cvt_pk_bf16_f32 v213, v214, v215
    v_mfma_f32_16x16x32_bf16 v[228:231], a[48:51], a[240:243], 0
    ds_write_b64 v247, v[212:213] offset:18432
    v_mfma_f32_16x16x32_bf16 v[212:215], v[18:21], v[192:195], 0
    v_mul_f32 v216, v216, v225
    v_mul_f32 v217, v217, v225
    v_mfma_f32_16x16x32_bf16 v[228:231], a[52:55], a[244:247], v[228:231]
    v_mul_f32 v218, v218, v225
    v_mul_f32 v219, v219, v225
    v_mfma_f32_16x16x32_bf16 v[228:231], a[56:59], a[216:219], v[228:231]
    v_cvt_pk_bf16_f32 v216, v216, v217
    v_cvt_pk_bf16_f32 v217, v218, v219
    v_mfma_f32_16x16x32_bf16 v[228:231], a[60:63], a[220:223], v[228:231]
    ds_write_b64 v247, v[216:217] offset:18560
    v_mfma_f32_16x16x32_bf16 v[216:219], v[48:51], v[192:195], 0
    v_cvt_pk_bf16_f32 v128, v236, v237
    v_cvt_pk_bf16_f32 v129, v238, v239
    v_mfma_f32_16x16x32_bf16 v[228:231], a[64:67], a[224:227], v[228:231]
    v_max3_f32 v248, v248, v224, v225
    v_mul_f32 v220, v220, v225
    v_mfma_f32_16x16x32_bf16 v[228:231], a[68:71], a[228:231], v[228:231]
    v_mul_f32 v221, v221, v225
    v_mul_f32 v222, v222, v225
    v_mfma_f32_16x16x32_bf16 v[232:235], a[240:243], a[72:75], 0
    v_mul_f32 v223, v223, v225
    v_cvt_pk_bf16_f32 v220, v220, v221
    v_mfma_f32_16x16x32_bf16 v[224:227], a[248:251], v[192:195], 0
    ds_read_b128 a[232:235], v240 offset:1536
    v_cvt_pk_bf16_f32 v221, v222, v223
    v_mfma_f32_16x16x32_bf16 v[232:235], a[244:247], a[76:79], v[232:235]
    ds_write_b64 v247, v[220:221] offset:18688
    v_mfma_f32_16x16x32_bf16 v[220:223], v[78:81], v[192:195], 0
    ds_read_b128 a[236:239], v241 offset:1536
    v_cvt_pk_bf16_f32 v130, v228, v229
    v_mfma_f32_16x16x32_bf16 v[232:235], a[216:219], a[80:83], v[232:235]
    s_waitcnt lgkmcnt(5)
    v_exp_f32 v208, v208
    v_mfma_f32_16x16x32_bf16 v[204:207], v[150:153], v[168:171], v[204:207]
    v_exp_f32 v209, v209
    v_mfma_f32_16x16x32_bf16 v[204:207], v[152:155], v[170:173], v[204:207]
    v_exp_f32 v210, v210
    v_mfma_f32_16x16x32_bf16 v[232:235], a[220:223], a[84:87], v[232:235]
    v_exp_f32 v211, v211
    v_mfma_f32_16x16x32_bf16 v[232:235], a[224:227], a[88:91], v[232:235]
    v_cvt_pk_bf16_f32 v183, v208, v209
    v_cvt_pk_bf16_f32 v186, v210, v211
    v_mfma_f32_16x16x32_bf16 v[232:235], a[228:231], a[92:95], v[232:235]
    ds_read_b128 v[208:211], v245 offset:192
    v_cvt_pk_bf16_f32 v131, v230, v231
    v_mfma_f32_16x16x32_bf16 v[236:239], a[240:243], a[96:99], 0
    v_exp_f32 v200, v200
    v_mfma_f32_16x16x32_bf16 v[236:239], a[244:247], a[100:103], v[236:239]
    v_exp_f32 v201, v201
    v_mfma_f32_16x16x32_bf16 v[236:239], a[216:219], a[104:107], v[236:239]
    ds_read_b64 v[174:175], v247 offset:30720
    v_cvt_pk_bf16_f32 v1, v232, v233
    v_mfma_f32_16x16x32_bf16 v[236:239], a[220:223], a[108:111], v[236:239]
    v_cvt_pk_bf16_f32 v4, v234, v235
    v_cvt_pk_bf16_f32 v182, v200, v201
    v_mfma_f32_16x16x32_bf16 v[236:239], a[224:227], a[112:115], v[236:239]
    s_waitcnt lgkmcnt(4)
    v_exp_f32 v196, v196
    v_mfma_f32_16x16x32_bf16 v[212:215], v[22:25], v[180:183], v[212:215]
    v_exp_f32 v197, v197
    v_mfma_f32_16x16x32_bf16 v[216:219], v[52:55], v[180:183], v[216:219]
    v_exp_f32 v198, v198
    v_mfma_f32_16x16x32_bf16 v[220:223], v[82:85], v[180:183], v[220:223]
    v_exp_f32 v199, v199
    v_mfma_f32_16x16x32_bf16 v[224:227], a[248:251], v[180:183], v[224:227]
    v_exp_f32 v202, v202
    v_mfma_f32_16x16x32_bf16 v[236:239], a[228:231], a[116:119], v[236:239]
    s_waitcnt vmcnt(3)
    ds_read_b64_tr_b16 a[144:145], v249 offset:0
    v_mfma_f32_16x16x32_bf16 v[228:231], a[240:243], a[120:123], 0
    ds_read_b128 a[240:243], v240 offset:1664
    ds_read_b64_tr_b16 a[146:147], v250 offset:0
    v_mfma_f32_16x16x32_bf16 v[228:231], a[244:247], a[124:127], v[228:231]
    ds_read_b128 a[244:247], v241 offset:1664
    ds_read_b64_tr_b16 a[168:169], v249 offset:32
    v_mfma_f32_16x16x32_bf16 v[228:231], a[216:219], a[128:131], v[228:231]
    ds_read_b128 a[216:219], v240 offset:1792
    ds_read_b64_tr_b16 a[170:171], v250 offset:32
    v_mfma_f32_16x16x32_bf16 v[228:231], a[220:223], a[132:135], v[228:231]
    ds_read_b128 a[220:223], v241 offset:1792
    ds_read_b64_tr_b16 a[192:193], v249 offset:64
    v_mfma_f32_16x16x32_bf16 v[228:231], a[224:227], a[136:139], v[228:231]
    ds_read_b64_tr_b16 a[194:195], v250 offset:64
    s_waitcnt lgkmcnt(11)
    v_mfma_f32_16x16x32_bf16 v[208:211], v[90:93], v[168:171], v[208:211]
    v_cvt_pk_bf16_f32 v31, v236, v237
    v_cvt_pk_bf16_f32 v34, v238, v239
    v_mfma_f32_16x16x32_bf16 v[208:211], v[92:95], v[170:173], v[208:211]
    v_exp_f32 v203, v203
    v_mfma_f32_16x16x32_bf16 v[228:231], a[228:231], a[140:143], v[228:231]
    v_cvt_pk_bf16_f32 v184, v196, v197
    v_cvt_pk_bf16_f32 v187, v198, v199
    v_mfma_f32_16x16x32_bf16 v[232:235], a[0:3], a[232:235], 0
    ds_read_b128 v[196:199], v246 offset:192
    v_cvt_pk_bf16_f32 v185, v202, v203
    v_mfma_f32_16x16x32_bf16 v[232:235], a[4:7], a[236:239], v[232:235]
    s_waitcnt lgkmcnt(9)
    v_exp_f32 v204, v204
    v_mfma_f32_16x16x32_bf16 v[212:215], v[26:29], v[184:187], v[212:215]
    v_cvt_pk_bf16_f32 v61, v228, v229
    v_cvt_pk_bf16_f32 v64, v230, v231
    v_mfma_f32_16x16x32_bf16 v[216:219], v[56:59], v[184:187], v[216:219]
    ds_read_b128 v[200:203], v244 offset:256
    ds_read_b128 a[224:227], v240 offset:3072
    v_mfma_f32_16x16x32_bf16 v[220:223], v[86:89], v[184:187], v[220:223]
    s_waitcnt vmcnt(0)
    ds_read_b64_tr_b16 a[148:149], v249 offset:3072
    v_mfma_f32_16x16x32_bf16 v[224:227], a[248:251], v[184:187], v[224:227]
    ds_read_b64_tr_b16 a[150:151], v250 offset:3072
    ds_read_b64_tr_b16 a[172:173], v249 offset:3104
    v_mfma_f32_16x16x32_bf16 v[232:235], a[8:11], a[240:243], v[232:235]
    s_waitcnt lgkmcnt(6)
    buffer_load_dwordx4 v252, s[12:15], s60 offen lds
    v_mfma_f32_16x16x32_bf16 v[232:235], a[12:15], a[244:247], v[232:235]
    ds_read_b64_tr_b16 a[174:175], v250 offset:3104
    ds_read_b64_tr_b16 a[196:197], v249 offset:3136
    v_mfma_f32_16x16x32_bf16 v[232:235], a[16:19], a[216:219], v[232:235]
    ds_read_b64_tr_b16 a[198:199], v250 offset:3136
    v_mov_b32 v226, 0x22e00
    v_mfma_f32_16x16x32_bf16 v[232:235], a[20:23], a[220:223], v[232:235]
    v_exp_f32 v205, v205
    v_mfma_f32_16x16x32_bf16 v[236:239], a[24:27], a[232:235], 0
    buffer_load_dwordx4 v253, s[12:15], s60 offen offset:1024 lds
    v_cvt_pk_bf16_f32 v190, v204, v205
    v_mfma_f32_16x16x32_bf16 v[236:239], a[28:31], a[236:239], v[236:239]
    v_exp_f32 v206, v206
    v_mfma_f32_16x16x32_bf16 v[236:239], a[32:35], a[240:243], v[236:239]
    v_exp_f32 v207, v207
    v_mfma_f32_16x16x32_bf16 v[236:239], a[36:39], a[244:247], v[236:239]
    s_waitcnt lgkmcnt(8)
    v_cvt_pk_bf16_f32 v132, v232, v233
    v_cvt_pk_bf16_f32 v133, v234, v235
    v_mfma_f32_16x16x32_bf16 v[196:199], v[126:129], v[168:171], v[196:199]
    buffer_load_dwordx4 v251, s[12:15], s60 offen offset:2048 lds
    s_add_u32 m0, s46, 0x17400
    v_mfma_f32_16x16x32_bf16 v[196:199], v[128:131], v[170:173], v[196:199]
    ds_read_b128 a[228:231], v241 offset:3072
    v_cvt_pk_bf16_f32 v193, v206, v207
    v_mfma_f32_16x16x32_bf16 v[236:239], a[40:43], a[216:219], v[236:239]
    ds_read_b128 v[204:207], v245 offset:256
    s_waitcnt lgkmcnt(2)
    v_mfma_f32_16x16x32_bf16 v[200:203], v[156:159], v[168:171], v[200:203]
    v_exp_f32 v208, v208
    v_mfma_f32_16x16x32_bf16 v[200:203], v[158:161], v[170:173], v[200:203]
    buffer_load_dwordx4 v252, s[12:15], s61 offen lds
    v_cndmask_b32 v226, v226, v247, vcc
    v_mfma_f32_16x16x32_bf16 v[236:239], a[44:47], a[220:223], v[236:239]
    s_mov_b32 vcc_lo, 0xff00fff0
    v_exp_f32 v209, v209
    v_mfma_f32_16x16x32_bf16 v[228:231], a[48:51], a[232:235], 0
    s_mov_b32 vcc_hi, 0xf000
    v_exp_f32 v210, v210
    v_mfma_f32_16x16x32_bf16 v[228:231], a[52:55], a[236:239], v[228:231]
    v_exp_f32 v211, v211
    v_mfma_f32_16x16x32_bf16 v[228:231], a[56:59], a[240:243], v[228:231]
    buffer_load_dwordx4 v253, s[12:15], s61 offen offset:1024 lds
    v_cvt_pk_bf16_f32 v134, v236, v237
    v_mfma_f32_16x16x32_bf16 v[228:231], a[60:63], a[244:247], v[228:231]
    v_cvt_pk_bf16_f32 v135, v238, v239
    v_cvt_pk_bf16_f32 v188, v208, v209
    v_mfma_f32_16x16x32_bf16 v[228:231], a[64:67], a[216:219], v[228:231]
    ds_read_b64 v[176:177], v247 offset:30848
    v_cvt_pk_bf16_f32 v191, v210, v211
    v_mfma_f32_16x16x32_bf16 v[228:231], a[68:71], a[220:223], v[228:231]
    ds_read_b128 v[208:211], v246 offset:256
    v_mov_b32 v187, 0
    v_mfma_f32_16x16x32_bf16 v[232:235], a[232:235], a[72:75], 0
    buffer_load_dwordx4 v251, s[12:15], s61 offen offset:2048 lds
    s_add_u32 m0, s46, 0x16800
    v_mfma_f32_16x16x32_bf16 v[232:235], a[236:239], a[76:79], v[232:235]
    v_rcp_f32 v225, v224
    v_mfma_f32_16x16x32_bf16 v[232:235], a[240:243], a[80:83], v[232:235]
    v_cvt_pk_bf16_f32 v136, v228, v229
    v_cvt_pk_bf16_f32 v137, v230, v231
    v_mfma_f32_16x16x32_bf16 v[232:235], a[244:247], a[84:87], v[232:235]
    v_exp_f32 v196, v196
    v_mfma_f32_16x16x32_bf16 v[232:235], a[216:219], a[88:91], v[232:235]
    s_waitcnt lgkmcnt(2)
    v_exp_f32 v197, v197
    v_mfma_f32_16x16x32_bf16 v[204:207], v[96:99], v[168:171], v[204:207]
    v_mul_f32 v212, v212, v225
    v_mul_f32 v213, v213, v225
    v_mfma_f32_16x16x32_bf16 v[204:207], v[98:101], v[170:173], v[204:207]
    v_cvt_pk_bf16_f32 v189, v196, v197
    v_mul_f32 v214, v214, v225
    v_mfma_f32_16x16x32_bf16 v[232:235], a[220:223], a[92:95], v[232:235]
    v_mul_f32 v215, v215, v225
    v_cvt_pk_bf16_f32 v212, v212, v213
    v_mfma_f32_16x16x32_bf16 v[236:239], a[232:235], a[96:99], 0
    v_cvt_pk_bf16_f32 v213, v214, v215
    v_mul_f32 v216, v216, v225
    v_mfma_f32_16x16x32_bf16 v[236:239], a[236:239], a[100:103], v[236:239]
    ds_write_b64 v226, v[212:213] offset:0
    v_mfma_f32_16x16x32_bf16 v[212:215], v[0:3], v[188:191], 0
    v_cvt_pk_bf16_f32 v7, v232, v233
    v_cvt_pk_bf16_f32 v10, v234, v235
    v_mfma_f32_16x16x32_bf16 v[236:239], a[240:243], a[104:107], v[236:239]
    v_exp_f32 v198, v198
    v_mfma_f32_16x16x32_bf16 v[236:239], a[244:247], a[108:111], v[236:239]
    s_waitcnt lgkmcnt(1)
    v_exp_f32 v199, v199
    v_mfma_f32_16x16x32_bf16 v[208:211], v[132:135], v[168:171], v[208:211]
    v_cvt_pk_bf16_f32 v192, v198, v199
    v_mul_f32 v217, v217, v225
    v_mfma_f32_16x16x32_bf16 v[208:211], v[134:137], v[170:173], v[208:211]
    ds_read_b128 v[196:199], v244 offset:320
    v_mul_f32 v218, v218, v225
    v_mfma_f32_16x16x32_bf16 v[236:239], a[216:219], a[112:115], v[236:239]
    v_mul_f32 v219, v219, v225
    v_cvt_pk_bf16_f32 v216, v216, v217
    v_mfma_f32_16x16x32_bf16 v[236:239], a[220:223], a[116:119], v[236:239]
    v_cvt_pk_bf16_f32 v217, v218, v219
    v_mul_f32 v220, v220, v225
    v_mfma_f32_16x16x32_bf16 v[228:231], a[232:235], a[120:123], 0
    ds_read_b128 a[232:235], v240 offset:3200
    v_mul_f32 v221, v221, v225
    v_mfma_f32_16x16x32_bf16 v[228:231], a[236:239], a[124:127], v[228:231]
    ds_read_b128 a[236:239], v241 offset:3200
    v_mul_f32 v222, v222, v225
    v_mfma_f32_16x16x32_bf16 v[228:231], a[240:243], a[128:131], v[228:231]
    ds_read_b128 a[240:243], v240 offset:3328
    v_mul_f32 v223, v223, v225
    v_mfma_f32_16x16x32_bf16 v[228:231], a[244:247], a[132:135], v[228:231]
    ds_read_b128 a[244:247], v241 offset:3328
    v_cvt_pk_bf16_f32 v220, v220, v221
    v_mfma_f32_16x16x32_bf16 v[228:231], a[216:219], a[136:139], v[228:231]
    ds_write_b64 v226, v[216:217] offset:128
    v_mfma_f32_16x16x32_bf16 v[216:219], v[30:33], v[188:191], 0
    v_cvt_pk_bf16_f32 v221, v222, v223
    v_max3_f32 v248, v248, v224, v225
    v_mfma_f32_16x16x32_bf16 v[228:231], a[220:223], a[140:143], v[228:231]
    ds_write_b64 v226, v[220:221] offset:256
    v_mfma_f32_16x16x32_bf16 v[220:223], v[60:63], v[188:191], 0
    v_cvt_pk_bf16_f32 v37, v236, v237
    v_cvt_pk_bf16_f32 v40, v238, v239
    v_mfma_f32_16x16x32_bf16 v[224:227], a[248:251], v[188:191], 0
    v_exp_f32 v200, v200
    v_mfma_f32_16x16x32_bf16 v[232:235], a[0:3], a[224:227], 0
    v_exp_f32 v201, v201
    v_mfma_f32_16x16x32_bf16 v[232:235], a[4:7], a[228:231], v[232:235]
    s_waitcnt lgkmcnt(5)
    v_cvt_pk_bf16_f32 v67, v228, v229
    v_cvt_pk_bf16_f32 v70, v230, v231
    v_mfma_f32_16x16x32_bf16 v[196:199], v[162:165], v[168:171], v[196:199]
    v_exp_f32 v202, v202
    v_mfma_f32_16x16x32_bf16 v[196:199], v[164:167], v[170:173], v[196:199]
    v_exp_f32 v203, v203
    v_mfma_f32_16x16x32_bf16 v[232:235], a[8:11], a[232:235], v[232:235]
    s_waitcnt lgkmcnt(4)
    v_cvt_pk_bf16_f32 v180, v200, v201
    v_cvt_pk_bf16_f32 v183, v202, v203
    v_mfma_f32_16x16x32_bf16 v[232:235], a[12:15], a[236:239], v[232:235]
    s_waitcnt lgkmcnt(3)
    v_exp_f32 v204, v204
    v_mfma_f32_16x16x32_bf16 v[232:235], a[16:19], a[240:243], v[232:235]
    s_waitcnt lgkmcnt(2)
    v_exp_f32 v205, v205
    v_mfma_f32_16x16x32_bf16 v[232:235], a[20:23], a[244:247], v[232:235]
    ds_read_b128 v[200:203], v245 offset:320
    v_cvt_pk_bf16_f32 v194, v204, v205
    v_mfma_f32_16x16x32_bf16 v[236:239], a[24:27], a[224:227], 0
    v_exp_f32 v208, v208
    v_mfma_f32_16x16x32_bf16 v[236:239], a[28:31], a[228:231], v[236:239]
    v_exp_f32 v209, v209
    v_mfma_f32_16x16x32_bf16 v[236:239], a[32:35], a[232:235], v[236:239]
    ds_read_b128 a[216:219], v240 offset:4608
    v_cvt_pk_bf16_f32 v144, v232, v233
    v_mfma_f32_16x16x32_bf16 v[236:239], a[36:39], a[236:239], v[236:239]
    v_cvt_pk_bf16_f32 v145, v234, v235
    v_cvt_pk_bf16_f32 v195, v208, v209
    v_mfma_f32_16x16x32_bf16 v[236:239], a[40:43], a[240:243], v[236:239]
    v_exp_f32 v206, v206
    v_mfma_f32_16x16x32_bf16 v[212:215], v[4:7], v[192:195], v[212:215]
    s_waitcnt vmcnt(3)
    ds_read_b64_tr_b16 a[152:153], v249 offset:0
    v_mfma_f32_16x16x32_bf16 v[216:219], v[34:37], v[192:195], v[216:219]
    ds_read_b64_tr_b16 a[154:155], v250 offset:0
    ds_read_b64_tr_b16 a[176:177], v249 offset:32
    v_mfma_f32_16x16x32_bf16 v[220:223], v[64:67], v[192:195], v[220:223]
    ds_read_b64_tr_b16 a[178:179], v250 offset:32
    ds_read_b64_tr_b16 a[200:201], v249 offset:64
    v_mfma_f32_16x16x32_bf16 v[224:227], a[248:251], v[192:195], v[224:227]
    ds_read_b64_tr_b16 a[202:203], v250 offset:64
    ds_read_b128 a[220:223], v241 offset:4608
    v_mfma_f32_16x16x32_bf16 v[236:239], a[44:47], a[244:247], v[236:239]
    v_exp_f32 v207, v207
    v_mfma_f32_16x16x32_bf16 v[228:231], a[48:51], a[224:227], 0
    v_exp_f32 v210, v210
    v_mfma_f32_16x16x32_bf16 v[228:231], a[52:55], a[228:231], v[228:231]
    v_exp_f32 v211, v211
    v_mfma_f32_16x16x32_bf16 v[228:231], a[56:59], a[232:235], v[228:231]
    s_waitcnt lgkmcnt(8)
    v_cvt_pk_bf16_f32 v181, v206, v207
    v_cvt_pk_bf16_f32 v146, v236, v237
    v_mfma_f32_16x16x32_bf16 v[200:203], v[138:141], v[168:171], v[200:203]
    v_cvt_pk_bf16_f32 v147, v238, v239
    v_cvt_pk_bf16_f32 v182, v210, v211
    v_mfma_f32_16x16x32_bf16 v[200:203], v[140:143], v[170:173], v[200:203]
    ds_read_b128 v[204:207], v246 offset:320
    ds_read_b128 v[208:211], v244 offset:0
    v_mfma_f32_16x16x32_bf16 v[212:215], v[8:11], v[180:183], v[212:215]
    ds_read_b64 v[178:179], v247 offset:30976
    v_mfma_f32_16x16x32_bf16 v[216:219], v[38:41], v[180:183], v[216:219]
    s_waitcnt lgkmcnt(4)
    buffer_load_dwordx4 v252, s[12:15], s62 offen lds
    v_mfma_f32_16x16x32_bf16 v[220:223], v[68:71], v[180:183], v[220:223]
    v_exp_f32 v196, v196
    v_mfma_f32_16x16x32_bf16 v[224:227], a[248:251], v[180:183], v[224:227]
    s_waitcnt vmcnt(1)
    ds_read_b64_tr_b16 a[156:157], v249 offset:3072
    v_mfma_f32_16x16x32_bf16 v[228:231], a[60:63], a[236:239], v[228:231]
    ds_read_b64_tr_b16 a[158:159], v250 offset:3072
    ds_read_b64_tr_b16 a[180:181], v249 offset:3104
    v_mfma_f32_16x16x32_bf16 v[228:231], a[64:67], a[240:243], v[228:231]
    ds_read_b64_tr_b16 a[182:183], v250 offset:3104
    ds_read_b64_tr_b16 a[204:205], v249 offset:3136
    v_mfma_f32_16x16x32_bf16 v[228:231], a[68:71], a[244:247], v[228:231]
    ds_read_b64_tr_b16 a[206:207], v250 offset:3136
    buffer_load_dwordx4 v253, s[12:15], s62 offen offset:1024 lds
    v_mfma_f32_16x16x32_bf16 v[232:235], a[224:227], a[72:75], 0
    v_exp_f32 v197, v197
    v_mfma_f32_16x16x32_bf16 v[232:235], a[228:231], a[76:79], v[232:235]
    v_exp_f32 v200, v200
    v_mfma_f32_16x16x32_bf16 v[232:235], a[232:235], a[80:83], v[232:235]
    v_exp_f32 v201, v201
    v_mfma_f32_16x16x32_bf16 v[232:235], a[236:239], a[84:87], v[232:235]
    buffer_load_dwordx4 v251, s[12:15], s62 offen offset:2048 lds
    v_cvt_pk_bf16_f32 v148, v228, v229
    v_mfma_f32_16x16x32_bf16 v[232:235], a[240:243], a[88:91], v[232:235]
    s_add_u32 m0, s46, 0x17400
    v_cvt_pk_bf16_f32 v149, v230, v231
    v_cvt_pk_bf16_f32 v186, v196, v197
    v_mfma_f32_16x16x32_bf16 v[232:235], a[244:247], a[92:95], v[232:235]
    ds_read_b128 v[196:199], v245 offset:0
    v_cvt_pk_bf16_f32 v184, v200, v201
    v_mfma_f32_16x16x32_bf16 v[236:239], a[224:227], a[96:99], 0
    s_waitcnt lgkmcnt(8)
    ds_read_b128 v[200:203], v246 offset:0
    v_mfma_f32_16x16x32_bf16 v[204:207], v[144:147], v[168:171], v[204:207]
    ds_read_b64 v[168:169], v247 offset:36864
    s_waitcnt lgkmcnt(3)
    v_mfma_f32_16x16x32_bf16 v[204:207], v[146:149], v[170:173], v[204:207]
    buffer_load_dwordx4 v252, s[12:15], s63 offen lds
    v_cvt_pk_bf16_f32 v13, v232, v233
    v_mfma_f32_16x16x32_bf16 v[208:211], v[156:159], v[174:177], v[208:211]
    ds_read_b64 v[170:171], v247 offset:36992
    v_cvt_pk_bf16_f32 v16, v234, v235
    v_mfma_f32_16x16x32_bf16 v[208:211], v[158:161], v[176:179], v[208:211]
    ds_read_b64 v[172:173], v247 offset:37120
    v_mfma_f32_16x16x32_bf16 v[236:239], a[228:231], a[100:103], v[236:239]
    v_exp_f32 v204, v204
    v_mfma_f32_16x16x32_bf16 v[236:239], a[232:235], a[104:107], v[236:239]
    buffer_load_dwordx4 v253, s[12:15], s63 offen offset:1024 lds
    v_mfma_f32_16x16x32_bf16 v[236:239], a[236:239], a[108:111], v[236:239]
    v_exp_f32 v205, v205
    v_mfma_f32_16x16x32_bf16 v[236:239], a[240:243], a[112:115], v[236:239]
    v_exp_f32 v208, v208
    v_mfma_f32_16x16x32_bf16 v[236:239], a[244:247], a[116:119], v[236:239]
    v_exp_f32 v209, v209
    v_mfma_f32_16x16x32_bf16 v[228:231], a[224:227], a[120:123], 0
    ds_read_b128 a[224:227], v240 offset:4736
    buffer_load_dwordx4 v251, s[12:15], s63 offen offset:2048 lds
    v_mfma_f32_16x16x32_bf16 v[228:231], a[228:231], a[124:127], v[228:231]
    ds_read_b128 a[228:231], v241 offset:4736
    v_cvt_pk_bf16_f32 v185, v204, v205
    v_mfma_f32_16x16x32_bf16 v[228:231], a[232:235], a[128:131], v[228:231]
    ds_read_b128 a[232:235], v240 offset:4864
    s_waitcnt lgkmcnt(7)
    v_mfma_f32_16x16x32_bf16 v[212:215], v[12:15], v[184:187], v[212:215]
    ds_read_b128 v[204:207], v244 offset:64
    v_cvt_pk_bf16_f32 v43, v236, v237
    v_mfma_f32_16x16x32_bf16 v[224:227], a[248:251], v[184:187], v[224:227]
    s_waitcnt lgkmcnt(7)
    v_cvt_pk_bf16_f32 v46, v238, v239
    v_cvt_pk_bf16_f32 v190, v208, v209
    v_mfma_f32_16x16x32_bf16 v[216:219], v[42:45], v[184:187], v[216:219]
    v_exp_f32 v210, v210
    v_mfma_f32_16x16x32_bf16 v[196:199], v[96:99], v[174:177], v[196:199]
    v_exp_f32 v211, v211
    v_mfma_f32_16x16x32_bf16 v[196:199], v[98:101], v[176:179], v[196:199]
    v_rcp_f32 v225, v224
    v_mfma_f32_16x16x32_bf16 v[200:203], v[132:135], v[174:177], v[200:203]
    v_cvt_pk_bf16_f32 v193, v210, v211
    v_mul_f32 v212, v212, v225
    v_mfma_f32_16x16x32_bf16 v[200:203], v[134:137], v[176:179], v[200:203]
    ds_read_b128 v[208:211], v245 offset:64
    v_mul_f32 v213, v213, v225
    v_mfma_f32_16x16x32_bf16 v[228:231], a[236:239], a[132:135], v[228:231]
    ds_read_b128 a[236:239], v241 offset:4864
    v_mul_f32 v214, v214, v225
    v_mfma_f32_16x16x32_bf16 v[228:231], a[240:243], a[136:139], v[228:231]
    v_exp_f32 v196, v196
    v_mfma_f32_16x16x32_bf16 v[228:231], a[244:247], a[140:143], v[228:231]
    v_exp_f32 v197, v197
    v_mfma_f32_16x16x32_bf16 v[232:235], a[0:3], a[216:219], 0
    v_exp_f32 v198, v198
    v_mfma_f32_16x16x32_bf16 v[232:235], a[4:7], a[220:223], v[232:235]
    s_waitcnt lgkmcnt(5)
    v_exp_f32 v199, v199
    v_mfma_f32_16x16x32_bf16 v[232:235], a[8:11], a[224:227], v[232:235]
    s_waitcnt lgkmcnt(4)
    v_cvt_pk_bf16_f32 v73, v228, v229
    v_cvt_pk_bf16_f32 v76, v230, v231
    v_mfma_f32_16x16x32_bf16 v[232:235], a[12:15], a[228:231], v[232:235]
    s_waitcnt lgkmcnt(3)
    v_cvt_pk_bf16_f32 v188, v196, v197
    v_cvt_pk_bf16_f32 v191, v198, v199
    v_mfma_f32_16x16x32_bf16 v[220:223], v[72:75], v[184:187], v[220:223]
    s_waitcnt lgkmcnt(2)
    v_exp_f32 v200, v200
    v_mfma_f32_16x16x32_bf16 v[204:207], v[162:165], v[174:177], v[204:207]
    ds_read_b128 v[196:199], v246 offset:64
    v_mul_f32 v215, v215, v225
    v_mfma_f32_16x16x32_bf16 v[204:207], v[164:167], v[176:179], v[204:207]
    v_exp_f32 v201, v201
    v_mfma_f32_16x16x32_bf16 v[232:235], a[16:19], a[232:235], v[232:235]
    s_waitcnt lgkmcnt(1)
    v_cvt_pk_bf16_f32 v189, v200, v201
    v_cvt_pk_bf16_f32 v212, v212, v213
    v_mfma_f32_16x16x32_bf16 v[208:211], v[138:141], v[174:177], v[208:211]
    v_cvt_pk_bf16_f32 v213, v214, v215
    v_mul_f32 v216, v216, v225
    v_mfma_f32_16x16x32_bf16 v[208:211], v[140:143], v[176:179], v[208:211]
    ds_write_b64 v247, v[212:213] offset:24576
    v_mfma_f32_16x16x32_bf16 v[212:215], v[6:9], v[188:191], 0
    v_mul_f32 v217, v217, v225
    v_mul_f32 v218, v218, v225
    v_mfma_f32_16x16x32_bf16 v[232:235], a[20:23], a[236:239], v[232:235]
    v_mul_f32 v219, v219, v225
    v_cvt_pk_bf16_f32 v216, v216, v217
    v_mfma_f32_16x16x32_bf16 v[236:239], a[24:27], a[216:219], 0
    v_cvt_pk_bf16_f32 v217, v218, v219
    v_max3_f32 v248, v248, v224, v225
    v_mfma_f32_16x16x32_bf16 v[236:239], a[28:31], a[220:223], v[236:239]
    ds_write_b64 v247, v[216:217] offset:24704
    v_mfma_f32_16x16x32_bf16 v[216:219], v[36:39], v[188:191], 0
    v_cvt_pk_bf16_f32 v150, v232, v233
    v_cvt_pk_bf16_f32 v151, v234, v235
    v_mfma_f32_16x16x32_bf16 v[236:239], a[32:35], a[224:227], v[236:239]
    v_mul_f32 v220, v220, v225
    v_mul_f32 v221, v221, v225
    v_mfma_f32_16x16x32_bf16 v[236:239], a[36:39], a[228:231], v[236:239]
    v_mul_f32 v222, v222, v225
    v_mul_f32 v223, v223, v225
    v_mfma_f32_16x16x32_bf16 v[224:227], a[248:251], v[188:191], 0
    v_exp_f32 v202, v202
    v_mfma_f32_16x16x32_bf16 v[236:239], a[40:43], a[232:235], v[236:239]
    s_waitcnt lgkmcnt(2)
    v_exp_f32 v203, v203
    v_mfma_f32_16x16x32_bf16 v[196:199], v[144:147], v[174:177], v[196:199]
    v_cvt_pk_bf16_f32 v220, v220, v221
    v_cvt_pk_bf16_f32 v192, v202, v203
    v_mfma_f32_16x16x32_bf16 v[196:199], v[146:149], v[176:179], v[196:199]
    ds_read_b128 v[200:203], v244 offset:128
    v_cvt_pk_bf16_f32 v221, v222, v223
    v_mfma_f32_16x16x32_bf16 v[236:239], a[44:47], a[236:239], v[236:239]
    ds_write_b64 v247, v[220:221] offset:24832
    v_mfma_f32_16x16x32_bf16 v[220:223], v[66:69], v[188:191], 0
L_h7:
    s_cbranch_execz L_hback
    v_exp_f32 v204, v204
    v_mfma_f32_16x16x32_bf16 v[228:231], a[48:51], a[216:219], 0
    v_exp_f32 v205, v205
    v_mfma_f32_16x16x32_bf16 v[228:231], a[52:55], a[220:223], v[228:231]
    v_exp_f32 v206, v206
    v_mfma_f32_16x16x32_bf16 v[228:231], a[56:59], a[224:227], v[228:231]
    v_cvt_pk_bf16_f32 v152, v236, v237
    v_cvt_pk_bf16_f32 v153, v238, v239
    v_mfma_f32_16x16x32_bf16 v[228:231], a[60:63], a[228:231], v[228:231]
    v_exp_f32 v207, v207
    v_mfma_f32_16x16x32_bf16 v[228:231], a[64:67], a[232:235], v[228:231]
    v_cvt_pk_bf16_f32 v180, v204, v205
    v_cvt_pk_bf16_f32 v183, v206, v207
    v_mfma_f32_16x16x32_bf16 v[228:231], a[68:71], a[236:239], v[228:231]
    ds_read_b128 v[204:207], v245 offset:128
    v_mfma_f32_16x16x32_bf16 v[232:235], a[216:219], a[72:75], 0
    v_exp_f32 v208, v208
    v_mfma_f32_16x16x32_bf16 v[232:235], a[220:223], a[76:79], v[232:235]
    v_exp_f32 v209, v209
    v_mfma_f32_16x16x32_bf16 v[232:235], a[224:227], a[80:83], v[232:235]
    v_exp_f32 v210, v210
    v_mfma_f32_16x16x32_bf16 v[232:235], a[228:231], a[84:87], v[232:235]
    v_cvt_pk_bf16_f32 v154, v228, v229
    v_cvt_pk_bf16_f32 v155, v230, v231
    v_mfma_f32_16x16x32_bf16 v[232:235], a[232:235], a[88:91], v[232:235]
    s_waitcnt lgkmcnt(2)
    v_exp_f32 v211, v211
    v_mfma_f32_16x16x32_bf16 v[200:203], v[102:105], v[174:177], v[200:203]
    v_cvt_pk_bf16_f32 v194, v208, v209
    v_cvt_pk_bf16_f32 v181, v210, v211
    v_mfma_f32_16x16x32_bf16 v[200:203], v[104:107], v[176:179], v[200:203]
    v_exp_f32 v196, v196
    v_mfma_f32_16x16x32_bf16 v[232:235], a[236:239], a[92:95], v[232:235]
    v_exp_f32 v197, v197
    v_mfma_f32_16x16x32_bf16 v[236:239], a[216:219], a[96:99], 0
    ds_read_b128 v[208:211], v246 offset:128
    v_cvt_pk_bf16_f32 v195, v196, v197
    v_mfma_f32_16x16x32_bf16 v[236:239], a[220:223], a[100:103], v[236:239]
    v_exp_f32 v198, v198
    v_mfma_f32_16x16x32_bf16 v[212:215], v[10:13], v[192:195], v[212:215]
    v_exp_f32 v199, v199
    v_mfma_f32_16x16x32_bf16 v[216:219], v[40:43], v[192:195], v[216:219]
    v_cvt_pk_bf16_f32 v19, v232, v233
    v_mbcnt_lo_u32_b32 v232, -1, 0
    v_mfma_f32_16x16x32_bf16 v[220:223], v[70:73], v[192:195], v[220:223]
    s_waitcnt vmcnt(3)
    v_mbcnt_hi_u32_b32 v232, -1, v232
    v_cvt_pk_bf16_f32 v22, v234, v235
    v_mfma_f32_16x16x32_bf16 v[224:227], a[248:251], v[192:195], v[224:227]
    ds_read_b64_tr_b16 a[160:161], v249 offset:0
    v_and_b32 v233, 15, v232
    v_mfma_f32_16x16x32_bf16 v[236:239], a[224:227], a[104:107], v[236:239]
    s_waitcnt vmcnt(0) lgkmcnt(2)
    v_lshrrev_b32 v232, 4, v232
    v_lshrrev_b32 v234, 1, v233
    v_mfma_f32_16x16x32_bf16 v[204:207], v[114:117], v[174:177], v[204:207]
    v_mul_u32_u24 v235, 0x180, v233
    v_xor_b32 v243, v232, v234
    v_mfma_f32_16x16x32_bf16 v[204:207], v[116:119], v[176:179], v[204:207]
    ds_read_b64_tr_b16 a[162:163], v250 offset:0
    v_lshl_add_u32 v242, v243, 4, v235
    v_mfma_f32_16x16x32_bf16 v[236:239], a[228:231], a[108:111], v[236:239]
    ds_read_b64_tr_b16 a[164:165], v249 offset:3072
    v_xor_b32 v243, 64, v242
    v_mfma_f32_16x16x32_bf16 v[236:239], a[232:235], a[112:115], v[236:239]
    v_add_u32 v242, 0x1e000, v242
    v_add_u32 v243, 0x1e000, v243
    v_mfma_f32_16x16x32_bf16 v[236:239], a[236:239], a[116:119], v[236:239]
    ds_read_b128 a[240:243], v242 offset:0
    ds_read_b128 a[244:247], v243 offset:0
    v_mfma_f32_16x16x32_bf16 v[228:231], a[216:219], a[120:123], 0
    ds_read_b128 a[216:219], v242 offset:128
    ds_read_b64_tr_b16 a[166:167], v250 offset:3072
    v_mfma_f32_16x16x32_bf16 v[228:231], a[220:223], a[124:127], v[228:231]
    ds_read_b128 a[220:223], v243 offset:128
    ds_read_b64_tr_b16 a[184:185], v249 offset:32
    v_mfma_f32_16x16x32_bf16 v[228:231], a[224:227], a[128:131], v[228:231]
    ds_read_b128 a[224:227], v242 offset:256
    v_cvt_pk_bf16_f32 v49, v236, v237
    v_mfma_f32_16x16x32_bf16 v[228:231], a[228:231], a[132:135], v[228:231]
    ds_read_b128 a[228:231], v243 offset:256
    v_cvt_pk_bf16_f32 v52, v238, v239
    v_mfma_f32_16x16x32_bf16 v[228:231], a[232:235], a[136:139], v[228:231]
    ds_read_b64_tr_b16 a[186:187], v250 offset:32
    ds_read_b64_tr_b16 a[188:189], v249 offset:3104
    v_mfma_f32_16x16x32_bf16 v[228:231], a[236:239], a[140:143], v[228:231]
    s_waitcnt lgkmcnt(13)
    ds_read_b64_tr_b16 a[190:191], v250 offset:3104
    v_mfma_f32_16x16x32_bf16 v[208:211], v[150:153], v[174:177], v[208:211]
    ds_read_b64_tr_b16 a[208:209], v249 offset:64
    ds_read_b64_tr_b16 a[210:211], v250 offset:64
    v_mfma_f32_16x16x32_bf16 v[208:211], v[152:155], v[176:179], v[208:211]
    s_waitcnt lgkmcnt(12)
    ds_read_b64_tr_b16 a[212:213], v249 offset:3136
    v_mfma_f32_16x16x32_bf16 v[236:239], a[144:147], a[240:243], 0
    s_waitcnt lgkmcnt(12)
    v_cvt_pk_bf16_f32 v79, v228, v229
    v_cvt_pk_bf16_f32 v82, v230, v231
    v_mfma_f32_16x16x32_bf16 v[236:239], a[148:151], a[244:247], v[236:239]
    s_waitcnt lgkmcnt(11)
    ds_read_b64_tr_b16 a[214:215], v250 offset:3136
    v_mfma_f32_16x16x32_bf16 v[236:239], a[152:155], a[216:219], v[236:239]
    ds_read_b128 a[232:235], v242 offset:6144
    s_waitcnt lgkmcnt(11)
    v_mfma_f32_16x16x32_bf16 v[236:239], a[156:159], a[220:223], v[236:239]
    v_lshrrev_b32 v249, 1, v232
    v_or_b32 v249, s66, v249
    v_mfma_f32_16x16x32_bf16 v[228:231], a[168:171], a[240:243], 0
    s_waitcnt lgkmcnt(9)
    v_mov_b32 v253, v249
    v_xor_b32 v249, v249, v234
    v_mfma_f32_16x16x32_bf16 v[236:239], a[160:163], a[224:227], v[236:239]
    s_waitcnt lgkmcnt(8)
    v_lshl_add_u32 v249, v249, 4, v235
    v_and_b32 v235, 1, v232
    v_mfma_f32_16x16x32_bf16 v[236:239], a[164:167], a[228:231], v[236:239]
    v_lshl_add_u32 v249, v235, 3, v249
    v_lshlrev_b32 v235, 3, v235
    v_mfma_f32_16x16x32_bf16 v[228:231], a[172:175], a[244:247], v[228:231]
    v_xor_b32 v250, s67, v232
    v_xor_b32 v252, v233, v235
    v_mfma_f32_16x16x32_bf16 v[228:231], a[176:179], a[216:219], v[228:231]
    s_mul_i32 s67, s28, 0x600
    v_xor_b32 v252, v252, v253
    v_mul_u32_u24 v250, 0x300, v250
    v_mfma_f32_16x16x32_bf16 v[228:231], a[180:183], a[220:223], v[228:231]
    s_waitcnt lgkmcnt(7)
    s_add_u32 s67, s67, 0x16800
    v_mul_u32_u24 v232, 0x180, v232
    v_mfma_f32_16x16x32_bf16 v[228:231], a[184:187], a[224:227], v[228:231]
    s_waitcnt lgkmcnt(1)
    v_xor_b32 v253, v253, v234
    v_add_u32 v232, s67, v232
    v_mfma_f32_16x16x32_bf16 v[228:231], a[188:191], a[228:231], v[228:231]
    v_and_b32 v234, 1, v233
    v_lshl_add_u32 v251, v233, 3, v250
    ds_read_b128 a[236:239], v243 offset:6144
    v_lshl_add_u32 v253, v253, 4, v232
    v_xor_b32 v233, v233, v235
    v_lshl_add_u32 v252, v252, 4, v232
    v_lshl_add_u32 v253, v234, 3, v253
    v_lshl_add_u32 v250, v233, 4, v250
    v_mfma_f32_16x16x32_bf16 v[232:235], a[192:195], a[240:243], 0
    ds_read_b128 a[240:243], v242 offset:6272
    s_barrier
    v_mfma_f32_16x16x32_bf16 v[232:235], a[196:199], a[244:247], v[232:235]
    ds_read_b128 a[244:247], v243 offset:6272
    v_cvt_pk_bf16_f32 v236, v236, v237
    v_mfma_f32_16x16x32_bf16 v[232:235], a[200:203], a[216:219], v[232:235]
    ds_read_b128 a[216:219], v242 offset:6400
    v_add_u32 v249, 0x16800, v249
    v_mfma_f32_16x16x32_bf16 v[232:235], a[204:207], a[220:223], v[232:235]
    ds_read_b128 a[220:223], v243 offset:6400
    v_cvt_pk_bf16_f32 v237, v238, v239
    v_mfma_f32_16x16x32_bf16 v[232:235], a[208:211], a[224:227], v[232:235]
    ds_write_b64 v249, v[236:237] offset:0
    v_mfma_f32_16x16x32_bf16 v[232:235], a[212:215], a[228:231], v[232:235]
    s_waitcnt lgkmcnt(6)
    v_cvt_pk_bf16_f32 v228, v228, v229
    v_cvt_pk_bf16_f32 v229, v230, v231
    v_mfma_f32_16x16x32_bf16 v[236:239], a[144:147], a[232:235], 0
    s_waitcnt lgkmcnt(5)
    ds_read_b128 a[224:227], v242 offset:12288
    v_mfma_f32_16x16x32_bf16 v[236:239], a[148:151], a[236:239], v[236:239]
    ds_write_b64 v249, v[228:229] offset:128
    v_mfma_f32_16x16x32_bf16 v[228:231], a[168:171], a[232:235], 0
    s_waitcnt lgkmcnt(6)
    v_cvt_pk_bf16_f32 v232, v232, v233
    v_cvt_pk_bf16_f32 v233, v234, v235
    v_mfma_f32_16x16x32_bf16 v[236:239], a[152:155], a[240:243], v[236:239]
    s_waitcnt lgkmcnt(5)
    ds_read_b128 a[228:231], v243 offset:12288
    v_mfma_f32_16x16x32_bf16 v[236:239], a[156:159], a[244:247], v[236:239]
    s_waitcnt lgkmcnt(5)
    v_exp_f32 v200, v200
    v_mfma_f32_16x16x32_bf16 v[236:239], a[160:163], a[216:219], v[236:239]
    s_waitcnt lgkmcnt(4)
    v_exp_f32 v201, v201
    v_mfma_f32_16x16x32_bf16 v[236:239], a[164:167], a[220:223], v[236:239]
    ds_write_b64 v249, v[232:233] offset:256
    v_mfma_f32_16x16x32_bf16 v[228:231], a[172:175], a[236:239], v[228:231]
    s_lshl2_add_u32 s67, s28, 0x23000
    v_cvt_pk_bf16_f32 v182, v198, v199
    v_cvt_pk_bf16_f32 v186, v200, v201
    v_mfma_f32_16x16x32_bf16 v[228:231], a[176:179], a[240:243], v[228:231]
    ds_read_b128 v[196:199], v244 offset:0
    ds_read_b128 v[200:203], v245 offset:0
    v_mfma_f32_16x16x32_bf16 v[212:215], v[14:17], v[180:183], v[212:215]
    ds_read_b64 v[174:175], v247 offset:43008
    v_cvt_pk_bf16_f32 v236, v236, v237
    v_mfma_f32_16x16x32_bf16 v[216:219], v[44:47], v[180:183], v[216:219]
    ds_read_b64 v[176:177], v247 offset:43136
    v_cvt_pk_bf16_f32 v237, v238, v239
    v_mfma_f32_16x16x32_bf16 v[220:223], v[74:77], v[180:183], v[220:223]
    ds_write_b64 v249, v[236:237] offset:6144
    v_mfma_f32_16x16x32_bf16 v[224:227], a[248:251], v[180:183], v[224:227]
    s_waitcnt lgkmcnt(8)
    v_exp_f32 v204, v204
    v_mfma_f32_16x16x32_bf16 v[228:231], a[180:183], a[244:247], v[228:231]
    v_exp_f32 v205, v205
    v_mfma_f32_16x16x32_bf16 v[228:231], a[184:187], a[216:219], v[228:231]
    ds_read_b64 v[178:179], v247 offset:43264
    v_cvt_pk_bf16_f32 v184, v204, v205
    v_mfma_f32_16x16x32_bf16 v[228:231], a[188:191], a[220:223], v[228:231]
    ds_read_b128 v[204:207], v246 offset:0
    v_mfma_f32_16x16x32_bf16 v[232:235], a[192:195], a[232:235], 0
    ds_read_b128 a[232:235], v242 offset:12416
    v_mfma_f32_16x16x32_bf16 v[232:235], a[196:199], a[236:239], v[232:235]
    ds_read_b128 a[236:239], v243 offset:12416
    v_mfma_f32_16x16x32_bf16 v[232:235], a[200:203], a[240:243], v[232:235]
    ds_read_b128 a[240:243], v242 offset:12544
    v_add_u32 v242, 0xfffe9800, v242
    v_mfma_f32_16x16x32_bf16 v[232:235], a[204:207], a[244:247], v[232:235]
    ds_read_b128 a[244:247], v243 offset:12544
    v_cvt_pk_bf16_f32 v228, v228, v229
    v_mfma_f32_16x16x32_bf16 v[232:235], a[208:211], a[216:219], v[232:235]
    v_exp_f32 v208, v208
    v_mfma_f32_16x16x32_bf16 v[232:235], a[212:215], a[220:223], v[232:235]
    s_waitcnt lgkmcnt(10)
    v_exp_f32 v209, v209
    v_mfma_f32_16x16x32_bf16 v[196:199], v[162:165], v[168:171], v[196:199]
    s_waitcnt lgkmcnt(9)
    v_cvt_pk_bf16_f32 v185, v208, v209
    v_cvt_pk_bf16_f32 v229, v230, v231
    v_mfma_f32_16x16x32_bf16 v[196:199], v[164:167], v[170:173], v[196:199]
    ds_read_b128 v[208:211], v244 offset:64
    v_cvt_pk_bf16_f32 v232, v232, v233
    v_mfma_f32_16x16x32_bf16 v[212:215], v[18:21], v[184:187], v[212:215]
    ds_write_b64 v249, v[228:229] offset:6272
    v_mfma_f32_16x16x32_bf16 v[216:219], v[48:51], v[184:187], v[216:219]
    ds_read_b128 a[216:219], v242 offset:6144
    v_add_u32 v243, 0xfffe9800, v243
    v_mfma_f32_16x16x32_bf16 v[220:223], v[78:81], v[184:187], v[220:223]
    v_exp_f32 v196, v196
    v_mfma_f32_16x16x32_bf16 v[224:227], a[248:251], v[184:187], v[224:227]
    v_exp_f32 v197, v197
    v_mfma_f32_16x16x32_bf16 v[200:203], v[138:141], v[168:171], v[200:203]
    s_waitcnt lgkmcnt(7)
    v_exp_f32 v198, v198
    v_mfma_f32_16x16x32_bf16 v[200:203], v[140:143], v[170:173], v[200:203]
    v_exp_f32 v199, v199
    v_mfma_f32_16x16x32_bf16 v[204:207], v[144:147], v[168:171], v[204:207]
    v_cvt_pk_bf16_f32 v190, v196, v197
    v_cvt_pk_bf16_f32 v193, v198, v199
    v_mfma_f32_16x16x32_bf16 v[204:207], v[146:149], v[170:173], v[204:207]
    ds_read_b128 v[196:199], v245 offset:64
    v_cvt_pk_bf16_f32 v233, v234, v235
    v_mfma_f32_16x16x32_bf16 v[236:239], a[144:147], a[224:227], 0
    ds_read_b128 a[220:223], v243 offset:6144
    v_mfma_f32_16x16x32_bf16 v[236:239], a[148:151], a[228:231], v[236:239]
    s_waitcnt lgkmcnt(5)
    v_exp_f32 v200, v200
    v_mfma_f32_16x16x32_bf16 v[236:239], a[152:155], a[232:235], v[236:239]
    ds_write_b64 v249, v[232:233] offset:6400
    v_mfma_f32_16x16x32_bf16 v[236:239], a[156:159], a[236:239], v[236:239]
    v_exp_f32 v201, v201
    v_mfma_f32_16x16x32_bf16 v[236:239], a[160:163], a[240:243], v[236:239]
    s_waitcnt lgkmcnt(5)
    v_exp_f32 v202, v202
    v_mfma_f32_16x16x32_bf16 v[208:211], v[102:105], v[168:171], v[208:211]
    v_exp_f32 v203, v203
    v_mfma_f32_16x16x32_bf16 v[208:211], v[104:107], v[170:173], v[208:211]
    v_cvt_pk_bf16_f32 v188, v200, v201
    v_cvt_pk_bf16_f32 v191, v202, v203
    v_mfma_f32_16x16x32_bf16 v[236:239], a[164:167], a[244:247], v[236:239]
    ds_read_b128 v[200:203], v246 offset:64
    v_mfma_f32_16x16x32_bf16 v[228:231], a[168:171], a[224:227], 0
    v_rcp_f32 v225, v224
    v_mfma_f32_16x16x32_bf16 v[228:231], a[172:175], a[228:231], v[228:231]
    v_exp_f32 v204, v204
    v_mfma_f32_16x16x32_bf16 v[228:231], a[176:179], a[232:235], v[228:231]
    v_exp_f32 v205, v205
    v_mfma_f32_16x16x32_bf16 v[228:231], a[180:183], a[236:239], v[228:231]
    v_cvt_pk_bf16_f32 v236, v236, v237
    v_cvt_pk_bf16_f32 v237, v238, v239
    v_mfma_f32_16x16x32_bf16 v[228:231], a[184:187], a[240:243], v[228:231]
    s_waitcnt lgkmcnt(3)
    v_mul_f32 v212, v212, v225
    v_mul_f32 v213, v213, v225
    v_mfma_f32_16x16x32_bf16 v[196:199], v[114:117], v[168:171], v[196:199]
    ds_write_b64 v249, v[236:237] offset:12288
    v_mfma_f32_16x16x32_bf16 v[196:199], v[116:119], v[170:173], v[196:199]
    v_cvt_pk_bf16_f32 v189, v204, v205
    v_mul_f32 v214, v214, v225
    v_mfma_f32_16x16x32_bf16 v[228:231], a[188:191], a[244:247], v[228:231]
    v_mul_f32 v215, v215, v225
    v_cvt_pk_bf16_f32 v212, v212, v213
    v_mfma_f32_16x16x32_bf16 v[232:235], a[192:195], a[224:227], 0
    ds_read_b128 a[224:227], v242 offset:6272
    v_cvt_pk_bf16_f32 v213, v214, v215
    v_mfma_f32_16x16x32_bf16 v[232:235], a[196:199], a[228:231], v[232:235]
    ds_read_b128 a[228:231], v243 offset:6272
    v_mul_f32 v216, v216, v225
    v_mfma_f32_16x16x32_bf16 v[232:235], a[200:203], a[232:235], v[232:235]
    ds_read_b128 a[232:235], v242 offset:6400
    v_cvt_pk_bf16_f32 v228, v228, v229
    v_mfma_f32_16x16x32_bf16 v[232:235], a[204:207], a[236:239], v[232:235]
    ds_read_b128 a[236:239], v243 offset:6400
    v_cvt_pk_bf16_f32 v229, v230, v231
    v_mfma_f32_16x16x32_bf16 v[232:235], a[208:211], a[240:243], v[232:235]
    s_waitcnt lgkmcnt(5)
    v_mul_f32 v217, v217, v225
    v_mul_f32 v218, v218, v225
    v_mfma_f32_16x16x32_bf16 v[200:203], v[150:153], v[168:171], v[200:203]
    ds_write_b64 v247, v[212:213] offset:30720
    v_mfma_f32_16x16x32_bf16 v[212:215], v[12:15], v[188:191], 0
    ds_write_b64 v249, v[228:229] offset:12416
    v_mfma_f32_16x16x32_bf16 v[200:203], v[152:155], v[170:173], v[200:203]
    v_mul_f32 v219, v219, v225
    v_cvt_pk_bf16_f32 v216, v216, v217
    v_mfma_f32_16x16x32_bf16 v[232:235], a[212:215], a[244:247], v[232:235]
    ds_read_b128 a[240:243], v240 offset:6144
    v_cvt_pk_bf16_f32 v217, v218, v219
    v_mfma_f32_16x16x32_bf16 v[236:239], a[144:147], a[216:219], 0
    ds_write_b64 v247, v[216:217] offset:30848
    v_mfma_f32_16x16x32_bf16 v[216:219], v[42:45], v[188:191], 0
    v_max3_f32 v248, v248, v224, v225
    v_mul_f32 v220, v220, v225
    v_mfma_f32_16x16x32_bf16 v[236:239], a[148:151], a[220:223], v[236:239]
    s_waitcnt lgkmcnt(7)
    v_mul_f32 v221, v221, v225
    v_mul_f32 v222, v222, v225
    v_mfma_f32_16x16x32_bf16 v[236:239], a[152:155], a[224:227], v[236:239]
    s_waitcnt lgkmcnt(6)
    v_mul_f32 v223, v223, v225
    v_cvt_pk_bf16_f32 v220, v220, v221
    v_mfma_f32_16x16x32_bf16 v[224:227], a[248:251], v[188:191], 0
    ds_read_b128 a[244:247], v241 offset:6144
    v_cvt_pk_bf16_f32 v221, v222, v223
    v_mfma_f32_16x16x32_bf16 v[236:239], a[156:159], a[228:231], v[236:239]
    s_waitcnt lgkmcnt(6)
    v_cvt_pk_bf16_f32 v232, v232, v233
    v_cvt_pk_bf16_f32 v233, v234, v235
    v_mfma_f32_16x16x32_bf16 v[236:239], a[160:163], a[232:235], v[236:239]
    s_waitcnt lgkmcnt(5)
    v_exp_f32 v206, v206
    v_mfma_f32_16x16x32_bf16 v[236:239], a[164:167], a[236:239], v[236:239]
    ds_write_b64 v247, v[220:221] offset:30976
    v_mfma_f32_16x16x32_bf16 v[220:223], v[72:75], v[188:191], 0
    ds_write_b64 v249, v[232:233] offset:12544
    v_mfma_f32_16x16x32_bf16 v[228:231], a[168:171], a[216:219], 0
    v_exp_f32 v207, v207
    v_mfma_f32_16x16x32_bf16 v[228:231], a[172:175], a[220:223], v[228:231]
    v_exp_f32 v208, v208
    v_mfma_f32_16x16x32_bf16 v[228:231], a[176:179], a[224:227], v[228:231]
    v_cvt_pk_bf16_f32 v192, v206, v207
    v_cvt_pk_bf16_f32 v236, v236, v237
    v_mfma_f32_16x16x32_bf16 v[228:231], a[180:183], a[228:231], v[228:231]
    ds_read_b128 v[204:207], v244 offset:128
    v_cvt_pk_bf16_f32 v237, v238, v239
    v_mfma_f32_16x16x32_bf16 v[228:231], a[184:187], a[232:235], v[228:231]
    ds_write_b64 v249, v[236:237] offset:18432
    v_mfma_f32_16x16x32_bf16 v[228:231], a[188:191], a[236:239], v[228:231]
    s_waitcnt lgkmcnt(5)
    v_exp_f32 v209, v209
    v_mfma_f32_16x16x32_bf16 v[232:235], a[192:195], a[216:219], 0
    ds_read_b128 a[216:219], v240 offset:6272
    v_cvt_pk_bf16_f32 v180, v208, v209
    v_mfma_f32_16x16x32_bf16 v[232:235], a[196:199], a[220:223], v[232:235]
    ds_read_b128 a[220:223], v241 offset:6272
    v_mfma_f32_16x16x32_bf16 v[232:235], a[200:203], a[224:227], v[232:235]
    ds_read_b128 a[224:227], v240 offset:6400
    v_cvt_pk_bf16_f32 v228, v228, v229
    v_mfma_f32_16x16x32_bf16 v[232:235], a[204:207], a[228:231], v[232:235]
    ds_read_b128 a[228:231], v241 offset:6400
    v_cvt_pk_bf16_f32 v229, v230, v231
    v_mfma_f32_16x16x32_bf16 v[232:235], a[208:211], a[232:235], v[232:235]
    ds_write_b64 v249, v[228:229] offset:18560
    v_mfma_f32_16x16x32_bf16 v[232:235], a[212:215], a[236:239], v[232:235]
    v_exp_f32 v210, v210
    v_mfma_f32_16x16x32_bf16 v[236:239], a[0:3], a[240:243], 0
    s_waitcnt lgkmcnt(7)
    v_exp_f32 v211, v211
    v_mfma_f32_16x16x32_bf16 v[236:239], a[4:7], a[244:247], v[236:239]
    ds_read_b128 a[232:235], v242 offset:12288
    v_cvt_pk_bf16_f32 v183, v210, v211
    v_mfma_f32_16x16x32_bf16 v[228:231], a[24:27], a[240:243], 0
    s_waitcnt lgkmcnt(5)
    v_cvt_pk_bf16_f32 v232, v232, v233
    v_cvt_pk_bf16_f32 v233, v234, v235
    v_mfma_f32_16x16x32_bf16 v[204:207], v[108:111], v[168:171], v[204:207]
    ds_write_b64 v249, v[232:233] offset:18688
    v_mfma_f32_16x16x32_bf16 v[204:207], v[110:113], v[170:173], v[204:207]
    s_barrier
    v_exp_f32 v196, v196
    v_mfma_f32_16x16x32_bf16 v[236:239], a[8:11], a[216:219], v[236:239]
    s_waitcnt lgkmcnt(5)
    v_exp_f32 v197, v197
    v_mfma_f32_16x16x32_bf16 v[236:239], a[12:15], a[220:223], v[236:239]
    s_waitcnt lgkmcnt(4)
    v_exp_f32 v200, v200
    v_mfma_f32_16x16x32_bf16 v[236:239], a[16:19], a[224:227], v[236:239]
    s_waitcnt lgkmcnt(3)
    v_exp_f32 v201, v201
    v_mfma_f32_16x16x32_bf16 v[236:239], a[20:23], a[228:231], v[236:239]
    ds_read_b128 v[208:211], v245 offset:128
    v_cvt_pk_bf16_f32 v194, v196, v197
    v_mfma_f32_16x16x32_bf16 v[228:231], a[28:31], a[244:247], v[228:231]
    ds_read_b128 a[236:239], v243 offset:12288
    v_cvt_pk_bf16_f32 v195, v200, v201
    v_mfma_f32_16x16x32_bf16 v[228:231], a[32:35], a[216:219], v[228:231]
    v_exp_f32 v198, v198
    v_mfma_f32_16x16x32_bf16 v[212:215], v[16:19], v[192:195], v[212:215]
    v_exp_f32 v199, v199
    v_mfma_f32_16x16x32_bf16 v[216:219], v[46:49], v[192:195], v[216:219]
    v_cvt_pk_bf16_f32 v181, v198, v199
    v_cvt_pk_bf16_f32 v156, v236, v237
    v_mfma_f32_16x16x32_bf16 v[220:223], v[76:79], v[192:195], v[220:223]
    v_exp_f32 v202, v202
    v_mfma_f32_16x16x32_bf16 v[224:227], a[248:251], v[192:195], v[224:227]
    v_exp_f32 v203, v203
    v_mfma_f32_16x16x32_bf16 v[228:231], a[36:39], a[220:223], v[228:231]
    ds_read_b128 v[196:199], v246 offset:128
    v_cvt_pk_bf16_f32 v182, v202, v203
    v_mfma_f32_16x16x32_bf16 v[228:231], a[40:43], a[224:227], v[228:231]
    ds_read_b128 v[200:203], v244 offset:0
    v_cvt_pk_bf16_f32 v157, v238, v239
    v_mfma_f32_16x16x32_bf16 v[212:215], v[20:23], v[180:183], v[212:215]
    v_exp_f32 v204, v204
    v_mfma_f32_16x16x32_bf16 v[216:219], v[50:53], v[180:183], v[216:219]
    v_exp_f32 v205, v205
    v_mfma_f32_16x16x32_bf16 v[220:223], v[80:83], v[180:183], v[220:223]
    ds_read_b128 a[252:255], v252 offset:0
    v_cvt_pk_bf16_f32 v186, v204, v205
    v_mfma_f32_16x16x32_bf16 v[224:227], a[248:251], v[180:183], v[224:227]
    ds_read_b128 v[204:207], v245 offset:0
    ds_read_b64 v[254:255], v253 offset:256
    v_mfma_f32_16x16x32_bf16 v[228:231], a[44:47], a[228:231], v[228:231]
    v_mfma_f32_16x16x32_bf16 v[232:235], a[48:51], a[240:243], 0
    s_waitcnt lgkmcnt(6)
    v_mfma_f32_16x16x32_bf16 v[208:211], v[120:123], v[168:171], v[208:211]
    v_mfma_f32_16x16x32_bf16 v[208:211], v[122:125], v[170:173], v[208:211]
    v_mfma_f32_16x16x32_bf16 v[232:235], a[52:55], a[244:247], v[232:235]
    v_mfma_f32_16x16x32_bf16 v[232:235], a[56:59], a[216:219], v[232:235]
    v_mfma_f32_16x16x32_bf16 v[232:235], a[60:63], a[220:223], v[232:235]
    v_mfma_f32_16x16x32_bf16 v[232:235], a[64:67], a[224:227], v[232:235]
    v_cvt_pk_bf16_f32 v158, v228, v229
    v_cvt_pk_bf16_f32 v159, v230, v231
    v_mfma_f32_16x16x32_bf16 v[232:235], a[68:71], a[228:231], v[232:235]
    s_waitcnt lgkmcnt(4)
    v_exp_f32 v208, v208
    v_mfma_f32_16x16x32_bf16 v[196:199], v[156:159], v[168:171], v[196:199]
    s_waitcnt lgkmcnt(3)
    v_exp_f32 v209, v209
    v_mfma_f32_16x16x32_bf16 v[200:203], v[102:105], v[174:177], v[200:203]
    ds_read_b64 v[168:169], v247 offset:49152
    v_cvt_pk_bf16_f32 v184, v208, v209
    v_mfma_f32_16x16x32_bf16 v[200:203], v[104:107], v[176:179], v[200:203]
    v_cvt_pk_bf16_f32 v160, v232, v233
    v_cvt_pk_bf16_f32 v161, v234, v235
    v_mfma_f32_16x16x32_bf16 v[236:239], a[240:243], a[72:75], 0
    ds_read_b128 v[208:211], v246 offset:0
    s_waitcnt lgkmcnt(3)
    v_mfma_f32_16x16x32_bf16 v[196:199], v[158:161], v[170:173], v[196:199]
    buffer_store_dwordx4 a[252:255], v250, s[20:23], s57 offen nt
    v_mfma_f32_16x16x32_bf16 v[204:207], v[114:117], v[174:177], v[204:207]
    s_waitcnt lgkmcnt(2)
    v_exp_f32 v200, v200
    v_mfma_f32_16x16x32_bf16 v[204:207], v[116:119], v[176:179], v[204:207]
    v_exp_f32 v201, v201
    v_mfma_f32_16x16x32_bf16 v[236:239], a[244:247], a[76:79], v[236:239]
    v_exp_f32 v202, v202
    v_mfma_f32_16x16x32_bf16 v[236:239], a[216:219], a[80:83], v[236:239]
    v_exp_f32 v196, v196
    v_mfma_f32_16x16x32_bf16 v[236:239], a[220:223], a[84:87], v[236:239]
    v_exp_f32 v197, v197
    v_mfma_f32_16x16x32_bf16 v[236:239], a[224:227], a[88:91], v[236:239]
    v_cvt_pk_bf16_f32 v185, v196, v197
    v_cvt_pk_bf16_f32 v190, v200, v201
    v_mfma_f32_16x16x32_bf16 v[236:239], a[228:231], a[92:95], v[236:239]
    ds_read_b128 v[196:199], v244 offset:64
    ds_read_b128 a[252:255], v252 offset:6144
    v_mfma_f32_16x16x32_bf16 v[224:227], a[248:251], v[184:187], v[224:227]
    v_exp_f32 v203, v203
    v_mfma_f32_16x16x32_bf16 v[228:231], a[240:243], a[96:99], 0
    ds_read_b64 v[170:171], v247 offset:49280
    v_cvt_pk_bf16_f32 v193, v202, v203
    v_mfma_f32_16x16x32_bf16 v[228:231], a[244:247], a[100:103], v[228:231]
    ds_read_b128 v[200:203], v245 offset:64
    v_cvt_pk_bf16_f32 v25, v236, v237
    v_mfma_f32_16x16x32_bf16 v[228:231], a[216:219], a[104:107], v[228:231]
    ds_read_b64 v[172:173], v247 offset:49408
    v_cvt_pk_bf16_f32 v28, v238, v239
    v_mfma_f32_16x16x32_bf16 v[212:215], v[24:27], v[184:187], v[212:215]
    s_waitcnt lgkmcnt(5)
    v_exp_f32 v204, v204
    v_mfma_f32_16x16x32_bf16 v[208:211], v[150:153], v[174:177], v[208:211]
    v_exp_f32 v205, v205
    v_mfma_f32_16x16x32_bf16 v[208:211], v[152:155], v[176:179], v[208:211]
    v_exp_f32 v206, v206
    v_mfma_f32_16x16x32_bf16 v[228:231], a[220:223], a[108:111], v[228:231]
    v_exp_f32 v207, v207
    v_mfma_f32_16x16x32_bf16 v[228:231], a[224:227], a[112:115], v[228:231]
    v_cvt_pk_bf16_f32 v188, v204, v205
    v_cvt_pk_bf16_f32 v191, v206, v207
    v_mfma_f32_16x16x32_bf16 v[228:231], a[228:231], a[116:119], v[228:231]
    ds_read_b128 v[204:207], v246 offset:64
    v_mfma_f32_16x16x32_bf16 v[232:235], a[240:243], a[120:123], 0
    ds_read_b128 a[240:243], v242 offset:12416
    v_mfma_f32_16x16x32_bf16 v[232:235], a[244:247], a[124:127], v[232:235]
    s_waitcnt lgkmcnt(6)
    ds_read_b128 a[244:247], v243 offset:12416
    v_mfma_f32_16x16x32_bf16 v[196:199], v[108:111], v[174:177], v[196:199]
    v_rcp_f32 v225, v224
    v_mfma_f32_16x16x32_bf16 v[196:199], v[110:113], v[176:179], v[196:199]
    v_cvt_pk_bf16_f32 v55, v228, v229
    v_cvt_pk_bf16_f32 v58, v230, v231
    v_mfma_f32_16x16x32_bf16 v[232:235], a[216:219], a[128:131], v[232:235]
    ds_read_b128 a[216:219], v242 offset:12544
    v_mul_f32 v212, v212, v225
    v_mfma_f32_16x16x32_bf16 v[216:219], v[54:57], v[184:187], v[216:219]
    s_waitcnt lgkmcnt(6)
    s_waitcnt lgkmcnt(5)
    v_mul_f32 v213, v213, v225
    v_mfma_f32_16x16x32_bf16 v[200:203], v[120:123], v[174:177], v[200:203]
    v_exp_f32 v208, v208
    v_mfma_f32_16x16x32_bf16 v[200:203], v[122:125], v[176:179], v[200:203]
    v_exp_f32 v209, v209
    v_mfma_f32_16x16x32_bf16 v[232:235], a[220:223], a[132:135], v[232:235]
    ds_read_b128 a[220:223], v243 offset:12544
    v_cvt_pk_bf16_f32 v189, v208, v209
    v_mfma_f32_16x16x32_bf16 v[232:235], a[224:227], a[136:139], v[232:235]
    ds_read_b128 a[224:227], v242 offset:18432
    v_mul_f32 v214, v214, v225
    v_mfma_f32_16x16x32_bf16 v[232:235], a[228:231], a[140:143], v[232:235]
    ds_read_b128 a[228:231], v243 offset:18432
    v_mul_f32 v215, v215, v225
    v_mfma_f32_16x16x32_bf16 v[236:239], a[144:147], a[232:235], 0
    buffer_store_dwordx2 v[254:255], v251, s[20:23], s57 offen offset:256 nt
    v_mfma_f32_16x16x32_bf16 v[236:239], a[148:151], a[236:239], v[236:239]
    s_waitcnt lgkmcnt(5)
    v_cvt_pk_bf16_f32 v212, v212, v213
    v_cvt_pk_bf16_f32 v213, v214, v215
    v_mfma_f32_16x16x32_bf16 v[204:207], v[156:159], v[174:177], v[204:207]
    s_mul_i32 s57, s31, 3
    v_cvt_pk_bf16_f32 v85, v232, v233
    v_cvt_pk_bf16_f32 v88, v234, v235
    v_mfma_f32_16x16x32_bf16 v[204:207], v[158:161], v[176:179], v[204:207]
    ds_read_b64 v[254:255], v253 offset:6400
    v_mul_f32 v216, v216, v225
    v_mfma_f32_16x16x32_bf16 v[220:223], v[84:87], v[184:187], v[220:223]
    ds_write_b64 v247, v[212:213] offset:36864
    v_mfma_f32_16x16x32_bf16 v[212:215], v[18:21], v[188:191], 0
    s_add_u32 s56, s56, s57
    v_mul_f32 v217, v217, v225
    v_mul_f32 v218, v218, v225
    v_mfma_f32_16x16x32_bf16 v[236:239], a[152:155], a[240:243], v[236:239]
    s_waitcnt lgkmcnt(5)
    v_mul_f32 v219, v219, v225
    v_cvt_pk_bf16_f32 v216, v216, v217
    v_mfma_f32_16x16x32_bf16 v[236:239], a[156:159], a[244:247], v[236:239]
    s_add_u32 s56, s56, s32
    v_cvt_pk_bf16_f32 v217, v218, v219
    v_mul_f32 v220, v220, v225
    v_mfma_f32_16x16x32_bf16 v[236:239], a[160:163], a[216:219], v[236:239]
    s_waitcnt lgkmcnt(4)
    v_mul_f32 v221, v221, v225
    v_mul_f32 v222, v222, v225
    v_mfma_f32_16x16x32_bf16 v[236:239], a[164:167], a[220:223], v[236:239]
    ds_write_b64 v247, v[216:217] offset:36992
    v_mfma_f32_16x16x32_bf16 v[216:219], v[48:51], v[188:191], 0
    buffer_store_dwordx4 a[252:255], v250, s[20:23], s52 offen nt
    v_mfma_f32_16x16x32_bf16 v[228:231], a[168:171], a[232:235], 0
    s_add_u32 s57, s28, 7
    v_mul_f32 v223, v223, v225
    v_cvt_pk_bf16_f32 v220, v220, v221
    v_mfma_f32_16x16x32_bf16 v[228:231], a[172:175], a[236:239], v[228:231]
    s_mul_i32 s57, s57, s30
    v_cvt_pk_bf16_f32 v236, v236, v237
    v_cvt_pk_bf16_f32 v237, v238, v239
    v_mfma_f32_16x16x32_bf16 v[228:231], a[176:179], a[240:243], v[228:231]
    ds_write_b64 v249, v[236:237] offset:24576
    v_mfma_f32_16x16x32_bf16 v[228:231], a[180:183], a[244:247], v[228:231]
    s_waitcnt lgkmcnt(4)
    v_cvt_pk_bf16_f32 v221, v222, v223
    v_max3_f32 v248, v248, v224, v225
    v_mfma_f32_16x16x32_bf16 v[224:227], a[248:251], v[188:191], 0
    s_waitcnt lgkmcnt(3)
    v_exp_f32 v210, v210
    v_mfma_f32_16x16x32_bf16 v[228:231], a[184:187], a[216:219], v[228:231]
    buffer_store_dwordx2 v[254:255], v251, s[20:23], s52 offen offset:256 nt
    v_mfma_f32_16x16x32_bf16 v[228:231], a[188:191], a[220:223], v[228:231]
    ds_write_b64 v247, v[220:221] offset:37120
    v_mfma_f32_16x16x32_bf16 v[220:223], v[78:81], v[188:191], 0
    ds_read_b128 a[252:255], v252 offset:12288
    v_add_u32 v209, 0xfffff900, v245
L_h8:
    s_cbranch_execz L_hback
    v_mfma_f32_16x16x32_bf16 v[232:235], a[192:195], a[232:235], 0
    ds_read_b128 a[232:235], v242 offset:18560
    v_cndmask_b32 v209, v244, v209, vcc
    v_mfma_f32_16x16x32_bf16 v[232:235], a[196:199], a[236:239], v[232:235]
    ds_read_b128 a[236:239], v243 offset:18560
    v_cvt_pk_bf16_f32 v228, v228, v229
    v_mfma_f32_16x16x32_bf16 v[232:235], a[200:203], a[240:243], v[232:235]
    ds_read_b128 a[240:243], v242 offset:18688
    v_cvt_pk_bf16_f32 v229, v230, v231
    v_mfma_f32_16x16x32_bf16 v[232:235], a[204:207], a[244:247], v[232:235]
    ds_read_b128 a[244:247], v243 offset:18688
    v_mov_b32 v208, 0x237c0
    v_mfma_f32_16x16x32_bf16 v[232:235], a[208:211], a[216:219], v[232:235]
    ds_write_b64 v249, v[228:229] offset:24704
    v_mfma_f32_16x16x32_bf16 v[232:235], a[212:215], a[220:223], v[232:235]
    ds_read_b64 v[254:255], v253 offset:12544
    v_mov_b32 v186, 0
    v_mfma_f32_16x16x32_bf16 v[236:239], a[144:147], a[224:227], 0
    ds_read_b128 a[216:219], v242 offset:0
    v_mov_b32 v189, 0
    v_mfma_f32_16x16x32_bf16 v[236:239], a[148:151], a[228:231], v[236:239]
    ds_read_b128 a[220:223], v243 offset:0
    s_mov_b32 vcc_lo, 0xff00ff00
    v_mfma_f32_16x16x32_bf16 v[228:231], a[168:171], a[224:227], 0
    s_waitcnt lgkmcnt(7)
    v_cvt_pk_bf16_f32 v232, v232, v233
    v_cvt_pk_bf16_f32 v233, v234, v235
    v_mfma_f32_16x16x32_bf16 v[236:239], a[152:155], a[232:235], v[236:239]
    s_waitcnt lgkmcnt(6)
    v_exp_f32 v211, v211
    v_mfma_f32_16x16x32_bf16 v[236:239], a[156:159], a[236:239], v[236:239]
    s_waitcnt lgkmcnt(5)
    v_cvt_pk_bf16_f32 v192, v210, v211
    v_add_u32 v210, 0xc0, v209
    v_mfma_f32_16x16x32_bf16 v[236:239], a[160:163], a[240:243], v[236:239]
    s_waitcnt lgkmcnt(4)
    v_exp_f32 v200, v200
    v_mfma_f32_16x16x32_bf16 v[236:239], a[164:167], a[244:247], v[236:239]
    ds_write_b64 v249, v[232:233] offset:24832
    v_mfma_f32_16x16x32_bf16 v[228:231], a[172:175], a[228:231], v[228:231]
    s_mov_b32 vcc_hi, 0xff00ff00
    v_add_u32 v209, 0x340, v209
    v_cndmask_b32 v244, v210, v209, vcc
    v_mfma_f32_16x16x32_bf16 v[228:231], a[176:179], a[232:235], v[228:231]
    s_mov_b32 vcc_lo, 0xf0f0
    v_exp_f32 v201, v201
    v_mfma_f32_16x16x32_bf16 v[228:231], a[180:183], a[236:239], v[228:231]
    s_mov_b32 vcc_hi, 0x0
    v_cvt_pk_bf16_f32 v236, v236, v237
    v_cvt_pk_bf16_f32 v237, v238, v239
    v_mfma_f32_16x16x32_bf16 v[228:231], a[184:187], a[240:243], v[228:231]
    s_mul_i32 s52, s31, 7
    v_exp_f32 v202, v202
    v_mfma_f32_16x16x32_bf16 v[228:231], a[188:191], a[244:247], v[228:231]
    s_add_u32 s51, s51, s52
    v_exp_f32 v203, v203
    v_mfma_f32_16x16x32_bf16 v[232:235], a[192:195], a[224:227], 0
    ds_read_b128 a[224:227], v242 offset:128
    v_add_u32 v245, 0x700, v244
    v_mfma_f32_16x16x32_bf16 v[232:235], a[196:199], a[228:231], v[232:235]
    ds_read_b128 a[228:231], v243 offset:128
    v_cvt_pk_bf16_f32 v194, v200, v201
    v_mfma_f32_16x16x32_bf16 v[232:235], a[200:203], a[232:235], v[232:235]
    ds_read_b128 a[232:235], v242 offset:256
    s_waitcnt lgkmcnt(3)
    v_mfma_f32_16x16x32_bf16 v[232:235], a[204:207], a[236:239], v[232:235]
    ds_read_b128 a[236:239], v243 offset:256
    s_barrier
    v_mfma_f32_16x16x32_bf16 v[232:235], a[208:211], a[240:243], v[232:235]
    ds_write_b64 v249, v[236:237] offset:0
    v_mfma_f32_16x16x32_bf16 v[232:235], a[212:215], a[244:247], v[232:235]
    s_add_u32 s51, s51, s32
    v_cvt_pk_bf16_f32 v228, v228, v229
    v_cvt_pk_bf16_f32 v229, v230, v231
    v_mfma_f32_16x16x32_bf16 v[236:239], a[144:147], a[216:219], 0
    ds_write_b64 v249, v[228:229] offset:128
    v_mfma_f32_16x16x32_bf16 v[236:239], a[148:151], a[220:223], v[236:239]
    s_add_u32 s52, s28, 11
    v_cvt_pk_bf16_f32 v181, v202, v203
    v_cvt_pk_bf16_f32 v232, v232, v233
    v_mfma_f32_16x16x32_bf16 v[228:231], a[168:171], a[216:219], 0
    s_waitcnt lgkmcnt(5)
    v_cvt_pk_bf16_f32 v233, v234, v235
    v_cndmask_b32 v244, v244, v208, vcc
    v_mfma_f32_16x16x32_bf16 v[236:239], a[152:155], a[224:227], v[236:239]
    s_waitcnt lgkmcnt(4)
    v_exp_f32 v204, v204
    v_mfma_f32_16x16x32_bf16 v[236:239], a[156:159], a[228:231], v[236:239]
    s_waitcnt lgkmcnt(3)
    v_exp_f32 v205, v205
    v_mfma_f32_16x16x32_bf16 v[236:239], a[160:163], a[232:235], v[236:239]
    s_waitcnt lgkmcnt(2)
    v_cvt_pk_bf16_f32 v195, v204, v205
    s_mov_b32 vcc_lo, 0x0
    v_mfma_f32_16x16x32_bf16 v[236:239], a[164:167], a[236:239], v[236:239]
    ds_write_b64 v249, v[232:233] offset:256
    v_mfma_f32_16x16x32_bf16 v[212:215], v[22:25], v[192:195], v[212:215]
    ds_read_b128 v[200:203], v244 offset:64
    s_mov_b32 vcc_hi, 0xf0f0000
    v_mfma_f32_16x16x32_bf16 v[216:219], v[52:55], v[192:195], v[216:219]
    ds_read_b128 a[240:243], v242 offset:24576
    v_cndmask_b32 v245, v245, v208, vcc
    v_mfma_f32_16x16x32_bf16 v[220:223], v[82:85], v[192:195], v[220:223]
    ds_read_b128 v[208:211], v244 offset:0
    v_cvt_pk_bf16_f32 v236, v236, v237
    v_mfma_f32_16x16x32_bf16 v[224:227], a[248:251], v[192:195], v[224:227]
    s_mov_b32 vcc_lo, 0xff000f
    v_exp_f32 v196, v196
    v_mfma_f32_16x16x32_bf16 v[228:231], a[172:175], a[220:223], v[228:231]
    s_mov_b32 vcc_hi, 0xff00ff
    v_exp_f32 v197, v197
    v_mfma_f32_16x16x32_bf16 v[228:231], a[176:179], a[224:227], v[228:231]
    s_mul_i32 s52, s52, s30
    v_exp_f32 v198, v198
    v_mfma_f32_16x16x32_bf16 v[228:231], a[180:183], a[228:231], v[228:231]
    v_exp_f32 v199, v199
    v_mfma_f32_16x16x32_bf16 v[228:231], a[184:187], a[232:235], v[228:231]
    v_cvt_pk_bf16_f32 v180, v196, v197
    v_cvt_pk_bf16_f32 v183, v198, v199
    v_mfma_f32_16x16x32_bf16 v[228:231], a[188:191], a[236:239], v[228:231]
    ds_read_b128 v[196:199], v245 offset:0
    v_cvt_pk_bf16_f32 v237, v238, v239
    v_mfma_f32_16x16x32_bf16 v[232:235], a[192:195], a[216:219], 0
    v_exp_f32 v206, v206
    v_mfma_f32_16x16x32_bf16 v[232:235], a[196:199], a[220:223], v[232:235]
    v_exp_f32 v207, v207
    v_mfma_f32_16x16x32_bf16 v[232:235], a[200:203], a[224:227], v[232:235]
    ds_read_b128 a[244:247], v243 offset:24576
    v_cvt_pk_bf16_f32 v182, v206, v207
    v_mfma_f32_16x16x32_bf16 v[232:235], a[204:207], a[228:231], v[232:235]
    s_waitcnt lgkmcnt(4)
    ds_read_b128 v[204:207], v245 offset:64
    v_mfma_f32_16x16x32_bf16 v[212:215], v[26:29], v[180:183], v[212:215]
    ds_read_b128 a[216:219], v242 offset:24704
    v_cvt_pk_bf16_f32 v228, v228, v229
    v_mfma_f32_16x16x32_bf16 v[216:219], v[56:59], v[180:183], v[216:219]
    ds_read_b128 a[220:223], v243 offset:24704
    v_cvt_pk_bf16_f32 v229, v230, v231
    v_mfma_f32_16x16x32_bf16 v[220:223], v[86:89], v[180:183], v[220:223]
    ds_read_b128 a[224:227], v242 offset:24832
    s_waitcnt lgkmcnt(6)
    v_mfma_f32_16x16x32_bf16 v[224:227], a[248:251], v[180:183], v[224:227]
    ds_read_b128 a[228:231], v243 offset:24832
    v_mov_b32 v192, 0
    v_mfma_f32_16x16x32_bf16 v[208:211], v[90:93], v[168:171], v[208:211]
    ds_write_b64 v249, v[236:237] offset:6144
    v_mfma_f32_16x16x32_bf16 v[208:211], v[92:95], v[170:173], v[208:211]
    ds_write_b64 v249, v[228:229] offset:6272
    v_mfma_f32_16x16x32_bf16 v[200:203], v[96:99], v[168:171], v[200:203]
    ds_read_b64 v[174:175], v247 offset:55296
    v_mov_b32 v195, 0
    v_mfma_f32_16x16x32_bf16 v[200:203], v[98:101], v[170:173], v[200:203]
    v_rcp_f32 v225, v224
    v_mfma_f32_16x16x32_bf16 v[232:235], a[208:211], a[232:235], v[232:235]
    s_waitcnt lgkmcnt(9)
    v_exp_f32 v208, v208
    v_mfma_f32_16x16x32_bf16 v[196:199], v[126:129], v[168:171], v[196:199]
    v_exp_f32 v209, v209
    v_mfma_f32_16x16x32_bf16 v[196:199], v[128:131], v[170:173], v[196:199]
    s_waitcnt lgkmcnt(7)
    v_exp_f32 v210, v210
    v_mfma_f32_16x16x32_bf16 v[204:207], v[132:135], v[168:171], v[204:207]
    v_exp_f32 v211, v211
    v_mfma_f32_16x16x32_bf16 v[204:207], v[134:137], v[170:173], v[204:207]
    v_cvt_pk_bf16_f32 v184, v208, v209
    v_cvt_pk_bf16_f32 v187, v210, v211
    v_mfma_f32_16x16x32_bf16 v[232:235], a[212:215], a[236:239], v[232:235]
    ds_read_b128 v[208:211], v244 offset:128
    v_mul_f32 v212, v212, v225
    v_mfma_f32_16x16x32_bf16 v[236:239], a[144:147], a[240:243], 0
    v_exp_f32 v196, v196
    v_mfma_f32_16x16x32_bf16 v[236:239], a[148:151], a[244:247], v[236:239]
    s_waitcnt lgkmcnt(5)
    v_exp_f32 v197, v197
    v_mfma_f32_16x16x32_bf16 v[236:239], a[152:155], a[216:219], v[236:239]
    v_mul_f32 v213, v213, v225
    v_cvt_pk_bf16_f32 v185, v196, v197
    v_mfma_f32_16x16x32_bf16 v[236:239], a[156:159], a[220:223], v[236:239]
    v_mul_f32 v214, v214, v225
    v_mul_f32 v215, v215, v225
    v_mfma_f32_16x16x32_bf16 v[236:239], a[160:163], a[224:227], v[236:239]
    s_waitcnt lgkmcnt(3)
    v_cvt_pk_bf16_f32 v212, v212, v213
    v_cvt_pk_bf16_f32 v213, v214, v215
    v_mfma_f32_16x16x32_bf16 v[236:239], a[164:167], a[228:231], v[236:239]
    ds_write_b64 v247, v[212:213] offset:43008
    v_mfma_f32_16x16x32_bf16 v[212:215], v[0:3], v[184:187], 0
    ds_read_b128 a[232:235], v242 offset:30720
    v_cvt_pk_bf16_f32 v232, v232, v233
    v_mfma_f32_16x16x32_bf16 v[228:231], a[168:171], a[240:243], 0
    ds_read_b128 a[236:239], v243 offset:30720
    v_cvt_pk_bf16_f32 v233, v234, v235
    v_mfma_f32_16x16x32_bf16 v[228:231], a[172:175], a[244:247], v[228:231]
    ds_write_b64 v249, v[232:233] offset:6400
    v_mfma_f32_16x16x32_bf16 v[228:231], a[176:179], a[216:219], v[228:231]
    v_mul_f32 v216, v216, v225
    v_mul_f32 v217, v217, v225
    v_mfma_f32_16x16x32_bf16 v[228:231], a[180:183], a[220:223], v[228:231]
    v_mul_f32 v218, v218, v225
    v_mul_f32 v219, v219, v225
    v_mfma_f32_16x16x32_bf16 v[228:231], a[184:187], a[224:227], v[228:231]
    v_cvt_pk_bf16_f32 v216, v216, v217
    v_cvt_pk_bf16_f32 v217, v218, v219
    v_mfma_f32_16x16x32_bf16 v[228:231], a[188:191], a[228:231], v[228:231]
    s_waitcnt lgkmcnt(4)
    v_exp_f32 v198, v198
    v_mfma_f32_16x16x32_bf16 v[208:211], v[138:141], v[168:171], v[208:211]
    ds_write_b64 v247, v[216:217] offset:43136
    v_mfma_f32_16x16x32_bf16 v[216:219], v[30:33], v[184:187], 0
    v_exp_f32 v199, v199
    v_mfma_f32_16x16x32_bf16 v[208:211], v[140:143], v[170:173], v[208:211]
    v_mul_f32 v220, v220, v225
    v_mul_f32 v221, v221, v225
    v_mfma_f32_16x16x32_bf16 v[232:235], a[192:195], a[240:243], 0
    ds_read_b128 a[240:243], v242 offset:30848
    v_mul_f32 v222, v222, v225
    v_mfma_f32_16x16x32_bf16 v[232:235], a[196:199], a[244:247], v[232:235]
    ds_read_b128 a[244:247], v243 offset:30848
    v_mul_f32 v223, v223, v225
    v_mfma_f32_16x16x32_bf16 v[232:235], a[200:203], a[216:219], v[232:235]
    ds_read_b128 a[216:219], v242 offset:30976
    v_cvt_pk_bf16_f32 v220, v220, v221
    v_mfma_f32_16x16x32_bf16 v[232:235], a[204:207], a[220:223], v[232:235]
    v_cvt_pk_bf16_f32 v188, v198, v199
    v_cvt_pk_bf16_f32 v221, v222, v223
    v_mfma_f32_16x16x32_bf16 v[232:235], a[208:211], a[224:227], v[232:235]
    ds_read_b128 v[196:199], v245 offset:128
    v_max3_f32 v248, v248, v224, v225
    v_mfma_f32_16x16x32_bf16 v[224:227], a[248:251], v[184:187], 0
    ds_write_b64 v247, v[220:221] offset:43264
    v_mfma_f32_16x16x32_bf16 v[220:223], v[60:63], v[184:187], 0
    ds_read_b128 a[220:223], v243 offset:30976
    v_cvt_pk_bf16_f32 v236, v236, v237
    v_mfma_f32_16x16x32_bf16 v[232:235], a[212:215], a[228:231], v[232:235]
    v_cvt_pk_bf16_f32 v237, v238, v239
    ds_write_b64 v249, v[236:237] offset:12288
    s_waitcnt lgkmcnt(8)
    v_mfma_f32_16x16x32_bf16 v[236:239], a[144:147], a[232:235], 0
    ds_read_b64 v[176:177], v247 offset:55424
    v_cvt_pk_bf16_f32 v228, v228, v229
    v_mfma_f32_16x16x32_bf16 v[236:239], a[148:151], a[236:239], v[236:239]
    s_waitcnt lgkmcnt(7)
    v_cvt_pk_bf16_f32 v229, v230, v231
    v_cvt_pk_bf16_f32 v232, v232, v233
    v_mfma_f32_16x16x32_bf16 v[236:239], a[152:155], a[240:243], v[236:239]
    s_waitcnt lgkmcnt(6)
    v_exp_f32 v200, v200
    v_mfma_f32_16x16x32_bf16 v[236:239], a[156:159], a[244:247], v[236:239]
    s_waitcnt lgkmcnt(4)
    v_exp_f32 v201, v201
    v_mfma_f32_16x16x32_bf16 v[196:199], v[144:147], v[168:171], v[196:199]
    ds_write_b64 v249, v[228:229] offset:12416
    v_mfma_f32_16x16x32_bf16 v[196:199], v[146:149], v[170:173], v[196:199]
    v_exp_f32 v202, v202
    v_mfma_f32_16x16x32_bf16 v[236:239], a[160:163], a[216:219], v[236:239]
    s_waitcnt lgkmcnt(3)
    v_exp_f32 v203, v203
    v_mfma_f32_16x16x32_bf16 v[236:239], a[164:167], a[220:223], v[236:239]
    v_cvt_pk_bf16_f32 v190, v200, v201
    v_cvt_pk_bf16_f32 v193, v202, v203
    v_mfma_f32_16x16x32_bf16 v[228:231], a[168:171], a[232:235], 0
    v_exp_f32 v204, v204
    v_mfma_f32_16x16x32_bf16 v[228:231], a[172:175], a[236:239], v[228:231]
    v_exp_f32 v205, v205
    v_mfma_f32_16x16x32_bf16 v[228:231], a[176:179], a[240:243], v[228:231]
    ds_read_b128 v[200:203], v244 offset:192
    v_cvt_pk_bf16_f32 v191, v204, v205
    v_mfma_f32_16x16x32_bf16 v[228:231], a[180:183], a[244:247], v[228:231]
    v_exp_f32 v206, v206
    v_mfma_f32_16x16x32_bf16 v[212:215], v[4:7], v[188:191], v[212:215]
    v_exp_f32 v207, v207
    v_mfma_f32_16x16x32_bf16 v[216:219], v[34:37], v[188:191], v[216:219]
    v_cvt_pk_bf16_f32 v194, v206, v207
    v_cvt_pk_bf16_f32 v233, v234, v235
    v_mfma_f32_16x16x32_bf16 v[220:223], v[64:67], v[188:191], v[220:223]
    ds_read_b128 v[204:207], v245 offset:192
    v_mov_b32 v182, 0
    v_mfma_f32_16x16x32_bf16 v[224:227], a[248:251], v[188:191], v[224:227]
    buffer_store_dwordx4 a[252:255], v250, s[20:23], s54 offen nt
    v_mfma_f32_16x16x32_bf16 v[212:215], v[8:11], v[192:195], v[212:215]
    ds_write_b64 v249, v[232:233] offset:12544
    v_mfma_f32_16x16x32_bf16 v[216:219], v[38:41], v[192:195], v[216:219]
    ds_read_b128 a[252:255], v252 offset:18432
    s_waitcnt lgkmcnt(3)
    v_mfma_f32_16x16x32_bf16 v[220:223], v[68:71], v[192:195], v[220:223]
    buffer_store_dwordx2 v[254:255], v251, s[20:23], s54 offen offset:256 nt
    v_mfma_f32_16x16x32_bf16 v[224:227], a[248:251], v[192:195], v[224:227]
    ds_read_b64 v[254:255], v253 offset:18688
    v_mov_b32 v185, 0
    v_mfma_f32_16x16x32_bf16 v[200:203], v[114:117], v[168:171], v[200:203]
    s_mul_i32 s54, s31, 11
    v_exp_f32 v208, v208
    v_mfma_f32_16x16x32_bf16 v[200:203], v[116:119], v[170:173], v[200:203]
    s_waitcnt lgkmcnt(3)
    v_exp_f32 v209, v209
    v_mfma_f32_16x16x32_bf16 v[204:207], v[150:153], v[168:171], v[204:207]
    ds_read_b64 v[178:179], v247 offset:55552
    v_cvt_pk_bf16_f32 v180, v208, v209
    v_mfma_f32_16x16x32_bf16 v[204:207], v[152:155], v[170:173], v[204:207]
    s_add_u32 s53, s53, s54
    v_add_u32 v208, 0xffffff40, v244
    v_cndmask_b32 v244, v244, v208, vcc
    v_mfma_f32_16x16x32_bf16 v[228:231], a[184:187], a[216:219], v[228:231]
    s_mov_b32 vcc_lo, 0xff00ff
    v_exp_f32 v210, v210
    v_mfma_f32_16x16x32_bf16 v[228:231], a[188:191], a[220:223], v[228:231]
    s_waitcnt lgkmcnt(2)
    v_exp_f32 v211, v211
    v_mfma_f32_16x16x32_bf16 v[232:235], a[192:195], a[232:235], 0
    buffer_store_dwordx4 a[252:255], v250, s[20:23], s56 offen nt
    v_mfma_f32_16x16x32_bf16 v[232:235], a[196:199], a[236:239], v[232:235]
    s_waitcnt lgkmcnt(1)
    ds_read_b128 a[252:255], v252 offset:24576
    v_mfma_f32_16x16x32_bf16 v[232:235], a[200:203], a[240:243], v[232:235]
    s_mov_b32 vcc_hi, 0xf000ff
    v_add_u32 v209, 0xffffff40, v245
    v_cvt_pk_bf16_f32 v183, v210, v211
    v_mfma_f32_16x16x32_bf16 v[232:235], a[204:207], a[244:247], v[232:235]
    buffer_store_dwordx2 v[254:255], v251, s[20:23], s56 offen offset:256 nt
    v_mfma_f32_16x16x32_bf16 v[232:235], a[208:211], a[216:219], v[232:235]
    ds_read_b64 v[254:255], v253 offset:24832
    v_cndmask_b32 v245, v245, v209, vcc
    v_mfma_f32_16x16x32_bf16 v[232:235], a[212:215], a[220:223], v[232:235]
    v_exp_f32 v196, v196
    v_exp_f32 v197, v197
    ds_read_b128 v[208:211], v244 offset:0
    v_cvt_pk_bf16_f32 v181, v196, v197
    v_exp_f32 v200, v200
    v_exp_f32 v201, v201
    v_mfma_f32_16x16x32_bf16 v[212:215], v[12:15], v[180:183], v[212:215]
    ds_read_b128 a[224:227], v242 offset:36864
    v_cvt_pk_bf16_f32 v186, v200, v201
    v_mfma_f32_16x16x32_bf16 v[216:219], v[42:45], v[180:183], v[216:219]
    ds_read_b128 v[200:203], v244 offset:64
    v_cvt_pk_bf16_f32 v236, v236, v237
    v_mfma_f32_16x16x32_bf16 v[220:223], v[72:75], v[180:183], v[220:223]
    s_add_u32 s53, s53, s32
    v_exp_f32 v198, v198
    v_mfma_f32_16x16x32_bf16 v[224:227], a[248:251], v[180:183], v[224:227]
    v_exp_f32 v199, v199
    v_exp_f32 v204, v204
    v_cvt_pk_bf16_f32 v184, v198, v199
    v_exp_f32 v205, v205
    ds_read_b128 v[196:199], v245 offset:0
    v_cvt_pk_bf16_f32 v187, v204, v205
    ds_read_b128 v[204:207], v245 offset:64
    s_waitcnt lgkmcnt(4)
    v_mfma_f32_16x16x32_bf16 v[212:215], v[16:19], v[184:187], v[212:215]
    s_barrier
    ds_read_b128 a[228:231], v243 offset:36864
    v_mfma_f32_16x16x32_bf16 v[216:219], v[46:49], v[184:187], v[216:219]
    ds_read_b128 a[232:235], v242 offset:36992
    ds_read_b128 a[236:239], v243 offset:36992
    v_mfma_f32_16x16x32_bf16 v[220:223], v[76:79], v[184:187], v[220:223]
    ds_read_b128 a[240:243], v242 offset:37120
    v_cvt_pk_bf16_f32 v237, v238, v239
    v_mfma_f32_16x16x32_bf16 v[224:227], a[248:251], v[184:187], v[224:227]
    s_waitcnt lgkmcnt(6)
    ds_read_b128 a[244:247], v243 offset:37120
    v_mfma_f32_16x16x32_bf16 v[208:211], v[138:141], v[174:177], v[208:211]
    ds_write_b64 v249, v[236:237] offset:18432
    v_mfma_f32_16x16x32_bf16 v[208:211], v[140:143], v[176:179], v[208:211]
    buffer_store_dwordx4 a[252:255], v250, s[20:23], s51 offen nt
    v_mfma_f32_16x16x32_bf16 v[200:203], v[114:117], v[174:177], v[200:203]
    s_waitcnt lgkmcnt(7)
    v_cvt_pk_bf16_f32 v228, v228, v229
    v_cvt_pk_bf16_f32 v229, v230, v231
    v_mfma_f32_16x16x32_bf16 v[196:199], v[144:147], v[174:177], v[196:199]
    s_waitcnt lgkmcnt(6)
    v_cvt_pk_bf16_f32 v232, v232, v233
    v_cvt_pk_bf16_f32 v233, v234, v235
    v_mfma_f32_16x16x32_bf16 v[196:199], v[146:149], v[176:179], v[196:199]
    ds_read_b128 a[252:255], v252 offset:0
    v_mov_b32 v190, 0
    v_mfma_f32_16x16x32_bf16 v[200:203], v[116:119], v[176:179], v[200:203]
    ds_write_b64 v249, v[228:229] offset:18560
    v_mfma_f32_16x16x32_bf16 v[204:207], v[150:153], v[174:177], v[204:207]
    ds_read_b128 a[216:219], v242 offset:43008
    v_mov_b32 v193, 0
    v_mfma_f32_16x16x32_bf16 v[204:207], v[152:155], v[176:179], v[204:207]
    s_mul_i32 s56, s31, 15
    v_exp_f32 v208, v208
    v_mfma_f32_16x16x32_bf16 v[236:239], a[144:147], a[224:227], 0
    s_waitcnt lgkmcnt(8)
    v_exp_f32 v209, v209
    v_mfma_f32_16x16x32_bf16 v[236:239], a[148:151], a[228:231], v[236:239]
    s_waitcnt lgkmcnt(7)
    v_exp_f32 v210, v210
    v_mfma_f32_16x16x32_bf16 v[236:239], a[152:155], a[232:235], v[236:239]
    s_waitcnt lgkmcnt(6)
    v_exp_f32 v211, v211
    v_mfma_f32_16x16x32_bf16 v[236:239], a[156:159], a[236:239], v[236:239]
    s_waitcnt lgkmcnt(5)
    v_cvt_pk_bf16_f32 v188, v208, v209
    v_cvt_pk_bf16_f32 v191, v210, v211
    v_mfma_f32_16x16x32_bf16 v[236:239], a[160:163], a[240:243], v[236:239]
    s_waitcnt lgkmcnt(4)
    v_rcp_f32 v225, v224
    v_mfma_f32_16x16x32_bf16 v[236:239], a[164:167], a[244:247], v[236:239]
    ds_read_b128 v[208:211], v244 offset:128
    v_mul_f32 v212, v212, v225
    v_mfma_f32_16x16x32_bf16 v[228:231], a[168:171], a[224:227], 0
    ds_read_b128 a[220:223], v243 offset:43008
    v_mul_f32 v213, v213, v225
    v_mfma_f32_16x16x32_bf16 v[228:231], a[172:175], a[228:231], v[228:231]
    ds_write_b64 v249, v[232:233] offset:18688
    v_mfma_f32_16x16x32_bf16 v[228:231], a[176:179], a[232:235], v[228:231]
    buffer_store_dwordx2 v[254:255], v251, s[20:23], s51 offen offset:256 nt
    v_mfma_f32_16x16x32_bf16 v[228:231], a[180:183], a[236:239], v[228:231]
    s_waitcnt lgkmcnt(5)
    v_cvt_pk_bf16_f32 v236, v236, v237
    v_cvt_pk_bf16_f32 v237, v238, v239
    v_mfma_f32_16x16x32_bf16 v[228:231], a[184:187], a[240:243], v[228:231]
    ds_read_b64 v[254:255], v253 offset:256
    v_mul_f32 v214, v214, v225
    v_mfma_f32_16x16x32_bf16 v[228:231], a[188:191], a[244:247], v[228:231]
    ds_write_b64 v249, v[236:237] offset:24576
    v_mfma_f32_16x16x32_bf16 v[232:235], a[192:195], a[224:227], 0
    ds_read_b128 a[224:227], v242 offset:43136
    s_waitcnt lgkmcnt(6)
    v_mfma_f32_16x16x32_bf16 v[232:235], a[196:199], a[228:231], v[232:235]
    buffer_store_dwordx4 a[252:255], v250, s[20:23], s53 offen nt
    v_mfma_f32_16x16x32_bf16 v[232:235], a[200:203], a[232:235], v[232:235]
    ds_read_b128 a[228:231], v243 offset:43136
    ds_read_b128 a[252:255], v252 offset:6144
    v_mfma_f32_16x16x32_bf16 v[232:235], a[204:207], a[236:239], v[232:235]
    ds_read_b128 a[232:235], v242 offset:43264
    ds_read_b128 a[236:239], v243 offset:43264
    v_mfma_f32_16x16x32_bf16 v[232:235], a[208:211], a[240:243], v[232:235]
    s_waitcnt lgkmcnt(9)
    v_cvt_pk_bf16_f32 v228, v228, v229
    v_cvt_pk_bf16_f32 v229, v230, v231
    v_mfma_f32_16x16x32_bf16 v[208:211], v[120:123], v[174:177], v[208:211]
    s_mul_i32 s51, s31, 13
    v_mul_f32 v215, v215, v225
    v_cvt_pk_bf16_f32 v212, v212, v213
    v_mfma_f32_16x16x32_bf16 v[208:211], v[122:125], v[176:179], v[208:211]
    s_add_u32 s55, s55, s56
    v_mul_f32 v216, v216, v225
    v_mul_f32 v217, v217, v225
    v_mfma_f32_16x16x32_bf16 v[232:235], a[212:215], a[244:247], v[232:235]
    s_add_u32 s57, s57, s51
    s_add_u32 s55, s55, s32
    s_add_u32 s57, s57, s32
    v_mfma_f32_16x16x32_bf16 v[236:239], a[144:147], a[216:219], 0
    s_waitcnt lgkmcnt(6)
    v_cvt_pk_bf16_f32 v213, v214, v215
    v_mul_f32 v218, v218, v225
    v_mfma_f32_16x16x32_bf16 v[236:239], a[148:151], a[220:223], v[236:239]
    s_waitcnt lgkmcnt(4)
    v_mul_f32 v219, v219, v225
    v_cvt_pk_bf16_f32 v216, v216, v217
    v_mfma_f32_16x16x32_bf16 v[236:239], a[152:155], a[224:227], v[236:239]
    s_waitcnt lgkmcnt(3)
    v_mul_f32 v220, v220, v225
    v_mul_f32 v221, v221, v225
    v_mfma_f32_16x16x32_bf16 v[236:239], a[156:159], a[228:231], v[236:239]
    ds_write_b64 v249, v[228:229] offset:24704
    v_mfma_f32_16x16x32_bf16 v[228:231], a[168:171], a[216:219], 0
    s_waitcnt lgkmcnt(2)
    v_cvt_pk_bf16_f32 v217, v218, v219
    v_mul_f32 v222, v222, v225
    v_mfma_f32_16x16x32_bf16 v[236:239], a[160:163], a[232:235], v[236:239]
    s_mov_b32 exec_hi, 0
    buffer_store_dwordx4 a[252:255], v250, s[20:23], s55 offen nt
    s_mov_b32 exec_hi, -1
    v_mfma_f32_16x16x32_bf16 v[228:231], a[172:175], a[220:223], v[228:231]
    ds_write_b64 v247, v[212:213] offset:49152
    v_mfma_f32_16x16x32_bf16 v[228:231], a[176:179], a[224:227], v[228:231]
    s_waitcnt lgkmcnt(2)
    v_mul_f32 v223, v223, v225
    v_cvt_pk_bf16_f32 v220, v220, v221
    v_mfma_f32_16x16x32_bf16 v[236:239], a[164:167], a[236:239], v[236:239]
    s_mov_b32 exec_lo, 0
    buffer_store_dwordx4 a[252:255], v250, s[20:23], s57 offen nt
    s_mov_b32 exec_lo, -1
    v_mfma_f32_16x16x32_bf16 v[228:231], a[180:183], a[228:231], v[228:231]
    s_add_u32 s54, s28, 11
    v_cvt_pk_bf16_f32 v232, v232, v233
    v_cvt_pk_bf16_f32 v221, v222, v223
    v_mfma_f32_16x16x32_bf16 v[228:231], a[184:187], a[232:235], v[228:231]
    ds_write_b64 v247, v[216:217] offset:49280
    v_mfma_f32_16x16x32_bf16 v[228:231], a[188:191], a[236:239], v[228:231]
    buffer_store_dwordx2 v[254:255], v251, s[20:23], s53 offen offset:256 nt
    v_cvt_pk_bf16_f32 v233, v234, v235
    ds_write_b64 v247, v[220:221] offset:49408
    ds_read_b64 v[254:255], v253 offset:6400
    ds_read_b128 a[252:255], v252 offset:12288
    ds_write_b64 v249, v[232:233] offset:24832
    v_mfma_f32_16x16x32_bf16 v[232:235], a[192:195], a[216:219], 0
    s_mul_i32 s53, s31, 3
    v_exp_f32 v196, v196
    v_mfma_f32_16x16x32_bf16 v[232:235], a[196:199], a[220:223], v[232:235]
    s_add_u32 s52, s52, s53
    v_exp_f32 v197, v197
    v_mfma_f32_16x16x32_bf16 v[232:235], a[200:203], a[224:227], v[232:235]
    s_add_u32 s52, s52, s32
    v_exp_f32 v198, v198
    v_mfma_f32_16x16x32_bf16 v[232:235], a[204:207], a[228:231], v[232:235]
    s_mul_i32 s54, s54, s30
    v_exp_f32 v199, v199
    v_mfma_f32_16x16x32_bf16 v[232:235], a[208:211], a[232:235], v[232:235]
    s_add_u32 s56, s28, 11
    v_cvt_pk_bf16_f32 v189, v196, v197
    v_cvt_pk_bf16_f32 v192, v198, v199
    v_mfma_f32_16x16x32_bf16 v[232:235], a[212:215], a[236:239], v[232:235]
    ds_read_b128 v[196:199], v245 offset:128
    v_max3_f32 v248, v248, v224, v225
    v_mfma_f32_16x16x32_bf16 v[212:215], v[12:15], v[188:191], 0
    s_mul_i32 s56, s56, s30
    s_waitcnt lgkmcnt(3)
    v_cvt_pk_bf16_f32 v236, v236, v237
    v_mfma_f32_16x16x32_bf16 v[216:219], v[42:45], v[188:191], 0
    s_mov_b32 exec_hi, 0
    buffer_store_dwordx2 v[254:255], v251, s[20:23], s55 offen offset:256 nt
    s_mov_b32 exec_hi, -1
    v_mfma_f32_16x16x32_bf16 v[220:223], v[72:75], v[188:191], 0
    s_mul_i32 s55, s31, 7
    v_cvt_pk_bf16_f32 v237, v238, v239
    s_waitcnt lgkmcnt(1)
    v_mfma_f32_16x16x32_bf16 v[224:227], a[248:251], v[188:191], 0
    s_barrier
    ds_read_b128 a[240:243], v242 offset:49152
    ds_read_b128 a[244:247], v243 offset:49152
    ds_read_b128 a[216:219], v242 offset:49280
    ds_read_b128 a[220:223], v243 offset:49280
    s_mov_b32 exec_lo, 0
    buffer_store_dwordx2 v[254:255], v251, s[20:23], s57 offen offset:256 nt
    s_mov_b32 exec_lo, -1
    ds_read_b64 v[254:255], v253 offset:12544
    ds_read_b128 a[224:227], v242 offset:49408
    ds_read_b128 a[228:231], v243 offset:49408
    ds_write_b64 v249, v[236:237] offset:0
    s_waitcnt lgkmcnt(8)
    v_mfma_f32_16x16x32_bf16 v[196:199], v[156:159], v[174:177], v[196:199]
    s_add_u32 s54, s54, s55
    v_cvt_pk_bf16_f32 v228, v228, v229
    v_cvt_pk_bf16_f32 v229, v230, v231
    v_mfma_f32_16x16x32_bf16 v[196:199], v[158:161], v[176:179], v[196:199]
    buffer_store_dwordx4 a[252:255], v250, s[20:23], s52 offen nt
    ds_write_b64 v249, v[228:229] offset:128
    s_waitcnt lgkmcnt(8)
    v_mfma_f32_16x16x32_bf16 v[236:239], a[144:147], a[240:243], 0
    ds_read_b128 a[252:255], v252 offset:18432
    s_waitcnt lgkmcnt(8)
    v_mfma_f32_16x16x32_bf16 v[236:239], a[148:151], a[244:247], v[236:239]
    s_add_u32 s54, s54, s32
    v_exp_f32 v200, v200
    v_mfma_f32_16x16x32_bf16 v[228:231], a[168:171], a[240:243], 0
    s_waitcnt lgkmcnt(7)
    v_exp_f32 v201, v201
    v_mfma_f32_16x16x32_bf16 v[236:239], a[152:155], a[216:219], v[236:239]
    s_waitcnt lgkmcnt(5)
    v_exp_f32 v204, v204
    v_mfma_f32_16x16x32_bf16 v[236:239], a[156:159], a[220:223], v[236:239]
    s_waitcnt lgkmcnt(4)
    v_exp_f32 v205, v205
    v_mfma_f32_16x16x32_bf16 v[236:239], a[160:163], a[224:227], v[236:239]
    s_waitcnt lgkmcnt(3)
    v_exp_f32 v202, v202
    v_mfma_f32_16x16x32_bf16 v[236:239], a[164:167], a[228:231], v[236:239]
    s_mul_i32 s57, s31, 11
    v_exp_f32 v203, v203
    v_mfma_f32_16x16x32_bf16 v[228:231], a[172:175], a[244:247], v[228:231]
    s_add_u32 s56, s56, s57
    v_exp_f32 v206, v206
    v_mfma_f32_16x16x32_bf16 v[228:231], a[176:179], a[216:219], v[228:231]
    s_add_u32 s56, s56, s32
    v_exp_f32 v207, v207
    v_mfma_f32_16x16x32_bf16 v[228:231], a[180:183], a[220:223], v[228:231]
    s_waitcnt lgkmcnt(0)
    v_exp_f32 v208, v208
    v_mfma_f32_16x16x32_bf16 v[228:231], a[184:187], a[224:227], v[228:231]
    s_add_u32 s51, s28, 11
    v_exp_f32 v209, v209
    v_mfma_f32_16x16x32_bf16 v[228:231], a[188:191], a[228:231], v[228:231]
    v_exp_f32 v210, v210
    v_exp_f32 v211, v211
    v_exp_f32 v196, v196
    v_exp_f32 v197, v197
    v_cvt_pk_bf16_f32 v194, v200, v201
    v_cvt_pk_bf16_f32 v195, v204, v205
    v_exp_f32 v198, v198
    v_exp_f32 v199, v199
    v_mfma_f32_16x16x32_bf16 v[212:215], v[16:19], v[192:195], v[212:215]
    s_mul_i32 s51, s51, s30
    v_cvt_pk_bf16_f32 v181, v202, v203
    v_cvt_pk_bf16_f32 v182, v206, v207
    v_mfma_f32_16x16x32_bf16 v[216:219], v[46:49], v[192:195], v[216:219]
    s_and_b32 s53, s28, 1
    v_mov_b32 v180, 0
    v_mov_b32 v183, 0
    v_mfma_f32_16x16x32_bf16 v[220:223], v[76:79], v[192:195], v[220:223]
    s_add_u32 s53, s53, 15
    v_cvt_pk_bf16_f32 v184, v208, v209
    v_cvt_pk_bf16_f32 v187, v210, v211
    v_mfma_f32_16x16x32_bf16 v[224:227], a[248:251], v[192:195], v[224:227]
    s_mul_i32 s53, s53, s30
    v_cvt_pk_bf16_f32 v185, v196, v197
    v_mov_b32 v186, 0
    v_mfma_f32_16x16x32_bf16 v[212:215], v[20:23], v[180:183], v[212:215]
    s_lshr_b32 s57, s28, 1
    v_cvt_pk_bf16_f32 v188, v198, v199
    v_mov_b32 v189, 0
    v_mfma_f32_16x16x32_bf16 v[216:219], v[50:53], v[180:183], v[216:219]
    s_lshl2_add_u32 s57, s57, 11
    v_mov_b32 v191, 0
    v_cvt_pk_bf16_f32 v232, v232, v233
    v_mfma_f32_16x16x32_bf16 v[220:223], v[80:83], v[180:183], v[220:223]
    buffer_store_dwordx2 v[254:255], v251, s[20:23], s52 offen offset:256 nt
    v_mfma_f32_16x16x32_bf16 v[224:227], a[248:251], v[180:183], v[224:227]
    ds_read_b64 v[254:255], v253 offset:18688
    v_cvt_pk_bf16_f32 v233, v234, v235
    v_mfma_f32_16x16x32_bf16 v[212:215], v[24:27], v[184:187], v[212:215]
    ds_write_b64 v249, v[232:233] offset:256
    v_mfma_f32_16x16x32_bf16 v[216:219], v[54:57], v[184:187], v[216:219]
L_h9:
    s_cbranch_execz L_hback
    s_mul_i32 s52, s31, 15
    v_cvt_pk_bf16_f32 v236, v236, v237
    v_cvt_pk_bf16_f32 v228, v228, v229
    v_mfma_f32_16x16x32_bf16 v[220:223], v[84:87], v[184:187], v[220:223]
    s_add_u32 s51, s51, s52
    v_cvt_pk_bf16_f32 v237, v238, v239
    v_cvt_pk_bf16_f32 v229, v230, v231
    v_mfma_f32_16x16x32_bf16 v[224:227], a[248:251], v[184:187], v[224:227]
    ds_write_b64 v249, v[236:237] offset:6144
    v_mfma_f32_16x16x32_bf16 v[212:215], v[28:31], v[188:191], v[212:215]
    ds_write_b64 v249, v[228:229] offset:6272
    v_mfma_f32_16x16x32_bf16 v[216:219], v[58:61], v[188:191], v[216:219]
    buffer_store_dwordx4 a[252:255], v250, s[20:23], s54 offen nt
    v_mfma_f32_16x16x32_bf16 v[220:223], v[88:91], v[188:191], v[220:223]
    s_waitcnt lgkmcnt(3)
    ds_read_b128 a[252:255], v252 offset:24576
    v_mfma_f32_16x16x32_bf16 v[224:227], a[248:251], v[188:191], v[224:227]
    s_add_u32 s51, s51, s32
    s_mul_i32 s57, s57, s31
    s_lshr_b32 s55, s28, 1
    v_mfma_f32_16x16x32_bf16 v[232:235], a[192:195], a[240:243], 0
    buffer_store_dwordx2 v[254:255], v251, s[20:23], s54 offen offset:256 nt
    v_mfma_f32_16x16x32_bf16 v[232:235], a[196:199], a[244:247], v[232:235]
    ds_read_b64 v[254:255], v253 offset:24832
    s_lshr_b32 s54, s28, 1
    v_mfma_f32_16x16x32_bf16 v[232:235], a[200:203], a[216:219], v[232:235]
    s_lshl2_add_u32 s54, s54, 3
    v_rcp_f32 v225, v224
    v_mfma_f32_16x16x32_bf16 v[232:235], a[204:207], a[220:223], v[232:235]
    s_mul_i32 s54, s54, s31
    v_max3_f32 v248, v248, v224, v225
    v_mov_b32 v226, 0x5d800000
    v_mfma_f32_16x16x32_bf16 v[232:235], a[208:211], a[224:227], v[232:235]
    s_add_u32 s53, s53, s54
    v_cmp_gt_f32 vcc, v248, v226
    v_mul_f32 v212, v212, v225
    v_mfma_f32_16x16x32_bf16 v[232:235], a[212:215], a[228:231], v[232:235]
    v_mul_f32 v213, v213, v225
    v_mul_f32 v214, v214, v225
    v_mul_f32 v215, v215, v225
    v_cvt_pk_bf16_f32 v212, v212, v213
    v_mul_f32 v216, v216, v225
    v_mul_f32 v217, v217, v225
    v_cvt_pk_bf16_f32 v213, v214, v215
    v_mul_f32 v218, v218, v225
    v_mul_f32 v219, v219, v225
    v_cvt_pk_bf16_f32 v216, v216, v217
    v_mul_f32 v220, v220, v225
    v_mul_f32 v221, v221, v225
    ds_write_b64 v247, v[212:213] offset:55296
    v_cvt_pk_bf16_f32 v217, v218, v219
    v_mul_f32 v222, v222, v225
    v_mul_f32 v223, v223, v225
    v_cvt_pk_bf16_f32 v220, v220, v221
    s_cmp_lg_u64 vcc, 0
    s_cselect_b32 s66, 1, 0
    v_cvt_pk_bf16_f32 v232, v232, v233
    ds_write_b64 v247, v[216:217] offset:55424
    v_cvt_pk_bf16_f32 v221, v222, v223
    v_mov_b32 v225, s66
    v_mov_b32 v226, s67
    v_cvt_pk_bf16_f32 v233, v234, v235
    ds_write_b64 v247, v[220:221] offset:55552
    ds_write_b32 v226, v225 offset:0
    ds_write_b64 v249, v[232:233] offset:6400
    s_waitcnt lgkmcnt(5)
    buffer_store_dwordx4 a[252:255], v250, s[20:23], s56 offen nt
    s_add_u32 s53, s53, s32
    v_mov_b32 v226, 0x23000
    s_sub_u32 s55, s55, 1
    buffer_store_dwordx2 v[254:255], v251, s[20:23], s56 offen offset:256 nt
    s_and_b32 s56, s28, 1
    s_add_u32 s56, s56, 15
    s_mul_i32 s56, s56, s30
    s_add_u32 s56, s56, s57
    s_add_u32 s56, s56, s32
    s_waitcnt lgkmcnt(0)
    s_barrier
    ds_read_b128 a[232:235], v242 offset:55296
    ds_read_b128 a[236:239], v243 offset:55296
    ds_read_b128 a[240:243], v242 offset:55424
    ds_read_b128 a[244:247], v243 offset:55424
    ds_read_b128 a[216:219], v242 offset:55552
    ds_read_b128 a[220:223], v243 offset:55552
    ds_read_b128 a[252:255], v252 offset:0
    ds_read_b64 v[254:255], v253 offset:256
    ds_read_b128 v[196:199], v226 offset:0
    s_waitcnt lgkmcnt(8)
    v_mfma_f32_16x16x32_bf16 v[236:239], a[144:147], a[232:235], 0
    v_mfma_f32_16x16x32_bf16 v[228:231], a[168:171], a[232:235], 0
    s_waitcnt lgkmcnt(7)
    v_mfma_f32_16x16x32_bf16 v[236:239], a[148:151], a[236:239], v[236:239]
    s_waitcnt lgkmcnt(6)
    v_mfma_f32_16x16x32_bf16 v[236:239], a[152:155], a[240:243], v[236:239]
    s_waitcnt lgkmcnt(5)
    v_mfma_f32_16x16x32_bf16 v[236:239], a[156:159], a[244:247], v[236:239]
    s_waitcnt lgkmcnt(4)
    v_mfma_f32_16x16x32_bf16 v[236:239], a[160:163], a[216:219], v[236:239]
    s_waitcnt lgkmcnt(3)
    v_mfma_f32_16x16x32_bf16 v[236:239], a[164:167], a[220:223], v[236:239]
    s_waitcnt lgkmcnt(1)
    v_mfma_f32_16x16x32_bf16 v[228:231], a[172:175], a[236:239], v[228:231]
    s_mov_b32 exec_hi, 0
    buffer_store_dwordx4 a[252:255], v250, s[20:23], s51 offen nt
    s_mov_b32 exec_hi, -1
    v_mfma_f32_16x16x32_bf16 v[228:231], a[176:179], a[240:243], v[228:231]
    v_mfma_f32_16x16x32_bf16 v[228:231], a[180:183], a[244:247], v[228:231]
    ds_read_b128 a[252:255], v252 offset:6144
    v_mfma_f32_16x16x32_bf16 v[228:231], a[184:187], a[216:219], v[228:231]
    s_mov_b32 exec_hi, 0
    buffer_store_dwordx2 v[254:255], v251, s[20:23], s51 offen offset:256 nt
    s_mov_b32 exec_hi, -1
    v_mfma_f32_16x16x32_bf16 v[228:231], a[188:191], a[220:223], v[228:231]
    ds_read_b64 v[254:255], v253 offset:6400
    v_cvt_pk_bf16_f32 v236, v236, v237
    v_mfma_f32_16x16x32_bf16 v[232:235], a[192:195], a[232:235], 0
    s_waitcnt lgkmcnt(2)
    v_cvt_pk_bf16_f32 v237, v238, v239
    v_or3_b32 v225, v196, v197, v198
    v_mfma_f32_16x16x32_bf16 v[232:235], a[196:199], a[236:239], v[232:235]
    ds_write_b64 v249, v[236:237] offset:12288
    v_mfma_f32_16x16x32_bf16 v[232:235], a[200:203], a[240:243], v[232:235]
    v_cvt_pk_bf16_f32 v228, v228, v229
    v_cvt_pk_bf16_f32 v229, v230, v231
    v_mfma_f32_16x16x32_bf16 v[232:235], a[204:207], a[244:247], v[232:235]
    ds_write_b64 v249, v[228:229] offset:12416
    v_mfma_f32_16x16x32_bf16 v[232:235], a[208:211], a[216:219], v[232:235]
    v_or_b32 v225, v225, v199
    s_waitcnt lgkmcnt(3)
    v_mfma_f32_16x16x32_bf16 v[232:235], a[212:215], a[220:223], v[232:235]
    buffer_store_dwordx4 a[252:255], v250, s[20:23], s53 offen nt
    v_readfirstlane_b32 s47, v225
    s_waitcnt lgkmcnt(2)
    s_nop 4
    v_cvt_pk_bf16_f32 v232, v232, v233
    v_cvt_pk_bf16_f32 v233, v234, v235
    ds_write_b64 v249, v[232:233] offset:12544
    buffer_store_dwordx2 v[254:255], v251, s[20:23], s53 offen offset:256 nt
    s_waitcnt lgkmcnt(0)
    s_barrier
    ds_read_b128 a[252:255], v252 offset:12288
    ds_read_b64 v[254:255], v253 offset:12544
    s_waitcnt lgkmcnt(1)
    s_mov_b32 exec_hi, s55
    buffer_store_dwordx4 a[252:255], v250, s[20:23], s56 offen nt
    s_mov_b32 exec_hi, -1
    s_waitcnt lgkmcnt(0)
    s_mov_b32 exec_hi, s55
    buffer_store_dwordx2 v[254:255], v251, s[20:23], s56 offen offset:256 nt
    s_mov_b32 exec_hi, -1
    s_nop 4
    s_cmp_lg_u32 s47, 0
    s_cbranch_scc1 L_safe
L_exit:
    s_endpgm
L_safe:
    s_waitcnt vmcnt(0) lgkmcnt(0)
    s_nop 7
    s_barrier
    v_mbcnt_lo_u32_b32 v1, -1, 0
    v_mbcnt_hi_u32_b32 v1, -1, v1
    s_lshl_b32 s51, s28, 1
    s_add_u32 s50, s31, 0xfffffe80
    s_mul_i32 s52, s36, 0x1d00
    v_lshrrev_b32 v2, 3, v1
    v_and_b32 v3, 7, v1
    v_xor_b32 v3, s51, v3
    v_lshl_add_u32 v4, v2, 7, s52
    v_mul_u32_u24 v8, 11, v2
    v_bfe_u32 v9, v8, 6, 1
    v_lshrrev_b32 v8, 5, v8
    v_xor_b32 v9, v3, v9
    v_mad_i32_i24 v8, v8, s50, v4
    v_lshl_add_u32 v168, v9, 4, v8
    v_add_u32 v8, 8, v2
    v_mul_u32_u24 v8, 11, v8
    v_bfe_u32 v9, v8, 6, 1
    v_lshrrev_b32 v8, 5, v8
    v_xor_b32 v9, v3, v9
    v_mad_i32_i24 v8, v8, s50, v4
    v_lshl_add_u32 v169, v9, 4, v8
    v_add_u32 v8, 16, v2
    v_mul_u32_u24 v8, 11, v8
    v_bfe_u32 v9, v8, 6, 1
    v_lshrrev_b32 v8, 5, v8
    v_xor_b32 v9, v3, v9
    v_mad_i32_i24 v8, v8, s50, v4
    v_lshl_add_u32 v170, v9, 4, v8
    s_movk_i32 s53, 0x480
    s_movk_i32 s54, -96
    v_lshrrev_b32 v10, 1, v1
    v_lshlrev_b32 v12, 4, v1
    v_mul_u32_u24 v8, 43, v10
    v_lshrrev_b32 v9, 8, v8
    v_lshrrev_b32 v8, 7, v8
    v_and_b32 v9, 4, v9
    v_xor_b32 v9, v8, v9
    v_mad_i32_i24 v8, v8, s54, v12
    v_mad_u32_u24 v172, v9, s53, v8
    v_add_u32 v8, 32, v10
    v_mul_u32_u24 v8, 43, v8
    v_lshrrev_b32 v9, 8, v8
    v_lshrrev_b32 v8, 7, v8
    v_and_b32 v9, 4, v9
    v_xor_b32 v9, v8, v9
    v_mad_i32_i24 v8, v8, s54, v12
    v_mad_u32_u24 v173, v9, s53, v8
    v_add_u32 v8, 64, v10
    v_mul_u32_u24 v8, 43, v8
    v_lshrrev_b32 v9, 8, v8
    v_lshrrev_b32 v8, 7, v8
    v_and_b32 v9, 4, v9
    v_xor_b32 v9, v8, v9
    v_mad_i32_i24 v8, v8, s54, v12
    v_mad_u32_u24 v174, v9, s53, v8
L_safe2:
    s_add_u32 s59, s40, s45
    s_add_u32 m0, s46, 0xc00
    s_add_u32 s60, s39, 0x180
    buffer_load_dwordx4 v168, s[4:7], s59 offen lds
    s_add_u32 m0, s29, 0
    s_add_u32 s52, s40, 0
    buffer_load_dwordx4 v172, s[8:11], s60 offen lds
    s_add_u32 m0, s46, 0xc00
    v_add_u32 v5, s52, v168
    buffer_load_dwordx4 v169, s[4:7], s59 offen offset:1024 lds
    s_add_u32 m0, s29, 0
    v_max_i32 v5, 0, v5
    buffer_load_dwordx4 v173, s[8:11], s60 offen offset:1024 lds
    s_add_u32 m0, s46, 0xc00
    s_add_u32 s53, s40, 0x400
    buffer_load_dwordx4 v170, s[4:7], s59 offen offset:2048 lds
    s_add_u32 m0, s29, 0
    v_add_u32 v6, s53, v169
    buffer_load_dwordx4 v174, s[8:11], s60 offen offset:2048 lds
    s_add_u32 m0, s46, 0
    v_max_i32 v6, 0, v6
    buffer_load_dwordx4 v5, s[4:7], 0 offen lds
    s_add_u32 m0, s46, 0x400
    s_add_u32 s54, s40, 0x800
    buffer_load_dwordx4 v6, s[4:7], 0 offen lds
    v_add_u32 v7, s54, v170
    v_max_i32 v7, 0, v7
    s_add_u32 m0, s46, 0x800
    s_add_u32 s61, s39, 0x9180
    buffer_load_dwordx4 v7, s[4:7], 0 offen lds
    s_add_u32 m0, s29, 0xc00
    s_add_u32 s62, s39, 0x12180
    buffer_load_dwordx4 v172, s[8:11], s61 offen lds
    buffer_load_dwordx4 v173, s[8:11], s61 offen offset:1024 lds
    buffer_load_dwordx4 v174, s[8:11], s61 offen offset:2048 lds
    s_add_u32 m0, s29, 0x1800
    s_add_u32 s63, s39, 0x1b180
    s_add_u32 s59, s41, s45
    s_add_u32 s60, s39, 0x24180
    s_add_u32 s61, s39, 0x2d180
    s_and_b32 s65, s48, 0xfff0
    s_lshl1_add_u32 s58, s45, s40
    v_and_b32 v13, 15, v1
    v_lshrrev_b32 v14, 4, v1
    v_lshrrev_b32 v15, 2, v13
    v_and_b32 v16, 3, v13
    v_and_b32 v17, 1, v14
    v_lshl_add_u32 v18, v14, 3, v15
    v_xor_b32 v19, 0, v17
    v_lshl_add_u32 v19, v19, 2, v18
    v_mul_u32_u24 v19, 0x60, v19
    v_lshl_add_u32 v19, v16, 3, v19
    v_add_u32 v249, s29, v19
    v_xor_b32 v19, 1, v17
    v_lshl_add_u32 v19, v19, 2, v18
    v_mul_u32_u24 v19, 0x60, v19
    v_lshl_add_u32 v19, v16, 3, v19
    v_add_u32 v250, s29, v19
    v_mov_b32 v17, v15
    v_and_b32 v18, 3, v17
    v_mul_u32_u24 v17, 0x1e00, v17
    v_lshlrev_b32 v18, 1, v18
    v_bfe_u32 v241, v16, 1, 1
    v_or_b32 v18, v18, v241
    v_xor_b32 v18, v18, v14
    v_lshl_add_u32 v17, v18, 4, v17
    v_mul_u32_u24 v18, 0x180, v16
    v_add_u32 v240, v17, v18
    v_xor_b32 v241, 64, v240
    s_add_u32 s55, s28, 3
    s_mul_i32 s56, s31, 3
    s_mul_i32 s55, s55, s30
    s_add_u32 s55, s55, s56
    s_add_u32 s55, s55, s32
    s_add_u32 s57, s28, 3
    s_mul_i32 s51, s31, 7
    s_mul_i32 s57, s57, s30
    s_add_u32 s57, s57, s51
    s_add_u32 s57, s57, s32
    s_add_u32 s52, s28, 3
    s_mul_i32 s53, s31, 11
    s_mul_i32 s52, s52, s30
    s_add_u32 s52, s52, s53
    s_add_u32 s52, s52, s32
    s_add_u32 s54, s28, 7
    s_mul_i32 s54, s54, s30
    s_add_u32 s56, s28, 7
    s_mul_i32 s56, s56, s30
    s_add_u32 s51, s28, 7
    s_mul_i32 s51, s51, s30
    s_add_u32 s53, s28, 3
    s_mul_i32 s53, s53, s30
    buffer_load_dwordx4 v172, s[8:11], s62 offen lds
    buffer_load_dwordx4 v173, s[8:11], s62 offen offset:1024 lds
    buffer_load_dwordx4 v174, s[8:11], s62 offen offset:2048 lds
    s_add_u32 m0, s46, 0x7800
    s_add_u32 s62, s39, 0x300
    buffer_load_dwordx4 v168, s[4:7], s41 offen lds
    buffer_load_dwordx4 v169, s[4:7], s41 offen offset:1024 lds
    s_waitcnt vmcnt(12)
    s_barrier
    ds_read_b128 a[216:219], v240 offset:3072
    ds_read_b128 a[220:223], v240 offset:4608
    ds_read_b128 a[240:243], v241 offset:3072
    ds_read_b128 a[244:247], v241 offset:4608
    buffer_load_dwordx4 v170, s[4:7], s41 offen offset:2048 lds
    s_add_u32 m0, s29, 0x2400
    s_waitcnt vmcnt(12)
    ds_read_b64_tr_b16 a[0:1], v249 offset:0
    ds_read_b64_tr_b16 a[2:3], v250 offset:0
    ds_read_b64_tr_b16 a[24:25], v249 offset:32
    ds_read_b64_tr_b16 a[26:27], v250 offset:32
    ds_read_b64_tr_b16 a[48:49], v249 offset:64
    ds_read_b64_tr_b16 a[50:51], v250 offset:64
    buffer_load_dwordx4 v172, s[8:11], s63 offen lds
    buffer_load_dwordx4 v173, s[8:11], s63 offen offset:1024 lds
    s_waitcnt lgkmcnt(4)
    v_mfma_f32_16x16x32_bf16 v[180:183], a[0:3], a[216:219], 0
    v_mfma_f32_16x16x32_bf16 v[192:195], a[0:3], a[220:223], 0
    s_waitcnt lgkmcnt(2)
    v_mfma_f32_16x16x32_bf16 v[184:187], a[24:27], a[216:219], 0
    s_waitcnt lgkmcnt(0)
    v_mfma_f32_16x16x32_bf16 v[188:191], a[48:51], a[216:219], 0
    buffer_load_dwordx4 v174, s[8:11], s63 offen offset:2048 lds
    s_add_u32 m0, s46, 0x8400
    v_mfma_f32_16x16x32_bf16 v[196:199], a[24:27], a[220:223], 0
    s_add_u32 s63, s39, 0x9300
    s_waitcnt vmcnt(12)
    s_barrier
    v_mfma_f32_16x16x32_bf16 v[200:203], a[48:51], a[220:223], 0
    ds_read_b128 a[224:227], v240 offset:0
    ds_read_b128 a[228:231], v240 offset:1536
    ds_read_b128 a[232:235], v241 offset:0
    ds_read_b128 a[236:239], v241 offset:1536
    ds_read_b128 a[216:219], v240 offset:128
    ds_read_b128 a[220:223], v240 offset:1664
    buffer_load_dwordx4 v168, s[4:7], s59 offen lds
    buffer_load_dwordx4 v169, s[4:7], s59 offen offset:1024 lds
    s_waitcnt lgkmcnt(5)
    v_mfma_f32_16x16x32_bf16 v[204:207], a[0:3], a[224:227], 0
    v_mfma_f32_16x16x32_bf16 v[208:211], a[24:27], a[224:227], 0
    s_waitcnt lgkmcnt(4)
    v_mfma_f32_16x16x32_bf16 v[212:215], a[48:51], a[224:227], 0
    ds_read_b128 a[224:227], v240 offset:3200
    buffer_load_dwordx4 v170, s[4:7], s59 offen offset:2048 lds
    v_mfma_f32_16x16x32_bf16 v[216:219], a[0:3], a[228:231], 0
    s_add_u32 m0, s29, 0
    s_add_u32 s59, s42, s45
    s_waitcnt vmcnt(12)
    v_mfma_f32_16x16x32_bf16 v[220:223], a[24:27], a[228:231], 0
    ds_read_b64_tr_b16 a[4:5], v249 offset:3072
    ds_read_b64_tr_b16 a[6:7], v250 offset:3072
    v_mfma_f32_16x16x32_bf16 v[224:227], a[48:51], a[228:231], 0
    ds_read_b64_tr_b16 a[28:29], v249 offset:3104
    ds_read_b64_tr_b16 a[30:31], v250 offset:3104
    ds_read_b64_tr_b16 a[52:53], v249 offset:3136
    ds_read_b64_tr_b16 a[54:55], v250 offset:3136
    ds_read_b128 a[228:231], v240 offset:4736
    buffer_load_dwordx4 v172, s[8:11], s60 offen lds
    buffer_load_dwordx4 v173, s[8:11], s60 offen offset:1024 lds
    s_waitcnt lgkmcnt(5)
    v_mfma_f32_16x16x32_bf16 v[204:207], a[4:7], a[232:235], v[204:207]
    v_mfma_f32_16x16x32_bf16 v[216:219], a[4:7], a[236:239], v[216:219]
    s_waitcnt lgkmcnt(3)
    v_mfma_f32_16x16x32_bf16 v[208:211], a[28:31], a[232:235], v[208:211]
    s_waitcnt lgkmcnt(1)
    v_mfma_f32_16x16x32_bf16 v[212:215], a[52:55], a[232:235], v[212:215]
    buffer_load_dwordx4 v174, s[8:11], s60 offen offset:2048 lds
    s_add_u32 m0, s29, 0xc00
    v_mfma_f32_16x16x32_bf16 v[220:223], a[28:31], a[236:239], v[220:223]
    s_add_u32 s60, s39, 0x12300
    s_waitcnt vmcnt(12)
    v_mfma_f32_16x16x32_bf16 v[224:227], a[52:55], a[236:239], v[224:227]
    ds_read_b64_tr_b16 a[8:9], v249 offset:6144
    ds_read_b64_tr_b16 a[10:11], v250 offset:6144
    v_mfma_f32_16x16x32_bf16 v[180:183], a[4:7], a[240:243], v[180:183]
    ds_read_b64_tr_b16 a[32:33], v249 offset:6176
    ds_read_b64_tr_b16 a[34:35], v250 offset:6176
    v_mfma_f32_16x16x32_bf16 v[184:187], a[28:31], a[240:243], v[184:187]
    buffer_load_dwordx4 v172, s[8:11], s61 offen lds
    ds_read_b64_tr_b16 a[56:57], v249 offset:6208
    v_mfma_f32_16x16x32_bf16 v[188:191], a[52:55], a[240:243], v[188:191]
    ds_read_b64_tr_b16 a[58:59], v250 offset:6208
    v_mfma_f32_16x16x32_bf16 v[192:195], a[4:7], a[244:247], v[192:195]
    v_mfma_f32_16x16x32_bf16 v[196:199], a[28:31], a[244:247], v[196:199]
    v_mfma_f32_16x16x32_bf16 v[200:203], a[52:55], a[244:247], v[200:203]
    buffer_load_dwordx4 v173, s[8:11], s61 offen offset:1024 lds
    s_waitcnt lgkmcnt(4)
    v_mfma_f32_16x16x32_bf16 v[204:207], a[8:11], a[216:219], v[204:207]
    v_mfma_f32_16x16x32_bf16 v[216:219], a[8:11], a[220:223], v[216:219]
    s_waitcnt lgkmcnt(2)
    v_mfma_f32_16x16x32_bf16 v[208:211], a[32:35], a[216:219], v[208:211]
    buffer_load_dwordx4 v174, s[8:11], s61 offen offset:2048 lds
    s_add_u32 m0, s37, 0xd80
    v_mfma_f32_16x16x32_bf16 v[220:223], a[32:35], a[220:223], v[220:223]
    s_add_u32 s61, s39, 0x1b300
    s_waitcnt vmcnt(12) lgkmcnt(0)
    s_barrier
    v_mfma_f32_16x16x32_bf16 v[212:215], a[56:59], a[216:219], v[212:215]
    ds_read_b128 a[232:235], v240 offset:30720
    ds_read_b128 a[236:239], v240 offset:32256
    v_mfma_f32_16x16x32_bf16 v[224:227], a[56:59], a[220:223], v[224:227]
    ds_read_b128 a[240:243], v241 offset:30720
    ds_read_b128 a[244:247], v241 offset:32256
    v_mfma_f32_16x16x32_bf16 v[180:183], a[8:11], a[224:227], v[180:183]
    buffer_load_dwordx4 v12, s[16:19], s65 offen lds
    s_add_u32 m0, s29, 0x1800
    v_mfma_f32_16x16x32_bf16 v[184:187], a[32:35], a[224:227], v[184:187]
    ds_read_b128 a[216:219], v240 offset:30848
    ds_read_b128 a[220:223], v240 offset:32384
    v_mfma_f32_16x16x32_bf16 v[188:191], a[56:59], a[224:227], v[188:191]
    ds_read_b128 a[224:227], v241 offset:128
    v_mfma_f32_16x16x32_bf16 v[192:195], a[8:11], a[228:231], v[192:195]
    v_mfma_f32_16x16x32_bf16 v[196:199], a[32:35], a[228:231], v[196:199]
    buffer_load_dwordx4 v172, s[8:11], s62 offen lds
    v_mfma_f32_16x16x32_bf16 v[200:203], a[56:59], a[228:231], v[200:203]
    ds_read_b128 a[228:231], v241 offset:1664
    s_waitcnt lgkmcnt(7)
    v_mfma_f32_16x16x32_bf16 v[228:231], a[0:3], a[232:235], 0
    v_mfma_f32_16x16x32_bf16 v[232:235], a[24:27], a[232:235], 0
    s_waitcnt lgkmcnt(6)
    v_mfma_f32_16x16x32_bf16 v[236:239], a[48:51], a[232:235], 0
    buffer_load_dwordx4 v173, s[8:11], s62 offen offset:1024 lds
    s_waitcnt vmcnt(12) lgkmcnt(5)
    v_mfma_f32_16x16x32_bf16 v[138:141], a[0:3], a[236:239], 0
    ds_read_b64_tr_b16 a[12:13], v249 offset:9216
    ds_read_b64_tr_b16 a[14:15], v250 offset:9216
    v_mfma_f32_16x16x32_bf16 v[142:145], a[24:27], a[236:239], 0
    ds_read_b64_tr_b16 a[36:37], v249 offset:9248
    ds_read_b64_tr_b16 a[38:39], v250 offset:9248
    v_mfma_f32_16x16x32_bf16 v[146:149], a[48:51], a[236:239], 0
    ds_read_b64_tr_b16 a[60:61], v249 offset:9280
    ds_read_b64_tr_b16 a[62:63], v250 offset:9280
    v_mfma_f32_16x16x32_bf16 v[228:231], a[4:7], a[240:243], v[228:231]
    ds_read_b128 a[232:235], v241 offset:3200
    buffer_load_dwordx4 v174, s[8:11], s62 offen offset:2048 lds
    v_mfma_f32_16x16x32_bf16 v[232:235], a[28:31], a[240:243], v[232:235]
    s_add_u32 m0, s29, 0x2400
    s_add_u32 s62, s39, 0x24300
    s_add_u32 s50, s31, 0xfffffe80
    v_mfma_f32_16x16x32_bf16 v[236:239], a[52:55], a[240:243], v[236:239]
    s_waitcnt lgkmcnt(10)
    ds_read_b128 a[236:239], v241 offset:4736
    v_mfma_f32_16x16x32_bf16 v[138:141], a[4:7], a[244:247], v[138:141]
    ds_read_b128 a[240:243], v241 offset:30848
    v_add_u32 v8, 4, v2
    v_mfma_f32_16x16x32_bf16 v[142:145], a[28:31], a[244:247], v[142:145]
    s_and_b32 s66, s28, 1
    v_mul_u32_u24 v8, 11, v8
    v_bfe_u32 v9, v8, 6, 1
    v_mfma_f32_16x16x32_bf16 v[146:149], a[52:55], a[244:247], v[146:149]
    ds_read_b128 a[244:247], v241 offset:32384
    v_lshrrev_b32 v8, 5, v8
    v_mfma_f32_16x16x32_bf16 v[228:231], a[8:11], a[216:219], v[228:231]
    s_lshl_b32 s66, s66, 2
    v_xor_b32 v9, v3, v9
    v_mad_i32_i24 v8, v8, s50, v4
    v_mfma_f32_16x16x32_bf16 v[232:235], a[32:35], a[216:219], v[232:235]
    s_lshr_b32 s67, s28, 1
    v_lshl_add_u32 v171, v9, 4, v8
    s_waitcnt lgkmcnt(4)
    v_mfma_f32_16x16x32_bf16 v[236:239], a[56:59], a[216:219], v[236:239]
    buffer_load_dwordx4 v172, s[8:11], s63 offen lds
    v_mbcnt_lo_u32_b32 v67, -1, 0
    v_mfma_f32_16x16x32_bf16 v[138:141], a[8:11], a[220:223], v[138:141]
    s_waitcnt vmcnt(11) lgkmcnt(3)
    s_barrier
    v_mbcnt_hi_u32_b32 v67, -1, v67
    v_mfma_f32_16x16x32_bf16 v[142:145], a[32:35], a[220:223], v[142:145]
    ds_read_b128 a[216:219], v240 offset:33792
    v_lshrrev_b32 v68, 1, v67
    v_mfma_f32_16x16x32_bf16 v[146:149], a[56:59], a[220:223], v[146:149]
    ds_read_b128 a[220:223], v240 offset:35328
    v_add_u32 v68, 0, v68
    v_mfma_f32_16x16x32_bf16 v[204:207], a[12:15], a[224:227], v[204:207]
    buffer_load_dwordx4 v173, s[8:11], s63 offen offset:1024 lds
    v_mul_u32_u24 v69, 43, v68
    v_mfma_f32_16x16x32_bf16 v[208:211], a[36:39], a[224:227], v[208:211]
    s_lshl_b32 s67, s67, 3
    v_lshrrev_b32 v70, 8, v69
    v_lshrrev_b32 v69, 7, v69
    v_mfma_f32_16x16x32_bf16 v[212:215], a[60:63], a[224:227], v[212:215]
    ds_read_b128 a[224:227], v241 offset:33792
    v_mad_i32_i24 v68, v69, -3, v68
    v_mfma_f32_16x16x32_bf16 v[216:219], a[12:15], a[228:231], v[216:219]
    s_mul_i32 s64, s35, 0xfc0
    v_and_b32 v70, 4, v70
    v_xor_b32 v69, v69, v70
    v_mfma_f32_16x16x32_bf16 v[220:223], a[36:39], a[228:231], v[220:223]
    buffer_load_dwordx4 v174, s[8:11], s63 offen offset:2048 lds
    s_add_u32 m0, s29, 0
    v_mfma_f32_16x16x32_bf16 v[224:227], a[60:63], a[228:231], v[224:227]
    s_add_u32 s63, s39, 0x2d300
    ds_read_b128 a[228:231], v241 offset:35328
    v_mfma_f32_16x16x32_bf16 v[180:183], a[12:15], a[232:235], v[180:183]
    s_add_u32 s64, s64, s37
    v_and_b32 v70, 4, v69
    v_mul_u32_u24 v252, 24, v70
    v_mfma_f32_16x16x32_bf16 v[184:187], a[36:39], a[232:235], v[184:187]
    s_waitcnt lgkmcnt(3)
    v_lshrrev_b32 v70, 3, v69
    v_lshl_add_u32 v252, v70, 2, v252
    v_mfma_f32_16x16x32_bf16 v[188:191], a[60:63], a[232:235], v[188:191]
    ds_read_b128 a[232:235], v240 offset:33920
    v_and_or_b32 v252, v69, 3, v252
    v_mfma_f32_16x16x32_bf16 v[192:195], a[12:15], a[236:239], v[192:195]
    s_waitcnt lgkmcnt(3)
    v_mad_u32_u24 v252, v252, 3, v68
    v_and_b32 v70, 1, v67
    v_mfma_f32_16x16x32_bf16 v[196:199], a[36:39], a[236:239], v[196:199]
    s_waitcnt vmcnt(10)
    ds_read_b64_tr_b16 a[16:17], v249 offset:0
    v_mfma_f32_16x16x32_bf16 v[200:203], a[60:63], a[236:239], v[200:203]
    ds_read_b64_tr_b16 a[18:19], v250 offset:0
    ds_read_b64_tr_b16 a[40:41], v249 offset:32
    v_mfma_f32_16x16x32_bf16 v[228:231], a[12:15], a[240:243], v[228:231]
    ds_read_b64_tr_b16 a[42:43], v250 offset:32
    ds_read_b64_tr_b16 a[64:65], v249 offset:64
    v_mfma_f32_16x16x32_bf16 v[232:235], a[36:39], a[240:243], v[232:235]
    ds_read_b64_tr_b16 a[66:67], v250 offset:64
    ds_read_b128 a[236:239], v240 offset:35456
    v_mfma_f32_16x16x32_bf16 v[236:239], a[60:63], a[240:243], v[236:239]
    ds_read_b128 a[240:243], v241 offset:33920
    v_lshl_add_u32 v252, v252, 3, v70
    v_mfma_f32_16x16x32_bf16 v[138:141], a[12:15], a[244:247], v[138:141]
    v_lshlrev_b32 v252, 4, v252
    v_lshrrev_b32 v68, 1, v67
    v_mfma_f32_16x16x32_bf16 v[142:145], a[36:39], a[244:247], v[142:145]
    v_add_u32 v68, 32, v68
    v_mul_u32_u24 v69, 43, v68
    v_mfma_f32_16x16x32_bf16 v[146:149], a[60:63], a[244:247], v[146:149]
    ds_read_b128 a[244:247], v241 offset:35456
    v_lshrrev_b32 v70, 8, v69
    v_mfma_f32_16x16x32_bf16 v[150:153], a[0:3], a[216:219], 0
    s_waitcnt lgkmcnt(11)
    v_lshrrev_b32 v69, 7, v69
    v_mad_i32_i24 v68, v69, -3, v68
    v_mfma_f32_16x16x32_bf16 v[154:157], a[24:27], a[216:219], 0
    v_and_b32 v70, 4, v70
    v_xor_b32 v69, v69, v70
    v_mfma_f32_16x16x32_bf16 v[158:161], a[48:51], a[216:219], 0
    ds_read_b128 a[216:219], v240 offset:256
    v_and_b32 v70, 4, v69
    v_mfma_f32_16x16x32_bf16 v[162:165], a[0:3], a[220:223], 0
    s_waitcnt lgkmcnt(10)
    s_waitcnt lgkmcnt(4)
    v_mul_u32_u24 v253, 24, v70
    v_mfma_f32_16x16x32_bf16 v[24:27], a[24:27], a[220:223], 0
    buffer_load_dwordx4 v172, s[8:11], s60 offen lds
    v_lshrrev_b32 v70, 3, v69
    v_mfma_f32_16x16x32_bf16 v[54:57], a[48:51], a[220:223], 0
    s_waitcnt vmcnt(8)
    ds_read_b64_tr_b16 a[20:21], v249 offset:3072
    v_mfma_f32_16x16x32_bf16 v[150:153], a[4:7], a[224:227], v[150:153]
    ds_read_b64_tr_b16 a[22:23], v250 offset:3072
    ds_read_b64_tr_b16 a[44:45], v249 offset:3104
    v_mfma_f32_16x16x32_bf16 v[154:157], a[28:31], a[224:227], v[154:157]
    ds_read_b64_tr_b16 a[46:47], v250 offset:3104
    ds_read_b64_tr_b16 a[68:69], v249 offset:3136
    v_mfma_f32_16x16x32_bf16 v[158:161], a[52:55], a[224:227], v[158:161]
    buffer_load_dwordx4 v173, s[8:11], s60 offen offset:1024 lds
    ds_read_b64_tr_b16 a[70:71], v250 offset:3136
    v_mfma_f32_16x16x32_bf16 v[162:165], a[4:7], a[228:231], v[162:165]
    ds_read_b128 a[220:223], v240 offset:1792
    ds_read_b128 a[224:227], v240 offset:3328
    v_mfma_f32_16x16x32_bf16 v[24:27], a[28:31], a[228:231], v[24:27]
    s_waitcnt lgkmcnt(8)
    v_lshl_add_u32 v253, v70, 2, v253
    v_and_or_b32 v253, v69, 3, v253
    v_mfma_f32_16x16x32_bf16 v[54:57], a[52:55], a[228:231], v[54:57]
    ds_read_b128 a[228:231], v240 offset:4864
    v_mad_u32_u24 v253, v253, 3, v68
    v_mfma_f32_16x16x32_bf16 v[150:153], a[8:11], a[232:235], v[150:153]
    buffer_load_dwordx4 v174, s[8:11], s60 offen offset:2048 lds
    s_add_u32 m0, s29, 0xc00
    v_mfma_f32_16x16x32_bf16 v[154:157], a[32:35], a[232:235], v[154:157]
    s_add_u32 s60, s39, 0
    v_and_b32 v70, 1, v67
    v_lshl_add_u32 v253, v253, 3, v70
    v_mfma_f32_16x16x32_bf16 v[158:161], a[56:59], a[232:235], v[158:161]
    ds_read_b128 a[232:235], v240 offset:30976
    v_lshlrev_b32 v253, 4, v253
    v_mfma_f32_16x16x32_bf16 v[162:165], a[8:11], a[236:239], v[162:165]
    v_add_u32 v253, 0xfffffc00, v253
    v_add_u32 v17, 3, v15
    v_mfma_f32_16x16x32_bf16 v[24:27], a[32:35], a[236:239], v[24:27]
    v_add_u32 v19, 3, v16
    s_waitcnt lgkmcnt(4)
    v_mfma_f32_16x16x32_bf16 v[54:57], a[56:59], a[236:239], v[54:57]
    buffer_load_dwordx4 v172, s[8:11], s61 offen lds
    ds_read_b128 a[236:239], v240 offset:32512
    v_mfma_f32_16x16x32_bf16 v[150:153], a[12:15], a[240:243], v[150:153]
    s_waitcnt lgkmcnt(4)
    v_and_b32 v18, 3, v17
    v_mul_u32_u24 v17, 0x1e00, v17
    v_mfma_f32_16x16x32_bf16 v[154:157], a[36:39], a[240:243], v[154:157]
    s_waitcnt lgkmcnt(3)
    v_lshlrev_b32 v18, 1, v18
    v_bfe_u32 v243, v19, 1, 1
    v_mfma_f32_16x16x32_bf16 v[158:161], a[60:63], a[240:243], v[158:161]
    ds_read_b128 a[240:243], v240 offset:34048
    v_or_b32 v18, v18, v243
    v_mfma_f32_16x16x32_bf16 v[162:165], a[12:15], a[244:247], v[162:165]
    buffer_load_dwordx4 v173, s[8:11], s61 offen offset:1024 lds
    v_xor_b32 v18, v18, v14
    v_mfma_f32_16x16x32_bf16 v[24:27], a[36:39], a[244:247], v[24:27]
    s_waitcnt lgkmcnt(3)
    s_waitcnt vmcnt(8) lgkmcnt(2)
    v_lshl_add_u32 v17, v18, 4, v17
    v_mfma_f32_16x16x32_bf16 v[54:57], a[60:63], a[244:247], v[54:57]
    ds_read_b64_tr_b16 a[72:73], v249 offset:6144
    ds_read_b64_tr_b16 a[74:75], v250 offset:6144
    v_mfma_f32_16x16x32_bf16 v[204:207], a[16:19], a[216:219], v[204:207]
    ds_read_b64_tr_b16 a[96:97], v249 offset:6176
    ds_read_b64_tr_b16 a[98:99], v250 offset:6176
    v_mfma_f32_16x16x32_bf16 v[208:211], a[40:43], a[216:219], v[208:211]
    buffer_load_dwordx4 v174, s[8:11], s61 offen offset:2048 lds
    s_add_u32 m0, s29, 0x1800
    v_mfma_f32_16x16x32_bf16 v[212:215], a[64:67], a[216:219], v[212:215]
    s_add_u32 s61, s39, 0x9000
    ds_read_b64_tr_b16 a[120:121], v249 offset:6208
    v_mfma_f32_16x16x32_bf16 v[216:219], a[16:19], a[220:223], v[216:219]
    ds_read_b64_tr_b16 a[122:123], v250 offset:6208
    ds_read_b128 a[244:247], v240 offset:35584
    v_mfma_f32_16x16x32_bf16 v[220:223], a[40:43], a[220:223], v[220:223]
    ds_read_b128 a[216:219], v241 offset:256
    v_mul_u32_u24 v18, 0x180, v19
    v_mfma_f32_16x16x32_bf16 v[224:227], a[64:67], a[220:223], v[224:227]
    ds_read_b128 a[220:223], v241 offset:1792
    v_add_u32 v242, v17, v18
    v_mfma_f32_16x16x32_bf16 v[180:183], a[16:19], a[224:227], v[180:183]
    s_waitcnt lgkmcnt(9)
    v_xor_b32 v243, 64, v242
    v_accvgpr_write_b32 a252, v168
    v_mfma_f32_16x16x32_bf16 v[184:187], a[40:43], a[224:227], v[184:187]
    v_accvgpr_read_b32 v254, a252
    v_accvgpr_write_b32 a253, v169
    v_mfma_f32_16x16x32_bf16 v[188:191], a[64:67], a[224:227], v[188:191]
    ds_read_b128 a[224:227], v241 offset:3328
    v_accvgpr_read_b32 v255, a253
    v_mfma_f32_16x16x32_bf16 v[192:195], a[16:19], a[228:231], v[192:195]
    v_accvgpr_write_b32 a254, v170
    v_accvgpr_write_b32 a255, v171
    v_mfma_f32_16x16x32_bf16 v[196:199], a[40:43], a[228:231], v[196:199]
    v_mov_b32 v17, 0x3f803f80
    v_accvgpr_write_b32 a248, v17
    v_mfma_f32_16x16x32_bf16 v[200:203], a[64:67], a[228:231], v[200:203]
    ds_read_b128 a[228:231], v241 offset:4864
    s_waitcnt lgkmcnt(5)
    v_mfma_f32_16x16x32_bf16 v[228:231], a[16:19], a[232:235], v[228:231]
    buffer_load_dwordx4 v172, s[8:11], s62 offen lds
    s_waitcnt vmcnt(7) lgkmcnt(4)
    v_mfma_f32_16x16x32_bf16 v[232:235], a[40:43], a[232:235], v[232:235]
    ds_read_b64_tr_b16 a[76:77], v249 offset:9216
    ds_read_b64_tr_b16 a[78:79], v250 offset:9216
    v_mfma_f32_16x16x32_bf16 v[236:239], a[64:67], a[232:235], v[236:239]
    ds_read_b64_tr_b16 a[100:101], v249 offset:9248
    ds_read_b64_tr_b16 a[102:103], v250 offset:9248
    v_mfma_f32_16x16x32_bf16 v[138:141], a[16:19], a[236:239], v[138:141]
    ds_read_b64_tr_b16 a[124:125], v249 offset:9280
    ds_read_b64_tr_b16 a[126:127], v250 offset:9280
    v_mfma_f32_16x16x32_bf16 v[142:145], a[40:43], a[236:239], v[142:145]
    buffer_load_dwordx4 v173, s[8:11], s62 offen offset:1024 lds
    ds_read_b128 a[232:235], v241 offset:30976
    v_mfma_f32_16x16x32_bf16 v[146:149], a[64:67], a[236:239], v[146:149]
    ds_read_b128 a[236:239], v241 offset:32512
    v_accvgpr_write_b32 a249, v17
    v_mfma_f32_16x16x32_bf16 v[150:153], a[16:19], a[240:243], v[150:153]
    s_waitcnt lgkmcnt(9)
    v_accvgpr_write_b32 a250, v17
    v_accvgpr_write_b32 a251, v17
    v_mfma_f32_16x16x32_bf16 v[154:157], a[40:43], a[240:243], v[154:157]
    s_waitcnt lgkmcnt(8)
    v_mov_b32 v248, 0
    v_lshrrev_b32 v18, 1, v13
    v_mfma_f32_16x16x32_bf16 v[158:161], a[64:67], a[240:243], v[158:161]
    buffer_load_dwordx4 v174, s[8:11], s62 offen offset:2048 lds
    s_add_u32 m0, s29, 0x2400
    v_mfma_f32_16x16x32_bf16 v[162:165], a[16:19], a[244:247], v[162:165]
    s_add_u32 s62, s39, 0x12000
    ds_read_b128 a[240:243], v241 offset:34048
    v_mfma_f32_16x16x32_bf16 v[24:27], a[40:43], a[244:247], v[24:27]
    v_xor_b32 v18, v14, v18
    v_xor_b32 v18, s66, v18
    v_mfma_f32_16x16x32_bf16 v[54:57], a[64:67], a[244:247], v[54:57]
    ds_read_b128 a[244:247], v241 offset:35584
    s_waitcnt lgkmcnt(4)
    v_mfma_f32_16x16x32_bf16 v[204:207], a[20:23], a[216:219], v[204:207]
    buffer_load_dwordx4 v172, s[8:11], s63 offen lds
    v_mul_u32_u24 v17, 0x180, v13
    v_mfma_f32_16x16x32_bf16 v[208:211], a[44:47], a[216:219], v[208:211]
    s_lshl_b32 s66, s36, 1
    v_lshl_add_u32 v17, v18, 4, v17
    v_add_u32 v17, s67, v17
    v_mfma_f32_16x16x32_bf16 v[212:215], a[68:71], a[216:219], v[212:215]
    ds_read_b128 a[216:219], v240 offset:0
    v_cvt_pk_bf16_f32 v102, v204, v205
    v_mfma_f32_16x16x32_bf16 v[216:219], a[20:23], a[220:223], v[216:219]
    s_mul_i32 s67, s36, 3
    v_cvt_pk_bf16_f32 v103, v206, v207
    v_cvt_pk_bf16_f32 v104, v208, v209
    v_mfma_f32_16x16x32_bf16 v[220:223], a[44:47], a[220:223], v[220:223]
    buffer_load_dwordx4 v173, s[8:11], s63 offen offset:1024 lds
    v_cvt_pk_bf16_f32 v105, v210, v211
    v_mfma_f32_16x16x32_bf16 v[224:227], a[68:71], a[220:223], v[224:227]
    s_sub_u32 s66, 1, s66
    v_cvt_pk_bf16_f32 v106, v212, v213
    v_cvt_pk_bf16_f32 v107, v214, v215
    v_mfma_f32_16x16x32_bf16 v[180:183], a[20:23], a[224:227], v[180:183]
    s_waitcnt lgkmcnt(2)
    v_cvt_pk_bf16_f32 v108, v216, v217
    v_cvt_pk_bf16_f32 v109, v218, v219
    v_mfma_f32_16x16x32_bf16 v[184:187], a[44:47], a[224:227], v[184:187]
    v_cvt_pk_bf16_f32 v110, v220, v221
    v_cvt_pk_bf16_f32 v111, v222, v223
    v_mfma_f32_16x16x32_bf16 v[188:191], a[68:71], a[224:227], v[188:191]
    buffer_load_dwordx4 v174, s[8:11], s63 offen offset:2048 lds
    s_add_u32 m0, s46, 0x1800
    v_mfma_f32_16x16x32_bf16 v[192:195], a[20:23], a[228:231], v[192:195]
    s_add_u32 s63, s39, 0x1b000
    v_cvt_pk_bf16_f32 v112, v224, v225
    v_cvt_pk_bf16_f32 v113, v226, v227
    v_mfma_f32_16x16x32_bf16 v[196:199], a[44:47], a[228:231], v[196:199]
    s_waitcnt lgkmcnt(1)
    v_cvt_pk_bf16_f32 v90, v180, v181
    v_cvt_pk_bf16_f32 v91, v182, v183
    v_mfma_f32_16x16x32_bf16 v[200:203], a[68:71], a[228:231], v[200:203]
    s_waitcnt lgkmcnt(0)
    v_cvt_pk_bf16_f32 v92, v184, v185
    v_cvt_pk_bf16_f32 v93, v186, v187
    v_mfma_f32_16x16x32_bf16 v[228:231], a[20:23], a[232:235], v[228:231]
    buffer_load_dwordx4 v168, s[4:7], s58 offen lds
    v_cvt_pk_bf16_f32 v94, v188, v189
    v_mfma_f32_16x16x32_bf16 v[232:235], a[44:47], a[232:235], v[232:235]
    v_cvt_pk_bf16_f32 v95, v190, v191
    v_cvt_pk_bf16_f32 v96, v192, v193
    v_mfma_f32_16x16x32_bf16 v[236:239], a[68:71], a[232:235], v[236:239]
    s_waitcnt vmcnt(10)
    ds_read_b64_tr_b16 a[80:81], v249 offset:0
    v_mfma_f32_16x16x32_bf16 v[138:141], a[20:23], a[236:239], v[138:141]
    ds_read_b64_tr_b16 a[82:83], v250 offset:0
    ds_read_b64_tr_b16 a[104:105], v249 offset:32
    v_mfma_f32_16x16x32_bf16 v[142:145], a[44:47], a[236:239], v[142:145]
    buffer_load_dwordx4 v171, s[4:7], s58 offen offset:512 lds
    s_lshl1_add_u32 s58, s45, s41
    v_mfma_f32_16x16x32_bf16 v[146:149], a[68:71], a[236:239], v[146:149]
    s_add_u32 m0, s46, 0x9000
    ds_read_b64_tr_b16 a[106:107], v250 offset:32
    v_mfma_f32_16x16x32_bf16 v[150:153], a[20:23], a[240:243], v[150:153]
    ds_read_b64_tr_b16 a[128:129], v249 offset:64
    ds_read_b64_tr_b16 a[130:131], v250 offset:64
    v_mfma_f32_16x16x32_bf16 v[154:157], a[44:47], a[240:243], v[154:157]
    v_cvt_pk_bf16_f32 v97, v194, v195
    v_cvt_pk_bf16_f32 v98, v196, v197
    v_mfma_f32_16x16x32_bf16 v[158:161], a[68:71], a[240:243], v[158:161]
    buffer_load_dwordx4 v168, s[4:7], s58 offen lds
    v_cvt_pk_bf16_f32 v99, v198, v199
    v_mfma_f32_16x16x32_bf16 v[162:165], a[20:23], a[244:247], v[162:165]
    v_cvt_pk_bf16_f32 v100, v200, v201
    v_cvt_pk_bf16_f32 v101, v202, v203
    v_mfma_f32_16x16x32_bf16 v[24:27], a[44:47], a[244:247], v[24:27]
    v_cvt_pk_bf16_f32 v114, v228, v229
    v_cvt_pk_bf16_f32 v115, v230, v231
    v_mfma_f32_16x16x32_bf16 v[54:57], a[68:71], a[244:247], v[54:57]
    v_cvt_pk_bf16_f32 v116, v232, v233
    v_cvt_pk_bf16_f32 v117, v234, v235
    v_mfma_f32_16x16x32_bf16 v[84:87], a[216:219], a[72:75], 0
    buffer_load_dwordx4 v171, s[4:7], s58 offen offset:512 lds
    s_add_u32 m0, s46, 0xf000
    v_mfma_f32_16x16x32_bf16 v[204:207], a[216:219], a[96:99], 0
    s_lshl1_add_u32 s58, s45, s42
    v_cvt_pk_bf16_f32 v118, v236, v237
    v_cvt_pk_bf16_f32 v119, v238, v239
    v_mfma_f32_16x16x32_bf16 v[208:211], a[216:219], a[120:123], 0
    v_cvt_pk_bf16_f32 v120, v138, v139
    v_cvt_pk_bf16_f32 v121, v140, v141
    v_cvt_pk_bf16_f32 v122, v142, v143
    v_cvt_pk_bf16_f32 v123, v144, v145
    s_waitcnt vmcnt(10)
    ds_read_b64_tr_b16 a[84:85], v249 offset:3072
    buffer_load_dwordx4 v168, s[4:7], s42 offen lds
    ds_read_b64_tr_b16 a[86:87], v250 offset:3072
    ds_read_b64_tr_b16 a[108:109], v249 offset:3104
    ds_read_b64_tr_b16 a[110:111], v250 offset:3104
    ds_read_b64_tr_b16 a[132:133], v249 offset:3136
    ds_read_b64_tr_b16 a[134:135], v250 offset:3136
    v_cvt_pk_bf16_f32 v124, v146, v147
    v_cvt_pk_bf16_f32 v125, v148, v149
    v_cvt_pk_bf16_f32 v126, v150, v151
    v_cvt_pk_bf16_f32 v127, v152, v153
    v_cvt_pk_bf16_f32 v128, v154, v155
    v_cvt_pk_bf16_f32 v129, v156, v157
    v_cvt_pk_bf16_f32 v130, v158, v159
    v_cvt_pk_bf16_f32 v131, v160, v161
    buffer_load_dwordx4 v169, s[4:7], s42 offen offset:1024 lds
    v_cvt_pk_bf16_f32 v132, v162, v163
    v_cvt_pk_bf16_f32 v133, v164, v165
    v_cvt_pk_bf16_f32 v134, v24, v25
    v_cvt_pk_bf16_f32 v135, v26, v27
    v_cvt_pk_bf16_f32 v136, v54, v55
    v_cvt_pk_bf16_f32 v137, v56, v57
    ds_read_b128 a[220:223], v240 offset:1536
    ds_read_b128 a[224:227], v240 offset:3072
    ds_read_b128 a[228:231], v240 offset:4608
    ds_read_b128 a[232:235], v240 offset:30720
    ds_read_b128 a[236:239], v240 offset:32256
    ds_read_b128 a[240:243], v240 offset:33792
    ds_read_b128 a[244:247], v240 offset:35328
    ds_read_b128 a[216:219], v241 offset:0
    v_add_u32 v247, 0x7800, v17
    v_add_u32 v251, 0x1e000, v17
    v_sub_u32 v17, v14, v15
    buffer_load_dwordx4 v170, s[4:7], s42 offen offset:2048 lds
    s_add_u32 m0, s46, 0xfc00
    v_mul_i32_i24 v17, 0x1c0, v17
    v_lshlrev_b32 v18, 4, v16
    v_sub_u32 v17, v17, v18
    v_add_u32 v17, s37, v17
    v_max_u32 v18, s33, v15
    v_sub_u32 v18, v14, v18
    v_add_u32 v244, 0, v18
    v_cmp_gt_u32 vcc, 7, v244
    v_add_u32 v244, 0xfffdc870, v17
    v_add_u32 v245, 4, v18
    v_cndmask_b32 v244, 0, v244, vcc
    v_add_u32 v244, 0x237c0, v244
    v_cmp_gt_u32 vcc, 7, v245
    buffer_load_dwordx4 v168, s[4:7], s59 offen lds
    s_waitcnt lgkmcnt(7)
    v_mfma_f32_16x16x32_bf16 v[212:215], a[220:223], a[72:75], 0
    v_add_u32 v245, 0xfffdcf70, v17
    v_cndmask_b32 v245, 0, v245, vcc
    v_mfma_f32_16x16x32_bf16 v[216:219], a[220:223], a[96:99], 0
    s_waitcnt lgkmcnt(6)
    v_add_u32 v245, 0x237c0, v245
    v_add_u32 v246, 8, v18
    v_mfma_f32_16x16x32_bf16 v[220:223], a[220:223], a[120:123], 0
    ds_read_b128 a[220:223], v241 offset:1536
    v_cmp_gt_u32 vcc, 7, v246
    v_mfma_f32_16x16x32_bf16 v[224:227], a[224:227], a[72:75], 0
    s_waitcnt lgkmcnt(5)
    buffer_load_dwordx4 v169, s[4:7], s59 offen offset:1024 lds
    v_mfma_f32_16x16x32_bf16 v[180:183], a[224:227], a[96:99], 0
    s_waitcnt vmcnt(12) lgkmcnt(4)
    ds_read_b64_tr_b16 a[88:89], v249 offset:6144
    v_mfma_f32_16x16x32_bf16 v[184:187], a[224:227], a[120:123], 0
    ds_read_b64_tr_b16 a[90:91], v250 offset:6144
    ds_read_b64_tr_b16 a[112:113], v249 offset:6176
    v_mfma_f32_16x16x32_bf16 v[188:191], a[228:231], a[72:75], 0
    ds_read_b64_tr_b16 a[114:115], v250 offset:6176
    ds_read_b64_tr_b16 a[136:137], v249 offset:6208
    v_mfma_f32_16x16x32_bf16 v[192:195], a[228:231], a[96:99], 0
    ds_read_b64_tr_b16 a[138:139], v250 offset:6208
    buffer_load_dwordx4 v170, s[4:7], s59 offen offset:2048 lds
    v_mfma_f32_16x16x32_bf16 v[196:199], a[228:231], a[120:123], 0
    s_add_u32 m0, s46, 0x10800
    ds_read_b128 a[224:227], v241 offset:3072
    v_mfma_f32_16x16x32_bf16 v[200:203], a[232:235], a[72:75], 0
    ds_read_b128 a[228:231], v241 offset:4608
    s_add_u32 s59, s43, s45
    v_mfma_f32_16x16x32_bf16 v[228:231], a[232:235], a[96:99], 0
    s_waitcnt lgkmcnt(8)
    v_add_u32 v246, 0xfffdd670, v17
    v_cndmask_b32 v246, 0, v246, vcc
    v_mfma_f32_16x16x32_bf16 v[232:235], a[232:235], a[120:123], 0
    ds_read_b128 a[232:235], v241 offset:30720
    v_add_u32 v246, 0x237c0, v246
    v_mfma_f32_16x16x32_bf16 v[236:239], a[236:239], a[72:75], 0
    buffer_load_dwordx4 v168, s[4:7], s58 offen lds
    v_min_u32 v20, 55, v1
    v_mfma_f32_16x16x32_bf16 v[138:141], a[236:239], a[96:99], 0
    v_lshlrev_b32 v62, 3, v20
    v_add_u32 v62, s64, v62
    v_mfma_f32_16x16x32_bf16 v[142:145], a[236:239], a[120:123], 0
    ds_read_b128 a[236:239], v241 offset:32256
    v_lshrrev_b32 v21, 1, v20
    v_mfma_f32_16x16x32_bf16 v[146:149], a[240:243], a[72:75], 0
    s_and_b32 s64, s48, 15
    v_and_b32 v20, 1, v20
    v_lshlrev_b32 v20, 1, v20
    v_mfma_f32_16x16x32_bf16 v[150:153], a[240:243], a[96:99], 0
    buffer_load_dwordx4 v171, s[4:7], s58 offen offset:512 lds
    s_add_u32 m0, s29, 0
    v_mfma_f32_16x16x32_bf16 v[154:157], a[240:243], a[120:123], 0
    s_waitcnt vmcnt(12) lgkmcnt(3)
    ds_read_b64_tr_b16 a[92:93], v249 offset:9216
    v_mfma_f32_16x16x32_bf16 v[158:161], a[244:247], a[72:75], 0
    ds_read_b64_tr_b16 a[94:95], v250 offset:9216
    ds_read_b64_tr_b16 a[116:117], v249 offset:9248
    v_mfma_f32_16x16x32_bf16 v[162:165], a[244:247], a[96:99], 0
    ds_read_b64_tr_b16 a[118:119], v250 offset:9248
    ds_read_b64_tr_b16 a[140:141], v249 offset:9280
    v_mfma_f32_16x16x32_bf16 v[24:27], a[244:247], a[120:123], 0
    ds_read_b64_tr_b16 a[142:143], v250 offset:9280
    buffer_load_dwordx4 v172, s[8:11], s60 offen lds
    v_mfma_f32_16x16x32_bf16 v[84:87], a[216:219], a[76:79], v[84:87]
    ds_read_b128 a[240:243], v241 offset:33792
    ds_read_b128 a[244:247], v241 offset:35328
    v_mfma_f32_16x16x32_bf16 v[204:207], a[216:219], a[100:103], v[204:207]
    s_lshl1_add_u32 s58, s45, s43
    v_add_u32 v22, -12, v21
    v_cmp_lt_u32 vcc, 11, v21
    v_mfma_f32_16x16x32_bf16 v[208:211], a[216:219], a[124:127], v[208:211]
    ds_read_b128 a[216:219], v240 offset:128
    v_cndmask_b32 v22, v21, v22, vcc
    v_mfma_f32_16x16x32_bf16 v[212:215], a[220:223], a[76:79], v[212:215]
    s_add_u32 s64, s64, s37
    v_mov_b32 v23, s34
    v_cndmask_b32 v23, 0, v23, vcc
    v_mfma_f32_16x16x32_bf16 v[216:219], a[220:223], a[100:103], v[216:219]
    s_waitcnt lgkmcnt(9)
    v_add_u32 v63, 0, v20
    v_add3_u32 v64, v22, v63, -6
    v_mfma_f32_16x16x32_bf16 v[220:223], a[220:223], a[124:127], v[220:223]
    ds_read_b128 a[220:223], v240 offset:1664
    v_add_u32 v65, 3, v64
    v_mfma_f32_16x16x32_bf16 v[224:227], a[224:227], a[76:79], v[224:227]
    buffer_load_dwordx4 v173, s[8:11], s60 offen offset:1024 lds
    v_and_b32 v66, 12, v22
    v_mfma_f32_16x16x32_bf16 v[180:183], a[224:227], a[100:103], v[180:183]
    v_add3_u32 v66, v66, v63, -3
    v_cmp_ne_u32 vcc, 0, v23
    v_mfma_f32_16x16x32_bf16 v[184:187], a[224:227], a[124:127], v[184:187]
    ds_read_b128 a[224:227], v240 offset:3200
    v_cndmask_b32 v65, v65, v66, vcc
    v_mfma_f32_16x16x32_bf16 v[188:191], a[228:231], a[76:79], v[188:191]
    s_waitcnt lgkmcnt(4)
    v_cmp_gt_u32 vcc, 7, v65
    v_mul_i32_i24 v64, s66, v64
    v_mfma_f32_16x16x32_bf16 v[192:195], a[228:231], a[100:103], v[192:195]
    s_waitcnt lgkmcnt(3)
    v_add_lshl_u32 v64, v64, 6, 1
    v_cndmask_b32 v50, 0, v64, vcc
    v_mfma_f32_16x16x32_bf16 v[196:199], a[228:231], a[124:127], v[196:199]
    ds_read_b128 a[228:231], v240 offset:4736
    v_mov_b32 v64, 0x3fb8aa3b
    v_mfma_f32_16x16x32_bf16 v[200:203], a[232:235], a[76:79], v[200:203]
    s_waitcnt lgkmcnt(3)
    s_waitcnt vmcnt(10)
    s_barrier
    v_mfma_f32_16x16x32_bf16 v[228:231], a[232:235], a[100:103], v[228:231]
    buffer_load_dwordx4 v174, s[8:11], s60 offen offset:2048 lds
    s_add_u32 m0, s29, 0xc00
    v_mfma_f32_16x16x32_bf16 v[232:235], a[232:235], a[124:127], v[232:235]
    s_add_u32 s60, s39, 0x24000
    ds_read_b128 a[232:235], v240 offset:30848
    v_mfma_f32_16x16x32_bf16 v[236:239], a[236:239], a[76:79], v[236:239]
    s_waitcnt lgkmcnt(3)
    v_cndmask_b32 v52, 0, v64, vcc
    v_mov_b32 v64, 0
    v_mfma_f32_16x16x32_bf16 v[138:141], a[236:239], a[100:103], v[138:141]
    v_mov_b32 v65, 0xf149f2ca
    v_cndmask_b32 v60, v65, v64, vcc
    v_mfma_f32_16x16x32_bf16 v[142:145], a[236:239], a[124:127], v[142:145]
    ds_read_b128 a[236:239], v240 offset:32384
    v_add_u32 v63, 1, v20
    v_mfma_f32_16x16x32_bf16 v[146:149], a[240:243], a[76:79], v[146:149]
    s_waitcnt lgkmcnt(3)
    v_add3_u32 v64, v22, v63, -6
    v_add_u32 v65, 3, v64
    v_mfma_f32_16x16x32_bf16 v[150:153], a[240:243], a[100:103], v[150:153]
    v_and_b32 v66, 12, v22
    v_add3_u32 v66, v66, v63, -3
    v_mfma_f32_16x16x32_bf16 v[154:157], a[240:243], a[124:127], v[154:157]
    buffer_load_dwordx4 v172, s[8:11], s61 offen lds
    ds_read_b128 a[240:243], v240 offset:33920
    v_mfma_f32_16x16x32_bf16 v[158:161], a[244:247], a[76:79], v[158:161]
    s_waitcnt lgkmcnt(3)
    v_cmp_ne_u32 vcc, 0, v23
    v_mul_i32_i24 v64, s66, v64
    v_mfma_f32_16x16x32_bf16 v[162:165], a[244:247], a[100:103], v[162:165]
    s_mul_i32 s66, s28, 0xffffee00
    v_cndmask_b32 v65, v65, v66, vcc
    v_cmp_gt_u32 vcc, 7, v65
    v_mfma_f32_16x16x32_bf16 v[24:27], a[244:247], a[124:127], v[24:27]
    ds_read_b128 a[244:247], v240 offset:35456
    v_add_lshl_u32 v64, v64, 6, 1
    v_mfma_f32_16x16x32_bf16 v[84:87], a[216:219], a[80:83], v[84:87]
    s_waitcnt lgkmcnt(3)
    v_cndmask_b32 v51, 0, v64, vcc
    v_mov_b32 v64, 0x3fb8aa3b
    v_mfma_f32_16x16x32_bf16 v[204:207], a[216:219], a[104:107], v[204:207]
    v_cndmask_b32 v53, 0, v64, vcc
    v_mov_b32 v64, 0
    v_mfma_f32_16x16x32_bf16 v[208:211], a[216:219], a[128:131], v[208:211]
    ds_read_b128 a[216:219], v241 offset:128
    v_mov_b32 v65, 0xf149f2ca
    v_mfma_f32_16x16x32_bf16 v[212:215], a[220:223], a[80:83], v[212:215]
    s_waitcnt lgkmcnt(3)
    v_cndmask_b32 v61, v65, v64, vcc
    s_mov_b32 vcc_lo, 0xcccccccc
    v_mfma_f32_16x16x32_bf16 v[216:219], a[220:223], a[104:107], v[216:219]
    s_mov_b32 vcc_hi, 0xcccccccc
    v_add_u32 v50, s64, v50
    v_add_u32 v51, s64, v51
    v_mfma_f32_16x16x32_bf16 v[220:223], a[220:223], a[128:131], v[220:223]
    ds_read_b128 a[220:223], v241 offset:1664
    ds_read_u16 v30, v50 offset:3456
    v_mfma_f32_16x16x32_bf16 v[224:227], a[224:227], a[80:83], v[224:227]
    ds_read_u16 v31, v51 offset:3456
    ds_read_u16 v32, v50 offset:3482
    v_mfma_f32_16x16x32_bf16 v[180:183], a[224:227], a[104:107], v[180:183]
    ds_read_u16 v33, v51 offset:3482
    ds_read_u16 v34, v50 offset:3508
    v_mfma_f32_16x16x32_bf16 v[184:187], a[224:227], a[128:131], v[184:187]
    ds_read_b128 a[224:227], v241 offset:3200
    ds_read_u16 v35, v51 offset:3508
    v_mfma_f32_16x16x32_bf16 v[188:191], a[228:231], a[80:83], v[188:191]
    ds_read_u16 v36, v50 offset:3534
    ds_read_u16 v37, v51 offset:3534
    v_mfma_f32_16x16x32_bf16 v[192:195], a[228:231], a[104:107], v[192:195]
    ds_read_u16 v38, v50 offset:3560
    ds_read_u16 v39, v51 offset:3560
    v_mfma_f32_16x16x32_bf16 v[196:199], a[228:231], a[128:131], v[196:199]
    ds_read_b128 a[228:231], v241 offset:4736
    ds_read_u16 v40, v50 offset:3586
    v_mfma_f32_16x16x32_bf16 v[200:203], a[232:235], a[80:83], v[200:203]
    s_waitcnt lgkmcnt(14)
    v_mov_b32 v64, 0xf149f2ca
    v_mov_b32 v65, 0xf149f2ca
    v_mfma_f32_16x16x32_bf16 v[228:231], a[232:235], a[104:107], v[228:231]
    ds_read_u16 v41, v51 offset:3586
    ds_read_u16 v42, v50 offset:3612
    v_mfma_f32_16x16x32_bf16 v[232:235], a[232:235], a[128:131], v[232:235]
    ds_read_b128 a[232:235], v241 offset:30848
    ds_read_u16 v43, v51 offset:3612
    v_mfma_f32_16x16x32_bf16 v[236:239], a[236:239], a[80:83], v[236:239]
    ds_read_u16 v44, v50 offset:3638
    ds_read_u16 v45, v51 offset:3638
    v_mfma_f32_16x16x32_bf16 v[138:141], a[236:239], a[104:107], v[138:141]
    ds_read_u16 v46, v50 offset:3664
    ds_read_u16 v47, v51 offset:3664
    v_mfma_f32_16x16x32_bf16 v[142:145], a[236:239], a[128:131], v[142:145]
    ds_read_b128 a[236:239], v241 offset:32384
    ds_read_u16 v48, v50 offset:3690
    v_mfma_f32_16x16x32_bf16 v[146:149], a[240:243], a[80:83], v[146:149]
    ds_read_u16 v49, v51 offset:3690
    s_waitcnt lgkmcnt(13)
    v_mfma_f32_16x16x32_bf16 v[150:153], a[240:243], a[104:107], v[150:153]
    s_waitcnt lgkmcnt(12)
    v_lshlrev_b32 v30, 16, v30
    v_fma_f32 v30, v30, v52, v60
    v_mfma_f32_16x16x32_bf16 v[154:157], a[240:243], a[128:131], v[154:157]
    ds_read_b128 a[240:243], v241 offset:33920
    v_lshlrev_b32 v31, 16, v31
    v_mfma_f32_16x16x32_bf16 v[158:161], a[244:247], a[80:83], v[158:161]
    s_waitcnt lgkmcnt(11)
    v_fma_f32 v31, v31, v53, v61
    v_lshlrev_b32 v32, 16, v32
    v_mfma_f32_16x16x32_bf16 v[162:165], a[244:247], a[104:107], v[162:165]
    ds_write_b64 v62, v[30:31] offset:0
    v_mfma_f32_16x16x32_bf16 v[24:27], a[244:247], a[128:131], v[24:27]
    ds_read_b128 a[244:247], v241 offset:35456
    v_add_u32 v62, s49, v62
    v_mfma_f32_16x16x32_bf16 v[84:87], a[216:219], a[84:87], v[84:87]
    s_waitcnt lgkmcnt(7)
    v_fma_f32 v32, v32, v52, v60
    v_lshlrev_b32 v33, 16, v33
    v_mfma_f32_16x16x32_bf16 v[204:207], a[216:219], a[108:111], v[204:207]
    s_waitcnt lgkmcnt(6)
    v_fma_f32 v33, v33, v53, v61
    v_lshlrev_b32 v34, 16, v34
    v_mfma_f32_16x16x32_bf16 v[208:211], a[216:219], a[132:135], v[208:211]
    ds_read_b128 a[216:219], v240 offset:256
    v_fma_f32 v34, v34, v52, v60
    v_mfma_f32_16x16x32_bf16 v[212:215], a[220:223], a[84:87], v[212:215]
    ds_write_b64 v62, v[32:33] offset:0
    v_mfma_f32_16x16x32_bf16 v[216:219], a[220:223], a[108:111], v[216:219]
    s_waitcnt lgkmcnt(4)
    v_add_u32 v62, s49, v62
    v_lshlrev_b32 v35, 16, v35
    v_mfma_f32_16x16x32_bf16 v[220:223], a[220:223], a[132:135], v[220:223]
    ds_read_b128 a[220:223], v240 offset:1792
    v_fma_f32 v35, v35, v53, v61
    v_mfma_f32_16x16x32_bf16 v[224:227], a[224:227], a[84:87], v[224:227]
    ds_write_b64 v62, v[34:35] offset:0
    v_mfma_f32_16x16x32_bf16 v[180:183], a[224:227], a[108:111], v[180:183]
    s_waitcnt lgkmcnt(4)
    v_add_u32 v62, s49, v62
    v_lshlrev_b32 v36, 16, v36
    v_mfma_f32_16x16x32_bf16 v[184:187], a[224:227], a[132:135], v[184:187]
    ds_read_b128 a[224:227], v240 offset:3328
    v_fma_f32 v36, v36, v52, v60
    v_mfma_f32_16x16x32_bf16 v[188:191], a[228:231], a[84:87], v[188:191]
    v_lshlrev_b32 v37, 16, v37
    v_fma_f32 v37, v37, v53, v61
    v_mfma_f32_16x16x32_bf16 v[192:195], a[228:231], a[108:111], v[192:195]
    ds_write_b64 v62, v[36:37] offset:0
    v_mfma_f32_16x16x32_bf16 v[196:199], a[228:231], a[132:135], v[196:199]
    ds_read_b128 a[228:231], v240 offset:4864
    v_add_u32 v62, s49, v62
    v_mfma_f32_16x16x32_bf16 v[200:203], a[232:235], a[84:87], v[200:203]
    s_waitcnt lgkmcnt(6)
    v_lshlrev_b32 v38, 16, v38
    v_fma_f32 v38, v38, v52, v60
    v_mfma_f32_16x16x32_bf16 v[228:231], a[232:235], a[108:111], v[228:231]
    s_waitcnt lgkmcnt(4)
    v_lshlrev_b32 v39, 16, v39
    v_fma_f32 v39, v39, v53, v61
    v_mfma_f32_16x16x32_bf16 v[232:235], a[232:235], a[132:135], v[232:235]
    ds_read_b128 a[232:235], v240 offset:30976
    v_lshlrev_b32 v40, 16, v40
    v_mfma_f32_16x16x32_bf16 v[236:239], a[236:239], a[84:87], v[236:239]
    ds_write_b64 v62, v[38:39] offset:0
    v_mfma_f32_16x16x32_bf16 v[138:141], a[236:239], a[108:111], v[138:141]
    s_waitcnt lgkmcnt(4)
    v_add_u32 v62, s49, v62
    v_fma_f32 v40, v40, v52, v60
    v_mfma_f32_16x16x32_bf16 v[142:145], a[236:239], a[132:135], v[142:145]
    ds_read_b128 a[236:239], v240 offset:32512
    v_lshlrev_b32 v41, 16, v41
    v_mfma_f32_16x16x32_bf16 v[146:149], a[240:243], a[84:87], v[146:149]
    v_fma_f32 v41, v41, v53, v61
    v_lshlrev_b32 v42, 16, v42
    v_mfma_f32_16x16x32_bf16 v[150:153], a[240:243], a[108:111], v[150:153]
    ds_write_b64 v62, v[40:41] offset:0
    v_mfma_f32_16x16x32_bf16 v[154:157], a[240:243], a[132:135], v[154:157]
    ds_read_b128 a[240:243], v240 offset:34048
    v_add_u32 v62, s49, v62
    v_mfma_f32_16x16x32_bf16 v[158:161], a[244:247], a[84:87], v[158:161]
    s_waitcnt lgkmcnt(5)
    v_fma_f32 v42, v42, v52, v60
    v_lshlrev_b32 v43, 16, v43
    v_mfma_f32_16x16x32_bf16 v[162:165], a[244:247], a[108:111], v[162:165]
    s_waitcnt lgkmcnt(4)
    v_fma_f32 v43, v43, v53, v61
    v_lshlrev_b32 v44, 16, v44
    v_mfma_f32_16x16x32_bf16 v[24:27], a[244:247], a[132:135], v[24:27]
    ds_read_b128 a[244:247], v240 offset:35584
    v_fma_f32 v44, v44, v52, v60
    v_mfma_f32_16x16x32_bf16 v[84:87], a[216:219], a[88:91], v[84:87]
    ds_write_b64 v62, v[42:43] offset:0
    v_mfma_f32_16x16x32_bf16 v[204:207], a[216:219], a[112:115], v[204:207]
    s_waitcnt lgkmcnt(4)
    v_add_u32 v62, s49, v62
    v_lshlrev_b32 v45, 16, v45
    v_mfma_f32_16x16x32_bf16 v[208:211], a[216:219], a[136:139], v[208:211]
    ds_read_b128 a[216:219], v241 offset:256
    v_fma_f32 v45, v45, v53, v61
    v_mfma_f32_16x16x32_bf16 v[212:215], a[220:223], a[88:91], v[212:215]
    ds_write_b64 v62, v[44:45] offset:0
    v_mfma_f32_16x16x32_bf16 v[216:219], a[220:223], a[112:115], v[216:219]
    s_waitcnt lgkmcnt(4)
    v_add_u32 v62, s49, v62
    v_lshlrev_b32 v46, 16, v46
    v_mfma_f32_16x16x32_bf16 v[220:223], a[220:223], a[136:139], v[220:223]
    ds_read_b128 a[220:223], v241 offset:1792
    v_fma_f32 v46, v46, v52, v60
    v_mfma_f32_16x16x32_bf16 v[224:227], a[224:227], a[88:91], v[224:227]
    v_lshlrev_b32 v47, 16, v47
    v_fma_f32 v47, v47, v53, v61
    v_mfma_f32_16x16x32_bf16 v[180:183], a[224:227], a[112:115], v[180:183]
    ds_write_b64 v62, v[46:47] offset:0
    v_mfma_f32_16x16x32_bf16 v[184:187], a[224:227], a[136:139], v[184:187]
    ds_read_b128 a[224:227], v241 offset:3328
    v_add_u32 v62, s49, v62
    v_mfma_f32_16x16x32_bf16 v[188:191], a[228:231], a[88:91], v[188:191]
    s_waitcnt lgkmcnt(6)
    v_lshlrev_b32 v48, 16, v48
    v_fma_f32 v48, v48, v52, v60
    v_mfma_f32_16x16x32_bf16 v[192:195], a[228:231], a[112:115], v[192:195]
    s_waitcnt lgkmcnt(4)
    v_lshlrev_b32 v49, 16, v49
    v_fma_f32 v49, v49, v53, v61
    v_mfma_f32_16x16x32_bf16 v[196:199], a[228:231], a[136:139], v[196:199]
    ds_read_b128 a[228:231], v241 offset:4864
    v_lshlrev_b32 v63, 3, v1
    v_mfma_f32_16x16x32_bf16 v[200:203], a[232:235], a[88:91], v[200:203]
    ds_write_b64 v62, v[48:49] offset:0
    v_mfma_f32_16x16x32_bf16 v[228:231], a[232:235], a[112:115], v[228:231]
    s_waitcnt lgkmcnt(4)
    v_add_u32 v62, s49, v62
    v_add_u32 v63, 0x237c0, v63
    v_mfma_f32_16x16x32_bf16 v[232:235], a[232:235], a[136:139], v[232:235]
    ds_read_b128 a[232:235], v241 offset:30976
    v_mfma_f32_16x16x32_bf16 v[236:239], a[236:239], a[88:91], v[236:239]
    ds_write_b64 v63, v[64:65] offset:0
    v_mfma_f32_16x16x32_bf16 v[138:141], a[236:239], a[112:115], v[138:141]
    s_waitcnt lgkmcnt(4)
    v_mfma_f32_16x16x32_bf16 v[142:145], a[236:239], a[136:139], v[142:145]
    ds_read_b128 a[236:239], v241 offset:32512
    v_mfma_f32_16x16x32_bf16 v[146:149], a[240:243], a[88:91], v[146:149]
    v_mfma_f32_16x16x32_bf16 v[150:153], a[240:243], a[112:115], v[150:153]
    s_waitcnt lgkmcnt(4)
    v_mfma_f32_16x16x32_bf16 v[154:157], a[240:243], a[136:139], v[154:157]
    ds_read_b128 a[240:243], v241 offset:34048
    v_mfma_f32_16x16x32_bf16 v[158:161], a[244:247], a[88:91], v[158:161]
    v_mfma_f32_16x16x32_bf16 v[162:165], a[244:247], a[112:115], v[162:165]
    s_waitcnt lgkmcnt(3)
    v_mfma_f32_16x16x32_bf16 v[24:27], a[244:247], a[136:139], v[24:27]
    ds_read_b128 a[244:247], v241 offset:35584
    v_mfma_f32_16x16x32_bf16 v[84:87], a[216:219], a[92:95], v[84:87]
    v_mfma_f32_16x16x32_bf16 v[204:207], a[216:219], a[116:119], v[204:207]
    v_mfma_f32_16x16x32_bf16 v[208:211], a[216:219], a[140:143], v[208:211]
    ds_read_b128 a[216:219], v240 offset:6144
    s_waitcnt lgkmcnt(3)
    v_mfma_f32_16x16x32_bf16 v[212:215], a[220:223], a[92:95], v[212:215]
    v_mfma_f32_16x16x32_bf16 v[216:219], a[220:223], a[116:119], v[216:219]
    v_mfma_f32_16x16x32_bf16 v[220:223], a[220:223], a[140:143], v[220:223]
    ds_read_b128 a[220:223], v241 offset:6144
    v_cvt_pk_bf16_f32 v0, v84, v85
    v_mfma_f32_16x16x32_bf16 v[224:227], a[224:227], a[92:95], v[224:227]
    s_waitcnt lgkmcnt(3)
    v_cvt_pk_bf16_f32 v3, v86, v87
    v_cvt_pk_bf16_f32 v30, v204, v205
    v_mfma_f32_16x16x32_bf16 v[180:183], a[224:227], a[116:119], v[180:183]
    v_cvt_pk_bf16_f32 v33, v206, v207
    v_cvt_pk_bf16_f32 v60, v208, v209
    v_mfma_f32_16x16x32_bf16 v[184:187], a[224:227], a[140:143], v[184:187]
    s_waitcnt lgkmcnt(2)
    v_cvt_pk_bf16_f32 v63, v210, v211
    v_cvt_pk_bf16_f32 v6, v212, v213
    v_mfma_f32_16x16x32_bf16 v[188:191], a[228:231], a[92:95], v[188:191]
    v_cvt_pk_bf16_f32 v9, v214, v215
    v_cvt_pk_bf16_f32 v36, v216, v217
    v_mfma_f32_16x16x32_bf16 v[192:195], a[228:231], a[116:119], v[192:195]
    v_cvt_pk_bf16_f32 v39, v218, v219
    v_cvt_pk_bf16_f32 v66, v220, v221
    v_mfma_f32_16x16x32_bf16 v[196:199], a[228:231], a[140:143], v[196:199]
    v_cvt_pk_bf16_f32 v69, v222, v223
    v_cvt_pk_bf16_f32 v12, v224, v225
    v_mfma_f32_16x16x32_bf16 v[200:203], a[232:235], a[92:95], v[200:203]
    v_cvt_pk_bf16_f32 v15, v226, v227
    v_cvt_pk_bf16_f32 v42, v180, v181
    v_mfma_f32_16x16x32_bf16 v[228:231], a[232:235], a[116:119], v[228:231]
    v_cvt_pk_bf16_f32 v45, v182, v183
    v_cvt_pk_bf16_f32 v72, v184, v185
    v_mfma_f32_16x16x32_bf16 v[232:235], a[232:235], a[140:143], v[232:235]
    v_cvt_pk_bf16_f32 v75, v186, v187
    v_cvt_pk_bf16_f32 v18, v188, v189
    v_mfma_f32_16x16x32_bf16 v[236:239], a[236:239], a[92:95], v[236:239]
    v_cvt_pk_bf16_f32 v21, v190, v191
    v_cvt_pk_bf16_f32 v48, v192, v193
    v_mfma_f32_16x16x32_bf16 v[138:141], a[236:239], a[116:119], v[138:141]
    v_cvt_pk_bf16_f32 v51, v194, v195
    v_cvt_pk_bf16_f32 v78, v196, v197
    v_mfma_f32_16x16x32_bf16 v[142:145], a[236:239], a[140:143], v[142:145]
    v_cvt_pk_bf16_f32 v81, v198, v199
    v_cvt_pk_bf16_f32 v1, v200, v201
    v_mfma_f32_16x16x32_bf16 v[146:149], a[240:243], a[92:95], v[146:149]
    v_cvt_pk_bf16_f32 v4, v202, v203
    v_cvt_pk_bf16_f32 v31, v228, v229
    v_mfma_f32_16x16x32_bf16 v[150:153], a[240:243], a[116:119], v[150:153]
    v_cvt_pk_bf16_f32 v34, v230, v231
    v_cvt_pk_bf16_f32 v61, v232, v233
    v_mfma_f32_16x16x32_bf16 v[154:157], a[240:243], a[140:143], v[154:157]
    buffer_load_dwordx4 v173, s[8:11], s61 offen offset:1024 lds
    v_cvt_pk_bf16_f32 v64, v234, v235
    v_mfma_f32_16x16x32_bf16 v[158:161], a[244:247], a[92:95], v[158:161]
    s_waitcnt lgkmcnt(0)
    v_cvt_pk_bf16_f32 v7, v236, v237
    v_cvt_pk_bf16_f32 v10, v238, v239
    v_mfma_f32_16x16x32_bf16 v[162:165], a[244:247], a[116:119], v[162:165]
    v_cvt_pk_bf16_f32 v37, v138, v139
    v_cvt_pk_bf16_f32 v40, v140, v141
    v_mfma_f32_16x16x32_bf16 v[24:27], a[244:247], a[140:143], v[24:27]
    v_cvt_pk_bf16_f32 v67, v142, v143
    v_cvt_pk_bf16_f32 v70, v144, v145
    v_mfma_f32_16x16x32_bf16 v[228:231], a[0:3], a[216:219], 0
    v_cvt_pk_bf16_f32 v13, v146, v147
    v_cvt_pk_bf16_f32 v16, v148, v149
    v_mfma_f32_16x16x32_bf16 v[228:231], a[4:7], a[220:223], v[228:231]
    v_cvt_pk_bf16_f32 v43, v150, v151
    v_cvt_pk_bf16_f32 v46, v152, v153
    v_mfma_f32_16x16x32_bf16 v[232:235], a[24:27], a[216:219], 0
    v_cvt_pk_bf16_f32 v73, v154, v155
    v_cvt_pk_bf16_f32 v76, v156, v157
    v_mfma_f32_16x16x32_bf16 v[232:235], a[28:31], a[220:223], v[232:235]
    buffer_load_dwordx4 v174, s[8:11], s61 offen offset:2048 lds
    s_add_u32 m0, s29, 0x1800
    v_mfma_f32_16x16x32_bf16 v[236:239], a[48:51], a[216:219], 0
    s_add_u32 s61, s39, 0x2d000
    v_cvt_pk_bf16_f32 v19, v158, v159
    v_cvt_pk_bf16_f32 v22, v160, v161
    v_mfma_f32_16x16x32_bf16 v[236:239], a[52:55], a[220:223], v[236:239]
    v_cvt_pk_bf16_f32 v49, v162, v163
    v_cvt_pk_bf16_f32 v52, v164, v165
    v_cvt_pk_bf16_f32 v79, v24, v25
    v_cvt_pk_bf16_f32 v82, v26, v27
    ds_read_b128 a[224:227], v240 offset:6272
    ds_read_b128 a[228:231], v241 offset:6272
    ds_read_b128 a[232:235], v240 offset:6400
    ds_read_b128 a[236:239], v241 offset:6400
    ds_read_b128 a[240:243], v240 offset:36864
    ds_read_b128 a[244:247], v241 offset:36864
    ds_read_b128 v[196:199], v244 offset:192
    ds_read_b128 v[200:203], v245 offset:192
    ds_read_b128 v[204:207], v246 offset:192
    ds_read_b128 v[208:211], v244 offset:256
    buffer_load_dwordx4 v172, s[8:11], s62 offen lds
    v_mov_b32 v195, 0
    s_waitcnt lgkmcnt(9)
    v_mfma_f32_16x16x32_bf16 v[228:231], a[8:11], a[224:227], v[228:231]
    s_waitcnt vmcnt(10)
    s_barrier
    s_waitcnt lgkmcnt(8)
    v_mfma_f32_16x16x32_bf16 v[228:231], a[12:15], a[228:231], v[228:231]
    v_mfma_f32_16x16x32_bf16 v[232:235], a[32:35], a[224:227], v[232:235]
    buffer_load_dwordx4 v173, s[8:11], s62 offen offset:1024 lds
    s_waitcnt lgkmcnt(7)
    v_mfma_f32_16x16x32_bf16 v[228:231], a[16:19], a[232:235], v[228:231]
    s_waitcnt lgkmcnt(6)
    v_mfma_f32_16x16x32_bf16 v[228:231], a[20:23], a[236:239], v[228:231]
    v_mfma_f32_16x16x32_bf16 v[232:235], a[36:39], a[228:231], v[232:235]
    v_mfma_f32_16x16x32_bf16 v[232:235], a[40:43], a[232:235], v[232:235]
    v_mfma_f32_16x16x32_bf16 v[232:235], a[44:47], a[236:239], v[232:235]
    v_mfma_f32_16x16x32_bf16 v[236:239], a[56:59], a[224:227], v[236:239]
    v_mfma_f32_16x16x32_bf16 v[236:239], a[60:63], a[228:231], v[236:239]
    buffer_load_dwordx4 v174, s[8:11], s62 offen offset:2048 lds
    s_add_u32 m0, s29, 0x2400
    v_mfma_f32_16x16x32_bf16 v[236:239], a[64:67], a[232:235], v[236:239]
    s_lshl_b32 s62, s28, 5
    s_add_u32 s62, s62, 0
    v_cvt_pk_bf16_f32 v138, v228, v229
    v_mfma_f32_16x16x32_bf16 v[236:239], a[68:71], a[236:239], v[236:239]
    v_cvt_pk_bf16_f32 v139, v230, v231
    v_cvt_pk_bf16_f32 v140, v232, v233
    v_mfma_f32_16x16x32_bf16 v[228:231], a[216:219], a[72:75], 0
    v_cvt_pk_bf16_f32 v141, v234, v235
    v_mfma_f32_16x16x32_bf16 v[228:231], a[220:223], a[76:79], v[228:231]
    v_mfma_f32_16x16x32_bf16 v[228:231], a[224:227], a[80:83], v[228:231]
    v_mfma_f32_16x16x32_bf16 v[228:231], a[228:231], a[84:87], v[228:231]
    v_mfma_f32_16x16x32_bf16 v[228:231], a[232:235], a[88:91], v[228:231]
    buffer_load_dwordx4 v172, s[8:11], s63 offen lds
    v_cvt_pk_bf16_f32 v142, v236, v237
    v_mfma_f32_16x16x32_bf16 v[228:231], a[236:239], a[92:95], v[228:231]
    v_cvt_pk_bf16_f32 v143, v238, v239
    v_mfma_f32_16x16x32_bf16 v[232:235], a[216:219], a[96:99], 0
    v_mfma_f32_16x16x32_bf16 v[232:235], a[220:223], a[100:103], v[232:235]
    v_mfma_f32_16x16x32_bf16 v[232:235], a[224:227], a[104:107], v[232:235]
    v_mfma_f32_16x16x32_bf16 v[232:235], a[228:231], a[108:111], v[232:235]
    v_mfma_f32_16x16x32_bf16 v[232:235], a[232:235], a[112:115], v[232:235]
    v_mfma_f32_16x16x32_bf16 v[232:235], a[236:239], a[116:119], v[232:235]
    buffer_load_dwordx4 v173, s[8:11], s63 offen offset:1024 lds
    v_cvt_pk_bf16_f32 v24, v228, v229
    v_mfma_f32_16x16x32_bf16 v[236:239], a[216:219], a[120:123], 0
    ds_read_b128 a[216:219], v240 offset:36992
    v_cvt_pk_bf16_f32 v27, v230, v231
    v_mfma_f32_16x16x32_bf16 v[236:239], a[220:223], a[124:127], v[236:239]
    ds_read_b128 a[220:223], v241 offset:36992
    s_waitcnt lgkmcnt(2)
    v_mfma_f32_16x16x32_bf16 v[236:239], a[224:227], a[128:131], v[236:239]
    s_waitcnt vmcnt(8)
    ds_read_b64_tr_b16 a[144:145], v249 offset:0
    v_mfma_f32_16x16x32_bf16 v[236:239], a[228:231], a[132:135], v[236:239]
    ds_read_b64_tr_b16 a[146:147], v250 offset:0
    ds_read_b64_tr_b16 a[168:169], v249 offset:32
    v_mfma_f32_16x16x32_bf16 v[236:239], a[232:235], a[136:139], v[236:239]
    ds_read_b64_tr_b16 a[170:171], v250 offset:32
    ds_read_b64_tr_b16 a[192:193], v249 offset:64
    v_mfma_f32_16x16x32_bf16 v[236:239], a[236:239], a[140:143], v[236:239]
    ds_read_b64_tr_b16 a[194:195], v250 offset:64
    buffer_load_dwordx4 v174, s[8:11], s63 offen offset:2048 lds
    v_mfma_f32_16x16x32_bf16 v[228:231], a[0:3], a[240:243], 0
    s_add_u32 m0, s29, 0
    s_lshl_b32 s63, s28, 5
    s_add_u32 s63, s63, 0x4800
    v_mfma_f32_16x16x32_bf16 v[228:231], a[4:7], a[244:247], v[228:231]
    v_cvt_pk_bf16_f32 v54, v232, v233
    v_cvt_pk_bf16_f32 v57, v234, v235
    v_mfma_f32_16x16x32_bf16 v[232:235], a[24:27], a[240:243], 0
    s_waitcnt lgkmcnt(7)
    v_cvt_pk_bf16_f32 v84, v236, v237
    v_cvt_pk_bf16_f32 v87, v238, v239
    v_mfma_f32_16x16x32_bf16 v[228:231], a[8:11], a[216:219], v[228:231]
    ds_read_b128 a[224:227], v240 offset:37120
    ds_read_b128 a[228:231], v241 offset:37120
    v_mfma_f32_16x16x32_bf16 v[232:235], a[28:31], a[244:247], v[232:235]
    ds_read_b128 a[232:235], v240 offset:61440
    ds_read_b128 a[236:239], v241 offset:61440
    v_mfma_f32_16x16x32_bf16 v[232:235], a[32:35], a[216:219], v[232:235]
    s_waitcnt lgkmcnt(10)
    v_mfma_f32_16x16x32_bf16 v[228:231], a[12:15], a[220:223], v[228:231]
    v_mfma_f32_16x16x32_bf16 v[232:235], a[36:39], a[220:223], v[232:235]
    s_waitcnt lgkmcnt(4)
    buffer_load_dwordx4 v172, s[8:11], s60 offen lds
    v_mfma_f32_16x16x32_bf16 v[236:239], a[48:51], a[240:243], 0
    v_mfma_f32_16x16x32_bf16 v[236:239], a[52:55], a[244:247], v[236:239]
    s_waitcnt vmcnt(7)
    ds_read_b64_tr_b16 a[148:149], v249 offset:3072
    v_mfma_f32_16x16x32_bf16 v[236:239], a[56:59], a[216:219], v[236:239]
    ds_read_b64_tr_b16 a[150:151], v250 offset:3072
    ds_read_b64_tr_b16 a[172:173], v249 offset:3104
    v_mfma_f32_16x16x32_bf16 v[236:239], a[60:63], a[220:223], v[236:239]
    s_waitcnt lgkmcnt(6)
    ds_read_b64_tr_b16 a[174:175], v250 offset:3104
    v_mfma_f32_16x16x32_bf16 v[228:231], a[16:19], a[224:227], v[228:231]
    ds_read_b64_tr_b16 a[196:197], v249 offset:3136
    ds_read_b64_tr_b16 a[198:199], v250 offset:3136
    v_mfma_f32_16x16x32_bf16 v[232:235], a[40:43], a[224:227], v[232:235]
    s_waitcnt lgkmcnt(8)
    v_mfma_f32_16x16x32_bf16 v[228:231], a[20:23], a[228:231], v[228:231]
    buffer_load_dwordx4 v173, s[8:11], s60 offen offset:1024 lds
    v_mfma_f32_16x16x32_bf16 v[232:235], a[44:47], a[228:231], v[232:235]
    v_mfma_f32_16x16x32_bf16 v[236:239], a[64:67], a[224:227], v[236:239]
    v_mfma_f32_16x16x32_bf16 v[236:239], a[68:71], a[228:231], v[236:239]
    s_nop 3
    v_cvt_pk_bf16_f32 v144, v228, v229
    v_cvt_pk_bf16_f32 v145, v230, v231
    v_mfma_f32_16x16x32_bf16 v[228:231], a[240:243], a[72:75], 0
    v_cvt_pk_bf16_f32 v146, v232, v233
    v_cvt_pk_bf16_f32 v147, v234, v235
    v_mfma_f32_16x16x32_bf16 v[228:231], a[244:247], a[76:79], v[228:231]
    v_cvt_pk_bf16_f32 v148, v236, v237
    v_cvt_pk_bf16_f32 v149, v238, v239
    v_mfma_f32_16x16x32_bf16 v[228:231], a[216:219], a[80:83], v[228:231]
    buffer_load_dwordx4 v174, s[8:11], s60 offen offset:2048 lds
    s_add_u32 m0, s29, 0xc00
    v_mfma_f32_16x16x32_bf16 v[228:231], a[220:223], a[84:87], v[228:231]
    s_waitcnt lgkmcnt(0)
    s_lshl_b32 s60, s28, 5
    s_add_u32 s60, s60, 0x1800
    v_mfma_f32_16x16x32_bf16 v[228:231], a[224:227], a[88:91], v[228:231]
    v_mfma_f32_16x16x32_bf16 v[228:231], a[228:231], a[92:95], v[228:231]
    v_mfma_f32_16x16x32_bf16 v[232:235], a[240:243], a[96:99], 0
    v_mfma_f32_16x16x32_bf16 v[232:235], a[244:247], a[100:103], v[232:235]
    v_mfma_f32_16x16x32_bf16 v[232:235], a[216:219], a[104:107], v[232:235]
    v_mfma_f32_16x16x32_bf16 v[232:235], a[220:223], a[108:111], v[232:235]
    buffer_load_dwordx4 v172, s[8:11], s61 offen lds
    v_mfma_f32_16x16x32_bf16 v[232:235], a[224:227], a[112:115], v[232:235]
    s_waitcnt vmcnt(7)
    ds_read_b64_tr_b16 a[152:153], v249 offset:6144
    v_mfma_f32_16x16x32_bf16 v[232:235], a[228:231], a[116:119], v[232:235]
    ds_read_b64_tr_b16 a[154:155], v250 offset:6144
    ds_read_b64_tr_b16 a[176:177], v249 offset:6176
    v_mfma_f32_16x16x32_bf16 v[236:239], a[240:243], a[120:123], 0
    ds_read_b64_tr_b16 a[178:179], v250 offset:6176
    ds_read_b64_tr_b16 a[200:201], v249 offset:6208
    v_mfma_f32_16x16x32_bf16 v[236:239], a[244:247], a[124:127], v[236:239]
    ds_read_b64_tr_b16 a[202:203], v250 offset:6208
    v_cvt_pk_bf16_f32 v25, v228, v229
    v_mfma_f32_16x16x32_bf16 v[236:239], a[216:219], a[128:131], v[236:239]
    v_cvt_pk_bf16_f32 v28, v230, v231
    v_cvt_pk_bf16_f32 v55, v232, v233
    v_mfma_f32_16x16x32_bf16 v[236:239], a[220:223], a[132:135], v[236:239]
    ds_read_b128 a[240:243], v240 offset:61568
    buffer_load_dwordx4 v173, s[8:11], s61 offen offset:1024 lds
    v_mfma_f32_16x16x32_bf16 v[236:239], a[224:227], a[136:139], v[236:239]
    ds_read_b128 a[244:247], v241 offset:61568
    v_cvt_pk_bf16_f32 v58, v234, v235
    v_mfma_f32_16x16x32_bf16 v[236:239], a[228:231], a[140:143], v[236:239]
    ds_read_b128 a[216:219], v240 offset:61696
    ds_read_b128 a[220:223], v241 offset:61696
    v_mfma_f32_16x16x32_bf16 v[228:231], a[0:3], a[232:235], 0
    ds_read_b128 a[224:227], v240 offset:62976
    ds_read_b128 a[228:231], v241 offset:62976
    v_mfma_f32_16x16x32_bf16 v[228:231], a[4:7], a[236:239], v[228:231]
    v_mfma_f32_16x16x32_bf16 v[232:235], a[24:27], a[232:235], 0
    v_mfma_f32_16x16x32_bf16 v[232:235], a[28:31], a[236:239], v[232:235]
    v_cvt_pk_bf16_f32 v85, v236, v237
    v_cvt_pk_bf16_f32 v88, v238, v239
    v_mfma_f32_16x16x32_bf16 v[236:239], a[48:51], a[232:235], 0
    v_mfma_f32_16x16x32_bf16 v[236:239], a[52:55], a[236:239], v[236:239]
    s_waitcnt lgkmcnt(5)
    buffer_load_dwordx4 v174, s[8:11], s61 offen offset:2048 lds
    v_mfma_f32_16x16x32_bf16 v[228:231], a[8:11], a[240:243], v[228:231]
    s_lshl_b32 s61, s28, 5
    s_add_u32 s61, s61, 0x6000
    s_add_u32 m0, s46, 0x16800
    v_mfma_f32_16x16x32_bf16 v[232:235], a[32:35], a[240:243], v[232:235]
    s_waitcnt lgkmcnt(4)
    v_mfma_f32_16x16x32_bf16 v[228:231], a[12:15], a[244:247], v[228:231]
    s_waitcnt lgkmcnt(3)
    v_mfma_f32_16x16x32_bf16 v[228:231], a[16:19], a[216:219], v[228:231]
    s_waitcnt lgkmcnt(2)
    v_mfma_f32_16x16x32_bf16 v[228:231], a[20:23], a[220:223], v[228:231]
    v_mfma_f32_16x16x32_bf16 v[232:235], a[36:39], a[244:247], v[232:235]
    v_mfma_f32_16x16x32_bf16 v[232:235], a[40:43], a[216:219], v[232:235]
    s_waitcnt vmcnt(6)
    ds_read_b64_tr_b16 a[156:157], v249 offset:9216
    v_mfma_f32_16x16x32_bf16 v[232:235], a[44:47], a[220:223], v[232:235]
    ds_read_b64_tr_b16 a[158:159], v250 offset:9216
    ds_read_b64_tr_b16 a[180:181], v249 offset:9248
    v_mfma_f32_16x16x32_bf16 v[236:239], a[56:59], a[240:243], v[236:239]
    ds_read_b64_tr_b16 a[182:183], v250 offset:9248
    ds_read_b64_tr_b16 a[204:205], v249 offset:9280
    v_mfma_f32_16x16x32_bf16 v[236:239], a[60:63], a[244:247], v[236:239]
    ds_read_b64_tr_b16 a[206:207], v250 offset:9280
    v_cvt_pk_bf16_f32 v150, v228, v229
    v_mfma_f32_16x16x32_bf16 v[236:239], a[64:67], a[216:219], v[236:239]
    v_cvt_pk_bf16_f32 v151, v230, v231
    v_cvt_pk_bf16_f32 v152, v232, v233
    v_mfma_f32_16x16x32_bf16 v[236:239], a[68:71], a[220:223], v[236:239]
    v_cvt_pk_bf16_f32 v153, v234, v235
    v_mfma_f32_16x16x32_bf16 v[228:231], a[232:235], a[72:75], 0
    v_mfma_f32_16x16x32_bf16 v[228:231], a[236:239], a[76:79], v[228:231]
    v_mfma_f32_16x16x32_bf16 v[228:231], a[240:243], a[80:83], v[228:231]
    v_mfma_f32_16x16x32_bf16 v[228:231], a[244:247], a[84:87], v[228:231]
    v_mfma_f32_16x16x32_bf16 v[228:231], a[216:219], a[88:91], v[228:231]
    v_mfma_f32_16x16x32_bf16 v[228:231], a[220:223], a[92:95], v[228:231]
    v_mfma_f32_16x16x32_bf16 v[232:235], a[232:235], a[96:99], 0
    v_cvt_pk_bf16_f32 v154, v236, v237
    v_cvt_pk_bf16_f32 v155, v238, v239
    v_mfma_f32_16x16x32_bf16 v[232:235], a[236:239], a[100:103], v[232:235]
    v_mfma_f32_16x16x32_bf16 v[232:235], a[240:243], a[104:107], v[232:235]
    v_mfma_f32_16x16x32_bf16 v[232:235], a[244:247], a[108:111], v[232:235]
    v_mfma_f32_16x16x32_bf16 v[232:235], a[216:219], a[112:115], v[232:235]
    v_mfma_f32_16x16x32_bf16 v[232:235], a[220:223], a[116:119], v[232:235]
    v_cvt_pk_bf16_f32 v2, v228, v229
    v_cvt_pk_bf16_f32 v5, v230, v231
    v_mfma_f32_16x16x32_bf16 v[236:239], a[232:235], a[120:123], 0
    ds_read_b128 a[232:235], v240 offset:63104
    s_waitcnt lgkmcnt(1)
    v_mfma_f32_16x16x32_bf16 v[236:239], a[236:239], a[124:127], v[236:239]
    ds_read_b128 a[236:239], v241 offset:63104
    v_mfma_f32_16x16x32_bf16 v[236:239], a[240:243], a[128:131], v[236:239]
    v_cvt_pk_bf16_f32 v32, v232, v233
    v_cvt_pk_bf16_f32 v35, v234, v235
    v_mfma_f32_16x16x32_bf16 v[236:239], a[244:247], a[132:135], v[236:239]
    ds_read_b128 a[240:243], v240 offset:63232
    ds_read_b128 a[244:247], v241 offset:63232
    v_mfma_f32_16x16x32_bf16 v[236:239], a[216:219], a[136:139], v[236:239]
    s_waitcnt vmcnt(3)
    ds_read_b64_tr_b16 a[160:161], v249 offset:0
    v_mfma_f32_16x16x32_bf16 v[236:239], a[220:223], a[140:143], v[236:239]
    ds_read_b64_tr_b16 a[162:163], v250 offset:0
    ds_read_b64_tr_b16 a[184:185], v249 offset:32
    v_mfma_f32_16x16x32_bf16 v[228:231], a[0:3], a[224:227], 0
    ds_read_b64_tr_b16 a[186:187], v250 offset:32
    ds_read_b64_tr_b16 a[208:209], v249 offset:64
    v_mfma_f32_16x16x32_bf16 v[228:231], a[4:7], a[228:231], v[228:231]
    ds_read_b64_tr_b16 a[210:211], v250 offset:64
    ds_read_b128 a[216:219], v242 offset:0
    v_mfma_f32_16x16x32_bf16 v[232:235], a[24:27], a[224:227], 0
    s_waitcnt lgkmcnt(10)
    v_cvt_pk_bf16_f32 v62, v236, v237
    v_cvt_pk_bf16_f32 v65, v238, v239
    v_mfma_f32_16x16x32_bf16 v[228:231], a[8:11], a[232:235], v[228:231]
    ds_read_b128 a[220:223], v243 offset:0
    s_waitcnt lgkmcnt(10)
    v_mfma_f32_16x16x32_bf16 v[228:231], a[12:15], a[236:239], v[228:231]
    v_mfma_f32_16x16x32_bf16 v[232:235], a[28:31], a[228:231], v[232:235]
    s_waitcnt lgkmcnt(9)
    v_mfma_f32_16x16x32_bf16 v[228:231], a[16:19], a[240:243], v[228:231]
    s_waitcnt lgkmcnt(8)
    v_mfma_f32_16x16x32_bf16 v[228:231], a[20:23], a[244:247], v[228:231]
    v_mfma_f32_16x16x32_bf16 v[232:235], a[32:35], a[232:235], v[232:235]
    v_mfma_f32_16x16x32_bf16 v[232:235], a[36:39], a[236:239], v[232:235]
    v_mfma_f32_16x16x32_bf16 v[232:235], a[40:43], a[240:243], v[232:235]
    v_mfma_f32_16x16x32_bf16 v[232:235], a[44:47], a[244:247], v[232:235]
    v_mfma_f32_16x16x32_bf16 v[236:239], a[48:51], a[224:227], 0
    v_mfma_f32_16x16x32_bf16 v[236:239], a[52:55], a[228:231], v[236:239]
    v_mfma_f32_16x16x32_bf16 v[236:239], a[56:59], a[232:235], v[236:239]
    v_mfma_f32_16x16x32_bf16 v[236:239], a[60:63], a[236:239], v[236:239]
    v_cvt_pk_bf16_f32 v156, v228, v229
    v_cvt_pk_bf16_f32 v157, v230, v231
    v_mfma_f32_16x16x32_bf16 v[236:239], a[64:67], a[240:243], v[236:239]
    v_mfma_f32_16x16x32_bf16 v[236:239], a[68:71], a[244:247], v[236:239]
    v_cvt_pk_bf16_f32 v158, v232, v233
    v_cvt_pk_bf16_f32 v159, v234, v235
    v_mfma_f32_16x16x32_bf16 v[228:231], a[224:227], a[72:75], 0
    v_mfma_f32_16x16x32_bf16 v[228:231], a[228:231], a[76:79], v[228:231]
    s_waitcnt vmcnt(0)
    ds_read_b64_tr_b16 a[164:165], v249 offset:3072
    v_mfma_f32_16x16x32_bf16 v[228:231], a[232:235], a[80:83], v[228:231]
    ds_read_b64_tr_b16 a[166:167], v250 offset:3072
    ds_read_b64_tr_b16 a[188:189], v249 offset:3104
    v_mfma_f32_16x16x32_bf16 v[228:231], a[236:239], a[84:87], v[228:231]
    ds_read_b64_tr_b16 a[190:191], v250 offset:3104
    ds_read_b64_tr_b16 a[212:213], v249 offset:3136
    v_mfma_f32_16x16x32_bf16 v[228:231], a[240:243], a[88:91], v[228:231]
    ds_read_b64_tr_b16 a[214:215], v250 offset:3136
    v_cvt_pk_bf16_f32 v160, v236, v237
    v_mfma_f32_16x16x32_bf16 v[228:231], a[244:247], a[92:95], v[228:231]
    v_cvt_pk_bf16_f32 v161, v238, v239
    v_add_u32 v249, s66, v249
    v_mfma_f32_16x16x32_bf16 v[232:235], a[224:227], a[96:99], 0
    v_add_u32 v250, s66, v250
    s_lshl_b32 s66, s28, 1
    v_mfma_f32_16x16x32_bf16 v[232:235], a[228:231], a[100:103], v[232:235]
    v_mfma_f32_16x16x32_bf16 v[232:235], a[232:235], a[104:107], v[232:235]
    v_mfma_f32_16x16x32_bf16 v[232:235], a[236:239], a[108:111], v[232:235]
    v_cvt_pk_bf16_f32 v8, v228, v229
    v_cvt_pk_bf16_f32 v11, v230, v231
    v_mfma_f32_16x16x32_bf16 v[232:235], a[240:243], a[112:115], v[232:235]
    s_waitcnt lgkmcnt(6)
    v_mfma_f32_16x16x32_bf16 v[232:235], a[244:247], a[116:119], v[232:235]
    v_mfma_f32_16x16x32_bf16 v[236:239], a[224:227], a[120:123], 0
    ds_read_b128 a[224:227], v242 offset:128
    s_waitcnt lgkmcnt(1)
    v_mfma_f32_16x16x32_bf16 v[236:239], a[228:231], a[124:127], v[236:239]
    ds_read_b128 a[228:231], v243 offset:128
    s_barrier
    v_mfma_f32_16x16x32_bf16 v[236:239], a[232:235], a[128:131], v[236:239]
    ds_read_b128 a[232:235], v242 offset:256
    v_cvt_pk_bf16_f32 v38, v232, v233
    v_mfma_f32_16x16x32_bf16 v[236:239], a[236:239], a[132:135], v[236:239]
    ds_read_b128 a[236:239], v243 offset:256
    v_cvt_pk_bf16_f32 v41, v234, v235
    v_mfma_f32_16x16x32_bf16 v[236:239], a[240:243], a[136:139], v[236:239]
    ds_read_b128 a[240:243], v240 offset:64512
    buffer_load_dwordx4 v254, s[4:7], s43 offen lds
    v_mfma_f32_16x16x32_bf16 v[236:239], a[244:247], a[140:143], v[236:239]
    ds_read_b128 a[244:247], v241 offset:64512
    v_accvgpr_read_b32 v254, a254
    v_mfma_f32_16x16x32_bf16 v[228:231], a[144:147], a[216:219], 0
    v_mfma_f32_16x16x32_bf16 v[228:231], a[148:151], a[220:223], v[228:231]
    v_mfma_f32_16x16x32_bf16 v[232:235], a[168:171], a[216:219], 0
    buffer_load_dwordx4 v255, s[4:7], s43 offen offset:1024 lds
    v_accvgpr_read_b32 v255, a252
    v_mfma_f32_16x16x32_bf16 v[232:235], a[172:175], a[220:223], v[232:235]
    s_waitcnt lgkmcnt(5)
    v_cvt_pk_bf16_f32 v68, v236, v237
    v_cvt_pk_bf16_f32 v71, v238, v239
    v_mfma_f32_16x16x32_bf16 v[228:231], a[152:155], a[224:227], v[228:231]
    s_waitcnt lgkmcnt(4)
    v_mfma_f32_16x16x32_bf16 v[228:231], a[156:159], a[228:231], v[228:231]
    s_waitcnt lgkmcnt(3)
    v_mfma_f32_16x16x32_bf16 v[228:231], a[160:163], a[232:235], v[228:231]
    buffer_load_dwordx4 v254, s[4:7], s43 offen offset:2048 lds
    s_add_u32 m0, s46, 0x17400
    v_mfma_f32_16x16x32_bf16 v[232:235], a[176:179], a[224:227], v[232:235]
    s_waitcnt lgkmcnt(2)
    v_accvgpr_read_b32 v254, a253
    v_mfma_f32_16x16x32_bf16 v[228:231], a[164:167], a[236:239], v[228:231]
    v_mfma_f32_16x16x32_bf16 v[232:235], a[180:183], a[228:231], v[232:235]
    v_mfma_f32_16x16x32_bf16 v[232:235], a[184:187], a[232:235], v[232:235]
    buffer_load_dwordx4 v255, s[4:7], s59 offen lds
    v_accvgpr_read_b32 v255, a254
    v_mfma_f32_16x16x32_bf16 v[232:235], a[188:191], a[236:239], v[232:235]
    v_mfma_f32_16x16x32_bf16 v[236:239], a[192:195], a[216:219], 0
    ds_read_b128 a[216:219], v240 offset:64640
    v_mfma_f32_16x16x32_bf16 v[236:239], a[196:199], a[220:223], v[236:239]
    v_mul_f32 v228, s38, v228
    v_mul_f32 v229, s38, v229
    v_mfma_f32_16x16x32_bf16 v[236:239], a[200:203], a[224:227], v[236:239]
    v_mul_f32 v230, s38, v230
    v_mul_f32 v231, s38, v231
    v_mfma_f32_16x16x32_bf16 v[236:239], a[204:207], a[228:231], v[236:239]
    v_cvt_pk_bf16_f32 v168, v228, v229
    v_cvt_pk_bf16_f32 v169, v230, v231
    v_mfma_f32_16x16x32_bf16 v[236:239], a[208:211], a[232:235], v[236:239]
    s_waitcnt lgkmcnt(1)
    v_mul_f32 v232, s3, v232
    v_mul_f32 v233, s3, v233
    v_mfma_f32_16x16x32_bf16 v[236:239], a[212:215], a[236:239], v[236:239]
    v_mul_f32 v234, s3, v234
    v_mul_f32 v235, s3, v235
    v_mfma_f32_16x16x32_bf16 v[228:231], a[0:3], a[240:243], 0
    v_cvt_pk_bf16_f32 v170, v232, v233
    v_cvt_pk_bf16_f32 v171, v234, v235
    v_mfma_f32_16x16x32_bf16 v[228:231], a[4:7], a[244:247], v[228:231]
    ds_read_b128 a[220:223], v241 offset:64640
    ds_read_b128 a[224:227], v240 offset:64768
    v_mfma_f32_16x16x32_bf16 v[196:199], v[102:105], v[168:171], v[196:199]
    v_mul_f32 v236, s38, v236
    v_mul_f32 v237, s38, v237
    v_mfma_f32_16x16x32_bf16 v[200:203], v[114:117], v[168:171], v[200:203]
    s_waitcnt lgkmcnt(2)
    v_mul_f32 v238, s38, v238
    v_mul_f32 v239, s38, v239
    v_mfma_f32_16x16x32_bf16 v[204:207], v[150:153], v[168:171], v[204:207]
    v_cvt_pk_bf16_f32 v172, v236, v237
    v_cvt_pk_bf16_f32 v173, v238, v239
    v_mfma_f32_16x16x32_bf16 v[208:211], v[108:111], v[168:171], v[208:211]
    ds_read_b128 a[228:231], v241 offset:64768
    ds_read_b128 a[232:235], v242 offset:1536
    v_mfma_f32_16x16x32_bf16 v[196:199], v[104:107], v[170:173], v[196:199]
    ds_read_b128 a[236:239], v243 offset:1536
    v_add_u32 v240, 0xf000, v240
    v_mfma_f32_16x16x32_bf16 v[200:203], v[116:119], v[170:173], v[200:203]
    buffer_load_dwordx4 v254, s[4:7], s59 offen offset:1024 lds
    v_add_u32 v241, 0xf000, v241
    v_mfma_f32_16x16x32_bf16 v[204:207], v[152:155], v[170:173], v[204:207]
    v_accvgpr_read_b32 v254, a252
    v_mfma_f32_16x16x32_bf16 v[208:211], v[110:113], v[170:173], v[208:211]
    v_max_f32 v248, v196, v197
    v_max3_f32 v248, v248, v198, v199
    v_mfma_f32_16x16x32_bf16 v[228:231], a[8:11], a[216:219], v[228:231]
    ds_read_b128 v[196:199], v245 offset:256
    v_max3_f32 v248, v248, v200, v201
    v_mfma_f32_16x16x32_bf16 v[232:235], a[24:27], a[240:243], 0
    buffer_load_dwordx4 v255, s[4:7], s59 offen offset:2048 lds
    s_add_u32 m0, s46, 0x18000
    v_mfma_f32_16x16x32_bf16 v[232:235], a[28:31], a[244:247], v[232:235]
    s_add_u32 s59, s44, s45
    v_accvgpr_read_b32 v255, a255
    v_max3_f32 v248, v248, v202, v203
    v_mfma_f32_16x16x32_bf16 v[232:235], a[32:35], a[216:219], v[232:235]
    ds_read_b128 v[200:203], v246 offset:256
    v_max3_f32 v248, v248, v204, v205
    v_mfma_f32_16x16x32_bf16 v[236:239], a[48:51], a[240:243], 0
    s_waitcnt lgkmcnt(6)
    v_max3_f32 v248, v248, v206, v207
    v_max3_f32 v248, v248, v208, v209
    v_mfma_f32_16x16x32_bf16 v[228:231], a[12:15], a[220:223], v[228:231]
    ds_read_b128 v[204:207], v244 offset:320
    buffer_load_dwordx4 v254, s[4:7], s58 offen lds
    v_mfma_f32_16x16x32_bf16 v[232:235], a[36:39], a[220:223], v[232:235]
    s_waitcnt lgkmcnt(6)
    v_xor_b32 v254, 16, v242
    v_add_u32 v254, 0x7500, v254
    v_mfma_f32_16x16x32_bf16 v[228:231], a[16:19], a[224:227], v[228:231]
    s_waitcnt lgkmcnt(5)
    v_cndmask_b32 v254, v242, v254, vcc
    v_max3_f32 v248, v248, v210, v211
    v_mfma_f32_16x16x32_bf16 v[228:231], a[20:23], a[228:231], v[228:231]
    ds_read_b128 v[208:211], v245 offset:320
    s_mov_b32 vcc_lo, 0x33333333
    v_mfma_f32_16x16x32_bf16 v[232:235], a[40:43], a[224:227], v[232:235]
    buffer_load_dwordx4 v255, s[4:7], s58 offen offset:512 lds
    v_xor_b32 v255, 64, v254
    v_mfma_f32_16x16x32_bf16 v[232:235], a[44:47], a[228:231], v[232:235]
    s_add_u32 m0, s46, 0
    s_lshl1_add_u32 s58, s45, s44
    v_cvt_pk_bf16_f32 v162, v228, v229
    v_mfma_f32_16x16x32_bf16 v[236:239], a[52:55], a[244:247], v[236:239]
    s_mov_b32 vcc_hi, 0x33333333
    v_cvt_pk_bf16_f32 v163, v230, v231
    s_waitcnt lgkmcnt(2)
    v_mfma_f32_16x16x32_bf16 v[196:199], v[120:123], v[168:171], v[196:199]
    v_cvt_pk_bf16_f32 v164, v232, v233
    v_cvt_pk_bf16_f32 v165, v234, v235
    v_mfma_f32_16x16x32_bf16 v[196:199], v[122:125], v[170:173], v[196:199]
    v_mfma_f32_16x16x32_bf16 v[200:203], v[156:159], v[168:171], v[200:203]
    s_waitcnt lgkmcnt(1)
    v_mfma_f32_16x16x32_bf16 v[200:203], v[158:161], v[170:173], v[200:203]
    v_mfma_f32_16x16x32_bf16 v[204:207], v[90:93], v[168:171], v[204:207]
    v_mfma_f32_16x16x32_bf16 v[204:207], v[92:95], v[170:173], v[204:207]
    s_waitcnt lgkmcnt(0)
    v_mfma_f32_16x16x32_bf16 v[208:211], v[126:129], v[168:171], v[208:211]
    v_mfma_f32_16x16x32_bf16 v[208:211], v[128:131], v[170:173], v[208:211]
    v_max3_f32 v248, v248, v196, v197
    v_max3_f32 v248, v248, v198, v199
    v_mfma_f32_16x16x32_bf16 v[236:239], a[56:59], a[216:219], v[236:239]
    ds_read_b128 v[196:199], v246 offset:320
    v_max3_f32 v248, v248, v200, v201
    v_mfma_f32_16x16x32_bf16 v[236:239], a[60:63], a[220:223], v[236:239]
    v_max3_f32 v248, v248, v202, v203
    v_max3_f32 v248, v248, v204, v205
    v_mfma_f32_16x16x32_bf16 v[236:239], a[64:67], a[224:227], v[236:239]
    ds_read_b128 v[200:203], v244 offset:192
    ds_read_b128 v[204:207], v245 offset:192
    v_mfma_f32_16x16x32_bf16 v[236:239], a[68:71], a[228:231], v[236:239]
    v_max3_f32 v248, v248, v208, v209
    v_mfma_f32_16x16x32_bf16 v[228:231], a[240:243], a[72:75], 0
    ds_read_b128 v[208:211], v246 offset:192
    v_mfma_f32_16x16x32_bf16 v[228:231], a[244:247], a[76:79], v[228:231]
    v_mfma_f32_16x16x32_bf16 v[228:231], a[216:219], a[80:83], v[228:231]
    v_mfma_f32_16x16x32_bf16 v[228:231], a[220:223], a[84:87], v[228:231]
    v_mfma_f32_16x16x32_bf16 v[228:231], a[224:227], a[88:91], v[228:231]
    v_mfma_f32_16x16x32_bf16 v[228:231], a[228:231], a[92:95], v[228:231]
    s_waitcnt lgkmcnt(3)
    v_cvt_pk_bf16_f32 v166, v236, v237
    v_cvt_pk_bf16_f32 v167, v238, v239
    v_mfma_f32_16x16x32_bf16 v[196:199], v[162:165], v[168:171], v[196:199]
    v_mfma_f32_16x16x32_bf16 v[232:235], a[240:243], a[96:99], 0
    s_waitcnt lgkmcnt(2)
    s_waitcnt lgkmcnt(1)
    v_mfma_f32_16x16x32_bf16 v[196:199], v[164:167], v[170:173], v[196:199]
    v_cvt_pk_bf16_f32 v14, v228, v229
    v_cvt_pk_bf16_f32 v17, v230, v231
    v_mfma_f32_16x16x32_bf16 v[200:203], v[102:105], v[168:171], v[200:203]
    s_waitcnt lgkmcnt(0)
    v_mfma_f32_16x16x32_bf16 v[200:203], v[104:107], v[170:173], v[200:203]
    v_mfma_f32_16x16x32_bf16 v[204:207], v[114:117], v[168:171], v[204:207]
    v_mfma_f32_16x16x32_bf16 v[204:207], v[116:119], v[170:173], v[204:207]
    v_mfma_f32_16x16x32_bf16 v[208:211], v[150:153], v[168:171], v[208:211]
    v_max3_f32 v248, v248, v196, v197
    v_mov_b32 v225, v248
    v_mfma_f32_16x16x32_bf16 v[208:211], v[152:155], v[170:173], v[208:211]
    ds_read_b128 v[196:199], v244 offset:256
    v_permlane16_swap_b32 v248, v225
    v_mfma_f32_16x16x32_bf16 v[232:235], a[244:247], a[100:103], v[232:235]
    v_max_f32 v248, v248, v225
    v_mov_b32 v225, v248
    v_mfma_f32_16x16x32_bf16 v[232:235], a[216:219], a[104:107], v[232:235]
    v_mfma_f32_16x16x32_bf16 v[232:235], a[220:223], a[108:111], v[232:235]
    v_permlane32_swap_b32 v248, v225
    v_max_f32 v248, v248, v225
    v_mfma_f32_16x16x32_bf16 v[232:235], a[224:227], a[112:115], v[232:235]
    v_sub_f32 v200, v200, v248
    v_sub_f32 v201, v201, v248
    v_mfma_f32_16x16x32_bf16 v[232:235], a[228:231], a[116:119], v[232:235]
    v_exp_f32 v200, v200
    v_mfma_f32_16x16x32_bf16 v[236:239], a[240:243], a[120:123], 0
    ds_read_b128 a[240:243], v242 offset:1664
    v_sub_f32 v202, v202, v248
    v_mfma_f32_16x16x32_bf16 v[236:239], a[244:247], a[124:127], v[236:239]
    ds_read_b128 a[244:247], v243 offset:1664
    v_sub_f32 v203, v203, v248
    v_mfma_f32_16x16x32_bf16 v[236:239], a[216:219], a[128:131], v[236:239]
    v_cvt_pk_bf16_f32 v44, v232, v233
    v_cvt_pk_bf16_f32 v47, v234, v235
    v_mfma_f32_16x16x32_bf16 v[236:239], a[220:223], a[132:135], v[236:239]
    ds_read_b128 a[216:219], v242 offset:1792
    ds_read_b128 a[220:223], v243 offset:1792
    v_mfma_f32_16x16x32_bf16 v[236:239], a[224:227], a[136:139], v[236:239]
    ds_read_b128 a[224:227], v240 offset:4608
    v_sub_f32 v204, v204, v248
    v_mfma_f32_16x16x32_bf16 v[236:239], a[228:231], a[140:143], v[236:239]
    ds_read_b128 a[228:231], v241 offset:4608
    v_sub_f32 v205, v205, v248
    v_mfma_f32_16x16x32_bf16 v[228:231], a[144:147], a[232:235], 0
    s_waitcnt lgkmcnt(6)
    v_exp_f32 v201, v201
    v_mfma_f32_16x16x32_bf16 v[196:199], v[108:111], v[168:171], v[196:199]
    v_exp_f32 v202, v202
    v_mfma_f32_16x16x32_bf16 v[196:199], v[110:113], v[170:173], v[196:199]
    v_cvt_pk_bf16_f32 v74, v236, v237
    v_cvt_pk_bf16_f32 v77, v238, v239
    v_mfma_f32_16x16x32_bf16 v[228:231], a[148:151], a[236:239], v[228:231]
    s_waitcnt lgkmcnt(5)
    v_exp_f32 v203, v203
    v_mfma_f32_16x16x32_bf16 v[228:231], a[152:155], a[240:243], v[228:231]
    s_waitcnt lgkmcnt(4)
    v_cvt_pk_bf16_f32 v180, v200, v201
    v_cvt_pk_bf16_f32 v183, v202, v203
    v_mfma_f32_16x16x32_bf16 v[228:231], a[156:159], a[244:247], v[228:231]
    ds_read_b128 v[200:203], v245 offset:256
    v_sub_f32 v206, v206, v248
    v_mfma_f32_16x16x32_bf16 v[232:235], a[168:171], a[232:235], 0
    s_waitcnt lgkmcnt(4)
    v_exp_f32 v204, v204
    v_mfma_f32_16x16x32_bf16 v[228:231], a[160:163], a[216:219], v[228:231]
    s_waitcnt lgkmcnt(3)
    v_exp_f32 v205, v205
    v_mfma_f32_16x16x32_bf16 v[228:231], a[164:167], a[220:223], v[228:231]
    v_exp_f32 v206, v206
    v_mfma_f32_16x16x32_bf16 v[232:235], a[172:175], a[236:239], v[232:235]
    v_sub_f32 v207, v207, v248
    v_cvt_pk_bf16_f32 v181, v204, v205
    v_mfma_f32_16x16x32_bf16 v[232:235], a[176:179], a[240:243], v[232:235]
    v_exp_f32 v207, v207
    v_mfma_f32_16x16x32_bf16 v[232:235], a[180:183], a[244:247], v[232:235]
    v_cvt_pk_bf16_f32 v184, v206, v207
    v_mul_f32 v228, s38, v228
    v_mfma_f32_16x16x32_bf16 v[232:235], a[184:187], a[216:219], v[232:235]
    v_mul_f32 v229, s38, v229
    v_mul_f32 v230, s38, v230
    v_mfma_f32_16x16x32_bf16 v[232:235], a[188:191], a[220:223], v[232:235]
    v_mul_f32 v231, s38, v231
    v_cvt_pk_bf16_f32 v174, v228, v229
    v_mfma_f32_16x16x32_bf16 v[236:239], a[192:195], a[232:235], 0
    ds_read_b128 a[232:235], v240 offset:4736
    v_cvt_pk_bf16_f32 v175, v230, v231
    v_mfma_f32_16x16x32_bf16 v[236:239], a[196:199], a[236:239], v[236:239]
    ds_read_b128 a[236:239], v241 offset:4736
    ds_read_b128 v[204:207], v246 offset:256
    v_mfma_f32_16x16x32_bf16 v[236:239], a[200:203], a[240:243], v[236:239]
    s_waitcnt lgkmcnt(3)
    v_mul_f32 v232, s3, v232
    v_mul_f32 v233, s3, v233
    v_mfma_f32_16x16x32_bf16 v[200:203], v[120:123], v[168:171], v[200:203]
    v_mul_f32 v234, s3, v234
    v_mul_f32 v235, s3, v235
    v_mfma_f32_16x16x32_bf16 v[200:203], v[122:125], v[170:173], v[200:203]
    v_cvt_pk_bf16_f32 v176, v232, v233
    v_cvt_pk_bf16_f32 v177, v234, v235
    v_mfma_f32_16x16x32_bf16 v[236:239], a[204:207], a[244:247], v[236:239]
    ds_read_b128 a[240:243], v240 offset:4864
    ds_read_b128 a[244:247], v241 offset:4864
    v_mfma_f32_16x16x32_bf16 v[236:239], a[208:211], a[216:219], v[236:239]
    ds_read_b128 a[216:219], v242 offset:3072
    v_sub_f32 v208, v208, v248
    v_mfma_f32_16x16x32_bf16 v[236:239], a[212:215], a[220:223], v[236:239]
    ds_read_b128 a[220:223], v243 offset:3072
    v_sub_f32 v209, v209, v248
    v_mfma_f32_16x16x32_bf16 v[228:231], a[0:3], a[224:227], 0
    v_exp_f32 v208, v208
    v_mfma_f32_16x16x32_bf16 v[228:231], a[4:7], a[228:231], v[228:231]
    s_waitcnt lgkmcnt(6)
    v_exp_f32 v209, v209
    v_mfma_f32_16x16x32_bf16 v[228:231], a[8:11], a[232:235], v[228:231]
    s_waitcnt lgkmcnt(4)
    v_mul_f32 v236, s38, v236
    v_mul_f32 v237, s38, v237
    v_mfma_f32_16x16x32_bf16 v[204:207], v[156:159], v[168:171], v[204:207]
    v_mul_f32 v238, s38, v238
    v_mul_f32 v239, s38, v239
    v_mfma_f32_16x16x32_bf16 v[204:207], v[158:161], v[170:173], v[204:207]
    v_cvt_pk_bf16_f32 v178, v236, v237
    v_cvt_pk_bf16_f32 v179, v238, v239
    v_mfma_f32_16x16x32_bf16 v[228:231], a[12:15], a[236:239], v[228:231]
    v_sub_f32 v210, v210, v248
    v_sub_f32 v211, v211, v248
    v_mfma_f32_16x16x32_bf16 v[232:235], a[24:27], a[224:227], 0
    s_waitcnt lgkmcnt(3)
    v_exp_f32 v210, v210
    v_mfma_f32_16x16x32_bf16 v[228:231], a[16:19], a[240:243], v[228:231]
    s_waitcnt lgkmcnt(2)
    v_exp_f32 v211, v211
    v_mfma_f32_16x16x32_bf16 v[228:231], a[20:23], a[244:247], v[228:231]
    v_cvt_pk_bf16_f32 v182, v208, v209
    v_cvt_pk_bf16_f32 v185, v210, v211
    v_mfma_f32_16x16x32_bf16 v[232:235], a[28:31], a[228:231], v[232:235]
    ds_read_b128 v[208:211], v244 offset:320
    v_sub_f32 v196, v196, v248
    v_mfma_f32_16x16x32_bf16 v[212:215], v[0:3], v[180:183], 0
    v_exp_f32 v196, v196
    v_mfma_f32_16x16x32_bf16 v[216:219], v[30:33], v[180:183], 0
    v_cvt_pk_bf16_f32 v102, v228, v229
    v_cvt_pk_bf16_f32 v103, v230, v231
    v_mfma_f32_16x16x32_bf16 v[220:223], v[60:63], v[180:183], 0
    v_sub_f32 v197, v197, v248
    v_sub_f32 v198, v198, v248
    v_mfma_f32_16x16x32_bf16 v[224:227], a[248:251], v[180:183], 0
    v_exp_f32 v197, v197
    v_mfma_f32_16x16x32_bf16 v[232:235], a[32:35], a[232:235], v[232:235]
    v_exp_f32 v198, v198
    v_mfma_f32_16x16x32_bf16 v[232:235], a[36:39], a[236:239], v[232:235]
    v_sub_f32 v199, v199, v248
    v_cvt_pk_bf16_f32 v186, v196, v197
    v_mfma_f32_16x16x32_bf16 v[232:235], a[40:43], a[240:243], v[232:235]
    v_exp_f32 v199, v199
    v_mfma_f32_16x16x32_bf16 v[232:235], a[44:47], a[244:247], v[232:235]
    v_cvt_pk_bf16_f32 v189, v198, v199
    v_sub_f32 v200, v200, v248
    v_mfma_f32_16x16x32_bf16 v[236:239], a[48:51], a[224:227], 0
    ds_read_b128 v[196:199], v245 offset:320
    v_sub_f32 v201, v201, v248
    v_mfma_f32_16x16x32_bf16 v[236:239], a[52:55], a[228:231], v[236:239]
    s_waitcnt lgkmcnt(1)
    v_exp_f32 v200, v200
    v_mfma_f32_16x16x32_bf16 v[208:211], v[90:93], v[168:171], v[208:211]
    v_cvt_pk_bf16_f32 v104, v232, v233
    v_cvt_pk_bf16_f32 v105, v234, v235
    v_mfma_f32_16x16x32_bf16 v[208:211], v[92:95], v[170:173], v[208:211]
    v_exp_f32 v201, v201
    v_mfma_f32_16x16x32_bf16 v[236:239], a[56:59], a[232:235], v[236:239]
    v_sub_f32 v202, v202, v248
    v_sub_f32 v203, v203, v248
    v_mfma_f32_16x16x32_bf16 v[236:239], a[60:63], a[236:239], v[236:239]
    v_exp_f32 v202, v202
    v_mfma_f32_16x16x32_bf16 v[236:239], a[64:67], a[240:243], v[236:239]
    v_exp_f32 v203, v203
    v_mfma_f32_16x16x32_bf16 v[236:239], a[68:71], a[244:247], v[236:239]
    v_cvt_pk_bf16_f32 v187, v200, v201
    v_cvt_pk_bf16_f32 v190, v202, v203
    v_mfma_f32_16x16x32_bf16 v[228:231], a[224:227], a[72:75], 0
    ds_read_b128 v[200:203], v246 offset:320
    v_sub_f32 v204, v204, v248
    v_mfma_f32_16x16x32_bf16 v[212:215], v[4:7], v[184:187], v[212:215]
    s_waitcnt lgkmcnt(1)
    v_exp_f32 v204, v204
    v_mfma_f32_16x16x32_bf16 v[216:219], v[34:37], v[184:187], v[216:219]
    v_cvt_pk_bf16_f32 v106, v236, v237
    v_cvt_pk_bf16_f32 v107, v238, v239
    v_mfma_f32_16x16x32_bf16 v[220:223], v[64:67], v[184:187], v[220:223]
    v_sub_f32 v205, v205, v248
    v_sub_f32 v206, v206, v248
    v_mfma_f32_16x16x32_bf16 v[224:227], a[248:251], v[184:187], v[224:227]
    v_exp_f32 v205, v205
    v_mfma_f32_16x16x32_bf16 v[196:199], v[126:129], v[168:171], v[196:199]
    v_exp_f32 v206, v206
    v_mfma_f32_16x16x32_bf16 v[196:199], v[128:131], v[170:173], v[196:199]
    v_sub_f32 v207, v207, v248
    v_cvt_pk_bf16_f32 v188, v204, v205
    v_mfma_f32_16x16x32_bf16 v[228:231], a[228:231], a[76:79], v[228:231]
    v_exp_f32 v207, v207
    v_mfma_f32_16x16x32_bf16 v[228:231], a[232:235], a[80:83], v[228:231]
    v_cvt_pk_bf16_f32 v191, v206, v207
    v_sub_f32 v208, v208, v248
    v_mfma_f32_16x16x32_bf16 v[228:231], a[236:239], a[84:87], v[228:231]
    ds_read_b128 v[204:207], v244 offset:0
    v_sub_f32 v209, v209, v248
    v_mfma_f32_16x16x32_bf16 v[212:215], v[8:11], v[188:191], v[212:215]
    s_waitcnt lgkmcnt(1)
    v_exp_f32 v208, v208
    v_mfma_f32_16x16x32_bf16 v[216:219], v[38:41], v[188:191], v[216:219]
    v_exp_f32 v209, v209
    v_mfma_f32_16x16x32_bf16 v[220:223], v[68:71], v[188:191], v[220:223]
    v_cvt_pk_bf16_f32 v192, v208, v209
    v_sub_f32 v196, v196, v248
    v_mfma_f32_16x16x32_bf16 v[224:227], a[248:251], v[188:191], v[224:227]
    ds_read_b128 v[208:211], v245 offset:0
    v_sub_f32 v197, v197, v248
    v_mfma_f32_16x16x32_bf16 v[200:203], v[162:165], v[168:171], v[200:203]
    v_exp_f32 v196, v196
    v_mfma_f32_16x16x32_bf16 v[200:203], v[164:167], v[170:173], v[200:203]
    v_exp_f32 v197, v197
    v_mfma_f32_16x16x32_bf16 v[228:231], a[240:243], a[88:91], v[228:231]
    v_cvt_pk_bf16_f32 v193, v196, v197
    v_mfma_f32_16x16x32_bf16 v[228:231], a[244:247], a[92:95], v[228:231]
    ds_read_b128 v[196:199], v246 offset:0
    s_waitcnt lgkmcnt(2)
    v_mfma_f32_16x16x32_bf16 v[204:207], v[108:111], v[174:177], v[204:207]
    v_mfma_f32_16x16x32_bf16 v[204:207], v[110:113], v[176:179], v[204:207]
    v_sub_f32 v200, v200, v248
    v_sub_f32 v201, v201, v248
    v_mfma_f32_16x16x32_bf16 v[232:235], a[224:227], a[96:99], 0
    v_exp_f32 v200, v200
    v_mfma_f32_16x16x32_bf16 v[232:235], a[228:231], a[100:103], v[232:235]
    v_cvt_pk_bf16_f32 v20, v228, v229
    v_cvt_pk_bf16_f32 v23, v230, v231
    v_mfma_f32_16x16x32_bf16 v[232:235], a[232:235], a[104:107], v[232:235]
    s_waitcnt lgkmcnt(1)
    v_exp_f32 v201, v201
    v_mfma_f32_16x16x32_bf16 v[208:211], v[120:123], v[174:177], v[208:211]
    v_cvt_pk_bf16_f32 v194, v200, v201
    v_max_f32 v248, v204, v205
    v_mfma_f32_16x16x32_bf16 v[208:211], v[122:125], v[176:179], v[208:211]
    ds_read_b128 v[200:203], v244 offset:64
    v_max3_f32 v248, v248, v206, v207
    v_mfma_f32_16x16x32_bf16 v[212:215], v[12:15], v[192:195], v[212:215]
    ds_read_b128 v[204:207], v245 offset:64
    s_waitcnt lgkmcnt(2)
    v_mfma_f32_16x16x32_bf16 v[216:219], v[42:45], v[192:195], v[216:219]
    v_mfma_f32_16x16x32_bf16 v[220:223], v[72:75], v[192:195], v[220:223]
    v_mfma_f32_16x16x32_bf16 v[224:227], a[248:251], v[192:195], v[224:227]
    v_max3_f32 v248, v248, v208, v209
    v_max3_f32 v248, v248, v210, v211
    v_mfma_f32_16x16x32_bf16 v[196:199], v[156:159], v[174:177], v[196:199]
    ds_read_b128 v[208:211], v246 offset:64
    v_mfma_f32_16x16x32_bf16 v[196:199], v[158:161], v[176:179], v[196:199]
    v_mfma_f32_16x16x32_bf16 v[232:235], a[236:239], a[108:111], v[232:235]
    v_mfma_f32_16x16x32_bf16 v[232:235], a[240:243], a[112:115], v[232:235]
    v_mfma_f32_16x16x32_bf16 v[232:235], a[244:247], a[116:119], v[232:235]
    s_waitcnt lgkmcnt(2)
    v_rcp_f32 v225, v224
    v_mfma_f32_16x16x32_bf16 v[200:203], v[90:93], v[174:177], v[200:203]
    s_waitcnt lgkmcnt(1)
    v_mul_f32 v212, v212, v225
    v_mul_f32 v213, v213, v225
    v_mfma_f32_16x16x32_bf16 v[200:203], v[92:95], v[176:179], v[200:203]
    v_mul_f32 v214, v214, v225
    v_cvt_pk_bf16_f32 v50, v232, v233
    v_mfma_f32_16x16x32_bf16 v[204:207], v[126:129], v[174:177], v[204:207]
    v_cvt_pk_bf16_f32 v53, v234, v235
    v_mul_f32 v215, v215, v225
    v_mfma_f32_16x16x32_bf16 v[204:207], v[128:131], v[176:179], v[204:207]
    v_cvt_pk_bf16_f32 v212, v212, v213
    v_cvt_pk_bf16_f32 v213, v214, v215
    v_mfma_f32_16x16x32_bf16 v[236:239], a[224:227], a[120:123], 0
    ds_read_b128 a[224:227], v242 offset:3200
    v_mul_f32 v216, v216, v225
    v_mfma_f32_16x16x32_bf16 v[236:239], a[228:231], a[124:127], v[236:239]
    ds_read_b128 a[228:231], v243 offset:3200
    v_mul_f32 v217, v217, v225
    v_mfma_f32_16x16x32_bf16 v[236:239], a[232:235], a[128:131], v[236:239]
    ds_read_b128 a[232:235], v242 offset:3328
    v_mul_f32 v218, v218, v225
    v_mfma_f32_16x16x32_bf16 v[236:239], a[236:239], a[132:135], v[236:239]
    ds_read_b128 a[236:239], v243 offset:3328
    v_mul_f32 v219, v219, v225
    v_mfma_f32_16x16x32_bf16 v[236:239], a[240:243], a[136:139], v[236:239]
    ds_read_b128 a[240:243], v240 offset:6144
    v_cvt_pk_bf16_f32 v216, v216, v217
    v_mfma_f32_16x16x32_bf16 v[236:239], a[244:247], a[140:143], v[236:239]
    ds_read_b128 a[244:247], v241 offset:6144
    v_cvt_pk_bf16_f32 v217, v218, v219
    v_mfma_f32_16x16x32_bf16 v[228:231], a[144:147], a[216:219], 0
    ds_write_b64 v251, v[212:213] offset:0
    v_mfma_f32_16x16x32_bf16 v[228:231], a[148:151], a[220:223], v[228:231]
    ds_write_b64 v251, v[216:217] offset:128
    v_mfma_f32_16x16x32_bf16 v[232:235], a[168:171], a[216:219], 0
    s_waitcnt lgkmcnt(7)
    v_cvt_pk_bf16_f32 v80, v236, v237
    v_cvt_pk_bf16_f32 v83, v238, v239
    v_mfma_f32_16x16x32_bf16 v[208:211], v[162:165], v[174:177], v[208:211]
    v_mul_f32 v220, v220, v225
    v_mul_f32 v221, v221, v225
    v_mfma_f32_16x16x32_bf16 v[208:211], v[164:167], v[176:179], v[208:211]
    v_mul_f32 v222, v222, v225
    v_mul_f32 v223, v223, v225
    v_mfma_f32_16x16x32_bf16 v[228:231], a[152:155], a[224:227], v[228:231]
    s_waitcnt lgkmcnt(6)
    v_cvt_pk_bf16_f32 v220, v220, v221
    v_cvt_pk_bf16_f32 v221, v222, v223
    v_mfma_f32_16x16x32_bf16 v[228:231], a[156:159], a[228:231], v[228:231]
    ds_write_b64 v251, v[220:221] offset:256
    v_mfma_f32_16x16x32_bf16 v[232:235], a[172:175], a[220:223], v[232:235]
    s_waitcnt lgkmcnt(6)
    v_max3_f32 v248, v248, v196, v197
    v_max3_f32 v248, v248, v198, v199
    v_mfma_f32_16x16x32_bf16 v[228:231], a[160:163], a[232:235], v[228:231]
    ds_read_b128 v[196:199], v244 offset:128
    v_max3_f32 v248, v248, v200, v201
    v_mfma_f32_16x16x32_bf16 v[232:235], a[176:179], a[224:227], v[232:235]
    s_waitcnt lgkmcnt(6)
    v_max3_f32 v248, v248, v202, v203
    v_max3_f32 v248, v248, v204, v205
    v_mfma_f32_16x16x32_bf16 v[228:231], a[164:167], a[236:239], v[228:231]
    ds_read_b128 v[200:203], v245 offset:128
    v_max3_f32 v248, v248, v206, v207
    v_mfma_f32_16x16x32_bf16 v[232:235], a[180:183], a[228:231], v[232:235]
    ds_read_b128 v[204:207], v246 offset:128
    v_max3_f32 v248, v248, v208, v209
    v_mfma_f32_16x16x32_bf16 v[232:235], a[184:187], a[232:235], v[232:235]
    v_max3_f32 v248, v248, v210, v211
    v_mfma_f32_16x16x32_bf16 v[232:235], a[188:191], a[236:239], v[232:235]
    v_mul_f32 v228, s38, v228
    v_mul_f32 v229, s38, v229
    v_mfma_f32_16x16x32_bf16 v[236:239], a[192:195], a[216:219], 0
    v_mul_f32 v230, s38, v230
    v_mul_f32 v231, s38, v231
    v_mfma_f32_16x16x32_bf16 v[236:239], a[196:199], a[220:223], v[236:239]
    v_cvt_pk_bf16_f32 v168, v228, v229
    v_cvt_pk_bf16_f32 v169, v230, v231
    v_mfma_f32_16x16x32_bf16 v[236:239], a[200:203], a[224:227], v[236:239]
    s_waitcnt lgkmcnt(4)
    v_mul_f32 v232, s3, v232
    v_mul_f32 v233, s3, v233
    v_mfma_f32_16x16x32_bf16 v[236:239], a[204:207], a[228:231], v[236:239]
    s_waitcnt lgkmcnt(2)
    v_mul_f32 v234, s3, v234
    v_mul_f32 v235, s3, v235
    v_mfma_f32_16x16x32_bf16 v[196:199], v[96:99], v[174:177], v[196:199]
    v_cvt_pk_bf16_f32 v170, v232, v233
    v_cvt_pk_bf16_f32 v171, v234, v235
    v_mfma_f32_16x16x32_bf16 v[196:199], v[98:101], v[176:179], v[196:199]
    ds_read_b128 a[216:219], v240 offset:6272
    ds_read_b128 a[220:223], v241 offset:6272
    v_mfma_f32_16x16x32_bf16 v[236:239], a[208:211], a[232:235], v[236:239]
    ds_read_b128 a[224:227], v240 offset:6400
    ds_read_b128 a[228:231], v241 offset:6400
    v_mfma_f32_16x16x32_bf16 v[236:239], a[212:215], a[236:239], v[236:239]
    ds_read_b128 a[232:235], v254 offset:4608
    ds_read_b128 a[236:239], v255 offset:4608
    v_mfma_f32_16x16x32_bf16 v[228:231], a[0:3], a[240:243], 0
    ds_read_b128 v[208:211], v244 offset:0
    v_max3_f32 v248, v248, v196, v197
    v_mfma_f32_16x16x32_bf16 v[228:231], a[4:7], a[244:247], v[228:231]
    ds_read_b128 v[196:199], v245 offset:0
    s_waitcnt lgkmcnt(8)
    v_mfma_f32_16x16x32_bf16 v[200:203], v[132:135], v[174:177], v[200:203]
    v_mul_f32 v236, s38, v236
    v_mul_f32 v237, s38, v237
    v_mfma_f32_16x16x32_bf16 v[200:203], v[134:137], v[176:179], v[200:203]
    v_mul_f32 v238, s38, v238
    v_mul_f32 v239, s38, v239
    v_mfma_f32_16x16x32_bf16 v[204:207], v[102:105], v[174:177], v[204:207]
    v_cvt_pk_bf16_f32 v172, v236, v237
    v_cvt_pk_bf16_f32 v173, v238, v239
    v_mfma_f32_16x16x32_bf16 v[204:207], v[104:107], v[176:179], v[204:207]
    s_waitcnt lgkmcnt(7)
    v_mfma_f32_16x16x32_bf16 v[228:231], a[8:11], a[216:219], v[228:231]
    s_waitcnt lgkmcnt(6)
    v_max3_f32 v248, v248, v200, v201
    v_mfma_f32_16x16x32_bf16 v[228:231], a[12:15], a[220:223], v[228:231]
    ds_read_b128 v[200:203], v246 offset:0
    s_waitcnt lgkmcnt(6)
    v_mfma_f32_16x16x32_bf16 v[228:231], a[16:19], a[224:227], v[228:231]
    s_waitcnt lgkmcnt(5)
    v_max3_f32 v248, v248, v204, v205
    v_mov_b32 v225, v248
    v_mfma_f32_16x16x32_bf16 v[228:231], a[20:23], a[228:231], v[228:231]
    ds_read_b128 v[204:207], v244 offset:64
    v_permlane16_swap_b32 v248, v225
    v_mfma_f32_16x16x32_bf16 v[232:235], a[24:27], a[240:243], 0
    v_max_f32 v248, v248, v225
    v_mov_b32 v225, v248
    v_mfma_f32_16x16x32_bf16 v[232:235], a[28:31], a[244:247], v[232:235]
    s_waitcnt lgkmcnt(3)
    v_permlane32_swap_b32 v248, v225
    v_max_f32 v248, v248, v225
    v_mfma_f32_16x16x32_bf16 v[208:211], v[108:111], v[174:177], v[208:211]
    s_waitcnt lgkmcnt(2)
    v_cvt_pk_bf16_f32 v108, v228, v229
    v_cvt_pk_bf16_f32 v109, v230, v231
    v_mfma_f32_16x16x32_bf16 v[208:211], v[110:113], v[176:179], v[208:211]
    v_mfma_f32_16x16x32_bf16 v[196:199], v[120:123], v[174:177], v[196:199]
    v_mfma_f32_16x16x32_bf16 v[196:199], v[122:125], v[176:179], v[196:199]
    v_mfma_f32_16x16x32_bf16 v[232:235], a[32:35], a[216:219], v[232:235]
    s_waitcnt lgkmcnt(1)
    v_mfma_f32_16x16x32_bf16 v[200:203], v[156:159], v[174:177], v[200:203]
    v_mfma_f32_16x16x32_bf16 v[200:203], v[158:161], v[176:179], v[200:203]
    s_waitcnt lgkmcnt(0)
    v_mfma_f32_16x16x32_bf16 v[204:207], v[90:93], v[174:177], v[204:207]
    v_sub_f32 v208, v208, v248
    v_sub_f32 v209, v209, v248
    v_mfma_f32_16x16x32_bf16 v[204:207], v[92:95], v[176:179], v[204:207]
    v_exp_f32 v208, v208
    v_mfma_f32_16x16x32_bf16 v[232:235], a[36:39], a[220:223], v[232:235]
    v_exp_f32 v209, v209
    v_mfma_f32_16x16x32_bf16 v[232:235], a[40:43], a[224:227], v[232:235]
    v_sub_f32 v210, v210, v248
    v_sub_f32 v211, v211, v248
    v_mfma_f32_16x16x32_bf16 v[232:235], a[44:47], a[228:231], v[232:235]
    v_exp_f32 v210, v210
    v_mfma_f32_16x16x32_bf16 v[236:239], a[48:51], a[240:243], 0
    v_exp_f32 v211, v211
    v_mfma_f32_16x16x32_bf16 v[236:239], a[52:55], a[244:247], v[236:239]
    v_cvt_pk_bf16_f32 v180, v208, v209
    v_cvt_pk_bf16_f32 v183, v210, v211
    v_mfma_f32_16x16x32_bf16 v[236:239], a[56:59], a[216:219], v[236:239]
    ds_read_b128 v[208:211], v245 offset:64
    v_cvt_pk_bf16_f32 v110, v232, v233
    v_mfma_f32_16x16x32_bf16 v[236:239], a[60:63], a[220:223], v[236:239]
    v_cvt_pk_bf16_f32 v111, v234, v235
    v_sub_f32 v196, v196, v248
    v_mfma_f32_16x16x32_bf16 v[236:239], a[64:67], a[224:227], v[236:239]
    v_exp_f32 v196, v196
    v_mfma_f32_16x16x32_bf16 v[236:239], a[68:71], a[228:231], v[236:239]
    v_sub_f32 v197, v197, v248
    v_sub_f32 v198, v198, v248
    v_mfma_f32_16x16x32_bf16 v[228:231], a[240:243], a[72:75], 0
    v_exp_f32 v197, v197
    v_mfma_f32_16x16x32_bf16 v[228:231], a[244:247], a[76:79], v[228:231]
    v_exp_f32 v198, v198
    v_mfma_f32_16x16x32_bf16 v[228:231], a[216:219], a[80:83], v[228:231]
    v_sub_f32 v199, v199, v248
    v_cvt_pk_bf16_f32 v112, v236, v237
    v_mfma_f32_16x16x32_bf16 v[228:231], a[220:223], a[84:87], v[228:231]
    v_cvt_pk_bf16_f32 v113, v238, v239
    v_cvt_pk_bf16_f32 v181, v196, v197
    v_mfma_f32_16x16x32_bf16 v[228:231], a[224:227], a[88:91], v[228:231]
    v_exp_f32 v199, v199
    v_mfma_f32_16x16x32_bf16 v[228:231], a[228:231], a[92:95], v[228:231]
    s_waitcnt lgkmcnt(0)
    v_cvt_pk_bf16_f32 v184, v198, v199
    v_sub_f32 v200, v200, v248
    v_mfma_f32_16x16x32_bf16 v[208:211], v[126:129], v[174:177], v[208:211]
    ds_read_b128 v[196:199], v246 offset:64
    v_sub_f32 v201, v201, v248
    v_mfma_f32_16x16x32_bf16 v[208:211], v[128:131], v[176:179], v[208:211]
    v_exp_f32 v200, v200
    v_mfma_f32_16x16x32_bf16 v[232:235], a[240:243], a[96:99], 0
    v_cvt_pk_bf16_f32 v26, v228, v229
    v_cvt_pk_bf16_f32 v29, v230, v231
    v_mfma_f32_16x16x32_bf16 v[232:235], a[244:247], a[100:103], v[232:235]
    v_exp_f32 v201, v201
    v_mfma_f32_16x16x32_bf16 v[232:235], a[216:219], a[104:107], v[232:235]
    v_sub_f32 v202, v202, v248
    v_sub_f32 v203, v203, v248
    v_mfma_f32_16x16x32_bf16 v[232:235], a[220:223], a[108:111], v[232:235]
    v_exp_f32 v202, v202
    v_mfma_f32_16x16x32_bf16 v[232:235], a[224:227], a[112:115], v[232:235]
    v_exp_f32 v203, v203
    v_mfma_f32_16x16x32_bf16 v[232:235], a[228:231], a[116:119], v[232:235]
    v_cvt_pk_bf16_f32 v182, v200, v201
    v_cvt_pk_bf16_f32 v185, v202, v203
    v_mfma_f32_16x16x32_bf16 v[236:239], a[240:243], a[120:123], 0
    ds_read_b128 a[240:243], v254 offset:4736
    ds_read_b128 v[200:203], v244 offset:128
    v_mfma_f32_16x16x32_bf16 v[212:215], v[6:9], v[180:183], 0
    s_waitcnt lgkmcnt(2)
    v_sub_f32 v204, v204, v248
    v_cvt_pk_bf16_f32 v56, v232, v233
    v_mfma_f32_16x16x32_bf16 v[216:219], v[36:39], v[180:183], 0
    v_cvt_pk_bf16_f32 v59, v234, v235
    v_sub_f32 v205, v205, v248
    v_mfma_f32_16x16x32_bf16 v[220:223], v[66:69], v[180:183], 0
    v_exp_f32 v204, v204
    v_mfma_f32_16x16x32_bf16 v[224:227], a[248:251], v[180:183], 0
    v_exp_f32 v205, v205
    v_mfma_f32_16x16x32_bf16 v[196:199], v[162:165], v[174:177], v[196:199]
    v_sub_f32 v206, v206, v248
    v_sub_f32 v207, v207, v248
    v_mfma_f32_16x16x32_bf16 v[196:199], v[164:167], v[176:179], v[196:199]
    v_exp_f32 v206, v206
    v_mfma_f32_16x16x32_bf16 v[236:239], a[244:247], a[124:127], v[236:239]
    ds_read_b128 a[244:247], v255 offset:4736
    v_cvt_pk_bf16_f32 v186, v204, v205
    v_mfma_f32_16x16x32_bf16 v[236:239], a[216:219], a[128:131], v[236:239]
    ds_read_b128 a[216:219], v254 offset:4864
    v_sub_f32 v208, v208, v248
    v_mfma_f32_16x16x32_bf16 v[236:239], a[220:223], a[132:135], v[236:239]
    ds_read_b128 a[220:223], v255 offset:4864
    v_sub_f32 v209, v209, v248
    v_mfma_f32_16x16x32_bf16 v[236:239], a[224:227], a[136:139], v[236:239]
    s_waitcnt lgkmcnt(3)
    v_exp_f32 v207, v207
    v_mfma_f32_16x16x32_bf16 v[200:203], v[96:99], v[174:177], v[200:203]
    v_cvt_pk_bf16_f32 v189, v206, v207
    v_sub_f32 v210, v210, v248
    v_mfma_f32_16x16x32_bf16 v[200:203], v[98:101], v[176:179], v[200:203]
    ds_read_b128 v[204:207], v245 offset:128
    v_sub_f32 v211, v211, v248
    v_mfma_f32_16x16x32_bf16 v[236:239], a[228:231], a[140:143], v[236:239]
    v_exp_f32 v208, v208
    v_mfma_f32_16x16x32_bf16 v[228:231], a[144:147], a[232:235], 0
    v_exp_f32 v209, v209
    v_mfma_f32_16x16x32_bf16 v[228:231], a[148:151], a[236:239], v[228:231]
    v_exp_f32 v210, v210
    v_mfma_f32_16x16x32_bf16 v[228:231], a[152:155], a[240:243], v[228:231]
    s_waitcnt lgkmcnt(3)
    v_exp_f32 v211, v211
    v_mfma_f32_16x16x32_bf16 v[228:231], a[156:159], a[244:247], v[228:231]
    s_waitcnt lgkmcnt(2)
    v_cvt_pk_bf16_f32 v86, v236, v237
    v_cvt_pk_bf16_f32 v89, v238, v239
    v_mfma_f32_16x16x32_bf16 v[228:231], a[160:163], a[216:219], v[228:231]
    s_waitcnt vmcnt(5) lgkmcnt(1)
    s_barrier
    v_cvt_pk_bf16_f32 v187, v208, v209
    v_mfma_f32_16x16x32_bf16 v[228:231], a[164:167], a[220:223], v[228:231]
    ds_read_b128 a[224:227], v240 offset:30720
    ds_read_b128 a[228:231], v241 offset:30720
    v_mfma_f32_16x16x32_bf16 v[212:215], v[10:13], v[184:187], v[212:215]
    v_cvt_pk_bf16_f32 v190, v210, v211
    v_sub_f32 v196, v196, v248
    v_mfma_f32_16x16x32_bf16 v[216:219], v[40:43], v[184:187], v[216:219]
    ds_read_b128 v[208:211], v246 offset:128
    v_sub_f32 v197, v197, v248
    v_mfma_f32_16x16x32_bf16 v[220:223], v[70:73], v[184:187], v[220:223]
    s_waitcnt lgkmcnt(3)
    v_mul_f32 v228, s38, v228
    v_mul_f32 v229, s38, v229
    v_mfma_f32_16x16x32_bf16 v[224:227], a[248:251], v[184:187], v[224:227]
    v_mul_f32 v230, s38, v230
    v_mul_f32 v231, s38, v231
    v_mfma_f32_16x16x32_bf16 v[204:207], v[132:135], v[174:177], v[204:207]
    v_exp_f32 v196, v196
    v_mfma_f32_16x16x32_bf16 v[204:207], v[134:137], v[176:179], v[204:207]
    v_exp_f32 v197, v197
    v_mfma_f32_16x16x32_bf16 v[232:235], a[168:171], a[232:235], 0
    v_sub_f32 v198, v198, v248
    v_sub_f32 v199, v199, v248
    v_mfma_f32_16x16x32_bf16 v[232:235], a[172:175], a[236:239], v[232:235]
    v_exp_f32 v198, v198
    v_mfma_f32_16x16x32_bf16 v[232:235], a[176:179], a[240:243], v[232:235]
    v_exp_f32 v199, v199
    v_mfma_f32_16x16x32_bf16 v[232:235], a[180:183], a[244:247], v[232:235]
    v_cvt_pk_bf16_f32 v188, v196, v197
    v_cvt_pk_bf16_f32 v191, v198, v199
    v_mfma_f32_16x16x32_bf16 v[232:235], a[184:187], a[216:219], v[232:235]
    ds_read_b128 v[196:199], v244 offset:0
    v_sub_f32 v200, v200, v248
    v_mfma_f32_16x16x32_bf16 v[212:215], v[14:17], v[188:191], v[212:215]
    s_waitcnt lgkmcnt(1)
    v_exp_f32 v200, v200
    v_mfma_f32_16x16x32_bf16 v[216:219], v[44:47], v[188:191], v[216:219]
    v_sub_f32 v201, v201, v248
    v_sub_f32 v204, v204, v248
    v_mfma_f32_16x16x32_bf16 v[220:223], v[74:77], v[188:191], v[220:223]
    v_exp_f32 v201, v201
    v_mfma_f32_16x16x32_bf16 v[224:227], a[248:251], v[188:191], v[224:227]
    v_cvt_pk_bf16_f32 v192, v200, v201
    v_sub_f32 v205, v205, v248
    v_mfma_f32_16x16x32_bf16 v[208:211], v[102:105], v[174:177], v[208:211]
    v_cvt_pk_bf16_f32 v174, v228, v229
    v_cvt_pk_bf16_f32 v175, v230, v231
    v_mfma_f32_16x16x32_bf16 v[208:211], v[104:107], v[176:179], v[208:211]
    ds_write_b64 v247, v[174:175] offset:0
    v_mfma_f32_16x16x32_bf16 v[232:235], a[188:191], a[220:223], v[232:235]
    ds_read_b128 v[200:203], v245 offset:0
    v_accvgpr_read_b32 v254, a252
    v_mfma_f32_16x16x32_bf16 v[236:239], a[192:195], a[232:235], 0
    ds_read_b128 a[232:235], v240 offset:30848
    buffer_load_dwordx4 v254, s[4:7], s44 offen lds
    v_mfma_f32_16x16x32_bf16 v[236:239], a[196:199], a[236:239], v[236:239]
    ds_read_b128 a[236:239], v241 offset:30848
    v_sub_f32 v208, v208, v248
    v_mfma_f32_16x16x32_bf16 v[236:239], a[200:203], a[240:243], v[236:239]
    s_waitcnt lgkmcnt(4)
    v_mul_f32 v232, s3, v232
    v_mul_f32 v233, s3, v233
    v_mfma_f32_16x16x32_bf16 v[196:199], v[90:93], v[168:171], v[196:199]
    v_mul_f32 v234, s3, v234
    v_mul_f32 v235, s3, v235
    v_mfma_f32_16x16x32_bf16 v[196:199], v[92:95], v[170:173], v[196:199]
    v_cvt_pk_bf16_f32 v176, v232, v233
    v_cvt_pk_bf16_f32 v177, v234, v235
    v_mfma_f32_16x16x32_bf16 v[236:239], a[204:207], a[244:247], v[236:239]
    ds_write_b64 v247, v[176:177] offset:128
    v_mfma_f32_16x16x32_bf16 v[236:239], a[208:211], a[216:219], v[236:239]
    ds_read_b128 a[240:243], v240 offset:30976
    ds_read_b128 a[244:247], v241 offset:30976
    v_mfma_f32_16x16x32_bf16 v[236:239], a[212:215], a[220:223], v[236:239]
    ds_read_b128 a[216:219], v242 offset:30720
    ds_read_b128 a[220:223], v243 offset:30720
    v_mfma_f32_16x16x32_bf16 v[228:231], a[0:3], a[224:227], 0
    s_waitcnt lgkmcnt(7)
    v_exp_f32 v204, v204
    v_mfma_f32_16x16x32_bf16 v[200:203], v[126:129], v[168:171], v[200:203]
    v_exp_f32 v205, v205
    v_mfma_f32_16x16x32_bf16 v[200:203], v[128:131], v[170:173], v[200:203]
    v_mul_f32 v236, s38, v236
    v_mul_f32 v237, s38, v237
    v_mfma_f32_16x16x32_bf16 v[228:231], a[4:7], a[228:231], v[228:231]
    s_waitcnt lgkmcnt(6)
    v_mul_f32 v238, s38, v238
    v_mul_f32 v239, s38, v239
    v_mfma_f32_16x16x32_bf16 v[228:231], a[8:11], a[232:235], v[228:231]
    s_waitcnt lgkmcnt(5)
    v_cvt_pk_bf16_f32 v178, v236, v237
    v_cvt_pk_bf16_f32 v179, v238, v239
    v_mfma_f32_16x16x32_bf16 v[228:231], a[12:15], a[236:239], v[228:231]
    ds_write_b64 v247, v[178:179] offset:256
    v_mfma_f32_16x16x32_bf16 v[232:235], a[24:27], a[224:227], 0
    s_waitcnt lgkmcnt(4)
    v_cvt_pk_bf16_f32 v193, v204, v205
    v_sub_f32 v209, v209, v248
    v_mfma_f32_16x16x32_bf16 v[228:231], a[16:19], a[240:243], v[228:231]
    ds_read_b128 v[204:207], v246 offset:0
    v_accvgpr_read_b32 v255, a253
    v_mfma_f32_16x16x32_bf16 v[232:235], a[28:31], a[228:231], v[232:235]
    s_waitcnt lgkmcnt(4)
    v_exp_f32 v208, v208
    v_mfma_f32_16x16x32_bf16 v[228:231], a[20:23], a[244:247], v[228:231]
    v_exp_f32 v209, v209
    v_mfma_f32_16x16x32_bf16 v[232:235], a[32:35], a[232:235], v[232:235]
    buffer_load_dwordx4 v255, s[4:7], s44 offen offset:1024 lds
    v_cvt_pk_bf16_f32 v194, v208, v209
    v_mfma_f32_16x16x32_bf16 v[232:235], a[36:39], a[236:239], v[232:235]
    ds_read_b128 v[208:211], v244 offset:64
    v_accvgpr_read_b32 v254, a254
    v_mfma_f32_16x16x32_bf16 v[212:215], v[18:21], v[192:195], v[212:215]
    v_accvgpr_read_b32 v255, a252
    v_max_f32 v248, v196, v197
    v_mfma_f32_16x16x32_bf16 v[216:219], v[48:51], v[192:195], v[216:219]
    v_max3_f32 v248, v248, v198, v199
    v_max3_f32 v248, v248, v200, v201
    v_mfma_f32_16x16x32_bf16 v[220:223], v[78:81], v[192:195], v[220:223]
    ds_read_b128 v[196:199], v245 offset:64
    buffer_load_dwordx4 v254, s[4:7], s44 offen offset:2048 lds
    v_mfma_f32_16x16x32_bf16 v[224:227], a[248:251], v[192:195], v[224:227]
    s_add_u32 m0, s46, 0xc00
    v_accvgpr_read_b32 v254, a253
    v_max3_f32 v248, v248, v202, v203
    v_mfma_f32_16x16x32_bf16 v[232:235], a[40:43], a[240:243], v[232:235]
    ds_read_b128 v[200:203], v246 offset:64
    s_waitcnt lgkmcnt(3)
    v_mfma_f32_16x16x32_bf16 v[204:207], v[162:165], v[168:171], v[204:207]
    v_mfma_f32_16x16x32_bf16 v[204:207], v[164:167], v[170:173], v[204:207]
    v_rcp_f32 v225, v224
    v_mfma_f32_16x16x32_bf16 v[232:235], a[44:47], a[244:247], v[232:235]
    v_mul_f32 v212, v212, v225
    v_mul_f32 v213, v213, v225
    v_mfma_f32_16x16x32_bf16 v[236:239], a[48:51], a[224:227], 0
    s_waitcnt lgkmcnt(2)
    v_mul_f32 v214, v214, v225
    v_mul_f32 v215, v215, v225
    v_mfma_f32_16x16x32_bf16 v[208:211], v[96:99], v[168:171], v[208:211]
    v_cvt_pk_bf16_f32 v212, v212, v213
    v_cvt_pk_bf16_f32 v213, v214, v215
    v_mfma_f32_16x16x32_bf16 v[208:211], v[98:101], v[170:173], v[208:211]
    ds_write_b64 v251, v[212:213] offset:6144
    v_mfma_f32_16x16x32_bf16 v[236:239], a[52:55], a[228:231], v[236:239]
    s_waitcnt lgkmcnt(2)
    v_mul_f32 v216, v216, v225
    v_mul_f32 v217, v217, v225
    v_mfma_f32_16x16x32_bf16 v[196:199], v[132:135], v[168:171], v[196:199]
    s_waitcnt lgkmcnt(1)
    v_mul_f32 v218, v218, v225
    v_mul_f32 v219, v219, v225
    v_mfma_f32_16x16x32_bf16 v[196:199], v[134:137], v[170:173], v[196:199]
    v_cvt_pk_bf16_f32 v216, v216, v217
    v_cvt_pk_bf16_f32 v217, v218, v219
    v_mfma_f32_16x16x32_bf16 v[200:203], v[102:105], v[168:171], v[200:203]
    ds_write_b64 v251, v[216:217] offset:6272
    v_mfma_f32_16x16x32_bf16 v[200:203], v[104:107], v[170:173], v[200:203]
    v_mul_f32 v220, v220, v225
    v_mul_f32 v221, v221, v225
    v_mfma_f32_16x16x32_bf16 v[236:239], a[56:59], a[232:235], v[236:239]
    v_mul_f32 v222, v222, v225
    v_mul_f32 v223, v223, v225
    v_mfma_f32_16x16x32_bf16 v[236:239], a[60:63], a[236:239], v[236:239]
    buffer_load_dwordx4 v255, s[4:7], s59 offen lds
    v_cvt_pk_bf16_f32 v220, v220, v221
    v_mfma_f32_16x16x32_bf16 v[236:239], a[64:67], a[240:243], v[236:239]
    v_cvt_pk_bf16_f32 v221, v222, v223
    v_accvgpr_read_b32 v255, a254
    v_mfma_f32_16x16x32_bf16 v[236:239], a[68:71], a[244:247], v[236:239]
    ds_write_b64 v251, v[220:221] offset:6400
    v_max3_f32 v248, v248, v204, v205
    v_max3_f32 v248, v248, v206, v207
    ds_read_b128 v[204:207], v244 offset:128
    buffer_load_dwordx4 v254, s[4:7], s59 offen offset:1024 lds
    v_accvgpr_read_b32 v254, a252
    v_max3_f32 v248, v248, v208, v209
    v_max3_f32 v248, v248, v210, v211
    ds_read_b128 v[208:211], v245 offset:128
    v_max3_f32 v248, v248, v196, v197
    v_max3_f32 v248, v248, v198, v199
    ds_read_b128 v[196:199], v246 offset:128
    v_max3_f32 v248, v248, v200, v201
    v_max3_f32 v248, v248, v202, v203
    ds_read_b128 v[200:203], v244 offset:0
    buffer_load_dwordx4 v255, s[4:7], s59 offen offset:2048 lds
    s_add_u32 m0, s46, 0x1800
    v_accvgpr_read_b32 v255, a255
    s_waitcnt lgkmcnt(3)
    v_mfma_f32_16x16x32_bf16 v[204:207], v[138:141], v[168:171], v[204:207]
    buffer_load_dwordx4 v254, s[4:7], s58 offen lds
    v_mfma_f32_16x16x32_bf16 v[204:207], v[140:143], v[170:173], v[204:207]
    s_nop 7
    s_waitcnt lgkmcnt(1)
    v_mfma_f32_16x16x32_bf16 v[208:211], v[144:147], v[168:171], v[208:211]
    v_max3_f32 v248, v248, v204, v205
    s_waitcnt lgkmcnt(0)
    v_mfma_f32_16x16x32_bf16 v[208:211], v[146:149], v[170:173], v[208:211]
    ds_read_b128 v[204:207], v245 offset:0
    buffer_load_dwordx4 v255, s[4:7], s58 offen offset:512 lds
    v_mfma_f32_16x16x32_bf16 v[196:199], v[108:111], v[168:171], v[196:199]
    s_add_u32 m0, s46, 0x16800
    v_mfma_f32_16x16x32_bf16 v[196:199], v[110:113], v[170:173], v[196:199]
    v_mfma_f32_16x16x32_bf16 v[200:203], v[90:93], v[168:171], v[200:203]
    v_cvt_pk_bf16_f32 v90, v228, v229
    v_cvt_pk_bf16_f32 v91, v230, v231
    v_mfma_f32_16x16x32_bf16 v[200:203], v[92:95], v[170:173], v[200:203]
    v_cvt_pk_bf16_f32 v92, v232, v233
    v_cvt_pk_bf16_f32 v93, v234, v235
    v_mfma_f32_16x16x32_bf16 v[228:231], a[224:227], a[72:75], 0
    v_cvt_pk_bf16_f32 v94, v236, v237
    v_cvt_pk_bf16_f32 v95, v238, v239
    v_mfma_f32_16x16x32_bf16 v[228:231], a[228:231], a[76:79], v[228:231]
    v_max3_f32 v248, v248, v208, v209
    v_max3_f32 v248, v248, v196, v197
    v_mfma_f32_16x16x32_bf16 v[228:231], a[232:235], a[80:83], v[228:231]
    ds_read_b128 v[208:211], v246 offset:0
    ds_read_b128 v[196:199], v244 offset:64
    v_mfma_f32_16x16x32_bf16 v[228:231], a[236:239], a[84:87], v[228:231]
    s_waitcnt lgkmcnt(2)
    v_mov_b32 v225, v248
    v_mfma_f32_16x16x32_bf16 v[204:207], v[126:129], v[168:171], v[204:207]
    v_mfma_f32_16x16x32_bf16 v[204:207], v[128:131], v[170:173], v[204:207]
    v_permlane16_swap_b32 v248, v225
    v_max_f32 v248, v248, v225
    v_mfma_f32_16x16x32_bf16 v[228:231], a[240:243], a[88:91], v[228:231]
    v_mov_b32 v225, v248
    v_mfma_f32_16x16x32_bf16 v[228:231], a[244:247], a[92:95], v[228:231]
    v_mfma_f32_16x16x32_bf16 v[232:235], a[224:227], a[96:99], 0
    v_permlane32_swap_b32 v248, v225
    v_max_f32 v248, v248, v225
    v_mfma_f32_16x16x32_bf16 v[232:235], a[228:231], a[100:103], v[232:235]
    v_sub_f32 v200, v200, v248
    v_sub_f32 v201, v201, v248
    v_mfma_f32_16x16x32_bf16 v[232:235], a[232:235], a[104:107], v[232:235]
    v_exp_f32 v200, v200
    v_mfma_f32_16x16x32_bf16 v[232:235], a[236:239], a[108:111], v[232:235]
    s_waitcnt lgkmcnt(1)
    v_cvt_pk_bf16_f32 v0, v228, v229
    v_cvt_pk_bf16_f32 v3, v230, v231
    v_mfma_f32_16x16x32_bf16 v[208:211], v[162:165], v[168:171], v[208:211]
    s_waitcnt lgkmcnt(0)
    v_exp_f32 v201, v201
    v_mfma_f32_16x16x32_bf16 v[208:211], v[164:167], v[170:173], v[208:211]
    v_sub_f32 v202, v202, v248
    v_sub_f32 v203, v203, v248
    v_mfma_f32_16x16x32_bf16 v[196:199], v[96:99], v[168:171], v[196:199]
    v_exp_f32 v202, v202
    v_mfma_f32_16x16x32_bf16 v[196:199], v[98:101], v[170:173], v[196:199]
    v_exp_f32 v203, v203
    v_mfma_f32_16x16x32_bf16 v[232:235], a[240:243], a[112:115], v[232:235]
    v_cvt_pk_bf16_f32 v180, v200, v201
    v_cvt_pk_bf16_f32 v183, v202, v203
    v_mfma_f32_16x16x32_bf16 v[232:235], a[244:247], a[116:119], v[232:235]
    ds_read_b128 v[200:203], v245 offset:64
    v_sub_f32 v204, v204, v248
    v_mfma_f32_16x16x32_bf16 v[236:239], a[224:227], a[120:123], 0
    ds_read_b128 a[224:227], v242 offset:30848
    v_sub_f32 v205, v205, v248
    v_mfma_f32_16x16x32_bf16 v[236:239], a[228:231], a[124:127], v[236:239]
    ds_read_b128 a[228:231], v243 offset:30848
    v_sub_f32 v206, v206, v248
    v_mfma_f32_16x16x32_bf16 v[236:239], a[232:235], a[128:131], v[236:239]
    v_cvt_pk_bf16_f32 v30, v232, v233
    v_cvt_pk_bf16_f32 v33, v234, v235
    v_mfma_f32_16x16x32_bf16 v[236:239], a[236:239], a[132:135], v[236:239]
    ds_read_b128 a[232:235], v242 offset:30976
    ds_read_b128 a[236:239], v243 offset:30976
    v_mfma_f32_16x16x32_bf16 v[236:239], a[240:243], a[136:139], v[236:239]
    ds_read_b128 a[240:243], v240 offset:32256
    v_sub_f32 v207, v207, v248
    v_mfma_f32_16x16x32_bf16 v[236:239], a[244:247], a[140:143], v[236:239]
    ds_read_b128 a[244:247], v241 offset:32256
    v_sub_f32 v208, v208, v248
    v_mfma_f32_16x16x32_bf16 v[228:231], a[144:147], a[216:219], 0
    v_exp_f32 v204, v204
    v_mfma_f32_16x16x32_bf16 v[228:231], a[148:151], a[220:223], v[228:231]
    v_exp_f32 v205, v205
    v_mfma_f32_16x16x32_bf16 v[232:235], a[168:171], a[216:219], 0
    s_waitcnt lgkmcnt(6)
    v_cvt_pk_bf16_f32 v60, v236, v237
    v_cvt_pk_bf16_f32 v63, v238, v239
    v_mfma_f32_16x16x32_bf16 v[200:203], v[132:135], v[168:171], v[200:203]
    s_waitcnt lgkmcnt(5)
    v_exp_f32 v206, v206
    v_mfma_f32_16x16x32_bf16 v[200:203], v[134:137], v[170:173], v[200:203]
    v_exp_f32 v207, v207
    v_mfma_f32_16x16x32_bf16 v[228:231], a[152:155], a[224:227], v[228:231]
    s_waitcnt lgkmcnt(4)
    v_cvt_pk_bf16_f32 v181, v204, v205
    v_cvt_pk_bf16_f32 v184, v206, v207
    v_mfma_f32_16x16x32_bf16 v[228:231], a[156:159], a[228:231], v[228:231]
    ds_read_b128 v[204:207], v246 offset:64
    v_sub_f32 v209, v209, v248
    v_mfma_f32_16x16x32_bf16 v[232:235], a[172:175], a[220:223], v[232:235]
    s_waitcnt lgkmcnt(4)
    v_exp_f32 v208, v208
    v_mfma_f32_16x16x32_bf16 v[228:231], a[160:163], a[232:235], v[228:231]
    s_waitcnt lgkmcnt(3)
    v_exp_f32 v209, v209
    v_mfma_f32_16x16x32_bf16 v[228:231], a[164:167], a[236:239], v[228:231]
    v_sub_f32 v210, v210, v248
    v_sub_f32 v211, v211, v248
    v_mfma_f32_16x16x32_bf16 v[232:235], a[176:179], a[224:227], v[232:235]
    v_exp_f32 v210, v210
    v_mfma_f32_16x16x32_bf16 v[232:235], a[180:183], a[228:231], v[232:235]
    v_exp_f32 v211, v211
    v_mfma_f32_16x16x32_bf16 v[232:235], a[184:187], a[232:235], v[232:235]
    v_cvt_pk_bf16_f32 v182, v208, v209
    v_mul_f32 v228, s38, v228
    v_mfma_f32_16x16x32_bf16 v[232:235], a[188:191], a[236:239], v[232:235]
    v_mul_f32 v229, s38, v229
    v_mul_f32 v230, s38, v230
    v_mfma_f32_16x16x32_bf16 v[212:215], v[12:15], v[180:183], 0
    v_mul_f32 v231, s38, v231
    v_cvt_pk_bf16_f32 v185, v210, v211
    v_mfma_f32_16x16x32_bf16 v[216:219], v[42:45], v[180:183], 0
    ds_read_b128 v[208:211], v244 offset:128
    v_sub_f32 v196, v196, v248
    v_mfma_f32_16x16x32_bf16 v[220:223], v[72:75], v[180:183], 0
    s_waitcnt lgkmcnt(1)
    v_mul_f32 v232, s3, v232
    v_mul_f32 v233, s3, v233
    v_mfma_f32_16x16x32_bf16 v[224:227], a[248:251], v[180:183], 0
    v_mul_f32 v234, s3, v234
    v_mul_f32 v235, s3, v235
    v_mfma_f32_16x16x32_bf16 v[204:207], v[102:105], v[168:171], v[204:207]
    v_exp_f32 v196, v196
    v_mfma_f32_16x16x32_bf16 v[204:207], v[104:107], v[170:173], v[204:207]
    v_sub_f32 v197, v197, v248
    v_sub_f32 v198, v198, v248
    v_mfma_f32_16x16x32_bf16 v[236:239], a[192:195], a[216:219], 0
    ds_read_b128 a[216:219], v240 offset:32384
    v_sub_f32 v199, v199, v248
    v_mfma_f32_16x16x32_bf16 v[236:239], a[196:199], a[220:223], v[236:239]
    ds_read_b128 a[220:223], v241 offset:32384
    v_sub_f32 v200, v200, v248
    v_mfma_f32_16x16x32_bf16 v[236:239], a[200:203], a[224:227], v[236:239]
    ds_read_b128 a[224:227], v240 offset:32512
    v_sub_f32 v201, v201, v248
    v_mfma_f32_16x16x32_bf16 v[236:239], a[204:207], a[228:231], v[236:239]
    ds_read_b128 a[228:231], v241 offset:32512
    v_sub_f32 v202, v202, v248
    v_mfma_f32_16x16x32_bf16 v[236:239], a[208:211], a[232:235], v[236:239]
    ds_read_b128 a[232:235], v242 offset:32256
    v_sub_f32 v203, v203, v248
    v_mfma_f32_16x16x32_bf16 v[236:239], a[212:215], a[236:239], v[236:239]
    s_waitcnt lgkmcnt(5)
    ds_read_b128 a[236:239], v243 offset:32256
    v_mfma_f32_16x16x32_bf16 v[208:211], v[138:141], v[168:171], v[208:211]
    v_exp_f32 v197, v197
    v_mfma_f32_16x16x32_bf16 v[208:211], v[140:143], v[170:173], v[208:211]
    v_exp_f32 v198, v198
    v_exp_f32 v199, v199
    v_cvt_pk_bf16_f32 v186, v196, v197
    v_mul_f32 v236, s38, v236
    v_mul_f32 v237, s38, v237
    v_mul_f32 v238, s38, v238
    v_mul_f32 v239, s38, v239
    v_cvt_pk_bf16_f32 v189, v198, v199
    ds_read_b128 v[196:199], v245 offset:128
    v_exp_f32 v200, v200
    v_exp_f32 v201, v201
    v_exp_f32 v202, v202
    v_exp_f32 v203, v203
    v_cvt_pk_bf16_f32 v187, v200, v201
    v_cvt_pk_bf16_f32 v190, v202, v203
    ds_read_b128 v[200:203], v246 offset:128
    v_mfma_f32_16x16x32_bf16 v[212:215], v[16:19], v[184:187], v[212:215]
    v_sub_f32 v204, v204, v248
    v_sub_f32 v205, v205, v248
    v_mfma_f32_16x16x32_bf16 v[216:219], v[46:49], v[184:187], v[216:219]
    v_exp_f32 v204, v204
    v_mfma_f32_16x16x32_bf16 v[220:223], v[76:79], v[184:187], v[220:223]
    v_exp_f32 v205, v205
    v_mfma_f32_16x16x32_bf16 v[224:227], a[248:251], v[184:187], v[224:227]
    v_sub_f32 v206, v206, v248
    v_exp_f32 v206, v206
    v_sub_f32 v207, v207, v248
    s_waitcnt lgkmcnt(1)
    v_mfma_f32_16x16x32_bf16 v[196:199], v[144:147], v[168:171], v[196:199]
    v_exp_f32 v207, v207
    v_mfma_f32_16x16x32_bf16 v[196:199], v[146:149], v[170:173], v[196:199]
    v_cvt_pk_bf16_f32 v188, v204, v205
    v_cvt_pk_bf16_f32 v191, v206, v207
    ds_read_b128 v[204:207], v244 offset:0
    v_sub_f32 v208, v208, v248
    v_mfma_f32_16x16x32_bf16 v[212:215], v[20:23], v[188:191], v[212:215]
    s_waitcnt lgkmcnt(1)
    v_exp_f32 v208, v208
    v_mfma_f32_16x16x32_bf16 v[216:219], v[50:53], v[188:191], v[216:219]
    v_sub_f32 v209, v209, v248
    v_sub_f32 v196, v196, v248
    v_mfma_f32_16x16x32_bf16 v[220:223], v[80:83], v[188:191], v[220:223]
    v_exp_f32 v209, v209
    v_mfma_f32_16x16x32_bf16 v[224:227], a[248:251], v[188:191], v[224:227]
    v_cvt_pk_bf16_f32 v192, v208, v209
    v_sub_f32 v197, v197, v248
    v_mfma_f32_16x16x32_bf16 v[200:203], v[108:111], v[168:171], v[200:203]
    v_cvt_pk_bf16_f32 v168, v228, v229
    v_cvt_pk_bf16_f32 v169, v230, v231
    v_mfma_f32_16x16x32_bf16 v[200:203], v[110:113], v[170:173], v[200:203]
    v_cvt_pk_bf16_f32 v170, v232, v233
    v_cvt_pk_bf16_f32 v171, v234, v235
    v_mfma_f32_16x16x32_bf16 v[228:231], a[0:3], a[240:243], 0
    v_cvt_pk_bf16_f32 v172, v236, v237
    v_cvt_pk_bf16_f32 v173, v238, v239
    v_mfma_f32_16x16x32_bf16 v[228:231], a[4:7], a[244:247], v[228:231]
    ds_read_b128 v[208:211], v245 offset:0
    s_waitcnt lgkmcnt(1)
    v_mfma_f32_16x16x32_bf16 v[204:207], v[96:99], v[174:177], v[204:207]
    v_exp_f32 v196, v196
    v_mfma_f32_16x16x32_bf16 v[204:207], v[98:101], v[176:179], v[204:207]
    v_exp_f32 v197, v197
    v_mfma_f32_16x16x32_bf16 v[228:231], a[8:11], a[216:219], v[228:231]
    v_cvt_pk_bf16_f32 v193, v196, v197
    v_sub_f32 v200, v200, v248
    v_mfma_f32_16x16x32_bf16 v[228:231], a[12:15], a[220:223], v[228:231]
    ds_read_b128 v[196:199], v246 offset:0
    v_sub_f32 v201, v201, v248
    v_mfma_f32_16x16x32_bf16 v[228:231], a[16:19], a[224:227], v[228:231]
    v_exp_f32 v200, v200
    v_mfma_f32_16x16x32_bf16 v[228:231], a[20:23], a[228:231], v[228:231]
    v_exp_f32 v201, v201
    v_mfma_f32_16x16x32_bf16 v[232:235], a[24:27], a[240:243], 0
    v_cvt_pk_bf16_f32 v194, v200, v201
    v_max_f32 v248, v204, v205
    v_mfma_f32_16x16x32_bf16 v[232:235], a[28:31], a[244:247], v[232:235]
    ds_read_b128 v[200:203], v244 offset:64
    v_max3_f32 v248, v248, v206, v207
    v_mfma_f32_16x16x32_bf16 v[212:215], v[24:27], v[192:195], v[212:215]
    ds_read_b128 v[204:207], v245 offset:64
    s_waitcnt lgkmcnt(3)
    v_mfma_f32_16x16x32_bf16 v[216:219], v[54:57], v[192:195], v[216:219]
    v_mfma_f32_16x16x32_bf16 v[220:223], v[84:87], v[192:195], v[220:223]
    v_mfma_f32_16x16x32_bf16 v[224:227], a[248:251], v[192:195], v[224:227]
    v_mfma_f32_16x16x32_bf16 v[208:211], v[132:135], v[174:177], v[208:211]
    s_waitcnt lgkmcnt(2)
    v_mfma_f32_16x16x32_bf16 v[208:211], v[134:137], v[176:179], v[208:211]
    v_mfma_f32_16x16x32_bf16 v[196:199], v[102:105], v[174:177], v[196:199]
    v_mfma_f32_16x16x32_bf16 v[196:199], v[104:107], v[176:179], v[196:199]
    v_mfma_f32_16x16x32_bf16 v[232:235], a[32:35], a[216:219], v[232:235]
    s_waitcnt lgkmcnt(1)
    s_waitcnt lgkmcnt(0)
    v_mfma_f32_16x16x32_bf16 v[200:203], v[138:141], v[174:177], v[200:203]
    v_rcp_f32 v225, v224
    v_mfma_f32_16x16x32_bf16 v[200:203], v[140:143], v[176:179], v[200:203]
    v_mul_f32 v212, v212, v225
    v_mul_f32 v213, v213, v225
    v_mfma_f32_16x16x32_bf16 v[204:207], v[144:147], v[174:177], v[204:207]
    v_mul_f32 v214, v214, v225
    v_mul_f32 v215, v215, v225
    v_mfma_f32_16x16x32_bf16 v[204:207], v[146:149], v[176:179], v[204:207]
    v_cvt_pk_bf16_f32 v212, v212, v213
    v_cvt_pk_bf16_f32 v213, v214, v215
    v_mfma_f32_16x16x32_bf16 v[232:235], a[36:39], a[220:223], v[232:235]
    ds_write_b64 v251, v[212:213] offset:12288
    v_mfma_f32_16x16x32_bf16 v[232:235], a[40:43], a[224:227], v[232:235]
    v_mul_f32 v216, v216, v225
    v_mul_f32 v217, v217, v225
    v_mfma_f32_16x16x32_bf16 v[232:235], a[44:47], a[228:231], v[232:235]
    v_mul_f32 v218, v218, v225
    v_mul_f32 v219, v219, v225
    v_mfma_f32_16x16x32_bf16 v[236:239], a[48:51], a[240:243], 0
    v_cvt_pk_bf16_f32 v216, v216, v217
    v_cvt_pk_bf16_f32 v217, v218, v219
    v_mfma_f32_16x16x32_bf16 v[236:239], a[52:55], a[244:247], v[236:239]
    ds_write_b64 v251, v[216:217] offset:12416
    v_mfma_f32_16x16x32_bf16 v[236:239], a[56:59], a[216:219], v[236:239]
    v_mul_f32 v220, v220, v225
    v_mul_f32 v221, v221, v225
    v_mfma_f32_16x16x32_bf16 v[236:239], a[60:63], a[220:223], v[236:239]
    v_mul_f32 v222, v222, v225
    v_mul_f32 v223, v223, v225
    v_mfma_f32_16x16x32_bf16 v[236:239], a[64:67], a[224:227], v[236:239]
    v_cvt_pk_bf16_f32 v220, v220, v221
    v_cvt_pk_bf16_f32 v221, v222, v223
    v_mfma_f32_16x16x32_bf16 v[236:239], a[68:71], a[228:231], v[236:239]
    ds_write_b64 v251, v[220:221] offset:12544
    v_max3_f32 v248, v248, v208, v209
    v_max3_f32 v248, v248, v210, v211
    ds_read_b128 v[208:211], v246 offset:64
    v_max3_f32 v248, v248, v196, v197
    v_max3_f32 v248, v248, v198, v199
    ds_read_b128 v[196:199], v244 offset:0
    v_max3_f32 v248, v248, v200, v201
    v_max3_f32 v248, v248, v202, v203
    ds_read_b128 v[200:203], v245 offset:0
    v_max3_f32 v248, v248, v204, v205
    v_max3_f32 v248, v248, v206, v207
    ds_read_b128 v[204:207], v246 offset:0
    s_waitcnt lgkmcnt(3)
    v_mfma_f32_16x16x32_bf16 v[208:211], v[108:111], v[174:177], v[208:211]
    v_mfma_f32_16x16x32_bf16 v[208:211], v[110:113], v[176:179], v[208:211]
    s_waitcnt lgkmcnt(2)
    v_mfma_f32_16x16x32_bf16 v[196:199], v[96:99], v[174:177], v[196:199]
    s_waitcnt lgkmcnt(1)
    v_cvt_pk_bf16_f32 v96, v228, v229
    v_cvt_pk_bf16_f32 v97, v230, v231
    v_mfma_f32_16x16x32_bf16 v[196:199], v[98:101], v[176:179], v[196:199]
    v_cvt_pk_bf16_f32 v98, v232, v233
    v_cvt_pk_bf16_f32 v99, v234, v235
    v_mfma_f32_16x16x32_bf16 v[200:203], v[132:135], v[174:177], v[200:203]
    s_waitcnt lgkmcnt(0)
    v_cvt_pk_bf16_f32 v100, v236, v237
    v_cvt_pk_bf16_f32 v101, v238, v239
    v_mfma_f32_16x16x32_bf16 v[200:203], v[134:137], v[176:179], v[200:203]
    v_max3_f32 v248, v248, v208, v209
    v_max3_f32 v248, v248, v210, v211
    v_mfma_f32_16x16x32_bf16 v[204:207], v[102:105], v[174:177], v[204:207]
    ds_read_b128 v[208:211], v244 offset:64
    v_mov_b32 v225, v248
    v_mfma_f32_16x16x32_bf16 v[204:207], v[104:107], v[176:179], v[204:207]
    v_mfma_f32_16x16x32_bf16 v[228:231], a[240:243], a[72:75], 0
    v_permlane16_swap_b32 v248, v225
    v_max_f32 v248, v248, v225
    v_mfma_f32_16x16x32_bf16 v[228:231], a[244:247], a[76:79], v[228:231]
    v_mov_b32 v225, v248
    v_mfma_f32_16x16x32_bf16 v[228:231], a[216:219], a[80:83], v[228:231]
    v_mfma_f32_16x16x32_bf16 v[228:231], a[220:223], a[84:87], v[228:231]
    v_permlane32_swap_b32 v248, v225
    v_max_f32 v248, v248, v225
    v_mfma_f32_16x16x32_bf16 v[228:231], a[224:227], a[88:91], v[228:231]
    v_sub_f32 v196, v196, v248
    v_sub_f32 v197, v197, v248
    v_mfma_f32_16x16x32_bf16 v[228:231], a[228:231], a[92:95], v[228:231]
    v_exp_f32 v196, v196
    v_mfma_f32_16x16x32_bf16 v[232:235], a[240:243], a[96:99], 0
    v_exp_f32 v197, v197
    v_mfma_f32_16x16x32_bf16 v[232:235], a[244:247], a[100:103], v[232:235]
    s_waitcnt lgkmcnt(0)
    v_sub_f32 v198, v198, v248
    v_sub_f32 v199, v199, v248
    v_mfma_f32_16x16x32_bf16 v[208:211], v[138:141], v[174:177], v[208:211]
    v_cvt_pk_bf16_f32 v6, v228, v229
    v_cvt_pk_bf16_f32 v9, v230, v231
    v_mfma_f32_16x16x32_bf16 v[208:211], v[140:143], v[176:179], v[208:211]
    v_exp_f32 v198, v198
    v_mfma_f32_16x16x32_bf16 v[232:235], a[216:219], a[104:107], v[232:235]
    v_exp_f32 v199, v199
    v_mfma_f32_16x16x32_bf16 v[232:235], a[220:223], a[108:111], v[232:235]
    v_cvt_pk_bf16_f32 v180, v196, v197
    v_cvt_pk_bf16_f32 v183, v198, v199
    v_mfma_f32_16x16x32_bf16 v[232:235], a[224:227], a[112:115], v[232:235]
    ds_read_b128 v[196:199], v245 offset:64
    v_sub_f32 v200, v200, v248
    v_mfma_f32_16x16x32_bf16 v[232:235], a[228:231], a[116:119], v[232:235]
    v_exp_f32 v200, v200
    v_mfma_f32_16x16x32_bf16 v[236:239], a[240:243], a[120:123], 0
    ds_read_b128 a[240:243], v242 offset:32384
    v_sub_f32 v201, v201, v248
    v_mfma_f32_16x16x32_bf16 v[236:239], a[244:247], a[124:127], v[236:239]
    ds_read_b128 a[244:247], v243 offset:32384
    v_sub_f32 v202, v202, v248
    v_mfma_f32_16x16x32_bf16 v[236:239], a[216:219], a[128:131], v[236:239]
    v_cvt_pk_bf16_f32 v36, v232, v233
    v_cvt_pk_bf16_f32 v39, v234, v235
    v_mfma_f32_16x16x32_bf16 v[236:239], a[220:223], a[132:135], v[236:239]
    ds_read_b128 a[216:219], v242 offset:32512
    ds_read_b128 a[220:223], v243 offset:32512
    v_mfma_f32_16x16x32_bf16 v[236:239], a[224:227], a[136:139], v[236:239]
    ds_read_b128 a[224:227], v242 offset:33792
    v_sub_f32 v203, v203, v248
    v_mfma_f32_16x16x32_bf16 v[236:239], a[228:231], a[140:143], v[236:239]
    ds_read_b128 a[228:231], v243 offset:33792
    v_sub_f32 v204, v204, v248
    v_mfma_f32_16x16x32_bf16 v[228:231], a[144:147], a[232:235], 0
    v_exp_f32 v201, v201
    v_mfma_f32_16x16x32_bf16 v[228:231], a[148:151], a[236:239], v[228:231]
    s_waitcnt lgkmcnt(6)
    v_exp_f32 v202, v202
    v_mfma_f32_16x16x32_bf16 v[196:199], v[144:147], v[174:177], v[196:199]
    v_cvt_pk_bf16_f32 v66, v236, v237
    v_cvt_pk_bf16_f32 v69, v238, v239
    v_mfma_f32_16x16x32_bf16 v[196:199], v[146:149], v[176:179], v[196:199]
    s_waitcnt lgkmcnt(5)
    v_exp_f32 v203, v203
    v_mfma_f32_16x16x32_bf16 v[228:231], a[152:155], a[240:243], v[228:231]
    s_waitcnt lgkmcnt(4)
    v_cvt_pk_bf16_f32 v181, v200, v201
    v_cvt_pk_bf16_f32 v184, v202, v203
    v_mfma_f32_16x16x32_bf16 v[228:231], a[156:159], a[244:247], v[228:231]
    ds_read_b128 v[200:203], v246 offset:64
    v_sub_f32 v205, v205, v248
    v_mfma_f32_16x16x32_bf16 v[232:235], a[168:171], a[232:235], 0
    s_waitcnt lgkmcnt(4)
    v_exp_f32 v204, v204
    v_mfma_f32_16x16x32_bf16 v[228:231], a[160:163], a[216:219], v[228:231]
    s_waitcnt lgkmcnt(3)
    v_exp_f32 v205, v205
    v_mfma_f32_16x16x32_bf16 v[228:231], a[164:167], a[220:223], v[228:231]
    v_sub_f32 v206, v206, v248
    v_sub_f32 v207, v207, v248
    v_mfma_f32_16x16x32_bf16 v[232:235], a[172:175], a[236:239], v[232:235]
    v_exp_f32 v206, v206
    v_mfma_f32_16x16x32_bf16 v[232:235], a[176:179], a[240:243], v[232:235]
    v_exp_f32 v207, v207
    v_mfma_f32_16x16x32_bf16 v[232:235], a[180:183], a[244:247], v[232:235]
    v_cvt_pk_bf16_f32 v182, v204, v205
    v_mul_f32 v228, s38, v228
    v_mfma_f32_16x16x32_bf16 v[232:235], a[184:187], a[216:219], v[232:235]
    v_mul_f32 v229, s38, v229
    v_mul_f32 v230, s38, v230
    v_mfma_f32_16x16x32_bf16 v[212:215], v[18:21], v[180:183], 0
    v_mul_f32 v231, s38, v231
    v_cvt_pk_bf16_f32 v185, v206, v207
    v_mfma_f32_16x16x32_bf16 v[216:219], v[48:51], v[180:183], 0
    s_waitcnt lgkmcnt(0)
    v_sub_f32 v208, v208, v248
    v_sub_f32 v209, v209, v248
    v_mfma_f32_16x16x32_bf16 v[220:223], v[78:81], v[180:183], 0
    v_exp_f32 v208, v208
    v_mfma_f32_16x16x32_bf16 v[224:227], a[248:251], v[180:183], 0
    v_exp_f32 v209, v209
    v_mfma_f32_16x16x32_bf16 v[200:203], v[108:111], v[174:177], v[200:203]
    v_cvt_pk_bf16_f32 v174, v228, v229
    v_cvt_pk_bf16_f32 v175, v230, v231
    v_mfma_f32_16x16x32_bf16 v[200:203], v[110:113], v[176:179], v[200:203]
    v_sub_f32 v210, v210, v248
    v_sub_f32 v211, v211, v248
    v_mfma_f32_16x16x32_bf16 v[232:235], a[188:191], a[220:223], v[232:235]
    v_exp_f32 v210, v210
    v_mfma_f32_16x16x32_bf16 v[236:239], a[192:195], a[232:235], 0
    ds_read_b128 a[232:235], v242 offset:33920
    v_cvt_pk_bf16_f32 v186, v208, v209
    v_mfma_f32_16x16x32_bf16 v[236:239], a[196:199], a[236:239], v[236:239]
    ds_read_b128 a[236:239], v243 offset:33920
    v_sub_f32 v196, v196, v248
    v_mfma_f32_16x16x32_bf16 v[236:239], a[200:203], a[240:243], v[236:239]
    v_mul_f32 v232, s3, v232
    v_mul_f32 v233, s3, v233
    v_mfma_f32_16x16x32_bf16 v[236:239], a[204:207], a[244:247], v[236:239]
    v_mul_f32 v234, s3, v234
    v_mul_f32 v235, s3, v235
    v_mfma_f32_16x16x32_bf16 v[236:239], a[208:211], a[216:219], v[236:239]
    v_cvt_pk_bf16_f32 v176, v232, v233
    v_cvt_pk_bf16_f32 v177, v234, v235
    v_mfma_f32_16x16x32_bf16 v[236:239], a[212:215], a[220:223], v[236:239]
    ds_read_b128 a[240:243], v242 offset:34048
    ds_read_b128 a[244:247], v243 offset:34048
    v_mfma_f32_16x16x32_bf16 v[228:231], a[144:147], a[224:227], 0
    v_exp_f32 v211, v211
    v_mfma_f32_16x16x32_bf16 v[228:231], a[148:151], a[228:231], v[228:231]
    v_cvt_pk_bf16_f32 v189, v210, v211
    v_sub_f32 v197, v197, v248
    v_mfma_f32_16x16x32_bf16 v[232:235], a[168:171], a[224:227], 0
    v_mul_f32 v236, s38, v236
    v_mul_f32 v237, s38, v237
    v_mfma_f32_16x16x32_bf16 v[232:235], a[172:175], a[228:231], v[232:235]
    s_waitcnt lgkmcnt(3)
    v_mul_f32 v238, s38, v238
    v_mul_f32 v239, s38, v239
    v_mfma_f32_16x16x32_bf16 v[228:231], a[152:155], a[232:235], v[228:231]
    s_waitcnt lgkmcnt(2)
    v_cvt_pk_bf16_f32 v178, v236, v237
    v_cvt_pk_bf16_f32 v179, v238, v239
    v_mfma_f32_16x16x32_bf16 v[228:231], a[156:159], a[236:239], v[228:231]
    v_exp_f32 v196, v196
    v_mfma_f32_16x16x32_bf16 v[232:235], a[176:179], a[232:235], v[232:235]
    v_exp_f32 v197, v197
    v_mfma_f32_16x16x32_bf16 v[232:235], a[180:183], a[236:239], v[232:235]
    v_sub_f32 v198, v198, v248
    v_sub_f32 v199, v199, v248
    v_mfma_f32_16x16x32_bf16 v[236:239], a[192:195], a[224:227], 0
    s_waitcnt lgkmcnt(1)
    s_waitcnt vmcnt(8) lgkmcnt(0)
    s_barrier
    v_mfma_f32_16x16x32_bf16 v[228:231], a[160:163], a[240:243], v[228:231]
    ds_read_b128 a[216:219], v240 offset:33792
    ds_read_b128 a[220:223], v241 offset:33792
    v_mfma_f32_16x16x32_bf16 v[228:231], a[164:167], a[244:247], v[228:231]
    ds_read_b128 a[224:227], v240 offset:33920
    v_cvt_pk_bf16_f32 v187, v196, v197
    v_mfma_f32_16x16x32_bf16 v[232:235], a[184:187], a[240:243], v[232:235]
    v_exp_f32 v198, v198
    v_mfma_f32_16x16x32_bf16 v[212:215], v[22:25], v[184:187], v[212:215]
    v_exp_f32 v199, v199
    v_mfma_f32_16x16x32_bf16 v[216:219], v[52:55], v[184:187], v[216:219]
    v_cvt_pk_bf16_f32 v190, v198, v199
    v_mul_f32 v228, s38, v228
    v_mfma_f32_16x16x32_bf16 v[220:223], v[82:85], v[184:187], v[220:223]
    v_mul_f32 v229, s38, v229
    v_mul_f32 v230, s38, v230
    v_mfma_f32_16x16x32_bf16 v[224:227], a[248:251], v[184:187], v[224:227]
    v_mul_f32 v231, s38, v231
    v_cvt_pk_bf16_f32 v228, v228, v229
    v_mfma_f32_16x16x32_bf16 v[232:235], a[188:191], a[244:247], v[232:235]
    v_cvt_pk_bf16_f32 v229, v230, v231
    v_sub_f32 v200, v200, v248
    v_mfma_f32_16x16x32_bf16 v[236:239], a[196:199], a[228:231], v[236:239]
    ds_write_b64 v247, v[228:229] offset:18432
    v_mfma_f32_16x16x32_bf16 v[236:239], a[200:203], a[232:235], v[236:239]
    ds_read_b128 a[228:231], v241 offset:33920
    ds_read_b128 a[232:235], v240 offset:34048
    v_mfma_f32_16x16x32_bf16 v[236:239], a[204:207], a[236:239], v[236:239]
    s_waitcnt lgkmcnt(5)
    v_mul_f32 v232, s3, v232
    v_mul_f32 v233, s3, v233
    v_mfma_f32_16x16x32_bf16 v[236:239], a[208:211], a[240:243], v[236:239]
    v_mul_f32 v234, s3, v234
    v_mul_f32 v235, s3, v235
    v_mfma_f32_16x16x32_bf16 v[236:239], a[212:215], a[244:247], v[236:239]
    ds_read_b128 a[236:239], v241 offset:34048
    v_cvt_pk_bf16_f32 v232, v232, v233
    v_mfma_f32_16x16x32_bf16 v[228:231], a[0:3], a[216:219], 0
    s_waitcnt lgkmcnt(5)
    v_cvt_pk_bf16_f32 v233, v234, v235
    v_sub_f32 v201, v201, v248
    v_mfma_f32_16x16x32_bf16 v[228:231], a[4:7], a[220:223], v[228:231]
    s_waitcnt lgkmcnt(4)
    v_mul_f32 v236, s38, v236
    v_mul_f32 v237, s38, v237
    v_mfma_f32_16x16x32_bf16 v[228:231], a[8:11], a[224:227], v[228:231]
    ds_write_b64 v247, v[232:233] offset:18560
    v_mfma_f32_16x16x32_bf16 v[232:235], a[24:27], a[216:219], 0
    v_mul_f32 v238, s38, v238
    v_mul_f32 v239, s38, v239
    v_mfma_f32_16x16x32_bf16 v[232:235], a[28:31], a[220:223], v[232:235]
    ds_read_b128 a[240:243], v242 offset:61440
    v_cvt_pk_bf16_f32 v236, v236, v237
    v_mfma_f32_16x16x32_bf16 v[232:235], a[32:35], a[224:227], v[232:235]
    s_waitcnt lgkmcnt(4)
    v_cvt_pk_bf16_f32 v237, v238, v239
    v_sub_f32 v202, v202, v248
    v_mfma_f32_16x16x32_bf16 v[228:231], a[12:15], a[228:231], v[228:231]
    ds_write_b64 v247, v[236:237] offset:18688
    v_mfma_f32_16x16x32_bf16 v[232:235], a[36:39], a[228:231], v[232:235]
    ds_read_b128 a[244:247], v243 offset:61440
    v_sub_f32 v203, v203, v248
    v_mfma_f32_16x16x32_bf16 v[236:239], a[48:51], a[216:219], 0
    s_waitcnt lgkmcnt(5)
    v_exp_f32 v200, v200
    v_mfma_f32_16x16x32_bf16 v[228:231], a[16:19], a[232:235], v[228:231]
    s_waitcnt lgkmcnt(4)
    v_exp_f32 v201, v201
    v_mfma_f32_16x16x32_bf16 v[228:231], a[20:23], a[236:239], v[228:231]
    v_exp_f32 v202, v202
    v_mfma_f32_16x16x32_bf16 v[232:235], a[40:43], a[232:235], v[232:235]
    v_exp_f32 v203, v203
    v_mfma_f32_16x16x32_bf16 v[232:235], a[44:47], a[236:239], v[232:235]
    v_cvt_pk_bf16_f32 v188, v200, v201
    v_cvt_pk_bf16_f32 v191, v202, v203
    v_mfma_f32_16x16x32_bf16 v[236:239], a[52:55], a[220:223], v[236:239]
    v_mov_b32 v204, 0x237c0
    v_cvt_pk_bf16_f32 v138, v228, v229
    v_mfma_f32_16x16x32_bf16 v[212:215], v[26:29], v[188:191], v[212:215]
    v_cvt_pk_bf16_f32 v139, v230, v231
    v_add_u32 v205, 0xfffff900, v245
    v_mfma_f32_16x16x32_bf16 v[216:219], v[56:59], v[188:191], v[216:219]
    v_cvt_pk_bf16_f32 v140, v232, v233
    v_cvt_pk_bf16_f32 v141, v234, v235
    v_mfma_f32_16x16x32_bf16 v[220:223], v[86:89], v[188:191], v[220:223]
    v_add_u32 v246, 0x700, v245
    v_mfma_f32_16x16x32_bf16 v[224:227], a[248:251], v[188:191], v[224:227]
    v_mov_b32 v191, 0
    v_mfma_f32_16x16x32_bf16 v[236:239], a[56:59], a[224:227], v[236:239]
    v_mfma_f32_16x16x32_bf16 v[236:239], a[60:63], a[228:231], v[236:239]
    v_mfma_f32_16x16x32_bf16 v[236:239], a[64:67], a[232:235], v[236:239]
    v_mfma_f32_16x16x32_bf16 v[236:239], a[68:71], a[236:239], v[236:239]
    v_mfma_f32_16x16x32_bf16 v[228:231], a[216:219], a[72:75], 0
    v_mfma_f32_16x16x32_bf16 v[228:231], a[220:223], a[76:79], v[228:231]
    v_mfma_f32_16x16x32_bf16 v[228:231], a[224:227], a[80:83], v[228:231]
    v_rcp_f32 v225, v224
    v_mfma_f32_16x16x32_bf16 v[228:231], a[228:231], a[84:87], v[228:231]
    v_mov_b32 v226, 0x22e00
    v_cndmask_b32 v226, v226, v247, vcc
    v_mfma_f32_16x16x32_bf16 v[228:231], a[232:235], a[88:91], v[228:231]
    s_mov_b32 vcc_lo, 0x0
    v_cvt_pk_bf16_f32 v142, v236, v237
    v_cvt_pk_bf16_f32 v143, v238, v239
    v_mfma_f32_16x16x32_bf16 v[228:231], a[236:239], a[92:95], v[228:231]
    s_mov_b32 vcc_hi, 0xf0000
    v_mul_f32 v212, v212, v225
    v_mul_f32 v213, v213, v225
    v_mfma_f32_16x16x32_bf16 v[232:235], a[216:219], a[96:99], 0
    v_mul_f32 v214, v214, v225
    v_mul_f32 v215, v215, v225
    v_mfma_f32_16x16x32_bf16 v[232:235], a[220:223], a[100:103], v[232:235]
    v_cvt_pk_bf16_f32 v212, v212, v213
    v_cvt_pk_bf16_f32 v12, v228, v229
    v_mfma_f32_16x16x32_bf16 v[232:235], a[224:227], a[104:107], v[232:235]
    v_cvt_pk_bf16_f32 v15, v230, v231
    v_cvt_pk_bf16_f32 v213, v214, v215
    v_mfma_f32_16x16x32_bf16 v[232:235], a[228:231], a[108:111], v[232:235]
    ds_write_b64 v226, v[212:213] offset:0
    v_mfma_f32_16x16x32_bf16 v[232:235], a[232:235], a[112:115], v[232:235]
    s_waitcnt lgkmcnt(1)
    v_mul_f32 v216, v216, v225
    v_mul_f32 v217, v217, v225
    v_mfma_f32_16x16x32_bf16 v[232:235], a[236:239], a[116:119], v[232:235]
    v_mul_f32 v218, v218, v225
    v_mul_f32 v219, v219, v225
    v_mfma_f32_16x16x32_bf16 v[236:239], a[216:219], a[120:123], 0
    ds_read_b128 a[216:219], v242 offset:61568
    v_cvt_pk_bf16_f32 v216, v216, v217
    v_mfma_f32_16x16x32_bf16 v[236:239], a[220:223], a[124:127], v[236:239]
    ds_read_b128 a[220:223], v243 offset:61568
    v_cvt_pk_bf16_f32 v217, v218, v219
    v_mfma_f32_16x16x32_bf16 v[236:239], a[224:227], a[128:131], v[236:239]
    v_cvt_pk_bf16_f32 v42, v232, v233
    v_cvt_pk_bf16_f32 v45, v234, v235
    v_mfma_f32_16x16x32_bf16 v[236:239], a[228:231], a[132:135], v[236:239]
    ds_read_b128 a[224:227], v242 offset:61696
    ds_read_b128 a[228:231], v243 offset:61696
    v_mfma_f32_16x16x32_bf16 v[236:239], a[232:235], a[136:139], v[236:239]
    ds_read_b128 a[232:235], v242 offset:62976
    v_mul_f32 v220, v220, v225
    v_mfma_f32_16x16x32_bf16 v[236:239], a[236:239], a[140:143], v[236:239]
    ds_read_b128 a[236:239], v243 offset:62976
    v_mul_f32 v221, v221, v225
    v_mfma_f32_16x16x32_bf16 v[228:231], a[144:147], a[240:243], 0
    ds_write_b64 v226, v[216:217] offset:128
    v_mfma_f32_16x16x32_bf16 v[228:231], a[148:151], a[244:247], v[228:231]
    v_mul_f32 v222, v222, v225
    v_mul_f32 v223, v223, v225
    v_mfma_f32_16x16x32_bf16 v[232:235], a[168:171], a[240:243], 0
    s_waitcnt lgkmcnt(6)
    v_cvt_pk_bf16_f32 v72, v236, v237
    v_cvt_pk_bf16_f32 v75, v238, v239
    v_mfma_f32_16x16x32_bf16 v[228:231], a[152:155], a[216:219], v[228:231]
    s_waitcnt lgkmcnt(5)
    v_cvt_pk_bf16_f32 v220, v220, v221
    v_cvt_pk_bf16_f32 v221, v222, v223
    v_mfma_f32_16x16x32_bf16 v[228:231], a[156:159], a[220:223], v[228:231]
    ds_write_b64 v226, v[220:221] offset:256
    v_mfma_f32_16x16x32_bf16 v[232:235], a[172:175], a[244:247], v[232:235]
    s_waitcnt lgkmcnt(5)
    v_cndmask_b32 v244, v205, v244, vcc
    v_cndmask_b32 v245, v245, v204, vcc
    v_mfma_f32_16x16x32_bf16 v[228:231], a[160:163], a[224:227], v[228:231]
    ds_read_b128 v[208:211], v245 offset:192
    s_waitcnt vmcnt(0) lgkmcnt(5)
    v_mfma_f32_16x16x32_bf16 v[228:231], a[164:167], a[228:231], v[228:231]
    s_barrier
    s_mov_b32 vcc_lo, 0xff00fff0
    s_mov_b32 vcc_hi, 0xf000
    v_mfma_f32_16x16x32_bf16 v[232:235], a[176:179], a[216:219], v[232:235]
    v_cndmask_b32 v244, v244, v204, vcc
    s_mov_b32 vcc_lo, 0xfff00ff
    v_mfma_f32_16x16x32_bf16 v[232:235], a[180:183], a[220:223], v[232:235]
    ds_read_b128 v[200:203], v244 offset:256
    v_mul_f32 v228, s38, v228
    v_mfma_f32_16x16x32_bf16 v[232:235], a[184:187], a[224:227], v[232:235]
    s_mov_b32 vcc_hi, 0xffffffff
    v_mul_f32 v229, s38, v229
    v_mul_f32 v230, s38, v230
    v_mfma_f32_16x16x32_bf16 v[232:235], a[188:191], a[228:231], v[232:235]
    v_mul_f32 v231, s38, v231
    v_cvt_pk_bf16_f32 v228, v228, v229
    v_mfma_f32_16x16x32_bf16 v[236:239], a[192:195], a[240:243], 0
    ds_read_b128 a[240:243], v242 offset:63104
    v_cvt_pk_bf16_f32 v229, v230, v231
    v_mfma_f32_16x16x32_bf16 v[236:239], a[196:199], a[244:247], v[236:239]
    ds_write_b64 v247, v[228:229] offset:24576
    v_mfma_f32_16x16x32_bf16 v[236:239], a[200:203], a[216:219], v[236:239]
    s_waitcnt lgkmcnt(3)
    v_mul_f32 v232, s3, v232
    v_mul_f32 v233, s3, v233
    v_mfma_f32_16x16x32_bf16 v[208:211], v[150:153], v[168:171], v[208:211]
    v_mul_f32 v234, s3, v234
    v_mul_f32 v235, s3, v235
    v_mfma_f32_16x16x32_bf16 v[208:211], v[152:155], v[170:173], v[208:211]
    ds_read_b128 a[244:247], v243 offset:63104
    v_cvt_pk_bf16_f32 v232, v232, v233
    v_mfma_f32_16x16x32_bf16 v[236:239], a[204:207], a[220:223], v[236:239]
    ds_read_b128 a[216:219], v242 offset:63232
    v_cvt_pk_bf16_f32 v233, v234, v235
    v_mfma_f32_16x16x32_bf16 v[236:239], a[208:211], a[224:227], v[236:239]
    ds_write_b64 v247, v[232:233] offset:24704
    v_mfma_f32_16x16x32_bf16 v[236:239], a[212:215], a[228:231], v[236:239]
    ds_read_b128 a[220:223], v243 offset:63232
    ds_read_b128 a[224:227], v240 offset:35328
    v_mfma_f32_16x16x32_bf16 v[228:231], a[144:147], a[232:235], 0
    ds_read_b128 a[228:231], v241 offset:35328
    v_cndmask_b32 v246, v246, v204, vcc
    v_mfma_f32_16x16x32_bf16 v[228:231], a[148:151], a[236:239], v[228:231]
    ds_read_b128 v[204:207], v244 offset:192
    ds_read_b128 v[196:199], v246 offset:192
    v_mfma_f32_16x16x32_bf16 v[232:235], a[168:171], a[232:235], 0
    s_mov_b32 vcc_lo, 0xff00ff00
    v_mul_f32 v236, s38, v236
    v_mul_f32 v237, s38, v237
    v_mfma_f32_16x16x32_bf16 v[232:235], a[172:175], a[236:239], v[232:235]
    s_waitcnt lgkmcnt(9)
    v_mul_f32 v238, s38, v238
    v_mul_f32 v239, s38, v239
    v_mfma_f32_16x16x32_bf16 v[200:203], v[120:123], v[168:171], v[200:203]
    s_mov_b32 vcc_hi, 0xff00ff00
    v_cvt_pk_bf16_f32 v236, v236, v237
    v_cvt_pk_bf16_f32 v237, v238, v239
    v_mfma_f32_16x16x32_bf16 v[200:203], v[122:125], v[170:173], v[200:203]
    ds_write_b64 v247, v[236:237] offset:24832
    v_mfma_f32_16x16x32_bf16 v[228:231], a[152:155], a[240:243], v[228:231]
    s_waitcnt lgkmcnt(8)
    v_mfma_f32_16x16x32_bf16 v[228:231], a[156:159], a[244:247], v[228:231]
    s_waitcnt lgkmcnt(7)
    v_mfma_f32_16x16x32_bf16 v[228:231], a[160:163], a[216:219], v[228:231]
    s_waitcnt lgkmcnt(5)
    v_mfma_f32_16x16x32_bf16 v[228:231], a[164:167], a[220:223], v[228:231]
    v_mfma_f32_16x16x32_bf16 v[232:235], a[176:179], a[240:243], v[232:235]
    s_waitcnt lgkmcnt(2)
    v_mfma_f32_16x16x32_bf16 v[204:207], v[114:117], v[168:171], v[204:207]
    s_waitcnt lgkmcnt(1)
    v_mfma_f32_16x16x32_bf16 v[204:207], v[116:119], v[170:173], v[204:207]
    v_mfma_f32_16x16x32_bf16 v[196:199], v[90:93], v[168:171], v[196:199]
    v_mfma_f32_16x16x32_bf16 v[196:199], v[92:95], v[170:173], v[196:199]
    v_mfma_f32_16x16x32_bf16 v[232:235], a[180:183], a[244:247], v[232:235]
    v_mul_f32 v228, s38, v228
    v_mul_f32 v229, s38, v229
    v_mfma_f32_16x16x32_bf16 v[232:235], a[184:187], a[216:219], v[232:235]
    v_mul_f32 v230, s38, v230
    v_mul_f32 v231, s38, v231
    v_mfma_f32_16x16x32_bf16 v[232:235], a[188:191], a[220:223], v[232:235]
    v_cvt_pk_bf16_f32 v228, v228, v229
    v_cvt_pk_bf16_f32 v229, v230, v231
    v_mfma_f32_16x16x32_bf16 v[236:239], a[192:195], a[232:235], 0
    ds_write_b64 v247, v[228:229] offset:30720
    v_mfma_f32_16x16x32_bf16 v[236:239], a[196:199], a[236:239], v[236:239]
    ds_read_b128 a[232:235], v240 offset:35456
    ds_read_b128 a[236:239], v241 offset:35456
    v_mfma_f32_16x16x32_bf16 v[236:239], a[200:203], a[240:243], v[236:239]
    v_mul_f32 v232, s3, v232
    v_mul_f32 v233, s3, v233
    v_mfma_f32_16x16x32_bf16 v[236:239], a[204:207], a[244:247], v[236:239]
    v_mul_f32 v234, s3, v234
    v_mul_f32 v235, s3, v235
    v_mfma_f32_16x16x32_bf16 v[236:239], a[208:211], a[216:219], v[236:239]
    ds_read_b128 a[240:243], v240 offset:35584
    v_cvt_pk_bf16_f32 v232, v232, v233
    v_mfma_f32_16x16x32_bf16 v[236:239], a[212:215], a[220:223], v[236:239]
    ds_read_b128 a[244:247], v241 offset:35584
    v_cvt_pk_bf16_f32 v233, v234, v235
    v_mfma_f32_16x16x32_bf16 v[228:231], a[0:3], a[224:227], 0
    ds_write_b64 v247, v[232:233] offset:30848
    v_mfma_f32_16x16x32_bf16 v[228:231], a[4:7], a[228:231], v[228:231]
    ds_read_b128 a[216:219], v242 offset:64512
    ds_read_b128 a[220:223], v243 offset:64512
    v_mfma_f32_16x16x32_bf16 v[232:235], a[24:27], a[224:227], 0
    v_mul_f32 v236, s38, v236
    v_mul_f32 v237, s38, v237
    v_mfma_f32_16x16x32_bf16 v[232:235], a[28:31], a[228:231], v[232:235]
    s_waitcnt lgkmcnt(6)
    v_mul_f32 v238, s38, v238
    v_mul_f32 v239, s38, v239
    v_mfma_f32_16x16x32_bf16 v[228:231], a[8:11], a[232:235], v[228:231]
    s_waitcnt lgkmcnt(5)
    v_cvt_pk_bf16_f32 v236, v236, v237
    v_cvt_pk_bf16_f32 v237, v238, v239
    v_mfma_f32_16x16x32_bf16 v[228:231], a[12:15], a[236:239], v[228:231]
    ds_write_b64 v247, v[236:237] offset:30976
    v_mfma_f32_16x16x32_bf16 v[232:235], a[32:35], a[232:235], v[232:235]
    s_waitcnt lgkmcnt(5)
    v_max_f32 v248, v204, v205
    v_max3_f32 v248, v248, v206, v207
    v_mfma_f32_16x16x32_bf16 v[228:231], a[16:19], a[240:243], v[228:231]
    ds_read_b128 v[204:207], v245 offset:256
    v_max3_f32 v248, v248, v208, v209
    v_mfma_f32_16x16x32_bf16 v[232:235], a[36:39], a[236:239], v[232:235]
    s_waitcnt lgkmcnt(5)
    v_max3_f32 v248, v248, v210, v211
    v_max3_f32 v248, v248, v196, v197
    v_mfma_f32_16x16x32_bf16 v[228:231], a[20:23], a[244:247], v[228:231]
    ds_read_b128 v[208:211], v246 offset:256
    v_max3_f32 v248, v248, v198, v199
    v_mfma_f32_16x16x32_bf16 v[232:235], a[40:43], a[240:243], v[232:235]
    ds_read_b128 v[196:199], v244 offset:320
    v_max3_f32 v248, v248, v200, v201
    v_mfma_f32_16x16x32_bf16 v[232:235], a[44:47], a[244:247], v[232:235]
    v_max3_f32 v248, v248, v202, v203
    v_mfma_f32_16x16x32_bf16 v[236:239], a[48:51], a[224:227], 0
    ds_read_b128 v[200:203], v245 offset:320
    v_mfma_f32_16x16x32_bf16 v[236:239], a[52:55], a[228:231], v[236:239]
    v_mfma_f32_16x16x32_bf16 v[236:239], a[56:59], a[232:235], v[236:239]
    v_mfma_f32_16x16x32_bf16 v[236:239], a[60:63], a[236:239], v[236:239]
    v_mfma_f32_16x16x32_bf16 v[236:239], a[64:67], a[240:243], v[236:239]
    s_waitcnt lgkmcnt(3)
    v_mfma_f32_16x16x32_bf16 v[204:207], v[156:159], v[168:171], v[204:207]
    v_mfma_f32_16x16x32_bf16 v[204:207], v[158:161], v[170:173], v[204:207]
    s_waitcnt lgkmcnt(2)
    s_waitcnt lgkmcnt(1)
    v_mfma_f32_16x16x32_bf16 v[208:211], v[96:99], v[168:171], v[208:211]
    v_mfma_f32_16x16x32_bf16 v[208:211], v[98:101], v[170:173], v[208:211]
    v_mfma_f32_16x16x32_bf16 v[196:199], v[126:129], v[168:171], v[196:199]
    s_waitcnt lgkmcnt(0)
    v_mfma_f32_16x16x32_bf16 v[196:199], v[128:131], v[170:173], v[196:199]
    v_mfma_f32_16x16x32_bf16 v[200:203], v[162:165], v[168:171], v[200:203]
    v_max3_f32 v248, v248, v204, v205
    v_max3_f32 v248, v248, v206, v207
    v_mfma_f32_16x16x32_bf16 v[200:203], v[164:167], v[170:173], v[200:203]
    ds_read_b128 v[204:207], v246 offset:320
    v_max3_f32 v248, v248, v208, v209
    v_mfma_f32_16x16x32_bf16 v[236:239], a[68:71], a[244:247], v[236:239]
    v_max3_f32 v248, v248, v210, v211
    ds_read_b128 v[208:211], v244 offset:192
    v_max3_f32 v248, v248, v196, v197
    ds_read_b128 v[196:199], v245 offset:192
    s_nop 0
    v_max3_f32 v248, v248, v200, v201
    ds_read_b128 v[200:203], v246 offset:192
    s_waitcnt lgkmcnt(3)
    v_mfma_f32_16x16x32_bf16 v[204:207], v[138:141], v[168:171], v[204:207]
    v_mfma_f32_16x16x32_bf16 v[204:207], v[140:143], v[170:173], v[204:207]
    s_nop 7
    s_waitcnt lgkmcnt(1)
    v_mfma_f32_16x16x32_bf16 v[208:211], v[114:117], v[168:171], v[208:211]
    s_waitcnt lgkmcnt(0)
    v_cvt_pk_bf16_f32 v114, v228, v229
    v_cvt_pk_bf16_f32 v115, v230, v231
    v_mfma_f32_16x16x32_bf16 v[208:211], v[116:119], v[170:173], v[208:211]
    v_cvt_pk_bf16_f32 v116, v232, v233
    v_cvt_pk_bf16_f32 v117, v234, v235
    v_mfma_f32_16x16x32_bf16 v[196:199], v[150:153], v[168:171], v[196:199]
    v_cvt_pk_bf16_f32 v118, v236, v237
    v_cvt_pk_bf16_f32 v119, v238, v239
    v_mfma_f32_16x16x32_bf16 v[196:199], v[152:155], v[170:173], v[196:199]
    v_max3_f32 v248, v248, v204, v205
    v_mov_b32 v225, v248
    v_mfma_f32_16x16x32_bf16 v[200:203], v[90:93], v[168:171], v[200:203]
    ds_read_b128 v[204:207], v244 offset:256
    v_permlane16_swap_b32 v248, v225
    v_mfma_f32_16x16x32_bf16 v[200:203], v[92:95], v[170:173], v[200:203]
    v_max_f32 v248, v248, v225
    v_mov_b32 v225, v248
    v_mfma_f32_16x16x32_bf16 v[228:231], a[224:227], a[72:75], 0
    v_mfma_f32_16x16x32_bf16 v[228:231], a[228:231], a[76:79], v[228:231]
    v_permlane32_swap_b32 v248, v225
    v_max_f32 v248, v248, v225
    v_mfma_f32_16x16x32_bf16 v[228:231], a[232:235], a[80:83], v[228:231]
    v_sub_f32 v208, v208, v248
    v_sub_f32 v209, v209, v248
    v_mfma_f32_16x16x32_bf16 v[228:231], a[236:239], a[84:87], v[228:231]
    v_exp_f32 v208, v208
    v_mfma_f32_16x16x32_bf16 v[228:231], a[240:243], a[88:91], v[228:231]
    v_exp_f32 v209, v209
    v_mfma_f32_16x16x32_bf16 v[228:231], a[244:247], a[92:95], v[228:231]
    v_sub_f32 v210, v210, v248
    v_sub_f32 v211, v211, v248
    v_mfma_f32_16x16x32_bf16 v[232:235], a[224:227], a[96:99], 0
    v_exp_f32 v210, v210
    v_mfma_f32_16x16x32_bf16 v[232:235], a[228:231], a[100:103], v[232:235]
    s_waitcnt lgkmcnt(0)
    v_exp_f32 v211, v211
    v_mfma_f32_16x16x32_bf16 v[204:207], v[120:123], v[168:171], v[204:207]
    v_cvt_pk_bf16_f32 v18, v228, v229
    v_cvt_pk_bf16_f32 v21, v230, v231
    v_mfma_f32_16x16x32_bf16 v[204:207], v[122:125], v[170:173], v[204:207]
    v_cvt_pk_bf16_f32 v193, v208, v209
    v_cvt_pk_bf16_f32 v180, v210, v211
    v_mfma_f32_16x16x32_bf16 v[232:235], a[232:235], a[104:107], v[232:235]
    ds_read_b128 v[208:211], v245 offset:256
    v_sub_f32 v196, v196, v248
    v_mfma_f32_16x16x32_bf16 v[232:235], a[236:239], a[108:111], v[232:235]
    v_exp_f32 v196, v196
    v_mfma_f32_16x16x32_bf16 v[232:235], a[240:243], a[112:115], v[232:235]
    v_sub_f32 v197, v197, v248
    v_sub_f32 v198, v198, v248
    v_mfma_f32_16x16x32_bf16 v[232:235], a[244:247], a[116:119], v[232:235]
    v_exp_f32 v197, v197
    v_mfma_f32_16x16x32_bf16 v[236:239], a[224:227], a[120:123], 0
    ds_read_b128 a[224:227], v242 offset:64640
    v_sub_f32 v199, v199, v248
    v_mfma_f32_16x16x32_bf16 v[236:239], a[228:231], a[124:127], v[236:239]
    ds_read_b128 a[228:231], v243 offset:64640
    v_cvt_pk_bf16_f32 v194, v196, v197
    v_mfma_f32_16x16x32_bf16 v[236:239], a[232:235], a[128:131], v[236:239]
    v_cvt_pk_bf16_f32 v48, v232, v233
    v_cvt_pk_bf16_f32 v51, v234, v235
    v_mfma_f32_16x16x32_bf16 v[236:239], a[236:239], a[132:135], v[236:239]
    ds_read_b128 a[232:235], v242 offset:64768
    ds_read_b128 a[236:239], v243 offset:64768
    v_mfma_f32_16x16x32_bf16 v[236:239], a[240:243], a[136:139], v[236:239]
    v_add_u32 v242, 0xf000, v242
    v_add_u32 v243, 0xf000, v243
    v_mfma_f32_16x16x32_bf16 v[236:239], a[244:247], a[140:143], v[236:239]
    ds_read_b128 a[240:243], v242 offset:4608
    ds_read_b128 a[244:247], v243 offset:4608
    v_mfma_f32_16x16x32_bf16 v[228:231], a[144:147], a[216:219], 0
    s_waitcnt lgkmcnt(6)
    v_exp_f32 v198, v198
    v_mfma_f32_16x16x32_bf16 v[208:211], v[156:159], v[168:171], v[208:211]
    v_exp_f32 v199, v199
    v_mfma_f32_16x16x32_bf16 v[208:211], v[158:161], v[170:173], v[208:211]
    v_cvt_pk_bf16_f32 v78, v236, v237
    v_cvt_pk_bf16_f32 v81, v238, v239
    v_mfma_f32_16x16x32_bf16 v[228:231], a[148:151], a[220:223], v[228:231]
    s_waitcnt lgkmcnt(5)
    v_cvt_pk_bf16_f32 v181, v198, v199
    v_sub_f32 v200, v200, v248
    v_mfma_f32_16x16x32_bf16 v[228:231], a[152:155], a[224:227], v[228:231]
    ds_read_b128 v[196:199], v246 offset:256
    v_sub_f32 v201, v201, v248
    v_mfma_f32_16x16x32_bf16 v[232:235], a[168:171], a[216:219], 0
    s_waitcnt lgkmcnt(5)
    v_exp_f32 v200, v200
    v_mfma_f32_16x16x32_bf16 v[228:231], a[156:159], a[228:231], v[228:231]
    s_waitcnt lgkmcnt(4)
    v_exp_f32 v201, v201
    v_mfma_f32_16x16x32_bf16 v[228:231], a[160:163], a[232:235], v[228:231]
    s_waitcnt lgkmcnt(3)
    v_sub_f32 v202, v202, v248
    v_sub_f32 v203, v203, v248
    v_mfma_f32_16x16x32_bf16 v[228:231], a[164:167], a[236:239], v[228:231]
    v_exp_f32 v202, v202
    v_mfma_f32_16x16x32_bf16 v[232:235], a[172:175], a[220:223], v[232:235]
    v_exp_f32 v203, v203
    v_mfma_f32_16x16x32_bf16 v[232:235], a[176:179], a[224:227], v[232:235]
    v_cvt_pk_bf16_f32 v192, v200, v201
    v_cvt_pk_bf16_f32 v195, v202, v203
    v_mfma_f32_16x16x32_bf16 v[232:235], a[180:183], a[228:231], v[232:235]
    ds_read_b128 v[200:203], v244 offset:320
    v_mul_f32 v228, s38, v228
    v_mfma_f32_16x16x32_bf16 v[212:215], v[0:3], v[192:195], 0
    v_mul_f32 v229, s38, v229
    v_mul_f32 v230, s38, v230
    v_mfma_f32_16x16x32_bf16 v[216:219], v[30:33], v[192:195], 0
    s_waitcnt lgkmcnt(1)
    v_mul_f32 v231, s38, v231
    v_cvt_pk_bf16_f32 v228, v228, v229
    v_mfma_f32_16x16x32_bf16 v[220:223], v[60:63], v[192:195], 0
    v_cvt_pk_bf16_f32 v229, v230, v231
    v_sub_f32 v204, v204, v248
    v_mfma_f32_16x16x32_bf16 v[224:227], a[248:251], v[192:195], 0
    ds_write_b64 v247, v[228:229] offset:36864
    v_mfma_f32_16x16x32_bf16 v[196:199], v[96:99], v[168:171], v[196:199]
    v_exp_f32 v204, v204
    v_mfma_f32_16x16x32_bf16 v[196:199], v[98:101], v[170:173], v[196:199]
    v_sub_f32 v205, v205, v248
    v_sub_f32 v206, v206, v248
    v_mfma_f32_16x16x32_bf16 v[232:235], a[184:187], a[232:235], v[232:235]
    v_exp_f32 v205, v205
    v_mfma_f32_16x16x32_bf16 v[232:235], a[188:191], a[236:239], v[232:235]
    s_waitcnt lgkmcnt(1)
    v_exp_f32 v206, v206
    v_mfma_f32_16x16x32_bf16 v[200:203], v[126:129], v[168:171], v[200:203]
    v_sub_f32 v207, v207, v248
    v_cvt_pk_bf16_f32 v183, v204, v205
    v_mfma_f32_16x16x32_bf16 v[200:203], v[128:131], v[170:173], v[200:203]
    v_exp_f32 v207, v207
    v_mfma_f32_16x16x32_bf16 v[236:239], a[192:195], a[216:219], 0
    v_mul_f32 v232, s3, v232
    v_mul_f32 v233, s3, v233
    v_mfma_f32_16x16x32_bf16 v[236:239], a[196:199], a[220:223], v[236:239]
    v_mul_f32 v234, s3, v234
    v_mul_f32 v235, s3, v235
    v_mfma_f32_16x16x32_bf16 v[236:239], a[200:203], a[224:227], v[236:239]
    ds_read_b128 a[216:219], v242 offset:4736
    v_cvt_pk_bf16_f32 v232, v232, v233
    v_mfma_f32_16x16x32_bf16 v[236:239], a[204:207], a[228:231], v[236:239]
    ds_read_b128 a[220:223], v243 offset:4736
    v_cvt_pk_bf16_f32 v233, v234, v235
    v_mfma_f32_16x16x32_bf16 v[236:239], a[208:211], a[232:235], v[236:239]
    ds_write_b64 v247, v[232:233] offset:36992
    v_mfma_f32_16x16x32_bf16 v[236:239], a[212:215], a[236:239], v[236:239]
    ds_read_b128 a[224:227], v242 offset:4864
    ds_read_b128 a[228:231], v243 offset:4864
    v_mfma_f32_16x16x32_bf16 v[228:231], a[144:147], a[240:243], 0
    v_add_u32 v242, 0x7800, v242
    v_add_u32 v243, 0x4200, v243
    v_mfma_f32_16x16x32_bf16 v[228:231], a[148:151], a[244:247], v[228:231]
    v_cndmask_b32 v242, v242, v243, vcc
    v_add_u32 v243, 0xfffe2000, v242
    v_mfma_f32_16x16x32_bf16 v[232:235], a[168:171], a[240:243], 0
    s_mov_b32 vcc_lo, 0xf0f0f0f0
    v_mul_f32 v236, s38, v236
    v_mul_f32 v237, s38, v237
    v_mfma_f32_16x16x32_bf16 v[232:235], a[172:175], a[244:247], v[232:235]
    v_mul_f32 v238, s38, v238
    v_mul_f32 v239, s38, v239
    v_cvt_pk_bf16_f32 v236, v236, v237
    s_waitcnt lgkmcnt(4)
    v_mfma_f32_16x16x32_bf16 v[228:231], a[152:155], a[216:219], v[228:231]
    s_mov_b32 vcc_hi, 0xf0f0f0f0
    v_cvt_pk_bf16_f32 v237, v238, v239
    v_cndmask_b32 v242, v242, v243, vcc
    v_mfma_f32_16x16x32_bf16 v[232:235], a[176:179], a[216:219], v[232:235]
    s_waitcnt lgkmcnt(3)
    ds_read_b128 a[232:235], v242 offset:0
    v_mfma_f32_16x16x32_bf16 v[228:231], a[156:159], a[220:223], v[228:231]
    ds_write_b64 v247, v[236:237] offset:37120
    v_mfma_f32_16x16x32_bf16 v[232:235], a[180:183], a[220:223], v[232:235]
    s_mov_b32 vcc_lo, 0xcccccccc
    v_xor_b32 v243, 64, v242
    v_cvt_pk_bf16_f32 v186, v206, v207
    v_mfma_f32_16x16x32_bf16 v[236:239], a[192:195], a[240:243], 0
    ds_read_b128 a[236:239], v243 offset:0
    ds_read_b128 a[240:243], v242 offset:128
    v_mfma_f32_16x16x32_bf16 v[236:239], a[196:199], a[244:247], v[236:239]
    ds_read_b128 a[244:247], v243 offset:128
    ds_read_b128 v[204:207], v245 offset:320
    v_mfma_f32_16x16x32_bf16 v[236:239], a[200:203], a[216:219], v[236:239]
    ds_read_b128 a[216:219], v242 offset:256
    v_sub_f32 v208, v208, v248
    v_mfma_f32_16x16x32_bf16 v[236:239], a[204:207], a[220:223], v[236:239]
    s_waitcnt lgkmcnt(8)
    ds_read_b128 a[220:223], v243 offset:256
    v_mfma_f32_16x16x32_bf16 v[228:231], a[160:163], a[224:227], v[228:231]
    s_mov_b32 vcc_hi, 0xcccccccc
    v_exp_f32 v208, v208
    v_mfma_f32_16x16x32_bf16 v[232:235], a[184:187], a[224:227], v[232:235]
    s_waitcnt lgkmcnt(8)
    v_sub_f32 v209, v209, v248
    v_sub_f32 v210, v210, v248
    v_mfma_f32_16x16x32_bf16 v[228:231], a[164:167], a[228:231], v[228:231]
    v_exp_f32 v209, v209
    v_mfma_f32_16x16x32_bf16 v[232:235], a[188:191], a[228:231], v[232:235]
    v_exp_f32 v210, v210
    v_mfma_f32_16x16x32_bf16 v[236:239], a[208:211], a[224:227], v[236:239]
    ds_read_b128 a[224:227], v240 offset:36864
    v_sub_f32 v211, v211, v248
    v_mfma_f32_16x16x32_bf16 v[236:239], a[212:215], a[228:231], v[236:239]
    ds_read_b128 a[228:231], v241 offset:36864
    v_mul_f32 v228, s38, v228
    v_mul_f32 v229, s38, v229
    v_mul_f32 v230, s38, v230
    v_mul_f32 v231, s38, v231
    v_cvt_pk_bf16_f32 v228, v228, v229
    v_cvt_pk_bf16_f32 v229, v230, v231
    s_waitcnt lgkmcnt(4)
    v_mfma_f32_16x16x32_bf16 v[204:207], v[162:165], v[168:171], v[204:207]
    ds_write_b64 v247, v[228:229] offset:43008
    v_mfma_f32_16x16x32_bf16 v[204:207], v[164:167], v[170:173], v[204:207]
    v_mul_f32 v232, s3, v232
    v_mul_f32 v233, s3, v233
    v_mfma_f32_16x16x32_bf16 v[228:231], a[144:147], a[232:235], 0
    v_mul_f32 v234, s3, v234
    v_mul_f32 v235, s3, v235
    v_mfma_f32_16x16x32_bf16 v[228:231], a[148:151], a[236:239], v[228:231]
    v_cvt_pk_bf16_f32 v232, v232, v233
    v_cvt_pk_bf16_f32 v233, v234, v235
    v_mfma_f32_16x16x32_bf16 v[228:231], a[152:155], a[240:243], v[228:231]
    ds_write_b64 v247, v[232:233] offset:43136
    v_mfma_f32_16x16x32_bf16 v[228:231], a[156:159], a[244:247], v[228:231]
    s_waitcnt lgkmcnt(5)
    v_mul_f32 v236, s38, v236
    v_mul_f32 v237, s38, v237
    v_mfma_f32_16x16x32_bf16 v[228:231], a[160:163], a[216:219], v[228:231]
    s_waitcnt lgkmcnt(4)
    v_mul_f32 v238, s38, v238
    v_mul_f32 v239, s38, v239
    v_mfma_f32_16x16x32_bf16 v[228:231], a[164:167], a[220:223], v[228:231]
    v_cvt_pk_bf16_f32 v236, v236, v237
    v_cvt_pk_bf16_f32 v237, v238, v239
    v_mfma_f32_16x16x32_bf16 v[232:235], a[168:171], a[232:235], 0
    ds_write_b64 v247, v[236:237] offset:43264
    v_mfma_f32_16x16x32_bf16 v[232:235], a[172:175], a[236:239], v[232:235]
    v_exp_f32 v211, v211
    v_mfma_f32_16x16x32_bf16 v[232:235], a[176:179], a[240:243], v[232:235]
    v_cvt_pk_bf16_f32 v184, v208, v209
    v_mul_f32 v228, s38, v228
    v_mfma_f32_16x16x32_bf16 v[232:235], a[180:183], a[244:247], v[232:235]
    v_mul_f32 v229, s38, v229
    v_mul_f32 v230, s38, v230
    v_mfma_f32_16x16x32_bf16 v[232:235], a[184:187], a[216:219], v[232:235]
    v_mul_f32 v231, s38, v231
    v_cvt_pk_bf16_f32 v228, v228, v229
    v_mfma_f32_16x16x32_bf16 v[232:235], a[188:191], a[220:223], v[232:235]
    v_cvt_pk_bf16_f32 v229, v230, v231
    v_cvt_pk_bf16_f32 v187, v210, v211
    v_mfma_f32_16x16x32_bf16 v[236:239], a[192:195], a[232:235], 0
    ds_write_b64 v247, v[228:229] offset:49152
    v_mfma_f32_16x16x32_bf16 v[236:239], a[196:199], a[236:239], v[236:239]
    ds_read_b128 a[232:235], v240 offset:36992
    ds_read_b128 a[236:239], v241 offset:36992
    v_mfma_f32_16x16x32_bf16 v[236:239], a[200:203], a[240:243], v[236:239]
    s_waitcnt lgkmcnt(5)
    v_mul_f32 v232, s3, v232
    v_mul_f32 v233, s3, v233
    v_mfma_f32_16x16x32_bf16 v[236:239], a[204:207], a[244:247], v[236:239]
    v_mul_f32 v234, s3, v234
    v_mul_f32 v235, s3, v235
    v_mfma_f32_16x16x32_bf16 v[236:239], a[208:211], a[216:219], v[236:239]
    ds_read_b128 a[240:243], v240 offset:37120
    v_cvt_pk_bf16_f32 v232, v232, v233
    v_mfma_f32_16x16x32_bf16 v[236:239], a[212:215], a[220:223], v[236:239]
    ds_read_b128 a[244:247], v241 offset:37120
    v_cvt_pk_bf16_f32 v233, v234, v235
    v_mfma_f32_16x16x32_bf16 v[228:231], a[0:3], a[224:227], 0
    ds_write_b64 v247, v[232:233] offset:49280
    v_mfma_f32_16x16x32_bf16 v[228:231], a[4:7], a[228:231], v[228:231]
    ds_read_b128 a[216:219], v242 offset:3072
    ds_read_b128 a[220:223], v243 offset:3072
    v_mfma_f32_16x16x32_bf16 v[232:235], a[24:27], a[224:227], 0
    v_mul_f32 v236, s38, v236
    v_mul_f32 v237, s38, v237
    v_mfma_f32_16x16x32_bf16 v[232:235], a[28:31], a[228:231], v[232:235]
    s_waitcnt lgkmcnt(6)
    v_mul_f32 v238, s38, v238
    v_mul_f32 v239, s38, v239
    v_mfma_f32_16x16x32_bf16 v[228:231], a[8:11], a[232:235], v[228:231]
    s_waitcnt lgkmcnt(5)
    v_cvt_pk_bf16_f32 v236, v236, v237
    v_cvt_pk_bf16_f32 v237, v238, v239
    v_mfma_f32_16x16x32_bf16 v[228:231], a[12:15], a[236:239], v[228:231]
    ds_write_b64 v247, v[236:237] offset:49408
    v_mfma_f32_16x16x32_bf16 v[232:235], a[32:35], a[232:235], v[232:235]
    s_waitcnt lgkmcnt(5)
    v_add_u32 v240, 0xffff1000, v240
    v_add_u32 v241, 0xffff1000, v241
    v_mfma_f32_16x16x32_bf16 v[228:231], a[16:19], a[240:243], v[228:231]
    ds_read_b128 v[208:211], v246 offset:320
    v_sub_f32 v196, v196, v248
    v_mfma_f32_16x16x32_bf16 v[232:235], a[36:39], a[236:239], v[232:235]
    s_waitcnt lgkmcnt(5)
    v_exp_f32 v196, v196
    v_mfma_f32_16x16x32_bf16 v[228:231], a[20:23], a[244:247], v[228:231]
    v_sub_f32 v197, v197, v248
    v_sub_f32 v198, v198, v248
    v_mfma_f32_16x16x32_bf16 v[232:235], a[40:43], a[240:243], v[232:235]
    v_exp_f32 v197, v197
    v_mfma_f32_16x16x32_bf16 v[232:235], a[44:47], a[244:247], v[232:235]
    v_exp_f32 v198, v198
    v_mfma_f32_16x16x32_bf16 v[236:239], a[48:51], a[224:227], 0
    v_sub_f32 v199, v199, v248
    v_cvt_pk_bf16_f32 v182, v196, v197
    v_mfma_f32_16x16x32_bf16 v[236:239], a[52:55], a[228:231], v[236:239]
    v_exp_f32 v199, v199
    v_mfma_f32_16x16x32_bf16 v[212:215], v[4:7], v[180:183], v[212:215]
    v_cvt_pk_bf16_f32 v185, v198, v199
    v_sub_f32 v200, v200, v248
    v_mfma_f32_16x16x32_bf16 v[216:219], v[34:37], v[180:183], v[216:219]
    ds_read_b128 v[196:199], v244 offset:0
    v_sub_f32 v201, v201, v248
    v_mfma_f32_16x16x32_bf16 v[220:223], v[64:67], v[180:183], v[220:223]
    s_waitcnt lgkmcnt(1)
    v_exp_f32 v200, v200
    v_mfma_f32_16x16x32_bf16 v[224:227], a[248:251], v[180:183], v[224:227]
    v_exp_f32 v201, v201
    v_mfma_f32_16x16x32_bf16 v[212:215], v[8:11], v[184:187], v[212:215]
    v_cvt_pk_bf16_f32 v189, v200, v201
    v_sub_f32 v204, v204, v248
    v_mfma_f32_16x16x32_bf16 v[216:219], v[38:41], v[184:187], v[216:219]
    ds_read_b128 v[200:203], v245 offset:0
    v_sub_f32 v205, v205, v248
    v_mfma_f32_16x16x32_bf16 v[220:223], v[68:71], v[184:187], v[220:223]
    v_exp_f32 v204, v204
    v_mfma_f32_16x16x32_bf16 v[224:227], a[248:251], v[184:187], v[224:227]
    v_exp_f32 v205, v205
    v_mfma_f32_16x16x32_bf16 v[208:211], v[138:141], v[168:171], v[208:211]
    ds_read_b64 v[168:169], v247 offset:18432
    v_cvt_pk_bf16_f32 v190, v204, v205
    v_mfma_f32_16x16x32_bf16 v[208:211], v[140:143], v[170:173], v[208:211]
    ds_read_b128 v[204:207], v246 offset:0
    ds_read_b64 v[170:171], v247 offset:18560
    v_mfma_f32_16x16x32_bf16 v[236:239], a[56:59], a[232:235], v[236:239]
    ds_read_b64 v[172:173], v247 offset:18688
    s_waitcnt lgkmcnt(5)
    v_mfma_f32_16x16x32_bf16 v[196:199], v[120:123], v[174:177], v[196:199]
    v_mfma_f32_16x16x32_bf16 v[196:199], v[122:125], v[176:179], v[196:199]
    v_mfma_f32_16x16x32_bf16 v[236:239], a[60:63], a[236:239], v[236:239]
    v_sub_f32 v208, v208, v248
    v_sub_f32 v209, v209, v248
    v_mfma_f32_16x16x32_bf16 v[236:239], a[64:67], a[240:243], v[236:239]
    s_waitcnt lgkmcnt(4)
    v_exp_f32 v208, v208
    v_mfma_f32_16x16x32_bf16 v[200:203], v[156:159], v[174:177], v[200:203]
    v_exp_f32 v209, v209
    v_mfma_f32_16x16x32_bf16 v[200:203], v[158:161], v[176:179], v[200:203]
    v_cvt_pk_bf16_f32 v188, v208, v209
    v_max_f32 v248, v196, v197
    v_mfma_f32_16x16x32_bf16 v[236:239], a[68:71], a[244:247], v[236:239]
    ds_read_b128 v[208:211], v244 offset:64
    v_max3_f32 v248, v248, v198, v199
    v_mfma_f32_16x16x32_bf16 v[212:215], v[12:15], v[188:191], v[212:215]
    ds_read_b128 v[196:199], v245 offset:64
    s_waitcnt lgkmcnt(4)
    v_mfma_f32_16x16x32_bf16 v[216:219], v[42:45], v[188:191], v[216:219]
    v_max3_f32 v248, v248, v200, v201
    v_max3_f32 v248, v248, v202, v203
    v_mfma_f32_16x16x32_bf16 v[220:223], v[72:75], v[188:191], v[220:223]
    ds_read_b128 v[200:203], v246 offset:64
    v_mfma_f32_16x16x32_bf16 v[224:227], a[248:251], v[188:191], v[224:227]
    v_mfma_f32_16x16x32_bf16 v[204:207], v[96:99], v[174:177], v[204:207]
    v_mfma_f32_16x16x32_bf16 v[204:207], v[98:101], v[176:179], v[204:207]
    s_nop 5
    v_rcp_f32 v225, v224
    s_nop 0
    s_waitcnt lgkmcnt(2)
    v_mfma_f32_16x16x32_bf16 v[208:211], v[126:129], v[174:177], v[208:211]
    v_mul_f32 v212, v212, v225
    v_mul_f32 v213, v213, v225
    v_mfma_f32_16x16x32_bf16 v[208:211], v[128:131], v[176:179], v[208:211]
    s_waitcnt lgkmcnt(1)
    v_mul_f32 v214, v214, v225
    v_mul_f32 v215, v215, v225
    v_mfma_f32_16x16x32_bf16 v[196:199], v[162:165], v[174:177], v[196:199]
    v_cvt_pk_bf16_f32 v212, v212, v213
    v_cvt_pk_bf16_f32 v213, v214, v215
    v_mfma_f32_16x16x32_bf16 v[196:199], v[164:167], v[176:179], v[196:199]
    s_waitcnt lgkmcnt(0)
    v_mul_f32 v216, v216, v225
    v_mul_f32 v217, v217, v225
    v_mfma_f32_16x16x32_bf16 v[200:203], v[138:141], v[174:177], v[200:203]
    ds_write_b64 v247, v[212:213] offset:6144
    v_mfma_f32_16x16x32_bf16 v[200:203], v[140:143], v[176:179], v[200:203]
    v_mul_f32 v218, v218, v225
    v_mul_f32 v219, v219, v225
    v_cvt_pk_bf16_f32 v216, v216, v217
    v_cvt_pk_bf16_f32 v217, v218, v219
    ds_write_b64 v247, v[216:217] offset:6272
    v_mul_f32 v220, v220, v225
    v_mul_f32 v221, v221, v225
    v_mul_f32 v222, v222, v225
    v_mul_f32 v223, v223, v225
    v_cvt_pk_bf16_f32 v220, v220, v221
    v_cvt_pk_bf16_f32 v221, v222, v223
    ds_write_b64 v247, v[220:221] offset:6400
    v_max3_f32 v248, v248, v204, v205
    v_max3_f32 v248, v248, v206, v207
    ds_read_b128 v[204:207], v244 offset:128
    v_max3_f32 v248, v248, v208, v209
    v_max3_f32 v248, v248, v210, v211
    ds_read_b128 v[208:211], v245 offset:128
    v_max3_f32 v248, v248, v196, v197
    v_max3_f32 v248, v248, v198, v199
    ds_read_b128 v[196:199], v246 offset:128
    v_max3_f32 v248, v248, v200, v201
    v_max3_f32 v248, v248, v202, v203
    ds_read_b128 v[200:203], v244 offset:0
    s_waitcnt lgkmcnt(3)
    v_mfma_f32_16x16x32_bf16 v[204:207], v[132:135], v[174:177], v[204:207]
    v_mfma_f32_16x16x32_bf16 v[204:207], v[134:137], v[176:179], v[204:207]
    s_waitcnt lgkmcnt(2)
    v_mfma_f32_16x16x32_bf16 v[208:211], v[102:105], v[174:177], v[208:211]
    s_waitcnt lgkmcnt(1)
    v_mfma_f32_16x16x32_bf16 v[208:211], v[104:107], v[176:179], v[208:211]
    v_mfma_f32_16x16x32_bf16 v[196:199], v[114:117], v[174:177], v[196:199]
    s_waitcnt lgkmcnt(0)
    v_mfma_f32_16x16x32_bf16 v[196:199], v[116:119], v[176:179], v[196:199]
    v_mfma_f32_16x16x32_bf16 v[200:203], v[120:123], v[174:177], v[200:203]
    v_cvt_pk_bf16_f32 v120, v228, v229
    v_cvt_pk_bf16_f32 v121, v230, v231
    v_mfma_f32_16x16x32_bf16 v[200:203], v[122:125], v[176:179], v[200:203]
    v_cvt_pk_bf16_f32 v122, v232, v233
    v_cvt_pk_bf16_f32 v123, v234, v235
    v_mfma_f32_16x16x32_bf16 v[228:231], a[224:227], a[72:75], 0
    v_cvt_pk_bf16_f32 v124, v236, v237
    v_cvt_pk_bf16_f32 v125, v238, v239
    v_mfma_f32_16x16x32_bf16 v[228:231], a[228:231], a[76:79], v[228:231]
    v_max3_f32 v248, v248, v204, v205
    v_max3_f32 v248, v248, v208, v209
    v_mfma_f32_16x16x32_bf16 v[228:231], a[232:235], a[80:83], v[228:231]
    ds_read_b128 v[204:207], v245 offset:0
    ds_read_b128 v[208:211], v246 offset:0
    v_mfma_f32_16x16x32_bf16 v[228:231], a[236:239], a[84:87], v[228:231]
    v_max3_f32 v248, v248, v196, v197
    v_mov_b32 v225, v248
    v_mfma_f32_16x16x32_bf16 v[228:231], a[240:243], a[88:91], v[228:231]
    ds_read_b128 v[196:199], v244 offset:64
    v_permlane16_swap_b32 v248, v225
    v_mfma_f32_16x16x32_bf16 v[228:231], a[244:247], a[92:95], v[228:231]
    v_max_f32 v248, v248, v225
    v_mov_b32 v225, v248
    v_mfma_f32_16x16x32_bf16 v[232:235], a[224:227], a[96:99], 0
    v_mfma_f32_16x16x32_bf16 v[232:235], a[228:231], a[100:103], v[232:235]
    v_permlane32_swap_b32 v248, v225
    v_max_f32 v248, v248, v225
    v_mfma_f32_16x16x32_bf16 v[232:235], a[232:235], a[104:107], v[232:235]
    v_sub_f32 v200, v200, v248
    v_cvt_pk_bf16_f32 v24, v228, v229
    v_mfma_f32_16x16x32_bf16 v[232:235], a[236:239], a[108:111], v[232:235]
    v_cvt_pk_bf16_f32 v27, v230, v231
    v_mbcnt_lo_u32_b32 v228, -1, 0
    v_mfma_f32_16x16x32_bf16 v[232:235], a[240:243], a[112:115], v[232:235]
    v_mbcnt_hi_u32_b32 v228, -1, v228
    v_lshrrev_b32 v229, 1, v228
    v_mfma_f32_16x16x32_bf16 v[232:235], a[244:247], a[116:119], v[232:235]
    s_waitcnt lgkmcnt(2)
    v_add_u32 v229, 64, v229
    v_mul_u32_u24 v230, 43, v229
    v_mfma_f32_16x16x32_bf16 v[204:207], v[156:159], v[174:177], v[204:207]
    s_waitcnt lgkmcnt(1)
    v_lshrrev_b32 v231, 8, v230
    v_lshrrev_b32 v230, 7, v230
    v_mfma_f32_16x16x32_bf16 v[204:207], v[158:161], v[176:179], v[204:207]
    s_waitcnt lgkmcnt(0)
    v_cvt_pk_bf16_f32 v54, v232, v233
    v_cvt_pk_bf16_f32 v57, v234, v235
    v_mfma_f32_16x16x32_bf16 v[208:211], v[96:99], v[174:177], v[208:211]
    v_mad_i32_i24 v229, v230, -3, v229
    v_and_b32 v231, 4, v231
    v_mfma_f32_16x16x32_bf16 v[208:211], v[98:101], v[176:179], v[208:211]
    v_xor_b32 v230, v230, v231
    v_and_b32 v231, 4, v230
    v_mfma_f32_16x16x32_bf16 v[196:199], v[126:129], v[174:177], v[196:199]
    v_mul_u32_u24 v251, 24, v231
    v_lshrrev_b32 v231, 3, v230
    v_mfma_f32_16x16x32_bf16 v[196:199], v[128:131], v[176:179], v[196:199]
    v_lshl_add_u32 v251, v231, 2, v251
    v_and_or_b32 v251, v230, 3, v251
    v_mfma_f32_16x16x32_bf16 v[236:239], a[224:227], a[120:123], 0
    ds_read_b128 a[224:227], v242 offset:3200
    v_mad_u32_u24 v251, v251, 3, v229
    v_mfma_f32_16x16x32_bf16 v[236:239], a[228:231], a[124:127], v[236:239]
    ds_read_b128 a[228:231], v243 offset:3200
    v_and_b32 v231, 1, v228
    v_mfma_f32_16x16x32_bf16 v[236:239], a[232:235], a[128:131], v[236:239]
    ds_read_b128 a[232:235], v242 offset:3328
    v_lshl_add_u32 v251, v251, 3, v231
    v_mfma_f32_16x16x32_bf16 v[236:239], a[236:239], a[132:135], v[236:239]
    ds_read_b128 a[236:239], v243 offset:3328
    v_lshlrev_b32 v251, 4, v251
    v_mfma_f32_16x16x32_bf16 v[236:239], a[240:243], a[136:139], v[236:239]
    ds_read_b128 a[240:243], v240 offset:0
    v_add_u32 v251, 0xfffff800, v251
    v_mfma_f32_16x16x32_bf16 v[236:239], a[244:247], a[140:143], v[236:239]
    ds_read_b128 a[244:247], v241 offset:0
    v_sub_f32 v201, v201, v248
    v_mfma_f32_16x16x32_bf16 v[232:235], a[144:147], a[216:219], 0
    v_exp_f32 v200, v200
    v_mfma_f32_16x16x32_bf16 v[232:235], a[148:151], a[220:223], v[232:235]
    v_exp_f32 v201, v201
    v_mfma_f32_16x16x32_bf16 v[228:231], a[192:195], a[216:219], 0
    v_sub_f32 v202, v202, v248
    v_cvt_pk_bf16_f32 v84, v236, v237
    v_mfma_f32_16x16x32_bf16 v[228:231], a[196:199], a[220:223], v[228:231]
    s_waitcnt lgkmcnt(5)
    v_cvt_pk_bf16_f32 v87, v238, v239
    v_sub_f32 v203, v203, v248
    v_mfma_f32_16x16x32_bf16 v[232:235], a[152:155], a[224:227], v[232:235]
    s_waitcnt lgkmcnt(4)
    v_exp_f32 v202, v202
    v_mfma_f32_16x16x32_bf16 v[232:235], a[156:159], a[228:231], v[232:235]
    s_waitcnt lgkmcnt(3)
    s_waitcnt lgkmcnt(2)
    s_barrier
    v_mfma_f32_16x16x32_bf16 v[232:235], a[160:163], a[232:235], v[232:235]
    buffer_load_dwordx4 v252, s[12:15], s62 offen lds
    v_cvt_pk_bf16_f32 v193, v200, v201
    v_mfma_f32_16x16x32_bf16 v[232:235], a[164:167], a[236:239], v[232:235]
    v_exp_f32 v203, v203
    v_mfma_f32_16x16x32_bf16 v[236:239], a[168:171], a[216:219], 0
    ds_read_b128 a[216:219], v240 offset:128
    v_cvt_pk_bf16_f32 v180, v202, v203
    v_mfma_f32_16x16x32_bf16 v[236:239], a[172:175], a[220:223], v[236:239]
    ds_read_b128 a[220:223], v241 offset:128
    ds_read_b128 v[200:203], v245 offset:64
    v_mfma_f32_16x16x32_bf16 v[236:239], a[176:179], a[224:227], v[236:239]
    buffer_load_dwordx4 v253, s[12:15], s62 offen offset:1024 lds
    v_mul_f32 v232, s38, v232
    v_mfma_f32_16x16x32_bf16 v[236:239], a[180:183], a[228:231], v[236:239]
    v_mul_f32 v233, s38, v233
    v_mul_f32 v234, s38, v234
    v_mfma_f32_16x16x32_bf16 v[236:239], a[184:187], a[232:235], v[236:239]
    v_mul_f32 v235, s38, v235
    v_cvt_pk_bf16_f32 v232, v232, v233
    v_mfma_f32_16x16x32_bf16 v[236:239], a[188:191], a[236:239], v[236:239]
    v_cvt_pk_bf16_f32 v233, v234, v235
    v_sub_f32 v204, v204, v248
    v_mfma_f32_16x16x32_bf16 v[228:231], a[200:203], a[224:227], v[228:231]
    buffer_load_dwordx4 v251, s[12:15], s62 offen offset:2048 lds
    s_add_u32 m0, s46, 0x17400
    v_mfma_f32_16x16x32_bf16 v[228:231], a[204:207], a[228:231], v[228:231]
    s_lshl_b32 s62, s28, 5
    s_add_u32 s62, s62, 0x3000
    v_mul_f32 v236, s3, v236
    v_mfma_f32_16x16x32_bf16 v[228:231], a[208:211], a[232:235], v[228:231]
    ds_write_b64 v247, v[232:233] offset:55296
    v_mfma_f32_16x16x32_bf16 v[228:231], a[212:215], a[236:239], v[228:231]
    s_waitcnt lgkmcnt(4)
    v_mul_f32 v237, s3, v237
    v_mul_f32 v238, s3, v238
    v_mfma_f32_16x16x32_bf16 v[232:235], a[0:3], a[240:243], 0
    buffer_load_dwordx4 v252, s[12:15], s63 offen lds
    v_mul_f32 v239, s3, v239
    v_mfma_f32_16x16x32_bf16 v[232:235], a[4:7], a[244:247], v[232:235]
    s_waitcnt lgkmcnt(1)
    v_cvt_pk_bf16_f32 v236, v236, v237
    v_cvt_pk_bf16_f32 v237, v238, v239
    v_mfma_f32_16x16x32_bf16 v[200:203], v[162:165], v[174:177], v[200:203]
    ds_write_b64 v247, v[236:237] offset:55424
    v_mfma_f32_16x16x32_bf16 v[200:203], v[164:167], v[176:179], v[200:203]
    v_mul_f32 v228, s38, v228
    v_mul_f32 v229, s38, v229
    v_mfma_f32_16x16x32_bf16 v[232:235], a[8:11], a[216:219], v[232:235]
    buffer_load_dwordx4 v253, s[12:15], s63 offen offset:1024 lds
    v_mul_f32 v230, s38, v230
    v_mfma_f32_16x16x32_bf16 v[232:235], a[12:15], a[220:223], v[232:235]
    v_mul_f32 v231, s38, v231
    v_cvt_pk_bf16_f32 v228, v228, v229
    v_mfma_f32_16x16x32_bf16 v[236:239], a[24:27], a[240:243], 0
    ds_read_b128 a[224:227], v240 offset:256
    v_cvt_pk_bf16_f32 v229, v230, v231
    v_mfma_f32_16x16x32_bf16 v[236:239], a[28:31], a[244:247], v[236:239]
    ds_write_b64 v247, v[228:229] offset:55552
    v_mfma_f32_16x16x32_bf16 v[236:239], a[32:35], a[216:219], v[236:239]
    buffer_load_dwordx4 v251, s[12:15], s63 offen offset:2048 lds
    s_add_u32 m0, s46, 0x16800
    v_mfma_f32_16x16x32_bf16 v[236:239], a[36:39], a[220:223], v[236:239]
    s_lshl_b32 s63, s28, 5
    s_add_u32 s63, s63, 0x7800
    v_sub_f32 v205, v205, v248
    v_mfma_f32_16x16x32_bf16 v[228:231], a[48:51], a[240:243], 0
    ds_read_b128 a[228:231], v241 offset:256
    ds_read_b128 a[232:235], v240 offset:1536
    v_mfma_f32_16x16x32_bf16 v[228:231], a[52:55], a[244:247], v[228:231]
    ds_read_b128 a[236:239], v241 offset:1536
    v_sub_f32 v206, v206, v248
    v_mfma_f32_16x16x32_bf16 v[228:231], a[56:59], a[216:219], v[228:231]
    v_exp_f32 v204, v204
    v_mfma_f32_16x16x32_bf16 v[228:231], a[60:63], a[220:223], v[228:231]
    v_exp_f32 v205, v205
    v_exp_f32 v206, v206
    s_waitcnt lgkmcnt(4)
    v_mfma_f32_16x16x32_bf16 v[232:235], a[16:19], a[224:227], v[232:235]
    v_sub_f32 v207, v207, v248
    v_cvt_pk_bf16_f32 v194, v204, v205
    v_mfma_f32_16x16x32_bf16 v[236:239], a[40:43], a[224:227], v[236:239]
    v_exp_f32 v207, v207
    v_mfma_f32_16x16x32_bf16 v[228:231], a[64:67], a[224:227], v[228:231]
    v_cvt_pk_bf16_f32 v181, v206, v207
    ds_read_b128 v[204:207], v246 offset:64
    v_sub_f32 v208, v208, v248
    s_waitcnt lgkmcnt(3)
    v_mfma_f32_16x16x32_bf16 v[232:235], a[20:23], a[228:231], v[232:235]
    v_exp_f32 v208, v208
    v_mfma_f32_16x16x32_bf16 v[236:239], a[44:47], a[228:231], v[236:239]
    v_sub_f32 v209, v209, v248
    v_sub_f32 v210, v210, v248
    v_mfma_f32_16x16x32_bf16 v[228:231], a[68:71], a[228:231], v[228:231]
    v_exp_f32 v209, v209
    v_exp_f32 v210, v210
    v_sub_f32 v211, v211, v248
    v_exp_f32 v211, v211
    v_cvt_pk_bf16_f32 v192, v208, v209
    v_cvt_pk_bf16_f32 v195, v210, v211
    ds_read_b128 v[208:211], v244 offset:128
    v_sub_f32 v196, v196, v248
    v_mfma_f32_16x16x32_bf16 v[212:215], v[6:9], v[192:195], 0
    v_exp_f32 v196, v196
    v_mfma_f32_16x16x32_bf16 v[216:219], v[36:39], v[192:195], 0
    v_sub_f32 v197, v197, v248
    v_sub_f32 v198, v198, v248
    v_mfma_f32_16x16x32_bf16 v[220:223], v[66:69], v[192:195], 0
    s_waitcnt lgkmcnt(1)
    v_exp_f32 v197, v197
    v_mfma_f32_16x16x32_bf16 v[224:227], a[248:251], v[192:195], 0
    v_exp_f32 v198, v198
    v_mfma_f32_16x16x32_bf16 v[204:207], v[138:141], v[174:177], v[204:207]
    v_sub_f32 v199, v199, v248
    v_cvt_pk_bf16_f32 v183, v196, v197
    v_mfma_f32_16x16x32_bf16 v[204:207], v[140:143], v[176:179], v[204:207]
    v_exp_f32 v199, v199
    v_sub_f32 v200, v200, v248
    v_cvt_pk_bf16_f32 v186, v198, v199
    ds_read_b128 v[196:199], v245 offset:128
    v_exp_f32 v200, v200
    s_waitcnt lgkmcnt(1)
    v_mfma_f32_16x16x32_bf16 v[208:211], v[132:135], v[174:177], v[208:211]
    v_sub_f32 v201, v201, v248
    v_sub_f32 v202, v202, v248
    v_mfma_f32_16x16x32_bf16 v[208:211], v[134:137], v[176:179], v[208:211]
    v_exp_f32 v201, v201
    v_exp_f32 v202, v202
    v_sub_f32 v203, v203, v248
    v_exp_f32 v203, v203
    v_cvt_pk_bf16_f32 v184, v200, v201
    v_cvt_pk_bf16_f32 v187, v202, v203
    ds_read_b128 v[200:203], v246 offset:128
    v_sub_f32 v204, v204, v248
    v_exp_f32 v204, v204
    v_sub_f32 v205, v205, v248
    v_exp_f32 v205, v205
    v_sub_f32 v206, v206, v248
    v_exp_f32 v206, v206
    v_sub_f32 v207, v207, v248
    s_waitcnt lgkmcnt(1)
    v_mfma_f32_16x16x32_bf16 v[196:199], v[102:105], v[174:177], v[196:199]
    v_exp_f32 v207, v207
    v_mfma_f32_16x16x32_bf16 v[196:199], v[104:107], v[176:179], v[196:199]
    v_cvt_pk_bf16_f32 v182, v204, v205
    v_cvt_pk_bf16_f32 v185, v206, v207
    ds_read_b128 v[204:207], v244 offset:0
    v_mfma_f32_16x16x32_bf16 v[212:215], v[10:13], v[180:183], v[212:215]
    v_sub_f32 v208, v208, v248
    v_sub_f32 v209, v209, v248
    v_mfma_f32_16x16x32_bf16 v[216:219], v[40:43], v[180:183], v[216:219]
    v_exp_f32 v208, v208
    v_mfma_f32_16x16x32_bf16 v[220:223], v[70:73], v[180:183], v[220:223]
    s_waitcnt lgkmcnt(1)
    v_exp_f32 v209, v209
    v_mfma_f32_16x16x32_bf16 v[224:227], a[248:251], v[180:183], v[224:227]
    v_cvt_pk_bf16_f32 v189, v208, v209
    s_waitcnt vmcnt(3)
    v_mfma_f32_16x16x32_bf16 v[212:215], v[14:17], v[184:187], v[212:215]
    ds_read_b64_tr_b16 a[144:145], v249 offset:0
    ds_read_b64_tr_b16 a[146:147], v250 offset:0
    v_mfma_f32_16x16x32_bf16 v[216:219], v[44:47], v[184:187], v[216:219]
    ds_read_b64_tr_b16 a[168:169], v249 offset:32
    ds_read_b64_tr_b16 a[170:171], v250 offset:32
    v_mfma_f32_16x16x32_bf16 v[220:223], v[74:77], v[184:187], v[220:223]
    ds_read_b64_tr_b16 a[192:193], v249 offset:64
    ds_read_b64_tr_b16 a[194:195], v250 offset:64
    v_mfma_f32_16x16x32_bf16 v[224:227], a[248:251], v[184:187], v[224:227]
    ds_read_b128 v[208:211], v245 offset:0
    v_sub_f32 v196, v196, v248
    v_mfma_f32_16x16x32_bf16 v[200:203], v[114:117], v[174:177], v[200:203]
    ds_read_b64 v[174:175], v247 offset:0
    v_sub_f32 v197, v197, v248
    v_mfma_f32_16x16x32_bf16 v[200:203], v[116:119], v[176:179], v[200:203]
    s_waitcnt lgkmcnt(8)
    ds_read_b64 v[176:177], v247 offset:128
    v_mfma_f32_16x16x32_bf16 v[204:207], v[126:129], v[168:171], v[204:207]
    ds_read_b64 v[178:179], v247 offset:256
    v_mfma_f32_16x16x32_bf16 v[204:207], v[128:131], v[170:173], v[204:207]
    v_exp_f32 v196, v196
    v_exp_f32 v197, v197
    s_nop 0
    v_cvt_pk_bf16_f32 v190, v196, v197
    ds_read_b128 v[196:199], v246 offset:0
    v_sub_f32 v200, v200, v248
    v_exp_f32 v200, v200
    v_sub_f32 v201, v201, v248
    v_exp_f32 v201, v201
    s_waitcnt lgkmcnt(5)
    buffer_load_dwordx4 v252, s[12:15], s60 offen lds
    s_waitcnt lgkmcnt(4)
    v_mfma_f32_16x16x32_bf16 v[208:211], v[162:165], v[168:171], v[208:211]
    v_cvt_pk_bf16_f32 v188, v200, v201
    s_waitcnt vmcnt(1)
    v_mfma_f32_16x16x32_bf16 v[208:211], v[164:167], v[170:173], v[208:211]
    ds_read_b64_tr_b16 a[148:149], v249 offset:3072
    ds_read_b64_tr_b16 a[150:151], v250 offset:3072
    v_mfma_f32_16x16x32_bf16 v[212:215], v[18:21], v[188:191], v[212:215]
    ds_read_b64_tr_b16 a[172:173], v249 offset:3104
    ds_read_b64_tr_b16 a[174:175], v250 offset:3104
    v_mfma_f32_16x16x32_bf16 v[216:219], v[48:51], v[188:191], v[216:219]
    buffer_load_dwordx4 v253, s[12:15], s60 offen offset:1024 lds
    ds_read_b64_tr_b16 a[196:197], v249 offset:3136
    v_mfma_f32_16x16x32_bf16 v[220:223], v[78:81], v[188:191], v[220:223]
    ds_read_b64_tr_b16 a[198:199], v250 offset:3136
    ds_read_b128 v[200:203], v244 offset:64
    v_mfma_f32_16x16x32_bf16 v[224:227], a[248:251], v[188:191], v[224:227]
    s_waitcnt lgkmcnt(7)
    v_max_f32 v248, v204, v205
    v_max3_f32 v248, v248, v206, v207
    v_mfma_f32_16x16x32_bf16 v[196:199], v[138:141], v[168:171], v[196:199]
    ds_read_b128 v[204:207], v245 offset:64
    v_max3_f32 v248, v248, v208, v209
    v_mfma_f32_16x16x32_bf16 v[196:199], v[140:143], v[170:173], v[196:199]
    buffer_load_dwordx4 v251, s[12:15], s60 offen offset:2048 lds
    s_add_u32 m0, s46, 0x17400
    v_rcp_f32 v225, v224
    v_max3_f32 v248, v248, v210, v211
    ds_read_b128 v[208:211], v246 offset:64
    v_mul_f32 v212, v212, v225
    v_mul_f32 v213, v213, v225
    v_mul_f32 v214, v214, v225
    v_mul_f32 v215, v215, v225
    v_cvt_pk_bf16_f32 v212, v212, v213
    v_cvt_pk_bf16_f32 v213, v214, v215
    ds_write_b64 v247, v[212:213] offset:12288
    v_mul_f32 v216, v216, v225
    s_waitcnt lgkmcnt(4)
    buffer_load_dwordx4 v252, s[12:15], s61 offen lds
    v_mul_f32 v217, v217, v225
    s_waitcnt lgkmcnt(3)
    v_mfma_f32_16x16x32_bf16 v[200:203], v[132:135], v[168:171], v[200:203]
    v_mul_f32 v218, v218, v225
    v_mul_f32 v219, v219, v225
    v_mfma_f32_16x16x32_bf16 v[200:203], v[134:137], v[170:173], v[200:203]
    s_waitcnt lgkmcnt(2)
    v_cvt_pk_bf16_f32 v216, v216, v217
    v_cvt_pk_bf16_f32 v217, v218, v219
    v_mfma_f32_16x16x32_bf16 v[204:207], v[102:105], v[168:171], v[204:207]
    ds_write_b64 v247, v[216:217] offset:12416
    v_mfma_f32_16x16x32_bf16 v[204:207], v[104:107], v[170:173], v[204:207]
    s_waitcnt lgkmcnt(2)
    buffer_load_dwordx4 v253, s[12:15], s61 offen offset:1024 lds
    v_mfma_f32_16x16x32_bf16 v[208:211], v[114:117], v[168:171], v[208:211]
    v_mul_f32 v220, v220, v225
    v_mul_f32 v221, v221, v225
    v_mfma_f32_16x16x32_bf16 v[208:211], v[116:119], v[170:173], v[208:211]
    v_mul_f32 v222, v222, v225
    v_mul_f32 v223, v223, v225
    v_cvt_pk_bf16_f32 v220, v220, v221
    v_cvt_pk_bf16_f32 v221, v222, v223
    ds_write_b64 v247, v[220:221] offset:12544
    buffer_load_dwordx4 v251, s[12:15], s61 offen offset:2048 lds
    s_add_u32 m0, s46, 0x16800
    v_max3_f32 v248, v248, v196, v197
    v_max3_f32 v248, v248, v198, v199
    ds_read_b128 v[196:199], v244 offset:128
    v_max3_f32 v248, v248, v200, v201
    v_max3_f32 v248, v248, v202, v203
    ds_read_b128 v[200:203], v245 offset:128
    v_max3_f32 v248, v248, v204, v205
    v_max3_f32 v248, v248, v206, v207
    ds_read_b128 v[204:207], v246 offset:128
    v_max3_f32 v248, v248, v208, v209
    v_max3_f32 v248, v248, v210, v211
    ds_read_b128 v[208:211], v244 offset:0
    s_waitcnt lgkmcnt(3)
    v_mfma_f32_16x16x32_bf16 v[196:199], v[144:147], v[168:171], v[196:199]
    v_mfma_f32_16x16x32_bf16 v[196:199], v[146:149], v[170:173], v[196:199]
    s_waitcnt lgkmcnt(2)
    v_mfma_f32_16x16x32_bf16 v[200:203], v[108:111], v[168:171], v[200:203]
    s_waitcnt lgkmcnt(1)
    v_mfma_f32_16x16x32_bf16 v[200:203], v[110:113], v[170:173], v[200:203]
    v_mfma_f32_16x16x32_bf16 v[204:207], v[120:123], v[168:171], v[204:207]
    s_waitcnt lgkmcnt(0)
    v_mfma_f32_16x16x32_bf16 v[204:207], v[122:125], v[170:173], v[204:207]
    v_mfma_f32_16x16x32_bf16 v[208:211], v[126:129], v[168:171], v[208:211]
    v_cvt_pk_bf16_f32 v126, v232, v233
    v_cvt_pk_bf16_f32 v127, v234, v235
    v_mfma_f32_16x16x32_bf16 v[208:211], v[128:131], v[170:173], v[208:211]
    v_cvt_pk_bf16_f32 v128, v236, v237
    v_cvt_pk_bf16_f32 v129, v238, v239
    v_mfma_f32_16x16x32_bf16 v[232:235], a[240:243], a[72:75], 0
    v_cvt_pk_bf16_f32 v130, v228, v229
    v_cvt_pk_bf16_f32 v131, v230, v231
    v_mfma_f32_16x16x32_bf16 v[232:235], a[244:247], a[76:79], v[232:235]
    v_max3_f32 v248, v248, v196, v197
    v_max3_f32 v248, v248, v200, v201
    v_mfma_f32_16x16x32_bf16 v[232:235], a[216:219], a[80:83], v[232:235]
    ds_read_b128 v[196:199], v245 offset:0
    ds_read_b128 v[200:203], v246 offset:0
    v_mfma_f32_16x16x32_bf16 v[232:235], a[220:223], a[84:87], v[232:235]
    v_max3_f32 v248, v248, v204, v205
    v_mov_b32 v225, v248
    v_mfma_f32_16x16x32_bf16 v[232:235], a[224:227], a[88:91], v[232:235]
    ds_read_b128 v[204:207], v244 offset:64
    v_permlane16_swap_b32 v248, v225
    v_mfma_f32_16x16x32_bf16 v[232:235], a[228:231], a[92:95], v[232:235]
    v_max_f32 v248, v248, v225
    v_mov_b32 v225, v248
    v_mfma_f32_16x16x32_bf16 v[236:239], a[240:243], a[96:99], 0
    v_mfma_f32_16x16x32_bf16 v[236:239], a[244:247], a[100:103], v[236:239]
    v_permlane32_swap_b32 v248, v225
    v_max_f32 v248, v248, v225
    v_mfma_f32_16x16x32_bf16 v[236:239], a[216:219], a[104:107], v[236:239]
    v_sub_f32 v208, v208, v248
    v_cvt_pk_bf16_f32 v1, v232, v233
    v_mfma_f32_16x16x32_bf16 v[236:239], a[220:223], a[108:111], v[236:239]
    v_cvt_pk_bf16_f32 v4, v234, v235
    v_sub_f32 v209, v209, v248
    v_mfma_f32_16x16x32_bf16 v[236:239], a[224:227], a[112:115], v[236:239]
    v_exp_f32 v208, v208
    v_mfma_f32_16x16x32_bf16 v[236:239], a[228:231], a[116:119], v[236:239]
    s_waitcnt lgkmcnt(2)
    v_exp_f32 v209, v209
    v_mfma_f32_16x16x32_bf16 v[196:199], v[162:165], v[168:171], v[196:199]
    s_waitcnt lgkmcnt(1)
    v_sub_f32 v210, v210, v248
    v_sub_f32 v211, v211, v248
    v_mfma_f32_16x16x32_bf16 v[196:199], v[164:167], v[170:173], v[196:199]
    s_waitcnt lgkmcnt(0)
    v_cvt_pk_bf16_f32 v31, v236, v237
    v_cvt_pk_bf16_f32 v34, v238, v239
    v_mfma_f32_16x16x32_bf16 v[200:203], v[138:141], v[168:171], v[200:203]
    v_exp_f32 v210, v210
    v_mfma_f32_16x16x32_bf16 v[200:203], v[140:143], v[170:173], v[200:203]
    v_exp_f32 v211, v211
    v_mfma_f32_16x16x32_bf16 v[204:207], v[132:135], v[168:171], v[204:207]
    v_cvt_pk_bf16_f32 v193, v208, v209
    v_cvt_pk_bf16_f32 v180, v210, v211
    v_mfma_f32_16x16x32_bf16 v[204:207], v[134:137], v[170:173], v[204:207]
    ds_read_b128 v[208:211], v245 offset:64
    v_sub_f32 v196, v196, v248
    v_mfma_f32_16x16x32_bf16 v[228:231], a[240:243], a[120:123], 0
    s_waitcnt vmcnt(3)
    ds_read_b64_tr_b16 a[152:153], v249 offset:0
    v_mfma_f32_16x16x32_bf16 v[228:231], a[244:247], a[124:127], v[228:231]
    ds_read_b64_tr_b16 a[154:155], v250 offset:0
    ds_read_b64_tr_b16 a[176:177], v249 offset:32
    v_mfma_f32_16x16x32_bf16 v[228:231], a[216:219], a[128:131], v[228:231]
    ds_read_b64_tr_b16 a[178:179], v250 offset:32
    ds_read_b64_tr_b16 a[200:201], v249 offset:64
    v_mfma_f32_16x16x32_bf16 v[228:231], a[220:223], a[132:135], v[228:231]
    ds_read_b64_tr_b16 a[202:203], v250 offset:64
    ds_read_b128 a[240:243], v240 offset:1664
    v_mfma_f32_16x16x32_bf16 v[228:231], a[224:227], a[136:139], v[228:231]
    ds_read_b128 a[244:247], v241 offset:1664
    ds_read_b128 a[216:219], v240 offset:1792
    v_mfma_f32_16x16x32_bf16 v[228:231], a[228:231], a[140:143], v[228:231]
    ds_read_b128 a[220:223], v241 offset:1792
    ds_read_b128 a[224:227], v240 offset:3072
    v_mfma_f32_16x16x32_bf16 v[232:235], a[0:3], a[232:235], 0
    ds_read_b128 a[228:231], v241 offset:3072
    v_sub_f32 v197, v197, v248
    v_mfma_f32_16x16x32_bf16 v[232:235], a[4:7], a[236:239], v[232:235]
    s_waitcnt lgkmcnt(12)
    v_exp_f32 v196, v196
    v_mfma_f32_16x16x32_bf16 v[208:211], v[102:105], v[168:171], v[208:211]
    v_cvt_pk_bf16_f32 v61, v228, v229
    v_cvt_pk_bf16_f32 v64, v230, v231
    v_mfma_f32_16x16x32_bf16 v[208:211], v[104:107], v[170:173], v[208:211]
    v_exp_f32 v197, v197
    v_mfma_f32_16x16x32_bf16 v[236:239], a[24:27], a[232:235], 0
    v_sub_f32 v198, v198, v248
    v_sub_f32 v199, v199, v248
    v_mfma_f32_16x16x32_bf16 v[236:239], a[28:31], a[236:239], v[236:239]
    s_waitcnt lgkmcnt(6)
    buffer_load_dwordx4 v252, s[12:15], s62 offen lds
    v_mfma_f32_16x16x32_bf16 v[228:231], a[48:51], a[232:235], 0
    s_waitcnt lgkmcnt(5)
    v_exp_f32 v198, v198
    v_mfma_f32_16x16x32_bf16 v[232:235], a[8:11], a[240:243], v[232:235]
    s_waitcnt lgkmcnt(4)
    v_exp_f32 v199, v199
    v_mfma_f32_16x16x32_bf16 v[232:235], a[12:15], a[244:247], v[232:235]
    s_waitcnt vmcnt(1) lgkmcnt(3)
    ds_read_b64_tr_b16 a[156:157], v249 offset:3072
    v_mfma_f32_16x16x32_bf16 v[232:235], a[16:19], a[216:219], v[232:235]
    buffer_load_dwordx4 v253, s[12:15], s62 offen offset:1024 lds
    ds_read_b64_tr_b16 a[158:159], v250 offset:3072
    v_mfma_f32_16x16x32_bf16 v[236:239], a[32:35], a[240:243], v[236:239]
    ds_read_b64_tr_b16 a[180:181], v249 offset:3104
    ds_read_b64_tr_b16 a[182:183], v250 offset:3104
    v_mfma_f32_16x16x32_bf16 v[236:239], a[36:39], a[244:247], v[236:239]
    ds_read_b64_tr_b16 a[204:205], v249 offset:3136
    ds_read_b64_tr_b16 a[206:207], v250 offset:3136
    v_mfma_f32_16x16x32_bf16 v[236:239], a[40:43], a[216:219], v[236:239]
    s_waitcnt lgkmcnt(8)
    v_cvt_pk_bf16_f32 v194, v196, v197
    v_cvt_pk_bf16_f32 v181, v198, v199
    v_mfma_f32_16x16x32_bf16 v[232:235], a[20:23], a[220:223], v[232:235]
    buffer_load_dwordx4 v251, s[12:15], s62 offen offset:2048 lds
    s_add_u32 m0, s46, 0x17400
    v_mfma_f32_16x16x32_bf16 v[236:239], a[44:47], a[220:223], v[236:239]
    ds_read_b128 v[196:199], v246 offset:64
    v_sub_f32 v200, v200, v248
    v_mfma_f32_16x16x32_bf16 v[228:231], a[52:55], a[236:239], v[228:231]
    v_exp_f32 v200, v200
    v_mfma_f32_16x16x32_bf16 v[228:231], a[56:59], a[240:243], v[228:231]
    v_sub_f32 v201, v201, v248
    v_sub_f32 v202, v202, v248
    v_mfma_f32_16x16x32_bf16 v[228:231], a[60:63], a[244:247], v[228:231]
    v_exp_f32 v201, v201
    v_mfma_f32_16x16x32_bf16 v[228:231], a[64:67], a[216:219], v[228:231]
    v_exp_f32 v202, v202
    v_mfma_f32_16x16x32_bf16 v[228:231], a[68:71], a[220:223], v[228:231]
    v_sub_f32 v203, v203, v248
    v_exp_f32 v203, v203
    s_waitcnt lgkmcnt(1)
    buffer_load_dwordx4 v252, s[12:15], s63 offen lds
    v_cvt_pk_bf16_f32 v192, v200, v201
    v_cvt_pk_bf16_f32 v195, v202, v203
    ds_read_b128 v[200:203], v244 offset:128
    v_sub_f32 v204, v204, v248
    v_mfma_f32_16x16x32_bf16 v[212:215], v[12:15], v[192:195], 0
    s_waitcnt lgkmcnt(1)
    v_exp_f32 v204, v204
    v_mfma_f32_16x16x32_bf16 v[216:219], v[42:45], v[192:195], 0
    v_sub_f32 v205, v205, v248
    v_sub_f32 v206, v206, v248
    v_mfma_f32_16x16x32_bf16 v[220:223], v[72:75], v[192:195], 0
    buffer_load_dwordx4 v253, s[12:15], s63 offen offset:1024 lds
    v_sub_f32 v207, v207, v248
    v_mfma_f32_16x16x32_bf16 v[224:227], a[248:251], v[192:195], 0
    v_exp_f32 v205, v205
    v_mfma_f32_16x16x32_bf16 v[196:199], v[114:117], v[168:171], v[196:199]
    v_exp_f32 v206, v206
    v_mfma_f32_16x16x32_bf16 v[196:199], v[116:119], v[170:173], v[196:199]
    v_exp_f32 v207, v207
    buffer_load_dwordx4 v251, s[12:15], s63 offen offset:2048 lds
    v_cvt_pk_bf16_f32 v183, v204, v205
    v_cvt_pk_bf16_f32 v186, v206, v207
    ds_read_b128 v[204:207], v245 offset:128
    s_waitcnt lgkmcnt(1)
    v_mfma_f32_16x16x32_bf16 v[200:203], v[144:147], v[168:171], v[200:203]
    v_sub_f32 v208, v208, v248
    v_sub_f32 v209, v209, v248
    v_mfma_f32_16x16x32_bf16 v[200:203], v[146:149], v[170:173], v[200:203]
    v_exp_f32 v208, v208
    v_exp_f32 v209, v209
    v_sub_f32 v210, v210, v248
    v_exp_f32 v210, v210
    v_sub_f32 v211, v211, v248
    v_exp_f32 v211, v211
    v_cvt_pk_bf16_f32 v184, v208, v209
    v_cvt_pk_bf16_f32 v187, v210, v211
    ds_read_b128 v[208:211], v246 offset:128
    v_sub_f32 v196, v196, v248
    v_exp_f32 v196, v196
    v_sub_f32 v197, v197, v248
    v_exp_f32 v197, v197
    v_sub_f32 v198, v198, v248
    v_exp_f32 v198, v198
    s_waitcnt lgkmcnt(1)
    v_mfma_f32_16x16x32_bf16 v[204:207], v[108:111], v[168:171], v[204:207]
    v_sub_f32 v199, v199, v248
    v_cvt_pk_bf16_f32 v182, v196, v197
    v_mfma_f32_16x16x32_bf16 v[204:207], v[110:113], v[170:173], v[204:207]
    v_exp_f32 v199, v199
    v_mfma_f32_16x16x32_bf16 v[212:215], v[16:19], v[180:183], v[212:215]
    v_cvt_pk_bf16_f32 v185, v198, v199
    v_sub_f32 v200, v200, v248
    v_mfma_f32_16x16x32_bf16 v[216:219], v[46:49], v[180:183], v[216:219]
    ds_read_b128 v[196:199], v244 offset:32
    v_sub_f32 v201, v201, v248
    v_mfma_f32_16x16x32_bf16 v[220:223], v[76:79], v[180:183], v[220:223]
    v_exp_f32 v200, v200
    v_mfma_f32_16x16x32_bf16 v[224:227], a[248:251], v[180:183], v[224:227]
    s_waitcnt lgkmcnt(1)
    v_exp_f32 v201, v201
    v_mfma_f32_16x16x32_bf16 v[212:215], v[20:23], v[184:187], v[212:215]
    v_cvt_pk_bf16_f32 v189, v200, v201
    v_sub_f32 v204, v204, v248
    v_mfma_f32_16x16x32_bf16 v[216:219], v[50:53], v[184:187], v[216:219]
    ds_read_b128 v[200:203], v245 offset:32
    v_sub_f32 v205, v205, v248
    v_mfma_f32_16x16x32_bf16 v[220:223], v[80:83], v[184:187], v[220:223]
    v_exp_f32 v204, v204
    v_mfma_f32_16x16x32_bf16 v[224:227], a[248:251], v[184:187], v[224:227]
    v_exp_f32 v205, v205
    v_mfma_f32_16x16x32_bf16 v[208:211], v[120:123], v[168:171], v[208:211]
    ds_read_b64 v[168:169], v247 offset:24576
    v_cvt_pk_bf16_f32 v190, v204, v205
    v_mfma_f32_16x16x32_bf16 v[208:211], v[122:125], v[170:173], v[208:211]
    ds_read_b128 v[204:207], v246 offset:32
    s_waitcnt lgkmcnt(3)
    v_mfma_f32_16x16x32_bf16 v[196:199], v[132:135], v[174:177], v[196:199]
    ds_read_b64 v[170:171], v247 offset:24704
    ds_read_b64 v[172:173], v247 offset:24832
    v_mfma_f32_16x16x32_bf16 v[196:199], v[134:137], v[176:179], v[196:199]
    s_nop 1
    v_sub_f32 v208, v208, v248
    v_exp_f32 v208, v208
    v_sub_f32 v209, v209, v248
    v_exp_f32 v209, v209
    s_nop 0
    s_waitcnt lgkmcnt(4)
    v_mfma_f32_16x16x32_bf16 v[200:203], v[102:105], v[174:177], v[200:203]
    v_cvt_pk_bf16_f32 v188, v208, v209
    v_max_f32 v248, v196, v197
    v_mfma_f32_16x16x32_bf16 v[200:203], v[104:107], v[176:179], v[200:203]
    ds_read_b128 v[208:211], v244 offset:96
    v_max3_f32 v248, v248, v198, v199
    v_mfma_f32_16x16x32_bf16 v[212:215], v[24:27], v[188:191], v[212:215]
    ds_read_b128 v[196:199], v245 offset:96
    v_mfma_f32_16x16x32_bf16 v[216:219], v[54:57], v[188:191], v[216:219]
    v_mfma_f32_16x16x32_bf16 v[220:223], v[84:87], v[188:191], v[220:223]
    s_waitcnt lgkmcnt(4)
    v_mfma_f32_16x16x32_bf16 v[224:227], a[248:251], v[188:191], v[224:227]
    v_max3_f32 v248, v248, v200, v201
    v_max3_f32 v248, v248, v202, v203
    v_mfma_f32_16x16x32_bf16 v[204:207], v[114:117], v[174:177], v[204:207]
    ds_read_b128 v[200:203], v246 offset:96
    v_mfma_f32_16x16x32_bf16 v[204:207], v[116:119], v[176:179], v[204:207]
    s_nop 2
    v_rcp_f32 v225, v224
    s_nop 0
    v_mul_f32 v212, v212, v225
    v_mul_f32 v213, v213, v225
    v_mul_f32 v214, v214, v225
    s_waitcnt lgkmcnt(2)
    v_mfma_f32_16x16x32_bf16 v[208:211], v[144:147], v[174:177], v[208:211]
    s_waitcnt vmcnt(3)
    ds_read_b64_tr_b16 a[160:161], v249 offset:0
    v_mfma_f32_16x16x32_bf16 v[208:211], v[146:149], v[176:179], v[208:211]
    s_waitcnt lgkmcnt(2)
    ds_read_b64_tr_b16 a[162:163], v250 offset:0
    v_mfma_f32_16x16x32_bf16 v[196:199], v[108:111], v[174:177], v[196:199]
    ds_read_b64_tr_b16 a[184:185], v249 offset:32
    ds_read_b64_tr_b16 a[186:187], v250 offset:32
    v_mfma_f32_16x16x32_bf16 v[196:199], v[110:113], v[176:179], v[196:199]
    ds_read_b64_tr_b16 a[208:209], v249 offset:64
    ds_read_b64_tr_b16 a[210:211], v250 offset:64
    v_mul_f32 v215, v215, v225
    v_cvt_pk_bf16_f32 v212, v212, v213
    s_waitcnt lgkmcnt(6)
    v_mfma_f32_16x16x32_bf16 v[200:203], v[120:123], v[174:177], v[200:203]
    v_cvt_pk_bf16_f32 v213, v214, v215
    v_mul_f32 v216, v216, v225
    v_mfma_f32_16x16x32_bf16 v[200:203], v[122:125], v[176:179], v[200:203]
    ds_write_b64 v247, v[212:213] offset:18432
    v_mul_f32 v217, v217, v225
    v_mul_f32 v218, v218, v225
    v_mul_f32 v219, v219, v225
    v_cvt_pk_bf16_f32 v216, v216, v217
    v_cvt_pk_bf16_f32 v217, v218, v219
    ds_write_b64 v247, v[216:217] offset:18560
    v_mul_f32 v220, v220, v225
    v_mul_f32 v221, v221, v225
    v_mul_f32 v222, v222, v225
    v_mul_f32 v223, v223, v225
    v_cvt_pk_bf16_f32 v220, v220, v221
    v_cvt_pk_bf16_f32 v221, v222, v223
    ds_write_b64 v247, v[220:221] offset:18688
    v_max3_f32 v248, v248, v204, v205
    v_max3_f32 v248, v248, v206, v207
    ds_read_b128 v[204:207], v244 offset:32
    v_max3_f32 v248, v248, v208, v209
    v_max3_f32 v248, v248, v210, v211
    ds_read_b128 v[208:211], v245 offset:32
    v_max3_f32 v248, v248, v196, v197
    v_max3_f32 v248, v248, v198, v199
    s_waitcnt vmcnt(0)
    ds_read_b64_tr_b16 a[164:165], v249 offset:3072
    ds_read_b64_tr_b16 a[166:167], v250 offset:3072
    ds_read_b64_tr_b16 a[188:189], v249 offset:3104
    ds_read_b64_tr_b16 a[190:191], v250 offset:3104
    ds_read_b64_tr_b16 a[212:213], v249 offset:3136
    ds_read_b64_tr_b16 a[214:215], v250 offset:3136
    ds_read_b128 v[196:199], v246 offset:32
    v_max3_f32 v248, v248, v200, v201
    v_max3_f32 v248, v248, v202, v203
    ds_read_b128 v[200:203], v244 offset:96
    v_mov_b32 v225, v248
    s_nop 1
    v_permlane16_swap_b32 v248, v225
    v_max_f32 v248, v248, v225
    v_mov_b32 v225, v248
    s_nop 1
    s_waitcnt lgkmcnt(9)
    v_mfma_f32_16x16x32_bf16 v[204:207], v[132:135], v[174:177], v[204:207]
    v_cvt_pk_bf16_f32 v132, v232, v233
    v_cvt_pk_bf16_f32 v133, v234, v235
    v_mfma_f32_16x16x32_bf16 v[204:207], v[134:137], v[176:179], v[204:207]
    s_waitcnt lgkmcnt(8)
    v_cvt_pk_bf16_f32 v134, v236, v237
    v_cvt_pk_bf16_f32 v135, v238, v239
    v_mfma_f32_16x16x32_bf16 v[208:211], v[102:105], v[174:177], v[208:211]
    v_cvt_pk_bf16_f32 v136, v228, v229
    v_cvt_pk_bf16_f32 v137, v230, v231
    v_mfma_f32_16x16x32_bf16 v[208:211], v[104:107], v[176:179], v[208:211]
    v_permlane32_swap_b32 v248, v225
    v_max_f32 v248, v248, v225
    v_mfma_f32_16x16x32_bf16 v[232:235], a[232:235], a[72:75], 0
    v_sub_f32 v204, v204, v248
    s_waitcnt lgkmcnt(2)
    v_mfma_f32_16x16x32_bf16 v[232:235], a[236:239], a[76:79], v[232:235]
    s_barrier
    v_exp_f32 v204, v204
    v_mfma_f32_16x16x32_bf16 v[232:235], a[240:243], a[80:83], v[232:235]
    s_waitcnt lgkmcnt(1)
    v_sub_f32 v205, v205, v248
    v_sub_f32 v206, v206, v248
    v_mfma_f32_16x16x32_bf16 v[196:199], v[114:117], v[174:177], v[196:199]
    s_waitcnt lgkmcnt(0)
    v_exp_f32 v205, v205
    v_mfma_f32_16x16x32_bf16 v[196:199], v[116:119], v[176:179], v[196:199]
    v_exp_f32 v206, v206
    v_mfma_f32_16x16x32_bf16 v[200:203], v[144:147], v[174:177], v[200:203]
    v_sub_f32 v207, v207, v248
    v_cvt_pk_bf16_f32 v193, v204, v205
    v_mfma_f32_16x16x32_bf16 v[200:203], v[146:149], v[176:179], v[200:203]
    v_exp_f32 v207, v207
    v_mfma_f32_16x16x32_bf16 v[232:235], a[244:247], a[84:87], v[232:235]
    v_cvt_pk_bf16_f32 v180, v206, v207
    v_sub_f32 v208, v208, v248
    v_mfma_f32_16x16x32_bf16 v[232:235], a[216:219], a[88:91], v[232:235]
    ds_read_b128 v[204:207], v245 offset:96
    v_sub_f32 v209, v209, v248
    v_mfma_f32_16x16x32_bf16 v[232:235], a[220:223], a[92:95], v[232:235]
    v_exp_f32 v208, v208
    v_mfma_f32_16x16x32_bf16 v[236:239], a[232:235], a[96:99], 0
    v_exp_f32 v209, v209
    v_mfma_f32_16x16x32_bf16 v[236:239], a[236:239], a[100:103], v[236:239]
    v_sub_f32 v210, v210, v248
    v_sub_f32 v211, v211, v248
    v_mfma_f32_16x16x32_bf16 v[236:239], a[240:243], a[104:107], v[236:239]
    v_exp_f32 v210, v210
    v_mfma_f32_16x16x32_bf16 v[236:239], a[244:247], a[108:111], v[236:239]
    v_cvt_pk_bf16_f32 v7, v232, v233
    v_cvt_pk_bf16_f32 v10, v234, v235
    v_mfma_f32_16x16x32_bf16 v[236:239], a[216:219], a[112:115], v[236:239]
    v_exp_f32 v211, v211
    v_mfma_f32_16x16x32_bf16 v[236:239], a[220:223], a[116:119], v[236:239]
    v_cvt_pk_bf16_f32 v194, v208, v209
    v_cvt_pk_bf16_f32 v181, v210, v211
    v_mfma_f32_16x16x32_bf16 v[228:231], a[232:235], a[120:123], 0
    ds_read_b128 a[232:235], v240 offset:3200
    ds_read_b128 v[208:211], v246 offset:96
    v_mfma_f32_16x16x32_bf16 v[228:231], a[236:239], a[124:127], v[228:231]
    ds_read_b128 a[236:239], v241 offset:3200
    v_sub_f32 v196, v196, v248
    v_mfma_f32_16x16x32_bf16 v[228:231], a[240:243], a[128:131], v[228:231]
    s_waitcnt lgkmcnt(3)
    v_cvt_pk_bf16_f32 v37, v236, v237
    v_cvt_pk_bf16_f32 v40, v238, v239
    v_mfma_f32_16x16x32_bf16 v[204:207], v[108:111], v[174:177], v[204:207]
    ds_read_b128 a[240:243], v240 offset:3328
    v_sub_f32 v197, v197, v248
    v_mfma_f32_16x16x32_bf16 v[204:207], v[110:113], v[176:179], v[204:207]
    v_exp_f32 v196, v196
    v_mfma_f32_16x16x32_bf16 v[228:231], a[244:247], a[132:135], v[228:231]
    ds_read_b128 a[244:247], v241 offset:3328
    v_sub_f32 v198, v198, v248
    v_mfma_f32_16x16x32_bf16 v[228:231], a[216:219], a[136:139], v[228:231]
    ds_read_b128 a[216:219], v240 offset:4608
    v_sub_f32 v199, v199, v248
    v_mfma_f32_16x16x32_bf16 v[228:231], a[220:223], a[140:143], v[228:231]
    ds_read_b128 a[220:223], v241 offset:4608
    v_sub_f32 v200, v200, v248
    v_mfma_f32_16x16x32_bf16 v[232:235], a[0:3], a[224:227], 0
    v_exp_f32 v197, v197
    v_mfma_f32_16x16x32_bf16 v[232:235], a[4:7], a[228:231], v[232:235]
    s_waitcnt lgkmcnt(6)
    v_exp_f32 v198, v198
    v_mfma_f32_16x16x32_bf16 v[232:235], a[8:11], a[232:235], v[232:235]
    s_waitcnt lgkmcnt(5)
    v_cvt_pk_bf16_f32 v67, v228, v229
    v_cvt_pk_bf16_f32 v70, v230, v231
    v_mfma_f32_16x16x32_bf16 v[208:211], v[120:123], v[174:177], v[208:211]
    ds_read_b64 v[174:175], v247 offset:30720
    v_cvt_pk_bf16_f32 v192, v196, v197
    v_mfma_f32_16x16x32_bf16 v[208:211], v[122:125], v[176:179], v[208:211]
    ds_read_b64 v[176:177], v247 offset:30848
    ds_read_b64 v[178:179], v247 offset:30976
    v_mfma_f32_16x16x32_bf16 v[236:239], a[24:27], a[224:227], 0
    s_waitcnt lgkmcnt(7)
    v_exp_f32 v199, v199
    v_mfma_f32_16x16x32_bf16 v[232:235], a[12:15], a[236:239], v[232:235]
    s_waitcnt lgkmcnt(6)
    v_cvt_pk_bf16_f32 v195, v198, v199
    v_sub_f32 v201, v201, v248
    v_mfma_f32_16x16x32_bf16 v[232:235], a[16:19], a[240:243], v[232:235]
    ds_read_b128 v[196:199], v244 offset:192
    v_sub_f32 v202, v202, v248
    v_mfma_f32_16x16x32_bf16 v[212:215], v[18:21], v[192:195], 0
    s_waitcnt lgkmcnt(6)
    v_exp_f32 v200, v200
    v_mfma_f32_16x16x32_bf16 v[216:219], v[48:51], v[192:195], 0
    v_exp_f32 v201, v201
    v_mfma_f32_16x16x32_bf16 v[220:223], v[78:81], v[192:195], 0
    v_exp_f32 v202, v202
    v_mfma_f32_16x16x32_bf16 v[224:227], a[248:251], v[192:195], 0
    v_sub_f32 v203, v203, v248
    v_cvt_pk_bf16_f32 v183, v200, v201
    v_mfma_f32_16x16x32_bf16 v[232:235], a[20:23], a[244:247], v[232:235]
    v_exp_f32 v203, v203
    v_mfma_f32_16x16x32_bf16 v[236:239], a[28:31], a[228:231], v[236:239]
    v_cvt_pk_bf16_f32 v186, v202, v203
    v_sub_f32 v204, v204, v248
    v_mfma_f32_16x16x32_bf16 v[236:239], a[32:35], a[232:235], v[236:239]
    ds_read_b128 v[200:203], v245 offset:192
    v_sub_f32 v205, v205, v248
    v_mfma_f32_16x16x32_bf16 v[236:239], a[36:39], a[236:239], v[236:239]
    v_cvt_pk_bf16_f32 v144, v232, v233
    v_cvt_pk_bf16_f32 v145, v234, v235
    v_mfma_f32_16x16x32_bf16 v[236:239], a[40:43], a[240:243], v[236:239]
    s_waitcnt lgkmcnt(1)
    v_exp_f32 v204, v204
    v_mfma_f32_16x16x32_bf16 v[196:199], v[150:153], v[168:171], v[196:199]
    v_exp_f32 v205, v205
    v_mfma_f32_16x16x32_bf16 v[196:199], v[152:155], v[170:173], v[196:199]
    v_sub_f32 v206, v206, v248
    v_sub_f32 v207, v207, v248
    v_mfma_f32_16x16x32_bf16 v[236:239], a[44:47], a[244:247], v[236:239]
    v_exp_f32 v206, v206
    v_mfma_f32_16x16x32_bf16 v[228:231], a[48:51], a[224:227], 0
    v_exp_f32 v207, v207
    v_mfma_f32_16x16x32_bf16 v[228:231], a[52:55], a[228:231], v[228:231]
    v_cvt_pk_bf16_f32 v184, v204, v205
    v_cvt_pk_bf16_f32 v187, v206, v207
    v_mfma_f32_16x16x32_bf16 v[228:231], a[56:59], a[232:235], v[228:231]
    ds_read_b128 v[204:207], v246 offset:192
    v_cvt_pk_bf16_f32 v146, v236, v237
    v_mfma_f32_16x16x32_bf16 v[228:231], a[60:63], a[236:239], v[228:231]
    s_waitcnt lgkmcnt(1)
    v_cvt_pk_bf16_f32 v147, v238, v239
    v_sub_f32 v208, v208, v248
    v_mfma_f32_16x16x32_bf16 v[200:203], v[90:93], v[168:171], v[200:203]
    v_exp_f32 v208, v208
    v_mfma_f32_16x16x32_bf16 v[200:203], v[92:95], v[170:173], v[200:203]
    v_sub_f32 v209, v209, v248
    v_sub_f32 v210, v210, v248
    v_mfma_f32_16x16x32_bf16 v[228:231], a[64:67], a[240:243], v[228:231]
    v_exp_f32 v209, v209
    v_mfma_f32_16x16x32_bf16 v[228:231], a[68:71], a[244:247], v[228:231]
    v_exp_f32 v210, v210
    v_mfma_f32_16x16x32_bf16 v[232:235], a[224:227], a[72:75], 0
    v_sub_f32 v211, v211, v248
    v_cvt_pk_bf16_f32 v182, v208, v209
    v_mfma_f32_16x16x32_bf16 v[232:235], a[228:231], a[76:79], v[232:235]
    v_exp_f32 v211, v211
    v_mfma_f32_16x16x32_bf16 v[212:215], v[22:25], v[180:183], v[212:215]
    v_cvt_pk_bf16_f32 v185, v210, v211
    v_cvt_pk_bf16_f32 v148, v228, v229
    v_mfma_f32_16x16x32_bf16 v[216:219], v[52:55], v[180:183], v[216:219]
    ds_read_b128 v[208:211], v244 offset:256
    v_cvt_pk_bf16_f32 v149, v230, v231
    v_mfma_f32_16x16x32_bf16 v[220:223], v[82:85], v[180:183], v[220:223]
    s_waitcnt lgkmcnt(1)
    v_max_f32 v248, v196, v197
    v_max3_f32 v248, v248, v198, v199
    v_mfma_f32_16x16x32_bf16 v[224:227], a[248:251], v[180:183], v[224:227]
    ds_read_b128 v[196:199], v245 offset:256
    v_max3_f32 v248, v248, v200, v201
    v_mfma_f32_16x16x32_bf16 v[212:215], v[26:29], v[184:187], v[212:215]
    v_max3_f32 v248, v248, v202, v203
    v_mfma_f32_16x16x32_bf16 v[216:219], v[56:59], v[184:187], v[216:219]
    ds_read_b128 v[200:203], v246 offset:256
    v_mfma_f32_16x16x32_bf16 v[220:223], v[86:89], v[184:187], v[220:223]
    v_mfma_f32_16x16x32_bf16 v[224:227], a[248:251], v[184:187], v[224:227]
    v_mov_b32 v187, 0
    v_mfma_f32_16x16x32_bf16 v[204:207], v[126:129], v[168:171], v[204:207]
    v_mfma_f32_16x16x32_bf16 v[204:207], v[128:131], v[170:173], v[204:207]
    v_mfma_f32_16x16x32_bf16 v[232:235], a[232:235], a[80:83], v[232:235]
    s_waitcnt lgkmcnt(2)
    v_mfma_f32_16x16x32_bf16 v[208:211], v[156:159], v[168:171], v[208:211]
    v_mfma_f32_16x16x32_bf16 v[208:211], v[158:161], v[170:173], v[208:211]
    s_waitcnt lgkmcnt(1)
    v_rcp_f32 v225, v224
    v_mfma_f32_16x16x32_bf16 v[196:199], v[96:99], v[168:171], v[196:199]
    v_mov_b32 v226, 0x22e00
    v_cndmask_b32 v226, v226, v247, vcc
    v_mfma_f32_16x16x32_bf16 v[196:199], v[98:101], v[170:173], v[196:199]
    s_mov_b32 vcc_lo, 0xff00fff0
    v_mul_f32 v212, v212, v225
    v_mul_f32 v213, v213, v225
    v_mfma_f32_16x16x32_bf16 v[232:235], a[236:239], a[84:87], v[232:235]
    s_mov_b32 vcc_hi, 0xf000
    v_mul_f32 v214, v214, v225
    v_mul_f32 v215, v215, v225
    v_mfma_f32_16x16x32_bf16 v[232:235], a[240:243], a[88:91], v[232:235]
    s_waitcnt lgkmcnt(0)
    v_cvt_pk_bf16_f32 v212, v212, v213
    v_cvt_pk_bf16_f32 v213, v214, v215
    v_mfma_f32_16x16x32_bf16 v[200:203], v[132:135], v[168:171], v[200:203]
    ds_write_b64 v226, v[212:213] offset:0
    v_mfma_f32_16x16x32_bf16 v[200:203], v[134:137], v[170:173], v[200:203]
    v_mul_f32 v216, v216, v225
    v_mul_f32 v217, v217, v225
    v_mfma_f32_16x16x32_bf16 v[232:235], a[244:247], a[92:95], v[232:235]
    v_mul_f32 v218, v218, v225
    v_mul_f32 v219, v219, v225
    v_mfma_f32_16x16x32_bf16 v[236:239], a[224:227], a[96:99], 0
    v_cvt_pk_bf16_f32 v216, v216, v217
    v_cvt_pk_bf16_f32 v217, v218, v219
    v_mfma_f32_16x16x32_bf16 v[236:239], a[228:231], a[100:103], v[236:239]
    ds_write_b64 v226, v[216:217] offset:128
    v_mfma_f32_16x16x32_bf16 v[236:239], a[232:235], a[104:107], v[236:239]
    v_cvt_pk_bf16_f32 v13, v232, v233
    v_cvt_pk_bf16_f32 v16, v234, v235
    v_mfma_f32_16x16x32_bf16 v[236:239], a[236:239], a[108:111], v[236:239]
    v_mul_f32 v220, v220, v225
    v_mul_f32 v221, v221, v225
    v_mfma_f32_16x16x32_bf16 v[236:239], a[240:243], a[112:115], v[236:239]
    v_mul_f32 v222, v222, v225
    v_mul_f32 v223, v223, v225
    v_mfma_f32_16x16x32_bf16 v[236:239], a[244:247], a[116:119], v[236:239]
    v_cvt_pk_bf16_f32 v220, v220, v221
    v_cvt_pk_bf16_f32 v221, v222, v223
    v_mfma_f32_16x16x32_bf16 v[228:231], a[224:227], a[120:123], 0
    ds_read_b128 a[224:227], v240 offset:4736
    v_max3_f32 v248, v248, v204, v205
    v_mfma_f32_16x16x32_bf16 v[228:231], a[228:231], a[124:127], v[228:231]
    ds_read_b128 a[228:231], v241 offset:4736
    v_max3_f32 v248, v248, v206, v207
    v_mfma_f32_16x16x32_bf16 v[228:231], a[232:235], a[128:131], v[228:231]
    v_cvt_pk_bf16_f32 v43, v236, v237
    v_cvt_pk_bf16_f32 v46, v238, v239
    v_mfma_f32_16x16x32_bf16 v[228:231], a[236:239], a[132:135], v[228:231]
    ds_read_b128 a[232:235], v240 offset:4864
    ds_read_b128 a[236:239], v241 offset:4864
    v_mfma_f32_16x16x32_bf16 v[228:231], a[240:243], a[136:139], v[228:231]
    ds_read_b128 v[204:207], v244 offset:320
    v_max3_f32 v248, v248, v208, v209
    v_mfma_f32_16x16x32_bf16 v[228:231], a[244:247], a[140:143], v[228:231]
    ds_write_b64 v226, v[220:221] offset:256
    v_mfma_f32_16x16x32_bf16 v[232:235], a[0:3], a[216:219], 0
    v_max3_f32 v248, v248, v210, v211
    v_max3_f32 v248, v248, v196, v197
    v_mfma_f32_16x16x32_bf16 v[232:235], a[4:7], a[220:223], v[232:235]
    ds_read_b128 v[208:211], v245 offset:320
    v_max3_f32 v248, v248, v198, v199
    v_mfma_f32_16x16x32_bf16 v[236:239], a[24:27], a[216:219], 0
    s_waitcnt lgkmcnt(6)
    v_cvt_pk_bf16_f32 v73, v228, v229
    v_cvt_pk_bf16_f32 v76, v230, v231
    v_mfma_f32_16x16x32_bf16 v[232:235], a[8:11], a[224:227], v[232:235]
    ds_read_b128 v[196:199], v246 offset:320
    v_max3_f32 v248, v248, v200, v201
    v_mfma_f32_16x16x32_bf16 v[236:239], a[28:31], a[220:223], v[236:239]
    s_waitcnt lgkmcnt(6)
    v_max3_f32 v248, v248, v202, v203
    v_mfma_f32_16x16x32_bf16 v[232:235], a[12:15], a[228:231], v[232:235]
    ds_read_b128 v[200:203], v244 offset:192
    s_waitcnt lgkmcnt(6)
    v_mfma_f32_16x16x32_bf16 v[232:235], a[16:19], a[232:235], v[232:235]
    s_waitcnt lgkmcnt(5)
    v_mfma_f32_16x16x32_bf16 v[232:235], a[20:23], a[236:239], v[232:235]
    s_waitcnt lgkmcnt(4)
    v_mfma_f32_16x16x32_bf16 v[204:207], v[162:165], v[168:171], v[204:207]
    v_mfma_f32_16x16x32_bf16 v[204:207], v[164:167], v[170:173], v[204:207]
    v_mfma_f32_16x16x32_bf16 v[236:239], a[32:35], a[224:227], v[236:239]
    s_waitcnt lgkmcnt(2)
    v_mfma_f32_16x16x32_bf16 v[208:211], v[138:141], v[168:171], v[208:211]
    v_mfma_f32_16x16x32_bf16 v[208:211], v[140:143], v[170:173], v[208:211]
    s_waitcnt lgkmcnt(1)
    v_mfma_f32_16x16x32_bf16 v[196:199], v[144:147], v[168:171], v[196:199]
    v_mfma_f32_16x16x32_bf16 v[196:199], v[146:149], v[170:173], v[196:199]
    s_waitcnt lgkmcnt(0)
    v_max3_f32 v248, v248, v204, v205
    v_mfma_f32_16x16x32_bf16 v[200:203], v[150:153], v[168:171], v[200:203]
    v_cvt_pk_bf16_f32 v150, v232, v233
    v_cvt_pk_bf16_f32 v151, v234, v235
    v_mfma_f32_16x16x32_bf16 v[200:203], v[152:155], v[170:173], v[200:203]
    ds_read_b128 v[204:207], v245 offset:192
    v_max3_f32 v248, v248, v208, v209
    v_mfma_f32_16x16x32_bf16 v[236:239], a[36:39], a[228:231], v[236:239]
    ds_read_b128 v[208:211], v246 offset:192
    v_max3_f32 v248, v248, v196, v197
    v_mfma_f32_16x16x32_bf16 v[236:239], a[40:43], a[232:235], v[236:239]
    ds_read_b128 v[196:199], v244 offset:256
    v_mov_b32 v225, v248
    v_mfma_f32_16x16x32_bf16 v[236:239], a[44:47], a[236:239], v[236:239]
    v_mfma_f32_16x16x32_bf16 v[228:231], a[48:51], a[216:219], 0
    v_permlane16_swap_b32 v248, v225
    v_max_f32 v248, v248, v225
    v_mfma_f32_16x16x32_bf16 v[228:231], a[52:55], a[220:223], v[228:231]
    v_mov_b32 v225, v248
    v_mfma_f32_16x16x32_bf16 v[228:231], a[56:59], a[224:227], v[228:231]
    v_mfma_f32_16x16x32_bf16 v[228:231], a[60:63], a[228:231], v[228:231]
    v_permlane32_swap_b32 v248, v225
    v_cvt_pk_bf16_f32 v152, v236, v237
    v_mfma_f32_16x16x32_bf16 v[228:231], a[64:67], a[232:235], v[228:231]
    v_cvt_pk_bf16_f32 v153, v238, v239
    v_max_f32 v248, v248, v225
    v_mfma_f32_16x16x32_bf16 v[228:231], a[68:71], a[236:239], v[228:231]
    s_waitcnt lgkmcnt(2)
    v_sub_f32 v200, v200, v248
    v_sub_f32 v201, v201, v248
    v_mfma_f32_16x16x32_bf16 v[204:207], v[90:93], v[168:171], v[204:207]
    s_waitcnt lgkmcnt(1)
    v_exp_f32 v200, v200
    v_mfma_f32_16x16x32_bf16 v[204:207], v[92:95], v[170:173], v[204:207]
    s_waitcnt lgkmcnt(0)
    v_cvt_pk_bf16_f32 v154, v228, v229
    v_cvt_pk_bf16_f32 v155, v230, v231
    v_mfma_f32_16x16x32_bf16 v[208:211], v[126:129], v[168:171], v[208:211]
    v_exp_f32 v201, v201
    v_mfma_f32_16x16x32_bf16 v[208:211], v[128:131], v[170:173], v[208:211]
    v_sub_f32 v202, v202, v248
    v_sub_f32 v203, v203, v248
    v_mfma_f32_16x16x32_bf16 v[196:199], v[156:159], v[168:171], v[196:199]
    v_exp_f32 v202, v202
    v_mfma_f32_16x16x32_bf16 v[196:199], v[158:161], v[170:173], v[196:199]
    v_exp_f32 v203, v203
    v_mfma_f32_16x16x32_bf16 v[232:235], a[216:219], a[72:75], 0
    v_cvt_pk_bf16_f32 v190, v200, v201
    v_cvt_pk_bf16_f32 v193, v202, v203
    v_mfma_f32_16x16x32_bf16 v[232:235], a[220:223], a[76:79], v[232:235]
    ds_read_b128 v[200:203], v245 offset:256
    v_sub_f32 v204, v204, v248
    v_mfma_f32_16x16x32_bf16 v[232:235], a[224:227], a[80:83], v[232:235]
    v_exp_f32 v204, v204
    v_mfma_f32_16x16x32_bf16 v[232:235], a[228:231], a[84:87], v[232:235]
    v_sub_f32 v205, v205, v248
    v_sub_f32 v206, v206, v248
    v_mfma_f32_16x16x32_bf16 v[232:235], a[232:235], a[88:91], v[232:235]
    v_exp_f32 v205, v205
    v_mfma_f32_16x16x32_bf16 v[232:235], a[236:239], a[92:95], v[232:235]
    v_exp_f32 v206, v206
    v_mfma_f32_16x16x32_bf16 v[236:239], a[216:219], a[96:99], 0
    v_sub_f32 v207, v207, v248
    v_cvt_pk_bf16_f32 v188, v204, v205
    v_mfma_f32_16x16x32_bf16 v[236:239], a[220:223], a[100:103], v[236:239]
    v_exp_f32 v207, v207
    v_mfma_f32_16x16x32_bf16 v[236:239], a[224:227], a[104:107], v[236:239]
    v_cvt_pk_bf16_f32 v191, v206, v207
    v_cvt_pk_bf16_f32 v19, v232, v233
    v_mfma_f32_16x16x32_bf16 v[236:239], a[228:231], a[108:111], v[236:239]
    ds_read_b128 v[204:207], v246 offset:256
    v_cvt_pk_bf16_f32 v22, v234, v235
    v_mfma_f32_16x16x32_bf16 v[236:239], a[232:235], a[112:115], v[236:239]
    s_waitcnt lgkmcnt(1)
    v_mbcnt_lo_u32_b32 v232, -1, 0
    v_mbcnt_hi_u32_b32 v232, -1, v232
    v_mfma_f32_16x16x32_bf16 v[200:203], v[96:99], v[168:171], v[200:203]
    v_and_b32 v233, 15, v232
    v_lshrrev_b32 v232, 4, v232
    v_mfma_f32_16x16x32_bf16 v[200:203], v[98:101], v[170:173], v[200:203]
    v_lshrrev_b32 v234, 1, v233
    v_mul_u32_u24 v235, 0x180, v233
    v_mfma_f32_16x16x32_bf16 v[236:239], a[236:239], a[116:119], v[236:239]
    v_xor_b32 v243, v232, v234
    v_lshl_add_u32 v242, v243, 4, v235
    v_mfma_f32_16x16x32_bf16 v[228:231], a[216:219], a[120:123], 0
    v_xor_b32 v243, 64, v242
    v_add_u32 v242, 0x1e000, v242
    v_mfma_f32_16x16x32_bf16 v[228:231], a[220:223], a[124:127], v[228:231]
    ds_read_b128 a[240:243], v242 offset:0
    v_add_u32 v243, 0x1e000, v243
    v_mfma_f32_16x16x32_bf16 v[228:231], a[224:227], a[128:131], v[228:231]
    v_cvt_pk_bf16_f32 v49, v236, v237
    v_cvt_pk_bf16_f32 v52, v238, v239
    v_mfma_f32_16x16x32_bf16 v[228:231], a[228:231], a[132:135], v[228:231]
    ds_read_b128 a[244:247], v243 offset:0
    ds_read_b128 a[216:219], v242 offset:128
    v_mfma_f32_16x16x32_bf16 v[228:231], a[232:235], a[136:139], v[228:231]
    ds_read_b128 a[220:223], v243 offset:128
    ds_read_b128 a[224:227], v242 offset:256
    v_mfma_f32_16x16x32_bf16 v[228:231], a[236:239], a[140:143], v[228:231]
    s_waitcnt lgkmcnt(5)
    ds_read_b128 a[228:231], v243 offset:256
    v_mfma_f32_16x16x32_bf16 v[204:207], v[132:135], v[168:171], v[204:207]
    ds_read_b128 a[232:235], v242 offset:6144
    ds_read_b128 a[236:239], v243 offset:6144
    v_mfma_f32_16x16x32_bf16 v[204:207], v[134:137], v[170:173], v[204:207]
    v_lshrrev_b32 v249, 1, v232
    v_or_b32 v249, s66, v249
    v_cvt_pk_bf16_f32 v79, v228, v229
    v_cvt_pk_bf16_f32 v82, v230, v231
    v_mov_b32 v253, v249
    v_xor_b32 v249, v249, v234
    v_lshl_add_u32 v249, v249, 4, v235
    s_waitcnt lgkmcnt(7)
    v_mfma_f32_16x16x32_bf16 v[236:239], a[144:147], a[240:243], 0
    v_and_b32 v235, 1, v232
    v_lshl_add_u32 v249, v235, 3, v249
    v_mfma_f32_16x16x32_bf16 v[228:231], a[168:171], a[240:243], 0
    v_add_u32 v249, 0x16800, v249
    s_waitcnt lgkmcnt(6)
    v_mfma_f32_16x16x32_bf16 v[236:239], a[148:151], a[244:247], v[236:239]
    v_xor_b32 v250, s67, v232
    v_mul_u32_u24 v250, 0x300, v250
    v_mfma_f32_16x16x32_bf16 v[228:231], a[172:175], a[244:247], v[228:231]
    s_waitcnt lgkmcnt(5)
    s_mul_i32 s67, s28, 0x600
    s_add_u32 s67, s67, 0x16800
    v_mfma_f32_16x16x32_bf16 v[236:239], a[152:155], a[216:219], v[236:239]
    s_waitcnt lgkmcnt(4)
    v_mul_u32_u24 v232, 0x180, v232
    v_add_u32 v232, s67, v232
    v_mfma_f32_16x16x32_bf16 v[236:239], a[156:159], a[220:223], v[236:239]
    s_waitcnt lgkmcnt(3)
    v_lshlrev_b32 v235, 3, v235
    v_xor_b32 v252, v233, v235
    v_mfma_f32_16x16x32_bf16 v[236:239], a[160:163], a[224:227], v[236:239]
    s_waitcnt lgkmcnt(2)
    v_xor_b32 v252, v252, v253
    v_lshl_add_u32 v252, v252, 4, v232
    v_mfma_f32_16x16x32_bf16 v[236:239], a[164:167], a[228:231], v[236:239]
    v_xor_b32 v253, v253, v234
    v_lshl_add_u32 v253, v253, 4, v232
    v_mfma_f32_16x16x32_bf16 v[228:231], a[176:179], a[216:219], v[228:231]
    v_and_b32 v234, 1, v233
    v_lshl_add_u32 v253, v234, 3, v253
    v_mfma_f32_16x16x32_bf16 v[228:231], a[180:183], a[220:223], v[228:231]
    v_lshl_add_u32 v251, v233, 3, v250
    v_xor_b32 v233, v233, v235
    v_mfma_f32_16x16x32_bf16 v[228:231], a[184:187], a[224:227], v[228:231]
    v_cvt_pk_bf16_f32 v236, v236, v237
    v_cvt_pk_bf16_f32 v237, v238, v239
    v_mfma_f32_16x16x32_bf16 v[228:231], a[188:191], a[228:231], v[228:231]
    ds_write_b64 v249, v[236:237] offset:0
    s_waitcnt lgkmcnt(2)
    v_mfma_f32_16x16x32_bf16 v[236:239], a[144:147], a[232:235], 0
    s_waitcnt lgkmcnt(1)
    v_lshl_add_u32 v250, v233, 4, v250
    v_sub_f32 v208, v208, v248
    v_mfma_f32_16x16x32_bf16 v[232:235], a[192:195], a[240:243], 0
    ds_read_b128 a[240:243], v242 offset:6272
    v_cvt_pk_bf16_f32 v228, v228, v229
    v_mfma_f32_16x16x32_bf16 v[232:235], a[196:199], a[244:247], v[232:235]
    ds_read_b128 a[244:247], v243 offset:6272
    v_cvt_pk_bf16_f32 v229, v230, v231
    v_mfma_f32_16x16x32_bf16 v[232:235], a[200:203], a[216:219], v[232:235]
    ds_write_b64 v249, v[228:229] offset:128
    v_mfma_f32_16x16x32_bf16 v[232:235], a[204:207], a[220:223], v[232:235]
    ds_read_b128 a[216:219], v242 offset:6400
    ds_read_b128 a[220:223], v243 offset:6400
    v_mfma_f32_16x16x32_bf16 v[232:235], a[208:211], a[224:227], v[232:235]
    ds_read_b128 a[224:227], v242 offset:12288
    v_sub_f32 v209, v209, v248
    v_mfma_f32_16x16x32_bf16 v[232:235], a[212:215], a[228:231], v[232:235]
    ds_read_b128 a[228:231], v243 offset:12288
    v_sub_f32 v210, v210, v248
    v_mfma_f32_16x16x32_bf16 v[236:239], a[148:151], a[236:239], v[236:239]
    v_exp_f32 v208, v208
    v_mfma_f32_16x16x32_bf16 v[228:231], a[168:171], a[232:235], 0
    v_exp_f32 v209, v209
    v_mfma_f32_16x16x32_bf16 v[228:231], a[172:175], a[236:239], v[228:231]
    s_waitcnt lgkmcnt(6)
    v_cvt_pk_bf16_f32 v232, v232, v233
    v_cvt_pk_bf16_f32 v233, v234, v235
    v_mfma_f32_16x16x32_bf16 v[236:239], a[152:155], a[240:243], v[236:239]
    ds_write_b64 v249, v[232:233] offset:256
    v_mfma_f32_16x16x32_bf16 v[228:231], a[176:179], a[240:243], v[228:231]
    s_waitcnt lgkmcnt(6)
    v_exp_f32 v210, v210
    v_mfma_f32_16x16x32_bf16 v[236:239], a[156:159], a[244:247], v[236:239]
    v_sub_f32 v211, v211, v248
    v_cvt_pk_bf16_f32 v189, v208, v209
    v_mfma_f32_16x16x32_bf16 v[228:231], a[180:183], a[244:247], v[228:231]
    s_waitcnt lgkmcnt(4)
    v_exp_f32 v211, v211
    v_mfma_f32_16x16x32_bf16 v[212:215], v[0:3], v[188:191], 0
    v_cvt_pk_bf16_f32 v192, v210, v211
    v_sub_f32 v196, v196, v248
    v_mfma_f32_16x16x32_bf16 v[216:219], v[30:33], v[188:191], 0
    ds_read_b128 v[208:211], v244 offset:320
    v_sub_f32 v197, v197, v248
    v_mfma_f32_16x16x32_bf16 v[220:223], v[60:63], v[188:191], 0
    v_exp_f32 v196, v196
    v_mfma_f32_16x16x32_bf16 v[224:227], a[248:251], v[188:191], 0
    v_exp_f32 v197, v197
    v_mfma_f32_16x16x32_bf16 v[236:239], a[160:163], a[216:219], v[236:239]
    s_waitcnt lgkmcnt(4)
    v_sub_f32 v198, v198, v248
    v_sub_f32 v199, v199, v248
    v_mfma_f32_16x16x32_bf16 v[236:239], a[164:167], a[220:223], v[236:239]
    v_exp_f32 v198, v198
    v_mfma_f32_16x16x32_bf16 v[228:231], a[184:187], a[216:219], v[228:231]
    v_exp_f32 v199, v199
    v_mfma_f32_16x16x32_bf16 v[228:231], a[188:191], a[220:223], v[228:231]
    v_cvt_pk_bf16_f32 v180, v196, v197
    v_cvt_pk_bf16_f32 v183, v198, v199
    v_mfma_f32_16x16x32_bf16 v[232:235], a[192:195], a[232:235], 0
    ds_read_b128 a[232:235], v242 offset:12416
    v_cvt_pk_bf16_f32 v236, v236, v237
    v_mfma_f32_16x16x32_bf16 v[232:235], a[196:199], a[236:239], v[232:235]
    ds_read_b128 a[236:239], v243 offset:12416
    v_cvt_pk_bf16_f32 v237, v238, v239
    v_mfma_f32_16x16x32_bf16 v[232:235], a[200:203], a[240:243], v[232:235]
    ds_write_b64 v249, v[236:237] offset:6144
    v_mfma_f32_16x16x32_bf16 v[232:235], a[204:207], a[244:247], v[232:235]
    ds_read_b128 a[240:243], v242 offset:12544
    v_cvt_pk_bf16_f32 v228, v228, v229
    v_mfma_f32_16x16x32_bf16 v[232:235], a[208:211], a[216:219], v[232:235]
    ds_read_b128 a[244:247], v243 offset:12544
    v_cvt_pk_bf16_f32 v229, v230, v231
    v_mfma_f32_16x16x32_bf16 v[232:235], a[212:215], a[220:223], v[232:235]
    s_waitcnt lgkmcnt(5)
    v_add_u32 v242, 0xfffe9800, v242
    v_add_u32 v243, 0xfffe9800, v243
    v_mfma_f32_16x16x32_bf16 v[208:211], v[162:165], v[168:171], v[208:211]
    ds_write_b64 v249, v[228:229] offset:6272
    v_mfma_f32_16x16x32_bf16 v[208:211], v[164:167], v[170:173], v[208:211]
    ds_read_b128 a[216:219], v242 offset:6144
    ds_read_b128 a[220:223], v243 offset:6144
    v_mfma_f32_16x16x32_bf16 v[236:239], a[144:147], a[224:227], 0
    ds_read_b128 v[196:199], v245 offset:320
    v_cvt_pk_bf16_f32 v232, v232, v233
    v_mfma_f32_16x16x32_bf16 v[236:239], a[148:151], a[228:231], v[236:239]
    s_waitcnt lgkmcnt(8)
    v_cvt_pk_bf16_f32 v233, v234, v235
    v_sub_f32 v200, v200, v248
    v_mfma_f32_16x16x32_bf16 v[236:239], a[152:155], a[232:235], v[236:239]
    ds_write_b64 v249, v[232:233] offset:6400
    v_mfma_f32_16x16x32_bf16 v[228:231], a[168:171], a[224:227], 0
    s_waitcnt lgkmcnt(8)
    v_exp_f32 v200, v200
    v_mfma_f32_16x16x32_bf16 v[236:239], a[156:159], a[236:239], v[236:239]
    s_waitcnt lgkmcnt(6)
    v_sub_f32 v201, v201, v248
    v_sub_f32 v202, v202, v248
    v_mfma_f32_16x16x32_bf16 v[236:239], a[160:163], a[240:243], v[236:239]
    s_waitcnt lgkmcnt(5)
    v_exp_f32 v201, v201
    v_mfma_f32_16x16x32_bf16 v[236:239], a[164:167], a[244:247], v[236:239]
    v_exp_f32 v202, v202
    v_mfma_f32_16x16x32_bf16 v[228:231], a[172:175], a[228:231], v[228:231]
    v_sub_f32 v203, v203, v248
    v_cvt_pk_bf16_f32 v194, v200, v201
    v_mfma_f32_16x16x32_bf16 v[228:231], a[176:179], a[232:235], v[228:231]
    v_exp_f32 v203, v203
    v_mfma_f32_16x16x32_bf16 v[228:231], a[180:183], a[236:239], v[228:231]
    s_waitcnt lgkmcnt(1)
    v_cvt_pk_bf16_f32 v236, v236, v237
    v_cvt_pk_bf16_f32 v237, v238, v239
    v_mfma_f32_16x16x32_bf16 v[196:199], v[138:141], v[168:171], v[196:199]
    ds_write_b64 v249, v[236:237] offset:12288
    v_mfma_f32_16x16x32_bf16 v[196:199], v[140:143], v[170:173], v[196:199]
    v_cvt_pk_bf16_f32 v181, v202, v203
    v_sub_f32 v204, v204, v248
    v_mfma_f32_16x16x32_bf16 v[228:231], a[184:187], a[240:243], v[228:231]
    ds_read_b128 v[200:203], v246 offset:320
    v_sub_f32 v205, v205, v248
    v_mfma_f32_16x16x32_bf16 v[228:231], a[188:191], a[244:247], v[228:231]
    v_exp_f32 v204, v204
    v_mfma_f32_16x16x32_bf16 v[232:235], a[192:195], a[224:227], 0
    ds_read_b128 a[224:227], v242 offset:6272
    v_sub_f32 v206, v206, v248
    v_mfma_f32_16x16x32_bf16 v[232:235], a[196:199], a[228:231], v[232:235]
    ds_read_b128 a[228:231], v243 offset:6272
    v_sub_f32 v207, v207, v248
    v_mfma_f32_16x16x32_bf16 v[232:235], a[200:203], a[232:235], v[232:235]
    ds_read_b128 a[232:235], v242 offset:6400
    v_cvt_pk_bf16_f32 v228, v228, v229
    v_mfma_f32_16x16x32_bf16 v[232:235], a[204:207], a[236:239], v[232:235]
    ds_read_b128 a[236:239], v243 offset:6400
    v_cvt_pk_bf16_f32 v229, v230, v231
    v_mfma_f32_16x16x32_bf16 v[232:235], a[208:211], a[240:243], v[232:235]
    ds_write_b64 v249, v[228:229] offset:12416
    v_mfma_f32_16x16x32_bf16 v[232:235], a[212:215], a[244:247], v[232:235]
    ds_read_b128 a[240:243], v240 offset:6144
    ds_read_b128 a[244:247], v241 offset:6144
    v_mfma_f32_16x16x32_bf16 v[236:239], a[144:147], a[216:219], 0
    s_waitcnt lgkmcnt(7)
    v_exp_f32 v205, v205
    v_mfma_f32_16x16x32_bf16 v[200:203], v[144:147], v[168:171], v[200:203]
    ds_read_b64 v[168:169], v247 offset:36864
    v_cvt_pk_bf16_f32 v195, v204, v205
    v_mfma_f32_16x16x32_bf16 v[200:203], v[146:149], v[170:173], v[200:203]
    ds_read_b64 v[170:171], v247 offset:36992
    v_cvt_pk_bf16_f32 v232, v232, v233
    v_mfma_f32_16x16x32_bf16 v[212:215], v[4:7], v[192:195], v[212:215]
    ds_read_b64 v[172:173], v247 offset:37120
    v_cvt_pk_bf16_f32 v233, v234, v235
    v_mfma_f32_16x16x32_bf16 v[216:219], v[34:37], v[192:195], v[216:219]
    ds_write_b64 v249, v[232:233] offset:12544
    v_mfma_f32_16x16x32_bf16 v[220:223], v[64:67], v[192:195], v[220:223]
    v_exp_f32 v206, v206
    v_mfma_f32_16x16x32_bf16 v[224:227], a[248:251], v[192:195], v[224:227]
    v_exp_f32 v207, v207
    v_mfma_f32_16x16x32_bf16 v[236:239], a[148:151], a[220:223], v[236:239]
    s_waitcnt lgkmcnt(10)
    v_cvt_pk_bf16_f32 v182, v206, v207
    v_sub_f32 v208, v208, v248
    v_mfma_f32_16x16x32_bf16 v[236:239], a[152:155], a[224:227], v[236:239]
    ds_read_b128 v[204:207], v244 offset:0
    v_sub_f32 v209, v209, v248
    v_mfma_f32_16x16x32_bf16 v[212:215], v[8:11], v[180:183], v[212:215]
    s_waitcnt lgkmcnt(9)
    v_exp_f32 v208, v208
    v_mfma_f32_16x16x32_bf16 v[216:219], v[38:41], v[180:183], v[216:219]
    v_exp_f32 v209, v209
    v_mfma_f32_16x16x32_bf16 v[220:223], v[68:71], v[180:183], v[220:223]
    v_cvt_pk_bf16_f32 v186, v208, v209
    v_sub_f32 v196, v196, v248
    v_mfma_f32_16x16x32_bf16 v[224:227], a[248:251], v[180:183], v[224:227]
    ds_read_b128 v[208:211], v245 offset:0
    s_waitcnt lgkmcnt(2)
    v_mfma_f32_16x16x32_bf16 v[236:239], a[156:159], a[228:231], v[236:239]
    s_barrier
    ds_read_b128 a[252:255], v252 offset:0
    v_mfma_f32_16x16x32_bf16 v[236:239], a[160:163], a[232:235], v[236:239]
    ds_read_b64 v[254:255], v253 offset:256
    v_sub_f32 v197, v197, v248
    v_mfma_f32_16x16x32_bf16 v[236:239], a[164:167], a[236:239], v[236:239]
    v_exp_f32 v196, v196
    v_mfma_f32_16x16x32_bf16 v[228:231], a[168:171], a[216:219], 0
    v_exp_f32 v197, v197
    v_mfma_f32_16x16x32_bf16 v[228:231], a[172:175], a[220:223], v[228:231]
    s_waitcnt lgkmcnt(3)
    v_cvt_pk_bf16_f32 v184, v196, v197
    v_sub_f32 v200, v200, v248
    v_mfma_f32_16x16x32_bf16 v[204:207], v[156:159], v[174:177], v[204:207]
    ds_read_b128 v[196:199], v246 offset:0
    v_cvt_pk_bf16_f32 v236, v236, v237
    v_mfma_f32_16x16x32_bf16 v[204:207], v[158:161], v[176:179], v[204:207]
    v_cvt_pk_bf16_f32 v237, v238, v239
    v_sub_f32 v201, v201, v248
    v_mfma_f32_16x16x32_bf16 v[228:231], a[176:179], a[224:227], v[228:231]
    ds_write_b64 v249, v[236:237] offset:18432
    v_mfma_f32_16x16x32_bf16 v[228:231], a[180:183], a[228:231], v[228:231]
    s_waitcnt lgkmcnt(4)
    s_waitcnt lgkmcnt(3)
    v_mfma_f32_16x16x32_bf16 v[208:211], v[96:99], v[174:177], v[208:211]
    buffer_store_dwordx4 a[252:255], v250, s[20:23], s55 offen nt
    v_mfma_f32_16x16x32_bf16 v[208:211], v[98:101], v[176:179], v[208:211]
    s_waitcnt lgkmcnt(2)
    ds_read_b128 a[252:255], v252 offset:6144
    v_mfma_f32_16x16x32_bf16 v[228:231], a[184:187], a[232:235], v[228:231]
    v_exp_f32 v200, v200
    v_mfma_f32_16x16x32_bf16 v[228:231], a[188:191], a[236:239], v[228:231]
    buffer_store_dwordx2 v[254:255], v251, s[20:23], s55 offen offset:256 nt
    v_mfma_f32_16x16x32_bf16 v[232:235], a[192:195], a[216:219], 0
    ds_read_b128 a[216:219], v240 offset:6272
    ds_read_b64 v[254:255], v253 offset:6400
    v_mfma_f32_16x16x32_bf16 v[232:235], a[196:199], a[220:223], v[232:235]
    ds_read_b128 a[220:223], v241 offset:6272
    s_mul_i32 s55, s31, 3
    v_mfma_f32_16x16x32_bf16 v[232:235], a[200:203], a[224:227], v[232:235]
    ds_read_b128 a[224:227], v240 offset:6400
    v_cvt_pk_bf16_f32 v228, v228, v229
    v_mfma_f32_16x16x32_bf16 v[232:235], a[204:207], a[228:231], v[232:235]
    ds_read_b128 a[228:231], v241 offset:6400
    v_cvt_pk_bf16_f32 v229, v230, v231
    v_mfma_f32_16x16x32_bf16 v[232:235], a[208:211], a[232:235], v[232:235]
    ds_write_b64 v249, v[228:229] offset:18560
    v_mfma_f32_16x16x32_bf16 v[232:235], a[212:215], a[236:239], v[232:235]
    ds_read_b128 a[232:235], v242 offset:12288
    ds_read_b128 a[236:239], v243 offset:12288
    v_mfma_f32_16x16x32_bf16 v[236:239], a[0:3], a[240:243], 0
    s_waitcnt lgkmcnt(8)
    s_add_u32 s54, s54, s55
    s_add_u32 s54, s54, s32
    v_mfma_f32_16x16x32_bf16 v[196:199], v[132:135], v[174:177], v[196:199]
    buffer_store_dwordx4 a[252:255], v250, s[20:23], s57 offen nt
    v_mfma_f32_16x16x32_bf16 v[196:199], v[134:137], v[176:179], v[196:199]
    s_waitcnt lgkmcnt(6)
    v_cvt_pk_bf16_f32 v232, v232, v233
    v_cvt_pk_bf16_f32 v233, v234, v235
    v_mfma_f32_16x16x32_bf16 v[236:239], a[4:7], a[244:247], v[236:239]
    ds_write_b64 v249, v[232:233] offset:18688
    v_mfma_f32_16x16x32_bf16 v[236:239], a[8:11], a[216:219], v[236:239]
    buffer_store_dwordx2 v[254:255], v251, s[20:23], s57 offen offset:256 nt
    v_mfma_f32_16x16x32_bf16 v[228:231], a[24:27], a[240:243], 0
    ds_read_b128 a[252:255], v252 offset:12288
    ds_read_b64 v[254:255], v253 offset:12544
    v_mfma_f32_16x16x32_bf16 v[228:231], a[28:31], a[244:247], v[228:231]
    s_mul_i32 s57, s31, 7
    s_add_u32 s56, s56, s57
    s_add_u32 s56, s56, s32
    v_mfma_f32_16x16x32_bf16 v[228:231], a[32:35], a[216:219], v[228:231]
    s_add_u32 s55, s28, 7
    s_mul_i32 s55, s55, s30
    s_add_u32 s57, s28, 11
    v_mfma_f32_16x16x32_bf16 v[232:235], a[48:51], a[240:243], 0
    s_mul_i32 s57, s57, s30
    v_exp_f32 v201, v201
    v_mfma_f32_16x16x32_bf16 v[232:235], a[52:55], a[244:247], v[232:235]
    s_waitcnt lgkmcnt(6)
    v_cvt_pk_bf16_f32 v185, v200, v201
    v_max_f32 v248, v204, v205
    v_mfma_f32_16x16x32_bf16 v[236:239], a[12:15], a[220:223], v[236:239]
    ds_read_b128 v[200:203], v244 offset:64
    v_max3_f32 v248, v248, v206, v207
    v_mfma_f32_16x16x32_bf16 v[212:215], v[12:15], v[184:187], v[212:215]
    ds_read_b128 v[204:207], v245 offset:64
    v_max3_f32 v248, v248, v208, v209
    v_mfma_f32_16x16x32_bf16 v[216:219], v[42:45], v[184:187], v[216:219]
    v_max3_f32 v248, v248, v210, v211
    v_max3_f32 v248, v248, v196, v197
    v_mfma_f32_16x16x32_bf16 v[220:223], v[72:75], v[184:187], v[220:223]
    ds_read_b128 v[208:211], v246 offset:64
    s_waitcnt lgkmcnt(4)
    v_mfma_f32_16x16x32_bf16 v[224:227], a[248:251], v[184:187], v[224:227]
    buffer_store_dwordx4 a[252:255], v250, s[20:23], s52 offen nt
    v_mfma_f32_16x16x32_bf16 v[236:239], a[16:19], a[224:227], v[236:239]
    s_waitcnt lgkmcnt(3)
    v_max3_f32 v248, v248, v198, v199
    v_mfma_f32_16x16x32_bf16 v[236:239], a[20:23], a[228:231], v[236:239]
    ds_read_b128 v[196:199], v244 offset:128
    v_mfma_f32_16x16x32_bf16 v[228:231], a[36:39], a[220:223], v[228:231]
    buffer_store_dwordx2 v[254:255], v251, s[20:23], s52 offen offset:256 nt
    v_mfma_f32_16x16x32_bf16 v[228:231], a[40:43], a[224:227], v[228:231]
    s_mul_i32 s52, s31, 11
    s_add_u32 s51, s51, s52
    s_add_u32 s51, s51, s32
    v_mfma_f32_16x16x32_bf16 v[228:231], a[44:47], a[228:231], v[228:231]
    s_add_u32 s52, s28, 11
    s_mul_i32 s52, s52, s30
    s_waitcnt lgkmcnt(2)
    v_mfma_f32_16x16x32_bf16 v[200:203], v[162:165], v[174:177], v[200:203]
    v_rcp_f32 v225, v224
    v_mfma_f32_16x16x32_bf16 v[200:203], v[164:167], v[176:179], v[200:203]
    s_waitcnt lgkmcnt(1)
    v_mul_f32 v212, v212, v225
    v_mul_f32 v213, v213, v225
    v_mfma_f32_16x16x32_bf16 v[204:207], v[138:141], v[174:177], v[204:207]
    v_mul_f32 v214, v214, v225
    v_mul_f32 v215, v215, v225
    v_mfma_f32_16x16x32_bf16 v[204:207], v[140:143], v[176:179], v[204:207]
    v_cvt_pk_bf16_f32 v212, v212, v213
    v_cvt_pk_bf16_f32 v213, v214, v215
    v_mfma_f32_16x16x32_bf16 v[208:211], v[144:147], v[174:177], v[208:211]
    ds_write_b64 v247, v[212:213] offset:24576
    v_mfma_f32_16x16x32_bf16 v[208:211], v[146:149], v[176:179], v[208:211]
    s_waitcnt lgkmcnt(1)
    v_mul_f32 v216, v216, v225
    v_mul_f32 v217, v217, v225
    v_mfma_f32_16x16x32_bf16 v[196:199], v[102:105], v[174:177], v[196:199]
    v_mul_f32 v218, v218, v225
    v_mul_f32 v219, v219, v225
    v_mfma_f32_16x16x32_bf16 v[196:199], v[104:107], v[176:179], v[196:199]
    v_cvt_pk_bf16_f32 v216, v216, v217
    v_cvt_pk_bf16_f32 v217, v218, v219
    v_mfma_f32_16x16x32_bf16 v[232:235], a[56:59], a[216:219], v[232:235]
    ds_write_b64 v247, v[216:217] offset:24704
    v_mfma_f32_16x16x32_bf16 v[232:235], a[60:63], a[220:223], v[232:235]
    v_mul_f32 v220, v220, v225
    v_mul_f32 v221, v221, v225
    v_mfma_f32_16x16x32_bf16 v[232:235], a[64:67], a[224:227], v[232:235]
    v_mul_f32 v222, v222, v225
    v_mul_f32 v223, v223, v225
    v_mfma_f32_16x16x32_bf16 v[232:235], a[68:71], a[228:231], v[232:235]
    v_cvt_pk_bf16_f32 v220, v220, v221
    v_cvt_pk_bf16_f32 v221, v222, v223
    ds_write_b64 v247, v[220:221] offset:24832
    v_max3_f32 v248, v248, v200, v201
    v_max3_f32 v248, v248, v202, v203
    ds_read_b128 v[200:203], v245 offset:128
    v_max3_f32 v248, v248, v204, v205
    v_max3_f32 v248, v248, v206, v207
    ds_read_b128 v[204:207], v246 offset:128
    v_max3_f32 v248, v248, v208, v209
    v_max3_f32 v248, v248, v210, v211
    ds_read_b128 v[208:211], v244 offset:0
    v_max3_f32 v248, v248, v196, v197
    ds_read_b128 v[196:199], v245 offset:0
    s_waitcnt lgkmcnt(3)
    v_mfma_f32_16x16x32_bf16 v[200:203], v[114:117], v[174:177], v[200:203]
    v_mfma_f32_16x16x32_bf16 v[200:203], v[116:119], v[176:179], v[200:203]
    s_waitcnt lgkmcnt(2)
    v_mfma_f32_16x16x32_bf16 v[204:207], v[150:153], v[174:177], v[204:207]
    s_waitcnt lgkmcnt(1)
    v_mfma_f32_16x16x32_bf16 v[204:207], v[152:155], v[176:179], v[204:207]
    s_waitcnt lgkmcnt(0)
    v_mfma_f32_16x16x32_bf16 v[208:211], v[156:159], v[174:177], v[208:211]
    v_cvt_pk_bf16_f32 v156, v236, v237
    v_cvt_pk_bf16_f32 v157, v238, v239
    v_mfma_f32_16x16x32_bf16 v[208:211], v[158:161], v[176:179], v[208:211]
    v_cvt_pk_bf16_f32 v158, v228, v229
    v_cvt_pk_bf16_f32 v159, v230, v231
    v_mfma_f32_16x16x32_bf16 v[196:199], v[96:99], v[174:177], v[196:199]
    v_cvt_pk_bf16_f32 v160, v232, v233
    v_cvt_pk_bf16_f32 v161, v234, v235
    v_mfma_f32_16x16x32_bf16 v[196:199], v[98:101], v[176:179], v[196:199]
    v_max3_f32 v248, v248, v200, v201
    v_max3_f32 v248, v248, v204, v205
    v_mfma_f32_16x16x32_bf16 v[236:239], a[240:243], a[72:75], 0
    ds_read_b128 v[200:203], v246 offset:0
    ds_read_b128 v[204:207], v244 offset:64
    v_mfma_f32_16x16x32_bf16 v[236:239], a[244:247], a[76:79], v[236:239]
    v_mov_b32 v225, v248
    v_mfma_f32_16x16x32_bf16 v[236:239], a[216:219], a[80:83], v[236:239]
    v_mfma_f32_16x16x32_bf16 v[236:239], a[220:223], a[84:87], v[236:239]
    v_permlane16_swap_b32 v248, v225
    v_max_f32 v248, v248, v225
    v_mfma_f32_16x16x32_bf16 v[236:239], a[224:227], a[88:91], v[236:239]
    v_mov_b32 v225, v248
    v_mfma_f32_16x16x32_bf16 v[236:239], a[228:231], a[92:95], v[236:239]
    v_mfma_f32_16x16x32_bf16 v[228:231], a[240:243], a[96:99], 0
    v_permlane32_swap_b32 v248, v225
    v_max_f32 v248, v248, v225
    v_mfma_f32_16x16x32_bf16 v[228:231], a[244:247], a[100:103], v[228:231]
    v_sub_f32 v208, v208, v248
    v_sub_f32 v209, v209, v248
    v_mfma_f32_16x16x32_bf16 v[228:231], a[216:219], a[104:107], v[228:231]
    v_exp_f32 v208, v208
    v_mfma_f32_16x16x32_bf16 v[228:231], a[220:223], a[108:111], v[228:231]
    s_waitcnt lgkmcnt(1)
    v_cvt_pk_bf16_f32 v25, v236, v237
    v_cvt_pk_bf16_f32 v28, v238, v239
    v_mfma_f32_16x16x32_bf16 v[200:203], v[132:135], v[174:177], v[200:203]
    s_waitcnt lgkmcnt(0)
    v_exp_f32 v209, v209
    v_mfma_f32_16x16x32_bf16 v[200:203], v[134:137], v[176:179], v[200:203]
    v_sub_f32 v210, v210, v248
    v_sub_f32 v211, v211, v248
    v_mfma_f32_16x16x32_bf16 v[204:207], v[162:165], v[174:177], v[204:207]
    v_exp_f32 v210, v210
    v_mfma_f32_16x16x32_bf16 v[204:207], v[164:167], v[176:179], v[204:207]
    v_exp_f32 v211, v211
    v_mfma_f32_16x16x32_bf16 v[228:231], a[224:227], a[112:115], v[228:231]
    v_cvt_pk_bf16_f32 v190, v208, v209
    v_cvt_pk_bf16_f32 v193, v210, v211
    v_mfma_f32_16x16x32_bf16 v[228:231], a[228:231], a[116:119], v[228:231]
    ds_read_b128 v[208:211], v245 offset:64
    v_sub_f32 v196, v196, v248
    v_mfma_f32_16x16x32_bf16 v[232:235], a[240:243], a[120:123], 0
    ds_read_b128 a[240:243], v242 offset:12416
    v_sub_f32 v197, v197, v248
    v_mfma_f32_16x16x32_bf16 v[232:235], a[244:247], a[124:127], v[232:235]
    ds_read_b128 a[244:247], v243 offset:12416
    v_sub_f32 v198, v198, v248
    v_mfma_f32_16x16x32_bf16 v[232:235], a[216:219], a[128:131], v[232:235]
    v_cvt_pk_bf16_f32 v55, v228, v229
    v_cvt_pk_bf16_f32 v58, v230, v231
    v_mfma_f32_16x16x32_bf16 v[232:235], a[220:223], a[132:135], v[232:235]
    ds_read_b128 a[216:219], v242 offset:12544
    ds_read_b128 a[220:223], v243 offset:12544
    v_mfma_f32_16x16x32_bf16 v[232:235], a[224:227], a[136:139], v[232:235]
    ds_read_b128 a[224:227], v242 offset:18432
    v_sub_f32 v199, v199, v248
    v_mfma_f32_16x16x32_bf16 v[232:235], a[228:231], a[140:143], v[232:235]
    ds_read_b128 a[228:231], v243 offset:18432
    v_sub_f32 v200, v200, v248
    v_mfma_f32_16x16x32_bf16 v[236:239], a[144:147], a[232:235], 0
    v_exp_f32 v196, v196
    v_mfma_f32_16x16x32_bf16 v[236:239], a[148:151], a[236:239], v[236:239]
    v_exp_f32 v197, v197
    v_mfma_f32_16x16x32_bf16 v[228:231], a[168:171], a[232:235], 0
    s_waitcnt lgkmcnt(6)
    v_cvt_pk_bf16_f32 v85, v232, v233
    v_cvt_pk_bf16_f32 v88, v234, v235
    v_mfma_f32_16x16x32_bf16 v[208:211], v[138:141], v[174:177], v[208:211]
    s_waitcnt lgkmcnt(5)
    v_exp_f32 v198, v198
    v_mfma_f32_16x16x32_bf16 v[208:211], v[140:143], v[176:179], v[208:211]
    v_exp_f32 v199, v199
    v_mfma_f32_16x16x32_bf16 v[236:239], a[152:155], a[240:243], v[236:239]
    s_waitcnt lgkmcnt(4)
    v_cvt_pk_bf16_f32 v188, v196, v197
    v_cvt_pk_bf16_f32 v191, v198, v199
    v_mfma_f32_16x16x32_bf16 v[236:239], a[156:159], a[244:247], v[236:239]
    ds_read_b128 v[196:199], v246 offset:64
    v_sub_f32 v201, v201, v248
    v_mfma_f32_16x16x32_bf16 v[228:231], a[172:175], a[236:239], v[228:231]
    s_waitcnt lgkmcnt(4)
    v_exp_f32 v200, v200
    v_mfma_f32_16x16x32_bf16 v[236:239], a[160:163], a[216:219], v[236:239]
    s_waitcnt lgkmcnt(3)
    v_exp_f32 v201, v201
    v_mfma_f32_16x16x32_bf16 v[236:239], a[164:167], a[220:223], v[236:239]
    v_sub_f32 v202, v202, v248
    v_sub_f32 v203, v203, v248
    v_mfma_f32_16x16x32_bf16 v[228:231], a[176:179], a[240:243], v[228:231]
    v_exp_f32 v202, v202
    v_mfma_f32_16x16x32_bf16 v[228:231], a[180:183], a[244:247], v[228:231]
    v_exp_f32 v203, v203
    v_mfma_f32_16x16x32_bf16 v[228:231], a[184:187], a[216:219], v[228:231]
    v_cvt_pk_bf16_f32 v189, v200, v201
    v_cvt_pk_bf16_f32 v236, v236, v237
    v_mfma_f32_16x16x32_bf16 v[228:231], a[188:191], a[220:223], v[228:231]
    v_cvt_pk_bf16_f32 v237, v238, v239
    v_cvt_pk_bf16_f32 v192, v202, v203
    v_mfma_f32_16x16x32_bf16 v[212:215], v[6:9], v[188:191], 0
    ds_write_b64 v249, v[236:237] offset:24576
    v_mfma_f32_16x16x32_bf16 v[216:219], v[36:39], v[188:191], 0
    ds_read_b128 v[200:203], v244 offset:128
    v_sub_f32 v204, v204, v248
    v_mfma_f32_16x16x32_bf16 v[220:223], v[66:69], v[188:191], 0
    s_waitcnt lgkmcnt(2)
    v_cvt_pk_bf16_f32 v228, v228, v229
    v_cvt_pk_bf16_f32 v229, v230, v231
    v_mfma_f32_16x16x32_bf16 v[224:227], a[248:251], v[188:191], 0
    ds_write_b64 v249, v[228:229] offset:24704
    v_mfma_f32_16x16x32_bf16 v[196:199], v[144:147], v[174:177], v[196:199]
    v_exp_f32 v204, v204
    v_mfma_f32_16x16x32_bf16 v[196:199], v[146:149], v[176:179], v[196:199]
    v_sub_f32 v205, v205, v248
    v_sub_f32 v206, v206, v248
    v_mfma_f32_16x16x32_bf16 v[232:235], a[192:195], a[232:235], 0
    ds_read_b128 a[232:235], v242 offset:18560
    v_sub_f32 v207, v207, v248
    v_mfma_f32_16x16x32_bf16 v[232:235], a[196:199], a[236:239], v[232:235]
    ds_read_b128 a[236:239], v243 offset:18560
    v_sub_f32 v208, v208, v248
    v_mfma_f32_16x16x32_bf16 v[232:235], a[200:203], a[240:243], v[232:235]
    ds_read_b128 a[240:243], v242 offset:18688
    v_sub_f32 v209, v209, v248
    v_mfma_f32_16x16x32_bf16 v[232:235], a[204:207], a[244:247], v[232:235]
    ds_read_b128 a[244:247], v243 offset:18688
    v_sub_f32 v210, v210, v248
    v_mfma_f32_16x16x32_bf16 v[232:235], a[208:211], a[216:219], v[232:235]
    ds_read_b128 a[216:219], v242 offset:0
    v_sub_f32 v211, v211, v248
    v_mfma_f32_16x16x32_bf16 v[232:235], a[212:215], a[220:223], v[232:235]
    ds_read_b128 a[220:223], v243 offset:0
    v_sub_f32 v196, v196, v248
    v_mfma_f32_16x16x32_bf16 v[236:239], a[144:147], a[224:227], 0
    s_waitcnt lgkmcnt(7)
    v_exp_f32 v205, v205
    v_mfma_f32_16x16x32_bf16 v[200:203], v[102:105], v[174:177], v[200:203]
    v_exp_f32 v206, v206
    v_mfma_f32_16x16x32_bf16 v[200:203], v[104:107], v[176:179], v[200:203]
    v_cvt_pk_bf16_f32 v232, v232, v233
    v_cvt_pk_bf16_f32 v233, v234, v235
    v_mfma_f32_16x16x32_bf16 v[236:239], a[148:151], a[228:231], v[236:239]
    ds_write_b64 v249, v[232:233] offset:24832
    v_mfma_f32_16x16x32_bf16 v[228:231], a[168:171], a[224:227], 0
    s_waitcnt lgkmcnt(6)
    v_exp_f32 v207, v207
    v_mfma_f32_16x16x32_bf16 v[236:239], a[152:155], a[232:235], v[236:239]
    s_waitcnt lgkmcnt(5)
    v_cvt_pk_bf16_f32 v180, v204, v205
    v_cvt_pk_bf16_f32 v183, v206, v207
    v_mfma_f32_16x16x32_bf16 v[236:239], a[156:159], a[236:239], v[236:239]
    ds_read_b128 v[204:207], v245 offset:128
    v_sub_f32 v197, v197, v248
    v_mfma_f32_16x16x32_bf16 v[228:231], a[172:175], a[228:231], v[228:231]
    s_waitcnt lgkmcnt(5)
    v_exp_f32 v208, v208
    v_mfma_f32_16x16x32_bf16 v[236:239], a[160:163], a[240:243], v[236:239]
    s_waitcnt lgkmcnt(4)
    v_exp_f32 v209, v209
    v_mfma_f32_16x16x32_bf16 v[236:239], a[164:167], a[244:247], v[236:239]
    v_exp_f32 v210, v210
    v_mfma_f32_16x16x32_bf16 v[228:231], a[176:179], a[232:235], v[228:231]
    v_exp_f32 v211, v211
    v_mfma_f32_16x16x32_bf16 v[228:231], a[180:183], a[236:239], v[228:231]
    s_waitcnt lgkmcnt(1)
    s_barrier
    v_cvt_pk_bf16_f32 v194, v208, v209
    v_mfma_f32_16x16x32_bf16 v[228:231], a[184:187], a[240:243], v[228:231]
    ds_read_b128 a[252:255], v252 offset:18432
    v_cvt_pk_bf16_f32 v236, v236, v237
    v_mfma_f32_16x16x32_bf16 v[228:231], a[188:191], a[244:247], v[228:231]
    ds_read_b64 v[254:255], v253 offset:18688
    v_cvt_pk_bf16_f32 v237, v238, v239
    v_mfma_f32_16x16x32_bf16 v[232:235], a[192:195], a[224:227], 0
    ds_write_b64 v249, v[236:237] offset:0
    v_mfma_f32_16x16x32_bf16 v[232:235], a[196:199], a[228:231], v[232:235]
    ds_read_b128 a[224:227], v242 offset:128
    ds_read_b128 a[228:231], v243 offset:128
    v_mfma_f32_16x16x32_bf16 v[232:235], a[200:203], a[232:235], v[232:235]
    ds_read_b128 a[232:235], v242 offset:256
    v_cvt_pk_bf16_f32 v228, v228, v229
    v_mfma_f32_16x16x32_bf16 v[232:235], a[204:207], a[236:239], v[232:235]
    ds_read_b128 a[236:239], v243 offset:256
    v_cvt_pk_bf16_f32 v229, v230, v231
    v_mfma_f32_16x16x32_bf16 v[232:235], a[208:211], a[240:243], v[232:235]
    ds_write_b64 v249, v[228:229] offset:128
    v_mfma_f32_16x16x32_bf16 v[232:235], a[212:215], a[244:247], v[232:235]
    ds_read_b128 a[240:243], v242 offset:24576
    ds_read_b128 a[244:247], v243 offset:24576
    v_mfma_f32_16x16x32_bf16 v[236:239], a[144:147], a[216:219], 0
    s_waitcnt lgkmcnt(9)
    v_cvt_pk_bf16_f32 v181, v210, v211
    s_waitcnt lgkmcnt(8)
    v_mfma_f32_16x16x32_bf16 v[204:207], v[114:117], v[174:177], v[204:207]
    ds_read_b128 v[208:211], v246 offset:128
    v_cvt_pk_bf16_f32 v232, v232, v233
    v_mfma_f32_16x16x32_bf16 v[204:207], v[116:119], v[176:179], v[204:207]
    v_cvt_pk_bf16_f32 v233, v234, v235
    v_sub_f32 v198, v198, v248
    v_mfma_f32_16x16x32_bf16 v[236:239], a[148:151], a[220:223], v[236:239]
    ds_write_b64 v249, v[232:233] offset:256
    v_mfma_f32_16x16x32_bf16 v[228:231], a[168:171], a[216:219], 0
    buffer_store_dwordx4 a[252:255], v250, s[20:23], s54 offen nt
    v_mfma_f32_16x16x32_bf16 v[228:231], a[172:175], a[220:223], v[228:231]
    s_waitcnt lgkmcnt(8)
    ds_read_b128 a[252:255], v252 offset:24576
    v_mfma_f32_16x16x32_bf16 v[236:239], a[152:155], a[224:227], v[236:239]
    s_waitcnt lgkmcnt(8)
    v_exp_f32 v196, v196
    v_mfma_f32_16x16x32_bf16 v[236:239], a[156:159], a[228:231], v[236:239]
    buffer_store_dwordx2 v[254:255], v251, s[20:23], s54 offen offset:256 nt
    v_mfma_f32_16x16x32_bf16 v[228:231], a[176:179], a[224:227], v[228:231]
    ds_read_b64 v[254:255], v253 offset:24832
    s_mul_i32 s54, s31, 15
    v_mfma_f32_16x16x32_bf16 v[228:231], a[180:183], a[228:231], v[228:231]
    s_add_u32 s53, s53, s54
    s_add_u32 s53, s53, s32
    s_add_u32 s54, s28, 11
    v_mfma_f32_16x16x32_bf16 v[232:235], a[192:195], a[216:219], 0
    ds_read_b128 a[216:219], v242 offset:24704
    s_mul_i32 s54, s54, s30
    v_mfma_f32_16x16x32_bf16 v[232:235], a[196:199], a[220:223], v[232:235]
    ds_read_b128 a[220:223], v243 offset:24704
    v_sub_f32 v199, v199, v248
    v_mfma_f32_16x16x32_bf16 v[232:235], a[200:203], a[224:227], v[232:235]
    ds_read_b128 a[224:227], v242 offset:24832
    v_sub_f32 v200, v200, v248
    v_mfma_f32_16x16x32_bf16 v[232:235], a[204:207], a[228:231], v[232:235]
    s_waitcnt lgkmcnt(6)
    ds_read_b128 a[228:231], v243 offset:24832
    v_mfma_f32_16x16x32_bf16 v[208:211], v[150:153], v[174:177], v[208:211]
    s_waitcnt lgkmcnt(5)
    ds_read_b64 v[174:175], v247 offset:43008
    v_mfma_f32_16x16x32_bf16 v[208:211], v[152:155], v[176:179], v[208:211]
    buffer_store_dwordx4 a[252:255], v250, s[20:23], s56 offen nt
    v_mfma_f32_16x16x32_bf16 v[236:239], a[160:163], a[232:235], v[236:239]
    s_waitcnt lgkmcnt(5)
    ds_read_b64 v[176:177], v247 offset:43136
    v_mfma_f32_16x16x32_bf16 v[236:239], a[164:167], a[236:239], v[236:239]
    ds_read_b64 v[178:179], v247 offset:43264
    v_sub_f32 v201, v201, v248
    v_mfma_f32_16x16x32_bf16 v[228:231], a[184:187], a[232:235], v[228:231]
    buffer_store_dwordx2 v[254:255], v251, s[20:23], s56 offen offset:256 nt
    v_mfma_f32_16x16x32_bf16 v[228:231], a[188:191], a[236:239], v[228:231]
    s_mul_i32 s56, s31, 13
    s_add_u32 s55, s55, s56
    s_add_u32 s55, s55, s32
    v_mfma_f32_16x16x32_bf16 v[232:235], a[208:211], a[232:235], v[232:235]
    s_add_u32 s56, s28, 11
    v_cvt_pk_bf16_f32 v236, v236, v237
    v_cvt_pk_bf16_f32 v237, v238, v239
    v_mfma_f32_16x16x32_bf16 v[232:235], a[212:215], a[236:239], v[232:235]
    ds_write_b64 v249, v[236:237] offset:6144
    v_cvt_pk_bf16_f32 v228, v228, v229
    v_cvt_pk_bf16_f32 v229, v230, v231
    ds_write_b64 v249, v[228:229] offset:6272
    s_mul_i32 s56, s56, s30
    v_exp_f32 v197, v197
    v_exp_f32 v198, v198
    v_exp_f32 v199, v199
    v_cvt_pk_bf16_f32 v232, v232, v233
    v_cvt_pk_bf16_f32 v233, v234, v235
    ds_write_b64 v249, v[232:233] offset:6400
    v_cvt_pk_bf16_f32 v195, v196, v197
    v_cvt_pk_bf16_f32 v182, v198, v199
    ds_read_b128 v[196:199], v244 offset:0
    v_mfma_f32_16x16x32_bf16 v[212:215], v[10:13], v[192:195], v[212:215]
    v_exp_f32 v200, v200
    v_mfma_f32_16x16x32_bf16 v[216:219], v[40:43], v[192:195], v[216:219]
    v_exp_f32 v201, v201
    v_mfma_f32_16x16x32_bf16 v[220:223], v[70:73], v[192:195], v[220:223]
    v_cvt_pk_bf16_f32 v186, v200, v201
    v_sub_f32 v204, v204, v248
    v_mfma_f32_16x16x32_bf16 v[224:227], a[248:251], v[192:195], v[224:227]
    ds_read_b128 v[200:203], v245 offset:0
    v_sub_f32 v205, v205, v248
    v_mfma_f32_16x16x32_bf16 v[212:215], v[14:17], v[180:183], v[212:215]
    v_exp_f32 v204, v204
    v_mfma_f32_16x16x32_bf16 v[216:219], v[44:47], v[180:183], v[216:219]
    v_exp_f32 v205, v205
    v_mfma_f32_16x16x32_bf16 v[220:223], v[74:77], v[180:183], v[220:223]
    v_cvt_pk_bf16_f32 v184, v204, v205
    v_sub_f32 v208, v208, v248
    v_mfma_f32_16x16x32_bf16 v[224:227], a[248:251], v[180:183], v[224:227]
    ds_read_b128 v[204:207], v246 offset:0
    s_waitcnt lgkmcnt(2)
    v_mfma_f32_16x16x32_bf16 v[196:199], v[162:165], v[168:171], v[196:199]
    v_exp_f32 v208, v208
    v_mfma_f32_16x16x32_bf16 v[196:199], v[164:167], v[170:173], v[196:199]
    v_sub_f32 v209, v209, v248
    v_exp_f32 v209, v209
    s_nop 0
    v_cvt_pk_bf16_f32 v185, v208, v209
    ds_read_b128 v[208:211], v244 offset:64
    s_waitcnt lgkmcnt(2)
    v_mfma_f32_16x16x32_bf16 v[212:215], v[18:21], v[184:187], v[212:215]
    v_mfma_f32_16x16x32_bf16 v[216:219], v[48:51], v[184:187], v[216:219]
    v_max_f32 v248, v196, v197
    v_max3_f32 v248, v248, v198, v199
    v_mfma_f32_16x16x32_bf16 v[220:223], v[78:81], v[184:187], v[220:223]
    ds_read_b128 v[196:199], v245 offset:64
    v_mfma_f32_16x16x32_bf16 v[224:227], a[248:251], v[184:187], v[224:227]
    v_mfma_f32_16x16x32_bf16 v[200:203], v[138:141], v[168:171], v[200:203]
    s_waitcnt lgkmcnt(2)
    v_mfma_f32_16x16x32_bf16 v[200:203], v[140:143], v[170:173], v[200:203]
    v_mfma_f32_16x16x32_bf16 v[204:207], v[144:147], v[168:171], v[204:207]
    v_mfma_f32_16x16x32_bf16 v[204:207], v[146:149], v[170:173], v[204:207]
    s_nop 2
    s_waitcnt lgkmcnt(1)
    v_mfma_f32_16x16x32_bf16 v[208:211], v[102:105], v[168:171], v[208:211]
    v_rcp_f32 v225, v224
    v_mfma_f32_16x16x32_bf16 v[208:211], v[104:107], v[170:173], v[208:211]
    v_mul_f32 v212, v212, v225
    v_mul_f32 v213, v213, v225
    v_mul_f32 v214, v214, v225
    s_waitcnt lgkmcnt(0)
    v_mfma_f32_16x16x32_bf16 v[196:199], v[114:117], v[168:171], v[196:199]
    v_mul_f32 v215, v215, v225
    v_cvt_pk_bf16_f32 v212, v212, v213
    v_mfma_f32_16x16x32_bf16 v[196:199], v[116:119], v[170:173], v[196:199]
    v_cvt_pk_bf16_f32 v213, v214, v215
    ds_write_b64 v247, v[212:213] offset:30720
    v_mul_f32 v216, v216, v225
    v_mul_f32 v217, v217, v225
    v_mul_f32 v218, v218, v225
    v_mul_f32 v219, v219, v225
    v_cvt_pk_bf16_f32 v216, v216, v217
    v_cvt_pk_bf16_f32 v217, v218, v219
    ds_write_b64 v247, v[216:217] offset:30848
    v_mul_f32 v220, v220, v225
    v_mul_f32 v221, v221, v225
    v_mul_f32 v222, v222, v225
    v_mul_f32 v223, v223, v225
    v_cvt_pk_bf16_f32 v220, v220, v221
    v_cvt_pk_bf16_f32 v221, v222, v223
    ds_write_b64 v247, v[220:221] offset:30976
    v_max3_f32 v248, v248, v200, v201
    v_max3_f32 v248, v248, v202, v203
    ds_read_b128 v[200:203], v246 offset:64
    v_max3_f32 v248, v248, v204, v205
    v_max3_f32 v248, v248, v206, v207
    ds_read_b128 v[204:207], v244 offset:128
    v_max3_f32 v248, v248, v208, v209
    v_max3_f32 v248, v248, v210, v211
    ds_read_b128 v[208:211], v245 offset:128
    v_max3_f32 v248, v248, v196, v197
    v_max3_f32 v248, v248, v198, v199
    ds_read_b128 v[196:199], v246 offset:128
    s_waitcnt lgkmcnt(3)
    v_mfma_f32_16x16x32_bf16 v[200:203], v[150:153], v[168:171], v[200:203]
    v_mfma_f32_16x16x32_bf16 v[200:203], v[152:155], v[170:173], v[200:203]
    s_waitcnt lgkmcnt(2)
    v_mfma_f32_16x16x32_bf16 v[204:207], v[108:111], v[168:171], v[204:207]
    s_waitcnt lgkmcnt(1)
    v_mfma_f32_16x16x32_bf16 v[204:207], v[110:113], v[170:173], v[204:207]
    v_mfma_f32_16x16x32_bf16 v[208:211], v[120:123], v[168:171], v[208:211]
    s_waitcnt lgkmcnt(0)
    v_mfma_f32_16x16x32_bf16 v[208:211], v[122:125], v[170:173], v[208:211]
    v_mfma_f32_16x16x32_bf16 v[196:199], v[156:159], v[168:171], v[196:199]
    v_max3_f32 v248, v248, v200, v201
    v_max3_f32 v248, v248, v202, v203
    v_mfma_f32_16x16x32_bf16 v[196:199], v[158:161], v[170:173], v[196:199]
    ds_read_b128 v[200:203], v244 offset:0
    v_max3_f32 v248, v248, v204, v205
    ds_read_b128 v[204:207], v245 offset:0
    s_nop 0
    v_max3_f32 v248, v248, v208, v209
    ds_read_b128 v[208:211], v246 offset:0
    s_nop 1
    v_max3_f32 v248, v248, v196, v197
    ds_read_b128 v[196:199], v244 offset:64
    v_mov_b32 v225, v248
    s_nop 1
    v_permlane16_swap_b32 v248, v225
    v_max_f32 v248, v248, v225
    v_mov_b32 v225, v248
    s_nop 1
    v_permlane32_swap_b32 v248, v225
    v_max_f32 v248, v248, v225
    s_waitcnt lgkmcnt(3)
    v_mfma_f32_16x16x32_bf16 v[200:203], v[162:165], v[168:171], v[200:203]
    v_mfma_f32_16x16x32_bf16 v[200:203], v[164:167], v[170:173], v[200:203]
    s_waitcnt lgkmcnt(2)
    v_mfma_f32_16x16x32_bf16 v[204:207], v[138:141], v[168:171], v[204:207]
    s_waitcnt lgkmcnt(1)
    v_mfma_f32_16x16x32_bf16 v[204:207], v[140:143], v[170:173], v[204:207]
    v_mfma_f32_16x16x32_bf16 v[208:211], v[144:147], v[168:171], v[208:211]
    s_waitcnt lgkmcnt(0)
    v_mfma_f32_16x16x32_bf16 v[208:211], v[146:149], v[170:173], v[208:211]
    v_mfma_f32_16x16x32_bf16 v[196:199], v[102:105], v[168:171], v[196:199]
    v_sub_f32 v200, v200, v248
    v_sub_f32 v201, v201, v248
    v_mfma_f32_16x16x32_bf16 v[196:199], v[104:107], v[170:173], v[196:199]
    v_exp_f32 v200, v200
    v_exp_f32 v201, v201
    v_sub_f32 v202, v202, v248
    v_exp_f32 v202, v202
    v_sub_f32 v203, v203, v248
    v_exp_f32 v203, v203
    v_cvt_pk_bf16_f32 v190, v200, v201
    v_cvt_pk_bf16_f32 v193, v202, v203
    ds_read_b128 v[200:203], v245 offset:64
    v_sub_f32 v204, v204, v248
    v_exp_f32 v204, v204
    v_sub_f32 v205, v205, v248
    v_exp_f32 v205, v205
    v_sub_f32 v206, v206, v248
    v_exp_f32 v206, v206
    v_sub_f32 v207, v207, v248
    v_exp_f32 v207, v207
    v_cvt_pk_bf16_f32 v188, v204, v205
    v_cvt_pk_bf16_f32 v191, v206, v207
    ds_read_b128 v[204:207], v246 offset:64
    v_sub_f32 v208, v208, v248
    v_exp_f32 v208, v208
    v_sub_f32 v209, v209, v248
    v_exp_f32 v209, v209
    v_sub_f32 v210, v210, v248
    v_exp_f32 v210, v210
    v_sub_f32 v211, v211, v248
    v_exp_f32 v211, v211
    v_cvt_pk_bf16_f32 v189, v208, v209
    v_cvt_pk_bf16_f32 v192, v210, v211
    s_waitcnt lgkmcnt(1)
    v_mfma_f32_16x16x32_bf16 v[212:215], v[12:15], v[188:191], 0
    ds_read_b128 v[208:211], v244 offset:128
    v_sub_f32 v196, v196, v248
    v_mfma_f32_16x16x32_bf16 v[216:219], v[42:45], v[188:191], 0
    v_exp_f32 v196, v196
    v_mfma_f32_16x16x32_bf16 v[220:223], v[72:75], v[188:191], 0
    v_sub_f32 v197, v197, v248
    v_sub_f32 v198, v198, v248
    v_mfma_f32_16x16x32_bf16 v[224:227], a[248:251], v[188:191], 0
    v_exp_f32 v197, v197
    v_mfma_f32_16x16x32_bf16 v[200:203], v[114:117], v[168:171], v[200:203]
    s_waitcnt lgkmcnt(1)
    v_exp_f32 v198, v198
    v_mfma_f32_16x16x32_bf16 v[200:203], v[116:119], v[170:173], v[200:203]
    v_sub_f32 v199, v199, v248
    v_cvt_pk_bf16_f32 v180, v196, v197
    v_mfma_f32_16x16x32_bf16 v[204:207], v[150:153], v[168:171], v[204:207]
    v_exp_f32 v199, v199
    v_mfma_f32_16x16x32_bf16 v[204:207], v[152:155], v[170:173], v[204:207]
    v_cvt_pk_bf16_f32 v183, v198, v199
    ds_read_b128 v[196:199], v245 offset:128
    s_waitcnt lgkmcnt(1)
    v_mfma_f32_16x16x32_bf16 v[208:211], v[108:111], v[168:171], v[208:211]
    v_sub_f32 v200, v200, v248
    v_sub_f32 v201, v201, v248
    v_mfma_f32_16x16x32_bf16 v[208:211], v[110:113], v[170:173], v[208:211]
    v_exp_f32 v200, v200
    v_exp_f32 v201, v201
    v_sub_f32 v202, v202, v248
    v_exp_f32 v202, v202
    v_sub_f32 v203, v203, v248
    v_exp_f32 v203, v203
    v_cvt_pk_bf16_f32 v194, v200, v201
    v_cvt_pk_bf16_f32 v181, v202, v203
    ds_read_b128 v[200:203], v246 offset:128
    v_sub_f32 v204, v204, v248
    v_exp_f32 v204, v204
    v_sub_f32 v205, v205, v248
    v_exp_f32 v205, v205
    v_sub_f32 v206, v206, v248
    v_exp_f32 v206, v206
    s_waitcnt lgkmcnt(1)
    v_mfma_f32_16x16x32_bf16 v[196:199], v[120:123], v[168:171], v[196:199]
    v_sub_f32 v207, v207, v248
    v_cvt_pk_bf16_f32 v195, v204, v205
    v_mfma_f32_16x16x32_bf16 v[196:199], v[122:125], v[170:173], v[196:199]
    v_exp_f32 v207, v207
    v_mfma_f32_16x16x32_bf16 v[212:215], v[16:19], v[192:195], v[212:215]
    v_cvt_pk_bf16_f32 v182, v206, v207
    v_sub_f32 v208, v208, v248
    v_mfma_f32_16x16x32_bf16 v[216:219], v[46:49], v[192:195], v[216:219]
    ds_read_b128 v[204:207], v244 offset:0
    v_sub_f32 v209, v209, v248
    v_mfma_f32_16x16x32_bf16 v[220:223], v[76:79], v[192:195], v[220:223]
    v_exp_f32 v208, v208
    v_mfma_f32_16x16x32_bf16 v[224:227], a[248:251], v[192:195], v[224:227]
    s_waitcnt lgkmcnt(1)
    v_exp_f32 v209, v209
    v_mfma_f32_16x16x32_bf16 v[212:215], v[20:23], v[180:183], v[212:215]
    v_cvt_pk_bf16_f32 v186, v208, v209
    v_sub_f32 v196, v196, v248
    v_mfma_f32_16x16x32_bf16 v[216:219], v[50:53], v[180:183], v[216:219]
    ds_read_b128 v[208:211], v245 offset:0
    v_sub_f32 v197, v197, v248
    v_mfma_f32_16x16x32_bf16 v[220:223], v[80:83], v[180:183], v[220:223]
    v_exp_f32 v196, v196
    v_mfma_f32_16x16x32_bf16 v[224:227], a[248:251], v[180:183], v[224:227]
    v_exp_f32 v197, v197
    v_mfma_f32_16x16x32_bf16 v[200:203], v[156:159], v[168:171], v[200:203]
    ds_read_b64 v[168:169], v247 offset:49152
    v_cvt_pk_bf16_f32 v184, v196, v197
    v_mfma_f32_16x16x32_bf16 v[200:203], v[158:161], v[170:173], v[200:203]
    ds_read_b128 v[196:199], v246 offset:0
    s_waitcnt lgkmcnt(3)
    v_mfma_f32_16x16x32_bf16 v[204:207], v[102:105], v[174:177], v[204:207]
    ds_read_b64 v[170:171], v247 offset:49280
    ds_read_b64 v[172:173], v247 offset:49408
    v_mfma_f32_16x16x32_bf16 v[204:207], v[104:107], v[176:179], v[204:207]
    s_nop 1
    v_sub_f32 v200, v200, v248
    v_exp_f32 v200, v200
    v_sub_f32 v201, v201, v248
    v_exp_f32 v201, v201
    s_nop 0
    s_waitcnt lgkmcnt(4)
    v_mfma_f32_16x16x32_bf16 v[208:211], v[114:117], v[174:177], v[208:211]
    v_cvt_pk_bf16_f32 v185, v200, v201
    v_max_f32 v248, v204, v205
    v_mfma_f32_16x16x32_bf16 v[208:211], v[116:119], v[176:179], v[208:211]
    ds_read_b128 v[200:203], v244 offset:64
    v_max3_f32 v248, v248, v206, v207
    v_mfma_f32_16x16x32_bf16 v[212:215], v[24:27], v[184:187], v[212:215]
    ds_read_b128 v[204:207], v245 offset:64
    v_mfma_f32_16x16x32_bf16 v[216:219], v[54:57], v[184:187], v[216:219]
    v_mfma_f32_16x16x32_bf16 v[220:223], v[84:87], v[184:187], v[220:223]
    s_waitcnt lgkmcnt(4)
    v_mfma_f32_16x16x32_bf16 v[224:227], a[248:251], v[184:187], v[224:227]
    v_max3_f32 v248, v248, v208, v209
    v_max3_f32 v248, v248, v210, v211
    v_mfma_f32_16x16x32_bf16 v[196:199], v[150:153], v[174:177], v[196:199]
    ds_read_b128 v[208:211], v246 offset:64
    v_mov_b32 v186, 0
    v_mfma_f32_16x16x32_bf16 v[196:199], v[152:155], v[176:179], v[196:199]
    s_nop 1
    v_rcp_f32 v225, v224
    s_nop 0
    v_mul_f32 v212, v212, v225
    v_mul_f32 v213, v213, v225
    v_mul_f32 v214, v214, v225
    v_mul_f32 v215, v215, v225
    s_waitcnt lgkmcnt(2)
    v_mfma_f32_16x16x32_bf16 v[200:203], v[108:111], v[174:177], v[200:203]
    v_cvt_pk_bf16_f32 v212, v212, v213
    v_cvt_pk_bf16_f32 v213, v214, v215
    v_mfma_f32_16x16x32_bf16 v[200:203], v[110:113], v[176:179], v[200:203]
    s_waitcnt lgkmcnt(1)
    v_mul_f32 v216, v216, v225
    v_mul_f32 v217, v217, v225
    v_mfma_f32_16x16x32_bf16 v[204:207], v[120:123], v[174:177], v[204:207]
    ds_write_b64 v247, v[212:213] offset:36864
    v_mfma_f32_16x16x32_bf16 v[204:207], v[122:125], v[176:179], v[204:207]
    v_mul_f32 v218, v218, v225
    v_mul_f32 v219, v219, v225
    v_cvt_pk_bf16_f32 v216, v216, v217
    v_cvt_pk_bf16_f32 v217, v218, v219
    s_waitcnt lgkmcnt(1)
    v_mfma_f32_16x16x32_bf16 v[208:211], v[156:159], v[174:177], v[208:211]
    ds_write_b64 v247, v[216:217] offset:36992
    v_mfma_f32_16x16x32_bf16 v[208:211], v[158:161], v[176:179], v[208:211]
    v_mul_f32 v220, v220, v225
    v_mul_f32 v221, v221, v225
    v_mul_f32 v222, v222, v225
    v_mul_f32 v223, v223, v225
    v_cvt_pk_bf16_f32 v220, v220, v221
    v_cvt_pk_bf16_f32 v221, v222, v223
    ds_write_b64 v247, v[220:221] offset:37120
    v_max3_f32 v248, v248, v196, v197
    v_max3_f32 v248, v248, v198, v199
    ds_read_b128 v[196:199], v244 offset:0
    v_max3_f32 v248, v248, v200, v201
    v_max3_f32 v248, v248, v202, v203
    ds_read_b128 v[200:203], v245 offset:0
    v_max3_f32 v248, v248, v204, v205
    v_max3_f32 v248, v248, v206, v207
    ds_read_b128 v[204:207], v246 offset:0
    v_max3_f32 v248, v248, v208, v209
    v_max3_f32 v248, v248, v210, v211
    ds_read_b128 v[208:211], v244 offset:64
    v_mov_b32 v225, v248
    s_nop 1
    v_permlane16_swap_b32 v248, v225
    v_max_f32 v248, v248, v225
    v_mov_b32 v225, v248
    s_nop 1
    v_permlane32_swap_b32 v248, v225
    v_max_f32 v248, v248, v225
    s_waitcnt lgkmcnt(3)
    v_mfma_f32_16x16x32_bf16 v[196:199], v[102:105], v[174:177], v[196:199]
    v_mfma_f32_16x16x32_bf16 v[196:199], v[104:107], v[176:179], v[196:199]
    s_waitcnt lgkmcnt(2)
    v_mfma_f32_16x16x32_bf16 v[200:203], v[114:117], v[174:177], v[200:203]
    s_waitcnt lgkmcnt(1)
    v_mfma_f32_16x16x32_bf16 v[200:203], v[116:119], v[176:179], v[200:203]
    v_mfma_f32_16x16x32_bf16 v[204:207], v[150:153], v[174:177], v[204:207]
    s_waitcnt lgkmcnt(0)
    v_mfma_f32_16x16x32_bf16 v[204:207], v[152:155], v[176:179], v[204:207]
    v_mfma_f32_16x16x32_bf16 v[208:211], v[108:111], v[174:177], v[208:211]
    v_sub_f32 v196, v196, v248
    v_sub_f32 v197, v197, v248
    v_mfma_f32_16x16x32_bf16 v[208:211], v[110:113], v[176:179], v[208:211]
    v_exp_f32 v196, v196
    v_exp_f32 v197, v197
    v_sub_f32 v198, v198, v248
    v_exp_f32 v198, v198
    v_sub_f32 v199, v199, v248
    v_exp_f32 v199, v199
    v_cvt_pk_bf16_f32 v190, v196, v197
    v_cvt_pk_bf16_f32 v193, v198, v199
    ds_read_b128 v[196:199], v245 offset:64
    v_sub_f32 v200, v200, v248
    v_exp_f32 v200, v200
    v_sub_f32 v201, v201, v248
    v_exp_f32 v201, v201
    v_sub_f32 v202, v202, v248
    v_exp_f32 v202, v202
    v_sub_f32 v203, v203, v248
    v_exp_f32 v203, v203
    v_cvt_pk_bf16_f32 v188, v200, v201
    v_cvt_pk_bf16_f32 v191, v202, v203
    ds_read_b128 v[200:203], v246 offset:64
    v_sub_f32 v204, v204, v248
    v_exp_f32 v204, v204
    v_sub_f32 v205, v205, v248
    v_exp_f32 v205, v205
    v_sub_f32 v206, v206, v248
    v_exp_f32 v206, v206
    v_sub_f32 v207, v207, v248
    v_exp_f32 v207, v207
    v_cvt_pk_bf16_f32 v189, v204, v205
    v_cvt_pk_bf16_f32 v192, v206, v207
    s_waitcnt lgkmcnt(1)
    v_mfma_f32_16x16x32_bf16 v[212:215], v[18:21], v[188:191], 0
    v_sub_f32 v208, v208, v248
    v_sub_f32 v209, v209, v248
    v_mfma_f32_16x16x32_bf16 v[216:219], v[48:51], v[188:191], 0
    v_exp_f32 v208, v208
    v_mfma_f32_16x16x32_bf16 v[220:223], v[78:81], v[188:191], 0
    v_exp_f32 v209, v209
    v_mfma_f32_16x16x32_bf16 v[224:227], a[248:251], v[188:191], 0
    v_sub_f32 v210, v210, v248
    v_sub_f32 v211, v211, v248
    v_mfma_f32_16x16x32_bf16 v[196:199], v[120:123], v[174:177], v[196:199]
    s_waitcnt lgkmcnt(0)
    v_exp_f32 v210, v210
    v_mfma_f32_16x16x32_bf16 v[196:199], v[122:125], v[176:179], v[196:199]
    v_exp_f32 v211, v211
    v_mfma_f32_16x16x32_bf16 v[200:203], v[156:159], v[174:177], v[200:203]
    ds_read_b64 v[174:175], v247 offset:55296
    v_cvt_pk_bf16_f32 v180, v208, v209
    v_mfma_f32_16x16x32_bf16 v[200:203], v[158:161], v[176:179], v[200:203]
    ds_read_b64 v[176:177], v247 offset:55424
    ds_read_b64 v[178:179], v247 offset:55552
    v_cvt_pk_bf16_f32 v183, v210, v211
    v_sub_f32 v196, v196, v248
    v_exp_f32 v196, v196
    v_sub_f32 v197, v197, v248
    v_exp_f32 v197, v197
    v_sub_f32 v198, v198, v248
    v_exp_f32 v198, v198
    v_sub_f32 v199, v199, v248
    v_exp_f32 v199, v199
    v_cvt_pk_bf16_f32 v194, v196, v197
    v_cvt_pk_bf16_f32 v181, v198, v199
    v_sub_f32 v200, v200, v248
    v_exp_f32 v200, v200
    v_sub_f32 v201, v201, v248
    v_exp_f32 v201, v201
    v_sub_f32 v202, v202, v248
    v_exp_f32 v202, v202
    v_sub_f32 v203, v203, v248
    v_exp_f32 v203, v203
    v_cvt_pk_bf16_f32 v195, v200, v201
    v_cvt_pk_bf16_f32 v182, v202, v203
    v_mov_b32 v204, 0x237c0
    v_mfma_f32_16x16x32_bf16 v[212:215], v[22:25], v[192:195], v[212:215]
    v_add_u32 v205, 0xfffff900, v245
    v_cndmask_b32 v205, v244, v205, vcc
    v_mfma_f32_16x16x32_bf16 v[216:219], v[52:55], v[192:195], v[216:219]
    s_mov_b32 vcc_lo, 0xff00ff00
    v_add_u32 v206, 0xc0, v205
    v_add_u32 v205, 0x340, v205
    v_mfma_f32_16x16x32_bf16 v[220:223], v[82:85], v[192:195], v[220:223]
    s_mov_b32 vcc_hi, 0xff00ff00
    v_cndmask_b32 v244, v206, v205, vcc
    v_add_u32 v245, 0x700, v244
    v_mfma_f32_16x16x32_bf16 v[224:227], a[248:251], v[192:195], v[224:227]
    s_mov_b32 vcc_lo, 0xf0f0
    s_mov_b32 vcc_hi, 0x0
    v_cndmask_b32 v244, v244, v204, vcc
    v_mfma_f32_16x16x32_bf16 v[212:215], v[26:29], v[180:183], v[212:215]
    ds_read_b128 v[196:199], v244 offset:64
    s_mov_b32 vcc_lo, 0x0
    v_mfma_f32_16x16x32_bf16 v[216:219], v[56:59], v[180:183], v[216:219]
    s_mov_b32 vcc_hi, 0xf0f0000
    v_cndmask_b32 v245, v245, v204, vcc
    v_mov_b32 v189, 0
    v_mfma_f32_16x16x32_bf16 v[220:223], v[86:89], v[180:183], v[220:223]
    ds_read_b128 v[204:207], v244 offset:0
    ds_read_b128 v[208:211], v245 offset:0
    v_mfma_f32_16x16x32_bf16 v[224:227], a[248:251], v[180:183], v[224:227]
    ds_read_b128 v[200:203], v245 offset:64
    v_mov_b32 v192, 0
    v_mov_b32 v195, 0
    v_mov_b32 v182, 0
    s_mov_b32 vcc_lo, 0xff000f
    s_mov_b32 vcc_hi, 0xff00ff
    s_nop 1
    v_rcp_f32 v225, v224
    s_nop 0
    v_mul_f32 v212, v212, v225
    v_mul_f32 v213, v213, v225
    v_mul_f32 v214, v214, v225
    v_mul_f32 v215, v215, v225
    v_cvt_pk_bf16_f32 v212, v212, v213
    v_cvt_pk_bf16_f32 v213, v214, v215
    ds_write_b64 v247, v[212:213] offset:43008
    s_waitcnt lgkmcnt(4)
    v_mfma_f32_16x16x32_bf16 v[196:199], v[96:99], v[168:171], v[196:199]
    v_mul_f32 v216, v216, v225
    v_mul_f32 v217, v217, v225
    v_mfma_f32_16x16x32_bf16 v[196:199], v[98:101], v[170:173], v[196:199]
    s_waitcnt lgkmcnt(3)
    v_mul_f32 v218, v218, v225
    v_mul_f32 v219, v219, v225
    v_mfma_f32_16x16x32_bf16 v[204:207], v[90:93], v[168:171], v[204:207]
    s_waitcnt lgkmcnt(2)
    v_cvt_pk_bf16_f32 v216, v216, v217
    v_cvt_pk_bf16_f32 v217, v218, v219
    v_mfma_f32_16x16x32_bf16 v[204:207], v[92:95], v[170:173], v[204:207]
    ds_write_b64 v247, v[216:217] offset:43136
    v_mfma_f32_16x16x32_bf16 v[208:211], v[126:129], v[168:171], v[208:211]
    s_waitcnt lgkmcnt(2)
    v_mul_f32 v220, v220, v225
    v_mul_f32 v221, v221, v225
    v_mfma_f32_16x16x32_bf16 v[208:211], v[128:131], v[170:173], v[208:211]
    v_mul_f32 v222, v222, v225
    v_mul_f32 v223, v223, v225
    v_mfma_f32_16x16x32_bf16 v[200:203], v[132:135], v[168:171], v[200:203]
    v_cvt_pk_bf16_f32 v220, v220, v221
    v_cvt_pk_bf16_f32 v221, v222, v223
    v_mfma_f32_16x16x32_bf16 v[200:203], v[134:137], v[170:173], v[200:203]
    ds_write_b64 v247, v[220:221] offset:43264
    v_mfma_f32_16x16x32_bf16 v[236:239], a[144:147], a[240:243], 0
    v_max_f32 v248, v204, v205
    v_max3_f32 v248, v248, v206, v207
    v_mfma_f32_16x16x32_bf16 v[236:239], a[148:151], a[244:247], v[236:239]
    ds_read_b128 v[204:207], v244 offset:128
    v_max3_f32 v248, v248, v208, v209
    v_mfma_f32_16x16x32_bf16 v[236:239], a[152:155], a[216:219], v[236:239]
    v_max3_f32 v248, v248, v210, v211
    v_max3_f32 v248, v248, v196, v197
    v_mfma_f32_16x16x32_bf16 v[236:239], a[156:159], a[220:223], v[236:239]
    ds_read_b128 v[208:211], v245 offset:128
    v_max3_f32 v248, v248, v198, v199
    v_mfma_f32_16x16x32_bf16 v[236:239], a[160:163], a[224:227], v[236:239]
    ds_read_b128 v[196:199], v244 offset:192
    v_max3_f32 v248, v248, v200, v201
    v_mfma_f32_16x16x32_bf16 v[236:239], a[164:167], a[228:231], v[236:239]
    v_max3_f32 v248, v248, v202, v203
    v_mfma_f32_16x16x32_bf16 v[228:231], a[168:171], a[240:243], 0
    ds_read_b128 v[200:203], v245 offset:192
    v_mfma_f32_16x16x32_bf16 v[228:231], a[172:175], a[244:247], v[228:231]
    v_mfma_f32_16x16x32_bf16 v[228:231], a[176:179], a[216:219], v[228:231]
    v_mfma_f32_16x16x32_bf16 v[228:231], a[180:183], a[220:223], v[228:231]
    v_mfma_f32_16x16x32_bf16 v[228:231], a[184:187], a[224:227], v[228:231]
    s_waitcnt lgkmcnt(3)
    v_cvt_pk_bf16_f32 v236, v236, v237
    v_cvt_pk_bf16_f32 v237, v238, v239
    v_mfma_f32_16x16x32_bf16 v[204:207], v[138:141], v[168:171], v[204:207]
    ds_write_b64 v249, v[236:237] offset:12288
    v_mfma_f32_16x16x32_bf16 v[204:207], v[140:143], v[170:173], v[204:207]
    s_waitcnt lgkmcnt(2)
    v_mfma_f32_16x16x32_bf16 v[208:211], v[144:147], v[168:171], v[208:211]
    v_mfma_f32_16x16x32_bf16 v[208:211], v[146:149], v[170:173], v[208:211]
    s_waitcnt lgkmcnt(1)
    v_mfma_f32_16x16x32_bf16 v[196:199], v[114:117], v[168:171], v[196:199]
    v_mfma_f32_16x16x32_bf16 v[196:199], v[116:119], v[170:173], v[196:199]
    v_mfma_f32_16x16x32_bf16 v[200:203], v[150:153], v[168:171], v[200:203]
    v_mfma_f32_16x16x32_bf16 v[200:203], v[152:155], v[170:173], v[200:203]
    v_max3_f32 v248, v248, v204, v205
    v_max3_f32 v248, v248, v206, v207
    v_mfma_f32_16x16x32_bf16 v[228:231], a[188:191], a[228:231], v[228:231]
    ds_read_b128 v[204:207], v244 offset:0
    v_max3_f32 v248, v248, v208, v209
    v_mfma_f32_16x16x32_bf16 v[232:235], a[192:195], a[240:243], 0
    v_max3_f32 v248, v248, v210, v211
    v_max3_f32 v248, v248, v196, v197
    v_mfma_f32_16x16x32_bf16 v[232:235], a[196:199], a[244:247], v[232:235]
    ds_read_b128 v[208:211], v245 offset:0
    ds_read_b128 v[196:199], v244 offset:64
    v_mfma_f32_16x16x32_bf16 v[232:235], a[200:203], a[216:219], v[232:235]
    v_cvt_pk_bf16_f32 v228, v228, v229
    v_cvt_pk_bf16_f32 v229, v230, v231
    v_mfma_f32_16x16x32_bf16 v[232:235], a[204:207], a[220:223], v[232:235]
    ds_write_b64 v249, v[228:229] offset:12416
    v_mfma_f32_16x16x32_bf16 v[232:235], a[208:211], a[224:227], v[232:235]
    v_max3_f32 v248, v248, v200, v201
    v_mov_b32 v225, v248
    v_mfma_f32_16x16x32_bf16 v[232:235], a[212:215], a[228:231], v[232:235]
    ds_read_b128 v[200:203], v245 offset:64
    v_permlane16_swap_b32 v248, v225
    v_max_f32 v248, v248, v225
    v_mov_b32 v225, v248
    s_nop 1
    v_permlane32_swap_b32 v248, v225
    s_waitcnt lgkmcnt(4)
    v_mfma_f32_16x16x32_bf16 v[204:207], v[90:93], v[168:171], v[204:207]
    v_cvt_pk_bf16_f32 v232, v232, v233
    v_cvt_pk_bf16_f32 v233, v234, v235
    v_mfma_f32_16x16x32_bf16 v[204:207], v[92:95], v[170:173], v[204:207]
    ds_write_b64 v249, v[232:233] offset:12544
    s_waitcnt lgkmcnt(4)
    v_mfma_f32_16x16x32_bf16 v[208:211], v[126:129], v[168:171], v[208:211]
    s_waitcnt lgkmcnt(3)
    v_max_f32 v248, v248, v225
    v_mfma_f32_16x16x32_bf16 v[208:211], v[128:131], v[170:173], v[208:211]
    v_mfma_f32_16x16x32_bf16 v[196:199], v[96:99], v[168:171], v[196:199]
    v_mfma_f32_16x16x32_bf16 v[196:199], v[98:101], v[170:173], v[196:199]
    v_sub_f32 v204, v204, v248
    s_waitcnt lgkmcnt(1)
    v_mfma_f32_16x16x32_bf16 v[200:203], v[132:135], v[168:171], v[200:203]
    v_exp_f32 v204, v204
    v_mfma_f32_16x16x32_bf16 v[200:203], v[134:137], v[170:173], v[200:203]
    v_sub_f32 v205, v205, v248
    v_exp_f32 v205, v205
    v_sub_f32 v206, v206, v248
    v_exp_f32 v206, v206
    s_waitcnt lgkmcnt(0)
    s_barrier
    ds_read_b128 a[232:235], v242 offset:30720
    ds_read_b128 a[236:239], v243 offset:30720
    ds_read_b128 a[240:243], v242 offset:30848
    ds_read_b128 a[244:247], v243 offset:30848
    ds_read_b128 a[216:219], v242 offset:30976
    ds_read_b128 a[220:223], v243 offset:30976
    ds_read_b128 a[224:227], v242 offset:36864
    ds_read_b128 a[228:231], v243 offset:36864
    ds_read_b128 a[252:255], v252 offset:0
    ds_read_b64 v[254:255], v253 offset:256
    v_sub_f32 v207, v207, v248
    v_exp_f32 v207, v207
    v_cvt_pk_bf16_f32 v184, v204, v205
    v_cvt_pk_bf16_f32 v187, v206, v207
    ds_read_b128 v[204:207], v244 offset:128
    v_sub_f32 v208, v208, v248
    v_exp_f32 v208, v208
    v_sub_f32 v209, v209, v248
    v_exp_f32 v209, v209
    v_sub_f32 v210, v210, v248
    v_exp_f32 v210, v210
    v_sub_f32 v211, v211, v248
    v_exp_f32 v211, v211
    s_waitcnt lgkmcnt(10)
    v_mfma_f32_16x16x32_bf16 v[236:239], a[144:147], a[232:235], 0
    v_cvt_pk_bf16_f32 v185, v208, v209
    v_cvt_pk_bf16_f32 v188, v210, v211
    v_mfma_f32_16x16x32_bf16 v[228:231], a[168:171], a[232:235], 0
    ds_read_b128 v[208:211], v245 offset:128
    v_sub_f32 v196, v196, v248
    v_mfma_f32_16x16x32_bf16 v[212:215], v[0:3], v[184:187], 0
    s_waitcnt lgkmcnt(10)
    v_exp_f32 v196, v196
    v_mfma_f32_16x16x32_bf16 v[216:219], v[30:33], v[184:187], 0
    v_sub_f32 v197, v197, v248
    v_sub_f32 v198, v198, v248
    v_mfma_f32_16x16x32_bf16 v[220:223], v[60:63], v[184:187], 0
    v_exp_f32 v197, v197
    v_mfma_f32_16x16x32_bf16 v[224:227], a[248:251], v[184:187], 0
    v_exp_f32 v198, v198
    v_mfma_f32_16x16x32_bf16 v[236:239], a[148:151], a[236:239], v[236:239]
    s_waitcnt lgkmcnt(9)
    v_sub_f32 v199, v199, v248
    v_cvt_pk_bf16_f32 v190, v196, v197
    v_mfma_f32_16x16x32_bf16 v[236:239], a[152:155], a[240:243], v[236:239]
    s_waitcnt lgkmcnt(8)
    v_exp_f32 v199, v199
    v_mfma_f32_16x16x32_bf16 v[236:239], a[156:159], a[244:247], v[236:239]
    s_waitcnt lgkmcnt(2)
    v_cvt_pk_bf16_f32 v193, v198, v199
    v_sub_f32 v200, v200, v248
    v_mfma_f32_16x16x32_bf16 v[236:239], a[160:163], a[216:219], v[236:239]
    ds_read_b128 v[196:199], v244 offset:192
    v_sub_f32 v201, v201, v248
    v_mfma_f32_16x16x32_bf16 v[236:239], a[164:167], a[220:223], v[236:239]
    buffer_store_dwordx4 a[252:255], v250, s[20:23], s51 offen nt
    v_mfma_f32_16x16x32_bf16 v[228:231], a[172:175], a[236:239], v[228:231]
    s_waitcnt lgkmcnt(1)
    ds_read_b128 a[252:255], v252 offset:6144
    v_mfma_f32_16x16x32_bf16 v[204:207], v[138:141], v[168:171], v[204:207]
    v_exp_f32 v200, v200
    v_mfma_f32_16x16x32_bf16 v[204:207], v[140:143], v[170:173], v[204:207]
    buffer_store_dwordx2 v[254:255], v251, s[20:23], s51 offen offset:256 nt
    v_mfma_f32_16x16x32_bf16 v[208:211], v[144:147], v[168:171], v[208:211]
    ds_read_b64 v[254:255], v253 offset:6400
    v_cvt_pk_bf16_f32 v236, v236, v237
    v_mfma_f32_16x16x32_bf16 v[208:211], v[146:149], v[170:173], v[208:211]
    s_mul_i32 s51, s31, 3
    v_cvt_pk_bf16_f32 v237, v238, v239
    s_add_u32 s57, s57, s51
    v_mfma_f32_16x16x32_bf16 v[228:231], a[176:179], a[240:243], v[228:231]
    ds_write_b64 v249, v[236:237] offset:18432
    v_mfma_f32_16x16x32_bf16 v[228:231], a[180:183], a[244:247], v[228:231]
    s_add_u32 s57, s57, s32
    s_and_b32 s51, s28, 1
    s_add_u32 s51, s51, 15
    v_mfma_f32_16x16x32_bf16 v[228:231], a[184:187], a[216:219], v[228:231]
    s_mul_i32 s51, s51, s30
    v_exp_f32 v201, v201
    v_mfma_f32_16x16x32_bf16 v[228:231], a[188:191], a[220:223], v[228:231]
    s_waitcnt lgkmcnt(2)
    v_sub_f32 v202, v202, v248
    v_sub_f32 v203, v203, v248
    v_mfma_f32_16x16x32_bf16 v[196:199], v[114:117], v[168:171], v[196:199]
    s_mov_b32 exec_hi, 0
    buffer_store_dwordx4 a[252:255], v250, s[20:23], s53 offen nt
    s_mov_b32 exec_hi, -1
    v_mfma_f32_16x16x32_bf16 v[196:199], v[116:119], v[170:173], v[196:199]
    v_exp_f32 v202, v202
    v_mfma_f32_16x16x32_bf16 v[232:235], a[192:195], a[232:235], 0
    ds_read_b128 a[232:235], v242 offset:36992
    v_cvt_pk_bf16_f32 v228, v228, v229
    v_mfma_f32_16x16x32_bf16 v[232:235], a[196:199], a[236:239], v[232:235]
    ds_read_b128 a[236:239], v243 offset:36992
    v_cvt_pk_bf16_f32 v229, v230, v231
    v_mfma_f32_16x16x32_bf16 v[232:235], a[200:203], a[240:243], v[232:235]
    ds_write_b64 v249, v[228:229] offset:18560
    v_mfma_f32_16x16x32_bf16 v[232:235], a[204:207], a[244:247], v[232:235]
    ds_read_b128 a[240:243], v242 offset:37120
    ds_read_b128 a[244:247], v243 offset:37120
    v_mfma_f32_16x16x32_bf16 v[232:235], a[208:211], a[216:219], v[232:235]
    ds_read_b128 a[216:219], v242 offset:43008
    s_waitcnt lgkmcnt(7)
    v_mfma_f32_16x16x32_bf16 v[232:235], a[212:215], a[220:223], v[232:235]
    ds_read_b128 a[220:223], v243 offset:43008
    s_mov_b32 exec_hi, 0
    buffer_store_dwordx2 v[254:255], v251, s[20:23], s53 offen offset:256 nt
    s_mov_b32 exec_hi, -1
    s_mul_i32 s53, s31, 7
    s_add_u32 s52, s52, s53
    s_add_u32 s52, s52, s32
    s_lshr_b32 s53, s28, 1
    s_sub_u32 s53, s53, 1
    v_exp_f32 v203, v203
    v_cvt_pk_bf16_f32 v232, v232, v233
    v_cvt_pk_bf16_f32 v233, v234, v235
    ds_write_b64 v249, v[232:233] offset:18688
    s_mov_b32 exec_lo, 0
    buffer_store_dwordx4 a[252:255], v250, s[20:23], s55 offen nt
    s_mov_b32 exec_lo, -1
    v_cvt_pk_bf16_f32 v191, v200, v201
    v_cvt_pk_bf16_f32 v194, v202, v203
    ds_read_b128 v[200:203], v245 offset:192
    v_mfma_f32_16x16x32_bf16 v[212:215], v[4:7], v[188:191], v[212:215]
    ds_read_b128 a[252:255], v252 offset:12288
    v_sub_f32 v204, v204, v248
    v_mfma_f32_16x16x32_bf16 v[216:219], v[34:37], v[188:191], v[216:219]
    s_mov_b32 exec_lo, 0
    buffer_store_dwordx2 v[254:255], v251, s[20:23], s55 offen offset:256 nt
    s_mov_b32 exec_lo, -1
    v_mfma_f32_16x16x32_bf16 v[220:223], v[64:67], v[188:191], v[220:223]
    ds_read_b64 v[254:255], v253 offset:12544
    s_mul_i32 s55, s31, 11
    v_mfma_f32_16x16x32_bf16 v[224:227], a[248:251], v[188:191], v[224:227]
    s_add_u32 s54, s54, s55
    s_add_u32 s54, s54, s32
    s_lshr_b32 s55, s28, 1
    v_mfma_f32_16x16x32_bf16 v[212:215], v[8:11], v[192:195], v[212:215]
    s_lshl2_add_u32 s55, s55, 11
    s_mul_i32 s55, s55, s31
    v_sub_f32 v205, v205, v248
    v_mfma_f32_16x16x32_bf16 v[216:219], v[38:41], v[192:195], v[216:219]
    v_exp_f32 v204, v204
    v_mfma_f32_16x16x32_bf16 v[220:223], v[68:71], v[192:195], v[220:223]
    v_exp_f32 v205, v205
    v_mfma_f32_16x16x32_bf16 v[224:227], a[248:251], v[192:195], v[224:227]
    v_sub_f32 v206, v206, v248
    s_waitcnt lgkmcnt(2)
    v_mfma_f32_16x16x32_bf16 v[200:203], v[150:153], v[168:171], v[200:203]
    v_exp_f32 v206, v206
    v_mfma_f32_16x16x32_bf16 v[200:203], v[152:155], v[170:173], v[200:203]
    s_waitcnt lgkmcnt(1)
    buffer_store_dwordx4 a[252:255], v250, s[20:23], s57 offen nt
    s_waitcnt lgkmcnt(0)
    v_sub_f32 v207, v207, v248
    v_exp_f32 v207, v207
    v_cvt_pk_bf16_f32 v180, v204, v205
    v_cvt_pk_bf16_f32 v183, v206, v207
    v_sub_f32 v208, v208, v248
    v_exp_f32 v208, v208
    buffer_store_dwordx2 v[254:255], v251, s[20:23], s57 offen offset:256 nt
    s_mul_i32 s57, s31, 15
    s_add_u32 s56, s56, s57
    s_add_u32 s56, s56, s32
    v_sub_f32 v209, v209, v248
    v_exp_f32 v209, v209
    v_sub_f32 v210, v210, v248
    v_exp_f32 v210, v210
    v_sub_f32 v211, v211, v248
    v_exp_f32 v211, v211
    v_cvt_pk_bf16_f32 v181, v208, v209
    v_cvt_pk_bf16_f32 v184, v210, v211
    v_sub_f32 v196, v196, v248
    v_mfma_f32_16x16x32_bf16 v[212:215], v[12:15], v[180:183], v[212:215]
    v_exp_f32 v196, v196
    v_mfma_f32_16x16x32_bf16 v[216:219], v[42:45], v[180:183], v[216:219]
    v_sub_f32 v197, v197, v248
    v_sub_f32 v200, v200, v248
    v_mfma_f32_16x16x32_bf16 v[220:223], v[72:75], v[180:183], v[220:223]
    v_exp_f32 v197, v197
    v_mfma_f32_16x16x32_bf16 v[224:227], a[248:251], v[180:183], v[224:227]
    v_cvt_pk_bf16_f32 v186, v196, v197
    v_exp_f32 v200, v200
    v_sub_f32 v201, v201, v248
    v_exp_f32 v201, v201
    v_mov_b32 v185, 0
    v_cvt_pk_bf16_f32 v187, v200, v201
    v_add_u32 v204, 0xffffff40, v244
    v_cndmask_b32 v244, v244, v204, vcc
    v_mfma_f32_16x16x32_bf16 v[212:215], v[16:19], v[184:187], v[212:215]
    ds_read_b128 v[196:199], v244 offset:64
    v_add_u32 v205, 0xffffff40, v245
    v_mfma_f32_16x16x32_bf16 v[216:219], v[46:49], v[184:187], v[216:219]
    s_mov_b32 vcc_lo, 0xff00ff
    s_mov_b32 vcc_hi, 0xf000ff
    v_cndmask_b32 v245, v245, v205, vcc
    v_mfma_f32_16x16x32_bf16 v[220:223], v[76:79], v[184:187], v[220:223]
    ds_read_b128 v[204:207], v244 offset:0
    ds_read_b128 v[208:211], v245 offset:0
    v_mfma_f32_16x16x32_bf16 v[224:227], a[248:251], v[184:187], v[224:227]
    ds_read_b128 v[200:203], v245 offset:64
    v_mov_b32 v190, 0
    v_mov_b32 v193, 0
    v_mov_b32 v180, 0
    v_mov_b32 v183, 0
    v_mov_b32 v186, 0
    s_nop 1
    v_rcp_f32 v225, v224
    s_nop 0
    v_mul_f32 v212, v212, v225
    v_mul_f32 v213, v213, v225
    v_mul_f32 v214, v214, v225
    v_mul_f32 v215, v215, v225
    v_cvt_pk_bf16_f32 v212, v212, v213
    v_cvt_pk_bf16_f32 v213, v214, v215
    ds_write_b64 v247, v[212:213] offset:49152
    s_waitcnt lgkmcnt(4)
    v_mfma_f32_16x16x32_bf16 v[196:199], v[114:117], v[174:177], v[196:199]
    v_mul_f32 v216, v216, v225
    v_mul_f32 v217, v217, v225
    v_mfma_f32_16x16x32_bf16 v[196:199], v[116:119], v[176:179], v[196:199]
    s_waitcnt lgkmcnt(3)
    v_mul_f32 v218, v218, v225
    v_mul_f32 v219, v219, v225
    v_mfma_f32_16x16x32_bf16 v[204:207], v[138:141], v[174:177], v[204:207]
    s_waitcnt lgkmcnt(2)
    v_cvt_pk_bf16_f32 v216, v216, v217
    v_cvt_pk_bf16_f32 v217, v218, v219
    v_mfma_f32_16x16x32_bf16 v[204:207], v[140:143], v[176:179], v[204:207]
    ds_write_b64 v247, v[216:217] offset:49280
    v_mfma_f32_16x16x32_bf16 v[208:211], v[144:147], v[174:177], v[208:211]
    s_waitcnt lgkmcnt(2)
    v_mul_f32 v220, v220, v225
    v_mul_f32 v221, v221, v225
    v_mfma_f32_16x16x32_bf16 v[208:211], v[146:149], v[176:179], v[208:211]
    v_mul_f32 v222, v222, v225
    v_mul_f32 v223, v223, v225
    v_mfma_f32_16x16x32_bf16 v[200:203], v[150:153], v[174:177], v[200:203]
    v_cvt_pk_bf16_f32 v220, v220, v221
    v_cvt_pk_bf16_f32 v221, v222, v223
    v_mfma_f32_16x16x32_bf16 v[200:203], v[152:155], v[176:179], v[200:203]
    ds_write_b64 v247, v[220:221] offset:49408
    v_mfma_f32_16x16x32_bf16 v[236:239], a[144:147], a[224:227], 0
    v_max_f32 v248, v204, v205
    v_max3_f32 v248, v248, v206, v207
    v_mfma_f32_16x16x32_bf16 v[236:239], a[148:151], a[228:231], v[236:239]
    ds_read_b128 v[204:207], v244 offset:128
    v_max3_f32 v248, v248, v208, v209
    v_mfma_f32_16x16x32_bf16 v[236:239], a[152:155], a[232:235], v[236:239]
    v_max3_f32 v248, v248, v210, v211
    v_max3_f32 v248, v248, v196, v197
    v_mfma_f32_16x16x32_bf16 v[236:239], a[156:159], a[236:239], v[236:239]
    ds_read_b128 v[208:211], v245 offset:128
    v_max3_f32 v248, v248, v198, v199
    v_mfma_f32_16x16x32_bf16 v[236:239], a[160:163], a[240:243], v[236:239]
    ds_read_b128 v[196:199], v244 offset:0
    v_max3_f32 v248, v248, v200, v201
    v_mfma_f32_16x16x32_bf16 v[236:239], a[164:167], a[244:247], v[236:239]
    v_max3_f32 v248, v248, v202, v203
    v_mfma_f32_16x16x32_bf16 v[228:231], a[168:171], a[224:227], 0
    ds_read_b128 v[200:203], v245 offset:0
    v_mfma_f32_16x16x32_bf16 v[228:231], a[172:175], a[228:231], v[228:231]
    v_mfma_f32_16x16x32_bf16 v[228:231], a[176:179], a[232:235], v[228:231]
    v_mfma_f32_16x16x32_bf16 v[228:231], a[180:183], a[236:239], v[228:231]
    v_mfma_f32_16x16x32_bf16 v[228:231], a[184:187], a[240:243], v[228:231]
    s_waitcnt lgkmcnt(3)
    v_cvt_pk_bf16_f32 v236, v236, v237
    v_cvt_pk_bf16_f32 v237, v238, v239
    v_mfma_f32_16x16x32_bf16 v[204:207], v[120:123], v[174:177], v[204:207]
    ds_write_b64 v249, v[236:237] offset:24576
    v_mfma_f32_16x16x32_bf16 v[204:207], v[122:125], v[176:179], v[204:207]
    s_waitcnt lgkmcnt(2)
    v_mfma_f32_16x16x32_bf16 v[208:211], v[156:159], v[174:177], v[208:211]
    v_mfma_f32_16x16x32_bf16 v[208:211], v[158:161], v[176:179], v[208:211]
    s_waitcnt lgkmcnt(1)
    v_mfma_f32_16x16x32_bf16 v[196:199], v[138:141], v[174:177], v[196:199]
    v_mfma_f32_16x16x32_bf16 v[196:199], v[140:143], v[176:179], v[196:199]
    v_mfma_f32_16x16x32_bf16 v[200:203], v[144:147], v[174:177], v[200:203]
    v_mfma_f32_16x16x32_bf16 v[200:203], v[146:149], v[176:179], v[200:203]
    v_max3_f32 v248, v248, v204, v205
    v_max3_f32 v248, v248, v206, v207
    v_mfma_f32_16x16x32_bf16 v[228:231], a[188:191], a[244:247], v[228:231]
    ds_read_b128 v[204:207], v244 offset:64
    v_max3_f32 v248, v248, v208, v209
    v_mfma_f32_16x16x32_bf16 v[232:235], a[192:195], a[224:227], 0
    ds_read_b128 a[224:227], v242 offset:43136
    v_max3_f32 v248, v248, v210, v211
    v_mfma_f32_16x16x32_bf16 v[232:235], a[196:199], a[228:231], v[232:235]
    ds_read_b128 a[228:231], v243 offset:43136
    ds_read_b128 v[208:211], v245 offset:64
    v_mfma_f32_16x16x32_bf16 v[232:235], a[200:203], a[232:235], v[232:235]
    ds_read_b128 a[232:235], v242 offset:43264
    v_cvt_pk_bf16_f32 v228, v228, v229
    v_mfma_f32_16x16x32_bf16 v[232:235], a[204:207], a[236:239], v[232:235]
    ds_read_b128 a[236:239], v243 offset:43264
    v_cvt_pk_bf16_f32 v229, v230, v231
    v_mfma_f32_16x16x32_bf16 v[232:235], a[208:211], a[240:243], v[232:235]
    ds_write_b64 v249, v[228:229] offset:24704
    v_mfma_f32_16x16x32_bf16 v[232:235], a[212:215], a[244:247], v[232:235]
    v_mov_b32 v225, v248
    v_mfma_f32_16x16x32_bf16 v[236:239], a[144:147], a[216:219], 0
    v_mfma_f32_16x16x32_bf16 v[236:239], a[148:151], a[220:223], v[236:239]
    s_waitcnt lgkmcnt(6)
    v_permlane16_swap_b32 v248, v225
    v_max_f32 v248, v248, v225
    v_mfma_f32_16x16x32_bf16 v[204:207], v[114:117], v[174:177], v[204:207]
    s_waitcnt lgkmcnt(5)
    v_cvt_pk_bf16_f32 v232, v232, v233
    v_cvt_pk_bf16_f32 v233, v234, v235
    v_mfma_f32_16x16x32_bf16 v[204:207], v[116:119], v[176:179], v[204:207]
    ds_write_b64 v249, v[232:233] offset:24832
    v_mfma_f32_16x16x32_bf16 v[236:239], a[152:155], a[224:227], v[236:239]
    s_waitcnt lgkmcnt(4)
    v_mov_b32 v225, v248
    v_mfma_f32_16x16x32_bf16 v[208:211], v[150:153], v[174:177], v[208:211]
    v_mfma_f32_16x16x32_bf16 v[208:211], v[152:155], v[176:179], v[208:211]
    v_permlane32_swap_b32 v248, v225
    v_max_f32 v248, v248, v225
    v_mfma_f32_16x16x32_bf16 v[236:239], a[156:159], a[228:231], v[236:239]
    s_waitcnt lgkmcnt(3)
    v_sub_f32 v196, v196, v248
    v_sub_f32 v197, v197, v248
    v_mfma_f32_16x16x32_bf16 v[236:239], a[160:163], a[232:235], v[236:239]
    s_waitcnt lgkmcnt(2)
    v_exp_f32 v196, v196
    v_mfma_f32_16x16x32_bf16 v[236:239], a[164:167], a[236:239], v[236:239]
    v_exp_f32 v197, v197
    v_mfma_f32_16x16x32_bf16 v[228:231], a[168:171], a[216:219], 0
    v_sub_f32 v198, v198, v248
    v_sub_f32 v199, v199, v248
    v_mfma_f32_16x16x32_bf16 v[228:231], a[172:175], a[220:223], v[228:231]
    s_waitcnt lgkmcnt(0)
    s_barrier
    v_cvt_pk_bf16_f32 v188, v196, v197
    v_mfma_f32_16x16x32_bf16 v[228:231], a[176:179], a[224:227], v[228:231]
    ds_read_b128 a[240:243], v242 offset:49152
    v_cvt_pk_bf16_f32 v236, v236, v237
    v_mfma_f32_16x16x32_bf16 v[228:231], a[180:183], a[228:231], v[228:231]
    ds_read_b128 a[244:247], v243 offset:49152
    v_cvt_pk_bf16_f32 v237, v238, v239
    v_mfma_f32_16x16x32_bf16 v[228:231], a[184:187], a[232:235], v[228:231]
    ds_write_b64 v249, v[236:237] offset:0
    v_mfma_f32_16x16x32_bf16 v[228:231], a[188:191], a[236:239], v[228:231]
    ds_read_b128 a[252:255], v252 offset:18432
    ds_read_b64 v[254:255], v253 offset:18688
    v_mfma_f32_16x16x32_bf16 v[232:235], a[192:195], a[216:219], 0
    ds_read_b128 a[216:219], v242 offset:49280
    v_sub_f32 v200, v200, v248
    v_mfma_f32_16x16x32_bf16 v[232:235], a[196:199], a[220:223], v[232:235]
    ds_read_b128 a[220:223], v243 offset:49280
    v_sub_f32 v201, v201, v248
    v_mfma_f32_16x16x32_bf16 v[232:235], a[200:203], a[224:227], v[232:235]
    ds_read_b128 a[224:227], v242 offset:49408
    v_cvt_pk_bf16_f32 v228, v228, v229
    v_mfma_f32_16x16x32_bf16 v[232:235], a[204:207], a[228:231], v[232:235]
    ds_read_b128 a[228:231], v243 offset:49408
    v_cvt_pk_bf16_f32 v229, v230, v231
    v_mfma_f32_16x16x32_bf16 v[232:235], a[208:211], a[232:235], v[232:235]
    ds_write_b64 v249, v[228:229] offset:128
    v_mfma_f32_16x16x32_bf16 v[232:235], a[212:215], a[236:239], v[232:235]
    s_waitcnt lgkmcnt(9)
    v_exp_f32 v198, v198
    v_mfma_f32_16x16x32_bf16 v[236:239], a[144:147], a[240:243], 0
    s_waitcnt lgkmcnt(8)
    v_exp_f32 v199, v199
    v_mfma_f32_16x16x32_bf16 v[236:239], a[148:151], a[244:247], v[236:239]
    v_cvt_pk_bf16_f32 v191, v198, v199
    s_waitcnt lgkmcnt(6)
    v_mfma_f32_16x16x32_bf16 v[228:231], a[168:171], a[240:243], 0
    ds_read_b128 v[196:199], v244 offset:128
    v_cvt_pk_bf16_f32 v232, v232, v233
    v_mfma_f32_16x16x32_bf16 v[228:231], a[172:175], a[244:247], v[228:231]
    s_waitcnt lgkmcnt(5)
    v_cvt_pk_bf16_f32 v233, v234, v235
    v_sub_f32 v202, v202, v248
    v_mfma_f32_16x16x32_bf16 v[236:239], a[152:155], a[216:219], v[236:239]
    ds_write_b64 v249, v[232:233] offset:256
    v_mfma_f32_16x16x32_bf16 v[228:231], a[176:179], a[216:219], v[228:231]
    buffer_store_dwordx4 a[252:255], v250, s[20:23], s52 offen nt
    v_mfma_f32_16x16x32_bf16 v[232:235], a[192:195], a[240:243], 0
    s_waitcnt lgkmcnt(5)
    ds_read_b128 a[252:255], v252 offset:24576
    v_mfma_f32_16x16x32_bf16 v[236:239], a[156:159], a[220:223], v[236:239]
    s_waitcnt lgkmcnt(5)
    v_exp_f32 v200, v200
    v_mfma_f32_16x16x32_bf16 v[236:239], a[160:163], a[224:227], v[236:239]
    buffer_store_dwordx2 v[254:255], v251, s[20:23], s52 offen offset:256 nt
    v_mfma_f32_16x16x32_bf16 v[228:231], a[180:183], a[220:223], v[228:231]
    ds_read_b64 v[254:255], v253 offset:24832
    s_lshr_b32 s52, s28, 1
    v_mfma_f32_16x16x32_bf16 v[228:231], a[184:187], a[224:227], v[228:231]
    s_lshl2_add_u32 s52, s52, 3
    s_mul_i32 s52, s52, s31
    s_add_u32 s51, s51, s52
    v_mfma_f32_16x16x32_bf16 v[232:235], a[196:199], a[244:247], v[232:235]
    s_add_u32 s51, s51, s32
    v_exp_f32 v201, v201
    v_mfma_f32_16x16x32_bf16 v[232:235], a[200:203], a[216:219], v[232:235]
    s_waitcnt lgkmcnt(3)
    v_exp_f32 v202, v202
    v_mfma_f32_16x16x32_bf16 v[196:199], v[120:123], v[174:177], v[196:199]
    v_sub_f32 v203, v203, v248
    v_cvt_pk_bf16_f32 v189, v200, v201
    v_mfma_f32_16x16x32_bf16 v[196:199], v[122:125], v[176:179], v[196:199]
    v_exp_f32 v203, v203
    v_mfma_f32_16x16x32_bf16 v[212:215], v[12:15], v[188:191], 0
    s_waitcnt lgkmcnt(1)
    v_cvt_pk_bf16_f32 v192, v202, v203
    v_sub_f32 v204, v204, v248
    v_mfma_f32_16x16x32_bf16 v[216:219], v[42:45], v[188:191], 0
    ds_read_b128 v[200:203], v245 offset:128
    v_sub_f32 v205, v205, v248
    v_mfma_f32_16x16x32_bf16 v[220:223], v[72:75], v[188:191], 0
    buffer_store_dwordx4 a[252:255], v250, s[20:23], s54 offen nt
    v_mfma_f32_16x16x32_bf16 v[224:227], a[248:251], v[188:191], 0
    s_waitcnt lgkmcnt(1)
    v_exp_f32 v204, v204
    v_mfma_f32_16x16x32_bf16 v[236:239], a[164:167], a[228:231], v[236:239]
    v_exp_f32 v205, v205
    v_mfma_f32_16x16x32_bf16 v[228:231], a[188:191], a[228:231], v[228:231]
    buffer_store_dwordx2 v[254:255], v251, s[20:23], s54 offen offset:256 nt
    v_mfma_f32_16x16x32_bf16 v[232:235], a[204:207], a[220:223], v[232:235]
    s_and_b32 s54, s28, 1
    s_add_u32 s54, s54, 15
    s_mul_i32 s54, s54, s30
    v_mfma_f32_16x16x32_bf16 v[232:235], a[208:211], a[224:227], v[232:235]
    s_add_u32 s54, s54, s55
    v_cvt_pk_bf16_f32 v236, v236, v237
    v_cvt_pk_bf16_f32 v237, v238, v239
    v_mfma_f32_16x16x32_bf16 v[232:235], a[212:215], a[228:231], v[232:235]
    ds_write_b64 v249, v[236:237] offset:6144
    s_waitcnt lgkmcnt(1)
    v_mfma_f32_16x16x32_bf16 v[200:203], v[156:159], v[174:177], v[200:203]
    s_add_u32 s54, s54, s32
    v_cvt_pk_bf16_f32 v228, v228, v229
    v_cvt_pk_bf16_f32 v229, v230, v231
    v_mfma_f32_16x16x32_bf16 v[200:203], v[158:161], v[176:179], v[200:203]
    ds_write_b64 v249, v[228:229] offset:6272
    v_cvt_pk_bf16_f32 v232, v232, v233
    v_cvt_pk_bf16_f32 v233, v234, v235
    ds_write_b64 v249, v[232:233] offset:6400
    v_sub_f32 v206, v206, v248
    v_exp_f32 v206, v206
    v_sub_f32 v207, v207, v248
    v_exp_f32 v207, v207
    v_cvt_pk_bf16_f32 v194, v204, v205
    v_cvt_pk_bf16_f32 v181, v206, v207
    v_sub_f32 v208, v208, v248
    v_exp_f32 v208, v208
    v_sub_f32 v209, v209, v248
    v_exp_f32 v209, v209
    v_sub_f32 v210, v210, v248
    v_exp_f32 v210, v210
    v_sub_f32 v211, v211, v248
    v_exp_f32 v211, v211
    v_cvt_pk_bf16_f32 v195, v208, v209
    v_cvt_pk_bf16_f32 v182, v210, v211
    v_sub_f32 v196, v196, v248
    v_mfma_f32_16x16x32_bf16 v[212:215], v[16:19], v[192:195], v[212:215]
    v_exp_f32 v196, v196
    v_mfma_f32_16x16x32_bf16 v[216:219], v[46:49], v[192:195], v[216:219]
    v_sub_f32 v197, v197, v248
    v_sub_f32 v198, v198, v248
    v_mfma_f32_16x16x32_bf16 v[220:223], v[76:79], v[192:195], v[220:223]
    v_exp_f32 v197, v197
    v_mfma_f32_16x16x32_bf16 v[224:227], a[248:251], v[192:195], v[224:227]
    v_exp_f32 v198, v198
    v_mfma_f32_16x16x32_bf16 v[212:215], v[20:23], v[180:183], v[212:215]
    v_sub_f32 v199, v199, v248
    v_cvt_pk_bf16_f32 v184, v196, v197
    v_mfma_f32_16x16x32_bf16 v[216:219], v[50:53], v[180:183], v[216:219]
    v_exp_f32 v199, v199
    v_mfma_f32_16x16x32_bf16 v[220:223], v[80:83], v[180:183], v[220:223]
    v_cvt_pk_bf16_f32 v187, v198, v199
    v_sub_f32 v200, v200, v248
    v_mfma_f32_16x16x32_bf16 v[224:227], a[248:251], v[180:183], v[224:227]
    v_exp_f32 v200, v200
    v_sub_f32 v201, v201, v248
    v_exp_f32 v201, v201
    v_sub_f32 v202, v202, v248
    v_exp_f32 v202, v202
    v_sub_f32 v203, v203, v248
    v_exp_f32 v203, v203
    v_cvt_pk_bf16_f32 v185, v200, v201
    v_cvt_pk_bf16_f32 v188, v202, v203
    v_mov_b32 v189, 0
    v_mfma_f32_16x16x32_bf16 v[212:215], v[24:27], v[184:187], v[212:215]
    v_mov_b32 v191, 0
    v_mfma_f32_16x16x32_bf16 v[216:219], v[54:57], v[184:187], v[216:219]
    v_mfma_f32_16x16x32_bf16 v[220:223], v[84:87], v[184:187], v[220:223]
    v_mfma_f32_16x16x32_bf16 v[224:227], a[248:251], v[184:187], v[224:227]
    v_mfma_f32_16x16x32_bf16 v[212:215], v[28:31], v[188:191], v[212:215]
    v_mfma_f32_16x16x32_bf16 v[216:219], v[58:61], v[188:191], v[216:219]
    v_mfma_f32_16x16x32_bf16 v[220:223], v[88:91], v[188:191], v[220:223]
    v_mfma_f32_16x16x32_bf16 v[224:227], a[248:251], v[188:191], v[224:227]
    s_nop 7
    v_rcp_f32 v225, v224
    s_nop 0
    v_mul_f32 v212, v212, v225
    v_mul_f32 v213, v213, v225
    v_mul_f32 v214, v214, v225
    v_mul_f32 v215, v215, v225
    v_cvt_pk_bf16_f32 v212, v212, v213
    v_cvt_pk_bf16_f32 v213, v214, v215
    ds_write_b64 v247, v[212:213] offset:55296
    v_mul_f32 v216, v216, v225
    v_mul_f32 v217, v217, v225
    v_mul_f32 v218, v218, v225
    v_mul_f32 v219, v219, v225
    v_cvt_pk_bf16_f32 v216, v216, v217
    v_cvt_pk_bf16_f32 v217, v218, v219
    ds_write_b64 v247, v[216:217] offset:55424
    v_mul_f32 v220, v220, v225
    v_mul_f32 v221, v221, v225
    v_mul_f32 v222, v222, v225
    v_mul_f32 v223, v223, v225
    v_cvt_pk_bf16_f32 v220, v220, v221
    v_cvt_pk_bf16_f32 v221, v222, v223
    ds_write_b64 v247, v[220:221] offset:55552
    s_waitcnt lgkmcnt(0)
    s_barrier
    ds_read_b128 a[232:235], v242 offset:55296
    ds_read_b128 a[236:239], v243 offset:55296
    ds_read_b128 a[240:243], v242 offset:55424
    ds_read_b128 a[244:247], v243 offset:55424
    ds_read_b128 a[216:219], v242 offset:55552
    ds_read_b128 a[220:223], v243 offset:55552
    ds_read_b128 a[252:255], v252 offset:0
    ds_read_b64 v[254:255], v253 offset:256
    s_waitcnt lgkmcnt(7)
    v_mfma_f32_16x16x32_bf16 v[236:239], a[144:147], a[232:235], 0
    v_mfma_f32_16x16x32_bf16 v[228:231], a[168:171], a[232:235], 0
    s_waitcnt lgkmcnt(6)
    v_mfma_f32_16x16x32_bf16 v[236:239], a[148:151], a[236:239], v[236:239]
    s_waitcnt lgkmcnt(5)
    v_mfma_f32_16x16x32_bf16 v[236:239], a[152:155], a[240:243], v[236:239]
    s_waitcnt lgkmcnt(4)
    v_mfma_f32_16x16x32_bf16 v[236:239], a[156:159], a[244:247], v[236:239]
    s_waitcnt lgkmcnt(3)
    v_mfma_f32_16x16x32_bf16 v[236:239], a[160:163], a[216:219], v[236:239]
    s_waitcnt lgkmcnt(2)
    v_mfma_f32_16x16x32_bf16 v[236:239], a[164:167], a[220:223], v[236:239]
    s_waitcnt lgkmcnt(0)
    v_mfma_f32_16x16x32_bf16 v[228:231], a[172:175], a[236:239], v[228:231]
    s_mov_b32 exec_hi, 0
    buffer_store_dwordx4 a[252:255], v250, s[20:23], s56 offen nt
    s_mov_b32 exec_hi, -1
    v_mfma_f32_16x16x32_bf16 v[228:231], a[176:179], a[240:243], v[228:231]
    v_mfma_f32_16x16x32_bf16 v[228:231], a[180:183], a[244:247], v[228:231]
    ds_read_b128 a[252:255], v252 offset:6144
    v_mfma_f32_16x16x32_bf16 v[228:231], a[184:187], a[216:219], v[228:231]
    s_mov_b32 exec_hi, 0
    buffer_store_dwordx2 v[254:255], v251, s[20:23], s56 offen offset:256 nt
    s_mov_b32 exec_hi, -1
    v_mfma_f32_16x16x32_bf16 v[228:231], a[188:191], a[220:223], v[228:231]
    ds_read_b64 v[254:255], v253 offset:6400
    v_cvt_pk_bf16_f32 v236, v236, v237
    v_mfma_f32_16x16x32_bf16 v[232:235], a[192:195], a[232:235], 0
    v_cvt_pk_bf16_f32 v237, v238, v239
    v_mfma_f32_16x16x32_bf16 v[232:235], a[196:199], a[236:239], v[232:235]
    ds_write_b64 v249, v[236:237] offset:12288
    v_mfma_f32_16x16x32_bf16 v[232:235], a[200:203], a[240:243], v[232:235]
    v_mfma_f32_16x16x32_bf16 v[232:235], a[204:207], a[244:247], v[232:235]
    v_cvt_pk_bf16_f32 v228, v228, v229
    v_cvt_pk_bf16_f32 v229, v230, v231
    v_mfma_f32_16x16x32_bf16 v[232:235], a[208:211], a[216:219], v[232:235]
    ds_write_b64 v249, v[228:229] offset:12416
    v_mfma_f32_16x16x32_bf16 v[232:235], a[212:215], a[220:223], v[232:235]
    s_waitcnt lgkmcnt(3)
    buffer_store_dwordx4 a[252:255], v250, s[20:23], s51 offen nt
    s_waitcnt lgkmcnt(2)
    s_nop 4
    v_cvt_pk_bf16_f32 v232, v232, v233
    v_cvt_pk_bf16_f32 v233, v234, v235
    ds_write_b64 v249, v[232:233] offset:12544
    buffer_store_dwordx2 v[254:255], v251, s[20:23], s51 offen offset:256 nt
    s_waitcnt lgkmcnt(0)
    s_barrier
    ds_read_b128 a[252:255], v252 offset:12288
    ds_read_b64 v[254:255], v253 offset:12544
    s_waitcnt lgkmcnt(1)
    s_mov_b32 exec_hi, s53
    buffer_store_dwordx4 a[252:255], v250, s[20:23], s54 offen nt
    s_mov_b32 exec_hi, -1
    s_waitcnt lgkmcnt(0)
    s_mov_b32 exec_hi, s53
    buffer_store_dwordx2 v[254:255], v251, s[20:23], s54 offen offset:256 nt
    s_mov_b32 exec_hi, -1
    s_endpgm
.section .rodata,"a"
.p2align 6
.amdhsa_kernel standalone__neighborhood_dinat__vision_kernel
  .amdhsa_next_free_vgpr 512
  .amdhsa_next_free_sgpr 102
  .amdhsa_accum_offset 256
  .amdhsa_group_segment_fixed_size 0
  .amdhsa_kernarg_size 56
  .amdhsa_user_sgpr_count 2
  .amdhsa_user_sgpr_kernarg_segment_ptr 1
  .amdhsa_system_sgpr_workgroup_id_x 1
.end_amdhsa_kernel
```

```asm
; @launch grid=(256,1,1) block=(256,1,1) lds=163840
.amdgcn_target "amdgcn-amd-amdhsa--gfx950"
.text
.globl standalone__neighborhood_dinat__vision_kernel
.p2align 12
.p2align 8
.type standalone__neighborhood_dinat__vision_kernel,@function
standalone__neighborhood_dinat__vision_kernel:
    s_cmpk_ge_u32 s2, 0x100
    s_cbranch_scc1 L_exit
    s_load_dwordx2 s[4:5], s[0:1], 0
    s_load_dwordx2 s[8:9], s[0:1], 8
    s_load_dwordx2 s[12:13], s[0:1], 16
    s_load_dwordx2 s[16:17], s[0:1], 24
    s_load_dwordx2 s[20:21], s[0:1], 32
    s_getpc_b64 s[68:69]
    v_lshrrev_b32 v4, 6, v0
    s_bfe_u32 s65, s2, 0x30003
    v_readfirstlane_b32 s28, v4
    s_lshl_b32 s66, s65, 13
    v_lshl_add_u32 v0, v0, 5, s66
    global_load_dword v11, v0, s[68:69]
    s_lshr_b32 s66, s2, 6
    s_and_b32 s67, s2, 1
    s_lshl2_add_u32 s64, s67, s66
    s_mov_b32 s30, 0x2a000
    s_mul_i32 s66, s64, 14
    s_bitcmp1_b32 s64, 0
    s_cselect_b32 s67, 16, -3
    s_cselect_b32 s35, -1, 1
    s_add_u32 s66, s66, s67
    s_mul_i32 s32, s66, s30
    s_mul_i32 s40, s30, 0x6f
    s_mul_i32 s30, s30, s35
    s_mul_i32 s66, s65, 28
    s_cmp_eq_u32 s65, 7
    s_cselect_b32 s36, 1, 0
    s_cselect_b32 s67, 18, -6
    s_cselect_b32 s31, -3, 3
    s_add_u32 s66, s66, s67
    s_bfe_u32 s67, s2, 0x10001
    s_add_u32 s66, s66, s67
    s_bfe_u32 s67, s2, 0x10002
    s_mulk_i32 s67, 0xe0
    s_add_u32 s66, s66, s67
    s_mulk_i32 s66, 0x180
    s_lshl_b32 s67, s36, 11
    s_sub_u32 s66, s66, s67
    s_lshl_b32 s45, s31, 11
    s_lshl_b32 s31, s31, 8
    s_mul_i32 s67, s30, s28
    s_add_u32 s67, s67, s32
    s_add_u32 s32, s32, s66
    s_min_i32 s40, s40, s67
    s_max_i32 s40, s40, 0
    s_add_u32 s40, s40, s66
    s_add_u32 s67, s67, s66
    s_lshl2_add_u32 s41, s30, s67
    s_mul_i32 s46, s28, 0x1e00
    s_mul_i32 s29, s28, 0x3000
    s_add_u32 s29, s29, 0x16800
    s_mul_i32 s39, s28, 0x60
    s_mov_b32 s6, 0x1260000
    s_mov_b32 s7, 0x20000
    s_mov_b32 s10, 0x36000
    s_mov_b32 s11, 0x20000
    v_mbcnt_lo_u32_b32 v1, -1, 0
    v_mbcnt_hi_u32_b32 v1, -1, v1
    s_lshl_b32 s51, s28, 1
    s_add_u32 s50, s31, 0xfffffe80
    s_mul_i32 s52, s36, 0x1d00
    v_lshrrev_b32 v2, 3, v1
    v_and_b32 v3, 7, v1
    v_xor_b32 v3, s51, v3
    v_lshl_add_u32 v4, v2, 7, s52
    v_mul_u32_u24 v8, 11, v2
    v_bfe_u32 v9, v8, 6, 1
    v_lshrrev_b32 v8, 5, v8
    v_xor_b32 v9, v3, v9
    v_mad_i32_i24 v8, v8, s50, v4
    v_lshl_add_u32 v168, v9, 4, v8
    v_add_u32 v8, 8, v2
    v_mul_u32_u24 v8, 11, v8
    v_bfe_u32 v9, v8, 6, 1
    v_lshrrev_b32 v8, 5, v8
    v_xor_b32 v9, v3, v9
    v_mad_i32_i24 v8, v8, s50, v4
    v_lshl_add_u32 v169, v9, 4, v8
    v_add_u32 v8, 16, v2
    v_mul_u32_u24 v8, 11, v8
    v_bfe_u32 v9, v8, 6, 1
    v_lshrrev_b32 v8, 5, v8
    v_xor_b32 v9, v3, v9
    v_mad_i32_i24 v8, v8, s50, v4
    v_lshl_add_u32 v170, v9, 4, v8
    s_movk_i32 s53, 0x480
    s_movk_i32 s54, -96
    v_lshrrev_b32 v10, 1, v1
    v_lshlrev_b32 v12, 4, v1
    v_mul_u32_u24 v8, 43, v10
    v_lshrrev_b32 v9, 8, v8
    v_lshrrev_b32 v8, 7, v8
    v_and_b32 v9, 4, v9
    v_xor_b32 v9, v8, v9
    v_mad_i32_i24 v8, v8, s54, v12
    v_mad_u32_u24 v172, v9, s53, v8
    v_add_u32 v8, 32, v10
    v_mul_u32_u24 v8, 43, v8
    v_lshrrev_b32 v9, 8, v8
    v_lshrrev_b32 v8, 7, v8
    v_and_b32 v9, 4, v9
    v_xor_b32 v9, v8, v9
    v_mad_i32_i24 v8, v8, s54, v12
    v_mad_u32_u24 v173, v9, s53, v8
    v_add_u32 v8, 64, v10
    v_mul_u32_u24 v8, 43, v8
    v_lshrrev_b32 v9, 8, v8
    v_lshrrev_b32 v8, 7, v8
    v_and_b32 v9, 4, v9
    v_xor_b32 v9, v8, v9
    v_mad_i32_i24 v8, v8, s54, v12
    v_mad_u32_u24 v174, v9, s53, v8
    s_waitcnt lgkmcnt(0)
    s_add_u32 m0, s46, 0xc00
    s_add_u32 s59, s40, s45
    buffer_load_dwordx4 v168, s[4:7], s59 offen lds
    s_add_u32 m0, s29, 0
    s_add_u32 s60, s39, 0x180
    buffer_load_dwordx4 v172, s[8:11], s60 offen lds
    s_add_u32 m0, s46, 0xc00
    s_add_u32 s52, s40, 0
    buffer_load_dwordx4 v169, s[4:7], s59 offen offset:1024 lds
    s_add_u32 m0, s29, 0
    v_add_u32 v5, s52, v168
    buffer_load_dwordx4 v173, s[8:11], s60 offen offset:1024 lds
    s_add_u32 m0, s46, 0xc00
    v_max_i32 v5, 0, v5
    buffer_load_dwordx4 v170, s[4:7], s59 offen offset:2048 lds
    s_add_u32 m0, s29, 0
    s_add_u32 s53, s40, 0x400
    buffer_load_dwordx4 v174, s[8:11], s60 offen offset:2048 lds
    s_add_u32 m0, s46, 0
    v_add_u32 v6, s53, v169
    buffer_load_dwordx4 v5, s[4:7], 0 offen lds
    s_add_u32 m0, s46, 0x400
    v_max_i32 v6, 0, v6
    buffer_load_dwordx4 v6, s[4:7], 0 offen lds
    s_add_u32 s54, s40, 0x800
    s_add_u32 m0, s46, 0x800
    v_add_u32 v7, s54, v170
    v_max_i32 v7, 0, v7
    buffer_load_dwordx4 v7, s[4:7], 0 offen lds
    s_add_u32 m0, s29, 0xc00
    s_add_u32 s61, s39, 0x9180
    buffer_load_dwordx4 v172, s[8:11], s61 offen lds
    buffer_load_dwordx4 v173, s[8:11], s61 offen offset:1024 lds
    buffer_load_dwordx4 v174, s[8:11], s61 offen offset:2048 lds
    s_add_u32 m0, s29, 0x1800
    s_mov_b32 s33, 0
    s_add_u32 s66, s64, 1
    s_and_b32 s66, s66, 6
    s_cselect_b32 s33, 0, 3
    s_add_u32 s66, s65, 1
    s_and_b32 s66, s66, 6
    s_cselect_b32 s34, 0, 1
    s_cmp_lt_i32 s30, 0
    s_cselect_b32 s35, 1, 0
    s_cselect_b32 s49, -1, 1
    s_mul_i32 s49, s49, 0x1c0
    s_cselect_b32 s48, 0, 0x4e
    s_mul_i32 s66, s28, 0x152
    s_add_u32 s48, s48, s66
    s_lshl2_add_u32 s42, s30, s41
    s_lshl2_add_u32 s43, s30, s42
    s_lshl2_add_u32 s44, s30, s43
    s_mul_i32 s66, s36, 0x1400
    s_add_u32 s32, s32, s66
    s_mul_i32 s37, s28, 0x1180
    s_add_u32 s37, s37, 0x239c0
    s_mov_b32 s38, 0x3e553b95
    s_mov_b32 s3, 0x3dd53b95
    s_mov_b32 s14, 0x12000
    s_mov_b32 s15, 0x20000
    s_mov_b32 s18, 0x548
    s_mov_b32 s19, 0x20000
    s_mov_b32 s22, 0x1260000
    s_mov_b32 s23, 0x20000
    s_mov_b32 s26, 0x1000000
    s_mov_b32 s27, 0x20000
    s_add_u32 s62, s39, 0x12180
    s_add_u32 s63, s39, 0x1b180
    v_and_b32 v13, 15, v1
    v_lshrrev_b32 v14, 4, v1
    v_lshrrev_b32 v15, 2, v13
    v_and_b32 v17, 1, v14
    v_lshl_add_u32 v18, v14, 3, v15
    v_xor_b32 v19, 0, v17
    v_lshl_add_u32 v19, v19, 2, v18
    v_and_b32 v16, 3, v13
    v_mul_u32_u24 v19, 0x60, v19
    v_lshl_add_u32 v19, v16, 3, v19
    v_add_u32 v249, s29, v19
    v_xor_b32 v19, 1, v17
    v_lshl_add_u32 v19, v19, 2, v18
    v_mov_b32 v17, v15
    v_and_b32 v18, 3, v17
    v_lshlrev_b32 v18, 1, v18
    v_bfe_u32 v241, v16, 1, 1
    v_or_b32 v18, v18, v241
    v_mul_u32_u24 v17, 0x1e00, v17
    v_xor_b32 v18, v18, v14
    v_lshl_add_u32 v17, v18, 4, v17
    v_mul_u32_u24 v19, 0x60, v19
    v_mul_u32_u24 v18, 0x180, v16
    v_lshl_add_u32 v19, v16, 3, v19
    v_add_u32 v240, v17, v18
    v_add_u32 v250, s29, v19
    v_xor_b32 v241, 64, v240
    s_add_u32 s59, s41, s45
    s_add_u32 s60, s39, 0x24180
    s_add_u32 s61, s39, 0x2d180
    s_and_b32 s65, s48, 0xfff0
    s_lshr_b32 s55, s2, 3
    s_lshl2_add_u32 s55, s55, s28
    s_mul_i32 s55, s55, 0x240
    s_lshl1_add_u32 s58, s45, s40
    s_add_u32 s56, s28, 3
    s_mul_i32 s57, s31, 3
    s_mul_i32 s56, s56, s30
    s_add_u32 s56, s56, s57
    s_add_u32 s56, s56, s32
    s_add_u32 s51, s28, 3
    s_mul_i32 s52, s31, 7
    s_mul_i32 s51, s51, s30
    s_add_u32 s51, s51, s52
    s_add_u32 s51, s51, s32
    s_add_u32 s53, s28, 3
    s_mul_i32 s54, s31, 11
    s_mul_i32 s53, s53, s30
    s_add_u32 s53, s53, s54
    s_add_u32 s53, s53, s32
    s_add_u32 s57, s28, 7
    s_mul_i32 s57, s57, s30
    s_add_u32 s52, s28, 7
    s_mul_i32 s52, s52, s30
    s_add_u32 s54, s28, 3
    s_mul_i32 s54, s54, s30
    buffer_load_dwordx4 v172, s[8:11], s62 offen lds
    s_mov_b64 exec, 0
    s_cmp_eq_u32 s28, 0
    s_cbranch_scc1 L_h1
    s_cmp_eq_u32 s28, 1
    s_cbranch_scc1 L_h2
    s_cmp_eq_u32 s28, 2
    s_cbranch_scc1 L_h3
    s_branch L_h4
    L_hback:
    s_mov_b64 exec, -1
    buffer_load_dwordx4 v173, s[8:11], s62 offen offset:1024 lds
    buffer_load_dwordx4 v174, s[8:11], s62 offen offset:2048 lds
    s_add_u32 m0, s46, 0x7800
    s_add_u32 s62, s39, 0x300
    buffer_load_dwordx4 v168, s[4:7], s41 offen lds
    buffer_load_dwordx4 v169, s[4:7], s41 offen offset:1024 lds
    s_waitcnt vmcnt(12)
    s_barrier
    ds_read_b128 a[216:219], v240 offset:3072
    ds_read_b128 a[220:223], v240 offset:4608
    ds_read_b128 a[240:243], v241 offset:3072
    ds_read_b128 a[244:247], v241 offset:4608
    buffer_load_dwordx4 v170, s[4:7], s41 offen offset:2048 lds
    s_add_u32 m0, s29, 0x2400
    s_waitcnt vmcnt(12)
    ds_read_b64_tr_b16 a[0:1], v249 offset:0
    ds_read_b64_tr_b16 a[2:3], v250 offset:0
    ds_read_b64_tr_b16 a[24:25], v249 offset:32
    ds_read_b64_tr_b16 a[26:27], v250 offset:32
    ds_read_b64_tr_b16 a[48:49], v249 offset:64
    ds_read_b64_tr_b16 a[50:51], v250 offset:64
    buffer_load_dwordx4 v172, s[8:11], s63 offen lds
    buffer_load_dwordx4 v173, s[8:11], s63 offen offset:1024 lds
    s_waitcnt lgkmcnt(4)
    v_mfma_f32_16x16x32_bf16 v[180:183], a[0:3], a[216:219], 0
    v_mfma_f32_16x16x32_bf16 v[192:195], a[0:3], a[220:223], 0
    s_waitcnt lgkmcnt(2)
    v_mfma_f32_16x16x32_bf16 v[184:187], a[24:27], a[216:219], 0
    s_waitcnt lgkmcnt(0)
    v_mfma_f32_16x16x32_bf16 v[188:191], a[48:51], a[216:219], 0
    buffer_load_dwordx4 v174, s[8:11], s63 offen offset:2048 lds
    s_waitcnt vmcnt(12)
    v_mfma_f32_16x16x32_bf16 v[196:199], a[24:27], a[220:223], 0
    s_barrier
    s_add_u32 m0, s46, 0x8400
    s_add_u32 s63, s39, 0x9300
    v_mfma_f32_16x16x32_bf16 v[200:203], a[48:51], a[220:223], 0
    ds_read_b128 a[224:227], v240 offset:0
    ds_read_b128 a[228:231], v240 offset:1536
    ds_read_b128 a[232:235], v241 offset:0
    ds_read_b128 a[236:239], v241 offset:1536
    ds_read_b128 a[216:219], v240 offset:128
    ds_read_b128 a[220:223], v240 offset:1664
    buffer_load_dwordx4 v168, s[4:7], s59 offen lds
    buffer_load_dwordx4 v169, s[4:7], s59 offen offset:1024 lds
    s_waitcnt lgkmcnt(5)
    v_mfma_f32_16x16x32_bf16 v[204:207], a[0:3], a[224:227], 0
    v_mfma_f32_16x16x32_bf16 v[208:211], a[24:27], a[224:227], 0
    s_waitcnt lgkmcnt(4)
    v_mfma_f32_16x16x32_bf16 v[212:215], a[48:51], a[224:227], 0
    ds_read_b128 a[224:227], v240 offset:3200
    s_waitcnt vmcnt(11)
    v_mfma_f32_16x16x32_bf16 v[216:219], a[0:3], a[228:231], 0
    ds_read_b64_tr_b16 a[4:5], v249 offset:3072
    ds_read_b64_tr_b16 a[6:7], v250 offset:3072
    v_mfma_f32_16x16x32_bf16 v[220:223], a[24:27], a[228:231], 0
    ds_read_b64_tr_b16 a[28:29], v249 offset:3104
    ds_read_b64_tr_b16 a[30:31], v250 offset:3104
    v_mfma_f32_16x16x32_bf16 v[224:227], a[48:51], a[228:231], 0
    ds_read_b64_tr_b16 a[52:53], v249 offset:3136
    ds_read_b64_tr_b16 a[54:55], v250 offset:3136
    buffer_load_dwordx4 v170, s[4:7], s59 offen offset:2048 lds
    s_add_u32 m0, s29, 0
    ds_read_b128 a[228:231], v240 offset:4736
    s_add_u32 s59, s42, s45
    buffer_load_dwordx4 v172, s[8:11], s60 offen lds
    s_waitcnt lgkmcnt(5)
    v_mfma_f32_16x16x32_bf16 v[204:207], a[4:7], a[232:235], v[204:207]
    v_mfma_f32_16x16x32_bf16 v[216:219], a[4:7], a[236:239], v[216:219]
    s_waitcnt lgkmcnt(3)
    v_mfma_f32_16x16x32_bf16 v[208:211], a[28:31], a[232:235], v[208:211]
    s_waitcnt lgkmcnt(1)
    buffer_load_dwordx4 v173, s[8:11], s60 offen offset:1024 lds
    v_mfma_f32_16x16x32_bf16 v[212:215], a[52:55], a[232:235], v[212:215]
    v_mfma_f32_16x16x32_bf16 v[220:223], a[28:31], a[236:239], v[220:223]
    s_waitcnt vmcnt(11)
    ds_read_b64_tr_b16 a[8:9], v249 offset:6144
    v_mfma_f32_16x16x32_bf16 v[224:227], a[52:55], a[236:239], v[224:227]
    ds_read_b64_tr_b16 a[10:11], v250 offset:6144
    ds_read_b64_tr_b16 a[32:33], v249 offset:6176
    v_mfma_f32_16x16x32_bf16 v[180:183], a[4:7], a[240:243], v[180:183]
    ds_read_b64_tr_b16 a[34:35], v250 offset:6176
    ds_read_b64_tr_b16 a[56:57], v249 offset:6208
    v_mfma_f32_16x16x32_bf16 v[184:187], a[28:31], a[240:243], v[184:187]
    ds_read_b64_tr_b16 a[58:59], v250 offset:6208
    buffer_load_dwordx4 v174, s[8:11], s60 offen offset:2048 lds
    v_mfma_f32_16x16x32_bf16 v[188:191], a[52:55], a[240:243], v[188:191]
    s_add_u32 m0, s29, 0xc00
    s_add_u32 s60, s39, 0x12300
    v_mfma_f32_16x16x32_bf16 v[192:195], a[4:7], a[244:247], v[192:195]
    v_mfma_f32_16x16x32_bf16 v[196:199], a[28:31], a[244:247], v[196:199]
    v_mfma_f32_16x16x32_bf16 v[200:203], a[52:55], a[244:247], v[200:203]
    buffer_load_dwordx4 v172, s[8:11], s61 offen lds
    s_waitcnt lgkmcnt(4)
    v_mfma_f32_16x16x32_bf16 v[204:207], a[8:11], a[216:219], v[204:207]
    v_mfma_f32_16x16x32_bf16 v[216:219], a[8:11], a[220:223], v[216:219]
    s_waitcnt lgkmcnt(2)
    v_mfma_f32_16x16x32_bf16 v[208:211], a[32:35], a[216:219], v[208:211]
    s_waitcnt lgkmcnt(0)
    buffer_load_dwordx4 v173, s[8:11], s61 offen offset:1024 lds
    v_mfma_f32_16x16x32_bf16 v[212:215], a[56:59], a[216:219], v[212:215]
    s_waitcnt vmcnt(11)
    s_barrier
    v_mfma_f32_16x16x32_bf16 v[220:223], a[32:35], a[220:223], v[220:223]
    ds_read_b128 a[232:235], v240 offset:30720
    ds_read_b128 a[236:239], v240 offset:32256
    v_mfma_f32_16x16x32_bf16 v[224:227], a[56:59], a[220:223], v[224:227]
    ds_read_b128 a[240:243], v241 offset:30720
    ds_read_b128 a[244:247], v241 offset:32256
    v_mfma_f32_16x16x32_bf16 v[180:183], a[8:11], a[224:227], v[180:183]
    ds_read_b128 a[216:219], v240 offset:30848
    buffer_load_dwordx4 v174, s[8:11], s61 offen offset:2048 lds
    v_mfma_f32_16x16x32_bf16 v[184:187], a[32:35], a[224:227], v[184:187]
    ds_read_b128 a[220:223], v240 offset:32384
    v_add_u32 v8, 4, v2
    v_mfma_f32_16x16x32_bf16 v[188:191], a[56:59], a[224:227], v[188:191]
    s_add_u32 m0, s37, 0xd80
    v_mul_u32_u24 v8, 11, v8
    v_bfe_u32 v9, v8, 6, 1
    v_mfma_f32_16x16x32_bf16 v[192:195], a[8:11], a[228:231], v[192:195]
    ds_read_b128 a[224:227], v241 offset:128
    v_lshrrev_b32 v8, 5, v8
    v_mfma_f32_16x16x32_bf16 v[196:199], a[32:35], a[228:231], v[196:199]
    buffer_load_dwordx4 v12, s[16:19], s65 offen lds
    v_xor_b32 v9, v3, v9
    v_mfma_f32_16x16x32_bf16 v[200:203], a[56:59], a[228:231], v[200:203]
    ds_read_b128 a[228:231], v241 offset:1664
    s_add_u32 m0, s29, 0x1800
    s_add_u32 s61, s39, 0x1b300
    s_waitcnt lgkmcnt(7)
    v_mfma_f32_16x16x32_bf16 v[228:231], a[0:3], a[232:235], 0
    s_add_u32 s50, s31, 0xfffffe80
    v_mad_i32_i24 v8, v8, s50, v4
    s_waitcnt lgkmcnt(6)
    v_mfma_f32_16x16x32_bf16 v[232:235], a[24:27], a[232:235], 0
    s_and_b32 s66, s28, 1
    v_lshl_add_u32 v171, v9, 4, v8
    v_add_u32 v17, 3, v15
    v_mfma_f32_16x16x32_bf16 v[236:239], a[48:51], a[232:235], 0
    buffer_load_dword v11, v12, s[12:15], s55 offen
    v_add_u32 v19, 3, v16
    v_mfma_f32_16x16x32_bf16 v[138:141], a[0:3], a[236:239], 0
    s_waitcnt lgkmcnt(5)
    v_and_b32 v18, 3, v17
    v_lshlrev_b32 v18, 1, v18
    v_mfma_f32_16x16x32_bf16 v[142:145], a[24:27], a[236:239], 0
    ds_read_b128 a[232:235], v241 offset:3200
    v_bfe_u32 v243, v19, 1, 1
    v_mfma_f32_16x16x32_bf16 v[146:149], a[48:51], a[236:239], 0
    ds_read_b128 a[236:239], v241 offset:4736
    v_or_b32 v18, v18, v243
    v_mfma_f32_16x16x32_bf16 v[228:231], a[4:7], a[240:243], v[228:231]
    s_waitcnt vmcnt(11) lgkmcnt(6)
    ds_read_b64_tr_b16 a[12:13], v249 offset:9216
    v_mfma_f32_16x16x32_bf16 v[232:235], a[28:31], a[240:243], v[232:235]
    ds_read_b64_tr_b16 a[14:15], v250 offset:9216
    ds_read_b64_tr_b16 a[36:37], v249 offset:9248
    v_mfma_f32_16x16x32_bf16 v[236:239], a[52:55], a[240:243], v[236:239]
    ds_read_b64_tr_b16 a[38:39], v250 offset:9248
    ds_read_b64_tr_b16 a[60:61], v249 offset:9280
    v_mfma_f32_16x16x32_bf16 v[138:141], a[4:7], a[244:247], v[138:141]
    ds_read_b64_tr_b16 a[62:63], v250 offset:9280
    s_waitcnt lgkmcnt(10)
    v_mfma_f32_16x16x32_bf16 v[142:145], a[28:31], a[244:247], v[142:145]
    buffer_load_dwordx4 v172, s[8:11], s62 offen lds
    v_mul_u32_u24 v17, 0x1e00, v17
    v_mfma_f32_16x16x32_bf16 v[146:149], a[52:55], a[244:247], v[146:149]
    ds_read_b128 a[240:243], v241 offset:30848
    v_xor_b32 v18, v18, v14
    v_mfma_f32_16x16x32_bf16 v[228:231], a[8:11], a[216:219], v[228:231]
    ds_read_b128 a[244:247], v241 offset:32384
    v_lshl_add_u32 v17, v18, 4, v17
    v_mfma_f32_16x16x32_bf16 v[232:235], a[32:35], a[216:219], v[232:235]
    s_lshl_b32 s66, s66, 2
    v_mul_u32_u24 v18, 0x180, v19
    v_add_u32 v242, v17, v18
    v_mfma_f32_16x16x32_bf16 v[236:239], a[56:59], a[216:219], v[236:239]
    buffer_load_dwordx4 v173, s[8:11], s62 offen offset:1024 lds
    v_mov_b32 v17, 0x3f803f80
    v_mfma_f32_16x16x32_bf16 v[138:141], a[8:11], a[220:223], v[138:141]
    s_waitcnt lgkmcnt(6)
    v_lshrrev_b32 v18, 1, v13
    v_accvgpr_write_b32 a248, v17
    v_mfma_f32_16x16x32_bf16 v[142:145], a[32:35], a[220:223], v[142:145]
    s_lshr_b32 s67, s28, 1
    s_waitcnt lgkmcnt(4)
    v_accvgpr_write_b32 a249, v17
    v_mfma_f32_16x16x32_bf16 v[146:149], a[56:59], a[220:223], v[146:149]
    s_lshl_b32 s67, s67, 3
    s_waitcnt lgkmcnt(2)
    v_accvgpr_write_b32 a250, v17
    v_mfma_f32_16x16x32_bf16 v[204:207], a[12:15], a[224:227], v[204:207]
    buffer_load_dwordx4 v174, s[8:11], s62 offen offset:2048 lds
    v_accvgpr_write_b32 a251, v17
    v_mfma_f32_16x16x32_bf16 v[208:211], a[36:39], a[224:227], v[208:211]
    s_add_u32 m0, s29, 0x2400
    v_xor_b32 v18, v14, v18
    v_xor_b32 v18, s66, v18
    v_mfma_f32_16x16x32_bf16 v[212:215], a[60:63], a[224:227], v[212:215]
    s_add_u32 s62, s39, 0x24300
    v_mul_u32_u24 v17, 0x180, v13
    v_lshl_add_u32 v17, v18, 4, v17
    v_mfma_f32_16x16x32_bf16 v[216:219], a[12:15], a[228:231], v[216:219]
    s_lshl_b32 s66, s36, 1
    v_add_u32 v17, s67, v17
    v_add_u32 v247, 0x7800, v17
    v_mfma_f32_16x16x32_bf16 v[220:223], a[36:39], a[228:231], v[220:223]
    buffer_load_dwordx4 v172, s[8:11], s63 offen lds
    v_add_u32 v251, 0x1e000, v17
    v_mfma_f32_16x16x32_bf16 v[224:227], a[60:63], a[228:231], v[224:227]
    s_waitcnt vmcnt(12)
    s_barrier
    v_sub_u32 v17, v14, v15
    v_mfma_f32_16x16x32_bf16 v[180:183], a[12:15], a[232:235], v[180:183]
    ds_read_b128 a[216:219], v240 offset:33792
    s_waitcnt lgkmcnt(2)
    v_mfma_f32_16x16x32_bf16 v[184:187], a[36:39], a[232:235], v[184:187]
    ds_read_b128 a[220:223], v240 offset:35328
    v_mul_i32_i24 v17, 0x1c0, v17
    v_mfma_f32_16x16x32_bf16 v[188:191], a[60:63], a[232:235], v[188:191]
    s_waitcnt lgkmcnt(2)
    v_lshlrev_b32 v18, 4, v16
    v_sub_u32 v17, v17, v18
    v_mfma_f32_16x16x32_bf16 v[192:195], a[12:15], a[236:239], v[192:195]
    ds_read_b128 a[224:227], v241 offset:33792
    v_max_u32 v18, s33, v15
    v_mfma_f32_16x16x32_bf16 v[196:199], a[36:39], a[236:239], v[196:199]
    buffer_load_dwordx4 v173, s[8:11], s63 offen offset:1024 lds
    v_sub_u32 v18, v14, v18
    v_mfma_f32_16x16x32_bf16 v[200:203], a[60:63], a[236:239], v[200:203]
    ds_read_b128 a[228:231], v241 offset:35328
    v_add_u32 v244, 0, v18
    v_mfma_f32_16x16x32_bf16 v[228:231], a[12:15], a[240:243], v[228:231]
    ds_read_b128 a[232:235], v240 offset:33920
    v_cmp_gt_u32 vcc, 7, v244
    v_mfma_f32_16x16x32_bf16 v[232:235], a[36:39], a[240:243], v[232:235]
    ds_read_b128 a[236:239], v240 offset:35456
    v_add_u32 v17, s37, v17
    v_mfma_f32_16x16x32_bf16 v[236:239], a[60:63], a[240:243], v[236:239]
    buffer_load_dwordx4 v174, s[8:11], s63 offen offset:2048 lds
    v_add_u32 v244, 0xfffdc870, v17
    v_mfma_f32_16x16x32_bf16 v[138:141], a[12:15], a[244:247], v[138:141]
    s_waitcnt lgkmcnt(5)
    v_cndmask_b32 v244, 0, v244, vcc
    v_add_u32 v245, 4, v18
    v_mfma_f32_16x16x32_bf16 v[142:145], a[36:39], a[244:247], v[142:145]
    ds_read_b128 a[240:243], v241 offset:33920
    v_cmp_gt_u32 vcc, 7, v245
    v_mfma_f32_16x16x32_bf16 v[146:149], a[60:63], a[244:247], v[146:149]
    ds_read_b128 a[244:247], v241 offset:35456
    v_add_u32 v245, 0xfffdcf70, v17
    v_mfma_f32_16x16x32_bf16 v[150:153], a[0:3], a[216:219], 0
    s_waitcnt lgkmcnt(6)
    v_cndmask_b32 v245, 0, v245, vcc
    v_add_u32 v246, 8, v18
    v_mfma_f32_16x16x32_bf16 v[154:157], a[24:27], a[216:219], 0
    s_add_u32 m0, s29, 0
    v_cmp_gt_u32 vcc, 7, v246
    v_add_u32 v246, 0xfffdd670, v17
    v_mfma_f32_16x16x32_bf16 v[158:161], a[48:51], a[216:219], 0
    ds_read_b128 a[216:219], v240 offset:256
    v_min_u32 v20, 55, v1
    v_mfma_f32_16x16x32_bf16 v[162:165], a[0:3], a[220:223], 0
    s_waitcnt lgkmcnt(6)
    v_cndmask_b32 v246, 0, v246, vcc
    v_lshrrev_b32 v21, 1, v20
    v_mfma_f32_16x16x32_bf16 v[24:27], a[24:27], a[220:223], 0
    s_add_u32 s63, s39, 0x2d300
    v_cmp_lt_u32 vcc, 11, v21
    v_lshlrev_b32 v62, 3, v20
    v_mfma_f32_16x16x32_bf16 v[54:57], a[48:51], a[220:223], 0
    ds_read_b128 a[220:223], v240 offset:1792
    v_add_u32 v22, -12, v21
    v_mfma_f32_16x16x32_bf16 v[150:153], a[4:7], a[224:227], v[150:153]
    s_waitcnt lgkmcnt(6)
    v_mov_b32 v23, s34
    v_and_b32 v20, 1, v20
    v_mfma_f32_16x16x32_bf16 v[154:157], a[28:31], a[224:227], v[154:157]
    s_sub_u32 s66, 1, s66
    s_waitcnt lgkmcnt(5)
    v_cndmask_b32 v22, v21, v22, vcc
    v_mfma_f32_16x16x32_bf16 v[158:161], a[52:55], a[224:227], v[158:161]
    ds_read_b128 a[224:227], v240 offset:3328
    v_cndmask_b32 v23, 0, v23, vcc
    v_mfma_f32_16x16x32_bf16 v[162:165], a[4:7], a[228:231], v[162:165]
    s_waitcnt lgkmcnt(5)
L_h1:
    s_cbranch_execz L_h5
    v_lshlrev_b32 v20, 1, v20
    v_cmp_ne_u32 vcc, 0, v23
    v_mfma_f32_16x16x32_bf16 v[24:27], a[28:31], a[228:231], v[24:27]
    s_mul_i32 s64, s35, 0xfc0
    v_add_u32 v63, 0, v20
    v_add3_u32 v64, v22, v63, -6
    v_mfma_f32_16x16x32_bf16 v[54:57], a[52:55], a[228:231], v[54:57]
    ds_read_b128 a[228:231], v240 offset:4864
    v_and_b32 v66, 12, v22
    v_mfma_f32_16x16x32_bf16 v[150:153], a[8:11], a[232:235], v[150:153]
    s_waitcnt vmcnt(11) lgkmcnt(5)
    ds_read_b64_tr_b16 a[16:17], v249 offset:0
    v_mfma_f32_16x16x32_bf16 v[154:157], a[32:35], a[232:235], v[154:157]
    ds_read_b64_tr_b16 a[18:19], v250 offset:0
    ds_read_b64_tr_b16 a[40:41], v249 offset:32
    v_mfma_f32_16x16x32_bf16 v[158:161], a[56:59], a[232:235], v[158:161]
    ds_read_b64_tr_b16 a[42:43], v250 offset:32
    ds_read_b64_tr_b16 a[64:65], v249 offset:64
    v_mfma_f32_16x16x32_bf16 v[162:165], a[8:11], a[236:239], v[162:165]
    ds_read_b64_tr_b16 a[66:67], v250 offset:64
    s_waitcnt lgkmcnt(9)
    v_mfma_f32_16x16x32_bf16 v[24:27], a[32:35], a[236:239], v[24:27]
    ds_read_b128 a[232:235], v240 offset:30976
    v_add_u32 v65, 3, v64
    v_mfma_f32_16x16x32_bf16 v[54:57], a[56:59], a[236:239], v[54:57]
    ds_read_b128 a[236:239], v240 offset:32512
    v_add3_u32 v66, v66, v63, -3
    v_mfma_f32_16x16x32_bf16 v[150:153], a[12:15], a[240:243], v[150:153]
    s_add_u32 s64, s64, s37
    v_cndmask_b32 v65, v65, v66, vcc
    v_cmp_gt_u32 vcc, 7, v65
    v_mfma_f32_16x16x32_bf16 v[154:157], a[36:39], a[240:243], v[154:157]
    s_mul_i32 s67, s36, 3
    v_mul_i32_i24 v64, s66, v64
    v_add_lshl_u32 v64, v64, 6, 1
    v_mfma_f32_16x16x32_bf16 v[158:161], a[60:63], a[240:243], v[158:161]
    ds_read_b128 a[240:243], v240 offset:34048
    v_cndmask_b32 v50, 0, v64, vcc
    v_mfma_f32_16x16x32_bf16 v[162:165], a[12:15], a[244:247], v[162:165]
    s_waitcnt lgkmcnt(7)
    v_mov_b32 v64, 0x3fb8aa3b
    v_cndmask_b32 v52, 0, v64, vcc
    v_mfma_f32_16x16x32_bf16 v[24:27], a[36:39], a[244:247], v[24:27]
    s_add_u32 s55, s28, 7
    s_waitcnt lgkmcnt(5)
    v_mov_b32 v64, 0
    v_mfma_f32_16x16x32_bf16 v[54:57], a[60:63], a[244:247], v[54:57]
    ds_read_b128 a[244:247], v240 offset:35584
    s_waitcnt lgkmcnt(4)
    v_mfma_f32_16x16x32_bf16 v[204:207], a[16:19], a[216:219], v[204:207]
    buffer_load_dwordx4 v172, s[8:11], s60 offen lds
    v_mov_b32 v65, 0xf149f2ca
    v_mfma_f32_16x16x32_bf16 v[208:211], a[40:43], a[216:219], v[208:211]
    s_mul_i32 s55, s55, s30
    v_cndmask_b32 v60, v65, v64, vcc
    v_cmp_ne_u32 vcc, 0, v23
    v_mfma_f32_16x16x32_bf16 v[212:215], a[64:67], a[216:219], v[212:215]
    ds_read_b128 a[216:219], v241 offset:256
    v_add_u32 v63, 1, v20
    v_mfma_f32_16x16x32_bf16 v[216:219], a[16:19], a[220:223], v[216:219]
    v_add3_u32 v64, v22, v63, -6
    v_and_b32 v66, 12, v22
    v_mfma_f32_16x16x32_bf16 v[220:223], a[40:43], a[220:223], v[220:223]
    buffer_load_dwordx4 v173, s[8:11], s60 offen offset:1024 lds
    v_add_u32 v65, 3, v64
    v_mfma_f32_16x16x32_bf16 v[224:227], a[64:67], a[220:223], v[224:227]
    s_waitcnt vmcnt(10)
    ds_read_b64_tr_b16 a[20:21], v249 offset:3072
    v_mfma_f32_16x16x32_bf16 v[180:183], a[16:19], a[224:227], v[180:183]
    ds_read_b64_tr_b16 a[22:23], v250 offset:3072
    ds_read_b64_tr_b16 a[44:45], v249 offset:3104
    v_mfma_f32_16x16x32_bf16 v[184:187], a[40:43], a[224:227], v[184:187]
    ds_read_b64_tr_b16 a[46:47], v250 offset:3104
    ds_read_b64_tr_b16 a[68:69], v249 offset:3136
    v_mfma_f32_16x16x32_bf16 v[188:191], a[64:67], a[224:227], v[188:191]
    ds_read_b64_tr_b16 a[70:71], v250 offset:3136
    s_waitcnt lgkmcnt(9)
    v_mfma_f32_16x16x32_bf16 v[192:195], a[16:19], a[228:231], v[192:195]
    buffer_load_dwordx4 v174, s[8:11], s60 offen offset:2048 lds
    v_add3_u32 v66, v66, v63, -3
    v_mfma_f32_16x16x32_bf16 v[196:199], a[40:43], a[228:231], v[196:199]
    s_add_u32 m0, s29, 0xc00
    v_cndmask_b32 v65, v65, v66, vcc
    v_cmp_gt_u32 vcc, 7, v65
    v_mfma_f32_16x16x32_bf16 v[200:203], a[64:67], a[228:231], v[200:203]
    s_waitcnt lgkmcnt(8)
    v_add_u32 v62, s64, v62
    v_mul_i32_i24 v64, s66, v64
    v_mfma_f32_16x16x32_bf16 v[228:231], a[16:19], a[232:235], v[228:231]
    ds_read_b128 a[220:223], v241 offset:1792
    v_add_lshl_u32 v64, v64, 6, 1
    v_mfma_f32_16x16x32_bf16 v[232:235], a[40:43], a[232:235], v[232:235]
    s_waitcnt lgkmcnt(8)
    v_cndmask_b32 v51, 0, v64, vcc
    v_mov_b32 v64, 0x3fb8aa3b
    v_mfma_f32_16x16x32_bf16 v[236:239], a[64:67], a[232:235], v[236:239]
    ds_read_b128 a[224:227], v241 offset:3328
    v_cndmask_b32 v53, 0, v64, vcc
    v_mfma_f32_16x16x32_bf16 v[138:141], a[16:19], a[236:239], v[138:141]
    ds_read_b128 a[228:231], v241 offset:4864
    v_mov_b32 v64, 0
    v_mfma_f32_16x16x32_bf16 v[142:145], a[40:43], a[236:239], v[142:145]
    ds_read_b128 a[232:235], v241 offset:30976
    s_waitcnt lgkmcnt(4)
    v_mfma_f32_16x16x32_bf16 v[146:149], a[64:67], a[236:239], v[146:149]
    buffer_load_dwordx4 v172, s[8:11], s61 offen lds
    v_mov_b32 v65, 0xf149f2ca
    v_mfma_f32_16x16x32_bf16 v[150:153], a[16:19], a[240:243], v[150:153]
    s_waitcnt vmcnt(7)
    ds_read_b64_tr_b16 a[72:73], v249 offset:6144
    v_mfma_f32_16x16x32_bf16 v[154:157], a[40:43], a[240:243], v[154:157]
    ds_read_b64_tr_b16 a[74:75], v250 offset:6144
    ds_read_b64_tr_b16 a[96:97], v249 offset:6176
    v_mfma_f32_16x16x32_bf16 v[158:161], a[64:67], a[240:243], v[158:161]
    ds_read_b64_tr_b16 a[98:99], v250 offset:6176
    ds_read_b64_tr_b16 a[120:121], v249 offset:6208
    v_mfma_f32_16x16x32_bf16 v[162:165], a[16:19], a[244:247], v[162:165]
    ds_read_b64_tr_b16 a[122:123], v250 offset:6208
    buffer_load_dwordx4 v173, s[8:11], s61 offen offset:1024 lds
    v_mfma_f32_16x16x32_bf16 v[24:27], a[40:43], a[244:247], v[24:27]
    ds_read_b128 a[236:239], v241 offset:32512
    v_cndmask_b32 v61, v65, v64, vcc
    v_mfma_f32_16x16x32_bf16 v[54:57], a[64:67], a[244:247], v[54:57]
    ds_read_b128 a[240:243], v241 offset:34048
    v_lshlrev_b32 v63, 3, v1
    v_mfma_f32_16x16x32_bf16 v[204:207], a[20:23], a[216:219], v[204:207]
    s_waitcnt lgkmcnt(11)
    v_mov_b32 v64, 0xf149f2ca
    v_mov_b32 v65, 0xf149f2ca
    v_mfma_f32_16x16x32_bf16 v[208:211], a[44:47], a[216:219], v[208:211]
    buffer_load_dwordx4 v174, s[8:11], s61 offen offset:2048 lds
    s_add_u32 m0, s29, 0x1800
    v_mfma_f32_16x16x32_bf16 v[212:215], a[68:71], a[216:219], v[212:215]
    ds_read_b128 a[244:247], v241 offset:35584
    v_cvt_pk_bf16_f32 v102, v204, v205
    v_mfma_f32_16x16x32_bf16 v[216:219], a[20:23], a[220:223], v[216:219]
    s_waitcnt lgkmcnt(11)
    v_cvt_pk_bf16_f32 v103, v206, v207
    v_cvt_pk_bf16_f32 v104, v208, v209
    v_mfma_f32_16x16x32_bf16 v[220:223], a[44:47], a[220:223], v[220:223]
    s_waitcnt lgkmcnt(10)
    v_cvt_pk_bf16_f32 v105, v210, v211
    v_cvt_pk_bf16_f32 v106, v212, v213
    v_mfma_f32_16x16x32_bf16 v[224:227], a[68:71], a[220:223], v[224:227]
    s_waitcnt lgkmcnt(9)
    s_waitcnt lgkmcnt(3)
    v_cvt_pk_bf16_f32 v107, v214, v215
    v_mfma_f32_16x16x32_bf16 v[180:183], a[20:23], a[224:227], v[180:183]
    buffer_load_dwordx4 v172, s[8:11], s62 offen lds
    v_cvt_pk_bf16_f32 v108, v216, v217
    v_mfma_f32_16x16x32_bf16 v[184:187], a[44:47], a[224:227], v[184:187]
    s_waitcnt vmcnt(7)
    ds_read_b64_tr_b16 a[76:77], v249 offset:9216
    v_mfma_f32_16x16x32_bf16 v[188:191], a[68:71], a[224:227], v[188:191]
    ds_read_b64_tr_b16 a[78:79], v250 offset:9216
    ds_read_b64_tr_b16 a[100:101], v249 offset:9248
    v_mfma_f32_16x16x32_bf16 v[192:195], a[20:23], a[228:231], v[192:195]
    ds_read_b64_tr_b16 a[102:103], v250 offset:9248
    ds_read_b64_tr_b16 a[124:125], v249 offset:9280
    v_mfma_f32_16x16x32_bf16 v[196:199], a[44:47], a[228:231], v[196:199]
    ds_read_b64_tr_b16 a[126:127], v250 offset:9280
    buffer_load_dwordx4 v173, s[8:11], s62 offen offset:1024 lds
    v_mfma_f32_16x16x32_bf16 v[200:203], a[68:71], a[228:231], v[200:203]
    s_waitcnt lgkmcnt(8)
    ds_read_b128 a[216:219], v240 offset:0
    v_mfma_f32_16x16x32_bf16 v[228:231], a[20:23], a[232:235], v[228:231]
    s_waitcnt lgkmcnt(8)
    v_cvt_pk_bf16_f32 v109, v218, v219
    v_cvt_pk_bf16_f32 v110, v220, v221
    v_mfma_f32_16x16x32_bf16 v[232:235], a[44:47], a[232:235], v[232:235]
    ds_read_b128 a[220:223], v240 offset:1536
    v_cvt_pk_bf16_f32 v111, v222, v223
    v_mfma_f32_16x16x32_bf16 v[236:239], a[68:71], a[232:235], v[236:239]
    buffer_load_dwordx4 v174, s[8:11], s62 offen offset:2048 lds
    s_add_u32 m0, s29, 0x2400
    v_mfma_f32_16x16x32_bf16 v[138:141], a[20:23], a[236:239], v[138:141]
    s_waitcnt lgkmcnt(8)
    v_cvt_pk_bf16_f32 v112, v224, v225
    v_cvt_pk_bf16_f32 v113, v226, v227
    v_mfma_f32_16x16x32_bf16 v[142:145], a[44:47], a[236:239], v[142:145]
    ds_read_b128 a[224:227], v240 offset:3072
    v_cvt_pk_bf16_f32 v90, v180, v181
    v_mfma_f32_16x16x32_bf16 v[146:149], a[68:71], a[236:239], v[146:149]
    ds_read_b128 a[228:231], v240 offset:4608
    v_cvt_pk_bf16_f32 v91, v182, v183
    v_mfma_f32_16x16x32_bf16 v[150:153], a[20:23], a[240:243], v[150:153]
    ds_read_b128 a[232:235], v240 offset:30720
    s_waitcnt lgkmcnt(5)
    v_mfma_f32_16x16x32_bf16 v[154:157], a[44:47], a[240:243], v[154:157]
    buffer_load_dwordx4 v172, s[8:11], s63 offen lds
    v_cvt_pk_bf16_f32 v92, v184, v185
    v_mfma_f32_16x16x32_bf16 v[158:161], a[68:71], a[240:243], v[158:161]
    ds_read_b128 a[236:239], v240 offset:32256
    v_cvt_pk_bf16_f32 v93, v186, v187
    v_mfma_f32_16x16x32_bf16 v[162:165], a[20:23], a[244:247], v[162:165]
    s_waitcnt lgkmcnt(5)
    v_cvt_pk_bf16_f32 v94, v188, v189
    v_cvt_pk_bf16_f32 v95, v190, v191
    v_mfma_f32_16x16x32_bf16 v[24:27], a[44:47], a[244:247], v[24:27]
    ds_read_b128 a[240:243], v240 offset:33792
    v_cvt_pk_bf16_f32 v96, v192, v193
    v_mfma_f32_16x16x32_bf16 v[54:57], a[68:71], a[244:247], v[54:57]
    buffer_load_dwordx4 v173, s[8:11], s63 offen offset:1024 lds
    v_cvt_pk_bf16_f32 v97, v194, v195
    v_mfma_f32_16x16x32_bf16 v[84:87], a[216:219], a[72:75], 0
    s_waitcnt lgkmcnt(5)
    v_cvt_pk_bf16_f32 v98, v196, v197
    v_cvt_pk_bf16_f32 v99, v198, v199
    v_mfma_f32_16x16x32_bf16 v[204:207], a[216:219], a[96:99], 0
    ds_read_b128 a[244:247], v240 offset:35328
    v_cvt_pk_bf16_f32 v100, v200, v201
    v_mfma_f32_16x16x32_bf16 v[208:211], a[216:219], a[120:123], 0
    s_and_b32 s64, s48, 15
    v_cvt_pk_bf16_f32 v101, v202, v203
    v_cvt_pk_bf16_f32 v114, v228, v229
    v_mfma_f32_16x16x32_bf16 v[212:215], a[220:223], a[72:75], 0
    buffer_load_dwordx4 v174, s[8:11], s63 offen offset:2048 lds
    s_waitcnt lgkmcnt(5)
    v_mfma_f32_16x16x32_bf16 v[216:219], a[220:223], a[96:99], 0
    s_add_u32 m0, s46, 0x1800
    v_cvt_pk_bf16_f32 v115, v230, v231
    v_cvt_pk_bf16_f32 v116, v232, v233
    v_mfma_f32_16x16x32_bf16 v[220:223], a[220:223], a[120:123], 0
    ds_read_b128 a[216:219], v241 offset:0
    v_cvt_pk_bf16_f32 v117, v234, v235
    v_mfma_f32_16x16x32_bf16 v[224:227], a[224:227], a[72:75], 0
    s_waitcnt lgkmcnt(5)
    v_cvt_pk_bf16_f32 v118, v236, v237
    v_cvt_pk_bf16_f32 v119, v238, v239
    v_mfma_f32_16x16x32_bf16 v[180:183], a[224:227], a[96:99], 0
    buffer_load_dwordx4 v168, s[4:7], s58 offen lds
    s_waitcnt lgkmcnt(4)
    v_mfma_f32_16x16x32_bf16 v[184:187], a[224:227], a[120:123], 0
    s_add_u32 s64, s64, s37
    v_cvt_pk_bf16_f32 v120, v138, v139
    v_cvt_pk_bf16_f32 v121, v140, v141
    v_mfma_f32_16x16x32_bf16 v[188:191], a[228:231], a[72:75], 0
    s_add_u32 s60, s39, 0
    s_waitcnt lgkmcnt(3)
    v_cvt_pk_bf16_f32 v122, v142, v143
    v_mfma_f32_16x16x32_bf16 v[192:195], a[228:231], a[96:99], 0
    ds_read_b128 a[220:223], v241 offset:1536
    v_cvt_pk_bf16_f32 v123, v144, v145
    v_mfma_f32_16x16x32_bf16 v[196:199], a[228:231], a[120:123], 0
    buffer_load_dwordx4 v171, s[4:7], s58 offen offset:512 lds
    v_cvt_pk_bf16_f32 v124, v146, v147
    v_mfma_f32_16x16x32_bf16 v[200:203], a[232:235], a[72:75], 0
    s_add_u32 m0, s46, 0x9000
    v_cvt_pk_bf16_f32 v125, v148, v149
    s_waitcnt lgkmcnt(3)
    v_mfma_f32_16x16x32_bf16 v[228:231], a[232:235], a[96:99], 0
    s_lshl1_add_u32 s58, s45, s41
    v_cvt_pk_bf16_f32 v126, v150, v151
    v_cvt_pk_bf16_f32 v127, v152, v153
    v_mfma_f32_16x16x32_bf16 v[232:235], a[232:235], a[120:123], 0
    s_add_u32 s61, s39, 0x9000
    v_cvt_pk_bf16_f32 v128, v154, v155
    v_cvt_pk_bf16_f32 v129, v156, v157
    v_mfma_f32_16x16x32_bf16 v[236:239], a[236:239], a[72:75], 0
    buffer_load_dwordx4 v168, s[4:7], s58 offen lds
    v_cvt_pk_bf16_f32 v130, v158, v159
    v_mfma_f32_16x16x32_bf16 v[138:141], a[236:239], a[96:99], 0
    ds_read_b128 a[224:227], v241 offset:3072
    v_cvt_pk_bf16_f32 v131, v160, v161
    v_mfma_f32_16x16x32_bf16 v[142:145], a[236:239], a[120:123], 0
    s_waitcnt lgkmcnt(3)
    v_cvt_pk_bf16_f32 v132, v162, v163
    v_cvt_pk_bf16_f32 v133, v164, v165
    v_mfma_f32_16x16x32_bf16 v[146:149], a[240:243], a[72:75], 0
    s_add_u32 s62, s39, 0x12000
    v_cvt_pk_bf16_f32 v134, v24, v25
    v_cvt_pk_bf16_f32 v135, v26, v27
    v_mfma_f32_16x16x32_bf16 v[150:153], a[240:243], a[96:99], 0
    buffer_load_dwordx4 v171, s[4:7], s58 offen offset:512 lds
    s_waitcnt lgkmcnt(2)
    v_mfma_f32_16x16x32_bf16 v[154:157], a[240:243], a[120:123], 0
    ds_read_b128 a[228:231], v241 offset:4608
    v_add_u32 v50, s64, v50
    v_mfma_f32_16x16x32_bf16 v[158:161], a[244:247], a[72:75], 0
    s_add_u32 m0, s46, 0xf000
    v_add_u32 v51, s64, v51
    v_add_u32 v63, 0x237c0, v63
    v_mfma_f32_16x16x32_bf16 v[162:165], a[244:247], a[96:99], 0
    ds_read_b128 a[232:235], v241 offset:30720
    v_mbcnt_lo_u32_b32 v67, -1, 0
    v_mfma_f32_16x16x32_bf16 v[24:27], a[244:247], a[120:123], 0
    ds_read_b128 a[236:239], v241 offset:32256
    s_waitcnt lgkmcnt(4)
    v_mfma_f32_16x16x32_bf16 v[84:87], a[216:219], a[76:79], v[84:87]
    buffer_load_dwordx4 v168, s[4:7], s42 offen lds
    v_mbcnt_hi_u32_b32 v67, -1, v67
    v_mfma_f32_16x16x32_bf16 v[204:207], a[216:219], a[100:103], v[204:207]
    ds_read_b128 a[240:243], v241 offset:33792
    v_lshrrev_b32 v68, 1, v67
    v_mfma_f32_16x16x32_bf16 v[208:211], a[216:219], a[124:127], v[208:211]
    ds_read_b128 a[244:247], v241 offset:35328
    v_add_u32 v68, 0, v68
    v_mfma_f32_16x16x32_bf16 v[212:215], a[220:223], a[76:79], v[212:215]
    s_waitcnt lgkmcnt(5)
    v_mul_u32_u24 v69, 43, v68
    v_lshrrev_b32 v70, 8, v69
    v_mfma_f32_16x16x32_bf16 v[216:219], a[220:223], a[100:103], v[216:219]
    buffer_load_dwordx4 v169, s[4:7], s42 offen offset:1024 lds
    v_lshrrev_b32 v69, 7, v69
    v_mfma_f32_16x16x32_bf16 v[220:223], a[220:223], a[124:127], v[220:223]
    ds_read_b128 a[216:219], v240 offset:128
    v_mad_i32_i24 v68, v69, -3, v68
    v_mfma_f32_16x16x32_bf16 v[224:227], a[224:227], a[76:79], v[224:227]
    s_waitcnt lgkmcnt(5)
    v_and_b32 v70, 4, v70
    v_xor_b32 v69, v69, v70
    v_mfma_f32_16x16x32_bf16 v[180:183], a[224:227], a[100:103], v[180:183]
    ds_read_b128 a[220:223], v240 offset:1664
    v_and_b32 v70, 4, v69
    v_mfma_f32_16x16x32_bf16 v[184:187], a[224:227], a[124:127], v[184:187]
    buffer_load_dwordx4 v170, s[4:7], s42 offen offset:2048 lds
    v_mul_u32_u24 v252, 24, v70
    v_mfma_f32_16x16x32_bf16 v[188:191], a[228:231], a[76:79], v[188:191]
    s_waitcnt lgkmcnt(5)
    v_lshrrev_b32 v70, 3, v69
    v_lshl_add_u32 v252, v70, 2, v252
    v_mfma_f32_16x16x32_bf16 v[192:195], a[228:231], a[100:103], v[192:195]
    s_add_u32 m0, s46, 0xfc00
    v_and_or_b32 v252, v69, 3, v252
    v_mad_u32_u24 v252, v252, 3, v68
    v_mfma_f32_16x16x32_bf16 v[196:199], a[228:231], a[124:127], v[196:199]
    ds_read_b128 a[224:227], v240 offset:3200
    v_lshrrev_b32 v68, 1, v67
    v_mfma_f32_16x16x32_bf16 v[200:203], a[232:235], a[76:79], v[200:203]
    s_waitcnt vmcnt(16) lgkmcnt(5)
    ds_read_b64_tr_b16 a[80:81], v249 offset:0
    v_mfma_f32_16x16x32_bf16 v[228:231], a[232:235], a[100:103], v[228:231]
    ds_read_b64_tr_b16 a[82:83], v250 offset:0
    buffer_load_dwordx4 v168, s[4:7], s59 offen lds
    v_mfma_f32_16x16x32_bf16 v[232:235], a[232:235], a[124:127], v[232:235]
    ds_read_b64_tr_b16 a[104:105], v249 offset:32
    ds_read_b64_tr_b16 a[106:107], v250 offset:32
    v_mfma_f32_16x16x32_bf16 v[236:239], a[236:239], a[76:79], v[236:239]
    ds_read_b64_tr_b16 a[128:129], v249 offset:64
    ds_read_b64_tr_b16 a[130:131], v250 offset:64
    v_mfma_f32_16x16x32_bf16 v[138:141], a[236:239], a[100:103], v[138:141]
    s_waitcnt lgkmcnt(9)
    v_and_b32 v70, 1, v67
    v_add_u32 v68, 32, v68
    v_mfma_f32_16x16x32_bf16 v[142:145], a[236:239], a[124:127], v[142:145]
    buffer_load_dwordx4 v169, s[4:7], s59 offen offset:1024 lds
    v_lshl_add_u32 v252, v252, 3, v70
    v_mfma_f32_16x16x32_bf16 v[146:149], a[240:243], a[76:79], v[146:149]
    ds_read_b128 a[228:231], v240 offset:4736
    v_mul_u32_u24 v69, 43, v68
    v_mfma_f32_16x16x32_bf16 v[150:153], a[240:243], a[100:103], v[150:153]
    ds_read_b128 a[232:235], v240 offset:30848
    v_lshrrev_b32 v70, 8, v69
    v_mfma_f32_16x16x32_bf16 v[154:157], a[240:243], a[124:127], v[154:157]
    ds_read_b128 a[236:239], v240 offset:32384
    v_lshrrev_b32 v69, 7, v69
    v_mfma_f32_16x16x32_bf16 v[158:161], a[244:247], a[76:79], v[158:161]
    s_waitcnt lgkmcnt(7)
    v_mad_i32_i24 v68, v69, -3, v68
    v_and_b32 v70, 4, v70
    v_mfma_f32_16x16x32_bf16 v[162:165], a[244:247], a[100:103], v[162:165]
    ds_read_b128 a[240:243], v240 offset:33920
    s_waitcnt lgkmcnt(6)
    v_mfma_f32_16x16x32_bf16 v[24:27], a[244:247], a[124:127], v[24:27]
    ds_read_b128 a[244:247], v240 offset:35456
    v_xor_b32 v69, v69, v70
    v_mfma_f32_16x16x32_bf16 v[84:87], a[216:219], a[80:83], v[84:87]
    s_waitcnt lgkmcnt(5)
    v_and_b32 v70, 4, v69
    v_mul_u32_u24 v253, 24, v70
    v_mfma_f32_16x16x32_bf16 v[204:207], a[216:219], a[104:107], v[204:207]
    ds_read_u16 v30, v50 offset:3456
    v_lshrrev_b32 v70, 3, v69
    v_mfma_f32_16x16x32_bf16 v[208:211], a[216:219], a[128:131], v[208:211]
    ds_read_b128 a[216:219], v241 offset:128
    v_lshl_add_u32 v253, v70, 2, v253
    v_mfma_f32_16x16x32_bf16 v[212:215], a[220:223], a[80:83], v[212:215]
    ds_read_u16 v31, v51 offset:3456
    v_and_b32 v70, 1, v67
    v_mfma_f32_16x16x32_bf16 v[216:219], a[220:223], a[104:107], v[216:219]
    ds_read_u16 v32, v50 offset:3482
    v_cvt_pk_bf16_f32 v136, v54, v55
    v_mfma_f32_16x16x32_bf16 v[220:223], a[220:223], a[128:131], v[220:223]
    ds_read_b128 a[220:223], v241 offset:1664
    v_cvt_pk_bf16_f32 v137, v56, v57
    v_mfma_f32_16x16x32_bf16 v[224:227], a[224:227], a[80:83], v[224:227]
    s_waitcnt lgkmcnt(9)
    v_and_or_b32 v253, v69, 3, v253
    v_mad_u32_u24 v253, v253, 3, v68
    v_mfma_f32_16x16x32_bf16 v[180:183], a[224:227], a[104:107], v[180:183]
    ds_read_u16 v33, v51 offset:3482
    v_lshl_add_u32 v253, v253, 3, v70
    v_mfma_f32_16x16x32_bf16 v[184:187], a[224:227], a[128:131], v[184:187]
    ds_read_b128 a[224:227], v241 offset:3200
    s_waitcnt lgkmcnt(10)
    v_mfma_f32_16x16x32_bf16 v[188:191], a[228:231], a[80:83], v[188:191]
    ds_read_u16 v34, v50 offset:3508
    s_waitcnt lgkmcnt(10)
    v_mfma_f32_16x16x32_bf16 v[192:195], a[228:231], a[104:107], v[192:195]
    ds_read_u16 v35, v51 offset:3508
    v_xor_b32 v243, 64, v242
    v_mfma_f32_16x16x32_bf16 v[196:199], a[228:231], a[128:131], v[196:199]
    ds_read_b128 a[228:231], v241 offset:4736
    v_add_u32 v244, 0x237c0, v244
    v_mfma_f32_16x16x32_bf16 v[200:203], a[232:235], a[80:83], v[200:203]
    s_waitcnt vmcnt(15) lgkmcnt(11)
    ds_read_b64_tr_b16 a[84:85], v249 offset:3072
    v_mfma_f32_16x16x32_bf16 v[228:231], a[232:235], a[104:107], v[228:231]
    ds_read_b64_tr_b16 a[86:87], v250 offset:3072
    ds_read_b64_tr_b16 a[108:109], v249 offset:3104
    v_mfma_f32_16x16x32_bf16 v[232:235], a[232:235], a[128:131], v[232:235]
    ds_read_b64_tr_b16 a[110:111], v250 offset:3104
    ds_read_b64_tr_b16 a[132:133], v249 offset:3136
    v_mfma_f32_16x16x32_bf16 v[236:239], a[236:239], a[80:83], v[236:239]
    ds_read_b64_tr_b16 a[134:135], v250 offset:3136
    s_waitcnt lgkmcnt(14)
    v_mfma_f32_16x16x32_bf16 v[138:141], a[236:239], a[104:107], v[138:141]
    ds_read_b128 a[232:235], v241 offset:30848
    v_lshlrev_b32 v30, 16, v30
    v_mfma_f32_16x16x32_bf16 v[142:145], a[236:239], a[128:131], v[142:145]
    ds_read_b128 a[236:239], v241 offset:32384
    v_fma_f32 v30, v30, v52, v60
    v_mfma_f32_16x16x32_bf16 v[146:149], a[240:243], a[80:83], v[146:149]
    buffer_load_dwordx4 v170, s[4:7], s59 offen offset:2048 lds
    v_add_u32 v245, 0x237c0, v245
    v_mfma_f32_16x16x32_bf16 v[150:153], a[240:243], a[104:107], v[150:153]
    ds_read_u16 v37, v51 offset:3534
    v_add_u32 v246, 0x237c0, v246
    v_mfma_f32_16x16x32_bf16 v[154:157], a[240:243], a[128:131], v[154:157]
    ds_read_b128 a[240:243], v241 offset:33920
    v_accvgpr_write_b32 a252, v168
    v_mfma_f32_16x16x32_bf16 v[158:161], a[244:247], a[80:83], v[158:161]
    s_waitcnt lgkmcnt(8)
    v_lshlrev_b32 v31, 16, v31
    v_fma_f32 v31, v31, v53, v61
    v_mfma_f32_16x16x32_bf16 v[162:165], a[244:247], a[104:107], v[162:165]
    ds_read_u16 v39, v51 offset:3560
    s_waitcnt lgkmcnt(7)
    v_mfma_f32_16x16x32_bf16 v[24:27], a[244:247], a[128:131], v[24:27]
    ds_read_b128 a[244:247], v241 offset:35456
    s_waitcnt lgkmcnt(6)
    v_mfma_f32_16x16x32_bf16 v[84:87], a[216:219], a[84:87], v[84:87]
    ds_read_u16 v41, v51 offset:3586
    v_lshlrev_b32 v32, 16, v32
    v_mfma_f32_16x16x32_bf16 v[204:207], a[216:219], a[108:111], v[204:207]
    ds_read_u16 v43, v51 offset:3612
    v_lshlrev_b32 v33, 16, v33
    v_mfma_f32_16x16x32_bf16 v[208:211], a[216:219], a[132:135], v[208:211]
    ds_read_b128 a[216:219], v240 offset:256
    v_fma_f32 v32, v32, v52, v60
    v_mfma_f32_16x16x32_bf16 v[212:215], a[220:223], a[84:87], v[212:215]
    ds_read_u16 v45, v51 offset:3638
    v_fma_f32 v33, v33, v53, v61
    v_mfma_f32_16x16x32_bf16 v[216:219], a[220:223], a[108:111], v[216:219]
    ds_read_u16 v47, v51 offset:3664
    v_lshlrev_b32 v34, 16, v34
    v_mfma_f32_16x16x32_bf16 v[220:223], a[220:223], a[132:135], v[220:223]
    ds_read_b128 a[220:223], v240 offset:1792
    v_lshlrev_b32 v35, 16, v35
    v_mfma_f32_16x16x32_bf16 v[224:227], a[224:227], a[84:87], v[224:227]
    s_waitcnt lgkmcnt(11)
    v_fma_f32 v34, v34, v52, v60
    v_fma_f32 v35, v35, v53, v61
    v_mfma_f32_16x16x32_bf16 v[180:183], a[224:227], a[108:111], v[180:183]
    s_waitcnt lgkmcnt(10)
    v_accvgpr_write_b32 a253, v169
    v_accvgpr_write_b32 a254, v170
    v_mfma_f32_16x16x32_bf16 v[184:187], a[224:227], a[132:135], v[184:187]
    ds_read_b128 a[224:227], v240 offset:3328
    v_accvgpr_write_b32 a255, v171
    v_mfma_f32_16x16x32_bf16 v[188:191], a[228:231], a[84:87], v[188:191]
    ds_read_u16 v49, v51 offset:3690
    v_accvgpr_read_b32 v254, a252
    v_mfma_f32_16x16x32_bf16 v[192:195], a[228:231], a[108:111], v[192:195]
    s_waitcnt lgkmcnt(10)
    v_lshlrev_b32 v37, 16, v37
    v_fma_f32 v37, v37, v53, v61
    v_mfma_f32_16x16x32_bf16 v[196:199], a[228:231], a[132:135], v[196:199]
    ds_read_b128 a[228:231], v240 offset:4864
    v_accvgpr_read_b32 v255, a253
    v_mfma_f32_16x16x32_bf16 v[200:203], a[232:235], a[84:87], v[200:203]
    s_waitcnt vmcnt(13) lgkmcnt(10)
    ds_read_b64_tr_b16 a[88:89], v249 offset:6144
    v_mfma_f32_16x16x32_bf16 v[228:231], a[232:235], a[108:111], v[228:231]
    ds_read_b64_tr_b16 a[90:91], v250 offset:6144
    ds_read_b64_tr_b16 a[112:113], v249 offset:6176
    v_mfma_f32_16x16x32_bf16 v[232:235], a[232:235], a[132:135], v[232:235]
    ds_read_b64_tr_b16 a[114:115], v250 offset:6176
    ds_read_b64_tr_b16 a[136:137], v249 offset:6208
    v_mfma_f32_16x16x32_bf16 v[236:239], a[236:239], a[84:87], v[236:239]
    ds_read_b64_tr_b16 a[138:139], v250 offset:6208
    s_waitcnt lgkmcnt(12)
    v_mfma_f32_16x16x32_bf16 v[138:141], a[236:239], a[108:111], v[138:141]
    ds_read_b128 a[232:235], v240 offset:30976
    v_lshlrev_b32 v39, 16, v39
    v_mfma_f32_16x16x32_bf16 v[142:145], a[236:239], a[132:135], v[142:145]
    ds_read_b128 a[236:239], v240 offset:32512
    v_lshlrev_b32 v41, 16, v41
    v_mfma_f32_16x16x32_bf16 v[146:149], a[240:243], a[84:87], v[146:149]
    s_add_u32 m0, s46, 0x10800
    v_lshlrev_b32 v43, 16, v43
    v_fma_f32 v39, v39, v53, v61
    v_mfma_f32_16x16x32_bf16 v[150:153], a[240:243], a[108:111], v[150:153]
    s_lshl1_add_u32 s58, s45, s42
    v_fma_f32 v41, v41, v53, v61
    v_fma_f32 v43, v43, v53, v61
    v_mfma_f32_16x16x32_bf16 v[154:157], a[240:243], a[132:135], v[154:157]
    ds_read_b128 a[240:243], v240 offset:34048
    v_mov_b32 v248, 0
    v_mfma_f32_16x16x32_bf16 v[158:161], a[244:247], a[84:87], v[158:161]
    s_waitcnt lgkmcnt(7)
    v_lshlrev_b32 v45, 16, v45
    v_lshlrev_b32 v47, 16, v47
    v_mfma_f32_16x16x32_bf16 v[162:165], a[244:247], a[108:111], v[162:165]
    buffer_load_dwordx4 v168, s[4:7], s58 offen lds
    s_waitcnt lgkmcnt(5)
    v_mfma_f32_16x16x32_bf16 v[24:27], a[244:247], a[132:135], v[24:27]
    ds_read_b128 a[244:247], v240 offset:35584
    s_waitcnt lgkmcnt(4)
    v_mfma_f32_16x16x32_bf16 v[84:87], a[216:219], a[88:91], v[84:87]
    ds_read_u16 v36, v50 offset:3534
    v_lshlrev_b32 v49, 16, v49
    v_mfma_f32_16x16x32_bf16 v[204:207], a[216:219], a[112:115], v[204:207]
    ds_read_u16 v38, v50 offset:3560
    v_fma_f32 v45, v45, v53, v61
    v_mfma_f32_16x16x32_bf16 v[208:211], a[216:219], a[136:139], v[208:211]
    ds_read_b128 a[216:219], v241 offset:256
    v_fma_f32 v47, v47, v53, v61
    v_mfma_f32_16x16x32_bf16 v[212:215], a[220:223], a[88:91], v[212:215]
    ds_read_u16 v40, v50 offset:3586
    v_fma_f32 v49, v49, v53, v61
    v_mfma_f32_16x16x32_bf16 v[216:219], a[220:223], a[112:115], v[216:219]
    ds_read_u16 v42, v50 offset:3612
    v_lshlrev_b32 v252, 4, v252
    v_mfma_f32_16x16x32_bf16 v[220:223], a[220:223], a[136:139], v[220:223]
    ds_read_b128 a[220:223], v241 offset:1792
    v_lshlrev_b32 v253, 4, v253
    v_mfma_f32_16x16x32_bf16 v[224:227], a[224:227], a[88:91], v[224:227]
    s_waitcnt lgkmcnt(9)
    v_add_u32 v253, 0xfffffc00, v253
    s_waitcnt lgkmcnt(8)
    v_mfma_f32_16x16x32_bf16 v[180:183], a[224:227], a[112:115], v[180:183]
    ds_read_u16 v44, v50 offset:3638
    s_waitcnt vmcnt(11)
    v_mfma_f32_16x16x32_bf16 v[184:187], a[224:227], a[136:139], v[184:187]
    ds_read_b64_tr_b16 a[92:93], v249 offset:9216
    ds_read_b64_tr_b16 a[94:95], v250 offset:9216
    v_mfma_f32_16x16x32_bf16 v[188:191], a[228:231], a[88:91], v[188:191]
    ds_read_b64_tr_b16 a[116:117], v249 offset:9248
    ds_read_b64_tr_b16 a[118:119], v250 offset:9248
    v_mfma_f32_16x16x32_bf16 v[192:195], a[228:231], a[112:115], v[192:195]
    ds_read_b64_tr_b16 a[140:141], v249 offset:9280
    ds_read_b64_tr_b16 a[142:143], v250 offset:9280
    v_mfma_f32_16x16x32_bf16 v[196:199], a[228:231], a[136:139], v[196:199]
    s_waitcnt lgkmcnt(14)
    ds_read_b128 a[224:227], v241 offset:3328
    v_mfma_f32_16x16x32_bf16 v[200:203], a[232:235], a[88:91], v[200:203]
    s_waitcnt lgkmcnt(14)
    ds_read_b128 a[228:231], v241 offset:4864
    v_mfma_f32_16x16x32_bf16 v[228:231], a[232:235], a[112:115], v[228:231]
    ds_read_u16 v46, v50 offset:3664
    ds_read_u16 v48, v50 offset:3690
    v_mfma_f32_16x16x32_bf16 v[232:235], a[232:235], a[136:139], v[232:235]
    ds_read_b128 a[232:235], v241 offset:30976
    buffer_load_dwordx4 v171, s[4:7], s58 offen offset:512 lds
    v_mfma_f32_16x16x32_bf16 v[236:239], a[236:239], a[88:91], v[236:239]
    ds_write_b64 v62, v[30:31] offset:0
    v_mfma_f32_16x16x32_bf16 v[138:141], a[236:239], a[112:115], v[138:141]
    s_add_u32 m0, s29, 0
    v_add_u32 v62, s49, v62
    s_waitcnt lgkmcnt(15)
    v_mfma_f32_16x16x32_bf16 v[142:145], a[236:239], a[136:139], v[142:145]
    ds_read_b128 a[236:239], v241 offset:32512
    v_lshlrev_b32 v36, 16, v36
    v_mfma_f32_16x16x32_bf16 v[146:149], a[240:243], a[88:91], v[146:149]
    ds_write_b64 v62, v[32:33] offset:0
    v_mfma_f32_16x16x32_bf16 v[150:153], a[240:243], a[112:115], v[150:153]
    buffer_load_dwordx4 v172, s[8:11], s60 offen lds
    v_add_u32 v62, s49, v62
    v_mfma_f32_16x16x32_bf16 v[154:157], a[240:243], a[136:139], v[154:157]
    ds_read_b128 a[240:243], v241 offset:34048
    v_fma_f32 v36, v36, v52, v60
L_h2:
    s_cbranch_execz L_h6
    v_mfma_f32_16x16x32_bf16 v[158:161], a[244:247], a[88:91], v[158:161]
    s_waitcnt lgkmcnt(13)
    v_lshlrev_b32 v38, 16, v38
    v_fma_f32 v38, v38, v52, v60
    v_mfma_f32_16x16x32_bf16 v[162:165], a[244:247], a[112:115], v[162:165]
    s_waitcnt lgkmcnt(11)
    v_lshlrev_b32 v40, 16, v40
    v_fma_f32 v40, v40, v52, v60
    v_mfma_f32_16x16x32_bf16 v[24:27], a[244:247], a[136:139], v[24:27]
    s_waitcnt lgkmcnt(9)
    v_lshlrev_b32 v42, 16, v42
    v_fma_f32 v42, v42, v52, v60
    v_mfma_f32_16x16x32_bf16 v[84:87], a[216:219], a[92:95], v[84:87]
    s_waitcnt vmcnt(9) lgkmcnt(8)
    v_lshlrev_b32 v44, 16, v44
    v_fma_f32 v44, v44, v52, v60
    v_mfma_f32_16x16x32_bf16 v[204:207], a[216:219], a[116:119], v[204:207]
    s_waitcnt lgkmcnt(7)
    ds_read_b128 a[244:247], v241 offset:35584
    v_mfma_f32_16x16x32_bf16 v[208:211], a[216:219], a[140:143], v[208:211]
    s_barrier
    v_cvt_pk_bf16_f32 v0, v84, v85
    v_cvt_pk_bf16_f32 v3, v86, v87
    v_mfma_f32_16x16x32_bf16 v[212:215], a[220:223], a[92:95], v[212:215]
    s_waitcnt lgkmcnt(5)
    v_lshlrev_b32 v46, 16, v46
    v_fma_f32 v46, v46, v52, v60
    v_mfma_f32_16x16x32_bf16 v[216:219], a[220:223], a[116:119], v[216:219]
    ds_read_b128 a[216:219], v240 offset:6144
    v_lshlrev_b32 v48, 16, v48
    v_mfma_f32_16x16x32_bf16 v[220:223], a[220:223], a[140:143], v[220:223]
    ds_read_b128 a[220:223], v241 offset:6144
    v_fma_f32 v48, v48, v52, v60
    v_mfma_f32_16x16x32_bf16 v[224:227], a[224:227], a[92:95], v[224:227]
    s_waitcnt lgkmcnt(5)
    v_cvt_pk_bf16_f32 v30, v204, v205
    v_cvt_pk_bf16_f32 v33, v206, v207
    v_mfma_f32_16x16x32_bf16 v[180:183], a[224:227], a[116:119], v[180:183]
    ds_write_b64 v62, v[34:35] offset:0
    v_mfma_f32_16x16x32_bf16 v[184:187], a[224:227], a[140:143], v[184:187]
    ds_read_b128 a[224:227], v240 offset:6272
    v_add_u32 v62, s49, v62
    v_mfma_f32_16x16x32_bf16 v[188:191], a[228:231], a[92:95], v[188:191]
    s_waitcnt lgkmcnt(5)
    v_cvt_pk_bf16_f32 v60, v208, v209
    v_cvt_pk_bf16_f32 v6, v212, v213
    v_mfma_f32_16x16x32_bf16 v[192:195], a[228:231], a[116:119], v[192:195]
    ds_write_b64 v63, v[64:65] offset:0
    v_mfma_f32_16x16x32_bf16 v[196:199], a[228:231], a[140:143], v[196:199]
    ds_read_b128 a[228:231], v241 offset:6272
    v_cvt_pk_bf16_f32 v63, v210, v211
    v_mfma_f32_16x16x32_bf16 v[200:203], a[232:235], a[92:95], v[200:203]
    buffer_load_dwordx4 v173, s[8:11], s60 offen offset:1024 lds
    v_cvt_pk_bf16_f32 v72, v184, v185
    v_mfma_f32_16x16x32_bf16 v[228:231], a[232:235], a[116:119], v[228:231]
    ds_write_b64 v62, v[36:37] offset:0
    v_mfma_f32_16x16x32_bf16 v[232:235], a[232:235], a[140:143], v[232:235]
    s_waitcnt lgkmcnt(7)
    v_add_u32 v62, s49, v62
    v_cvt_pk_bf16_f32 v78, v196, v197
    v_mfma_f32_16x16x32_bf16 v[236:239], a[236:239], a[92:95], v[236:239]
    ds_read_b128 a[232:235], v240 offset:6400
    v_cvt_pk_bf16_f32 v81, v198, v199
    v_mfma_f32_16x16x32_bf16 v[138:141], a[236:239], a[116:119], v[138:141]
    s_add_u32 s63, s39, 0x1b000
    v_cvt_pk_bf16_f32 v31, v228, v229
    v_cvt_pk_bf16_f32 v34, v230, v231
    v_mfma_f32_16x16x32_bf16 v[142:145], a[236:239], a[140:143], v[142:145]
    s_waitcnt lgkmcnt(7)
    v_cvt_pk_bf16_f32 v61, v232, v233
    v_cvt_pk_bf16_f32 v64, v234, v235
    v_mfma_f32_16x16x32_bf16 v[146:149], a[240:243], a[92:95], v[146:149]
    ds_read_b128 a[236:239], v241 offset:6400
    v_cvt_pk_bf16_f32 v7, v236, v237
    v_mfma_f32_16x16x32_bf16 v[150:153], a[240:243], a[116:119], v[150:153]
    s_add_u32 s59, s43, s45
    v_cvt_pk_bf16_f32 v10, v238, v239
    v_cvt_pk_bf16_f32 v37, v138, v139
    v_mfma_f32_16x16x32_bf16 v[154:157], a[240:243], a[140:143], v[154:157]
    buffer_load_dwordx4 v174, s[8:11], s60 offen offset:2048 lds
    v_cvt_pk_bf16_f32 v67, v142, v143
    v_mfma_f32_16x16x32_bf16 v[158:161], a[244:247], a[92:95], v[158:161]
    ds_write_b64 v62, v[38:39] offset:0
    v_mfma_f32_16x16x32_bf16 v[162:165], a[244:247], a[116:119], v[162:165]
    s_add_u32 m0, s29, 0xc00
    v_add_u32 v62, s49, v62
    v_cvt_pk_bf16_f32 v70, v144, v145
    v_mfma_f32_16x16x32_bf16 v[24:27], a[244:247], a[140:143], v[24:27]
    ds_write_b64 v62, v[40:41] offset:0
    v_mfma_f32_16x16x32_bf16 v[228:231], a[0:3], a[216:219], 0
    s_waitcnt lgkmcnt(5)
    v_cvt_pk_bf16_f32 v40, v140, v141
    v_add_u32 v62, s49, v62
    v_mfma_f32_16x16x32_bf16 v[228:231], a[4:7], a[220:223], v[228:231]
    ds_read_b128 a[240:243], v240 offset:36864
    v_cvt_pk_bf16_f32 v13, v146, v147
    v_mfma_f32_16x16x32_bf16 v[228:231], a[8:11], a[224:227], v[228:231]
    ds_read_b128 a[244:247], v241 offset:36864
    v_cvt_pk_bf16_f32 v79, v24, v25
    v_mfma_f32_16x16x32_bf16 v[228:231], a[12:15], a[228:231], v[228:231]
    buffer_load_dwordx4 v172, s[8:11], s61 offen lds
    v_cvt_pk_bf16_f32 v82, v26, v27
    v_mfma_f32_16x16x32_bf16 v[232:235], a[24:27], a[216:219], 0
    s_waitcnt lgkmcnt(5)
    v_cvt_pk_bf16_f32 v16, v148, v149
    v_cvt_pk_bf16_f32 v73, v154, v155
    v_mfma_f32_16x16x32_bf16 v[228:231], a[16:19], a[232:235], v[228:231]
    ds_write_b64 v62, v[42:43] offset:0
    v_mfma_f32_16x16x32_bf16 v[232:235], a[28:31], a[220:223], v[232:235]
    s_add_u32 s60, s39, 0x24000
    v_add_u32 v62, s49, v62
    s_waitcnt lgkmcnt(5)
    v_mfma_f32_16x16x32_bf16 v[228:231], a[20:23], a[236:239], v[228:231]
    ds_write_b64 v62, v[44:45] offset:0
    v_mfma_f32_16x16x32_bf16 v[232:235], a[32:35], a[224:227], v[232:235]
    s_lshl1_add_u32 s58, s45, s43
    v_add_u32 v62, s49, v62
    v_cvt_pk_bf16_f32 v43, v150, v151
    v_mfma_f32_16x16x32_bf16 v[232:235], a[36:39], a[228:231], v[232:235]
    ds_write_b64 v62, v[46:47] offset:0
    v_mfma_f32_16x16x32_bf16 v[232:235], a[40:43], a[232:235], v[232:235]
    s_mov_b32 vcc_lo, 0xcccccccc
    v_cvt_pk_bf16_f32 v138, v228, v229
    v_cvt_pk_bf16_f32 v139, v230, v231
    v_mfma_f32_16x16x32_bf16 v[232:235], a[44:47], a[236:239], v[232:235]
    s_mov_b32 vcc_hi, 0xcccccccc
    v_add_u32 v62, s49, v62
    v_cvt_pk_bf16_f32 v46, v152, v153
    v_mfma_f32_16x16x32_bf16 v[236:239], a[48:51], a[216:219], 0
    ds_write_b64 v62, v[48:49] offset:0
    v_mfma_f32_16x16x32_bf16 v[236:239], a[52:55], a[220:223], v[236:239]
    s_mul_i32 s66, s28, 0xffffee00
    v_add_u32 v62, s49, v62
    v_cvt_pk_bf16_f32 v140, v232, v233
    v_mfma_f32_16x16x32_bf16 v[236:239], a[56:59], a[224:227], v[236:239]
    v_cvt_pk_bf16_f32 v141, v234, v235
    v_cvt_pk_bf16_f32 v76, v156, v157
    v_mfma_f32_16x16x32_bf16 v[236:239], a[60:63], a[228:231], v[236:239]
    v_cvt_pk_bf16_f32 v19, v158, v159
    v_cvt_pk_bf16_f32 v22, v160, v161
    v_mfma_f32_16x16x32_bf16 v[236:239], a[64:67], a[232:235], v[236:239]
    v_cvt_pk_bf16_f32 v49, v162, v163
    v_cvt_pk_bf16_f32 v52, v164, v165
    v_mfma_f32_16x16x32_bf16 v[236:239], a[68:71], a[236:239], v[236:239]
    ds_read_b128 v[196:199], v244 offset:192
    v_cvt_pk_bf16_f32 v1, v200, v201
    v_mfma_f32_16x16x32_bf16 v[228:231], a[216:219], a[72:75], 0
    ds_read_b128 v[204:207], v246 offset:192
    v_cvt_pk_bf16_f32 v4, v202, v203
    v_mfma_f32_16x16x32_bf16 v[228:231], a[220:223], a[76:79], v[228:231]
    ds_read_b128 v[200:203], v245 offset:192
    v_cvt_pk_bf16_f32 v42, v180, v181
    v_mfma_f32_16x16x32_bf16 v[228:231], a[224:227], a[80:83], v[228:231]
    v_cvt_pk_bf16_f32 v142, v236, v237
    v_cvt_pk_bf16_f32 v143, v238, v239
    v_mfma_f32_16x16x32_bf16 v[228:231], a[228:231], a[84:87], v[228:231]
    ds_read_b128 v[208:211], v244 offset:256
    v_cvt_pk_bf16_f32 v45, v182, v183
    v_mfma_f32_16x16x32_bf16 v[228:231], a[232:235], a[88:91], v[228:231]
    v_cvt_pk_bf16_f32 v9, v214, v215
    v_cvt_pk_bf16_f32 v36, v216, v217
    v_mfma_f32_16x16x32_bf16 v[228:231], a[236:239], a[92:95], v[228:231]
    v_cvt_pk_bf16_f32 v39, v218, v219
    v_cvt_pk_bf16_f32 v66, v220, v221
    v_mfma_f32_16x16x32_bf16 v[232:235], a[216:219], a[96:99], 0
    v_cvt_pk_bf16_f32 v69, v222, v223
    v_cvt_pk_bf16_f32 v12, v224, v225
    v_mfma_f32_16x16x32_bf16 v[232:235], a[220:223], a[100:103], v[232:235]
    v_cvt_pk_bf16_f32 v15, v226, v227
    v_cvt_pk_bf16_f32 v75, v186, v187
    v_mfma_f32_16x16x32_bf16 v[232:235], a[224:227], a[104:107], v[232:235]
    v_cvt_pk_bf16_f32 v24, v228, v229
    v_cvt_pk_bf16_f32 v27, v230, v231
    v_mfma_f32_16x16x32_bf16 v[232:235], a[228:231], a[108:111], v[232:235]
    s_waitcnt lgkmcnt(4)
    v_cvt_pk_bf16_f32 v18, v188, v189
    v_cvt_pk_bf16_f32 v21, v190, v191
    v_mfma_f32_16x16x32_bf16 v[232:235], a[232:235], a[112:115], v[232:235]
    v_cvt_pk_bf16_f32 v48, v192, v193
    v_cvt_pk_bf16_f32 v51, v194, v195
    v_mfma_f32_16x16x32_bf16 v[232:235], a[236:239], a[116:119], v[232:235]
    v_mov_b32 v195, 0
    v_mfma_f32_16x16x32_bf16 v[236:239], a[216:219], a[120:123], 0
    ds_read_b128 a[216:219], v240 offset:36992
    v_mfma_f32_16x16x32_bf16 v[236:239], a[220:223], a[124:127], v[236:239]
    ds_read_b128 a[220:223], v241 offset:36992
    v_mfma_f32_16x16x32_bf16 v[236:239], a[224:227], a[128:131], v[236:239]
    ds_read_b128 a[224:227], v240 offset:37120
    v_mfma_f32_16x16x32_bf16 v[236:239], a[228:231], a[132:135], v[236:239]
    buffer_load_dwordx4 v173, s[8:11], s61 offen offset:1024 lds
    v_cvt_pk_bf16_f32 v54, v232, v233
    v_mfma_f32_16x16x32_bf16 v[236:239], a[232:235], a[136:139], v[236:239]
    ds_read_b128 a[228:231], v241 offset:37120
    v_cvt_pk_bf16_f32 v57, v234, v235
    v_mfma_f32_16x16x32_bf16 v[236:239], a[236:239], a[140:143], v[236:239]
    v_mfma_f32_16x16x32_bf16 v[228:231], a[0:3], a[240:243], 0
    v_mfma_f32_16x16x32_bf16 v[228:231], a[4:7], a[244:247], v[228:231]
    v_mfma_f32_16x16x32_bf16 v[232:235], a[24:27], a[240:243], 0
    v_mfma_f32_16x16x32_bf16 v[232:235], a[28:31], a[244:247], v[232:235]
    s_waitcnt lgkmcnt(3)
    v_mfma_f32_16x16x32_bf16 v[228:231], a[8:11], a[216:219], v[228:231]
    buffer_load_dwordx4 v174, s[8:11], s61 offen offset:2048 lds
    s_waitcnt lgkmcnt(2)
    v_mfma_f32_16x16x32_bf16 v[228:231], a[12:15], a[220:223], v[228:231]
    s_add_u32 m0, s29, 0x1800
    v_cvt_pk_bf16_f32 v84, v236, v237
    v_cvt_pk_bf16_f32 v87, v238, v239
    v_mfma_f32_16x16x32_bf16 v[232:235], a[32:35], a[216:219], v[232:235]
    s_add_u32 s61, s39, 0x2d000
    v_mfma_f32_16x16x32_bf16 v[232:235], a[36:39], a[220:223], v[232:235]
    v_mfma_f32_16x16x32_bf16 v[236:239], a[48:51], a[240:243], 0
    v_mfma_f32_16x16x32_bf16 v[236:239], a[52:55], a[244:247], v[236:239]
    s_waitcnt lgkmcnt(1)
    v_mfma_f32_16x16x32_bf16 v[228:231], a[16:19], a[224:227], v[228:231]
    v_mfma_f32_16x16x32_bf16 v[232:235], a[40:43], a[224:227], v[232:235]
    buffer_load_dwordx4 v172, s[8:11], s62 offen lds
    s_waitcnt lgkmcnt(0)
    v_mfma_f32_16x16x32_bf16 v[228:231], a[20:23], a[228:231], v[228:231]
    v_mfma_f32_16x16x32_bf16 v[232:235], a[44:47], a[228:231], v[232:235]
    v_mfma_f32_16x16x32_bf16 v[236:239], a[56:59], a[216:219], v[236:239]
    v_mfma_f32_16x16x32_bf16 v[236:239], a[60:63], a[220:223], v[236:239]
    v_mfma_f32_16x16x32_bf16 v[236:239], a[64:67], a[224:227], v[236:239]
    v_mfma_f32_16x16x32_bf16 v[236:239], a[68:71], a[228:231], v[236:239]
    s_waitcnt vmcnt(10)
    s_barrier
    ds_read_b128 a[232:235], v240 offset:61440
    buffer_load_dwordx4 v173, s[8:11], s62 offen offset:1024 lds
    v_cvt_pk_bf16_f32 v144, v228, v229
    v_cvt_pk_bf16_f32 v145, v230, v231
    v_mfma_f32_16x16x32_bf16 v[228:231], a[240:243], a[72:75], 0
    v_cvt_pk_bf16_f32 v146, v232, v233
    v_cvt_pk_bf16_f32 v147, v234, v235
    v_mfma_f32_16x16x32_bf16 v[228:231], a[244:247], a[76:79], v[228:231]
    ds_read_b128 a[236:239], v241 offset:61440
    v_cvt_pk_bf16_f32 v148, v236, v237
    v_mfma_f32_16x16x32_bf16 v[228:231], a[216:219], a[80:83], v[228:231]
    v_cvt_pk_bf16_f32 v149, v238, v239
    v_mfma_f32_16x16x32_bf16 v[228:231], a[220:223], a[84:87], v[228:231]
    v_mfma_f32_16x16x32_bf16 v[228:231], a[224:227], a[88:91], v[228:231]
    v_mfma_f32_16x16x32_bf16 v[228:231], a[228:231], a[92:95], v[228:231]
    v_mfma_f32_16x16x32_bf16 v[232:235], a[240:243], a[96:99], 0
    buffer_load_dwordx4 v174, s[8:11], s62 offen offset:2048 lds
    s_add_u32 m0, s29, 0x2400
    v_mfma_f32_16x16x32_bf16 v[232:235], a[244:247], a[100:103], v[232:235]
    s_lshl_b32 s62, s28, 5
    s_add_u32 s62, s62, 0
    v_mfma_f32_16x16x32_bf16 v[232:235], a[216:219], a[104:107], v[232:235]
    v_mfma_f32_16x16x32_bf16 v[232:235], a[220:223], a[108:111], v[232:235]
    v_cvt_pk_bf16_f32 v25, v228, v229
    v_cvt_pk_bf16_f32 v28, v230, v231
    v_mfma_f32_16x16x32_bf16 v[232:235], a[224:227], a[112:115], v[232:235]
    v_mfma_f32_16x16x32_bf16 v[232:235], a[228:231], a[116:119], v[232:235]
    v_mfma_f32_16x16x32_bf16 v[236:239], a[240:243], a[120:123], 0
    ds_read_b128 a[240:243], v240 offset:61568
    s_waitcnt lgkmcnt(2)
    v_mfma_f32_16x16x32_bf16 v[236:239], a[244:247], a[124:127], v[236:239]
    ds_read_b128 a[244:247], v241 offset:61568
    v_mfma_f32_16x16x32_bf16 v[236:239], a[216:219], a[128:131], v[236:239]
    ds_read_b128 a[216:219], v240 offset:61696
    v_mfma_f32_16x16x32_bf16 v[236:239], a[220:223], a[132:135], v[236:239]
    ds_read_b128 a[220:223], v241 offset:61696
    v_cvt_pk_bf16_f32 v55, v232, v233
    v_mfma_f32_16x16x32_bf16 v[236:239], a[224:227], a[136:139], v[236:239]
    ds_read_b128 a[224:227], v240 offset:62976
    v_cvt_pk_bf16_f32 v58, v234, v235
    v_mfma_f32_16x16x32_bf16 v[236:239], a[228:231], a[140:143], v[236:239]
    ds_read_b128 a[228:231], v241 offset:62976
    v_mfma_f32_16x16x32_bf16 v[228:231], a[0:3], a[232:235], 0
    s_waitcnt lgkmcnt(6)
    v_mfma_f32_16x16x32_bf16 v[228:231], a[4:7], a[236:239], v[228:231]
    v_mfma_f32_16x16x32_bf16 v[232:235], a[24:27], a[232:235], 0
    buffer_load_dwordx4 v172, s[8:11], s63 offen lds
    v_mfma_f32_16x16x32_bf16 v[232:235], a[28:31], a[236:239], v[232:235]
    s_waitcnt lgkmcnt(5)
    v_cvt_pk_bf16_f32 v85, v236, v237
    v_cvt_pk_bf16_f32 v88, v238, v239
    v_mfma_f32_16x16x32_bf16 v[228:231], a[8:11], a[240:243], v[228:231]
    v_mfma_f32_16x16x32_bf16 v[232:235], a[32:35], a[240:243], v[232:235]
    s_waitcnt lgkmcnt(4)
    v_mfma_f32_16x16x32_bf16 v[228:231], a[12:15], a[244:247], v[228:231]
    s_waitcnt lgkmcnt(3)
    v_mfma_f32_16x16x32_bf16 v[228:231], a[16:19], a[216:219], v[228:231]
    s_waitcnt lgkmcnt(2)
    v_mfma_f32_16x16x32_bf16 v[228:231], a[20:23], a[220:223], v[228:231]
    v_mfma_f32_16x16x32_bf16 v[232:235], a[36:39], a[244:247], v[232:235]
    buffer_load_dwordx4 v173, s[8:11], s63 offen offset:1024 lds
    v_mfma_f32_16x16x32_bf16 v[232:235], a[40:43], a[216:219], v[232:235]
    v_mfma_f32_16x16x32_bf16 v[232:235], a[44:47], a[220:223], v[232:235]
    v_mfma_f32_16x16x32_bf16 v[236:239], a[48:51], a[232:235], 0
    v_mfma_f32_16x16x32_bf16 v[236:239], a[52:55], a[236:239], v[236:239]
    v_mfma_f32_16x16x32_bf16 v[236:239], a[56:59], a[240:243], v[236:239]
    v_mfma_f32_16x16x32_bf16 v[236:239], a[60:63], a[244:247], v[236:239]
    v_cvt_pk_bf16_f32 v150, v228, v229
    v_cvt_pk_bf16_f32 v151, v230, v231
    v_mfma_f32_16x16x32_bf16 v[236:239], a[64:67], a[216:219], v[236:239]
    buffer_load_dwordx4 v174, s[8:11], s63 offen offset:2048 lds
    s_add_u32 m0, s29, 0
    v_mfma_f32_16x16x32_bf16 v[236:239], a[68:71], a[220:223], v[236:239]
    s_lshl_b32 s63, s28, 5
    v_cvt_pk_bf16_f32 v152, v232, v233
    v_cvt_pk_bf16_f32 v153, v234, v235
    v_mfma_f32_16x16x32_bf16 v[228:231], a[232:235], a[72:75], 0
    s_add_u32 s63, s63, 0x4800
    v_mfma_f32_16x16x32_bf16 v[228:231], a[236:239], a[76:79], v[228:231]
    v_mfma_f32_16x16x32_bf16 v[228:231], a[240:243], a[80:83], v[228:231]
    v_mfma_f32_16x16x32_bf16 v[228:231], a[244:247], a[84:87], v[228:231]
    v_cvt_pk_bf16_f32 v154, v236, v237
    v_cvt_pk_bf16_f32 v155, v238, v239
    v_mfma_f32_16x16x32_bf16 v[228:231], a[216:219], a[88:91], v[228:231]
    v_mfma_f32_16x16x32_bf16 v[228:231], a[220:223], a[92:95], v[228:231]
    v_mfma_f32_16x16x32_bf16 v[232:235], a[232:235], a[96:99], 0
    s_waitcnt vmcnt(9)
    ds_read_b64_tr_b16 a[144:145], v249 offset:0
    v_mfma_f32_16x16x32_bf16 v[232:235], a[236:239], a[100:103], v[232:235]
    ds_read_b64_tr_b16 a[146:147], v250 offset:0
    ds_read_b64_tr_b16 a[168:169], v249 offset:32
    v_mfma_f32_16x16x32_bf16 v[232:235], a[240:243], a[104:107], v[232:235]
    ds_read_b64_tr_b16 a[170:171], v250 offset:32
    ds_read_b64_tr_b16 a[192:193], v249 offset:64
    v_mfma_f32_16x16x32_bf16 v[232:235], a[244:247], a[108:111], v[232:235]
    ds_read_b64_tr_b16 a[194:195], v250 offset:64
    v_cvt_pk_bf16_f32 v2, v228, v229
    v_mfma_f32_16x16x32_bf16 v[232:235], a[216:219], a[112:115], v[232:235]
    v_cvt_pk_bf16_f32 v5, v230, v231
    s_waitcnt lgkmcnt(6)
    v_mfma_f32_16x16x32_bf16 v[232:235], a[220:223], a[116:119], v[232:235]
    v_mfma_f32_16x16x32_bf16 v[236:239], a[232:235], a[120:123], 0
    ds_read_b128 a[232:235], v240 offset:63104
    v_mfma_f32_16x16x32_bf16 v[236:239], a[236:239], a[124:127], v[236:239]
    ds_read_b128 a[236:239], v241 offset:63104
    v_mfma_f32_16x16x32_bf16 v[236:239], a[240:243], a[128:131], v[236:239]
    ds_read_b128 a[240:243], v240 offset:63232
    v_mfma_f32_16x16x32_bf16 v[236:239], a[244:247], a[132:135], v[236:239]
    ds_read_b128 a[244:247], v241 offset:63232
    v_cvt_pk_bf16_f32 v32, v232, v233
    v_mfma_f32_16x16x32_bf16 v[236:239], a[216:219], a[136:139], v[236:239]
    ds_read_b128 a[216:219], v240 offset:64512
    v_cvt_pk_bf16_f32 v35, v234, v235
    v_mfma_f32_16x16x32_bf16 v[236:239], a[220:223], a[140:143], v[236:239]
    ds_read_b128 a[220:223], v241 offset:64512
    s_waitcnt lgkmcnt(6)
    v_mfma_f32_16x16x32_bf16 v[228:231], a[0:3], a[224:227], 0
    buffer_load_dwordx4 v172, s[8:11], s60 offen lds
    v_mfma_f32_16x16x32_bf16 v[228:231], a[4:7], a[228:231], v[228:231]
    s_waitcnt vmcnt(7)
    ds_read_b64_tr_b16 a[148:149], v249 offset:3072
    v_mfma_f32_16x16x32_bf16 v[232:235], a[24:27], a[224:227], 0
    ds_read_b64_tr_b16 a[150:151], v250 offset:3072
    ds_read_b64_tr_b16 a[172:173], v249 offset:3104
    v_mfma_f32_16x16x32_bf16 v[232:235], a[28:31], a[228:231], v[232:235]
    s_waitcnt lgkmcnt(8)
    ds_read_b64_tr_b16 a[174:175], v250 offset:3104
    v_mfma_f32_16x16x32_bf16 v[228:231], a[8:11], a[232:235], v[228:231]
    ds_read_b64_tr_b16 a[196:197], v249 offset:3136
    ds_read_b64_tr_b16 a[198:199], v250 offset:3136
    v_mfma_f32_16x16x32_bf16 v[232:235], a[32:35], a[232:235], v[232:235]
    s_waitcnt lgkmcnt(10)
    v_cvt_pk_bf16_f32 v62, v236, v237
    v_cvt_pk_bf16_f32 v65, v238, v239
    v_mfma_f32_16x16x32_bf16 v[228:231], a[12:15], a[236:239], v[228:231]
    s_waitcnt lgkmcnt(9)
    v_mfma_f32_16x16x32_bf16 v[228:231], a[16:19], a[240:243], v[228:231]
    buffer_load_dwordx4 v173, s[8:11], s60 offen offset:1024 lds
    s_waitcnt lgkmcnt(8)
    v_mfma_f32_16x16x32_bf16 v[228:231], a[20:23], a[244:247], v[228:231]
    v_mfma_f32_16x16x32_bf16 v[232:235], a[36:39], a[236:239], v[232:235]
    v_mfma_f32_16x16x32_bf16 v[232:235], a[40:43], a[240:243], v[232:235]
    v_mfma_f32_16x16x32_bf16 v[232:235], a[44:47], a[244:247], v[232:235]
    v_mfma_f32_16x16x32_bf16 v[236:239], a[48:51], a[224:227], 0
    v_mfma_f32_16x16x32_bf16 v[236:239], a[52:55], a[228:231], v[236:239]
    v_mfma_f32_16x16x32_bf16 v[236:239], a[56:59], a[232:235], v[236:239]
    buffer_load_dwordx4 v174, s[8:11], s60 offen offset:2048 lds
    s_add_u32 m0, s29, 0xc00
    v_mfma_f32_16x16x32_bf16 v[236:239], a[60:63], a[236:239], v[236:239]
    s_waitcnt lgkmcnt(0)
    v_cvt_pk_bf16_f32 v156, v228, v229
    v_cvt_pk_bf16_f32 v157, v230, v231
    v_mfma_f32_16x16x32_bf16 v[236:239], a[64:67], a[240:243], v[236:239]
    s_lshl_b32 s60, s28, 5
    v_cvt_pk_bf16_f32 v158, v232, v233
    v_cvt_pk_bf16_f32 v159, v234, v235
    v_mfma_f32_16x16x32_bf16 v[236:239], a[68:71], a[244:247], v[236:239]
    s_add_u32 s60, s60, 0x1800
    v_mfma_f32_16x16x32_bf16 v[228:231], a[224:227], a[72:75], 0
    v_mfma_f32_16x16x32_bf16 v[228:231], a[228:231], a[76:79], v[228:231]
    v_mfma_f32_16x16x32_bf16 v[228:231], a[232:235], a[80:83], v[228:231]
    v_mfma_f32_16x16x32_bf16 v[228:231], a[236:239], a[84:87], v[228:231]
    buffer_load_dwordx4 v172, s[8:11], s61 offen lds
    v_mfma_f32_16x16x32_bf16 v[228:231], a[240:243], a[88:91], v[228:231]
    v_mfma_f32_16x16x32_bf16 v[228:231], a[244:247], a[92:95], v[228:231]
    v_cvt_pk_bf16_f32 v160, v236, v237
    v_cvt_pk_bf16_f32 v161, v238, v239
    v_mfma_f32_16x16x32_bf16 v[232:235], a[224:227], a[96:99], 0
    v_mfma_f32_16x16x32_bf16 v[232:235], a[228:231], a[100:103], v[232:235]
    v_mfma_f32_16x16x32_bf16 v[232:235], a[232:235], a[104:107], v[232:235]
    v_mfma_f32_16x16x32_bf16 v[232:235], a[236:239], a[108:111], v[232:235]
    v_mfma_f32_16x16x32_bf16 v[232:235], a[240:243], a[112:115], v[232:235]
    buffer_load_dwordx4 v173, s[8:11], s61 offen offset:1024 lds
    v_cvt_pk_bf16_f32 v8, v228, v229
    v_mfma_f32_16x16x32_bf16 v[232:235], a[244:247], a[116:119], v[232:235]
    v_cvt_pk_bf16_f32 v11, v230, v231
    v_mfma_f32_16x16x32_bf16 v[236:239], a[224:227], a[120:123], 0
    ds_read_b128 a[224:227], v240 offset:64640
    v_mfma_f32_16x16x32_bf16 v[236:239], a[228:231], a[124:127], v[236:239]
    ds_read_b128 a[228:231], v241 offset:64640
    v_mfma_f32_16x16x32_bf16 v[236:239], a[232:235], a[128:131], v[236:239]
    ds_read_b128 a[232:235], v240 offset:64768
    v_add_u32 v240, 0xf000, v240
    v_mfma_f32_16x16x32_bf16 v[236:239], a[236:239], a[132:135], v[236:239]
    ds_read_b128 a[236:239], v241 offset:64768
    v_cvt_pk_bf16_f32 v38, v232, v233
    v_mfma_f32_16x16x32_bf16 v[236:239], a[240:243], a[136:139], v[236:239]
    ds_read_b128 a[240:243], v242 offset:0
    v_cvt_pk_bf16_f32 v41, v234, v235
    v_mfma_f32_16x16x32_bf16 v[236:239], a[244:247], a[140:143], v[236:239]
    buffer_load_dwordx4 v174, s[8:11], s61 offen offset:2048 lds
    v_add_u32 v241, 0xf000, v241
    v_mfma_f32_16x16x32_bf16 v[228:231], a[0:3], a[216:219], 0
    ds_read_b128 a[244:247], v243 offset:0
    s_add_u32 m0, s46, 0x16800
    v_mfma_f32_16x16x32_bf16 v[228:231], a[4:7], a[220:223], v[228:231]
    s_lshl_b32 s61, s28, 5
    s_add_u32 s61, s61, 0x6000
    v_cvt_pk_bf16_f32 v68, v236, v237
    v_mfma_f32_16x16x32_bf16 v[232:235], a[24:27], a[216:219], 0
    v_cvt_pk_bf16_f32 v71, v238, v239
    s_waitcnt lgkmcnt(5)
    v_mfma_f32_16x16x32_bf16 v[228:231], a[8:11], a[224:227], v[228:231]
    v_mfma_f32_16x16x32_bf16 v[232:235], a[28:31], a[220:223], v[232:235]
    s_waitcnt lgkmcnt(4)
    v_mfma_f32_16x16x32_bf16 v[228:231], a[12:15], a[228:231], v[228:231]
    s_waitcnt lgkmcnt(3)
    v_mfma_f32_16x16x32_bf16 v[228:231], a[16:19], a[232:235], v[228:231]
    s_waitcnt lgkmcnt(2)
    v_mfma_f32_16x16x32_bf16 v[228:231], a[20:23], a[236:239], v[228:231]
    v_mfma_f32_16x16x32_bf16 v[232:235], a[32:35], a[224:227], v[232:235]
    v_mfma_f32_16x16x32_bf16 v[232:235], a[36:39], a[228:231], v[232:235]
    v_mfma_f32_16x16x32_bf16 v[232:235], a[40:43], a[232:235], v[232:235]
    v_mfma_f32_16x16x32_bf16 v[232:235], a[44:47], a[236:239], v[232:235]
    v_mfma_f32_16x16x32_bf16 v[236:239], a[48:51], a[216:219], 0
    v_mfma_f32_16x16x32_bf16 v[236:239], a[52:55], a[220:223], v[236:239]
    v_mfma_f32_16x16x32_bf16 v[236:239], a[56:59], a[224:227], v[236:239]
    v_mfma_f32_16x16x32_bf16 v[236:239], a[60:63], a[228:231], v[236:239]
    v_cvt_pk_bf16_f32 v162, v228, v229
    v_cvt_pk_bf16_f32 v163, v230, v231
    v_mfma_f32_16x16x32_bf16 v[236:239], a[64:67], a[232:235], v[236:239]
    v_mfma_f32_16x16x32_bf16 v[236:239], a[68:71], a[236:239], v[236:239]
    v_cvt_pk_bf16_f32 v164, v232, v233
    v_cvt_pk_bf16_f32 v165, v234, v235
    v_mfma_f32_16x16x32_bf16 v[228:231], a[216:219], a[72:75], 0
    v_mfma_f32_16x16x32_bf16 v[228:231], a[220:223], a[76:79], v[228:231]
    v_mfma_f32_16x16x32_bf16 v[228:231], a[224:227], a[80:83], v[228:231]
    v_mfma_f32_16x16x32_bf16 v[228:231], a[228:231], a[84:87], v[228:231]
    v_mfma_f32_16x16x32_bf16 v[228:231], a[232:235], a[88:91], v[228:231]
    v_mfma_f32_16x16x32_bf16 v[228:231], a[236:239], a[92:95], v[228:231]
    v_cvt_pk_bf16_f32 v166, v236, v237
    v_cvt_pk_bf16_f32 v167, v238, v239
    v_mfma_f32_16x16x32_bf16 v[232:235], a[216:219], a[96:99], 0
    v_mfma_f32_16x16x32_bf16 v[232:235], a[220:223], a[100:103], v[232:235]
    v_mfma_f32_16x16x32_bf16 v[232:235], a[224:227], a[104:107], v[232:235]
    v_mfma_f32_16x16x32_bf16 v[232:235], a[228:231], a[108:111], v[232:235]
    v_mfma_f32_16x16x32_bf16 v[232:235], a[232:235], a[112:115], v[232:235]
    s_waitcnt vmcnt(9)
    ds_read_b64_tr_b16 a[152:153], v249 offset:6144
    v_mfma_f32_16x16x32_bf16 v[232:235], a[236:239], a[116:119], v[232:235]
    ds_read_b64_tr_b16 a[154:155], v250 offset:6144
    s_waitcnt vmcnt(6)
    v_mfma_f32_16x16x32_bf16 v[236:239], a[216:219], a[120:123], 0
    ds_read_b128 a[216:219], v242 offset:128
    ds_read_b64_tr_b16 a[156:157], v249 offset:9216
    v_mfma_f32_16x16x32_bf16 v[236:239], a[220:223], a[124:127], v[236:239]
    ds_read_b64_tr_b16 a[158:159], v250 offset:9216
    ds_read_b128 a[220:223], v243 offset:128
    v_mfma_f32_16x16x32_bf16 v[236:239], a[224:227], a[128:131], v[236:239]
    s_waitcnt vmcnt(3)
    ds_read_b64_tr_b16 a[160:161], v249 offset:0
    v_mfma_f32_16x16x32_bf16 v[236:239], a[228:231], a[132:135], v[236:239]
    ds_read_b64_tr_b16 a[162:163], v250 offset:0
    ds_read_b128 a[224:227], v242 offset:256
    v_mfma_f32_16x16x32_bf16 v[236:239], a[232:235], a[136:139], v[236:239]
    ds_read_b128 a[228:231], v243 offset:256
    ds_read_b64_tr_b16 a[176:177], v249 offset:6176
    v_mfma_f32_16x16x32_bf16 v[236:239], a[236:239], a[140:143], v[236:239]
    ds_read_b64_tr_b16 a[178:179], v250 offset:6176
    ds_read_b64_tr_b16 a[180:181], v249 offset:9248
    ds_read_b64_tr_b16 a[182:183], v250 offset:9248
    v_cvt_pk_bf16_f32 v14, v228, v229
    v_cvt_pk_bf16_f32 v17, v230, v231
    s_waitcnt lgkmcnt(14)
    v_mfma_f32_16x16x32_bf16 v[228:231], a[144:147], a[240:243], 0
    ds_read_b64_tr_b16 a[184:185], v249 offset:32
    ds_read_b64_tr_b16 a[186:187], v250 offset:32
    v_mfma_f32_16x16x32_bf16 v[228:231], a[148:151], a[244:247], v[228:231]
    s_waitcnt lgkmcnt(13)
    v_cvt_pk_bf16_f32 v44, v232, v233
    v_cvt_pk_bf16_f32 v47, v234, v235
    v_mfma_f32_16x16x32_bf16 v[228:231], a[152:155], a[216:219], v[228:231]
    ds_read_b64_tr_b16 a[200:201], v249 offset:6208
    ds_read_b64_tr_b16 a[202:203], v250 offset:6208
    v_mfma_f32_16x16x32_bf16 v[232:235], a[168:171], a[240:243], 0
    s_waitcnt lgkmcnt(12)
    ds_read_b64_tr_b16 a[204:205], v249 offset:9280
    v_mfma_f32_16x16x32_bf16 v[228:231], a[156:159], a[220:223], v[228:231]
    ds_read_b64_tr_b16 a[206:207], v250 offset:9280
    ds_read_b64_tr_b16 a[208:209], v249 offset:64
    v_mfma_f32_16x16x32_bf16 v[232:235], a[172:175], a[244:247], v[232:235]
    s_waitcnt lgkmcnt(12)
    ds_read_b64_tr_b16 a[210:211], v250 offset:64
    v_mfma_f32_16x16x32_bf16 v[228:231], a[160:163], a[224:227], v[228:231]
    ds_read_b128 a[232:235], v242 offset:1536
    ds_read_b128 a[236:239], v243 offset:1536
    s_waitcnt lgkmcnt(12)
    v_mfma_f32_16x16x32_bf16 v[232:235], a[176:179], a[216:219], v[232:235]
    v_cvt_pk_bf16_f32 v74, v236, v237
    s_waitcnt lgkmcnt(10)
    v_mfma_f32_16x16x32_bf16 v[232:235], a[180:183], a[220:223], v[232:235]
    v_cvt_pk_bf16_f32 v77, v238, v239
    s_waitcnt lgkmcnt(8)
    v_mfma_f32_16x16x32_bf16 v[232:235], a[184:187], a[224:227], v[232:235]
    v_mfma_f32_16x16x32_bf16 v[236:239], a[192:195], a[240:243], 0
    ds_read_b128 a[240:243], v242 offset:1664
    v_mfma_f32_16x16x32_bf16 v[236:239], a[196:199], a[244:247], v[236:239]
    s_waitcnt lgkmcnt(7)
    s_waitcnt vmcnt(0)
    v_mfma_f32_16x16x32_bf16 v[236:239], a[200:203], a[216:219], v[236:239]
    s_waitcnt lgkmcnt(5)
    ds_read_b64_tr_b16 a[164:165], v249 offset:3072
    v_mfma_f32_16x16x32_bf16 v[236:239], a[204:207], a[220:223], v[236:239]
    ds_read_b64_tr_b16 a[166:167], v250 offset:3072
    s_waitcnt lgkmcnt(5)
    v_mfma_f32_16x16x32_bf16 v[236:239], a[208:211], a[224:227], v[236:239]
    ds_read_b64_tr_b16 a[188:189], v249 offset:3104
    ds_read_b64_tr_b16 a[190:191], v250 offset:3104
    ds_read_b64_tr_b16 a[212:213], v249 offset:3136
    ds_read_b64_tr_b16 a[214:215], v250 offset:3136
    ds_read_b128 a[244:247], v243 offset:1664
    ds_read_b128 a[216:219], v242 offset:1792
    ds_read_b128 a[220:223], v243 offset:1792
    v_add_u32 v249, s66, v249
    v_add_u32 v250, s66, v250
    s_lshl_b32 s66, s28, 1
    s_waitcnt lgkmcnt(7)
    v_mfma_f32_16x16x32_bf16 v[228:231], a[164:167], a[228:231], v[228:231]
    s_nop 7
    s_waitcnt lgkmcnt(3)
    v_mfma_f32_16x16x32_bf16 v[232:235], a[188:191], a[228:231], v[232:235]
    s_barrier
    v_mul_f32 v228, s38, v228
    v_mul_f32 v229, s38, v229
    v_mfma_f32_16x16x32_bf16 v[236:239], a[212:215], a[228:231], v[236:239]
    v_mul_f32 v230, s38, v230
    v_mul_f32 v231, s38, v231
    v_cvt_pk_bf16_f32 v168, v228, v229
    v_cvt_pk_bf16_f32 v169, v230, v231
    v_mfma_f32_16x16x32_bf16 v[228:231], a[144:147], a[232:235], 0
L_h3:
    s_cbranch_execz L_h7
    v_mul_f32 v232, s3, v232
    v_mul_f32 v233, s3, v233
    v_mfma_f32_16x16x32_bf16 v[228:231], a[148:151], a[236:239], v[228:231]
    v_mul_f32 v234, s3, v234
    v_mul_f32 v235, s3, v235
    v_mfma_f32_16x16x32_bf16 v[228:231], a[152:155], a[240:243], v[228:231]
    s_waitcnt lgkmcnt(2)
    v_cvt_pk_bf16_f32 v170, v232, v233
    v_cvt_pk_bf16_f32 v171, v234, v235
    v_mfma_f32_16x16x32_bf16 v[228:231], a[156:159], a[244:247], v[228:231]
    v_mul_f32 v236, s38, v236
    v_mul_f32 v237, s38, v237
    v_mfma_f32_16x16x32_bf16 v[196:199], v[102:105], v[168:171], v[196:199]
    s_waitcnt lgkmcnt(1)
    v_mul_f32 v238, s38, v238
    v_mul_f32 v239, s38, v239
    v_mfma_f32_16x16x32_bf16 v[200:203], v[114:117], v[168:171], v[200:203]
    v_cvt_pk_bf16_f32 v172, v236, v237
    v_cvt_pk_bf16_f32 v173, v238, v239
    v_mfma_f32_16x16x32_bf16 v[204:207], v[150:153], v[168:171], v[204:207]
    ds_read_b128 a[224:227], v240 offset:4608
    ds_read_b128 a[228:231], v241 offset:4608
    v_mfma_f32_16x16x32_bf16 v[196:199], v[104:107], v[170:173], v[196:199]
    buffer_load_dwordx4 v254, s[4:7], s43 offen lds
    v_accvgpr_read_b32 v254, a254
    v_mfma_f32_16x16x32_bf16 v[200:203], v[116:119], v[170:173], v[200:203]
    v_mfma_f32_16x16x32_bf16 v[204:207], v[152:155], v[170:173], v[204:207]
    v_mfma_f32_16x16x32_bf16 v[208:211], v[108:111], v[168:171], v[208:211]
    v_mfma_f32_16x16x32_bf16 v[208:211], v[110:113], v[170:173], v[208:211]
    buffer_load_dwordx4 v255, s[4:7], s43 offen offset:1024 lds
    v_accvgpr_read_b32 v255, a252
    v_mfma_f32_16x16x32_bf16 v[228:231], a[160:163], a[216:219], v[228:231]
    s_waitcnt lgkmcnt(2)
    v_exp_f32 v196, v196
    v_mfma_f32_16x16x32_bf16 v[228:231], a[164:167], a[220:223], v[228:231]
    v_exp_f32 v197, v197
    v_mfma_f32_16x16x32_bf16 v[232:235], a[168:171], a[232:235], 0
    v_exp_f32 v198, v198
    v_mfma_f32_16x16x32_bf16 v[232:235], a[172:175], a[236:239], v[232:235]
    v_exp_f32 v199, v199
    v_mfma_f32_16x16x32_bf16 v[232:235], a[176:179], a[240:243], v[232:235]
    v_cvt_pk_bf16_f32 v180, v196, v197
    v_cvt_pk_bf16_f32 v183, v198, v199
    v_mfma_f32_16x16x32_bf16 v[232:235], a[180:183], a[244:247], v[232:235]
    ds_read_b128 v[196:199], v245 offset:256
    v_mul_f32 v228, s38, v228
    v_mfma_f32_16x16x32_bf16 v[232:235], a[184:187], a[216:219], v[232:235]
    v_mul_f32 v229, s38, v229
    v_mul_f32 v230, s38, v230
    v_mfma_f32_16x16x32_bf16 v[232:235], a[188:191], a[220:223], v[232:235]
    v_mul_f32 v231, s38, v231
    v_cvt_pk_bf16_f32 v174, v228, v229
    v_mfma_f32_16x16x32_bf16 v[236:239], a[192:195], a[232:235], 0
    ds_read_b128 a[232:235], v240 offset:4736
    v_cvt_pk_bf16_f32 v175, v230, v231
    v_mfma_f32_16x16x32_bf16 v[236:239], a[196:199], a[236:239], v[236:239]
    s_waitcnt lgkmcnt(2)
    ds_read_b128 a[236:239], v241 offset:4736
    v_mfma_f32_16x16x32_bf16 v[236:239], a[200:203], a[240:243], v[236:239]
    ds_read_b128 a[240:243], v240 offset:4864
    v_mul_f32 v232, s3, v232
    v_mfma_f32_16x16x32_bf16 v[236:239], a[204:207], a[244:247], v[236:239]
    v_mul_f32 v233, s3, v233
    v_mul_f32 v234, s3, v234
    v_mfma_f32_16x16x32_bf16 v[236:239], a[208:211], a[216:219], v[236:239]
    ds_read_b128 a[244:247], v241 offset:4864
    v_mul_f32 v235, s3, v235
    v_mfma_f32_16x16x32_bf16 v[236:239], a[212:215], a[220:223], v[236:239]
    v_cvt_pk_bf16_f32 v176, v232, v233
    v_cvt_pk_bf16_f32 v177, v234, v235
    v_mfma_f32_16x16x32_bf16 v[228:231], a[0:3], a[224:227], 0
    s_waitcnt lgkmcnt(4)
    v_exp_f32 v200, v200
    v_mfma_f32_16x16x32_bf16 v[196:199], v[120:123], v[168:171], v[196:199]
    buffer_load_dwordx4 v254, s[4:7], s43 offen offset:2048 lds
    v_accvgpr_read_b32 v254, a253
    v_mfma_f32_16x16x32_bf16 v[196:199], v[122:125], v[170:173], v[196:199]
    s_add_u32 m0, s46, 0x17400
    v_mul_f32 v236, s38, v236
    v_mul_f32 v237, s38, v237
    v_mfma_f32_16x16x32_bf16 v[228:231], a[4:7], a[228:231], v[228:231]
    v_mul_f32 v238, s38, v238
    v_mul_f32 v239, s38, v239
    v_mfma_f32_16x16x32_bf16 v[232:235], a[24:27], a[224:227], 0
    v_cvt_pk_bf16_f32 v178, v236, v237
    v_cvt_pk_bf16_f32 v179, v238, v239
    v_mfma_f32_16x16x32_bf16 v[232:235], a[28:31], a[228:231], v[232:235]
    s_waitcnt lgkmcnt(3)
    v_exp_f32 v201, v201
    v_mfma_f32_16x16x32_bf16 v[228:231], a[8:11], a[232:235], v[228:231]
    s_waitcnt lgkmcnt(2)
    v_exp_f32 v202, v202
    v_mfma_f32_16x16x32_bf16 v[228:231], a[12:15], a[236:239], v[228:231]
    s_waitcnt lgkmcnt(1)
    v_exp_f32 v203, v203
    v_mfma_f32_16x16x32_bf16 v[228:231], a[16:19], a[240:243], v[228:231]
    s_waitcnt lgkmcnt(0)
    v_cvt_pk_bf16_f32 v181, v200, v201
    v_cvt_pk_bf16_f32 v184, v202, v203
    v_mfma_f32_16x16x32_bf16 v[228:231], a[20:23], a[244:247], v[228:231]
    ds_read_b128 v[200:203], v246 offset:256
    ds_read_b128 a[216:219], v242 offset:3072
    v_mfma_f32_16x16x32_bf16 v[232:235], a[32:35], a[232:235], v[232:235]
    v_exp_f32 v204, v204
    v_mfma_f32_16x16x32_bf16 v[232:235], a[36:39], a[236:239], v[232:235]
    v_exp_f32 v205, v205
    v_mfma_f32_16x16x32_bf16 v[232:235], a[40:43], a[240:243], v[232:235]
    ds_read_b128 a[220:223], v243 offset:3072
    v_cvt_pk_bf16_f32 v182, v204, v205
    v_mfma_f32_16x16x32_bf16 v[232:235], a[44:47], a[244:247], v[232:235]
    v_exp_f32 v206, v206
    v_mfma_f32_16x16x32_bf16 v[212:215], v[0:3], v[180:183], 0
    v_exp_f32 v207, v207
    v_mfma_f32_16x16x32_bf16 v[216:219], v[30:33], v[180:183], 0
    v_cvt_pk_bf16_f32 v185, v206, v207
    v_cvt_pk_bf16_f32 v102, v228, v229
    v_mfma_f32_16x16x32_bf16 v[220:223], v[60:63], v[180:183], 0
    ds_read_b128 v[204:207], v244 offset:320
    v_cvt_pk_bf16_f32 v103, v230, v231
    v_mfma_f32_16x16x32_bf16 v[224:227], a[248:251], v[180:183], 0
    v_exp_f32 v208, v208
    v_mfma_f32_16x16x32_bf16 v[236:239], a[48:51], a[224:227], 0
    s_waitcnt lgkmcnt(3)
    v_exp_f32 v209, v209
    v_mfma_f32_16x16x32_bf16 v[200:203], v[156:159], v[168:171], v[200:203]
    v_exp_f32 v210, v210
    v_mfma_f32_16x16x32_bf16 v[200:203], v[158:161], v[170:173], v[200:203]
    v_exp_f32 v211, v211
    v_mfma_f32_16x16x32_bf16 v[236:239], a[52:55], a[228:231], v[236:239]
    v_cvt_pk_bf16_f32 v186, v208, v209
    v_cvt_pk_bf16_f32 v189, v210, v211
    v_mfma_f32_16x16x32_bf16 v[236:239], a[56:59], a[232:235], v[236:239]
    ds_read_b128 v[208:211], v245 offset:320
    v_cvt_pk_bf16_f32 v104, v232, v233
    v_mfma_f32_16x16x32_bf16 v[236:239], a[60:63], a[236:239], v[236:239]
    v_exp_f32 v196, v196
    v_mfma_f32_16x16x32_bf16 v[236:239], a[64:67], a[240:243], v[236:239]
    v_exp_f32 v197, v197
    v_mfma_f32_16x16x32_bf16 v[236:239], a[68:71], a[244:247], v[236:239]
    s_waitcnt lgkmcnt(1)
    v_cvt_pk_bf16_f32 v187, v196, v197
    v_cvt_pk_bf16_f32 v105, v234, v235
    v_mfma_f32_16x16x32_bf16 v[204:207], v[90:93], v[168:171], v[204:207]
    v_exp_f32 v198, v198
    v_mfma_f32_16x16x32_bf16 v[212:215], v[4:7], v[184:187], v[212:215]
    v_exp_f32 v199, v199
    v_mfma_f32_16x16x32_bf16 v[216:219], v[34:37], v[184:187], v[216:219]
    v_cvt_pk_bf16_f32 v190, v198, v199
    v_cvt_pk_bf16_f32 v106, v236, v237
    v_mfma_f32_16x16x32_bf16 v[220:223], v[64:67], v[184:187], v[220:223]
    ds_read_b128 v[196:199], v246 offset:320
    v_cvt_pk_bf16_f32 v107, v238, v239
    v_mfma_f32_16x16x32_bf16 v[224:227], a[248:251], v[184:187], v[224:227]
    v_exp_f32 v200, v200
    v_mfma_f32_16x16x32_bf16 v[204:207], v[92:95], v[170:173], v[204:207]
    s_waitcnt lgkmcnt(1)
    v_exp_f32 v201, v201
    v_mfma_f32_16x16x32_bf16 v[208:211], v[126:129], v[168:171], v[208:211]
    v_exp_f32 v202, v202
    v_mfma_f32_16x16x32_bf16 v[208:211], v[128:131], v[170:173], v[208:211]
    v_exp_f32 v203, v203
    v_mfma_f32_16x16x32_bf16 v[228:231], a[224:227], a[72:75], 0
    v_cvt_pk_bf16_f32 v188, v200, v201
    v_cvt_pk_bf16_f32 v191, v202, v203
    v_mfma_f32_16x16x32_bf16 v[228:231], a[228:231], a[76:79], v[228:231]
    ds_read_b128 v[200:203], v244 offset:0
    buffer_load_dwordx4 v255, s[4:7], s59 offen lds
    v_mfma_f32_16x16x32_bf16 v[212:215], v[8:11], v[188:191], v[212:215]
    v_exp_f32 v204, v204
    v_mfma_f32_16x16x32_bf16 v[216:219], v[38:41], v[188:191], v[216:219]
    v_exp_f32 v205, v205
    v_mfma_f32_16x16x32_bf16 v[220:223], v[68:71], v[188:191], v[220:223]
    s_waitcnt lgkmcnt(1)
    v_cvt_pk_bf16_f32 v192, v204, v205
    v_accvgpr_read_b32 v255, a254
    v_mfma_f32_16x16x32_bf16 v[224:227], a[248:251], v[188:191], v[224:227]
    ds_read_b128 v[204:207], v245 offset:0
    buffer_load_dwordx4 v254, s[4:7], s59 offen offset:1024 lds
    v_mfma_f32_16x16x32_bf16 v[196:199], v[162:165], v[168:171], v[196:199]
    v_exp_f32 v208, v208
    v_mfma_f32_16x16x32_bf16 v[196:199], v[164:167], v[170:173], v[196:199]
    v_exp_f32 v209, v209
    v_mfma_f32_16x16x32_bf16 v[228:231], a[232:235], a[80:83], v[228:231]
    v_cvt_pk_bf16_f32 v193, v208, v209
    v_accvgpr_read_b32 v254, a252
    v_mfma_f32_16x16x32_bf16 v[228:231], a[236:239], a[84:87], v[228:231]
    s_waitcnt lgkmcnt(1)
    ds_read_b128 v[208:211], v246 offset:0
    v_mfma_f32_16x16x32_bf16 v[200:203], v[108:111], v[174:177], v[200:203]
    v_exp_f32 v196, v196
    v_mfma_f32_16x16x32_bf16 v[200:203], v[110:113], v[176:179], v[200:203]
    v_exp_f32 v197, v197
    v_mfma_f32_16x16x32_bf16 v[228:231], a[240:243], a[88:91], v[228:231]
    buffer_load_dwordx4 v255, s[4:7], s59 offen offset:2048 lds
    v_cvt_pk_bf16_f32 v194, v196, v197
    v_mfma_f32_16x16x32_bf16 v[228:231], a[244:247], a[92:95], v[228:231]
    ds_read_b128 v[196:199], v244 offset:64
    v_accvgpr_read_b32 v255, a255
    v_mfma_f32_16x16x32_bf16 v[212:215], v[12:15], v[192:195], v[212:215]
    s_add_u32 m0, s46, 0x18000
    v_exp_f32 v200, v200
    v_mfma_f32_16x16x32_bf16 v[216:219], v[42:45], v[192:195], v[216:219]
    s_add_u32 s59, s44, s45
    v_exp_f32 v201, v201
    v_mfma_f32_16x16x32_bf16 v[220:223], v[72:75], v[192:195], v[220:223]
    v_exp_f32 v202, v202
    v_mfma_f32_16x16x32_bf16 v[224:227], a[248:251], v[192:195], v[224:227]
    v_exp_f32 v203, v203
    v_mfma_f32_16x16x32_bf16 v[232:235], a[224:227], a[96:99], 0
    s_waitcnt lgkmcnt(2)
    v_cvt_pk_bf16_f32 v180, v200, v201
    v_cvt_pk_bf16_f32 v183, v202, v203
    v_mfma_f32_16x16x32_bf16 v[204:207], v[120:123], v[174:177], v[204:207]
    ds_read_b128 v[200:203], v245 offset:64
    v_cvt_pk_bf16_f32 v20, v228, v229
    v_mfma_f32_16x16x32_bf16 v[204:207], v[122:125], v[176:179], v[204:207]
    s_waitcnt lgkmcnt(2)
    v_rcp_f32 v225, v224
    v_mfma_f32_16x16x32_bf16 v[208:211], v[156:159], v[174:177], v[208:211]
    v_cvt_pk_bf16_f32 v23, v230, v231
    v_mul_f32 v212, v212, v225
    v_mfma_f32_16x16x32_bf16 v[208:211], v[158:161], v[176:179], v[208:211]
    v_mul_f32 v213, v213, v225
    v_mul_f32 v214, v214, v225
    v_mfma_f32_16x16x32_bf16 v[232:235], a[228:231], a[100:103], v[232:235]
    s_waitcnt lgkmcnt(1)
    v_exp_f32 v204, v204
    v_mfma_f32_16x16x32_bf16 v[196:199], v[90:93], v[174:177], v[196:199]
    v_exp_f32 v205, v205
    v_mfma_f32_16x16x32_bf16 v[196:199], v[92:95], v[176:179], v[196:199]
    v_exp_f32 v208, v208
    v_mfma_f32_16x16x32_bf16 v[232:235], a[232:235], a[104:107], v[232:235]
    v_exp_f32 v209, v209
    v_mfma_f32_16x16x32_bf16 v[232:235], a[236:239], a[108:111], v[232:235]
    v_exp_f32 v206, v206
    v_mfma_f32_16x16x32_bf16 v[232:235], a[240:243], a[112:115], v[232:235]
    v_exp_f32 v207, v207
    v_mfma_f32_16x16x32_bf16 v[232:235], a[244:247], a[116:119], v[232:235]
    v_cvt_pk_bf16_f32 v181, v204, v205
    v_cvt_pk_bf16_f32 v182, v208, v209
    v_mfma_f32_16x16x32_bf16 v[236:239], a[224:227], a[120:123], 0
    ds_read_b128 a[224:227], v242 offset:3200
    s_waitcnt lgkmcnt(1)
    v_mfma_f32_16x16x32_bf16 v[200:203], v[126:129], v[174:177], v[200:203]
    v_mul_f32 v215, v215, v225
    v_cvt_pk_bf16_f32 v212, v212, v213
    v_mfma_f32_16x16x32_bf16 v[200:203], v[128:131], v[176:179], v[200:203]
    v_cvt_pk_bf16_f32 v50, v232, v233
    v_cvt_pk_bf16_f32 v53, v234, v235
    v_mfma_f32_16x16x32_bf16 v[236:239], a[228:231], a[124:127], v[236:239]
    ds_read_b128 a[228:231], v243 offset:3200
    v_cvt_pk_bf16_f32 v184, v206, v207
    v_mfma_f32_16x16x32_bf16 v[236:239], a[232:235], a[128:131], v[236:239]
    ds_read_b128 a[232:235], v242 offset:3328
    v_cvt_pk_bf16_f32 v213, v214, v215
    v_mfma_f32_16x16x32_bf16 v[236:239], a[236:239], a[132:135], v[236:239]
    ds_read_b128 a[236:239], v243 offset:3328
    v_mul_f32 v216, v216, v225
    v_mfma_f32_16x16x32_bf16 v[236:239], a[240:243], a[136:139], v[236:239]
    ds_read_b128 a[240:243], v240 offset:6144
    v_mul_f32 v217, v217, v225
    v_mfma_f32_16x16x32_bf16 v[236:239], a[244:247], a[140:143], v[236:239]
    ds_read_b128 a[244:247], v241 offset:6144
    v_mul_f32 v218, v218, v225
    v_mfma_f32_16x16x32_bf16 v[228:231], a[144:147], a[216:219], 0
    ds_read_b128 v[204:207], v246 offset:64
    v_mul_f32 v219, v219, v225
    v_mfma_f32_16x16x32_bf16 v[228:231], a[148:151], a[220:223], v[228:231]
    s_waitcnt lgkmcnt(6)
    v_cvt_pk_bf16_f32 v216, v216, v217
    v_cvt_pk_bf16_f32 v80, v236, v237
    v_mfma_f32_16x16x32_bf16 v[228:231], a[152:155], a[224:227], v[228:231]
    v_cvt_pk_bf16_f32 v83, v238, v239
    v_cvt_pk_bf16_f32 v217, v218, v219
    v_mfma_f32_16x16x32_bf16 v[232:235], a[168:171], a[216:219], 0
    ds_write_b64 v251, v[212:213] offset:0
    v_mfma_f32_16x16x32_bf16 v[212:215], v[6:9], v[180:183], 0
    s_waitcnt lgkmcnt(6)
    v_mul_f32 v220, v220, v225
    v_mul_f32 v221, v221, v225
    v_mfma_f32_16x16x32_bf16 v[228:231], a[156:159], a[228:231], v[228:231]
    s_waitcnt lgkmcnt(5)
    v_mul_f32 v222, v222, v225
    v_mul_f32 v223, v223, v225
    v_mfma_f32_16x16x32_bf16 v[228:231], a[160:163], a[232:235], v[228:231]
    s_waitcnt lgkmcnt(4)
    v_cvt_pk_bf16_f32 v220, v220, v221
    v_cvt_pk_bf16_f32 v221, v222, v223
    v_mfma_f32_16x16x32_bf16 v[228:231], a[164:167], a[236:239], v[228:231]
    ds_write_b64 v251, v[216:217] offset:128
    v_mfma_f32_16x16x32_bf16 v[216:219], v[36:39], v[180:183], 0
    ds_write_b64 v251, v[220:221] offset:256
    v_mfma_f32_16x16x32_bf16 v[220:223], v[66:69], v[180:183], 0
    buffer_load_dwordx4 v254, s[4:7], s58 offen lds
    v_max3_f32 v248, v248, v224, v225
    v_mfma_f32_16x16x32_bf16 v[224:227], a[248:251], v[180:183], 0
    v_exp_f32 v210, v210
    v_mfma_f32_16x16x32_bf16 v[232:235], a[172:175], a[220:223], v[232:235]
    v_mul_f32 v228, s38, v228
    v_mul_f32 v229, s38, v229
    v_mfma_f32_16x16x32_bf16 v[232:235], a[176:179], a[224:227], v[232:235]
    v_mul_f32 v230, s38, v230
    v_mul_f32 v231, s38, v231
    v_mfma_f32_16x16x32_bf16 v[232:235], a[180:183], a[228:231], v[232:235]
    s_waitcnt lgkmcnt(3)
    v_cvt_pk_bf16_f32 v168, v228, v229
    v_cvt_pk_bf16_f32 v169, v230, v231
    v_mfma_f32_16x16x32_bf16 v[204:207], v[162:165], v[174:177], v[204:207]
    v_exp_f32 v211, v211
    v_mfma_f32_16x16x32_bf16 v[204:207], v[164:167], v[176:179], v[204:207]
    v_cvt_pk_bf16_f32 v185, v210, v211
    v_xor_b32 v254, 16, v242
    v_mfma_f32_16x16x32_bf16 v[232:235], a[184:187], a[232:235], v[232:235]
    ds_read_b128 v[208:211], v244 offset:128
    v_add_u32 v254, 0x7500, v254
    v_mfma_f32_16x16x32_bf16 v[232:235], a[188:191], a[236:239], v[232:235]
    v_exp_f32 v196, v196
    v_mfma_f32_16x16x32_bf16 v[236:239], a[192:195], a[216:219], 0
    ds_read_b128 a[216:219], v240 offset:6272
    v_cndmask_b32 v254, v242, v254, vcc
    v_mfma_f32_16x16x32_bf16 v[236:239], a[196:199], a[220:223], v[236:239]
    ds_read_b128 a[220:223], v241 offset:6272
    buffer_load_dwordx4 v255, s[4:7], s58 offen offset:512 lds
    v_mfma_f32_16x16x32_bf16 v[236:239], a[200:203], a[224:227], v[236:239]
    s_mov_b32 vcc_lo, 0x33333333
    v_mul_f32 v232, s3, v232
    v_mul_f32 v233, s3, v233
    v_mfma_f32_16x16x32_bf16 v[236:239], a[204:207], a[228:231], v[236:239]
    s_mov_b32 vcc_hi, 0x33333333
    v_mul_f32 v234, s3, v234
    v_mul_f32 v235, s3, v235
    v_mfma_f32_16x16x32_bf16 v[236:239], a[208:211], a[232:235], v[236:239]
    ds_read_b128 a[224:227], v240 offset:6400
    v_cvt_pk_bf16_f32 v170, v232, v233
    v_mfma_f32_16x16x32_bf16 v[236:239], a[212:215], a[236:239], v[236:239]
    ds_read_b128 a[228:231], v241 offset:6400
    v_cvt_pk_bf16_f32 v171, v234, v235
    v_mfma_f32_16x16x32_bf16 v[228:231], a[0:3], a[240:243], 0
    s_add_u32 m0, s46, 0
    v_exp_f32 v197, v197
    v_mfma_f32_16x16x32_bf16 v[228:231], a[4:7], a[244:247], v[228:231]
    s_lshl1_add_u32 s58, s45, s44
    v_exp_f32 v200, v200
    v_mfma_f32_16x16x32_bf16 v[232:235], a[24:27], a[240:243], 0
    v_mul_f32 v236, s38, v236
    s_waitcnt lgkmcnt(3)
    v_mfma_f32_16x16x32_bf16 v[208:211], v[96:99], v[174:177], v[208:211]
    v_mul_f32 v237, s38, v237
    v_mul_f32 v238, s38, v238
    v_mfma_f32_16x16x32_bf16 v[208:211], v[98:101], v[176:179], v[208:211]
    v_mul_f32 v239, s38, v239
    v_cvt_pk_bf16_f32 v172, v236, v237
    v_mfma_f32_16x16x32_bf16 v[228:231], a[8:11], a[216:219], v[228:231]
    s_waitcnt lgkmcnt(2)
    v_cvt_pk_bf16_f32 v173, v238, v239
    v_cvt_pk_bf16_f32 v186, v196, v197
    v_mfma_f32_16x16x32_bf16 v[228:231], a[12:15], a[220:223], v[228:231]
    v_exp_f32 v201, v201
    v_mfma_f32_16x16x32_bf16 v[232:235], a[28:31], a[244:247], v[232:235]
    s_waitcnt lgkmcnt(1)
    v_exp_f32 v198, v198
    v_mfma_f32_16x16x32_bf16 v[228:231], a[16:19], a[224:227], v[228:231]
    s_waitcnt lgkmcnt(0)
    v_exp_f32 v199, v199
    v_mfma_f32_16x16x32_bf16 v[228:231], a[20:23], a[228:231], v[228:231]
    v_cvt_pk_bf16_f32 v187, v200, v201
    v_cvt_pk_bf16_f32 v189, v198, v199
    v_mfma_f32_16x16x32_bf16 v[232:235], a[32:35], a[216:219], v[232:235]
    ds_read_b128 v[196:199], v245 offset:128
    v_xor_b32 v255, 64, v254
    v_mfma_f32_16x16x32_bf16 v[212:215], v[10:13], v[184:187], v[212:215]
    v_exp_f32 v202, v202
    v_mfma_f32_16x16x32_bf16 v[216:219], v[40:43], v[184:187], v[216:219]
    v_exp_f32 v203, v203
    v_mfma_f32_16x16x32_bf16 v[220:223], v[70:73], v[184:187], v[220:223]
    v_cvt_pk_bf16_f32 v190, v202, v203
    v_cvt_pk_bf16_f32 v108, v228, v229
    v_mfma_f32_16x16x32_bf16 v[224:227], a[248:251], v[184:187], v[224:227]
    ds_read_b128 v[200:203], v246 offset:128
    v_cvt_pk_bf16_f32 v109, v230, v231
    v_mfma_f32_16x16x32_bf16 v[232:235], a[36:39], a[220:223], v[232:235]
    v_exp_f32 v204, v204
    v_mfma_f32_16x16x32_bf16 v[232:235], a[40:43], a[224:227], v[232:235]
    v_exp_f32 v205, v205
    v_mfma_f32_16x16x32_bf16 v[232:235], a[44:47], a[228:231], v[232:235]
    v_exp_f32 v206, v206
    v_mfma_f32_16x16x32_bf16 v[236:239], a[48:51], a[240:243], 0
    v_exp_f32 v207, v207
    v_mfma_f32_16x16x32_bf16 v[236:239], a[52:55], a[244:247], v[236:239]
    v_cvt_pk_bf16_f32 v188, v204, v205
    v_cvt_pk_bf16_f32 v191, v206, v207
    v_mfma_f32_16x16x32_bf16 v[236:239], a[56:59], a[216:219], v[236:239]
    ds_read_b128 v[204:207], v244 offset:0
    v_cvt_pk_bf16_f32 v110, v232, v233
    v_mfma_f32_16x16x32_bf16 v[212:215], v[14:17], v[188:191], v[212:215]
    s_waitcnt lgkmcnt(2)
    v_exp_f32 v208, v208
    v_mfma_f32_16x16x32_bf16 v[216:219], v[44:47], v[188:191], v[216:219]
    v_exp_f32 v209, v209
    v_mfma_f32_16x16x32_bf16 v[220:223], v[74:77], v[188:191], v[220:223]
    v_cvt_pk_bf16_f32 v192, v208, v209
    v_cvt_pk_bf16_f32 v111, v234, v235
    v_mfma_f32_16x16x32_bf16 v[224:227], a[248:251], v[188:191], v[224:227]
    ds_read_b128 v[208:211], v245 offset:0
    ds_read_b128 a[232:235], v254 offset:4608
    v_mfma_f32_16x16x32_bf16 v[196:199], v[132:135], v[174:177], v[196:199]
    ds_read_b128 a[236:239], v255 offset:4608
    v_mfma_f32_16x16x32_bf16 v[196:199], v[134:137], v[176:179], v[196:199]
    v_mfma_f32_16x16x32_bf16 v[236:239], a[60:63], a[220:223], v[236:239]
    s_waitcnt lgkmcnt(4)
    v_mfma_f32_16x16x32_bf16 v[200:203], v[102:105], v[174:177], v[200:203]
    v_mfma_f32_16x16x32_bf16 v[200:203], v[104:107], v[176:179], v[200:203]
    v_mfma_f32_16x16x32_bf16 v[236:239], a[64:67], a[224:227], v[236:239]
    v_mfma_f32_16x16x32_bf16 v[236:239], a[68:71], a[228:231], v[236:239]
    s_waitcnt lgkmcnt(3)
    v_mfma_f32_16x16x32_bf16 v[204:207], v[90:93], v[168:171], v[204:207]
    v_exp_f32 v196, v196
    v_mfma_f32_16x16x32_bf16 v[204:207], v[92:95], v[170:173], v[204:207]
    v_exp_f32 v197, v197
    v_mfma_f32_16x16x32_bf16 v[228:231], a[240:243], a[72:75], 0
    v_exp_f32 v200, v200
    v_mfma_f32_16x16x32_bf16 v[228:231], a[244:247], a[76:79], v[228:231]
    v_exp_f32 v201, v201
    v_mfma_f32_16x16x32_bf16 v[228:231], a[216:219], a[80:83], v[228:231]
    s_waitcnt lgkmcnt(2)
    v_cvt_pk_bf16_f32 v193, v196, v197
    v_cvt_pk_bf16_f32 v194, v200, v201
    v_mfma_f32_16x16x32_bf16 v[208:211], v[126:129], v[168:171], v[208:211]
    ds_read_b128 v[196:199], v246 offset:0
    v_cvt_pk_bf16_f32 v112, v236, v237
    v_mfma_f32_16x16x32_bf16 v[212:215], v[18:21], v[192:195], v[212:215]
    ds_read_b128 v[200:203], v244 offset:64
    v_cvt_pk_bf16_f32 v113, v238, v239
    v_mfma_f32_16x16x32_bf16 v[216:219], v[48:51], v[192:195], v[216:219]
    v_exp_f32 v204, v204
    v_mfma_f32_16x16x32_bf16 v[220:223], v[78:81], v[192:195], v[220:223]
    v_exp_f32 v205, v205
    v_mfma_f32_16x16x32_bf16 v[224:227], a[248:251], v[192:195], v[224:227]
    v_exp_f32 v206, v206
    v_mfma_f32_16x16x32_bf16 v[208:211], v[128:131], v[170:173], v[208:211]
    v_exp_f32 v207, v207
    v_mfma_f32_16x16x32_bf16 v[228:231], a[220:223], a[84:87], v[228:231]
    v_cvt_pk_bf16_f32 v180, v204, v205
    v_cvt_pk_bf16_f32 v183, v206, v207
    v_mfma_f32_16x16x32_bf16 v[228:231], a[224:227], a[88:91], v[228:231]
    ds_read_b128 v[204:207], v245 offset:64
    v_mfma_f32_16x16x32_bf16 v[228:231], a[228:231], a[92:95], v[228:231]
    v_rcp_f32 v225, v224
    v_mfma_f32_16x16x32_bf16 v[232:235], a[240:243], a[96:99], 0
    v_mul_f32 v212, v212, v225
    v_mul_f32 v213, v213, v225
    v_mfma_f32_16x16x32_bf16 v[232:235], a[244:247], a[100:103], v[232:235]
    s_waitcnt lgkmcnt(2)
    v_mul_f32 v214, v214, v225
    v_mul_f32 v215, v215, v225
    v_mfma_f32_16x16x32_bf16 v[196:199], v[162:165], v[168:171], v[196:199]
    v_cvt_pk_bf16_f32 v212, v212, v213
    v_cvt_pk_bf16_f32 v213, v214, v215
    v_mfma_f32_16x16x32_bf16 v[196:199], v[164:167], v[170:173], v[196:199]
    s_waitcnt lgkmcnt(1)
    v_cvt_pk_bf16_f32 v26, v228, v229
    v_cvt_pk_bf16_f32 v29, v230, v231
    v_mfma_f32_16x16x32_bf16 v[200:203], v[96:99], v[168:171], v[200:203]
    ds_write_b64 v251, v[212:213] offset:6144
    v_mfma_f32_16x16x32_bf16 v[200:203], v[98:101], v[170:173], v[200:203]
    v_exp_f32 v208, v208
    v_mfma_f32_16x16x32_bf16 v[232:235], a[216:219], a[104:107], v[232:235]
    v_exp_f32 v209, v209
    v_mfma_f32_16x16x32_bf16 v[232:235], a[220:223], a[108:111], v[232:235]
    s_waitcnt lgkmcnt(1)
    v_exp_f32 v210, v210
    v_mfma_f32_16x16x32_bf16 v[204:207], v[132:135], v[168:171], v[204:207]
    v_exp_f32 v211, v211
    v_mfma_f32_16x16x32_bf16 v[204:207], v[134:137], v[170:173], v[204:207]
    v_cvt_pk_bf16_f32 v181, v208, v209
    v_cvt_pk_bf16_f32 v184, v210, v211
    v_mfma_f32_16x16x32_bf16 v[232:235], a[224:227], a[112:115], v[232:235]
    ds_read_b128 v[208:211], v246 offset:64
    v_mul_f32 v216, v216, v225
    v_mfma_f32_16x16x32_bf16 v[232:235], a[228:231], a[116:119], v[232:235]
    v_exp_f32 v196, v196
    v_mfma_f32_16x16x32_bf16 v[236:239], a[240:243], a[120:123], 0
    ds_read_b128 a[240:243], v254 offset:4736
    v_mul_f32 v217, v217, v225
    v_mfma_f32_16x16x32_bf16 v[236:239], a[244:247], a[124:127], v[236:239]
    ds_read_b128 a[244:247], v255 offset:4736
    v_mul_f32 v218, v218, v225
    v_mfma_f32_16x16x32_bf16 v[236:239], a[216:219], a[128:131], v[236:239]
    ds_read_b128 a[216:219], v254 offset:4864
    v_cvt_pk_bf16_f32 v56, v232, v233
    v_mfma_f32_16x16x32_bf16 v[236:239], a[220:223], a[132:135], v[236:239]
    ds_read_b128 a[220:223], v255 offset:4864
    v_cvt_pk_bf16_f32 v59, v234, v235
    v_mfma_f32_16x16x32_bf16 v[236:239], a[224:227], a[136:139], v[236:239]
    v_exp_f32 v197, v197
    v_mfma_f32_16x16x32_bf16 v[236:239], a[228:231], a[140:143], v[236:239]
    v_exp_f32 v198, v198
    v_mfma_f32_16x16x32_bf16 v[228:231], a[144:147], a[232:235], 0
    v_exp_f32 v199, v199
    v_mfma_f32_16x16x32_bf16 v[228:231], a[148:151], a[236:239], v[228:231]
    v_cvt_pk_bf16_f32 v182, v196, v197
    v_cvt_pk_bf16_f32 v185, v198, v199
    v_mfma_f32_16x16x32_bf16 v[232:235], a[168:171], a[232:235], 0
    ds_read_b128 v[196:199], v244 offset:128
    s_waitcnt lgkmcnt(4)
    v_mfma_f32_16x16x32_bf16 v[212:215], v[12:15], v[180:183], 0
    v_cvt_pk_bf16_f32 v86, v236, v237
    v_cvt_pk_bf16_f32 v89, v238, v239
    v_mfma_f32_16x16x32_bf16 v[208:211], v[102:105], v[168:171], v[208:211]
    v_mul_f32 v219, v219, v225
    v_cvt_pk_bf16_f32 v216, v216, v217
    v_mfma_f32_16x16x32_bf16 v[208:211], v[104:107], v[170:173], v[208:211]
    v_cvt_pk_bf16_f32 v217, v218, v219
    s_waitcnt vmcnt(5) lgkmcnt(1)
    v_mfma_f32_16x16x32_bf16 v[228:231], a[152:155], a[240:243], v[228:231]
    s_barrier
    ds_read_b128 a[224:227], v240 offset:30720
    v_mfma_f32_16x16x32_bf16 v[228:231], a[156:159], a[244:247], v[228:231]
    ds_read_b128 a[228:231], v241 offset:30720
    v_mul_f32 v220, v220, v225
    v_mfma_f32_16x16x32_bf16 v[228:231], a[160:163], a[216:219], v[228:231]
    ds_write_b64 v251, v[216:217] offset:6272
    v_mfma_f32_16x16x32_bf16 v[216:219], v[42:45], v[180:183], 0
    v_mul_f32 v221, v221, v225
    v_mul_f32 v222, v222, v225
    v_mfma_f32_16x16x32_bf16 v[228:231], a[164:167], a[220:223], v[228:231]
    v_mul_f32 v223, v223, v225
    v_cvt_pk_bf16_f32 v220, v220, v221
    v_mfma_f32_16x16x32_bf16 v[232:235], a[172:175], a[236:239], v[232:235]
    v_cvt_pk_bf16_f32 v221, v222, v223
    v_max3_f32 v248, v248, v224, v225
    v_mfma_f32_16x16x32_bf16 v[224:227], a[248:251], v[180:183], 0
    ds_write_b64 v251, v[220:221] offset:6400
    v_mfma_f32_16x16x32_bf16 v[220:223], v[72:75], v[180:183], 0
    v_mul_f32 v228, s38, v228
    v_mul_f32 v229, s38, v229
    v_mfma_f32_16x16x32_bf16 v[232:235], a[176:179], a[240:243], v[232:235]
    v_mul_f32 v230, s38, v230
    v_mul_f32 v231, s38, v231
    v_mfma_f32_16x16x32_bf16 v[232:235], a[180:183], a[244:247], v[232:235]
    s_waitcnt lgkmcnt(4)
    v_cvt_pk_bf16_f32 v174, v228, v229
    v_cvt_pk_bf16_f32 v175, v230, v231
    v_mfma_f32_16x16x32_bf16 v[196:199], v[138:141], v[168:171], v[196:199]
    s_waitcnt lgkmcnt(3)
    v_exp_f32 v200, v200
    v_mfma_f32_16x16x32_bf16 v[196:199], v[140:143], v[170:173], v[196:199]
    v_exp_f32 v201, v201
    v_mfma_f32_16x16x32_bf16 v[232:235], a[184:187], a[216:219], v[232:235]
    v_exp_f32 v202, v202
    v_mfma_f32_16x16x32_bf16 v[232:235], a[188:191], a[220:223], v[232:235]
    v_exp_f32 v203, v203
    v_mfma_f32_16x16x32_bf16 v[236:239], a[192:195], a[232:235], 0
    ds_read_b128 a[232:235], v240 offset:30848
    v_cvt_pk_bf16_f32 v186, v200, v201
    v_mfma_f32_16x16x32_bf16 v[236:239], a[196:199], a[236:239], v[236:239]
    ds_read_b128 a[236:239], v241 offset:30848
    v_cvt_pk_bf16_f32 v189, v202, v203
    v_mfma_f32_16x16x32_bf16 v[236:239], a[200:203], a[240:243], v[236:239]
    v_mul_f32 v232, s3, v232
    v_mul_f32 v233, s3, v233
    v_mfma_f32_16x16x32_bf16 v[236:239], a[204:207], a[244:247], v[236:239]
    v_mul_f32 v234, s3, v234
    v_mul_f32 v235, s3, v235
    v_mfma_f32_16x16x32_bf16 v[236:239], a[208:211], a[216:219], v[236:239]
    v_cvt_pk_bf16_f32 v176, v232, v233
    v_cvt_pk_bf16_f32 v177, v234, v235
    v_mfma_f32_16x16x32_bf16 v[236:239], a[212:215], a[220:223], v[236:239]
    ds_read_b128 a[240:243], v240 offset:30976
    ds_read_b128 a[244:247], v241 offset:30976
    v_mfma_f32_16x16x32_bf16 v[228:231], a[0:3], a[224:227], 0
    s_waitcnt lgkmcnt(4)
    v_exp_f32 v204, v204
    v_mfma_f32_16x16x32_bf16 v[228:231], a[4:7], a[228:231], v[228:231]
    ds_read_b128 v[200:203], v245 offset:128
    v_accvgpr_read_b32 v254, a252
    v_mfma_f32_16x16x32_bf16 v[232:235], a[24:27], a[224:227], 0
    v_mul_f32 v236, s38, v236
    s_waitcnt lgkmcnt(4)
    v_mfma_f32_16x16x32_bf16 v[228:231], a[8:11], a[232:235], v[228:231]
    v_mul_f32 v237, s38, v237
    v_mul_f32 v238, s38, v238
    v_mfma_f32_16x16x32_bf16 v[232:235], a[28:31], a[228:231], v[232:235]
    s_waitcnt lgkmcnt(3)
    v_mul_f32 v239, s38, v239
    v_cvt_pk_bf16_f32 v178, v236, v237
    v_mfma_f32_16x16x32_bf16 v[228:231], a[12:15], a[236:239], v[228:231]
    ds_read_b128 a[216:219], v242 offset:30720
    v_cvt_pk_bf16_f32 v179, v238, v239
    v_mfma_f32_16x16x32_bf16 v[232:235], a[32:35], a[232:235], v[232:235]
    v_exp_f32 v205, v205
    v_mfma_f32_16x16x32_bf16 v[232:235], a[36:39], a[236:239], v[232:235]
    ds_read_b128 a[220:223], v243 offset:30720
    s_waitcnt lgkmcnt(4)
    v_mfma_f32_16x16x32_bf16 v[228:231], a[16:19], a[240:243], v[228:231]
    buffer_load_dwordx4 v254, s[4:7], s44 offen lds
    s_waitcnt lgkmcnt(3)
    v_mfma_f32_16x16x32_bf16 v[228:231], a[20:23], a[244:247], v[228:231]
    v_cvt_pk_bf16_f32 v187, v204, v205
    v_accvgpr_read_b32 v255, a253
    v_mfma_f32_16x16x32_bf16 v[232:235], a[40:43], a[240:243], v[232:235]
    v_exp_f32 v206, v206
    v_mfma_f32_16x16x32_bf16 v[212:215], v[16:19], v[184:187], v[212:215]
    v_exp_f32 v207, v207
    v_mfma_f32_16x16x32_bf16 v[216:219], v[46:49], v[184:187], v[216:219]
    buffer_load_dwordx4 v255, s[4:7], s44 offen offset:1024 lds
    v_cvt_pk_bf16_f32 v90, v228, v229
    v_mfma_f32_16x16x32_bf16 v[220:223], v[76:79], v[184:187], v[220:223]
    v_cvt_pk_bf16_f32 v91, v230, v231
    v_cvt_pk_bf16_f32 v190, v206, v207
    v_mfma_f32_16x16x32_bf16 v[224:227], a[248:251], v[184:187], v[224:227]
    ds_read_b128 v[204:207], v246 offset:128
    v_accvgpr_read_b32 v254, a254
    v_mfma_f32_16x16x32_bf16 v[232:235], a[44:47], a[244:247], v[232:235]
    s_waitcnt lgkmcnt(3)
    v_exp_f32 v208, v208
    v_mfma_f32_16x16x32_bf16 v[200:203], v[144:147], v[168:171], v[200:203]
L_h4:
    s_cbranch_execz L_h8
    v_exp_f32 v209, v209
    v_mfma_f32_16x16x32_bf16 v[200:203], v[146:149], v[170:173], v[200:203]
    v_exp_f32 v210, v210
    v_mfma_f32_16x16x32_bf16 v[236:239], a[48:51], a[224:227], 0
    v_exp_f32 v211, v211
    v_mfma_f32_16x16x32_bf16 v[236:239], a[52:55], a[228:231], v[236:239]
    v_cvt_pk_bf16_f32 v92, v232, v233
    v_cvt_pk_bf16_f32 v93, v234, v235
    v_mfma_f32_16x16x32_bf16 v[236:239], a[56:59], a[232:235], v[236:239]
    v_cvt_pk_bf16_f32 v188, v208, v209
    v_cvt_pk_bf16_f32 v191, v210, v211
    v_mfma_f32_16x16x32_bf16 v[236:239], a[60:63], a[236:239], v[236:239]
    ds_read_b128 v[208:211], v244 offset:0
    v_accvgpr_read_b32 v255, a252
    v_mfma_f32_16x16x32_bf16 v[212:215], v[20:23], v[188:191], v[212:215]
    v_exp_f32 v196, v196
    v_mfma_f32_16x16x32_bf16 v[216:219], v[50:53], v[188:191], v[216:219]
    v_exp_f32 v197, v197
    v_mfma_f32_16x16x32_bf16 v[220:223], v[80:83], v[188:191], v[220:223]
    buffer_load_dwordx4 v254, s[4:7], s44 offen offset:2048 lds
    v_cvt_pk_bf16_f32 v192, v196, v197
    v_mfma_f32_16x16x32_bf16 v[224:227], a[248:251], v[188:191], v[224:227]
    ds_read_b128 v[196:199], v245 offset:0
    v_accvgpr_read_b32 v254, a253
    v_mfma_f32_16x16x32_bf16 v[236:239], a[64:67], a[240:243], v[236:239]
    s_add_u32 m0, s46, 0xc00
    v_exp_f32 v200, v200
    v_mfma_f32_16x16x32_bf16 v[236:239], a[68:71], a[244:247], v[236:239]
    v_exp_f32 v201, v201
    v_mfma_f32_16x16x32_bf16 v[228:231], a[224:227], a[72:75], 0
    s_waitcnt lgkmcnt(2)
    v_cvt_pk_bf16_f32 v193, v200, v201
    v_mfma_f32_16x16x32_bf16 v[204:207], v[108:111], v[168:171], v[204:207]
    ds_read_b128 v[200:203], v246 offset:0
    buffer_load_dwordx4 v255, s[4:7], s59 offen lds
    v_mfma_f32_16x16x32_bf16 v[204:207], v[110:113], v[170:173], v[204:207]
    v_cvt_pk_bf16_f32 v94, v236, v237
    v_cvt_pk_bf16_f32 v95, v238, v239
    v_mfma_f32_16x16x32_bf16 v[228:231], a[228:231], a[76:79], v[228:231]
    ds_write_b64 v247, v[174:175] offset:0
    v_mfma_f32_16x16x32_bf16 v[228:231], a[232:235], a[80:83], v[228:231]
    ds_write_b64 v247, v[176:177] offset:128
    v_mfma_f32_16x16x32_bf16 v[228:231], a[236:239], a[84:87], v[228:231]
    ds_write_b64 v247, v[178:179] offset:256
    v_mfma_f32_16x16x32_bf16 v[228:231], a[240:243], a[88:91], v[228:231]
    s_waitcnt lgkmcnt(5)
    v_exp_f32 v204, v204
    v_mfma_f32_16x16x32_bf16 v[208:211], v[96:99], v[174:177], v[208:211]
    v_exp_f32 v205, v205
    v_mfma_f32_16x16x32_bf16 v[208:211], v[98:101], v[176:179], v[208:211]
    buffer_load_dwordx4 v254, s[4:7], s59 offen offset:1024 lds
    v_cvt_pk_bf16_f32 v194, v204, v205
    v_mfma_f32_16x16x32_bf16 v[228:231], a[244:247], a[92:95], v[228:231]
    ds_read_b128 v[204:207], v244 offset:64
    v_accvgpr_read_b32 v255, a254
    v_mfma_f32_16x16x32_bf16 v[212:215], v[24:27], v[192:195], v[212:215]
    s_waitcnt lgkmcnt(5)
    v_accvgpr_read_b32 v254, a252
    v_mfma_f32_16x16x32_bf16 v[216:219], v[54:57], v[192:195], v[216:219]
    v_exp_f32 v208, v208
    v_mfma_f32_16x16x32_bf16 v[220:223], v[84:87], v[192:195], v[220:223]
    v_exp_f32 v209, v209
    v_mfma_f32_16x16x32_bf16 v[224:227], a[248:251], v[192:195], v[224:227]
    v_exp_f32 v210, v210
    v_mfma_f32_16x16x32_bf16 v[196:199], v[132:135], v[174:177], v[196:199]
    s_waitcnt lgkmcnt(4)
    v_exp_f32 v211, v211
    v_mfma_f32_16x16x32_bf16 v[196:199], v[134:137], v[176:179], v[196:199]
    v_cvt_pk_bf16_f32 v180, v208, v209
    v_cvt_pk_bf16_f32 v183, v210, v211
    v_mfma_f32_16x16x32_bf16 v[200:203], v[102:105], v[174:177], v[200:203]
    ds_read_b128 v[208:211], v245 offset:64
    v_cvt_pk_bf16_f32 v0, v228, v229
    v_mfma_f32_16x16x32_bf16 v[200:203], v[104:107], v[176:179], v[200:203]
    buffer_load_dwordx4 v255, s[4:7], s59 offen offset:2048 lds
    v_cvt_pk_bf16_f32 v3, v230, v231
    v_mfma_f32_16x16x32_bf16 v[232:235], a[224:227], a[96:99], 0
    s_add_u32 m0, s46, 0x1800
    v_exp_f32 v196, v196
    v_mfma_f32_16x16x32_bf16 v[232:235], a[228:231], a[100:103], v[232:235]
    v_exp_f32 v197, v197
    v_mfma_f32_16x16x32_bf16 v[232:235], a[232:235], a[104:107], v[232:235]
    v_exp_f32 v198, v198
    v_mfma_f32_16x16x32_bf16 v[232:235], a[236:239], a[108:111], v[232:235]
    v_exp_f32 v199, v199
    v_mfma_f32_16x16x32_bf16 v[232:235], a[240:243], a[112:115], v[232:235]
    v_cvt_pk_bf16_f32 v181, v196, v197
    v_cvt_pk_bf16_f32 v184, v198, v199
    v_mfma_f32_16x16x32_bf16 v[232:235], a[244:247], a[116:119], v[232:235]
    s_waitcnt lgkmcnt(1)
    v_rcp_f32 v225, v224
    v_mfma_f32_16x16x32_bf16 v[204:207], v[138:141], v[174:177], v[204:207]
    ds_read_b128 v[196:199], v246 offset:64
    v_mul_f32 v212, v212, v225
    v_mfma_f32_16x16x32_bf16 v[204:207], v[140:143], v[176:179], v[204:207]
    v_exp_f32 v200, v200
    v_mfma_f32_16x16x32_bf16 v[236:239], a[224:227], a[120:123], 0
    ds_read_b128 a[224:227], v242 offset:30848
    v_cvt_pk_bf16_f32 v30, v232, v233
    v_mfma_f32_16x16x32_bf16 v[236:239], a[228:231], a[124:127], v[236:239]
    ds_read_b128 a[228:231], v243 offset:30848
    v_cvt_pk_bf16_f32 v33, v234, v235
    v_mfma_f32_16x16x32_bf16 v[236:239], a[232:235], a[128:131], v[236:239]
    ds_read_b128 a[232:235], v242 offset:30976
    v_mul_f32 v213, v213, v225
    v_mfma_f32_16x16x32_bf16 v[236:239], a[236:239], a[132:135], v[236:239]
    ds_read_b128 a[236:239], v243 offset:30976
    s_waitcnt lgkmcnt(5)
    v_mfma_f32_16x16x32_bf16 v[208:211], v[144:147], v[174:177], v[208:211]
    v_exp_f32 v201, v201
    v_mfma_f32_16x16x32_bf16 v[208:211], v[146:149], v[176:179], v[208:211]
    v_cvt_pk_bf16_f32 v182, v200, v201
    v_mul_f32 v214, v214, v225
    v_mfma_f32_16x16x32_bf16 v[236:239], a[240:243], a[136:139], v[236:239]
    ds_read_b128 a[240:243], v240 offset:32256
    v_mul_f32 v215, v215, v225
    v_mfma_f32_16x16x32_bf16 v[236:239], a[244:247], a[140:143], v[236:239]
    ds_read_b128 a[244:247], v241 offset:32256
    v_cvt_pk_bf16_f32 v212, v212, v213
    v_mfma_f32_16x16x32_bf16 v[228:231], a[144:147], a[216:219], 0
    v_cvt_pk_bf16_f32 v213, v214, v215
    v_mul_f32 v216, v216, v225
    v_mfma_f32_16x16x32_bf16 v[228:231], a[148:151], a[220:223], v[228:231]
    s_waitcnt lgkmcnt(5)
    v_mul_f32 v217, v217, v225
    v_cvt_pk_bf16_f32 v60, v236, v237
    v_mfma_f32_16x16x32_bf16 v[196:199], v[108:111], v[174:177], v[196:199]
    v_cvt_pk_bf16_f32 v63, v238, v239
    v_mul_f32 v218, v218, v225
    v_mfma_f32_16x16x32_bf16 v[196:199], v[110:113], v[176:179], v[196:199]
    ds_write_b64 v251, v[212:213] offset:12288
    v_mfma_f32_16x16x32_bf16 v[212:215], v[18:21], v[180:183], 0
    v_mul_f32 v219, v219, v225
    v_cvt_pk_bf16_f32 v216, v216, v217
    v_mfma_f32_16x16x32_bf16 v[228:231], a[152:155], a[224:227], v[228:231]
    s_waitcnt lgkmcnt(5)
    v_cvt_pk_bf16_f32 v217, v218, v219
    v_mul_f32 v220, v220, v225
    v_mfma_f32_16x16x32_bf16 v[228:231], a[156:159], a[228:231], v[228:231]
    s_waitcnt lgkmcnt(4)
    v_mul_f32 v221, v221, v225
    v_mul_f32 v222, v222, v225
    v_mfma_f32_16x16x32_bf16 v[228:231], a[160:163], a[232:235], v[228:231]
    s_waitcnt lgkmcnt(3)
    v_mul_f32 v223, v223, v225
    v_cvt_pk_bf16_f32 v220, v220, v221
    v_mfma_f32_16x16x32_bf16 v[228:231], a[164:167], a[236:239], v[228:231]
    ds_write_b64 v251, v[216:217] offset:12416
    v_mfma_f32_16x16x32_bf16 v[216:219], v[48:51], v[180:183], 0
    v_cvt_pk_bf16_f32 v221, v222, v223
    v_max3_f32 v248, v248, v224, v225
    v_mfma_f32_16x16x32_bf16 v[224:227], a[248:251], v[180:183], 0
    ds_write_b64 v251, v[220:221] offset:12544
    v_mfma_f32_16x16x32_bf16 v[220:223], v[78:81], v[180:183], 0
    v_exp_f32 v202, v202
    v_mfma_f32_16x16x32_bf16 v[232:235], a[168:171], a[216:219], 0
    v_mul_f32 v228, s38, v228
    v_mul_f32 v229, s38, v229
    v_mfma_f32_16x16x32_bf16 v[232:235], a[172:175], a[220:223], v[232:235]
    v_mul_f32 v230, s38, v230
    v_mul_f32 v231, s38, v231
    v_mfma_f32_16x16x32_bf16 v[232:235], a[176:179], a[224:227], v[232:235]
    v_cvt_pk_bf16_f32 v168, v228, v229
    v_cvt_pk_bf16_f32 v169, v230, v231
    v_mfma_f32_16x16x32_bf16 v[232:235], a[180:183], a[228:231], v[232:235]
    s_waitcnt lgkmcnt(3)
    v_exp_f32 v203, v203
    v_mfma_f32_16x16x32_bf16 v[232:235], a[184:187], a[232:235], v[232:235]
    v_exp_f32 v204, v204
    v_mfma_f32_16x16x32_bf16 v[232:235], a[188:191], a[236:239], v[232:235]
    v_exp_f32 v205, v205
    v_mfma_f32_16x16x32_bf16 v[236:239], a[192:195], a[216:219], 0
    ds_read_b128 a[216:219], v240 offset:32384
    v_cvt_pk_bf16_f32 v185, v202, v203
    v_mfma_f32_16x16x32_bf16 v[236:239], a[196:199], a[220:223], v[236:239]
    ds_read_b128 a[220:223], v241 offset:32384
    v_cvt_pk_bf16_f32 v186, v204, v205
    v_mfma_f32_16x16x32_bf16 v[236:239], a[200:203], a[224:227], v[236:239]
    ds_read_b128 a[224:227], v240 offset:32512
    v_mul_f32 v232, s3, v232
    v_mfma_f32_16x16x32_bf16 v[236:239], a[204:207], a[228:231], v[236:239]
    ds_read_b128 a[228:231], v241 offset:32512
    v_mul_f32 v233, s3, v233
    v_mfma_f32_16x16x32_bf16 v[236:239], a[208:211], a[232:235], v[236:239]
    v_mul_f32 v234, s3, v234
    v_mul_f32 v235, s3, v235
    v_mfma_f32_16x16x32_bf16 v[236:239], a[212:215], a[236:239], v[236:239]
    v_cvt_pk_bf16_f32 v170, v232, v233
    v_cvt_pk_bf16_f32 v171, v234, v235
    v_mfma_f32_16x16x32_bf16 v[228:231], a[0:3], a[240:243], 0
    v_exp_f32 v208, v208
    v_mfma_f32_16x16x32_bf16 v[228:231], a[4:7], a[244:247], v[228:231]
    v_exp_f32 v209, v209
    v_mfma_f32_16x16x32_bf16 v[232:235], a[24:27], a[240:243], 0
    ds_read_b128 a[232:235], v242 offset:32256
    s_waitcnt lgkmcnt(4)
    v_mfma_f32_16x16x32_bf16 v[228:231], a[8:11], a[216:219], v[228:231]
    v_mul_f32 v236, s38, v236
    s_waitcnt lgkmcnt(3)
    v_mfma_f32_16x16x32_bf16 v[228:231], a[12:15], a[220:223], v[228:231]
    v_mul_f32 v237, s38, v237
    s_waitcnt lgkmcnt(2)
    v_mfma_f32_16x16x32_bf16 v[228:231], a[16:19], a[224:227], v[228:231]
    v_mul_f32 v238, s38, v238
    s_waitcnt lgkmcnt(1)
    v_mfma_f32_16x16x32_bf16 v[228:231], a[20:23], a[228:231], v[228:231]
    v_mul_f32 v239, s38, v239
    v_cvt_pk_bf16_f32 v172, v236, v237
    v_mfma_f32_16x16x32_bf16 v[232:235], a[28:31], a[244:247], v[232:235]
    v_cvt_pk_bf16_f32 v173, v238, v239
    v_cvt_pk_bf16_f32 v187, v208, v209
    v_mfma_f32_16x16x32_bf16 v[232:235], a[32:35], a[216:219], v[232:235]
    v_exp_f32 v206, v206
    v_mfma_f32_16x16x32_bf16 v[212:215], v[22:25], v[184:187], v[212:215]
    v_cvt_pk_bf16_f32 v96, v228, v229
    v_cvt_pk_bf16_f32 v97, v230, v231
    v_mfma_f32_16x16x32_bf16 v[216:219], v[52:55], v[184:187], v[216:219]
    v_exp_f32 v207, v207
    v_mfma_f32_16x16x32_bf16 v[220:223], v[82:85], v[184:187], v[220:223]
    v_exp_f32 v210, v210
    v_mfma_f32_16x16x32_bf16 v[224:227], a[248:251], v[184:187], v[224:227]
    v_exp_f32 v211, v211
    v_mfma_f32_16x16x32_bf16 v[232:235], a[36:39], a[220:223], v[232:235]
    v_exp_f32 v196, v196
    v_mfma_f32_16x16x32_bf16 v[232:235], a[40:43], a[224:227], v[232:235]
    v_exp_f32 v197, v197
    v_mfma_f32_16x16x32_bf16 v[232:235], a[44:47], a[228:231], v[232:235]
    v_exp_f32 v198, v198
    v_mfma_f32_16x16x32_bf16 v[236:239], a[48:51], a[240:243], 0
    v_exp_f32 v199, v199
    v_mfma_f32_16x16x32_bf16 v[236:239], a[52:55], a[244:247], v[236:239]
    v_cvt_pk_bf16_f32 v189, v206, v207
    v_cvt_pk_bf16_f32 v190, v210, v211
    v_mfma_f32_16x16x32_bf16 v[236:239], a[56:59], a[216:219], v[236:239]
    v_cvt_pk_bf16_f32 v188, v196, v197
    v_cvt_pk_bf16_f32 v191, v198, v199
    v_mfma_f32_16x16x32_bf16 v[236:239], a[60:63], a[220:223], v[236:239]
    v_cvt_pk_bf16_f32 v98, v232, v233
    v_cvt_pk_bf16_f32 v99, v234, v235
    v_mfma_f32_16x16x32_bf16 v[212:215], v[26:29], v[188:191], v[212:215]
    ds_read_b128 a[236:239], v243 offset:32256
    v_mov_b32 v200, 0x237c0
    v_mfma_f32_16x16x32_bf16 v[216:219], v[56:59], v[188:191], v[216:219]
    v_add_u32 v201, 0xfffff900, v245
    v_add_u32 v246, 0x700, v245
    v_mfma_f32_16x16x32_bf16 v[220:223], v[86:89], v[188:191], v[220:223]
    buffer_load_dwordx4 v254, s[4:7], s58 offen lds
    v_accvgpr_read_b32 v255, a255
    v_mfma_f32_16x16x32_bf16 v[224:227], a[248:251], v[188:191], v[224:227]
    v_mov_b32 v191, 0
    v_mfma_f32_16x16x32_bf16 v[236:239], a[64:67], a[224:227], v[236:239]
    v_mfma_f32_16x16x32_bf16 v[236:239], a[68:71], a[228:231], v[236:239]
    v_mfma_f32_16x16x32_bf16 v[228:231], a[240:243], a[72:75], 0
    buffer_load_dwordx4 v255, s[4:7], s58 offen offset:512 lds
    s_add_u32 m0, s46, 0x16800
    v_mfma_f32_16x16x32_bf16 v[228:231], a[244:247], a[76:79], v[228:231]
    v_mfma_f32_16x16x32_bf16 v[228:231], a[216:219], a[80:83], v[228:231]
    v_rcp_f32 v225, v224
    v_mfma_f32_16x16x32_bf16 v[228:231], a[220:223], a[84:87], v[228:231]
    v_mul_f32 v212, v212, v225
    v_cvt_pk_bf16_f32 v100, v236, v237
    v_mfma_f32_16x16x32_bf16 v[228:231], a[224:227], a[88:91], v[228:231]
    v_cvt_pk_bf16_f32 v101, v238, v239
    v_mul_f32 v213, v213, v225
    v_mfma_f32_16x16x32_bf16 v[228:231], a[228:231], a[92:95], v[228:231]
    v_mov_b32 v226, 0x22e00
    v_mul_f32 v214, v214, v225
    v_mfma_f32_16x16x32_bf16 v[232:235], a[240:243], a[96:99], 0
    v_mul_f32 v215, v215, v225
    v_cvt_pk_bf16_f32 v212, v212, v213
    v_mfma_f32_16x16x32_bf16 v[232:235], a[244:247], a[100:103], v[232:235]
    v_mul_f32 v216, v216, v225
    v_mul_f32 v217, v217, v225
    v_mfma_f32_16x16x32_bf16 v[232:235], a[216:219], a[104:107], v[232:235]
    v_cvt_pk_bf16_f32 v6, v228, v229
    v_cvt_pk_bf16_f32 v9, v230, v231
    v_mfma_f32_16x16x32_bf16 v[232:235], a[220:223], a[108:111], v[232:235]
    s_waitcnt lgkmcnt(0)
    v_cndmask_b32 v226, v226, v247, vcc
    v_cvt_pk_bf16_f32 v213, v214, v215
    v_mfma_f32_16x16x32_bf16 v[232:235], a[224:227], a[112:115], v[232:235]
    s_mov_b32 vcc_lo, 0x0
    v_mul_f32 v218, v218, v225
    v_mul_f32 v219, v219, v225
    v_mfma_f32_16x16x32_bf16 v[232:235], a[228:231], a[116:119], v[232:235]
    s_mov_b32 vcc_hi, 0xf0000
    v_cvt_pk_bf16_f32 v216, v216, v217
    v_mul_f32 v220, v220, v225
    v_mfma_f32_16x16x32_bf16 v[236:239], a[240:243], a[120:123], 0
    ds_read_b128 a[240:243], v242 offset:32384
    v_mul_f32 v221, v221, v225
    v_mfma_f32_16x16x32_bf16 v[236:239], a[244:247], a[124:127], v[236:239]
    ds_read_b128 a[244:247], v243 offset:32384
    v_cvt_pk_bf16_f32 v36, v232, v233
    v_mfma_f32_16x16x32_bf16 v[236:239], a[216:219], a[128:131], v[236:239]
    ds_read_b128 a[216:219], v242 offset:32512
    v_cvt_pk_bf16_f32 v39, v234, v235
    v_mfma_f32_16x16x32_bf16 v[236:239], a[220:223], a[132:135], v[236:239]
    ds_read_b128 a[220:223], v243 offset:32512
    v_cvt_pk_bf16_f32 v217, v218, v219
    v_mfma_f32_16x16x32_bf16 v[236:239], a[224:227], a[136:139], v[236:239]
    ds_read_b128 a[224:227], v242 offset:33792
    v_mul_f32 v222, v222, v225
    v_mfma_f32_16x16x32_bf16 v[236:239], a[228:231], a[140:143], v[236:239]
    ds_read_b128 a[228:231], v243 offset:33792
    v_mul_f32 v223, v223, v225
    v_mfma_f32_16x16x32_bf16 v[228:231], a[144:147], a[232:235], 0
    ds_write_b64 v226, v[212:213] offset:0
    v_mfma_f32_16x16x32_bf16 v[228:231], a[148:151], a[236:239], v[228:231]
    v_cvt_pk_bf16_f32 v220, v220, v221
    v_cvt_pk_bf16_f32 v221, v222, v223
    v_mfma_f32_16x16x32_bf16 v[232:235], a[168:171], a[232:235], 0
    v_cvt_pk_bf16_f32 v66, v236, v237
    v_cvt_pk_bf16_f32 v69, v238, v239
    v_mfma_f32_16x16x32_bf16 v[232:235], a[172:175], a[236:239], v[232:235]
    s_waitcnt lgkmcnt(6)
    v_cndmask_b32 v245, v245, v200, vcc
    v_cndmask_b32 v244, v201, v244, vcc
    v_mfma_f32_16x16x32_bf16 v[228:231], a[152:155], a[240:243], v[228:231]
    s_waitcnt lgkmcnt(5)
    v_max3_f32 v248, v248, v224, v225
    s_mov_b32 vcc_lo, 0xff00fff0
    v_mfma_f32_16x16x32_bf16 v[228:231], a[156:159], a[244:247], v[228:231]
    s_waitcnt lgkmcnt(4)
    ds_read_b128 v[204:207], v245 offset:192
    v_mfma_f32_16x16x32_bf16 v[228:231], a[160:163], a[216:219], v[228:231]
    ds_write_b64 v226, v[216:217] offset:128
    v_mfma_f32_16x16x32_bf16 v[232:235], a[176:179], a[240:243], v[232:235]
    s_waitcnt lgkmcnt(5)
    s_mov_b32 vcc_hi, 0xf000
    v_cndmask_b32 v244, v244, v200, vcc
    v_mfma_f32_16x16x32_bf16 v[228:231], a[164:167], a[220:223], v[228:231]
    ds_write_b64 v226, v[220:221] offset:256
    v_mfma_f32_16x16x32_bf16 v[232:235], a[180:183], a[244:247], v[232:235]
    ds_read_b128 v[196:199], v244 offset:256
    s_mov_b32 vcc_lo, 0xfff00ff
    v_mfma_f32_16x16x32_bf16 v[232:235], a[184:187], a[216:219], v[232:235]
    s_mov_b32 vcc_hi, 0xffffffff
    v_cndmask_b32 v246, v246, v200, vcc
    s_mov_b32 vcc_lo, 0xff00ff00
    v_mfma_f32_16x16x32_bf16 v[232:235], a[188:191], a[220:223], v[232:235]
    s_mov_b32 vcc_hi, 0xff00ff00
    v_mul_f32 v228, s38, v228
    v_mul_f32 v229, s38, v229
    v_mfma_f32_16x16x32_bf16 v[236:239], a[192:195], a[232:235], 0
    ds_read_b128 a[232:235], v242 offset:33920
    v_mul_f32 v230, s38, v230
    v_mfma_f32_16x16x32_bf16 v[236:239], a[196:199], a[236:239], v[236:239]
    ds_read_b128 a[236:239], v243 offset:33920
    v_mul_f32 v231, s38, v231
    v_mfma_f32_16x16x32_bf16 v[236:239], a[200:203], a[240:243], v[236:239]
    v_cvt_pk_bf16_f32 v174, v228, v229
    v_cvt_pk_bf16_f32 v175, v230, v231
    v_mfma_f32_16x16x32_bf16 v[236:239], a[204:207], a[244:247], v[236:239]
    s_waitcnt lgkmcnt(6)
    v_mul_f32 v232, s3, v232
    v_mul_f32 v233, s3, v233
    v_mfma_f32_16x16x32_bf16 v[236:239], a[208:211], a[216:219], v[236:239]
    v_mul_f32 v234, s3, v234
    v_mul_f32 v235, s3, v235
    v_mfma_f32_16x16x32_bf16 v[236:239], a[212:215], a[220:223], v[236:239]
    ds_read_b128 a[240:243], v242 offset:34048
    v_cvt_pk_bf16_f32 v176, v232, v233
    v_mfma_f32_16x16x32_bf16 v[228:231], a[144:147], a[224:227], 0
    ds_read_b128 a[244:247], v243 offset:34048
    v_cvt_pk_bf16_f32 v177, v234, v235
    v_mfma_f32_16x16x32_bf16 v[228:231], a[148:151], a[228:231], v[228:231]
    ds_read_b128 v[200:203], v244 offset:192
    s_waitcnt lgkmcnt(7)
    v_mfma_f32_16x16x32_bf16 v[204:207], v[150:153], v[168:171], v[204:207]
    v_mul_f32 v236, s38, v236
    s_waitcnt lgkmcnt(4)
    v_mfma_f32_16x16x32_bf16 v[204:207], v[152:155], v[170:173], v[204:207]
    v_mul_f32 v237, s38, v237
    v_mul_f32 v238, s38, v238
    v_mfma_f32_16x16x32_bf16 v[196:199], v[120:123], v[168:171], v[196:199]
    v_mul_f32 v239, s38, v239
    v_cvt_pk_bf16_f32 v178, v236, v237
    v_mfma_f32_16x16x32_bf16 v[196:199], v[122:125], v[170:173], v[196:199]
    ds_read_b128 v[208:211], v246 offset:192
    v_cvt_pk_bf16_f32 v179, v238, v239
    v_mfma_f32_16x16x32_bf16 v[228:231], a[152:155], a[232:235], v[228:231]
    s_waitcnt lgkmcnt(4)
    v_exp_f32 v204, v204
    v_mfma_f32_16x16x32_bf16 v[228:231], a[156:159], a[236:239], v[228:231]
    v_exp_f32 v205, v205
    v_mfma_f32_16x16x32_bf16 v[232:235], a[168:171], a[224:227], 0
    s_waitcnt lgkmcnt(3)
    v_exp_f32 v206, v206
    v_mfma_f32_16x16x32_bf16 v[228:231], a[160:163], a[240:243], v[228:231]
    s_waitcnt lgkmcnt(2)
    v_exp_f32 v207, v207
    v_mfma_f32_16x16x32_bf16 v[228:231], a[164:167], a[244:247], v[228:231]
    s_waitcnt vmcnt(8)
    s_barrier
    v_cvt_pk_bf16_f32 v194, v204, v205
    v_mfma_f32_16x16x32_bf16 v[232:235], a[172:175], a[228:231], v[232:235]
    ds_read_b128 a[216:219], v240 offset:33792
    v_cvt_pk_bf16_f32 v181, v206, v207
    v_mfma_f32_16x16x32_bf16 v[232:235], a[176:179], a[232:235], v[232:235]
    ds_read_b128 a[220:223], v241 offset:33792
    v_mul_f32 v228, s38, v228
    v_mfma_f32_16x16x32_bf16 v[232:235], a[180:183], a[236:239], v[232:235]
    v_mul_f32 v229, s38, v229
    v_mul_f32 v230, s38, v230
    v_mfma_f32_16x16x32_bf16 v[232:235], a[184:187], a[240:243], v[232:235]
    v_mul_f32 v231, s38, v231
    s_waitcnt lgkmcnt(3)
    v_mfma_f32_16x16x32_bf16 v[200:203], v[114:117], v[168:171], v[200:203]
    ds_read_b128 v[204:207], v246 offset:256
    v_cvt_pk_bf16_f32 v228, v228, v229
    v_mfma_f32_16x16x32_bf16 v[200:203], v[116:119], v[170:173], v[200:203]
    v_exp_f32 v196, v196
    v_mfma_f32_16x16x32_bf16 v[232:235], a[188:191], a[244:247], v[232:235]
    v_exp_f32 v197, v197
    v_mfma_f32_16x16x32_bf16 v[236:239], a[192:195], a[224:227], 0
    ds_read_b128 a[224:227], v240 offset:33920
    v_cvt_pk_bf16_f32 v229, v230, v231
    v_mfma_f32_16x16x32_bf16 v[236:239], a[196:199], a[228:231], v[236:239]
    ds_read_b128 a[228:231], v241 offset:33920
    s_waitcnt lgkmcnt(5)
    v_mfma_f32_16x16x32_bf16 v[208:211], v[90:93], v[168:171], v[208:211]
    ds_write_b64 v247, v[228:229] offset:18432
    v_mfma_f32_16x16x32_bf16 v[208:211], v[92:95], v[170:173], v[208:211]
    s_waitcnt lgkmcnt(5)
    v_mul_f32 v232, s3, v232
    v_mul_f32 v233, s3, v233
    v_mfma_f32_16x16x32_bf16 v[236:239], a[200:203], a[232:235], v[236:239]
    ds_read_b128 a[232:235], v240 offset:34048
    v_mul_f32 v234, s3, v234
    v_mfma_f32_16x16x32_bf16 v[236:239], a[204:207], a[236:239], v[236:239]
    ds_read_b128 a[236:239], v241 offset:34048
    v_mul_f32 v235, s3, v235
    v_mfma_f32_16x16x32_bf16 v[236:239], a[208:211], a[240:243], v[236:239]
    v_cvt_pk_bf16_f32 v232, v232, v233
    v_cvt_pk_bf16_f32 v233, v234, v235
    v_mfma_f32_16x16x32_bf16 v[236:239], a[212:215], a[244:247], v[236:239]
    ds_write_b64 v247, v[232:233] offset:18560
    v_mfma_f32_16x16x32_bf16 v[228:231], a[0:3], a[216:219], 0
    s_waitcnt lgkmcnt(7)
    v_exp_f32 v200, v200
    v_mfma_f32_16x16x32_bf16 v[228:231], a[4:7], a[220:223], v[228:231]
    s_waitcnt lgkmcnt(5)
    v_exp_f32 v201, v201
    v_mfma_f32_16x16x32_bf16 v[204:207], v[96:99], v[168:171], v[204:207]
    v_exp_f32 v202, v202
    v_mfma_f32_16x16x32_bf16 v[204:207], v[98:101], v[170:173], v[204:207]
    v_exp_f32 v203, v203
    v_mfma_f32_16x16x32_bf16 v[228:231], a[8:11], a[224:227], v[228:231]
    s_waitcnt lgkmcnt(4)
    v_cvt_pk_bf16_f32 v193, v200, v201
    v_cvt_pk_bf16_f32 v180, v202, v203
    v_mfma_f32_16x16x32_bf16 v[228:231], a[12:15], a[228:231], v[228:231]
    s_waitcnt lgkmcnt(2)
    ds_read_b128 v[200:203], v245 offset:256
    v_mfma_f32_16x16x32_bf16 v[228:231], a[16:19], a[232:235], v[228:231]
    s_waitcnt lgkmcnt(2)
    v_mul_f32 v236, s38, v236
    v_mul_f32 v237, s38, v237
    v_mfma_f32_16x16x32_bf16 v[228:231], a[20:23], a[236:239], v[228:231]
    v_mul_f32 v238, s38, v238
    v_mul_f32 v239, s38, v239
    v_mfma_f32_16x16x32_bf16 v[232:235], a[24:27], a[216:219], 0
    v_cvt_pk_bf16_f32 v236, v236, v237
    v_cvt_pk_bf16_f32 v237, v238, v239
    v_mfma_f32_16x16x32_bf16 v[232:235], a[28:31], a[220:223], v[232:235]
    ds_write_b64 v247, v[236:237] offset:18688
    v_mfma_f32_16x16x32_bf16 v[232:235], a[32:35], a[224:227], v[232:235]
    v_cvt_pk_bf16_f32 v138, v228, v229
    v_cvt_pk_bf16_f32 v139, v230, v231
    v_mfma_f32_16x16x32_bf16 v[232:235], a[36:39], a[228:231], v[232:235]
    v_exp_f32 v208, v208
    v_mfma_f32_16x16x32_bf16 v[232:235], a[40:43], a[232:235], v[232:235]
    v_exp_f32 v209, v209
    v_mfma_f32_16x16x32_bf16 v[232:235], a[44:47], a[236:239], v[232:235]
    v_exp_f32 v210, v210
    v_mfma_f32_16x16x32_bf16 v[236:239], a[48:51], a[216:219], 0
    s_waitcnt lgkmcnt(1)
    v_exp_f32 v211, v211
    v_mfma_f32_16x16x32_bf16 v[200:203], v[156:159], v[168:171], v[200:203]
    v_cvt_pk_bf16_f32 v192, v208, v209
    v_cvt_pk_bf16_f32 v195, v210, v211
    v_mfma_f32_16x16x32_bf16 v[200:203], v[158:161], v[170:173], v[200:203]
    ds_read_b128 v[208:211], v244 offset:320
    v_cvt_pk_bf16_f32 v183, v196, v197
    v_mfma_f32_16x16x32_bf16 v[212:215], v[0:3], v[192:195], 0
    v_exp_f32 v198, v198
    v_mfma_f32_16x16x32_bf16 v[216:219], v[30:33], v[192:195], 0
    v_exp_f32 v199, v199
    v_mfma_f32_16x16x32_bf16 v[220:223], v[60:63], v[192:195], 0
    v_cvt_pk_bf16_f32 v186, v198, v199
    v_cvt_pk_bf16_f32 v140, v232, v233
    v_mfma_f32_16x16x32_bf16 v[224:227], a[248:251], v[192:195], 0
    ds_read_b128 v[196:199], v245 offset:320
    v_cvt_pk_bf16_f32 v141, v234, v235
    v_mfma_f32_16x16x32_bf16 v[236:239], a[52:55], a[220:223], v[236:239]
    v_exp_f32 v204, v204
    v_mfma_f32_16x16x32_bf16 v[236:239], a[56:59], a[224:227], v[236:239]
    v_exp_f32 v205, v205
    v_mfma_f32_16x16x32_bf16 v[236:239], a[60:63], a[228:231], v[236:239]
    ds_read_b128 a[240:243], v242 offset:61440
    v_cvt_pk_bf16_f32 v182, v204, v205
    v_mfma_f32_16x16x32_bf16 v[236:239], a[64:67], a[232:235], v[236:239]
    v_exp_f32 v200, v200
    v_mfma_f32_16x16x32_bf16 v[212:215], v[4:7], v[180:183], v[212:215]
    v_exp_f32 v201, v201
    v_mfma_f32_16x16x32_bf16 v[216:219], v[34:37], v[180:183], v[216:219]
    v_exp_f32 v202, v202
    v_mfma_f32_16x16x32_bf16 v[220:223], v[64:67], v[180:183], v[220:223]
    v_exp_f32 v203, v203
    v_mfma_f32_16x16x32_bf16 v[224:227], a[248:251], v[180:183], v[224:227]
    v_cvt_pk_bf16_f32 v184, v200, v201
    v_cvt_pk_bf16_f32 v187, v202, v203
    v_mfma_f32_16x16x32_bf16 v[236:239], a[68:71], a[236:239], v[236:239]
    s_waitcnt lgkmcnt(2)
    v_exp_f32 v206, v206
    v_mfma_f32_16x16x32_bf16 v[208:211], v[126:129], v[168:171], v[208:211]
    ds_read_b128 v[200:203], v246 offset:320
    ds_read_b128 a[244:247], v243 offset:61440
    v_mfma_f32_16x16x32_bf16 v[208:211], v[128:131], v[170:173], v[208:211]
    v_exp_f32 v207, v207
    v_mfma_f32_16x16x32_bf16 v[228:231], a[216:219], a[72:75], 0
    v_cvt_pk_bf16_f32 v185, v206, v207
    v_cvt_pk_bf16_f32 v142, v236, v237
    v_mfma_f32_16x16x32_bf16 v[228:231], a[220:223], a[76:79], v[228:231]
    ds_read_b128 v[204:207], v244 offset:0
    v_cvt_pk_bf16_f32 v143, v238, v239
    v_mfma_f32_16x16x32_bf16 v[212:215], v[8:11], v[184:187], v[212:215]
    s_waitcnt lgkmcnt(4)
    v_exp_f32 v208, v208
    v_mfma_f32_16x16x32_bf16 v[216:219], v[38:41], v[184:187], v[216:219]
    v_exp_f32 v209, v209
    v_mfma_f32_16x16x32_bf16 v[220:223], v[68:71], v[184:187], v[220:223]
    v_cvt_pk_bf16_f32 v189, v208, v209
    v_mfma_f32_16x16x32_bf16 v[224:227], a[248:251], v[184:187], v[224:227]
    ds_read_b128 v[208:211], v245 offset:0
    v_mfma_f32_16x16x32_bf16 v[196:199], v[162:165], v[168:171], v[196:199]
    v_mfma_f32_16x16x32_bf16 v[196:199], v[164:167], v[170:173], v[196:199]
    v_mfma_f32_16x16x32_bf16 v[228:231], a[224:227], a[80:83], v[228:231]
    v_mfma_f32_16x16x32_bf16 v[228:231], a[228:231], a[84:87], v[228:231]
    v_mfma_f32_16x16x32_bf16 v[228:231], a[232:235], a[88:91], v[228:231]
    v_mfma_f32_16x16x32_bf16 v[228:231], a[236:239], a[92:95], v[228:231]
    v_mfma_f32_16x16x32_bf16 v[232:235], a[216:219], a[96:99], 0
    s_waitcnt lgkmcnt(3)
    v_mfma_f32_16x16x32_bf16 v[200:203], v[138:141], v[168:171], v[200:203]
    ds_read_b64 v[168:169], v247 offset:18432
    v_mfma_f32_16x16x32_bf16 v[200:203], v[140:143], v[170:173], v[200:203]
    v_exp_f32 v196, v196
    v_mfma_f32_16x16x32_bf16 v[232:235], a[220:223], a[100:103], v[232:235]
    s_waitcnt lgkmcnt(2)
    v_exp_f32 v197, v197
    v_mfma_f32_16x16x32_bf16 v[204:207], v[120:123], v[174:177], v[204:207]
    v_cvt_pk_bf16_f32 v190, v196, v197
    v_cvt_pk_bf16_f32 v12, v228, v229
    v_mfma_f32_16x16x32_bf16 v[204:207], v[122:125], v[176:179], v[204:207]
    ds_read_b128 v[196:199], v246 offset:0
    v_cvt_pk_bf16_f32 v15, v230, v231
    v_mfma_f32_16x16x32_bf16 v[232:235], a[224:227], a[104:107], v[232:235]
    v_exp_f32 v200, v200
    v_mfma_f32_16x16x32_bf16 v[232:235], a[228:231], a[108:111], v[232:235]
    s_waitcnt lgkmcnt(2)
    v_exp_f32 v201, v201
    v_mfma_f32_16x16x32_bf16 v[208:211], v[156:159], v[174:177], v[208:211]
    ds_read_b64 v[170:171], v247 offset:18560
    v_cvt_pk_bf16_f32 v188, v200, v201
    v_mfma_f32_16x16x32_bf16 v[208:211], v[158:161], v[176:179], v[208:211]
    ds_read_b128 v[200:203], v244 offset:64
    ds_read_b64 v[172:173], v247 offset:18688
    v_mfma_f32_16x16x32_bf16 v[212:215], v[12:15], v[188:191], v[212:215]
    v_exp_f32 v204, v204
    v_mfma_f32_16x16x32_bf16 v[224:227], a[248:251], v[188:191], v[224:227]
    v_exp_f32 v205, v205
    v_mfma_f32_16x16x32_bf16 v[232:235], a[232:235], a[112:115], v[232:235]
    v_exp_f32 v206, v206
    v_mfma_f32_16x16x32_bf16 v[232:235], a[236:239], a[116:119], v[232:235]
    v_exp_f32 v207, v207
    v_mfma_f32_16x16x32_bf16 v[236:239], a[216:219], a[120:123], 0
    ds_read_b128 a[216:219], v242 offset:61568
    v_cvt_pk_bf16_f32 v193, v204, v205
    v_mfma_f32_16x16x32_bf16 v[236:239], a[220:223], a[124:127], v[236:239]
    ds_read_b128 a[220:223], v243 offset:61568
    v_cvt_pk_bf16_f32 v180, v206, v207
    v_mfma_f32_16x16x32_bf16 v[236:239], a[224:227], a[128:131], v[236:239]
    v_cvt_pk_bf16_f32 v42, v232, v233
    v_cvt_pk_bf16_f32 v45, v234, v235
    v_mfma_f32_16x16x32_bf16 v[236:239], a[228:231], a[132:135], v[236:239]
    ds_read_b128 a[224:227], v242 offset:61696
    ds_read_b128 a[228:231], v243 offset:61696
    v_mfma_f32_16x16x32_bf16 v[216:219], v[42:45], v[188:191], v[216:219]
    s_waitcnt lgkmcnt(7)
    v_exp_f32 v208, v208
    v_mfma_f32_16x16x32_bf16 v[196:199], v[96:99], v[174:177], v[196:199]
    ds_read_b128 v[204:207], v245 offset:64
    v_mfma_f32_16x16x32_bf16 v[196:199], v[98:101], v[176:179], v[196:199]
    v_exp_f32 v209, v209
    v_mfma_f32_16x16x32_bf16 v[236:239], a[232:235], a[136:139], v[236:239]
    ds_read_b128 a[232:235], v242 offset:62976
    v_cvt_pk_bf16_f32 v194, v208, v209
    v_mfma_f32_16x16x32_bf16 v[236:239], a[236:239], a[140:143], v[236:239]
    s_waitcnt lgkmcnt(7)
    v_exp_f32 v210, v210
    v_mfma_f32_16x16x32_bf16 v[200:203], v[126:129], v[174:177], v[200:203]
    ds_read_b128 a[236:239], v243 offset:62976
    v_mfma_f32_16x16x32_bf16 v[200:203], v[128:131], v[176:179], v[200:203]
L_h5:
    s_cbranch_execz L_h9
    v_exp_f32 v211, v211
    v_mfma_f32_16x16x32_bf16 v[228:231], a[144:147], a[240:243], 0
    v_exp_f32 v196, v196
    v_mfma_f32_16x16x32_bf16 v[228:231], a[148:151], a[244:247], v[228:231]
    s_waitcnt lgkmcnt(6)
    v_cvt_pk_bf16_f32 v72, v236, v237
    v_cvt_pk_bf16_f32 v75, v238, v239
    v_mfma_f32_16x16x32_bf16 v[228:231], a[152:155], a[216:219], v[228:231]
    s_waitcnt lgkmcnt(5)
    v_exp_f32 v197, v197
    v_mfma_f32_16x16x32_bf16 v[220:223], v[72:75], v[188:191], v[220:223]
    v_cvt_pk_bf16_f32 v181, v210, v211
    v_cvt_pk_bf16_f32 v192, v196, v197
    v_mfma_f32_16x16x32_bf16 v[228:231], a[156:159], a[220:223], v[228:231]
    s_waitcnt lgkmcnt(4)
    v_exp_f32 v198, v198
    v_mfma_f32_16x16x32_bf16 v[228:231], a[160:163], a[224:227], v[228:231]
    s_waitcnt lgkmcnt(3)
    v_exp_f32 v199, v199
    v_mfma_f32_16x16x32_bf16 v[228:231], a[164:167], a[228:231], v[228:231]
    ds_read_b128 v[208:211], v246 offset:64
    v_cvt_pk_bf16_f32 v195, v198, v199
    v_mfma_f32_16x16x32_bf16 v[232:235], a[168:171], a[240:243], 0
    v_rcp_f32 v225, v224
    v_mfma_f32_16x16x32_bf16 v[232:235], a[172:175], a[244:247], v[232:235]
    s_waitcnt lgkmcnt(3)
    v_mul_f32 v212, v212, v225
    v_mul_f32 v213, v213, v225
    v_mfma_f32_16x16x32_bf16 v[204:207], v[162:165], v[174:177], v[204:207]
    v_mul_f32 v228, s38, v228
    v_mul_f32 v229, s38, v229
    v_mfma_f32_16x16x32_bf16 v[204:207], v[164:167], v[176:179], v[204:207]
    v_mul_f32 v230, s38, v230
    v_mul_f32 v231, s38, v231
    v_mfma_f32_16x16x32_bf16 v[232:235], a[176:179], a[216:219], v[232:235]
    ds_read_b128 v[196:199], v244 offset:128
    v_cvt_pk_bf16_f32 v228, v228, v229
    v_mfma_f32_16x16x32_bf16 v[232:235], a[180:183], a[220:223], v[232:235]
    v_cvt_pk_bf16_f32 v229, v230, v231
    v_mul_f32 v214, v214, v225
    v_mfma_f32_16x16x32_bf16 v[232:235], a[184:187], a[224:227], v[232:235]
    ds_write_b64 v247, v[228:229] offset:24576
    v_mfma_f32_16x16x32_bf16 v[232:235], a[188:191], a[228:231], v[232:235]
    s_waitcnt lgkmcnt(3)
    v_mul_f32 v215, v215, v225
    v_cvt_pk_bf16_f32 v212, v212, v213
    v_mfma_f32_16x16x32_bf16 v[236:239], a[192:195], a[240:243], 0
    ds_read_b128 a[240:243], v242 offset:63104
    v_cvt_pk_bf16_f32 v213, v214, v215
    v_mfma_f32_16x16x32_bf16 v[236:239], a[196:199], a[244:247], v[236:239]
    ds_read_b128 a[244:247], v243 offset:63104
    v_mul_f32 v232, s3, v232
    v_mfma_f32_16x16x32_bf16 v[236:239], a[200:203], a[216:219], v[236:239]
    ds_read_b128 a[216:219], v242 offset:63232
    v_mul_f32 v233, s3, v233
    v_mfma_f32_16x16x32_bf16 v[236:239], a[204:207], a[220:223], v[236:239]
    ds_read_b128 a[220:223], v243 offset:63232
    v_mul_f32 v234, s3, v234
    v_mfma_f32_16x16x32_bf16 v[236:239], a[208:211], a[224:227], v[236:239]
    s_waitcnt lgkmcnt(6)
    v_mul_f32 v235, s3, v235
    v_cvt_pk_bf16_f32 v232, v232, v233
    v_mfma_f32_16x16x32_bf16 v[208:211], v[138:141], v[174:177], v[208:211]
    ds_read_b128 a[224:227], v240 offset:35328
    v_cvt_pk_bf16_f32 v233, v234, v235
    v_mfma_f32_16x16x32_bf16 v[208:211], v[140:143], v[176:179], v[208:211]
    ds_write_b64 v247, v[232:233] offset:24704
    v_mfma_f32_16x16x32_bf16 v[236:239], a[212:215], a[228:231], v[236:239]
    ds_read_b128 a[228:231], v241 offset:35328
    v_mul_f32 v216, v216, v225
    v_mfma_f32_16x16x32_bf16 v[228:231], a[144:147], a[232:235], 0
    ds_write_b64 v247, v[212:213] offset:6144
    v_mfma_f32_16x16x32_bf16 v[212:215], v[6:9], v[192:195], 0
    s_waitcnt lgkmcnt(9)
    v_mul_f32 v217, v217, v225
    v_mul_f32 v218, v218, v225
    v_mfma_f32_16x16x32_bf16 v[196:199], v[132:135], v[174:177], v[196:199]
    v_mul_f32 v236, s38, v236
    v_mul_f32 v237, s38, v237
    v_mfma_f32_16x16x32_bf16 v[196:199], v[134:137], v[176:179], v[196:199]
    v_mul_f32 v238, s38, v238
    v_mul_f32 v239, s38, v239
    v_mfma_f32_16x16x32_bf16 v[228:231], a[148:151], a[236:239], v[228:231]
    s_waitcnt lgkmcnt(7)
    v_cvt_pk_bf16_f32 v236, v236, v237
    v_cvt_pk_bf16_f32 v237, v238, v239
    v_mfma_f32_16x16x32_bf16 v[228:231], a[152:155], a[240:243], v[228:231]
    s_waitcnt lgkmcnt(6)
    v_mul_f32 v219, v219, v225
    v_cvt_pk_bf16_f32 v216, v216, v217
    v_mfma_f32_16x16x32_bf16 v[228:231], a[156:159], a[244:247], v[228:231]
    s_waitcnt lgkmcnt(5)
    v_cvt_pk_bf16_f32 v217, v218, v219
    v_mul_f32 v220, v220, v225
    v_mfma_f32_16x16x32_bf16 v[228:231], a[160:163], a[216:219], v[228:231]
    s_waitcnt lgkmcnt(4)
    v_mul_f32 v221, v221, v225
    v_mul_f32 v222, v222, v225
    v_mfma_f32_16x16x32_bf16 v[228:231], a[164:167], a[220:223], v[228:231]
    ds_write_b64 v247, v[236:237] offset:24832
    v_mfma_f32_16x16x32_bf16 v[232:235], a[168:171], a[232:235], 0
    ds_write_b64 v247, v[216:217] offset:6272
    v_mfma_f32_16x16x32_bf16 v[216:219], v[36:39], v[192:195], 0
    v_mul_f32 v223, v223, v225
    v_cvt_pk_bf16_f32 v220, v220, v221
    v_mfma_f32_16x16x32_bf16 v[232:235], a[172:175], a[236:239], v[232:235]
    v_cvt_pk_bf16_f32 v221, v222, v223
    v_mul_f32 v228, s38, v228
    v_mfma_f32_16x16x32_bf16 v[232:235], a[176:179], a[240:243], v[232:235]
    v_mul_f32 v229, s38, v229
    v_mul_f32 v230, s38, v230
    v_mfma_f32_16x16x32_bf16 v[232:235], a[180:183], a[244:247], v[232:235]
    v_mul_f32 v231, s38, v231
    v_cvt_pk_bf16_f32 v228, v228, v229
    v_mfma_f32_16x16x32_bf16 v[232:235], a[184:187], a[216:219], v[232:235]
    v_cvt_pk_bf16_f32 v229, v230, v231
    v_max3_f32 v248, v248, v224, v225
    v_mfma_f32_16x16x32_bf16 v[224:227], a[248:251], v[192:195], 0
    ds_write_b64 v247, v[228:229] offset:30720
    v_mfma_f32_16x16x32_bf16 v[232:235], a[188:191], a[220:223], v[232:235]
    s_waitcnt lgkmcnt(3)
    v_exp_f32 v200, v200
    v_mfma_f32_16x16x32_bf16 v[236:239], a[192:195], a[232:235], 0
    ds_read_b128 a[232:235], v240 offset:35456
    v_mfma_f32_16x16x32_bf16 v[236:239], a[196:199], a[236:239], v[236:239]
    ds_read_b128 a[236:239], v241 offset:35456
    v_mfma_f32_16x16x32_bf16 v[236:239], a[200:203], a[240:243], v[236:239]
    ds_read_b128 a[240:243], v240 offset:35584
    v_mul_f32 v232, s3, v232
    v_mfma_f32_16x16x32_bf16 v[236:239], a[204:207], a[244:247], v[236:239]
    v_mul_f32 v233, s3, v233
    v_mul_f32 v234, s3, v234
    v_mfma_f32_16x16x32_bf16 v[236:239], a[208:211], a[216:219], v[236:239]
    v_mul_f32 v235, s3, v235
    v_cvt_pk_bf16_f32 v232, v232, v233
    v_mfma_f32_16x16x32_bf16 v[236:239], a[212:215], a[220:223], v[236:239]
    ds_read_b128 a[244:247], v241 offset:35584
    v_cvt_pk_bf16_f32 v233, v234, v235
    v_mfma_f32_16x16x32_bf16 v[228:231], a[0:3], a[224:227], 0
    ds_write_b64 v247, v[232:233] offset:30848
    v_mfma_f32_16x16x32_bf16 v[228:231], a[4:7], a[228:231], v[228:231]
    ds_write_b64 v247, v[220:221] offset:6400
    v_mfma_f32_16x16x32_bf16 v[220:223], v[66:69], v[192:195], 0
    s_waitcnt lgkmcnt(5)
    v_mul_f32 v236, s38, v236
    v_mul_f32 v237, s38, v237
    v_mfma_f32_16x16x32_bf16 v[228:231], a[8:11], a[232:235], v[228:231]
    s_waitcnt lgkmcnt(4)
    v_mul_f32 v238, s38, v238
    v_mul_f32 v239, s38, v239
    v_mfma_f32_16x16x32_bf16 v[228:231], a[12:15], a[236:239], v[228:231]
    s_waitcnt lgkmcnt(3)
    v_cvt_pk_bf16_f32 v236, v236, v237
    v_cvt_pk_bf16_f32 v237, v238, v239
    v_mfma_f32_16x16x32_bf16 v[228:231], a[16:19], a[240:243], v[228:231]
    ds_write_b64 v247, v[236:237] offset:30976
    v_mfma_f32_16x16x32_bf16 v[232:235], a[24:27], a[224:227], 0
    v_exp_f32 v201, v201
    v_mfma_f32_16x16x32_bf16 v[232:235], a[28:31], a[228:231], v[232:235]
    s_waitcnt lgkmcnt(3)
    v_exp_f32 v202, v202
    v_mfma_f32_16x16x32_bf16 v[228:231], a[20:23], a[244:247], v[228:231]
    v_exp_f32 v203, v203
    v_mfma_f32_16x16x32_bf16 v[232:235], a[32:35], a[232:235], v[232:235]
    v_cvt_pk_bf16_f32 v183, v200, v201
    v_cvt_pk_bf16_f32 v186, v202, v203
    v_mfma_f32_16x16x32_bf16 v[232:235], a[36:39], a[236:239], v[232:235]
    ds_read_b128 v[200:203], v245 offset:128
    ds_read_b128 a[216:219], v242 offset:64512
    v_mfma_f32_16x16x32_bf16 v[232:235], a[40:43], a[240:243], v[232:235]
    v_cvt_pk_bf16_f32 v114, v228, v229
    v_cvt_pk_bf16_f32 v115, v230, v231
    v_mfma_f32_16x16x32_bf16 v[232:235], a[44:47], a[244:247], v[232:235]
    v_exp_f32 v204, v204
    v_mfma_f32_16x16x32_bf16 v[236:239], a[48:51], a[224:227], 0
    v_exp_f32 v205, v205
    v_mfma_f32_16x16x32_bf16 v[236:239], a[52:55], a[228:231], v[236:239]
    v_exp_f32 v206, v206
    v_mfma_f32_16x16x32_bf16 v[236:239], a[56:59], a[232:235], v[236:239]
    v_exp_f32 v207, v207
    v_mfma_f32_16x16x32_bf16 v[236:239], a[60:63], a[236:239], v[236:239]
    v_cvt_pk_bf16_f32 v116, v232, v233
    v_cvt_pk_bf16_f32 v117, v234, v235
    v_mfma_f32_16x16x32_bf16 v[236:239], a[64:67], a[240:243], v[236:239]
    v_cvt_pk_bf16_f32 v184, v204, v205
    v_cvt_pk_bf16_f32 v187, v206, v207
    v_mfma_f32_16x16x32_bf16 v[236:239], a[68:71], a[244:247], v[236:239]
    v_exp_f32 v208, v208
    v_mfma_f32_16x16x32_bf16 v[228:231], a[224:227], a[72:75], 0
    v_exp_f32 v209, v209
    v_mfma_f32_16x16x32_bf16 v[228:231], a[228:231], a[76:79], v[228:231]
    ds_read_b128 v[204:207], v246 offset:128
    v_cvt_pk_bf16_f32 v182, v208, v209
    v_mfma_f32_16x16x32_bf16 v[228:231], a[232:235], a[80:83], v[228:231]
    v_exp_f32 v210, v210
    v_mfma_f32_16x16x32_bf16 v[212:215], v[10:13], v[180:183], v[212:215]
    v_exp_f32 v211, v211
    v_mfma_f32_16x16x32_bf16 v[216:219], v[40:43], v[180:183], v[216:219]
    v_cvt_pk_bf16_f32 v185, v210, v211
    s_waitcnt lgkmcnt(2)
    v_mfma_f32_16x16x32_bf16 v[220:223], v[70:73], v[180:183], v[220:223]
    ds_read_b128 v[208:211], v244 offset:0
    v_cvt_pk_bf16_f32 v118, v236, v237
    v_mfma_f32_16x16x32_bf16 v[224:227], a[248:251], v[180:183], v[224:227]
    v_exp_f32 v196, v196
    v_mfma_f32_16x16x32_bf16 v[212:215], v[14:17], v[184:187], v[212:215]
    s_waitcnt vmcnt(0)
    v_exp_f32 v197, v197
    v_mfma_f32_16x16x32_bf16 v[216:219], v[44:47], v[184:187], v[216:219]
    s_barrier
    v_cvt_pk_bf16_f32 v189, v196, v197
    v_cvt_pk_bf16_f32 v119, v238, v239
    v_mfma_f32_16x16x32_bf16 v[220:223], v[74:77], v[184:187], v[220:223]
    ds_read_b128 v[196:199], v245 offset:0
    ds_read_b128 a[220:223], v243 offset:64512
    v_mfma_f32_16x16x32_bf16 v[224:227], a[248:251], v[184:187], v[224:227]
    v_mfma_f32_16x16x32_bf16 v[200:203], v[102:105], v[174:177], v[200:203]
    v_mfma_f32_16x16x32_bf16 v[200:203], v[104:107], v[176:179], v[200:203]
    v_mfma_f32_16x16x32_bf16 v[228:231], a[236:239], a[84:87], v[228:231]
    v_mfma_f32_16x16x32_bf16 v[228:231], a[240:243], a[88:91], v[228:231]
    v_mfma_f32_16x16x32_bf16 v[228:231], a[244:247], a[92:95], v[228:231]
    s_waitcnt lgkmcnt(3)
    v_mfma_f32_16x16x32_bf16 v[204:207], v[114:117], v[174:177], v[204:207]
    ds_read_b64 v[174:175], v247 offset:0
    v_mfma_f32_16x16x32_bf16 v[204:207], v[116:119], v[176:179], v[204:207]
    ds_read_b64 v[176:177], v247 offset:128
    ds_read_b64 v[178:179], v247 offset:256
    v_mfma_f32_16x16x32_bf16 v[232:235], a[224:227], a[96:99], 0
    s_waitcnt lgkmcnt(5)
    v_exp_f32 v200, v200
    v_mfma_f32_16x16x32_bf16 v[208:211], v[126:129], v[168:171], v[208:211]
    v_exp_f32 v201, v201
    v_mfma_f32_16x16x32_bf16 v[208:211], v[128:131], v[170:173], v[208:211]
    v_cvt_pk_bf16_f32 v190, v200, v201
    v_cvt_pk_bf16_f32 v18, v228, v229
    v_mfma_f32_16x16x32_bf16 v[232:235], a[228:231], a[100:103], v[232:235]
    ds_read_b128 v[200:203], v246 offset:0
    v_cvt_pk_bf16_f32 v21, v230, v231
    v_mfma_f32_16x16x32_bf16 v[232:235], a[232:235], a[104:107], v[232:235]
    s_waitcnt lgkmcnt(5)
    v_exp_f32 v204, v204
    v_mfma_f32_16x16x32_bf16 v[196:199], v[162:165], v[168:171], v[196:199]
    v_exp_f32 v205, v205
    v_mfma_f32_16x16x32_bf16 v[196:199], v[164:167], v[170:173], v[196:199]
    v_exp_f32 v208, v208
    v_mfma_f32_16x16x32_bf16 v[232:235], a[236:239], a[108:111], v[232:235]
    v_exp_f32 v209, v209
    v_mfma_f32_16x16x32_bf16 v[232:235], a[240:243], a[112:115], v[232:235]
    v_cvt_pk_bf16_f32 v188, v204, v205
    v_cvt_pk_bf16_f32 v193, v208, v209
    v_mfma_f32_16x16x32_bf16 v[232:235], a[244:247], a[116:119], v[232:235]
    ds_read_b128 v[204:207], v244 offset:64
    v_mfma_f32_16x16x32_bf16 v[212:215], v[18:21], v[188:191], v[212:215]
    v_exp_f32 v210, v210
    v_mfma_f32_16x16x32_bf16 v[224:227], a[248:251], v[188:191], v[224:227]
    v_exp_f32 v211, v211
    v_mfma_f32_16x16x32_bf16 v[236:239], a[224:227], a[120:123], 0
    s_waitcnt lgkmcnt(1)
    ds_read_b128 a[224:227], v242 offset:64640
    v_mfma_f32_16x16x32_bf16 v[200:203], v[138:141], v[168:171], v[200:203]
    v_cvt_pk_bf16_f32 v48, v232, v233
    v_cvt_pk_bf16_f32 v51, v234, v235
    v_mfma_f32_16x16x32_bf16 v[200:203], v[140:143], v[170:173], v[200:203]
    v_exp_f32 v196, v196
    v_mfma_f32_16x16x32_bf16 v[216:219], v[48:51], v[188:191], v[216:219]
    v_exp_f32 v197, v197
    v_mfma_f32_16x16x32_bf16 v[236:239], a[228:231], a[124:127], v[236:239]
    ds_read_b128 a[228:231], v243 offset:64640
    v_cvt_pk_bf16_f32 v180, v210, v211
    v_mfma_f32_16x16x32_bf16 v[236:239], a[232:235], a[128:131], v[236:239]
    ds_read_b128 a[232:235], v242 offset:64768
    v_add_u32 v242, 0xf000, v242
    v_mfma_f32_16x16x32_bf16 v[236:239], a[236:239], a[132:135], v[236:239]
    ds_read_b128 a[236:239], v243 offset:64768
    v_add_u32 v243, 0xf000, v243
    v_mfma_f32_16x16x32_bf16 v[236:239], a[240:243], a[136:139], v[236:239]
    ds_read_b128 a[240:243], v242 offset:4608
    v_cvt_pk_bf16_f32 v194, v196, v197
    v_mfma_f32_16x16x32_bf16 v[236:239], a[244:247], a[140:143], v[236:239]
    ds_read_b128 a[244:247], v243 offset:4608
    ds_read_b128 v[208:211], v245 offset:64
    v_mfma_f32_16x16x32_bf16 v[228:231], a[144:147], a[216:219], 0
    v_exp_f32 v198, v198
    v_mfma_f32_16x16x32_bf16 v[228:231], a[148:151], a[220:223], v[228:231]
    s_waitcnt lgkmcnt(6)
    v_exp_f32 v199, v199
    v_mfma_f32_16x16x32_bf16 v[204:207], v[132:135], v[168:171], v[204:207]
    v_cvt_pk_bf16_f32 v78, v236, v237
    v_cvt_pk_bf16_f32 v81, v238, v239
    v_mfma_f32_16x16x32_bf16 v[204:207], v[134:137], v[170:173], v[204:207]
    v_rcp_f32 v225, v224
    v_mfma_f32_16x16x32_bf16 v[220:223], v[78:81], v[188:191], v[220:223]
    v_cvt_pk_bf16_f32 v181, v198, v199
    v_mul_f32 v212, v212, v225
    v_mfma_f32_16x16x32_bf16 v[228:231], a[152:155], a[224:227], v[228:231]
    s_waitcnt lgkmcnt(5)
    v_exp_f32 v200, v200
    v_mfma_f32_16x16x32_bf16 v[228:231], a[156:159], a[228:231], v[228:231]
    s_waitcnt lgkmcnt(4)
    v_exp_f32 v201, v201
    v_mfma_f32_16x16x32_bf16 v[228:231], a[160:163], a[232:235], v[228:231]
    s_waitcnt lgkmcnt(3)
    v_exp_f32 v202, v202
    v_mfma_f32_16x16x32_bf16 v[228:231], a[164:167], a[236:239], v[228:231]
    ds_read_b128 v[196:199], v246 offset:64
    v_mul_f32 v213, v213, v225
    v_mfma_f32_16x16x32_bf16 v[232:235], a[168:171], a[216:219], 0
    v_exp_f32 v203, v203
    v_mfma_f32_16x16x32_bf16 v[232:235], a[172:175], a[220:223], v[232:235]
    v_cvt_pk_bf16_f32 v192, v200, v201
    v_cvt_pk_bf16_f32 v195, v202, v203
    v_mfma_f32_16x16x32_bf16 v[232:235], a[176:179], a[224:227], v[232:235]
    v_mul_f32 v228, s38, v228
    v_mul_f32 v229, s38, v229
    v_mfma_f32_16x16x32_bf16 v[232:235], a[180:183], a[228:231], v[232:235]
    v_mul_f32 v230, s38, v230
    v_mul_f32 v231, s38, v231
    v_mfma_f32_16x16x32_bf16 v[232:235], a[184:187], a[232:235], v[232:235]
    v_cvt_pk_bf16_f32 v228, v228, v229
    v_cvt_pk_bf16_f32 v229, v230, v231
    v_mfma_f32_16x16x32_bf16 v[232:235], a[188:191], a[236:239], v[232:235]
    ds_write_b64 v247, v[228:229] offset:36864
    v_mfma_f32_16x16x32_bf16 v[236:239], a[192:195], a[216:219], 0
    ds_read_b128 a[216:219], v242 offset:4736
    s_waitcnt lgkmcnt(3)
    v_mfma_f32_16x16x32_bf16 v[208:211], v[102:105], v[168:171], v[208:211]
    v_mul_f32 v214, v214, v225
    v_mul_f32 v215, v215, v225
    v_mfma_f32_16x16x32_bf16 v[208:211], v[104:107], v[170:173], v[208:211]
    v_mul_f32 v232, s3, v232
    v_mul_f32 v233, s3, v233
    v_mfma_f32_16x16x32_bf16 v[236:239], a[196:199], a[220:223], v[236:239]
    ds_read_b128 a[220:223], v243 offset:4736
    v_mul_f32 v234, s3, v234
    v_mfma_f32_16x16x32_bf16 v[236:239], a[200:203], a[224:227], v[236:239]
    ds_read_b128 a[224:227], v242 offset:4864
    v_mul_f32 v235, s3, v235
    v_mfma_f32_16x16x32_bf16 v[236:239], a[204:207], a[228:231], v[236:239]
    ds_read_b128 a[228:231], v243 offset:4864
    v_cvt_pk_bf16_f32 v232, v232, v233
    v_mfma_f32_16x16x32_bf16 v[236:239], a[208:211], a[232:235], v[236:239]
    s_waitcnt lgkmcnt(5)
    v_cvt_pk_bf16_f32 v233, v234, v235
    v_add_u32 v242, 0x7800, v242
    v_mfma_f32_16x16x32_bf16 v[196:199], v[114:117], v[168:171], v[196:199]
    ds_write_b64 v247, v[232:233] offset:36992
    v_mfma_f32_16x16x32_bf16 v[196:199], v[116:119], v[170:173], v[196:199]
    v_add_u32 v243, 0x4200, v243
    v_cndmask_b32 v242, v242, v243, vcc
    v_mfma_f32_16x16x32_bf16 v[236:239], a[212:215], a[236:239], v[236:239]
    s_mov_b32 vcc_lo, 0xf0f0f0f0
    v_add_u32 v243, 0xfffe2000, v242
    v_cvt_pk_bf16_f32 v212, v212, v213
    v_mfma_f32_16x16x32_bf16 v[228:231], a[144:147], a[240:243], 0
    s_mov_b32 vcc_hi, 0xf0f0f0f0
    v_cndmask_b32 v242, v242, v243, vcc
    v_xor_b32 v243, 64, v242
    v_mfma_f32_16x16x32_bf16 v[228:231], a[148:151], a[244:247], v[228:231]
    s_waitcnt lgkmcnt(4)
    ds_read_b128 a[232:235], v242 offset:0
    v_mfma_f32_16x16x32_bf16 v[228:231], a[152:155], a[216:219], v[228:231]
    s_waitcnt lgkmcnt(4)
    v_mul_f32 v236, s38, v236
    v_mul_f32 v237, s38, v237
    v_mfma_f32_16x16x32_bf16 v[228:231], a[156:159], a[220:223], v[228:231]
    s_waitcnt lgkmcnt(3)
    v_mul_f32 v238, s38, v238
    v_mul_f32 v239, s38, v239
    v_mfma_f32_16x16x32_bf16 v[228:231], a[160:163], a[224:227], v[228:231]
    ds_read_b128 a[236:239], v243 offset:0
    v_cvt_pk_bf16_f32 v236, v236, v237
    v_mfma_f32_16x16x32_bf16 v[232:235], a[168:171], a[240:243], 0
    s_mov_b32 vcc_lo, 0xcccccccc
    v_cvt_pk_bf16_f32 v237, v238, v239
    v_cvt_pk_bf16_f32 v213, v214, v215
    v_mfma_f32_16x16x32_bf16 v[232:235], a[172:175], a[244:247], v[232:235]
    ds_write_b64 v247, v[236:237] offset:37120
    v_mfma_f32_16x16x32_bf16 v[232:235], a[176:179], a[216:219], v[232:235]
    s_waitcnt lgkmcnt(4)
    v_mul_f32 v216, v216, v225
    v_mul_f32 v217, v217, v225
    v_mfma_f32_16x16x32_bf16 v[228:231], a[164:167], a[228:231], v[228:231]
    ds_read_b128 v[200:203], v244 offset:128
    v_mul_f32 v218, v218, v225
    v_mfma_f32_16x16x32_bf16 v[232:235], a[180:183], a[220:223], v[232:235]
    ds_write_b64 v247, v[212:213] offset:12288
    v_mfma_f32_16x16x32_bf16 v[212:215], v[12:15], v[192:195], 0
    s_mov_b32 vcc_hi, 0xcccccccc
    v_mul_f32 v219, v219, v225
    v_cvt_pk_bf16_f32 v216, v216, v217
    v_mfma_f32_16x16x32_bf16 v[232:235], a[184:187], a[224:227], v[232:235]
    v_mul_f32 v228, s38, v228
    v_mul_f32 v229, s38, v229
    v_mfma_f32_16x16x32_bf16 v[232:235], a[188:191], a[228:231], v[232:235]
    v_mul_f32 v230, s38, v230
    v_mul_f32 v231, s38, v231
    v_mfma_f32_16x16x32_bf16 v[236:239], a[192:195], a[240:243], 0
    ds_read_b128 a[240:243], v242 offset:128
    v_cvt_pk_bf16_f32 v228, v228, v229
    v_mfma_f32_16x16x32_bf16 v[236:239], a[196:199], a[244:247], v[236:239]
    ds_read_b128 a[244:247], v243 offset:128
    v_cvt_pk_bf16_f32 v229, v230, v231
    v_mfma_f32_16x16x32_bf16 v[236:239], a[200:203], a[216:219], v[236:239]
    ds_read_b128 a[216:219], v242 offset:256
    v_mul_f32 v232, s3, v232
    v_mfma_f32_16x16x32_bf16 v[236:239], a[204:207], a[220:223], v[236:239]
    ds_read_b128 a[220:223], v243 offset:256
    v_mul_f32 v233, s3, v233
    v_mfma_f32_16x16x32_bf16 v[236:239], a[208:211], a[224:227], v[236:239]
    ds_write_b64 v247, v[228:229] offset:43008
    v_mfma_f32_16x16x32_bf16 v[236:239], a[212:215], a[228:231], v[236:239]
    s_waitcnt lgkmcnt(6)
    v_mul_f32 v234, s3, v234
    v_mul_f32 v235, s3, v235
    v_mfma_f32_16x16x32_bf16 v[200:203], v[144:147], v[168:171], v[200:203]
    ds_read_b128 a[224:227], v240 offset:36864
    v_cvt_pk_bf16_f32 v232, v232, v233
    v_mfma_f32_16x16x32_bf16 v[200:203], v[146:149], v[170:173], v[200:203]
    ds_read_b128 a[228:231], v241 offset:36864
    v_cvt_pk_bf16_f32 v233, v234, v235
    v_mfma_f32_16x16x32_bf16 v[228:231], a[144:147], a[232:235], 0
    ds_write_b64 v247, v[232:233] offset:43136
    v_mfma_f32_16x16x32_bf16 v[228:231], a[148:151], a[236:239], v[228:231]
    s_waitcnt lgkmcnt(7)
    v_mul_f32 v236, s38, v236
    v_mul_f32 v237, s38, v237
    v_mfma_f32_16x16x32_bf16 v[228:231], a[152:155], a[240:243], v[228:231]
    s_waitcnt lgkmcnt(6)
    v_mul_f32 v238, s38, v238
    v_mul_f32 v239, s38, v239
    v_mfma_f32_16x16x32_bf16 v[228:231], a[156:159], a[244:247], v[228:231]
    s_waitcnt lgkmcnt(5)
    v_cvt_pk_bf16_f32 v236, v236, v237
    v_cvt_pk_bf16_f32 v237, v238, v239
    v_mfma_f32_16x16x32_bf16 v[228:231], a[160:163], a[216:219], v[228:231]
    s_waitcnt lgkmcnt(4)
    v_cvt_pk_bf16_f32 v217, v218, v219
    v_mul_f32 v220, v220, v225
    v_mfma_f32_16x16x32_bf16 v[228:231], a[164:167], a[220:223], v[228:231]
    ds_write_b64 v247, v[236:237] offset:43264
    v_mfma_f32_16x16x32_bf16 v[232:235], a[168:171], a[232:235], 0
    ds_write_b64 v247, v[216:217] offset:12416
    v_mfma_f32_16x16x32_bf16 v[216:219], v[42:45], v[192:195], 0
    v_mul_f32 v221, v221, v225
    v_mul_f32 v222, v222, v225
    v_mfma_f32_16x16x32_bf16 v[232:235], a[172:175], a[236:239], v[232:235]
    v_mul_f32 v223, v223, v225
    v_mul_f32 v228, s38, v228
    v_mfma_f32_16x16x32_bf16 v[232:235], a[176:179], a[240:243], v[232:235]
    v_mul_f32 v229, s38, v229
    v_mul_f32 v230, s38, v230
    v_mfma_f32_16x16x32_bf16 v[232:235], a[180:183], a[244:247], v[232:235]
    v_mul_f32 v231, s38, v231
    v_cvt_pk_bf16_f32 v228, v228, v229
    v_mfma_f32_16x16x32_bf16 v[232:235], a[184:187], a[216:219], v[232:235]
    v_cvt_pk_bf16_f32 v229, v230, v231
    v_cvt_pk_bf16_f32 v220, v220, v221
    v_mfma_f32_16x16x32_bf16 v[232:235], a[188:191], a[220:223], v[232:235]
    ds_write_b64 v247, v[228:229] offset:49152
    v_mfma_f32_16x16x32_bf16 v[236:239], a[192:195], a[232:235], 0
    ds_read_b128 a[232:235], v240 offset:36992
    s_waitcnt lgkmcnt(4)
    v_mfma_f32_16x16x32_bf16 v[236:239], a[196:199], a[236:239], v[236:239]
    ds_read_b128 a[236:239], v241 offset:36992
    v_cvt_pk_bf16_f32 v221, v222, v223
    v_mfma_f32_16x16x32_bf16 v[236:239], a[200:203], a[240:243], v[236:239]
    ds_read_b128 a[240:243], v240 offset:37120
    v_mul_f32 v232, s3, v232
    v_mfma_f32_16x16x32_bf16 v[236:239], a[204:207], a[244:247], v[236:239]
    ds_read_b128 a[244:247], v241 offset:37120
    v_mul_f32 v233, s3, v233
    v_mfma_f32_16x16x32_bf16 v[236:239], a[208:211], a[216:219], v[236:239]
    v_mul_f32 v234, s3, v234
    v_mul_f32 v235, s3, v235
    v_mfma_f32_16x16x32_bf16 v[236:239], a[212:215], a[220:223], v[236:239]
    v_cvt_pk_bf16_f32 v232, v232, v233
    v_cvt_pk_bf16_f32 v233, v234, v235
    v_mfma_f32_16x16x32_bf16 v[228:231], a[0:3], a[224:227], 0
    ds_write_b64 v247, v[232:233] offset:49280
    v_mfma_f32_16x16x32_bf16 v[228:231], a[4:7], a[228:231], v[228:231]
    ds_write_b64 v247, v[220:221] offset:12544
    v_mfma_f32_16x16x32_bf16 v[220:223], v[72:75], v[192:195], 0
    s_waitcnt lgkmcnt(5)
    v_mul_f32 v236, s38, v236
    v_mul_f32 v237, s38, v237
    v_mfma_f32_16x16x32_bf16 v[228:231], a[8:11], a[232:235], v[228:231]
    s_waitcnt lgkmcnt(4)
    v_mul_f32 v238, s38, v238
    v_mul_f32 v239, s38, v239
    v_mfma_f32_16x16x32_bf16 v[228:231], a[12:15], a[236:239], v[228:231]
    s_waitcnt lgkmcnt(3)
    v_cvt_pk_bf16_f32 v236, v236, v237
    v_cvt_pk_bf16_f32 v237, v238, v239
    v_mfma_f32_16x16x32_bf16 v[228:231], a[16:19], a[240:243], v[228:231]
    s_waitcnt lgkmcnt(2)
    v_max3_f32 v248, v248, v224, v225
    v_add_u32 v240, 0xffff1000, v240
    v_mfma_f32_16x16x32_bf16 v[224:227], a[248:251], v[192:195], 0
    ds_write_b64 v247, v[236:237] offset:49408
    v_mfma_f32_16x16x32_bf16 v[228:231], a[20:23], a[244:247], v[228:231]
    v_exp_f32 v204, v204
    v_mfma_f32_16x16x32_bf16 v[232:235], a[24:27], a[224:227], 0
    v_exp_f32 v205, v205
    v_mfma_f32_16x16x32_bf16 v[232:235], a[28:31], a[228:231], v[232:235]
    v_exp_f32 v206, v206
    v_mfma_f32_16x16x32_bf16 v[232:235], a[32:35], a[232:235], v[232:235]
    v_exp_f32 v207, v207
    v_mfma_f32_16x16x32_bf16 v[232:235], a[36:39], a[236:239], v[232:235]
    v_cvt_pk_bf16_f32 v183, v204, v205
    v_cvt_pk_bf16_f32 v186, v206, v207
    v_mfma_f32_16x16x32_bf16 v[232:235], a[40:43], a[240:243], v[232:235]
    ds_read_b128 v[204:207], v245 offset:128
    v_cvt_pk_bf16_f32 v120, v228, v229
    v_mfma_f32_16x16x32_bf16 v[232:235], a[44:47], a[244:247], v[232:235]
    ds_read_b128 a[216:219], v242 offset:3072
    v_cvt_pk_bf16_f32 v121, v230, v231
    v_mfma_f32_16x16x32_bf16 v[236:239], a[48:51], a[224:227], 0
    v_exp_f32 v208, v208
    v_mfma_f32_16x16x32_bf16 v[236:239], a[52:55], a[228:231], v[236:239]
    v_exp_f32 v209, v209
    v_mfma_f32_16x16x32_bf16 v[236:239], a[56:59], a[232:235], v[236:239]
    v_exp_f32 v210, v210
    v_mfma_f32_16x16x32_bf16 v[236:239], a[60:63], a[236:239], v[236:239]
    v_exp_f32 v211, v211
    v_mfma_f32_16x16x32_bf16 v[236:239], a[64:67], a[240:243], v[236:239]
    v_cvt_pk_bf16_f32 v184, v208, v209
    v_cvt_pk_bf16_f32 v187, v210, v211
    v_mfma_f32_16x16x32_bf16 v[236:239], a[68:71], a[244:247], v[236:239]
    ds_read_b128 v[208:211], v246 offset:128
    v_cvt_pk_bf16_f32 v122, v232, v233
    v_mfma_f32_16x16x32_bf16 v[228:231], a[224:227], a[72:75], 0
    ds_read_b128 a[220:223], v243 offset:3072
    v_cvt_pk_bf16_f32 v123, v234, v235
    v_mfma_f32_16x16x32_bf16 v[228:231], a[228:231], a[76:79], v[228:231]
    v_exp_f32 v196, v196
    v_mfma_f32_16x16x32_bf16 v[228:231], a[232:235], a[80:83], v[228:231]
    v_exp_f32 v197, v197
    v_mfma_f32_16x16x32_bf16 v[228:231], a[236:239], a[84:87], v[228:231]
    s_waitcnt lgkmcnt(3)
    v_cvt_pk_bf16_f32 v182, v196, v197
    v_cvt_pk_bf16_f32 v124, v236, v237
    v_mfma_f32_16x16x32_bf16 v[204:207], v[108:111], v[168:171], v[204:207]
    v_cvt_pk_bf16_f32 v125, v238, v239
    v_add_u32 v241, 0xffff1000, v241
    v_mfma_f32_16x16x32_bf16 v[212:215], v[16:19], v[180:183], v[212:215]
    v_exp_f32 v198, v198
    v_mfma_f32_16x16x32_bf16 v[216:219], v[46:49], v[180:183], v[216:219]
    v_exp_f32 v199, v199
    v_mfma_f32_16x16x32_bf16 v[220:223], v[76:79], v[180:183], v[220:223]
    v_exp_f32 v200, v200
    v_mfma_f32_16x16x32_bf16 v[224:227], a[248:251], v[180:183], v[224:227]
    v_exp_f32 v201, v201
    v_mfma_f32_16x16x32_bf16 v[204:207], v[110:113], v[170:173], v[204:207]
    v_cvt_pk_bf16_f32 v185, v198, v199
    v_cvt_pk_bf16_f32 v189, v200, v201
    v_mfma_f32_16x16x32_bf16 v[228:231], a[240:243], a[88:91], v[228:231]
    ds_read_b128 v[196:199], v244 offset:32
    ds_read_b128 v[200:203], v245 offset:32
    v_mfma_f32_16x16x32_bf16 v[212:215], v[20:23], v[184:187], v[212:215]
    s_waitcnt lgkmcnt(3)
    v_mfma_f32_16x16x32_bf16 v[216:219], v[50:53], v[184:187], v[216:219]
    v_exp_f32 v204, v204
    v_mfma_f32_16x16x32_bf16 v[220:223], v[80:83], v[184:187], v[220:223]
    v_exp_f32 v205, v205
    v_mfma_f32_16x16x32_bf16 v[224:227], a[248:251], v[184:187], v[224:227]
    v_cvt_pk_bf16_f32 v190, v204, v205
    v_mfma_f32_16x16x32_bf16 v[208:211], v[120:123], v[168:171], v[208:211]
    ds_read_b128 v[204:207], v246 offset:32
    ds_read_b64 v[168:169], v247 offset:24576
    v_mfma_f32_16x16x32_bf16 v[208:211], v[122:125], v[170:173], v[208:211]
    ds_read_b64 v[170:171], v247 offset:24704
    ds_read_b64 v[172:173], v247 offset:24832
    v_mfma_f32_16x16x32_bf16 v[228:231], a[244:247], a[92:95], v[228:231]
    v_mfma_f32_16x16x32_bf16 v[232:235], a[224:227], a[96:99], 0
    v_mfma_f32_16x16x32_bf16 v[232:235], a[228:231], a[100:103], v[232:235]
    v_mfma_f32_16x16x32_bf16 v[232:235], a[232:235], a[104:107], v[232:235]
    v_mfma_f32_16x16x32_bf16 v[232:235], a[236:239], a[108:111], v[232:235]
    v_mfma_f32_16x16x32_bf16 v[232:235], a[240:243], a[112:115], v[232:235]
    v_exp_f32 v208, v208
    v_mfma_f32_16x16x32_bf16 v[232:235], a[244:247], a[116:119], v[232:235]
    s_waitcnt lgkmcnt(5)
    v_exp_f32 v209, v209
    v_mfma_f32_16x16x32_bf16 v[196:199], v[132:135], v[174:177], v[196:199]
    s_waitcnt lgkmcnt(4)
    v_cvt_pk_bf16_f32 v24, v228, v229
    v_mbcnt_lo_u32_b32 v228, -1, 0
    v_mfma_f32_16x16x32_bf16 v[196:199], v[134:137], v[176:179], v[196:199]
    v_cvt_pk_bf16_f32 v27, v230, v231
    v_cvt_pk_bf16_f32 v54, v232, v233
    v_mfma_f32_16x16x32_bf16 v[200:203], v[102:105], v[174:177], v[200:203]
    v_cvt_pk_bf16_f32 v57, v234, v235
    v_cvt_pk_bf16_f32 v188, v208, v209
    v_mfma_f32_16x16x32_bf16 v[200:203], v[104:107], v[176:179], v[200:203]
    ds_read_b128 v[208:211], v244 offset:96
    v_mbcnt_hi_u32_b32 v228, -1, v228
    v_mfma_f32_16x16x32_bf16 v[212:215], v[24:27], v[188:191], v[212:215]
    s_waitcnt lgkmcnt(4)
    v_lshrrev_b32 v229, 1, v228
    v_add_u32 v229, 64, v229
    v_mfma_f32_16x16x32_bf16 v[216:219], v[54:57], v[188:191], v[216:219]
    v_mul_u32_u24 v230, 43, v229
    v_lshrrev_b32 v231, 8, v230
    v_mfma_f32_16x16x32_bf16 v[224:227], a[248:251], v[188:191], v[224:227]
    v_lshrrev_b32 v230, 7, v230
    v_mad_i32_i24 v229, v230, -3, v229
    v_mfma_f32_16x16x32_bf16 v[204:207], v[114:117], v[174:177], v[204:207]
L_h6:
    s_cbranch_execz L_hback
    v_and_b32 v231, 4, v231
    v_xor_b32 v230, v230, v231
    v_mfma_f32_16x16x32_bf16 v[204:207], v[116:119], v[176:179], v[204:207]
    v_and_b32 v231, 4, v230
    v_mul_u32_u24 v251, 24, v231
    v_mfma_f32_16x16x32_bf16 v[236:239], a[224:227], a[120:123], 0
    ds_read_b128 a[224:227], v242 offset:3200
    v_lshrrev_b32 v231, 3, v230
    v_mfma_f32_16x16x32_bf16 v[236:239], a[228:231], a[124:127], v[236:239]
    ds_read_b128 a[228:231], v243 offset:3200
    v_lshl_add_u32 v251, v231, 2, v251
    v_mfma_f32_16x16x32_bf16 v[236:239], a[232:235], a[128:131], v[236:239]
    ds_read_b128 a[232:235], v242 offset:3328
    v_and_or_b32 v251, v230, 3, v251
    v_mfma_f32_16x16x32_bf16 v[236:239], a[236:239], a[132:135], v[236:239]
    ds_read_b128 a[236:239], v243 offset:3328
    v_mad_u32_u24 v251, v251, 3, v229
    v_mfma_f32_16x16x32_bf16 v[236:239], a[240:243], a[136:139], v[236:239]
    ds_read_b128 a[240:243], v240 offset:0
    v_and_b32 v231, 1, v228
    v_mfma_f32_16x16x32_bf16 v[236:239], a[244:247], a[140:143], v[236:239]
    ds_read_b128 a[244:247], v241 offset:0
    v_lshl_add_u32 v251, v251, 3, v231
    v_mfma_f32_16x16x32_bf16 v[232:235], a[144:147], a[216:219], 0
    v_lshlrev_b32 v251, 4, v251
    v_add_u32 v251, 0xfffff800, v251
    v_mfma_f32_16x16x32_bf16 v[232:235], a[148:151], a[220:223], v[232:235]
    v_exp_f32 v196, v196
    v_mfma_f32_16x16x32_bf16 v[228:231], a[192:195], a[216:219], 0
    s_waitcnt lgkmcnt(6)
    s_waitcnt lgkmcnt(5)
    v_cvt_pk_bf16_f32 v84, v236, v237
    v_mfma_f32_16x16x32_bf16 v[208:211], v[144:147], v[174:177], v[208:211]
    v_cvt_pk_bf16_f32 v87, v238, v239
    v_mfma_f32_16x16x32_bf16 v[208:211], v[146:149], v[176:179], v[208:211]
    v_exp_f32 v197, v197
    v_mfma_f32_16x16x32_bf16 v[220:223], v[84:87], v[188:191], v[220:223]
    v_exp_f32 v198, v198
    v_mfma_f32_16x16x32_bf16 v[232:235], a[152:155], a[224:227], v[232:235]
    s_waitcnt lgkmcnt(2)
    s_barrier
    v_cvt_pk_bf16_f32 v193, v196, v197
    v_mfma_f32_16x16x32_bf16 v[232:235], a[156:159], a[228:231], v[232:235]
    buffer_load_dwordx4 v252, s[12:15], s62 offen lds
    v_mfma_f32_16x16x32_bf16 v[232:235], a[160:163], a[232:235], v[232:235]
    v_exp_f32 v199, v199
    v_mfma_f32_16x16x32_bf16 v[232:235], a[164:167], a[236:239], v[232:235]
    v_exp_f32 v200, v200
    v_mfma_f32_16x16x32_bf16 v[236:239], a[168:171], a[216:219], 0
    ds_read_b128 a[216:219], v240 offset:128
    v_cvt_pk_bf16_f32 v180, v198, v199
    v_mfma_f32_16x16x32_bf16 v[236:239], a[172:175], a[220:223], v[236:239]
    buffer_load_dwordx4 v253, s[12:15], s62 offen offset:1024 lds
    ds_read_b128 v[196:199], v245 offset:96
    v_mfma_f32_16x16x32_bf16 v[236:239], a[176:179], a[224:227], v[236:239]
    v_mul_f32 v232, s38, v232
    v_mul_f32 v233, s38, v233
    v_mfma_f32_16x16x32_bf16 v[236:239], a[180:183], a[228:231], v[236:239]
    v_mul_f32 v234, s38, v234
    v_mul_f32 v235, s38, v235
    v_mfma_f32_16x16x32_bf16 v[236:239], a[184:187], a[232:235], v[236:239]
    v_cvt_pk_bf16_f32 v232, v232, v233
    v_cvt_pk_bf16_f32 v233, v234, v235
    v_mfma_f32_16x16x32_bf16 v[236:239], a[188:191], a[236:239], v[236:239]
    buffer_load_dwordx4 v251, s[12:15], s62 offen offset:2048 lds
    s_add_u32 m0, s46, 0x17400
    v_mfma_f32_16x16x32_bf16 v[228:231], a[196:199], a[220:223], v[228:231]
    ds_read_b128 a[220:223], v241 offset:128
    s_lshl_b32 s62, s28, 5
    v_mfma_f32_16x16x32_bf16 v[228:231], a[200:203], a[224:227], v[228:231]
    ds_write_b64 v247, v[232:233] offset:55296
    v_mfma_f32_16x16x32_bf16 v[228:231], a[204:207], a[228:231], v[228:231]
    s_waitcnt lgkmcnt(4)
    ds_read_b128 a[224:227], v240 offset:256
    v_mfma_f32_16x16x32_bf16 v[228:231], a[208:211], a[232:235], v[228:231]
    buffer_load_dwordx4 v252, s[12:15], s63 offen lds
    v_mul_f32 v236, s3, v236
    v_mfma_f32_16x16x32_bf16 v[228:231], a[212:215], a[236:239], v[228:231]
    s_add_u32 s62, s62, 0x3000
    v_mul_f32 v237, s3, v237
    v_mul_f32 v238, s3, v238
    v_mfma_f32_16x16x32_bf16 v[232:235], a[0:3], a[240:243], 0
    v_mul_f32 v239, s3, v239
    v_cvt_pk_bf16_f32 v236, v236, v237
    v_mfma_f32_16x16x32_bf16 v[232:235], a[4:7], a[244:247], v[232:235]
    s_waitcnt lgkmcnt(3)
    v_cvt_pk_bf16_f32 v237, v238, v239
    v_mul_f32 v228, s38, v228
    v_mfma_f32_16x16x32_bf16 v[196:199], v[108:111], v[174:177], v[196:199]
    buffer_load_dwordx4 v253, s[12:15], s63 offen offset:1024 lds
    ds_read_b128 a[228:231], v241 offset:256
    v_mfma_f32_16x16x32_bf16 v[196:199], v[110:113], v[176:179], v[196:199]
    ds_write_b64 v247, v[236:237] offset:55424
    v_mfma_f32_16x16x32_bf16 v[232:235], a[8:11], a[216:219], v[232:235]
    s_waitcnt lgkmcnt(4)
    v_mul_f32 v229, s38, v229
    v_mul_f32 v230, s38, v230
    v_mfma_f32_16x16x32_bf16 v[232:235], a[12:15], a[220:223], v[232:235]
    v_mul_f32 v231, s38, v231
    v_cvt_pk_bf16_f32 v228, v228, v229
    v_mfma_f32_16x16x32_bf16 v[236:239], a[24:27], a[240:243], 0
    buffer_load_dwordx4 v251, s[12:15], s63 offen offset:2048 lds
    v_cvt_pk_bf16_f32 v229, v230, v231
    v_mfma_f32_16x16x32_bf16 v[236:239], a[28:31], a[244:247], v[236:239]
    ds_write_b64 v247, v[228:229] offset:55552
    v_mfma_f32_16x16x32_bf16 v[236:239], a[32:35], a[216:219], v[236:239]
    s_waitcnt lgkmcnt(3)
    v_exp_f32 v201, v201
    v_mfma_f32_16x16x32_bf16 v[232:235], a[16:19], a[224:227], v[232:235]
    s_add_u32 m0, s46, 0x16800
    v_exp_f32 v202, v202
    v_mfma_f32_16x16x32_bf16 v[236:239], a[36:39], a[220:223], v[236:239]
    s_waitcnt lgkmcnt(2)
    v_exp_f32 v203, v203
    v_mfma_f32_16x16x32_bf16 v[232:235], a[20:23], a[228:231], v[232:235]
    s_lshl_b32 s63, s28, 5
    v_cvt_pk_bf16_f32 v194, v200, v201
    v_cvt_pk_bf16_f32 v181, v202, v203
    v_mfma_f32_16x16x32_bf16 v[236:239], a[40:43], a[224:227], v[236:239]
    ds_read_b128 v[200:203], v246 offset:96
    ds_read_b128 a[232:235], v240 offset:1536
    v_mfma_f32_16x16x32_bf16 v[236:239], a[44:47], a[228:231], v[236:239]
    ds_read_b128 a[236:239], v241 offset:1536
    v_cvt_pk_bf16_f32 v126, v232, v233
    v_mfma_f32_16x16x32_bf16 v[228:231], a[48:51], a[240:243], 0
    s_add_u32 s63, s63, 0x7800
    v_rcp_f32 v225, v224
    v_mfma_f32_16x16x32_bf16 v[228:231], a[52:55], a[244:247], v[228:231]
    v_cvt_pk_bf16_f32 v127, v234, v235
    v_mul_f32 v212, v212, v225
    v_mfma_f32_16x16x32_bf16 v[228:231], a[56:59], a[216:219], v[228:231]
    v_cvt_pk_bf16_f32 v128, v236, v237
    v_cvt_pk_bf16_f32 v129, v238, v239
    v_mfma_f32_16x16x32_bf16 v[228:231], a[60:63], a[220:223], v[228:231]
    v_exp_f32 v204, v204
    v_mfma_f32_16x16x32_bf16 v[228:231], a[64:67], a[224:227], v[228:231]
    v_exp_f32 v205, v205
    v_mfma_f32_16x16x32_bf16 v[228:231], a[68:71], a[228:231], v[228:231]
    v_exp_f32 v206, v206
    v_mfma_f32_16x16x32_bf16 v[232:235], a[240:243], a[72:75], 0
    v_exp_f32 v207, v207
    v_mfma_f32_16x16x32_bf16 v[232:235], a[244:247], a[76:79], v[232:235]
    v_mul_f32 v213, v213, v225
    v_cvt_pk_bf16_f32 v192, v204, v205
    v_mfma_f32_16x16x32_bf16 v[232:235], a[216:219], a[80:83], v[232:235]
    v_cvt_pk_bf16_f32 v195, v206, v207
    v_cvt_pk_bf16_f32 v130, v228, v229
    v_mfma_f32_16x16x32_bf16 v[232:235], a[220:223], a[84:87], v[232:235]
    v_cvt_pk_bf16_f32 v131, v230, v231
    v_mul_f32 v214, v214, v225
    v_mfma_f32_16x16x32_bf16 v[232:235], a[224:227], a[88:91], v[232:235]
    v_mul_f32 v215, v215, v225
    v_cvt_pk_bf16_f32 v212, v212, v213
    v_mfma_f32_16x16x32_bf16 v[232:235], a[228:231], a[92:95], v[232:235]
    v_cvt_pk_bf16_f32 v213, v214, v215
    v_mul_f32 v216, v216, v225
    v_mfma_f32_16x16x32_bf16 v[236:239], a[240:243], a[96:99], 0
    s_waitcnt lgkmcnt(2)
    v_mul_f32 v217, v217, v225
    v_mul_f32 v218, v218, v225
    v_mfma_f32_16x16x32_bf16 v[200:203], v[120:123], v[174:177], v[200:203]
    ds_write_b64 v247, v[212:213] offset:18432
    v_mfma_f32_16x16x32_bf16 v[212:215], v[18:21], v[192:195], 0
    v_cvt_pk_bf16_f32 v1, v232, v233
    v_cvt_pk_bf16_f32 v4, v234, v235
    v_mfma_f32_16x16x32_bf16 v[200:203], v[122:125], v[176:179], v[200:203]
    s_waitcnt lgkmcnt(1)
    v_mul_f32 v219, v219, v225
    v_cvt_pk_bf16_f32 v216, v216, v217
    v_mfma_f32_16x16x32_bf16 v[236:239], a[244:247], a[100:103], v[236:239]
    v_cvt_pk_bf16_f32 v217, v218, v219
    v_mul_f32 v220, v220, v225
    v_mfma_f32_16x16x32_bf16 v[236:239], a[216:219], a[104:107], v[236:239]
    ds_write_b64 v247, v[216:217] offset:18560
    v_mfma_f32_16x16x32_bf16 v[216:219], v[48:51], v[192:195], 0
    v_mul_f32 v221, v221, v225
    v_mul_f32 v222, v222, v225
    v_mfma_f32_16x16x32_bf16 v[236:239], a[220:223], a[108:111], v[236:239]
    v_mul_f32 v223, v223, v225
    v_cvt_pk_bf16_f32 v220, v220, v221
    v_mfma_f32_16x16x32_bf16 v[236:239], a[224:227], a[112:115], v[236:239]
    ds_read_b128 v[204:207], v244 offset:192
    v_cvt_pk_bf16_f32 v221, v222, v223
    v_mfma_f32_16x16x32_bf16 v[236:239], a[228:231], a[116:119], v[236:239]
    ds_write_b64 v247, v[220:221] offset:18688
    v_mfma_f32_16x16x32_bf16 v[220:223], v[78:81], v[192:195], 0
    ds_read_b64 v[174:175], v247 offset:30720
    v_max3_f32 v248, v248, v224, v225
    v_mfma_f32_16x16x32_bf16 v[224:227], a[248:251], v[192:195], 0
    v_exp_f32 v208, v208
    v_mfma_f32_16x16x32_bf16 v[228:231], a[240:243], a[120:123], 0
    ds_read_b128 a[240:243], v240 offset:1664
    v_cvt_pk_bf16_f32 v31, v236, v237
    v_mfma_f32_16x16x32_bf16 v[228:231], a[244:247], a[124:127], v[228:231]
    ds_read_b128 a[244:247], v241 offset:1664
    v_cvt_pk_bf16_f32 v34, v238, v239
    v_mfma_f32_16x16x32_bf16 v[228:231], a[216:219], a[128:131], v[228:231]
    ds_read_b128 a[216:219], v240 offset:1792
    ds_read_b64 v[176:177], v247 offset:30848
    v_mfma_f32_16x16x32_bf16 v[228:231], a[220:223], a[132:135], v[228:231]
    ds_read_b128 a[220:223], v241 offset:1792
    ds_read_b64 v[178:179], v247 offset:30976
    v_mfma_f32_16x16x32_bf16 v[228:231], a[224:227], a[136:139], v[228:231]
    v_exp_f32 v209, v209
    v_mfma_f32_16x16x32_bf16 v[228:231], a[228:231], a[140:143], v[228:231]
    s_waitcnt vmcnt(3)
    ds_read_b64_tr_b16 a[144:145], v249 offset:0
    v_mfma_f32_16x16x32_bf16 v[232:235], a[0:3], a[232:235], 0
    ds_read_b64_tr_b16 a[146:147], v250 offset:0
    ds_read_b64_tr_b16 a[168:169], v249 offset:32
    v_mfma_f32_16x16x32_bf16 v[232:235], a[4:7], a[236:239], v[232:235]
    ds_read_b64_tr_b16 a[170:171], v250 offset:32
    ds_read_b64_tr_b16 a[192:193], v249 offset:64
    v_mfma_f32_16x16x32_bf16 v[236:239], a[24:27], a[232:235], 0
    ds_read_b64_tr_b16 a[194:195], v250 offset:64
    s_waitcnt lgkmcnt(11)
    v_mfma_f32_16x16x32_bf16 v[204:207], v[150:153], v[168:171], v[204:207]
    v_cvt_pk_bf16_f32 v61, v228, v229
    v_cvt_pk_bf16_f32 v64, v230, v231
    v_mfma_f32_16x16x32_bf16 v[204:207], v[152:155], v[170:173], v[204:207]
    v_exp_f32 v210, v210
    v_mfma_f32_16x16x32_bf16 v[232:235], a[8:11], a[240:243], v[232:235]
    s_waitcnt lgkmcnt(10)
    v_exp_f32 v211, v211
    v_mfma_f32_16x16x32_bf16 v[232:235], a[12:15], a[244:247], v[232:235]
    s_waitcnt lgkmcnt(9)
    v_cvt_pk_bf16_f32 v183, v208, v209
    v_cvt_pk_bf16_f32 v186, v210, v211
    v_mfma_f32_16x16x32_bf16 v[232:235], a[16:19], a[216:219], v[232:235]
    s_waitcnt lgkmcnt(7)
    v_exp_f32 v200, v200
    v_mfma_f32_16x16x32_bf16 v[232:235], a[20:23], a[220:223], v[232:235]
    ds_read_b128 v[208:211], v245 offset:192
    ds_read_b128 a[224:227], v240 offset:3072
    v_mfma_f32_16x16x32_bf16 v[236:239], a[28:31], a[236:239], v[236:239]
    v_exp_f32 v201, v201
    v_mfma_f32_16x16x32_bf16 v[236:239], a[32:35], a[240:243], v[236:239]
    ds_read_b128 a[228:231], v241 offset:3072
    s_waitcnt lgkmcnt(3)
    v_mfma_f32_16x16x32_bf16 v[236:239], a[36:39], a[244:247], v[236:239]
    buffer_load_dwordx4 v252, s[12:15], s60 offen lds
    v_cvt_pk_bf16_f32 v132, v232, v233
    v_mfma_f32_16x16x32_bf16 v[236:239], a[40:43], a[216:219], v[236:239]
    s_waitcnt vmcnt(1)
    ds_read_b64_tr_b16 a[148:149], v249 offset:3072
    v_mfma_f32_16x16x32_bf16 v[236:239], a[44:47], a[220:223], v[236:239]
    ds_read_b64_tr_b16 a[150:151], v250 offset:3072
    ds_read_b64_tr_b16 a[172:173], v249 offset:3104
    v_mfma_f32_16x16x32_bf16 v[228:231], a[48:51], a[232:235], 0
    ds_read_b64_tr_b16 a[174:175], v250 offset:3104
    ds_read_b64_tr_b16 a[196:197], v249 offset:3136
    v_mfma_f32_16x16x32_bf16 v[228:231], a[52:55], a[236:239], v[228:231]
    ds_read_b64_tr_b16 a[198:199], v250 offset:3136
    buffer_load_dwordx4 v253, s[12:15], s60 offen offset:1024 lds
    v_mfma_f32_16x16x32_bf16 v[228:231], a[56:59], a[240:243], v[228:231]
    v_cvt_pk_bf16_f32 v133, v234, v235
    v_cvt_pk_bf16_f32 v182, v200, v201
    v_mfma_f32_16x16x32_bf16 v[228:231], a[60:63], a[244:247], v[228:231]
    v_exp_f32 v196, v196
    v_mfma_f32_16x16x32_bf16 v[212:215], v[22:25], v[180:183], v[212:215]
    v_exp_f32 v197, v197
    v_mfma_f32_16x16x32_bf16 v[216:219], v[52:55], v[180:183], v[216:219]
    buffer_load_dwordx4 v251, s[12:15], s60 offen offset:2048 lds
    s_add_u32 m0, s46, 0x17400
    v_mfma_f32_16x16x32_bf16 v[220:223], v[82:85], v[180:183], v[220:223]
    v_exp_f32 v198, v198
    v_mfma_f32_16x16x32_bf16 v[224:227], a[248:251], v[180:183], v[224:227]
    s_waitcnt lgkmcnt(8)
    v_exp_f32 v199, v199
    v_mfma_f32_16x16x32_bf16 v[208:211], v[90:93], v[168:171], v[208:211]
    v_cvt_pk_bf16_f32 v184, v196, v197
    v_cvt_pk_bf16_f32 v187, v198, v199
    v_mfma_f32_16x16x32_bf16 v[208:211], v[92:95], v[170:173], v[208:211]
    ds_read_b128 v[196:199], v246 offset:192
    s_waitcnt lgkmcnt(1)
    v_mfma_f32_16x16x32_bf16 v[228:231], a[64:67], a[216:219], v[228:231]
    buffer_load_dwordx4 v252, s[12:15], s61 offen lds
    v_cvt_pk_bf16_f32 v134, v236, v237
    v_mfma_f32_16x16x32_bf16 v[228:231], a[68:71], a[220:223], v[228:231]
    v_exp_f32 v202, v202
    v_mfma_f32_16x16x32_bf16 v[232:235], a[232:235], a[72:75], 0
    v_exp_f32 v203, v203
    v_mfma_f32_16x16x32_bf16 v[232:235], a[236:239], a[76:79], v[232:235]
    v_cvt_pk_bf16_f32 v185, v202, v203
    v_cvt_pk_bf16_f32 v135, v238, v239
    v_mfma_f32_16x16x32_bf16 v[232:235], a[240:243], a[80:83], v[232:235]
    buffer_load_dwordx4 v253, s[12:15], s61 offen offset:1024 lds
    ds_read_b128 v[200:203], v244 offset:256
    v_mfma_f32_16x16x32_bf16 v[212:215], v[26:29], v[184:187], v[212:215]
    v_exp_f32 v204, v204
    v_mfma_f32_16x16x32_bf16 v[216:219], v[56:59], v[184:187], v[216:219]
    v_exp_f32 v205, v205
    v_mfma_f32_16x16x32_bf16 v[220:223], v[86:89], v[184:187], v[220:223]
    v_exp_f32 v206, v206
    v_mfma_f32_16x16x32_bf16 v[224:227], a[248:251], v[184:187], v[224:227]
    buffer_load_dwordx4 v251, s[12:15], s61 offen offset:2048 lds
    s_waitcnt lgkmcnt(1)
    v_mfma_f32_16x16x32_bf16 v[196:199], v[126:129], v[168:171], v[196:199]
    s_add_u32 m0, s46, 0x16800
    v_exp_f32 v207, v207
    v_mfma_f32_16x16x32_bf16 v[196:199], v[128:131], v[170:173], v[196:199]
    v_cvt_pk_bf16_f32 v190, v204, v205
    v_cvt_pk_bf16_f32 v193, v206, v207
    v_mfma_f32_16x16x32_bf16 v[232:235], a[244:247], a[84:87], v[232:235]
    ds_read_b128 v[204:207], v245 offset:256
    v_cvt_pk_bf16_f32 v136, v228, v229
    v_mfma_f32_16x16x32_bf16 v[232:235], a[216:219], a[88:91], v[232:235]
    v_cvt_pk_bf16_f32 v137, v230, v231
    v_mov_b32 v226, 0x22e00
    v_mfma_f32_16x16x32_bf16 v[232:235], a[220:223], a[92:95], v[232:235]
    s_waitcnt lgkmcnt(1)
    v_exp_f32 v208, v208
    v_mfma_f32_16x16x32_bf16 v[200:203], v[156:159], v[168:171], v[200:203]
    v_exp_f32 v209, v209
    v_mfma_f32_16x16x32_bf16 v[200:203], v[158:161], v[170:173], v[200:203]
    v_exp_f32 v210, v210
    v_mfma_f32_16x16x32_bf16 v[236:239], a[232:235], a[96:99], 0
    v_exp_f32 v211, v211
    v_mfma_f32_16x16x32_bf16 v[236:239], a[236:239], a[100:103], v[236:239]
    v_cvt_pk_bf16_f32 v7, v232, v233
    v_cvt_pk_bf16_f32 v10, v234, v235
    v_mfma_f32_16x16x32_bf16 v[236:239], a[240:243], a[104:107], v[236:239]
    v_cvt_pk_bf16_f32 v188, v208, v209
    v_cvt_pk_bf16_f32 v191, v210, v211
    v_mfma_f32_16x16x32_bf16 v[236:239], a[244:247], a[108:111], v[236:239]
    v_rcp_f32 v225, v224
    v_mfma_f32_16x16x32_bf16 v[236:239], a[216:219], a[112:115], v[236:239]
    s_waitcnt lgkmcnt(0)
    v_exp_f32 v196, v196
    v_mfma_f32_16x16x32_bf16 v[204:207], v[96:99], v[168:171], v[204:207]
    v_exp_f32 v197, v197
    v_mfma_f32_16x16x32_bf16 v[204:207], v[98:101], v[170:173], v[204:207]
    ds_read_b128 v[208:211], v246 offset:256
    v_mul_f32 v212, v212, v225
    v_mfma_f32_16x16x32_bf16 v[236:239], a[220:223], a[116:119], v[236:239]
    v_mul_f32 v213, v213, v225
    v_cvt_pk_bf16_f32 v189, v196, v197
    v_mfma_f32_16x16x32_bf16 v[228:231], a[232:235], a[120:123], 0
    ds_read_b128 a[232:235], v240 offset:3200
    v_mul_f32 v214, v214, v225
    v_mfma_f32_16x16x32_bf16 v[228:231], a[236:239], a[124:127], v[228:231]
    ds_read_b128 a[236:239], v241 offset:3200
    v_mul_f32 v215, v215, v225
    v_mfma_f32_16x16x32_bf16 v[228:231], a[240:243], a[128:131], v[228:231]
    ds_read_b128 a[240:243], v240 offset:3328
    v_cvt_pk_bf16_f32 v37, v236, v237
    v_mfma_f32_16x16x32_bf16 v[228:231], a[244:247], a[132:135], v[228:231]
    ds_read_b128 a[244:247], v241 offset:3328
    v_cvt_pk_bf16_f32 v40, v238, v239
    v_mfma_f32_16x16x32_bf16 v[228:231], a[216:219], a[136:139], v[228:231]
    v_cvt_pk_bf16_f32 v212, v212, v213
    v_cndmask_b32 v226, v226, v247, vcc
    v_mfma_f32_16x16x32_bf16 v[228:231], a[220:223], a[140:143], v[228:231]
    s_mov_b32 vcc_lo, 0xff00fff0
    v_cvt_pk_bf16_f32 v213, v214, v215
    v_mul_f32 v216, v216, v225
    v_mfma_f32_16x16x32_bf16 v[232:235], a[0:3], a[224:227], 0
    ds_write_b64 v226, v[212:213] offset:0
    v_mfma_f32_16x16x32_bf16 v[212:215], v[0:3], v[188:191], 0
    s_mov_b32 vcc_hi, 0xf000
    v_mul_f32 v217, v217, v225
    v_cvt_pk_bf16_f32 v67, v228, v229
    v_mfma_f32_16x16x32_bf16 v[232:235], a[4:7], a[228:231], v[232:235]
    s_waitcnt lgkmcnt(4)
    v_cvt_pk_bf16_f32 v70, v230, v231
    v_mul_f32 v218, v218, v225
    v_mfma_f32_16x16x32_bf16 v[208:211], v[132:135], v[168:171], v[208:211]
    v_mul_f32 v219, v219, v225
    v_cvt_pk_bf16_f32 v216, v216, v217
    v_mfma_f32_16x16x32_bf16 v[208:211], v[134:137], v[170:173], v[208:211]
    v_cvt_pk_bf16_f32 v217, v218, v219
    v_mul_f32 v220, v220, v225
    v_mfma_f32_16x16x32_bf16 v[232:235], a[8:11], a[232:235], v[232:235]
    s_waitcnt lgkmcnt(3)
    v_mul_f32 v221, v221, v225
    v_mul_f32 v222, v222, v225
    v_mfma_f32_16x16x32_bf16 v[232:235], a[12:15], a[236:239], v[232:235]
    s_waitcnt lgkmcnt(2)
    v_mul_f32 v223, v223, v225
    v_cvt_pk_bf16_f32 v220, v220, v221
    v_mfma_f32_16x16x32_bf16 v[232:235], a[16:19], a[240:243], v[232:235]
    s_waitcnt lgkmcnt(1)
    v_cvt_pk_bf16_f32 v221, v222, v223
    v_max3_f32 v248, v248, v224, v225
    v_mfma_f32_16x16x32_bf16 v[232:235], a[20:23], a[244:247], v[232:235]
    ds_write_b64 v226, v[216:217] offset:128
    v_mfma_f32_16x16x32_bf16 v[216:219], v[30:33], v[188:191], 0
    ds_write_b64 v226, v[220:221] offset:256
    v_mfma_f32_16x16x32_bf16 v[220:223], v[60:63], v[188:191], 0
    v_exp_f32 v198, v198
    v_mfma_f32_16x16x32_bf16 v[224:227], a[248:251], v[188:191], 0
    v_exp_f32 v199, v199
    v_mfma_f32_16x16x32_bf16 v[236:239], a[24:27], a[224:227], 0
    v_cvt_pk_bf16_f32 v144, v232, v233
    v_cvt_pk_bf16_f32 v145, v234, v235
    v_mfma_f32_16x16x32_bf16 v[236:239], a[28:31], a[228:231], v[236:239]
    ds_read_b128 a[216:219], v240 offset:4608
    v_cvt_pk_bf16_f32 v192, v198, v199
    v_mfma_f32_16x16x32_bf16 v[236:239], a[32:35], a[232:235], v[236:239]
    ds_read_b128 v[196:199], v244 offset:320
    v_mov_b32 v187, 0
    v_mfma_f32_16x16x32_bf16 v[236:239], a[36:39], a[236:239], v[236:239]
    s_waitcnt vmcnt(3)
    ds_read_b64_tr_b16 a[152:153], v249 offset:0
    v_mfma_f32_16x16x32_bf16 v[236:239], a[40:43], a[240:243], v[236:239]
    ds_read_b64_tr_b16 a[154:155], v250 offset:0
    ds_read_b64_tr_b16 a[176:177], v249 offset:32
    v_mfma_f32_16x16x32_bf16 v[236:239], a[44:47], a[244:247], v[236:239]
    ds_read_b64_tr_b16 a[178:179], v250 offset:32
    ds_read_b64_tr_b16 a[200:201], v249 offset:64
    v_mfma_f32_16x16x32_bf16 v[228:231], a[48:51], a[224:227], 0
    ds_read_b64_tr_b16 a[202:203], v250 offset:64
    ds_read_b128 a[220:223], v241 offset:4608
    v_mfma_f32_16x16x32_bf16 v[228:231], a[52:55], a[228:231], v[228:231]
    v_exp_f32 v200, v200
    v_mfma_f32_16x16x32_bf16 v[228:231], a[56:59], a[232:235], v[228:231]
    v_cvt_pk_bf16_f32 v146, v236, v237
    v_cvt_pk_bf16_f32 v147, v238, v239
    v_mfma_f32_16x16x32_bf16 v[228:231], a[60:63], a[236:239], v[228:231]
    v_exp_f32 v201, v201
    v_mfma_f32_16x16x32_bf16 v[228:231], a[64:67], a[240:243], v[228:231]
    v_exp_f32 v202, v202
    v_mfma_f32_16x16x32_bf16 v[228:231], a[68:71], a[244:247], v[228:231]
    v_exp_f32 v203, v203
    v_mfma_f32_16x16x32_bf16 v[232:235], a[224:227], a[72:75], 0
    v_cvt_pk_bf16_f32 v180, v200, v201
    v_cvt_pk_bf16_f32 v183, v202, v203
    v_mfma_f32_16x16x32_bf16 v[232:235], a[228:231], a[76:79], v[232:235]
    ds_read_b128 v[200:203], v245 offset:320
    v_mfma_f32_16x16x32_bf16 v[232:235], a[232:235], a[80:83], v[232:235]
    v_exp_f32 v204, v204
    v_mfma_f32_16x16x32_bf16 v[232:235], a[236:239], a[84:87], v[232:235]
    s_waitcnt lgkmcnt(2)
    buffer_load_dwordx4 v252, s[12:15], s62 offen lds
    v_mfma_f32_16x16x32_bf16 v[196:199], v[162:165], v[168:171], v[196:199]
    s_waitcnt vmcnt(1)
    ds_read_b64_tr_b16 a[156:157], v249 offset:3072
    v_mfma_f32_16x16x32_bf16 v[196:199], v[164:167], v[170:173], v[196:199]
    ds_read_b64_tr_b16 a[158:159], v250 offset:3072
    ds_read_b64_tr_b16 a[180:181], v249 offset:3104
    v_mfma_f32_16x16x32_bf16 v[232:235], a[240:243], a[88:91], v[232:235]
    ds_read_b64_tr_b16 a[182:183], v250 offset:3104
    ds_read_b64_tr_b16 a[204:205], v249 offset:3136
    v_mfma_f32_16x16x32_bf16 v[232:235], a[244:247], a[92:95], v[232:235]
    ds_read_b64_tr_b16 a[206:207], v250 offset:3136
    buffer_load_dwordx4 v253, s[12:15], s62 offen offset:1024 lds
    v_mfma_f32_16x16x32_bf16 v[236:239], a[224:227], a[96:99], 0
    v_cvt_pk_bf16_f32 v148, v228, v229
    v_cvt_pk_bf16_f32 v149, v230, v231
    v_mfma_f32_16x16x32_bf16 v[236:239], a[228:231], a[100:103], v[236:239]
    v_exp_f32 v205, v205
    v_mfma_f32_16x16x32_bf16 v[236:239], a[232:235], a[104:107], v[236:239]
    v_cvt_pk_bf16_f32 v13, v232, v233
    v_cvt_pk_bf16_f32 v16, v234, v235
    v_mfma_f32_16x16x32_bf16 v[236:239], a[236:239], a[108:111], v[236:239]
    buffer_load_dwordx4 v251, s[12:15], s62 offen offset:2048 lds
    s_add_u32 m0, s46, 0x17400
    v_mfma_f32_16x16x32_bf16 v[236:239], a[240:243], a[112:115], v[236:239]
    v_exp_f32 v208, v208
    v_mfma_f32_16x16x32_bf16 v[236:239], a[244:247], a[116:119], v[236:239]
    v_exp_f32 v209, v209
    v_mfma_f32_16x16x32_bf16 v[228:231], a[224:227], a[120:123], 0
    s_waitcnt lgkmcnt(6)
    ds_read_b128 a[224:227], v240 offset:4736
    v_mfma_f32_16x16x32_bf16 v[200:203], v[138:141], v[168:171], v[200:203]
    v_cvt_pk_bf16_f32 v194, v204, v205
    s_waitcnt lgkmcnt(1)
    v_mfma_f32_16x16x32_bf16 v[200:203], v[140:143], v[170:173], v[200:203]
    buffer_load_dwordx4 v252, s[12:15], s63 offen lds
    v_cvt_pk_bf16_f32 v195, v208, v209
    v_mfma_f32_16x16x32_bf16 v[228:231], a[228:231], a[124:127], v[228:231]
    ds_read_b128 a[228:231], v241 offset:4736
    v_cvt_pk_bf16_f32 v43, v236, v237
    v_mfma_f32_16x16x32_bf16 v[212:215], v[4:7], v[192:195], v[212:215]
    v_exp_f32 v206, v206
    v_mfma_f32_16x16x32_bf16 v[216:219], v[34:37], v[192:195], v[216:219]
    v_exp_f32 v207, v207
    v_mfma_f32_16x16x32_bf16 v[220:223], v[64:67], v[192:195], v[220:223]
    buffer_load_dwordx4 v253, s[12:15], s63 offen offset:1024 lds
    v_cvt_pk_bf16_f32 v181, v206, v207
    v_mfma_f32_16x16x32_bf16 v[224:227], a[248:251], v[192:195], v[224:227]
    ds_read_b128 v[204:207], v246 offset:320
    v_cvt_pk_bf16_f32 v46, v238, v239
    v_mfma_f32_16x16x32_bf16 v[228:231], a[232:235], a[128:131], v[228:231]
    ds_read_b128 a[232:235], v240 offset:4864
    v_mfma_f32_16x16x32_bf16 v[228:231], a[236:239], a[132:135], v[228:231]
    ds_read_b128 a[236:239], v241 offset:4864
    v_mfma_f32_16x16x32_bf16 v[228:231], a[240:243], a[136:139], v[228:231]
    buffer_load_dwordx4 v251, s[12:15], s63 offen offset:2048 lds
    v_mfma_f32_16x16x32_bf16 v[228:231], a[244:247], a[140:143], v[228:231]
    v_exp_f32 v210, v210
    v_mfma_f32_16x16x32_bf16 v[232:235], a[0:3], a[216:219], 0
    v_exp_f32 v211, v211
    v_mfma_f32_16x16x32_bf16 v[232:235], a[4:7], a[220:223], v[232:235]
    s_waitcnt lgkmcnt(4)
    v_exp_f32 v196, v196
    v_mfma_f32_16x16x32_bf16 v[232:235], a[8:11], a[224:227], v[232:235]
    s_waitcnt lgkmcnt(3)
    v_cvt_pk_bf16_f32 v182, v210, v211
    v_cvt_pk_bf16_f32 v73, v228, v229
    v_mfma_f32_16x16x32_bf16 v[232:235], a[12:15], a[228:231], v[232:235]
    ds_read_b128 v[208:211], v244 offset:0
    v_cvt_pk_bf16_f32 v76, v230, v231
    v_mfma_f32_16x16x32_bf16 v[212:215], v[8:11], v[180:183], v[212:215]
    v_exp_f32 v197, v197
    v_mfma_f32_16x16x32_bf16 v[216:219], v[38:41], v[180:183], v[216:219]
    s_waitcnt lgkmcnt(2)
    v_cvt_pk_bf16_f32 v186, v196, v197
    v_mfma_f32_16x16x32_bf16 v[220:223], v[68:71], v[180:183], v[220:223]
    ds_read_b128 v[196:199], v245 offset:0
    v_mfma_f32_16x16x32_bf16 v[224:227], a[248:251], v[180:183], v[224:227]
    v_exp_f32 v200, v200
    v_mfma_f32_16x16x32_bf16 v[204:207], v[144:147], v[168:171], v[204:207]
    v_exp_f32 v201, v201
    v_mfma_f32_16x16x32_bf16 v[204:207], v[146:149], v[170:173], v[204:207]
    ds_read_b64 v[168:169], v247 offset:36864
    v_cvt_pk_bf16_f32 v184, v200, v201
    v_mfma_f32_16x16x32_bf16 v[232:235], a[16:19], a[232:235], v[232:235]
    ds_read_b128 v[200:203], v246 offset:0
    s_waitcnt lgkmcnt(4)
    v_mfma_f32_16x16x32_bf16 v[232:235], a[20:23], a[236:239], v[232:235]
    ds_read_b64 v[170:171], v247 offset:36992
    s_waitcnt lgkmcnt(4)
    v_mfma_f32_16x16x32_bf16 v[208:211], v[156:159], v[174:177], v[208:211]
    v_exp_f32 v204, v204
    v_mfma_f32_16x16x32_bf16 v[208:211], v[158:161], v[176:179], v[208:211]
    v_exp_f32 v205, v205
    v_mfma_f32_16x16x32_bf16 v[236:239], a[24:27], a[216:219], 0
    ds_read_b64 v[172:173], v247 offset:37120
    s_waitcnt lgkmcnt(4)
    v_mfma_f32_16x16x32_bf16 v[196:199], v[96:99], v[174:177], v[196:199]
    v_cvt_pk_bf16_f32 v185, v204, v205
    v_cvt_pk_bf16_f32 v150, v232, v233
    v_mfma_f32_16x16x32_bf16 v[196:199], v[98:101], v[176:179], v[196:199]
    ds_read_b128 v[204:207], v244 offset:64
    v_cvt_pk_bf16_f32 v151, v234, v235
    v_mfma_f32_16x16x32_bf16 v[212:215], v[12:15], v[184:187], v[212:215]
    v_exp_f32 v208, v208
    v_mfma_f32_16x16x32_bf16 v[216:219], v[42:45], v[184:187], v[216:219]
    v_exp_f32 v209, v209
    v_mfma_f32_16x16x32_bf16 v[220:223], v[72:75], v[184:187], v[220:223]
    s_waitcnt lgkmcnt(3)
    v_exp_f32 v210, v210
    v_mfma_f32_16x16x32_bf16 v[224:227], a[248:251], v[184:187], v[224:227]
    v_exp_f32 v211, v211
    v_mfma_f32_16x16x32_bf16 v[200:203], v[132:135], v[174:177], v[200:203]
    v_cvt_pk_bf16_f32 v190, v208, v209
    v_cvt_pk_bf16_f32 v193, v210, v211
    v_mfma_f32_16x16x32_bf16 v[200:203], v[134:137], v[176:179], v[200:203]
    ds_read_b128 v[208:211], v245 offset:64
    v_mfma_f32_16x16x32_bf16 v[236:239], a[28:31], a[220:223], v[236:239]
    v_exp_f32 v196, v196
    v_mfma_f32_16x16x32_bf16 v[236:239], a[32:35], a[224:227], v[236:239]
    v_rcp_f32 v225, v224
    v_mfma_f32_16x16x32_bf16 v[236:239], a[36:39], a[228:231], v[236:239]
    v_mul_f32 v212, v212, v225
    v_mul_f32 v213, v213, v225
    v_mfma_f32_16x16x32_bf16 v[236:239], a[40:43], a[232:235], v[236:239]
    s_waitcnt lgkmcnt(1)
    v_mul_f32 v214, v214, v225
    v_mul_f32 v215, v215, v225
    v_mfma_f32_16x16x32_bf16 v[204:207], v[162:165], v[174:177], v[204:207]
    v_cvt_pk_bf16_f32 v212, v212, v213
    v_cvt_pk_bf16_f32 v213, v214, v215
    v_mfma_f32_16x16x32_bf16 v[204:207], v[164:167], v[176:179], v[204:207]
    ds_write_b64 v247, v[212:213] offset:24576
    v_mfma_f32_16x16x32_bf16 v[236:239], a[44:47], a[236:239], v[236:239]
    v_exp_f32 v197, v197
    v_mfma_f32_16x16x32_bf16 v[228:231], a[48:51], a[216:219], 0
    v_exp_f32 v198, v198
    v_mfma_f32_16x16x32_bf16 v[228:231], a[52:55], a[220:223], v[228:231]
    v_exp_f32 v199, v199
    v_mfma_f32_16x16x32_bf16 v[228:231], a[56:59], a[224:227], v[228:231]
    v_cvt_pk_bf16_f32 v188, v196, v197
    v_cvt_pk_bf16_f32 v191, v198, v199
    v_mfma_f32_16x16x32_bf16 v[228:231], a[60:63], a[228:231], v[228:231]
    s_waitcnt lgkmcnt(1)
    v_cvt_pk_bf16_f32 v152, v236, v237
    v_cvt_pk_bf16_f32 v153, v238, v239
    v_mfma_f32_16x16x32_bf16 v[208:211], v[138:141], v[174:177], v[208:211]
    ds_read_b128 v[196:199], v246 offset:64
    v_mul_f32 v216, v216, v225
    v_mfma_f32_16x16x32_bf16 v[208:211], v[140:143], v[176:179], v[208:211]
    v_exp_f32 v200, v200
    v_mfma_f32_16x16x32_bf16 v[228:231], a[64:67], a[232:235], v[228:231]
    v_exp_f32 v201, v201
    v_mfma_f32_16x16x32_bf16 v[228:231], a[68:71], a[236:239], v[228:231]
    v_exp_f32 v202, v202
    v_mfma_f32_16x16x32_bf16 v[232:235], a[216:219], a[72:75], 0
    v_exp_f32 v203, v203
    v_mfma_f32_16x16x32_bf16 v[232:235], a[220:223], a[76:79], v[232:235]
L_h7:
    s_cbranch_execz L_hback
    v_cvt_pk_bf16_f32 v189, v200, v201
    v_cvt_pk_bf16_f32 v192, v202, v203
    v_mfma_f32_16x16x32_bf16 v[232:235], a[224:227], a[80:83], v[232:235]
    ds_read_b128 v[200:203], v244 offset:128
    v_cvt_pk_bf16_f32 v154, v228, v229
    v_mfma_f32_16x16x32_bf16 v[212:215], v[6:9], v[188:191], 0
    v_cvt_pk_bf16_f32 v155, v230, v231
    v_mul_f32 v217, v217, v225
    v_mfma_f32_16x16x32_bf16 v[232:235], a[228:231], a[84:87], v[232:235]
    v_mul_f32 v218, v218, v225
    v_mul_f32 v219, v219, v225
    v_mfma_f32_16x16x32_bf16 v[232:235], a[232:235], a[88:91], v[232:235]
    v_cvt_pk_bf16_f32 v216, v216, v217
    v_cvt_pk_bf16_f32 v217, v218, v219
    v_mfma_f32_16x16x32_bf16 v[232:235], a[236:239], a[92:95], v[232:235]
    ds_write_b64 v247, v[216:217] offset:24704
    v_mfma_f32_16x16x32_bf16 v[216:219], v[36:39], v[188:191], 0
    v_mul_f32 v220, v220, v225
    v_mul_f32 v221, v221, v225
    v_mfma_f32_16x16x32_bf16 v[236:239], a[216:219], a[96:99], 0
    v_mul_f32 v222, v222, v225
    v_mul_f32 v223, v223, v225
    v_mfma_f32_16x16x32_bf16 v[236:239], a[220:223], a[100:103], v[236:239]
    s_waitcnt lgkmcnt(2)
    v_cvt_pk_bf16_f32 v19, v232, v233
    v_mbcnt_lo_u32_b32 v232, -1, 0
    v_mfma_f32_16x16x32_bf16 v[196:199], v[144:147], v[174:177], v[196:199]
    v_mbcnt_hi_u32_b32 v232, -1, v232
    v_cvt_pk_bf16_f32 v22, v234, v235
    v_mfma_f32_16x16x32_bf16 v[196:199], v[146:149], v[176:179], v[196:199]
    s_waitcnt vmcnt(3)
    v_and_b32 v233, 15, v232
    v_lshrrev_b32 v232, 4, v232
    v_mfma_f32_16x16x32_bf16 v[236:239], a[224:227], a[104:107], v[236:239]
    s_waitcnt vmcnt(0)
    v_lshrrev_b32 v234, 1, v233
    v_mul_u32_u24 v235, 0x180, v233
    v_mfma_f32_16x16x32_bf16 v[236:239], a[228:231], a[108:111], v[236:239]
    ds_read_b64_tr_b16 a[160:161], v249 offset:0
    v_xor_b32 v243, v232, v234
    v_mfma_f32_16x16x32_bf16 v[236:239], a[232:235], a[112:115], v[236:239]
    ds_read_b64_tr_b16 a[162:163], v250 offset:0
    v_lshl_add_u32 v242, v243, 4, v235
    v_mfma_f32_16x16x32_bf16 v[236:239], a[236:239], a[116:119], v[236:239]
    ds_read_b64_tr_b16 a[164:165], v249 offset:3072
    v_xor_b32 v243, 64, v242
    v_mfma_f32_16x16x32_bf16 v[228:231], a[216:219], a[120:123], 0
    s_waitcnt lgkmcnt(4)
    v_add_u32 v242, 0x1e000, v242
    v_add_u32 v243, 0x1e000, v243
    v_mfma_f32_16x16x32_bf16 v[200:203], v[102:105], v[174:177], v[200:203]
    ds_read_b128 a[240:243], v242 offset:0
    ds_read_b128 a[244:247], v243 offset:0
    v_mfma_f32_16x16x32_bf16 v[200:203], v[104:107], v[176:179], v[200:203]
    ds_read_b128 a[216:219], v242 offset:128
    ds_read_b64_tr_b16 a[166:167], v250 offset:3072
    v_mfma_f32_16x16x32_bf16 v[228:231], a[220:223], a[124:127], v[228:231]
    ds_read_b128 a[220:223], v243 offset:128
    v_cvt_pk_bf16_f32 v49, v236, v237
    v_mfma_f32_16x16x32_bf16 v[228:231], a[224:227], a[128:131], v[228:231]
    ds_read_b128 a[224:227], v242 offset:256
    v_cvt_pk_bf16_f32 v52, v238, v239
    v_mfma_f32_16x16x32_bf16 v[228:231], a[228:231], a[132:135], v[228:231]
    ds_read_b128 a[228:231], v243 offset:256
    ds_read_b64_tr_b16 a[184:185], v249 offset:32
    v_mfma_f32_16x16x32_bf16 v[228:231], a[232:235], a[136:139], v[228:231]
    ds_read_b64_tr_b16 a[186:187], v250 offset:32
    ds_read_b64_tr_b16 a[188:189], v249 offset:3104
    v_mfma_f32_16x16x32_bf16 v[228:231], a[236:239], a[140:143], v[228:231]
    ds_read_b64_tr_b16 a[190:191], v250 offset:3104
    ds_read_b64_tr_b16 a[208:209], v249 offset:64
    ds_read_b64_tr_b16 a[210:211], v250 offset:64
    ds_read_b64_tr_b16 a[212:213], v249 offset:3136
    v_lshrrev_b32 v249, 1, v232
    v_or_b32 v249, s66, v249
    s_waitcnt lgkmcnt(13)
    v_mfma_f32_16x16x32_bf16 v[236:239], a[144:147], a[240:243], 0
    v_cvt_pk_bf16_f32 v79, v228, v229
    s_waitcnt lgkmcnt(12)
    v_mfma_f32_16x16x32_bf16 v[236:239], a[148:151], a[244:247], v[236:239]
    ds_read_b64_tr_b16 a[214:215], v250 offset:3136
    s_waitcnt lgkmcnt(12)
    v_mfma_f32_16x16x32_bf16 v[236:239], a[152:155], a[216:219], v[236:239]
    v_cvt_pk_bf16_f32 v82, v230, v231
    v_mov_b32 v253, v249
    v_mfma_f32_16x16x32_bf16 v[228:231], a[168:171], a[240:243], 0
    s_waitcnt lgkmcnt(10)
    v_xor_b32 v249, v249, v234
    v_lshl_add_u32 v249, v249, 4, v235
    v_mfma_f32_16x16x32_bf16 v[236:239], a[156:159], a[220:223], v[236:239]
    s_waitcnt lgkmcnt(9)
    ds_read_b128 a[232:235], v242 offset:6144
    v_mfma_f32_16x16x32_bf16 v[236:239], a[160:163], a[224:227], v[236:239]
    s_waitcnt lgkmcnt(9)
    v_and_b32 v235, 1, v232
    v_lshl_add_u32 v249, v235, 3, v249
    v_mfma_f32_16x16x32_bf16 v[236:239], a[164:167], a[228:231], v[236:239]
    ds_read_b128 a[236:239], v243 offset:6144
    v_lshlrev_b32 v235, 3, v235
    v_mfma_f32_16x16x32_bf16 v[228:231], a[172:175], a[244:247], v[228:231]
    v_xor_b32 v250, s67, v232
    v_xor_b32 v252, v233, v235
    v_mfma_f32_16x16x32_bf16 v[228:231], a[176:179], a[216:219], v[228:231]
    s_mul_i32 s67, s28, 0x600
    v_xor_b32 v252, v252, v253
    v_mul_u32_u24 v250, 0x300, v250
    v_mfma_f32_16x16x32_bf16 v[228:231], a[180:183], a[220:223], v[228:231]
    s_waitcnt lgkmcnt(8)
    s_add_u32 s67, s67, 0x16800
    v_mul_u32_u24 v232, 0x180, v232
    v_mfma_f32_16x16x32_bf16 v[228:231], a[184:187], a[224:227], v[228:231]
    s_waitcnt lgkmcnt(2)
    v_xor_b32 v253, v253, v234
    v_add_u32 v232, s67, v232
    v_mfma_f32_16x16x32_bf16 v[228:231], a[188:191], a[228:231], v[228:231]
    v_and_b32 v234, 1, v233
    v_lshl_add_u32 v251, v233, 3, v250
    v_lshl_add_u32 v253, v253, 4, v232
    v_xor_b32 v233, v233, v235
    v_lshl_add_u32 v252, v252, 4, v232
    v_lshl_add_u32 v253, v234, 3, v253
    v_lshl_add_u32 v250, v233, 4, v250
    v_mfma_f32_16x16x32_bf16 v[232:235], a[192:195], a[240:243], 0
    ds_read_b128 a[240:243], v242 offset:6272
    s_barrier
    v_mfma_f32_16x16x32_bf16 v[232:235], a[196:199], a[244:247], v[232:235]
    ds_read_b128 a[244:247], v243 offset:6272
    v_cvt_pk_bf16_f32 v236, v236, v237
    v_mfma_f32_16x16x32_bf16 v[232:235], a[200:203], a[216:219], v[232:235]
    ds_read_b128 a[216:219], v242 offset:6400
    v_add_u32 v249, 0x16800, v249
    v_mfma_f32_16x16x32_bf16 v[232:235], a[204:207], a[220:223], v[232:235]
    s_lshl2_add_u32 s67, s28, 0x23000
    v_cvt_pk_bf16_f32 v237, v238, v239
    v_cvt_pk_bf16_f32 v228, v228, v229
    v_mfma_f32_16x16x32_bf16 v[232:235], a[208:211], a[224:227], v[232:235]
    ds_write_b64 v249, v[236:237] offset:0
    v_mfma_f32_16x16x32_bf16 v[232:235], a[212:215], a[228:231], v[232:235]
    s_waitcnt lgkmcnt(5)
    v_cvt_pk_bf16_f32 v229, v230, v231
    v_cvt_pk_bf16_f32 v220, v220, v221
    v_mfma_f32_16x16x32_bf16 v[236:239], a[144:147], a[232:235], 0
    s_waitcnt lgkmcnt(4)
    ds_read_b128 a[220:223], v243 offset:6400
    v_mfma_f32_16x16x32_bf16 v[236:239], a[148:151], a[236:239], v[236:239]
    ds_write_b64 v249, v[228:229] offset:128
    v_mfma_f32_16x16x32_bf16 v[228:231], a[168:171], a[232:235], 0
    s_waitcnt lgkmcnt(5)
    v_cvt_pk_bf16_f32 v221, v222, v223
    v_max3_f32 v248, v248, v224, v225
    v_mfma_f32_16x16x32_bf16 v[224:227], a[248:251], v[188:191], 0
    ds_write_b64 v247, v[220:221] offset:24832
    v_mfma_f32_16x16x32_bf16 v[220:223], v[66:69], v[188:191], 0
    v_exp_f32 v204, v204
    v_mfma_f32_16x16x32_bf16 v[236:239], a[152:155], a[240:243], v[236:239]
    s_waitcnt lgkmcnt(5)
    v_exp_f32 v205, v205
    v_mfma_f32_16x16x32_bf16 v[236:239], a[156:159], a[244:247], v[236:239]
    s_waitcnt lgkmcnt(4)
    v_exp_f32 v206, v206
    v_mfma_f32_16x16x32_bf16 v[236:239], a[160:163], a[216:219], v[236:239]
    v_exp_f32 v207, v207
    v_mfma_f32_16x16x32_bf16 v[228:231], a[172:175], a[236:239], v[228:231]
    s_waitcnt lgkmcnt(2)
    v_cvt_pk_bf16_f32 v180, v204, v205
    v_cvt_pk_bf16_f32 v183, v206, v207
    v_mfma_f32_16x16x32_bf16 v[236:239], a[164:167], a[220:223], v[236:239]
    ds_read_b128 v[204:207], v245 offset:128
    ds_read_b128 a[224:227], v242 offset:12288
    v_mfma_f32_16x16x32_bf16 v[228:231], a[176:179], a[240:243], v[228:231]
    ds_read_b128 a[228:231], v243 offset:12288
    v_cvt_pk_bf16_f32 v232, v232, v233
    v_mfma_f32_16x16x32_bf16 v[228:231], a[180:183], a[244:247], v[228:231]
    v_exp_f32 v208, v208
    v_mfma_f32_16x16x32_bf16 v[228:231], a[184:187], a[216:219], v[228:231]
    v_cvt_pk_bf16_f32 v233, v234, v235
    v_cvt_pk_bf16_f32 v236, v236, v237
    v_mfma_f32_16x16x32_bf16 v[228:231], a[188:191], a[220:223], v[228:231]
    ds_write_b64 v249, v[232:233] offset:256
    v_mfma_f32_16x16x32_bf16 v[232:235], a[192:195], a[232:235], 0
    ds_read_b128 a[232:235], v242 offset:12416
    v_cvt_pk_bf16_f32 v237, v238, v239
    v_mfma_f32_16x16x32_bf16 v[232:235], a[196:199], a[236:239], v[232:235]
    ds_read_b128 a[236:239], v243 offset:12416
    v_mfma_f32_16x16x32_bf16 v[232:235], a[200:203], a[240:243], v[232:235]
    ds_read_b128 a[240:243], v242 offset:12544
    v_cvt_pk_bf16_f32 v228, v228, v229
    v_mfma_f32_16x16x32_bf16 v[232:235], a[204:207], a[244:247], v[232:235]
    s_waitcnt lgkmcnt(6)
    ds_read_b128 a[244:247], v243 offset:12544
    v_mfma_f32_16x16x32_bf16 v[204:207], v[114:117], v[174:177], v[204:207]
    ds_write_b64 v249, v[236:237] offset:6144
    v_mfma_f32_16x16x32_bf16 v[204:207], v[116:119], v[176:179], v[204:207]
    s_waitcnt lgkmcnt(7)
    v_cvt_pk_bf16_f32 v229, v230, v231
    v_add_u32 v242, 0xfffe9800, v242
    v_mfma_f32_16x16x32_bf16 v[232:235], a[208:211], a[216:219], v[232:235]
    ds_write_b64 v249, v[228:229] offset:6272
    v_mfma_f32_16x16x32_bf16 v[232:235], a[212:215], a[220:223], v[232:235]
    v_exp_f32 v209, v209
    v_mfma_f32_16x16x32_bf16 v[236:239], a[144:147], a[224:227], 0
    s_waitcnt lgkmcnt(7)
    v_exp_f32 v210, v210
    v_mfma_f32_16x16x32_bf16 v[236:239], a[148:151], a[228:231], v[236:239]
    s_waitcnt lgkmcnt(5)
    v_exp_f32 v211, v211
    v_mfma_f32_16x16x32_bf16 v[236:239], a[152:155], a[232:235], v[236:239]
    s_waitcnt lgkmcnt(4)
    v_cvt_pk_bf16_f32 v194, v208, v209
    v_cvt_pk_bf16_f32 v181, v210, v211
    v_mfma_f32_16x16x32_bf16 v[236:239], a[156:159], a[236:239], v[236:239]
    s_waitcnt lgkmcnt(3)
    v_exp_f32 v196, v196
    v_mfma_f32_16x16x32_bf16 v[236:239], a[160:163], a[240:243], v[236:239]
    s_waitcnt lgkmcnt(2)
    v_exp_f32 v197, v197
    v_mfma_f32_16x16x32_bf16 v[236:239], a[164:167], a[244:247], v[236:239]
    ds_read_b128 v[208:211], v246 offset:128
    v_cvt_pk_bf16_f32 v195, v196, v197
    v_mfma_f32_16x16x32_bf16 v[228:231], a[168:171], a[224:227], 0
    v_exp_f32 v198, v198
    v_mfma_f32_16x16x32_bf16 v[212:215], v[10:13], v[192:195], v[212:215]
    v_exp_f32 v199, v199
    v_mfma_f32_16x16x32_bf16 v[216:219], v[40:43], v[192:195], v[216:219]
    v_cvt_pk_bf16_f32 v182, v198, v199
    v_cvt_pk_bf16_f32 v232, v232, v233
    v_mfma_f32_16x16x32_bf16 v[220:223], v[70:73], v[192:195], v[220:223]
    ds_read_b128 v[196:199], v244 offset:0
    v_cvt_pk_bf16_f32 v233, v234, v235
    v_mfma_f32_16x16x32_bf16 v[224:227], a[248:251], v[192:195], v[224:227]
    v_exp_f32 v200, v200
    v_mfma_f32_16x16x32_bf16 v[212:215], v[14:17], v[180:183], v[212:215]
    v_exp_f32 v201, v201
    v_mfma_f32_16x16x32_bf16 v[216:219], v[44:47], v[180:183], v[216:219]
    ds_read_b128 a[216:219], v242 offset:6144
    v_cvt_pk_bf16_f32 v186, v200, v201
    v_mfma_f32_16x16x32_bf16 v[220:223], v[74:77], v[180:183], v[220:223]
    ds_read_b128 v[200:203], v245 offset:0
    v_add_u32 v243, 0xfffe9800, v243
    v_mfma_f32_16x16x32_bf16 v[224:227], a[248:251], v[180:183], v[224:227]
    s_waitcnt lgkmcnt(3)
    v_exp_f32 v204, v204
    v_mfma_f32_16x16x32_bf16 v[208:211], v[150:153], v[174:177], v[208:211]
    v_exp_f32 v205, v205
    v_mfma_f32_16x16x32_bf16 v[208:211], v[152:155], v[176:179], v[208:211]
    ds_read_b128 a[220:223], v243 offset:6144
    v_cvt_pk_bf16_f32 v184, v204, v205
    v_mfma_f32_16x16x32_bf16 v[228:231], a[172:175], a[228:231], v[228:231]
    ds_read_b128 v[204:207], v246 offset:0
    s_waitcnt lgkmcnt(4)
    v_mfma_f32_16x16x32_bf16 v[196:199], v[162:165], v[168:171], v[196:199]
    ds_write_b64 v249, v[232:233] offset:6400
    v_mfma_f32_16x16x32_bf16 v[196:199], v[164:167], v[170:173], v[196:199]
    v_exp_f32 v208, v208
    v_mfma_f32_16x16x32_bf16 v[228:231], a[176:179], a[232:235], v[228:231]
    v_exp_f32 v209, v209
    v_mfma_f32_16x16x32_bf16 v[228:231], a[180:183], a[236:239], v[228:231]
    v_cvt_pk_bf16_f32 v185, v208, v209
    v_cvt_pk_bf16_f32 v236, v236, v237
    v_mfma_f32_16x16x32_bf16 v[228:231], a[184:187], a[240:243], v[228:231]
    s_waitcnt lgkmcnt(3)
    v_exp_f32 v196, v196
    v_mfma_f32_16x16x32_bf16 v[212:215], v[18:21], v[184:187], v[212:215]
    ds_read_b128 v[208:211], v244 offset:64
    v_cvt_pk_bf16_f32 v237, v238, v239
    v_mfma_f32_16x16x32_bf16 v[216:219], v[48:51], v[184:187], v[216:219]
    v_exp_f32 v197, v197
    v_mfma_f32_16x16x32_bf16 v[220:223], v[78:81], v[184:187], v[220:223]
    s_waitcnt lgkmcnt(2)
    v_exp_f32 v198, v198
    v_mfma_f32_16x16x32_bf16 v[224:227], a[248:251], v[184:187], v[224:227]
    v_exp_f32 v199, v199
    v_mfma_f32_16x16x32_bf16 v[200:203], v[138:141], v[168:171], v[200:203]
    v_cvt_pk_bf16_f32 v190, v196, v197
    v_cvt_pk_bf16_f32 v193, v198, v199
    v_mfma_f32_16x16x32_bf16 v[200:203], v[140:143], v[170:173], v[200:203]
    ds_read_b128 v[196:199], v245 offset:64
    ds_read_b64 v[174:175], v247 offset:43008
    v_mfma_f32_16x16x32_bf16 v[204:207], v[144:147], v[168:171], v[204:207]
    ds_write_b64 v249, v[236:237] offset:12288
    v_mfma_f32_16x16x32_bf16 v[204:207], v[146:149], v[170:173], v[204:207]
    v_rcp_f32 v225, v224
    v_mfma_f32_16x16x32_bf16 v[228:231], a[188:191], a[244:247], v[228:231]
    v_mul_f32 v212, v212, v225
    v_mul_f32 v213, v213, v225
    v_mfma_f32_16x16x32_bf16 v[232:235], a[192:195], a[224:227], 0
    ds_read_b128 a[224:227], v242 offset:6272
    v_mul_f32 v214, v214, v225
    v_mfma_f32_16x16x32_bf16 v[232:235], a[196:199], a[228:231], v[232:235]
    ds_read_b128 a[228:231], v243 offset:6272
    v_mul_f32 v215, v215, v225
    v_mfma_f32_16x16x32_bf16 v[232:235], a[200:203], a[232:235], v[232:235]
    ds_read_b128 a[232:235], v242 offset:6400
    v_cvt_pk_bf16_f32 v228, v228, v229
    v_mfma_f32_16x16x32_bf16 v[232:235], a[204:207], a[236:239], v[232:235]
    ds_read_b128 a[236:239], v243 offset:6400
    v_cvt_pk_bf16_f32 v229, v230, v231
    v_mfma_f32_16x16x32_bf16 v[232:235], a[208:211], a[240:243], v[232:235]
    s_waitcnt lgkmcnt(7)
    v_exp_f32 v200, v200
    v_mfma_f32_16x16x32_bf16 v[208:211], v[102:105], v[168:171], v[208:211]
    ds_write_b64 v249, v[228:229] offset:12416
    v_mfma_f32_16x16x32_bf16 v[208:211], v[104:107], v[170:173], v[208:211]
    ds_read_b128 a[240:243], v240 offset:6144
    v_cvt_pk_bf16_f32 v212, v212, v213
    v_mfma_f32_16x16x32_bf16 v[232:235], a[212:215], a[244:247], v[232:235]
    ds_read_b128 a[244:247], v241 offset:6144
    v_cvt_pk_bf16_f32 v213, v214, v215
    v_mfma_f32_16x16x32_bf16 v[236:239], a[144:147], a[216:219], 0
    v_exp_f32 v201, v201
    v_mfma_f32_16x16x32_bf16 v[236:239], a[148:151], a[220:223], v[236:239]
    s_waitcnt lgkmcnt(6)
    v_exp_f32 v202, v202
    v_mfma_f32_16x16x32_bf16 v[196:199], v[114:117], v[168:171], v[196:199]
    v_cvt_pk_bf16_f32 v232, v232, v233
    v_cvt_pk_bf16_f32 v233, v234, v235
    v_mfma_f32_16x16x32_bf16 v[196:199], v[116:119], v[170:173], v[196:199]
    ds_write_b64 v249, v[232:233] offset:12544
    v_mfma_f32_16x16x32_bf16 v[236:239], a[152:155], a[224:227], v[236:239]
    s_waitcnt lgkmcnt(6)
    v_exp_f32 v203, v203
    v_mfma_f32_16x16x32_bf16 v[236:239], a[156:159], a[228:231], v[236:239]
    s_waitcnt lgkmcnt(5)
    v_cvt_pk_bf16_f32 v188, v200, v201
    v_cvt_pk_bf16_f32 v191, v202, v203
    v_mfma_f32_16x16x32_bf16 v[236:239], a[160:163], a[232:235], v[236:239]
    s_waitcnt lgkmcnt(4)
    v_exp_f32 v204, v204
    v_mfma_f32_16x16x32_bf16 v[236:239], a[164:167], a[236:239], v[236:239]
    ds_read_b128 v[200:203], v246 offset:64
    v_mul_f32 v216, v216, v225
    v_mfma_f32_16x16x32_bf16 v[228:231], a[168:171], a[216:219], 0
    v_exp_f32 v205, v205
    v_mfma_f32_16x16x32_bf16 v[228:231], a[172:175], a[220:223], v[228:231]
    v_cvt_pk_bf16_f32 v189, v204, v205
    v_mul_f32 v217, v217, v225
    v_mfma_f32_16x16x32_bf16 v[228:231], a[176:179], a[224:227], v[228:231]
    v_cvt_pk_bf16_f32 v236, v236, v237
    v_cvt_pk_bf16_f32 v237, v238, v239
    v_mfma_f32_16x16x32_bf16 v[228:231], a[180:183], a[228:231], v[228:231]
    ds_write_b64 v249, v[236:237] offset:18432
    v_mfma_f32_16x16x32_bf16 v[228:231], a[184:187], a[232:235], v[228:231]
    s_waitcnt lgkmcnt(3)
    v_mul_f32 v218, v218, v225
    v_mul_f32 v219, v219, v225
    v_mfma_f32_16x16x32_bf16 v[228:231], a[188:191], a[236:239], v[228:231]
    ds_write_b64 v247, v[212:213] offset:30720
    v_mfma_f32_16x16x32_bf16 v[212:215], v[12:15], v[188:191], 0
    v_cvt_pk_bf16_f32 v216, v216, v217
    v_cvt_pk_bf16_f32 v217, v218, v219
    v_mfma_f32_16x16x32_bf16 v[232:235], a[192:195], a[216:219], 0
    ds_read_b128 a[216:219], v240 offset:6272
    v_mul_f32 v220, v220, v225
    v_mfma_f32_16x16x32_bf16 v[232:235], a[196:199], a[220:223], v[232:235]
    ds_read_b128 a[220:223], v241 offset:6272
    v_cvt_pk_bf16_f32 v228, v228, v229
    v_mfma_f32_16x16x32_bf16 v[232:235], a[200:203], a[224:227], v[232:235]
    ds_read_b128 a[224:227], v240 offset:6400
    v_cvt_pk_bf16_f32 v229, v230, v231
    v_mfma_f32_16x16x32_bf16 v[232:235], a[204:207], a[228:231], v[232:235]
    ds_read_b128 a[228:231], v241 offset:6400
    v_mul_f32 v221, v221, v225
    v_mfma_f32_16x16x32_bf16 v[232:235], a[208:211], a[232:235], v[232:235]
    ds_write_b64 v249, v[228:229] offset:18560
    v_mfma_f32_16x16x32_bf16 v[232:235], a[212:215], a[236:239], v[232:235]
    ds_write_b64 v247, v[216:217] offset:30848
    v_mfma_f32_16x16x32_bf16 v[216:219], v[42:45], v[188:191], 0
    s_waitcnt lgkmcnt(8)
    v_mul_f32 v222, v222, v225
    v_mul_f32 v223, v223, v225
    v_mfma_f32_16x16x32_bf16 v[200:203], v[150:153], v[168:171], v[200:203]
    s_barrier
    v_cvt_pk_bf16_f32 v220, v220, v221
    v_cvt_pk_bf16_f32 v232, v232, v233
    v_mfma_f32_16x16x32_bf16 v[200:203], v[152:155], v[170:173], v[200:203]
    v_cvt_pk_bf16_f32 v233, v234, v235
    v_cvt_pk_bf16_f32 v221, v222, v223
    v_mfma_f32_16x16x32_bf16 v[236:239], a[0:3], a[240:243], 0
    ds_write_b64 v249, v[232:233] offset:18688
    v_mfma_f32_16x16x32_bf16 v[236:239], a[4:7], a[244:247], v[236:239]
    s_waitcnt lgkmcnt(6)
    v_exp_f32 v206, v206
    v_mfma_f32_16x16x32_bf16 v[236:239], a[8:11], a[216:219], v[236:239]
    s_waitcnt lgkmcnt(5)
    v_exp_f32 v207, v207
    v_mfma_f32_16x16x32_bf16 v[236:239], a[12:15], a[220:223], v[236:239]
    s_waitcnt lgkmcnt(4)
    v_max3_f32 v248, v248, v224, v225
    v_cvt_pk_bf16_f32 v192, v206, v207
    v_mfma_f32_16x16x32_bf16 v[224:227], a[248:251], v[188:191], 0
    ds_write_b64 v247, v[220:221] offset:30976
    v_mfma_f32_16x16x32_bf16 v[220:223], v[72:75], v[188:191], 0
    ds_read_b128 v[204:207], v244 offset:128
    ds_read_b128 a[232:235], v242 offset:12288
    v_mfma_f32_16x16x32_bf16 v[236:239], a[16:19], a[224:227], v[236:239]
    s_waitcnt lgkmcnt(6)
    v_exp_f32 v208, v208
    v_mfma_f32_16x16x32_bf16 v[236:239], a[20:23], a[228:231], v[236:239]
    ds_read_b128 a[236:239], v243 offset:12288
    ds_read_b64 v[176:177], v247 offset:43136
    v_mfma_f32_16x16x32_bf16 v[228:231], a[24:27], a[240:243], 0
    v_exp_f32 v209, v209
    v_mfma_f32_16x16x32_bf16 v[228:231], a[28:31], a[244:247], v[228:231]
    v_exp_f32 v210, v210
    v_mfma_f32_16x16x32_bf16 v[228:231], a[32:35], a[216:219], v[228:231]
    v_exp_f32 v211, v211
    v_mfma_f32_16x16x32_bf16 v[228:231], a[36:39], a[220:223], v[228:231]
    v_cvt_pk_bf16_f32 v156, v236, v237
    v_cvt_pk_bf16_f32 v157, v238, v239
    v_mfma_f32_16x16x32_bf16 v[228:231], a[40:43], a[224:227], v[228:231]
    v_cvt_pk_bf16_f32 v180, v208, v209
    v_cvt_pk_bf16_f32 v183, v210, v211
    v_mfma_f32_16x16x32_bf16 v[228:231], a[44:47], a[228:231], v[228:231]
    ds_read_b128 v[208:211], v245 offset:128
    ds_read_b64 v[178:179], v247 offset:43264
    v_mfma_f32_16x16x32_bf16 v[232:235], a[48:51], a[240:243], 0
    v_exp_f32 v196, v196
    v_mfma_f32_16x16x32_bf16 v[232:235], a[52:55], a[244:247], v[232:235]
    v_exp_f32 v197, v197
    v_mfma_f32_16x16x32_bf16 v[232:235], a[56:59], a[216:219], v[232:235]
    v_exp_f32 v198, v198
    v_mfma_f32_16x16x32_bf16 v[232:235], a[60:63], a[220:223], v[232:235]
    v_cvt_pk_bf16_f32 v158, v228, v229
    v_cvt_pk_bf16_f32 v159, v230, v231
    v_mfma_f32_16x16x32_bf16 v[232:235], a[64:67], a[224:227], v[232:235]
    s_waitcnt lgkmcnt(5)
    v_exp_f32 v199, v199
    v_mfma_f32_16x16x32_bf16 v[204:207], v[108:111], v[168:171], v[204:207]
    v_cvt_pk_bf16_f32 v194, v196, v197
    v_cvt_pk_bf16_f32 v181, v198, v199
    v_mfma_f32_16x16x32_bf16 v[204:207], v[110:113], v[170:173], v[204:207]
    v_exp_f32 v200, v200
    v_mfma_f32_16x16x32_bf16 v[232:235], a[68:71], a[228:231], v[232:235]
    v_exp_f32 v201, v201
    v_mfma_f32_16x16x32_bf16 v[236:239], a[240:243], a[72:75], 0
    ds_read_b128 v[196:199], v246 offset:128
    v_cvt_pk_bf16_f32 v195, v200, v201
    v_mfma_f32_16x16x32_bf16 v[236:239], a[244:247], a[76:79], v[236:239]
    v_exp_f32 v202, v202
    v_mfma_f32_16x16x32_bf16 v[212:215], v[16:19], v[192:195], v[212:215]
    v_exp_f32 v203, v203
    v_mfma_f32_16x16x32_bf16 v[216:219], v[46:49], v[192:195], v[216:219]
    v_cvt_pk_bf16_f32 v160, v232, v233
    v_cvt_pk_bf16_f32 v161, v234, v235
    v_mfma_f32_16x16x32_bf16 v[220:223], v[76:79], v[192:195], v[220:223]
    ds_read_b128 a[252:255], v252 offset:0
    v_cvt_pk_bf16_f32 v182, v202, v203
    v_mfma_f32_16x16x32_bf16 v[224:227], a[248:251], v[192:195], v[224:227]
    s_waitcnt lgkmcnt(2)
    v_exp_f32 v204, v204
    v_mfma_f32_16x16x32_bf16 v[212:215], v[20:23], v[180:183], v[212:215]
    ds_read_b128 v[200:203], v244 offset:0
    ds_read_b64 v[254:255], v253 offset:256
    v_mfma_f32_16x16x32_bf16 v[216:219], v[50:53], v[180:183], v[216:219]
    v_exp_f32 v205, v205
    v_mfma_f32_16x16x32_bf16 v[220:223], v[80:83], v[180:183], v[220:223]
    v_cvt_pk_bf16_f32 v186, v204, v205
    v_mfma_f32_16x16x32_bf16 v[224:227], a[248:251], v[180:183], v[224:227]
    ds_read_b128 v[204:207], v245 offset:0
    v_mfma_f32_16x16x32_bf16 v[208:211], v[120:123], v[168:171], v[208:211]
    v_mfma_f32_16x16x32_bf16 v[208:211], v[122:125], v[170:173], v[208:211]
    v_mfma_f32_16x16x32_bf16 v[236:239], a[216:219], a[80:83], v[236:239]
    v_mfma_f32_16x16x32_bf16 v[236:239], a[220:223], a[84:87], v[236:239]
    v_mfma_f32_16x16x32_bf16 v[236:239], a[224:227], a[88:91], v[236:239]
    s_waitcnt lgkmcnt(4)
    v_mfma_f32_16x16x32_bf16 v[196:199], v[156:159], v[168:171], v[196:199]
    ds_read_b64 v[168:169], v247 offset:49152
    v_mfma_f32_16x16x32_bf16 v[196:199], v[158:161], v[170:173], v[196:199]
    ds_read_b64 v[170:171], v247 offset:49280
    ds_read_b64 v[172:173], v247 offset:49408
    v_mfma_f32_16x16x32_bf16 v[236:239], a[228:231], a[92:95], v[236:239]
    s_waitcnt lgkmcnt(6)
    v_exp_f32 v208, v208
    v_mfma_f32_16x16x32_bf16 v[228:231], a[240:243], a[96:99], 0
    v_exp_f32 v209, v209
    v_mfma_f32_16x16x32_bf16 v[228:231], a[244:247], a[100:103], v[228:231]
    s_waitcnt lgkmcnt(5)
    v_exp_f32 v196, v196
    v_mfma_f32_16x16x32_bf16 v[200:203], v[102:105], v[174:177], v[200:203]
    s_waitcnt lgkmcnt(4)
    v_cvt_pk_bf16_f32 v25, v236, v237
    v_cvt_pk_bf16_f32 v28, v238, v239
    v_mfma_f32_16x16x32_bf16 v[200:203], v[104:107], v[176:179], v[200:203]
    v_exp_f32 v197, v197
    v_mfma_f32_16x16x32_bf16 v[228:231], a[216:219], a[104:107], v[228:231]
    v_cvt_pk_bf16_f32 v184, v208, v209
    v_cvt_pk_bf16_f32 v185, v196, v197
    v_mfma_f32_16x16x32_bf16 v[228:231], a[220:223], a[108:111], v[228:231]
    ds_read_b128 v[208:211], v246 offset:0
    s_waitcnt lgkmcnt(4)
    v_mfma_f32_16x16x32_bf16 v[212:215], v[24:27], v[184:187], v[212:215]
    ds_read_b128 v[196:199], v244 offset:64
    v_mfma_f32_16x16x32_bf16 v[224:227], a[248:251], v[184:187], v[224:227]
    v_exp_f32 v200, v200
    v_mfma_f32_16x16x32_bf16 v[204:207], v[114:117], v[174:177], v[204:207]
    v_exp_f32 v201, v201
    v_mfma_f32_16x16x32_bf16 v[204:207], v[116:119], v[176:179], v[204:207]
    v_exp_f32 v202, v202
    v_mfma_f32_16x16x32_bf16 v[228:231], a[224:227], a[112:115], v[228:231]
    v_exp_f32 v203, v203
    v_mfma_f32_16x16x32_bf16 v[228:231], a[228:231], a[116:119], v[228:231]
    v_cvt_pk_bf16_f32 v190, v200, v201
    v_cvt_pk_bf16_f32 v193, v202, v203
    v_mfma_f32_16x16x32_bf16 v[232:235], a[240:243], a[120:123], 0
    ds_read_b128 a[240:243], v242 offset:12416
    ds_read_b128 v[200:203], v245 offset:64
    v_mfma_f32_16x16x32_bf16 v[232:235], a[244:247], a[124:127], v[232:235]
    ds_read_b128 a[244:247], v243 offset:12416
    v_mfma_f32_16x16x32_bf16 v[232:235], a[216:219], a[128:131], v[232:235]
    ds_read_b128 a[216:219], v242 offset:12544
    v_cvt_pk_bf16_f32 v55, v228, v229
    v_mfma_f32_16x16x32_bf16 v[232:235], a[220:223], a[132:135], v[232:235]
    ds_read_b128 a[220:223], v243 offset:12544
    v_cvt_pk_bf16_f32 v58, v230, v231
    v_mfma_f32_16x16x32_bf16 v[216:219], v[54:57], v[184:187], v[216:219]
    buffer_store_dwordx4 a[252:255], v250, s[20:23], s56 offen nt
    v_mfma_f32_16x16x32_bf16 v[232:235], a[224:227], a[136:139], v[232:235]
    ds_read_b128 a[224:227], v242 offset:18432
    s_waitcnt lgkmcnt(7)
    v_mfma_f32_16x16x32_bf16 v[208:211], v[150:153], v[174:177], v[208:211]
    ds_read_b128 a[252:255], v252 offset:6144
    s_waitcnt lgkmcnt(7)
    v_mfma_f32_16x16x32_bf16 v[208:211], v[152:155], v[176:179], v[208:211]
    buffer_store_dwordx2 v[254:255], v251, s[20:23], s56 offen offset:256 nt
    v_mfma_f32_16x16x32_bf16 v[196:199], v[108:111], v[174:177], v[196:199]
    ds_read_b64 v[254:255], v253 offset:6400
    s_mul_i32 s56, s31, 3
    v_mfma_f32_16x16x32_bf16 v[196:199], v[110:113], v[176:179], v[196:199]
    s_add_u32 s55, s55, s56
    v_exp_f32 v204, v204
    v_mfma_f32_16x16x32_bf16 v[232:235], a[228:231], a[140:143], v[232:235]
    ds_read_b128 a[228:231], v243 offset:18432
    s_add_u32 s55, s55, s32
    v_mfma_f32_16x16x32_bf16 v[236:239], a[144:147], a[232:235], 0
    s_add_u32 s56, s28, 7
    v_exp_f32 v205, v205
    v_mfma_f32_16x16x32_bf16 v[236:239], a[148:151], a[236:239], v[236:239]
    s_waitcnt lgkmcnt(8)
    v_exp_f32 v206, v206
    v_mfma_f32_16x16x32_bf16 v[236:239], a[152:155], a[240:243], v[236:239]
    s_waitcnt lgkmcnt(6)
    v_cvt_pk_bf16_f32 v85, v232, v233
    v_cvt_pk_bf16_f32 v88, v234, v235
    v_mfma_f32_16x16x32_bf16 v[200:203], v[120:123], v[174:177], v[200:203]
    s_mul_i32 s56, s56, s30
    v_exp_f32 v207, v207
    v_mfma_f32_16x16x32_bf16 v[220:223], v[84:87], v[184:187], v[220:223]
    v_cvt_pk_bf16_f32 v188, v204, v205
    v_cvt_pk_bf16_f32 v191, v206, v207
    v_mfma_f32_16x16x32_bf16 v[200:203], v[122:125], v[176:179], v[200:203]
    ds_read_b128 v[204:207], v246 offset:64
    v_mov_b32 v186, 0
    v_mfma_f32_16x16x32_bf16 v[236:239], a[156:159], a[244:247], v[236:239]
    s_waitcnt lgkmcnt(5)
    v_rcp_f32 v225, v224
    v_mfma_f32_16x16x32_bf16 v[236:239], a[160:163], a[216:219], v[236:239]
    v_exp_f32 v208, v208
    v_mfma_f32_16x16x32_bf16 v[236:239], a[164:167], a[220:223], v[236:239]
    s_waitcnt lgkmcnt(3)
    v_exp_f32 v209, v209
    v_mfma_f32_16x16x32_bf16 v[228:231], a[168:171], a[232:235], 0
    buffer_store_dwordx4 a[252:255], v250, s[20:23], s51 offen nt
    v_mfma_f32_16x16x32_bf16 v[228:231], a[172:175], a[236:239], v[228:231]
    s_waitcnt lgkmcnt(2)
    v_mul_f32 v212, v212, v225
    v_mul_f32 v213, v213, v225
    v_mfma_f32_16x16x32_bf16 v[228:231], a[176:179], a[240:243], v[228:231]
    ds_read_b128 a[252:255], v252 offset:12288
    v_cvt_pk_bf16_f32 v236, v236, v237
    v_mfma_f32_16x16x32_bf16 v[228:231], a[180:183], a[244:247], v[228:231]
    v_cvt_pk_bf16_f32 v237, v238, v239
    v_cvt_pk_bf16_f32 v189, v208, v209
    v_mfma_f32_16x16x32_bf16 v[228:231], a[184:187], a[216:219], v[228:231]
    ds_write_b64 v249, v[236:237] offset:24576
    v_mfma_f32_16x16x32_bf16 v[228:231], a[188:191], a[220:223], v[228:231]
    buffer_store_dwordx2 v[254:255], v251, s[20:23], s51 offen offset:256 nt
    v_mfma_f32_16x16x32_bf16 v[232:235], a[192:195], a[232:235], 0
    ds_read_b128 a[232:235], v242 offset:18560
    v_mul_f32 v214, v214, v225
    v_mfma_f32_16x16x32_bf16 v[232:235], a[196:199], a[236:239], v[232:235]
    ds_read_b128 a[236:239], v243 offset:18560
    v_mul_f32 v215, v215, v225
    v_mfma_f32_16x16x32_bf16 v[232:235], a[200:203], a[240:243], v[232:235]
    ds_read_b128 a[240:243], v242 offset:18688
    v_cvt_pk_bf16_f32 v228, v228, v229
    v_mfma_f32_16x16x32_bf16 v[232:235], a[204:207], a[244:247], v[232:235]
    ds_read_b128 a[244:247], v243 offset:18688
    v_cvt_pk_bf16_f32 v229, v230, v231
    v_mfma_f32_16x16x32_bf16 v[232:235], a[208:211], a[216:219], v[232:235]
    ds_write_b64 v249, v[228:229] offset:24704
    v_mfma_f32_16x16x32_bf16 v[232:235], a[212:215], a[220:223], v[232:235]
    ds_read_b64 v[254:255], v253 offset:12544
    v_cvt_pk_bf16_f32 v212, v212, v213
L_h8:
    s_cbranch_execz L_hback
    v_mfma_f32_16x16x32_bf16 v[236:239], a[144:147], a[224:227], 0
    s_waitcnt lgkmcnt(8)
    v_cvt_pk_bf16_f32 v213, v214, v215
    v_mul_f32 v216, v216, v225
    v_mfma_f32_16x16x32_bf16 v[204:207], v[156:159], v[174:177], v[204:207]
    ds_read_b128 a[216:219], v242 offset:0
    v_cvt_pk_bf16_f32 v232, v232, v233
    v_mfma_f32_16x16x32_bf16 v[204:207], v[158:161], v[176:179], v[204:207]
    ds_read_b128 a[220:223], v243 offset:0
    v_cvt_pk_bf16_f32 v233, v234, v235
    v_mfma_f32_16x16x32_bf16 v[236:239], a[148:151], a[228:231], v[236:239]
    s_waitcnt lgkmcnt(7)
    v_mul_f32 v217, v217, v225
    v_mul_f32 v218, v218, v225
    v_mfma_f32_16x16x32_bf16 v[236:239], a[152:155], a[232:235], v[236:239]
    s_waitcnt lgkmcnt(6)
    v_mul_f32 v219, v219, v225
    v_cvt_pk_bf16_f32 v216, v216, v217
    v_mfma_f32_16x16x32_bf16 v[236:239], a[156:159], a[236:239], v[236:239]
    s_waitcnt lgkmcnt(5)
    v_cvt_pk_bf16_f32 v217, v218, v219
    v_mul_f32 v220, v220, v225
    v_mfma_f32_16x16x32_bf16 v[236:239], a[160:163], a[240:243], v[236:239]
    s_waitcnt lgkmcnt(4)
    v_mul_f32 v221, v221, v225
    v_mul_f32 v222, v222, v225
    v_mfma_f32_16x16x32_bf16 v[236:239], a[164:167], a[244:247], v[236:239]
    ds_write_b64 v249, v[232:233] offset:24832
    v_mfma_f32_16x16x32_bf16 v[228:231], a[168:171], a[224:227], 0
    ds_write_b64 v247, v[212:213] offset:36864
    v_mfma_f32_16x16x32_bf16 v[212:215], v[18:21], v[188:191], 0
    ds_write_b64 v247, v[216:217] offset:36992
    v_mfma_f32_16x16x32_bf16 v[216:219], v[48:51], v[188:191], 0
    s_mul_i32 s51, s31, 7
    v_mul_f32 v223, v223, v225
    v_cvt_pk_bf16_f32 v236, v236, v237
    v_mfma_f32_16x16x32_bf16 v[228:231], a[172:175], a[228:231], v[228:231]
    s_add_u32 s57, s57, s51
    v_cvt_pk_bf16_f32 v237, v238, v239
    v_cvt_pk_bf16_f32 v220, v220, v221
    v_mfma_f32_16x16x32_bf16 v[228:231], a[176:179], a[232:235], v[228:231]
    s_waitcnt lgkmcnt(5)
    v_cvt_pk_bf16_f32 v221, v222, v223
    v_add_u32 v209, 0xfffff900, v245
    v_mfma_f32_16x16x32_bf16 v[228:231], a[180:183], a[236:239], v[228:231]
    ds_write_b64 v247, v[220:221] offset:37120
    v_mfma_f32_16x16x32_bf16 v[220:223], v[78:81], v[188:191], 0
    s_add_u32 s57, s57, s32
    s_waitcnt lgkmcnt(3)
    s_barrier
    v_mfma_f32_16x16x32_bf16 v[228:231], a[184:187], a[240:243], v[228:231]
    ds_write_b64 v249, v[236:237] offset:0
    v_mfma_f32_16x16x32_bf16 v[228:231], a[188:191], a[244:247], v[228:231]
    s_add_u32 s51, s28, 11
    v_exp_f32 v210, v210
    v_mfma_f32_16x16x32_bf16 v[232:235], a[192:195], a[224:227], 0
    ds_read_b128 a[224:227], v242 offset:128
    v_max3_f32 v248, v248, v224, v225
    v_mfma_f32_16x16x32_bf16 v[224:227], a[248:251], v[188:191], 0
    s_mul_i32 s51, s51, s30
    v_exp_f32 v211, v211
    v_mfma_f32_16x16x32_bf16 v[232:235], a[196:199], a[228:231], v[232:235]
    ds_read_b128 a[228:231], v243 offset:128
    v_cvt_pk_bf16_f32 v228, v228, v229
    v_mfma_f32_16x16x32_bf16 v[232:235], a[200:203], a[232:235], v[232:235]
    ds_read_b128 a[232:235], v242 offset:256
    v_cvt_pk_bf16_f32 v229, v230, v231
    v_mfma_f32_16x16x32_bf16 v[232:235], a[204:207], a[236:239], v[232:235]
    ds_write_b64 v249, v[228:229] offset:128
    v_mfma_f32_16x16x32_bf16 v[232:235], a[208:211], a[240:243], v[232:235]
    ds_read_b128 a[236:239], v243 offset:256
    v_cvt_pk_bf16_f32 v192, v210, v211
    v_mfma_f32_16x16x32_bf16 v[232:235], a[212:215], a[244:247], v[232:235]
    v_cndmask_b32 v209, v244, v209, vcc
    v_add_u32 v210, 0xc0, v209
    v_mfma_f32_16x16x32_bf16 v[236:239], a[144:147], a[216:219], 0
    s_mov_b32 vcc_lo, 0xff00ff00
    v_add_u32 v209, 0x340, v209
    v_mov_b32 v208, 0x237c0
    v_mfma_f32_16x16x32_bf16 v[236:239], a[148:151], a[220:223], v[236:239]
    s_waitcnt lgkmcnt(4)
    v_cvt_pk_bf16_f32 v232, v232, v233
    v_cvt_pk_bf16_f32 v233, v234, v235
    v_mfma_f32_16x16x32_bf16 v[236:239], a[152:155], a[224:227], v[236:239]
    ds_write_b64 v249, v[232:233] offset:256
    v_mfma_f32_16x16x32_bf16 v[228:231], a[168:171], a[216:219], 0
    s_waitcnt lgkmcnt(4)
    v_exp_f32 v200, v200
    v_mfma_f32_16x16x32_bf16 v[236:239], a[156:159], a[228:231], v[236:239]
    s_waitcnt lgkmcnt(3)
    v_exp_f32 v201, v201
    v_mfma_f32_16x16x32_bf16 v[236:239], a[160:163], a[232:235], v[236:239]
    s_mov_b32 vcc_hi, 0xff00ff00
    v_cndmask_b32 v244, v210, v209, vcc
    v_add_u32 v245, 0x700, v244
    v_mfma_f32_16x16x32_bf16 v[228:231], a[172:175], a[220:223], v[228:231]
    s_mov_b32 vcc_lo, 0xf0f0
    s_waitcnt lgkmcnt(1)
    v_cvt_pk_bf16_f32 v194, v200, v201
    v_mfma_f32_16x16x32_bf16 v[236:239], a[164:167], a[236:239], v[236:239]
    s_mov_b32 vcc_hi, 0x0
    v_exp_f32 v202, v202
    v_mfma_f32_16x16x32_bf16 v[228:231], a[176:179], a[224:227], v[228:231]
    v_exp_f32 v203, v203
    v_mfma_f32_16x16x32_bf16 v[228:231], a[180:183], a[228:231], v[228:231]
    v_cvt_pk_bf16_f32 v181, v202, v203
    v_cndmask_b32 v244, v244, v208, vcc
    v_mfma_f32_16x16x32_bf16 v[228:231], a[184:187], a[232:235], v[228:231]
    s_mov_b32 vcc_lo, 0x0
    v_exp_f32 v204, v204
    v_mfma_f32_16x16x32_bf16 v[228:231], a[188:191], a[236:239], v[228:231]
    s_mov_b32 vcc_hi, 0xf0f0000
    v_exp_f32 v205, v205
    v_mfma_f32_16x16x32_bf16 v[232:235], a[192:195], a[216:219], 0
    ds_read_b128 v[200:203], v244 offset:64
    v_cvt_pk_bf16_f32 v195, v204, v205
    v_mfma_f32_16x16x32_bf16 v[232:235], a[196:199], a[220:223], v[232:235]
    ds_read_b128 a[240:243], v242 offset:24576
    v_cndmask_b32 v245, v245, v208, vcc
    v_mfma_f32_16x16x32_bf16 v[212:215], v[22:25], v[192:195], v[212:215]
    ds_read_b128 v[208:211], v244 offset:0
    v_cvt_pk_bf16_f32 v236, v236, v237
    v_mfma_f32_16x16x32_bf16 v[216:219], v[52:55], v[192:195], v[216:219]
    s_mov_b32 vcc_lo, 0xff000f
    v_exp_f32 v196, v196
    v_mfma_f32_16x16x32_bf16 v[220:223], v[82:85], v[192:195], v[220:223]
    s_mov_b32 vcc_hi, 0xff00ff
    v_exp_f32 v197, v197
    v_mfma_f32_16x16x32_bf16 v[224:227], a[248:251], v[192:195], v[224:227]
    v_exp_f32 v198, v198
    v_mfma_f32_16x16x32_bf16 v[232:235], a[200:203], a[224:227], v[232:235]
    v_exp_f32 v199, v199
    v_mfma_f32_16x16x32_bf16 v[232:235], a[204:207], a[228:231], v[232:235]
    v_cvt_pk_bf16_f32 v180, v196, v197
    v_cvt_pk_bf16_f32 v183, v198, v199
    v_mfma_f32_16x16x32_bf16 v[232:235], a[208:211], a[232:235], v[232:235]
    v_exp_f32 v206, v206
    v_mfma_f32_16x16x32_bf16 v[232:235], a[212:215], a[236:239], v[232:235]
    s_waitcnt lgkmcnt(2)
    v_exp_f32 v207, v207
    v_mfma_f32_16x16x32_bf16 v[200:203], v[96:99], v[168:171], v[200:203]
    ds_read_b128 v[196:199], v245 offset:0
    v_cvt_pk_bf16_f32 v182, v206, v207
    v_mfma_f32_16x16x32_bf16 v[200:203], v[98:101], v[170:173], v[200:203]
    s_waitcnt lgkmcnt(1)
    ds_read_b128 v[204:207], v245 offset:64
    v_mfma_f32_16x16x32_bf16 v[212:215], v[26:29], v[180:183], v[212:215]
    ds_read_b128 a[244:247], v243 offset:24576
    ds_read_b128 a[216:219], v242 offset:24704
    v_mfma_f32_16x16x32_bf16 v[216:219], v[56:59], v[180:183], v[216:219]
    ds_read_b128 a[220:223], v243 offset:24704
    ds_read_b128 a[224:227], v242 offset:24832
    v_mfma_f32_16x16x32_bf16 v[220:223], v[86:89], v[180:183], v[220:223]
    ds_read_b128 a[228:231], v243 offset:24832
    v_cvt_pk_bf16_f32 v237, v238, v239
    v_mfma_f32_16x16x32_bf16 v[224:227], a[248:251], v[180:183], v[224:227]
    ds_write_b64 v249, v[236:237] offset:6144
    v_mfma_f32_16x16x32_bf16 v[208:211], v[90:93], v[168:171], v[208:211]
    v_cvt_pk_bf16_f32 v228, v228, v229
    v_cvt_pk_bf16_f32 v229, v230, v231
    v_mfma_f32_16x16x32_bf16 v[208:211], v[92:95], v[170:173], v[208:211]
    ds_write_b64 v249, v[228:229] offset:6272
    v_mfma_f32_16x16x32_bf16 v[236:239], a[144:147], a[240:243], 0
    s_waitcnt lgkmcnt(8)
    v_cvt_pk_bf16_f32 v232, v232, v233
    v_cvt_pk_bf16_f32 v233, v234, v235
    v_mfma_f32_16x16x32_bf16 v[196:199], v[126:129], v[168:171], v[196:199]
    s_waitcnt lgkmcnt(7)
    v_rcp_f32 v225, v224
    v_mfma_f32_16x16x32_bf16 v[196:199], v[128:131], v[170:173], v[196:199]
    s_waitcnt lgkmcnt(6)
    v_exp_f32 v208, v208
    v_mfma_f32_16x16x32_bf16 v[204:207], v[132:135], v[168:171], v[204:207]
    v_exp_f32 v209, v209
    v_mfma_f32_16x16x32_bf16 v[204:207], v[134:137], v[170:173], v[204:207]
    v_exp_f32 v210, v210
    v_mfma_f32_16x16x32_bf16 v[236:239], a[148:151], a[244:247], v[236:239]
    s_waitcnt lgkmcnt(5)
    v_exp_f32 v211, v211
    v_mfma_f32_16x16x32_bf16 v[236:239], a[152:155], a[216:219], v[236:239]
    s_waitcnt lgkmcnt(4)
    v_cvt_pk_bf16_f32 v184, v208, v209
    v_cvt_pk_bf16_f32 v187, v210, v211
    v_mfma_f32_16x16x32_bf16 v[236:239], a[156:159], a[220:223], v[236:239]
    s_waitcnt lgkmcnt(3)
    v_exp_f32 v196, v196
    v_mfma_f32_16x16x32_bf16 v[236:239], a[160:163], a[224:227], v[236:239]
    s_waitcnt lgkmcnt(2)
    ds_read_b128 v[208:211], v244 offset:128
    v_mfma_f32_16x16x32_bf16 v[236:239], a[164:167], a[228:231], v[236:239]
    ds_write_b64 v249, v[232:233] offset:6400
    v_mfma_f32_16x16x32_bf16 v[228:231], a[168:171], a[240:243], 0
    v_exp_f32 v197, v197
    v_mfma_f32_16x16x32_bf16 v[228:231], a[172:175], a[244:247], v[228:231]
    v_mul_f32 v212, v212, v225
    v_mul_f32 v213, v213, v225
    v_mfma_f32_16x16x32_bf16 v[228:231], a[176:179], a[216:219], v[228:231]
    v_cvt_pk_bf16_f32 v185, v196, v197
    v_mul_f32 v214, v214, v225
    v_mfma_f32_16x16x32_bf16 v[228:231], a[180:183], a[220:223], v[228:231]
    v_mul_f32 v215, v215, v225
    v_cvt_pk_bf16_f32 v212, v212, v213
    v_mfma_f32_16x16x32_bf16 v[228:231], a[184:187], a[224:227], v[228:231]
    v_cvt_pk_bf16_f32 v213, v214, v215
    v_mul_f32 v216, v216, v225
    v_mfma_f32_16x16x32_bf16 v[228:231], a[188:191], a[228:231], v[228:231]
    ds_write_b64 v247, v[212:213] offset:43008
    v_mfma_f32_16x16x32_bf16 v[212:215], v[0:3], v[184:187], 0
    v_mul_f32 v217, v217, v225
    v_mul_f32 v218, v218, v225
    v_mfma_f32_16x16x32_bf16 v[232:235], a[192:195], a[240:243], 0
    v_mul_f32 v219, v219, v225
    v_cvt_pk_bf16_f32 v216, v216, v217
    v_mfma_f32_16x16x32_bf16 v[232:235], a[196:199], a[244:247], v[232:235]
    ds_read_b128 a[232:235], v242 offset:30720
    v_cvt_pk_bf16_f32 v217, v218, v219
    v_mfma_f32_16x16x32_bf16 v[232:235], a[200:203], a[216:219], v[232:235]
    ds_write_b64 v247, v[216:217] offset:43136
    v_mfma_f32_16x16x32_bf16 v[216:219], v[30:33], v[184:187], 0
    s_waitcnt lgkmcnt(4)
    v_mul_f32 v220, v220, v225
    v_mul_f32 v221, v221, v225
    v_mfma_f32_16x16x32_bf16 v[208:211], v[138:141], v[168:171], v[208:211]
    v_mul_f32 v222, v222, v225
    v_mul_f32 v223, v223, v225
    v_mfma_f32_16x16x32_bf16 v[208:211], v[140:143], v[170:173], v[208:211]
    ds_read_b128 a[236:239], v243 offset:30720
    v_cvt_pk_bf16_f32 v220, v220, v221
    v_mfma_f32_16x16x32_bf16 v[232:235], a[204:207], a[220:223], v[232:235]
    ds_read_b128 a[240:243], v242 offset:30848
    v_cvt_pk_bf16_f32 v221, v222, v223
    v_mfma_f32_16x16x32_bf16 v[232:235], a[208:211], a[224:227], v[232:235]
    ds_write_b64 v247, v[220:221] offset:43264
    v_mfma_f32_16x16x32_bf16 v[220:223], v[60:63], v[184:187], 0
    ds_read_b128 a[244:247], v243 offset:30848
    v_max3_f32 v248, v248, v224, v225
    v_mfma_f32_16x16x32_bf16 v[224:227], a[248:251], v[184:187], 0
    v_exp_f32 v198, v198
    v_mfma_f32_16x16x32_bf16 v[232:235], a[212:215], a[228:231], v[232:235]
    v_exp_f32 v199, v199
    ds_read_b128 a[216:219], v242 offset:30976
    v_cvt_pk_bf16_f32 v188, v198, v199
    ds_read_b128 v[196:199], v245 offset:128
    ds_read_b128 a[220:223], v243 offset:30976
    v_cvt_pk_bf16_f32 v236, v236, v237
    v_cvt_pk_bf16_f32 v237, v238, v239
    ds_write_b64 v249, v[236:237] offset:12288
    s_waitcnt lgkmcnt(9)
    v_mfma_f32_16x16x32_bf16 v[236:239], a[144:147], a[232:235], 0
    s_waitcnt lgkmcnt(7)
    v_cvt_pk_bf16_f32 v228, v228, v229
    v_cvt_pk_bf16_f32 v229, v230, v231
    v_mfma_f32_16x16x32_bf16 v[236:239], a[148:151], a[236:239], v[236:239]
    s_waitcnt lgkmcnt(6)
    v_exp_f32 v200, v200
    v_mfma_f32_16x16x32_bf16 v[236:239], a[152:155], a[240:243], v[236:239]
    s_waitcnt lgkmcnt(4)
    v_exp_f32 v201, v201
    v_mfma_f32_16x16x32_bf16 v[236:239], a[156:159], a[244:247], v[236:239]
    ds_write_b64 v249, v[228:229] offset:12416
    v_mfma_f32_16x16x32_bf16 v[228:231], a[168:171], a[232:235], 0
    s_waitcnt lgkmcnt(4)
    v_exp_f32 v202, v202
    v_mfma_f32_16x16x32_bf16 v[236:239], a[160:163], a[216:219], v[236:239]
    s_waitcnt lgkmcnt(3)
    v_exp_f32 v203, v203
    v_mfma_f32_16x16x32_bf16 v[196:199], v[144:147], v[168:171], v[196:199]
    s_waitcnt lgkmcnt(2)
    v_cvt_pk_bf16_f32 v190, v200, v201
    v_cvt_pk_bf16_f32 v193, v202, v203
    v_mfma_f32_16x16x32_bf16 v[196:199], v[146:149], v[170:173], v[196:199]
    v_exp_f32 v204, v204
    v_mfma_f32_16x16x32_bf16 v[236:239], a[164:167], a[220:223], v[236:239]
    v_exp_f32 v205, v205
    v_mfma_f32_16x16x32_bf16 v[228:231], a[172:175], a[236:239], v[228:231]
    ds_read_b128 v[200:203], v244 offset:192
    v_cvt_pk_bf16_f32 v191, v204, v205
    v_mfma_f32_16x16x32_bf16 v[228:231], a[176:179], a[240:243], v[228:231]
    v_mov_b32 v189, 0
    v_mov_b32 v192, 0
    v_mfma_f32_16x16x32_bf16 v[228:231], a[180:183], a[244:247], v[228:231]
    v_exp_f32 v206, v206
    v_mfma_f32_16x16x32_bf16 v[212:215], v[4:7], v[188:191], v[212:215]
    v_exp_f32 v207, v207
    v_mfma_f32_16x16x32_bf16 v[216:219], v[34:37], v[188:191], v[216:219]
    v_cvt_pk_bf16_f32 v194, v206, v207
    v_mov_b32 v195, 0
    v_mfma_f32_16x16x32_bf16 v[220:223], v[64:67], v[188:191], v[220:223]
    ds_read_b128 v[204:207], v245 offset:192
    v_cvt_pk_bf16_f32 v232, v232, v233
    v_mfma_f32_16x16x32_bf16 v[224:227], a[248:251], v[188:191], v[224:227]
    buffer_store_dwordx4 a[252:255], v250, s[20:23], s53 offen nt
    v_mfma_f32_16x16x32_bf16 v[212:215], v[8:11], v[192:195], v[212:215]
    v_cvt_pk_bf16_f32 v233, v234, v235
    v_mov_b32 v182, 0
    v_mfma_f32_16x16x32_bf16 v[216:219], v[38:41], v[192:195], v[216:219]
    ds_read_b128 a[252:255], v252 offset:18432
    s_waitcnt lgkmcnt(2)
    v_mfma_f32_16x16x32_bf16 v[220:223], v[68:71], v[192:195], v[220:223]
    buffer_store_dwordx2 v[254:255], v251, s[20:23], s53 offen offset:256 nt
    v_mfma_f32_16x16x32_bf16 v[224:227], a[248:251], v[192:195], v[224:227]
    ds_read_b64 v[254:255], v253 offset:18688
    v_mov_b32 v185, 0
    v_mfma_f32_16x16x32_bf16 v[200:203], v[114:117], v[168:171], v[200:203]
    ds_write_b64 v249, v[232:233] offset:12544
    v_mfma_f32_16x16x32_bf16 v[200:203], v[116:119], v[170:173], v[200:203]
    s_waitcnt lgkmcnt(3)
    v_exp_f32 v208, v208
    v_mfma_f32_16x16x32_bf16 v[204:207], v[150:153], v[168:171], v[204:207]
    s_mul_i32 s53, s31, 11
    v_exp_f32 v209, v209
    v_mfma_f32_16x16x32_bf16 v[204:207], v[152:155], v[170:173], v[204:207]
    s_add_u32 s52, s52, s53
    v_exp_f32 v210, v210
    v_mfma_f32_16x16x32_bf16 v[228:231], a[184:187], a[216:219], v[228:231]
    s_add_u32 s52, s52, s32
    v_exp_f32 v211, v211
    v_mfma_f32_16x16x32_bf16 v[228:231], a[188:191], a[220:223], v[228:231]
    s_waitcnt lgkmcnt(2)
    v_exp_f32 v196, v196
    v_mfma_f32_16x16x32_bf16 v[232:235], a[192:195], a[232:235], 0
    buffer_store_dwordx4 a[252:255], v250, s[20:23], s55 offen nt
    v_mfma_f32_16x16x32_bf16 v[232:235], a[196:199], a[236:239], v[232:235]
    s_waitcnt lgkmcnt(1)
    ds_read_b128 a[252:255], v252 offset:24576
    v_mfma_f32_16x16x32_bf16 v[232:235], a[200:203], a[240:243], v[232:235]
    s_add_u32 s53, s28, 11
    v_exp_f32 v197, v197
    v_mfma_f32_16x16x32_bf16 v[232:235], a[204:207], a[244:247], v[232:235]
    buffer_store_dwordx2 v[254:255], v251, s[20:23], s55 offen offset:256 nt
    v_mfma_f32_16x16x32_bf16 v[232:235], a[208:211], a[216:219], v[232:235]
    ds_read_b64 v[254:255], v253 offset:24832
    v_cvt_pk_bf16_f32 v180, v208, v209
    v_mfma_f32_16x16x32_bf16 v[232:235], a[212:215], a[220:223], v[232:235]
    v_cvt_pk_bf16_f32 v183, v210, v211
    v_cvt_pk_bf16_f32 v181, v196, v197
    v_exp_f32 v200, v200
    v_exp_f32 v201, v201
    v_mfma_f32_16x16x32_bf16 v[212:215], v[12:15], v[180:183], v[212:215]
    s_mul_i32 s55, s31, 15
    v_add_u32 v208, 0xffffff40, v244
    v_cvt_pk_bf16_f32 v186, v200, v201
    v_mfma_f32_16x16x32_bf16 v[216:219], v[42:45], v[180:183], v[216:219]
    ds_read_b64 v[174:175], v247 offset:55296
    v_cndmask_b32 v244, v244, v208, vcc
    v_mfma_f32_16x16x32_bf16 v[220:223], v[72:75], v[180:183], v[220:223]
    ds_read_b64 v[176:177], v247 offset:55424
    ds_read_b128 v[200:203], v244 offset:64
    v_mfma_f32_16x16x32_bf16 v[224:227], a[248:251], v[180:183], v[224:227]
    ds_read_b64 v[178:179], v247 offset:55552
    s_mov_b32 vcc_lo, 0xff00ff
    v_add_u32 v209, 0xffffff40, v245
    s_mov_b32 vcc_hi, 0xf000ff
    v_cndmask_b32 v245, v245, v209, vcc
    ds_read_b128 v[208:211], v244 offset:0
    s_waitcnt lgkmcnt(5)
    s_barrier
    v_exp_f32 v198, v198
    v_exp_f32 v199, v199
    v_exp_f32 v204, v204
    v_exp_f32 v205, v205
    ds_read_b128 a[224:227], v242 offset:36864
    v_cvt_pk_bf16_f32 v184, v198, v199
    v_cvt_pk_bf16_f32 v187, v204, v205
    ds_read_b128 v[196:199], v245 offset:0
    ds_read_b128 v[204:207], v245 offset:64
    v_mfma_f32_16x16x32_bf16 v[212:215], v[16:19], v[184:187], v[212:215]
    ds_read_b128 a[228:231], v243 offset:36864
    ds_read_b128 a[232:235], v242 offset:36992
    v_mfma_f32_16x16x32_bf16 v[216:219], v[46:49], v[184:187], v[216:219]
    s_waitcnt lgkmcnt(7)
    ds_read_b128 a[236:239], v243 offset:36992
    v_mfma_f32_16x16x32_bf16 v[220:223], v[76:79], v[184:187], v[220:223]
    ds_read_b128 a[240:243], v242 offset:37120
    v_cvt_pk_bf16_f32 v236, v236, v237
    v_mfma_f32_16x16x32_bf16 v[224:227], a[248:251], v[184:187], v[224:227]
    s_waitcnt lgkmcnt(7)
    v_cvt_pk_bf16_f32 v237, v238, v239
    v_cvt_pk_bf16_f32 v228, v228, v229
    v_mfma_f32_16x16x32_bf16 v[208:211], v[138:141], v[174:177], v[208:211]
    ds_read_b128 a[244:247], v243 offset:37120
    v_cvt_pk_bf16_f32 v229, v230, v231
    v_mfma_f32_16x16x32_bf16 v[208:211], v[140:143], v[176:179], v[208:211]
    ds_write_b64 v249, v[236:237] offset:18432
    v_mfma_f32_16x16x32_bf16 v[200:203], v[114:117], v[174:177], v[200:203]
    s_waitcnt lgkmcnt(8)
    v_cvt_pk_bf16_f32 v232, v232, v233
    v_cvt_pk_bf16_f32 v233, v234, v235
    v_mfma_f32_16x16x32_bf16 v[200:203], v[116:119], v[176:179], v[200:203]
    s_waitcnt lgkmcnt(7)
    v_rcp_f32 v225, v224
    v_mfma_f32_16x16x32_bf16 v[196:199], v[144:147], v[174:177], v[196:199]
    s_waitcnt lgkmcnt(6)
    v_exp_f32 v208, v208
    v_mfma_f32_16x16x32_bf16 v[196:199], v[146:149], v[176:179], v[196:199]
    buffer_store_dwordx4 a[252:255], v250, s[20:23], s57 offen nt
    v_mfma_f32_16x16x32_bf16 v[204:207], v[150:153], v[174:177], v[204:207]
    ds_write_b64 v249, v[228:229] offset:18560
    v_mfma_f32_16x16x32_bf16 v[204:207], v[152:155], v[176:179], v[204:207]
    ds_read_b128 a[252:255], v252 offset:0
    v_mul_f32 v212, v212, v225
    v_mfma_f32_16x16x32_bf16 v[236:239], a[144:147], a[224:227], 0
    s_waitcnt lgkmcnt(7)
    v_exp_f32 v209, v209
    v_mfma_f32_16x16x32_bf16 v[236:239], a[148:151], a[228:231], v[236:239]
    s_waitcnt lgkmcnt(6)
    v_exp_f32 v210, v210
    v_mfma_f32_16x16x32_bf16 v[236:239], a[152:155], a[232:235], v[236:239]
    s_waitcnt lgkmcnt(5)
    v_exp_f32 v211, v211
    v_mfma_f32_16x16x32_bf16 v[236:239], a[156:159], a[236:239], v[236:239]
    s_waitcnt lgkmcnt(4)
    v_cvt_pk_bf16_f32 v188, v208, v209
    v_cvt_pk_bf16_f32 v191, v210, v211
    v_mfma_f32_16x16x32_bf16 v[236:239], a[160:163], a[240:243], v[236:239]
    s_waitcnt lgkmcnt(3)
    ds_read_b128 a[216:219], v242 offset:43008
    v_mfma_f32_16x16x32_bf16 v[236:239], a[164:167], a[244:247], v[236:239]
    buffer_store_dwordx2 v[254:255], v251, s[20:23], s57 offen offset:256 nt
    v_mfma_f32_16x16x32_bf16 v[228:231], a[168:171], a[224:227], 0
    ds_read_b64 v[254:255], v253 offset:256
    ds_read_b128 a[220:223], v243 offset:43008
    v_mfma_f32_16x16x32_bf16 v[228:231], a[172:175], a[228:231], v[228:231]
    ds_write_b64 v249, v[232:233] offset:18688
    v_mfma_f32_16x16x32_bf16 v[228:231], a[176:179], a[232:235], v[228:231]
    ds_read_b128 v[208:211], v244 offset:128
    v_cvt_pk_bf16_f32 v236, v236, v237
    v_mfma_f32_16x16x32_bf16 v[228:231], a[180:183], a[236:239], v[228:231]
    s_mul_i32 s57, s31, 13
    v_cvt_pk_bf16_f32 v237, v238, v239
    v_mul_f32 v213, v213, v225
    v_mfma_f32_16x16x32_bf16 v[228:231], a[184:187], a[240:243], v[228:231]
    ds_write_b64 v249, v[236:237] offset:24576
    v_mfma_f32_16x16x32_bf16 v[228:231], a[188:191], a[244:247], v[228:231]
    s_waitcnt lgkmcnt(6)
    v_mul_f32 v214, v214, v225
    v_mul_f32 v215, v215, v225
    v_mfma_f32_16x16x32_bf16 v[232:235], a[192:195], a[224:227], 0
    ds_read_b128 a[224:227], v242 offset:43136
    v_cvt_pk_bf16_f32 v212, v212, v213
    v_mfma_f32_16x16x32_bf16 v[232:235], a[196:199], a[228:231], v[232:235]
    buffer_store_dwordx4 a[252:255], v250, s[20:23], s52 offen nt
    v_mfma_f32_16x16x32_bf16 v[232:235], a[200:203], a[232:235], v[232:235]
    ds_read_b128 a[228:231], v243 offset:43136
    ds_read_b128 a[252:255], v252 offset:6144
    v_mfma_f32_16x16x32_bf16 v[232:235], a[204:207], a[236:239], v[232:235]
    ds_read_b128 a[232:235], v242 offset:43264
    s_waitcnt lgkmcnt(8)
    v_mfma_f32_16x16x32_bf16 v[232:235], a[208:211], a[240:243], v[232:235]
    buffer_store_dwordx2 v[254:255], v251, s[20:23], s52 offen offset:256 nt
    v_mfma_f32_16x16x32_bf16 v[232:235], a[212:215], a[244:247], v[232:235]
    ds_read_b64 v[254:255], v253 offset:6400
    ds_read_b128 a[236:239], v243 offset:43264
    v_mfma_f32_16x16x32_bf16 v[236:239], a[144:147], a[216:219], 0
    s_waitcnt lgkmcnt(7)
    v_cvt_pk_bf16_f32 v228, v228, v229
    v_cvt_pk_bf16_f32 v229, v230, v231
    v_mfma_f32_16x16x32_bf16 v[208:211], v[120:123], v[174:177], v[208:211]
    ds_write_b64 v249, v[228:229] offset:24704
    v_mfma_f32_16x16x32_bf16 v[208:211], v[122:125], v[176:179], v[208:211]
    s_add_u32 s54, s54, s55
    s_add_u32 s56, s56, s57
    s_add_u32 s54, s54, s32
    v_mfma_f32_16x16x32_bf16 v[236:239], a[148:151], a[220:223], v[236:239]
    s_waitcnt lgkmcnt(6)
    s_add_u32 s56, s56, s32
    v_mul_f32 v216, v216, v225
    v_mfma_f32_16x16x32_bf16 v[236:239], a[152:155], a[224:227], v[236:239]
    s_waitcnt lgkmcnt(5)
    v_mul_f32 v217, v217, v225
    s_waitcnt lgkmcnt(4)
    v_mfma_f32_16x16x32_bf16 v[236:239], a[156:159], a[228:231], v[236:239]
    s_mov_b32 exec_hi, 0
    buffer_store_dwordx4 a[252:255], v250, s[20:23], s54 offen nt
    s_mov_b32 exec_hi, -1
    v_mfma_f32_16x16x32_bf16 v[228:231], a[168:171], a[216:219], 0
    s_waitcnt lgkmcnt(3)
    v_cvt_pk_bf16_f32 v213, v214, v215
    v_mul_f32 v218, v218, v225
    v_mfma_f32_16x16x32_bf16 v[236:239], a[160:163], a[232:235], v[236:239]
    s_waitcnt lgkmcnt(2)
    s_waitcnt lgkmcnt(1)
    v_mul_f32 v219, v219, v225
    v_mfma_f32_16x16x32_bf16 v[236:239], a[164:167], a[236:239], v[236:239]
    s_mov_b32 exec_lo, 0
    buffer_store_dwordx4 a[252:255], v250, s[20:23], s56 offen nt
    s_mov_b32 exec_lo, -1
    v_mfma_f32_16x16x32_bf16 v[228:231], a[172:175], a[220:223], v[228:231]
    s_mul_i32 s52, s31, 3
    v_cvt_pk_bf16_f32 v216, v216, v217
    v_mul_f32 v220, v220, v225
    v_mfma_f32_16x16x32_bf16 v[228:231], a[176:179], a[224:227], v[228:231]
    s_add_u32 s51, s51, s52
    v_mul_f32 v221, v221, v225
    v_cvt_pk_bf16_f32 v217, v218, v219
    v_mfma_f32_16x16x32_bf16 v[228:231], a[180:183], a[228:231], v[228:231]
    ds_write_b64 v247, v[212:213] offset:49152
    v_mfma_f32_16x16x32_bf16 v[228:231], a[184:187], a[232:235], v[228:231]
    s_add_u32 s51, s51, s32
    v_mul_f32 v222, v222, v225
    v_mul_f32 v223, v223, v225
    v_mfma_f32_16x16x32_bf16 v[228:231], a[188:191], a[236:239], v[228:231]
    v_cvt_pk_bf16_f32 v220, v220, v221
    v_cvt_pk_bf16_f32 v232, v232, v233
    ds_write_b64 v247, v[216:217] offset:49280
    v_cvt_pk_bf16_f32 v221, v222, v223
    s_mov_b32 exec_hi, 0
    buffer_store_dwordx2 v[254:255], v251, s[20:23], s54 offen offset:256 nt
    s_mov_b32 exec_hi, -1
    v_cvt_pk_bf16_f32 v233, v234, v235
    ds_write_b64 v247, v[220:221] offset:49408
    ds_read_b128 a[252:255], v252 offset:12288
    ds_write_b64 v249, v[232:233] offset:24832
    v_mfma_f32_16x16x32_bf16 v[232:235], a[192:195], a[216:219], 0
    s_mov_b32 exec_lo, 0
    buffer_store_dwordx2 v[254:255], v251, s[20:23], s56 offen offset:256 nt
    s_mov_b32 exec_lo, -1
    v_mfma_f32_16x16x32_bf16 v[232:235], a[196:199], a[220:223], v[232:235]
    ds_read_b64 v[254:255], v253 offset:12544
    v_mov_b32 v190, 0
    v_mfma_f32_16x16x32_bf16 v[232:235], a[200:203], a[224:227], v[232:235]
    s_mul_i32 s54, s31, 7
    v_exp_f32 v196, v196
    v_mfma_f32_16x16x32_bf16 v[232:235], a[204:207], a[228:231], v[232:235]
    s_mul_i32 s53, s53, s30
    v_exp_f32 v197, v197
    v_mfma_f32_16x16x32_bf16 v[232:235], a[208:211], a[232:235], v[232:235]
    s_add_u32 s53, s53, s54
    v_exp_f32 v198, v198
    v_mfma_f32_16x16x32_bf16 v[232:235], a[212:215], a[236:239], v[232:235]
    v_exp_f32 v199, v199
    v_cvt_pk_bf16_f32 v189, v196, v197
    v_cvt_pk_bf16_f32 v192, v198, v199
    ds_read_b128 v[196:199], v245 offset:128
    v_mfma_f32_16x16x32_bf16 v[212:215], v[12:15], v[188:191], 0
    s_add_u32 s53, s53, s32
    v_max3_f32 v248, v248, v224, v225
    v_cvt_pk_bf16_f32 v236, v236, v237
    v_mfma_f32_16x16x32_bf16 v[216:219], v[42:45], v[188:191], 0
    s_waitcnt lgkmcnt(2)
    s_barrier
    v_cvt_pk_bf16_f32 v237, v238, v239
    v_mfma_f32_16x16x32_bf16 v[220:223], v[72:75], v[188:191], 0
    ds_read_b128 a[240:243], v242 offset:49152
    ds_read_b128 a[244:247], v243 offset:49152
    v_mfma_f32_16x16x32_bf16 v[224:227], a[248:251], v[188:191], 0
    ds_read_b128 a[216:219], v242 offset:49280
    ds_read_b128 a[220:223], v243 offset:49280
    ds_read_b128 a[224:227], v242 offset:49408
    ds_read_b128 a[228:231], v243 offset:49408
    ds_write_b64 v249, v[236:237] offset:0
    buffer_store_dwordx4 a[252:255], v250, s[20:23], s51 offen nt
    v_cvt_pk_bf16_f32 v228, v228, v229
    v_cvt_pk_bf16_f32 v229, v230, v231
    v_exp_f32 v200, v200
    s_waitcnt lgkmcnt(7)
    v_mfma_f32_16x16x32_bf16 v[196:199], v[156:159], v[174:177], v[196:199]
    s_add_u32 s55, s28, 11
    v_exp_f32 v201, v201
    v_mfma_f32_16x16x32_bf16 v[196:199], v[158:161], v[176:179], v[196:199]
    v_exp_f32 v204, v204
    v_exp_f32 v205, v205
    s_waitcnt lgkmcnt(6)
    v_mfma_f32_16x16x32_bf16 v[236:239], a[144:147], a[240:243], 0
    ds_read_b128 a[252:255], v252 offset:18432
    s_waitcnt lgkmcnt(6)
    v_mfma_f32_16x16x32_bf16 v[236:239], a[148:151], a[244:247], v[236:239]
    ds_write_b64 v249, v[228:229] offset:128
    v_mfma_f32_16x16x32_bf16 v[228:231], a[168:171], a[240:243], 0
    s_waitcnt lgkmcnt(6)
    v_exp_f32 v202, v202
    v_mfma_f32_16x16x32_bf16 v[236:239], a[152:155], a[216:219], v[236:239]
    s_waitcnt lgkmcnt(5)
    v_exp_f32 v203, v203
    v_mfma_f32_16x16x32_bf16 v[236:239], a[156:159], a[220:223], v[236:239]
    s_waitcnt lgkmcnt(4)
    v_cvt_pk_bf16_f32 v194, v200, v201
    v_cvt_pk_bf16_f32 v195, v204, v205
    v_mfma_f32_16x16x32_bf16 v[236:239], a[160:163], a[224:227], v[236:239]
    s_waitcnt lgkmcnt(3)
    v_exp_f32 v206, v206
    v_mfma_f32_16x16x32_bf16 v[236:239], a[164:167], a[228:231], v[236:239]
    s_mul_i32 s56, s31, 11
    v_exp_f32 v207, v207
    v_mfma_f32_16x16x32_bf16 v[228:231], a[172:175], a[244:247], v[228:231]
    s_mul_i32 s55, s55, s30
    v_mov_b32 v193, 0
    v_cvt_pk_bf16_f32 v181, v202, v203
    v_mfma_f32_16x16x32_bf16 v[228:231], a[176:179], a[216:219], v[228:231]
    s_waitcnt lgkmcnt(1)
    v_exp_f32 v208, v208
    v_mfma_f32_16x16x32_bf16 v[212:215], v[16:19], v[192:195], v[212:215]
    s_add_u32 s55, s55, s56
    v_exp_f32 v209, v209
    v_mfma_f32_16x16x32_bf16 v[216:219], v[46:49], v[192:195], v[216:219]
    s_add_u32 s55, s55, s32
    v_exp_f32 v210, v210
    v_mfma_f32_16x16x32_bf16 v[220:223], v[76:79], v[192:195], v[220:223]
    s_add_u32 s57, s28, 11
    v_exp_f32 v211, v211
    v_mfma_f32_16x16x32_bf16 v[224:227], a[248:251], v[192:195], v[224:227]
    s_mul_i32 s57, s57, s30
    v_exp_f32 v196, v196
    v_mfma_f32_16x16x32_bf16 v[228:231], a[180:183], a[220:223], v[228:231]
    s_and_b32 s52, s28, 1
    v_exp_f32 v197, v197
    v_mfma_f32_16x16x32_bf16 v[228:231], a[184:187], a[224:227], v[228:231]
    s_add_u32 s52, s52, 15
    v_exp_f32 v198, v198
    v_mfma_f32_16x16x32_bf16 v[228:231], a[188:191], a[228:231], v[228:231]
    v_exp_f32 v199, v199
    v_cvt_pk_bf16_f32 v182, v206, v207
    v_mov_b32 v180, 0
    v_mov_b32 v183, 0
    v_cvt_pk_bf16_f32 v184, v208, v209
    v_cvt_pk_bf16_f32 v187, v210, v211
    v_mfma_f32_16x16x32_bf16 v[212:215], v[20:23], v[180:183], v[212:215]
    s_mul_i32 s52, s52, s30
    v_cvt_pk_bf16_f32 v185, v196, v197
    v_mov_b32 v186, 0
    v_mfma_f32_16x16x32_bf16 v[216:219], v[50:53], v[180:183], v[216:219]
    s_lshr_b32 s56, s28, 1
    v_cvt_pk_bf16_f32 v188, v198, v199
L_h9:
    s_cbranch_execz L_hback
    v_mov_b32 v189, 0
    v_mfma_f32_16x16x32_bf16 v[220:223], v[80:83], v[180:183], v[220:223]
    s_lshl2_add_u32 s56, s56, 11
    v_mov_b32 v191, 0
    v_cvt_pk_bf16_f32 v232, v232, v233
    v_mfma_f32_16x16x32_bf16 v[224:227], a[248:251], v[180:183], v[224:227]
    buffer_store_dwordx2 v[254:255], v251, s[20:23], s51 offen offset:256 nt
    v_mfma_f32_16x16x32_bf16 v[212:215], v[24:27], v[184:187], v[212:215]
    ds_read_b64 v[254:255], v253 offset:18688
    v_cvt_pk_bf16_f32 v233, v234, v235
    v_mfma_f32_16x16x32_bf16 v[216:219], v[54:57], v[184:187], v[216:219]
    ds_write_b64 v249, v[232:233] offset:256
    v_mfma_f32_16x16x32_bf16 v[220:223], v[84:87], v[184:187], v[220:223]
    s_mul_i32 s51, s31, 15
    v_cvt_pk_bf16_f32 v236, v236, v237
    v_cvt_pk_bf16_f32 v228, v228, v229
    v_mfma_f32_16x16x32_bf16 v[224:227], a[248:251], v[184:187], v[224:227]
    s_add_u32 s57, s57, s51
    v_cvt_pk_bf16_f32 v237, v238, v239
    v_cvt_pk_bf16_f32 v229, v230, v231
    v_mfma_f32_16x16x32_bf16 v[212:215], v[28:31], v[188:191], v[212:215]
    ds_write_b64 v249, v[236:237] offset:6144
    v_mfma_f32_16x16x32_bf16 v[216:219], v[58:61], v[188:191], v[216:219]
    ds_write_b64 v249, v[228:229] offset:6272
    v_mfma_f32_16x16x32_bf16 v[220:223], v[88:91], v[188:191], v[220:223]
    buffer_store_dwordx4 a[252:255], v250, s[20:23], s53 offen nt
    v_mfma_f32_16x16x32_bf16 v[224:227], a[248:251], v[188:191], v[224:227]
    s_waitcnt lgkmcnt(3)
    ds_read_b128 a[252:255], v252 offset:24576
    v_mfma_f32_16x16x32_bf16 v[232:235], a[192:195], a[240:243], 0
    s_add_u32 s57, s57, s32
    s_mul_i32 s56, s56, s31
    s_lshr_b32 s54, s28, 1
    v_mfma_f32_16x16x32_bf16 v[232:235], a[196:199], a[244:247], v[232:235]
    buffer_store_dwordx2 v[254:255], v251, s[20:23], s53 offen offset:256 nt
    v_mfma_f32_16x16x32_bf16 v[232:235], a[200:203], a[216:219], v[232:235]
    s_lshr_b32 s53, s28, 1
    v_rcp_f32 v225, v224
    v_mfma_f32_16x16x32_bf16 v[232:235], a[204:207], a[220:223], v[232:235]
    s_lshl2_add_u32 s53, s53, 3
    v_max3_f32 v248, v248, v224, v225
    v_mov_b32 v226, 0x5d800000
    v_mfma_f32_16x16x32_bf16 v[232:235], a[208:211], a[224:227], v[232:235]
    s_mul_i32 s53, s53, s31
    v_cmp_gt_f32 vcc, v248, v226
    v_mul_f32 v212, v212, v225
    v_mfma_f32_16x16x32_bf16 v[232:235], a[212:215], a[228:231], v[232:235]
    v_mul_f32 v213, v213, v225
    v_mul_f32 v214, v214, v225
    v_mul_f32 v215, v215, v225
    v_cvt_pk_bf16_f32 v212, v212, v213
    v_mul_f32 v216, v216, v225
    v_mul_f32 v217, v217, v225
    v_cvt_pk_bf16_f32 v213, v214, v215
    v_mul_f32 v218, v218, v225
    v_mul_f32 v219, v219, v225
    v_cvt_pk_bf16_f32 v216, v216, v217
    v_mul_f32 v220, v220, v225
    v_mul_f32 v221, v221, v225
    ds_write_b64 v247, v[212:213] offset:55296
    v_cvt_pk_bf16_f32 v217, v218, v219
    v_mul_f32 v222, v222, v225
    v_mul_f32 v223, v223, v225
    v_cvt_pk_bf16_f32 v220, v220, v221
    s_cmp_lg_u64 vcc, 0
    s_cselect_b32 s66, 1, 0
    v_cvt_pk_bf16_f32 v232, v232, v233
    ds_write_b64 v247, v[216:217] offset:55424
    v_cvt_pk_bf16_f32 v221, v222, v223
    v_mov_b32 v225, s66
    v_mov_b32 v226, s67
    v_cvt_pk_bf16_f32 v233, v234, v235
    ds_write_b64 v247, v[220:221] offset:55552
    ds_write_b32 v226, v225 offset:0
    ds_write_b64 v249, v[232:233] offset:6400
    ds_read_b64 v[254:255], v253 offset:24832
    s_waitcnt lgkmcnt(6)
    buffer_store_dwordx4 a[252:255], v250, s[20:23], s55 offen nt
    s_add_u32 s52, s52, s53
    s_add_u32 s52, s52, s32
    v_mov_b32 v226, 0x23000
    s_sub_u32 s54, s54, 1
    s_waitcnt lgkmcnt(1)
    s_barrier
    ds_read_b128 a[232:235], v242 offset:55296
    ds_read_b128 a[236:239], v243 offset:55296
    ds_read_b128 a[240:243], v242 offset:55424
    ds_read_b128 a[244:247], v243 offset:55424
    ds_read_b128 a[216:219], v242 offset:55552
    ds_read_b128 a[220:223], v243 offset:55552
    ds_read_b128 a[252:255], v252 offset:0
    s_waitcnt lgkmcnt(7)
    buffer_store_dwordx2 v[254:255], v251, s[20:23], s55 offen offset:256 nt
    ds_read_b64 v[254:255], v253 offset:256
    ds_read_b128 v[196:199], v226 offset:0
    s_and_b32 s55, s28, 1
    s_add_u32 s55, s55, 15
    s_mul_i32 s55, s55, s30
    s_add_u32 s55, s55, s56
    s_add_u32 s55, s55, s32
    s_waitcnt lgkmcnt(8)
    v_mfma_f32_16x16x32_bf16 v[236:239], a[144:147], a[232:235], 0
    v_mfma_f32_16x16x32_bf16 v[228:231], a[168:171], a[232:235], 0
    s_waitcnt lgkmcnt(7)
    v_mfma_f32_16x16x32_bf16 v[236:239], a[148:151], a[236:239], v[236:239]
    s_waitcnt lgkmcnt(6)
    v_mfma_f32_16x16x32_bf16 v[236:239], a[152:155], a[240:243], v[236:239]
    s_waitcnt lgkmcnt(5)
    v_mfma_f32_16x16x32_bf16 v[236:239], a[156:159], a[244:247], v[236:239]
    s_waitcnt lgkmcnt(4)
    v_mfma_f32_16x16x32_bf16 v[236:239], a[160:163], a[216:219], v[236:239]
    s_waitcnt lgkmcnt(3)
    v_mfma_f32_16x16x32_bf16 v[236:239], a[164:167], a[220:223], v[236:239]
    s_waitcnt lgkmcnt(1)
    v_mfma_f32_16x16x32_bf16 v[228:231], a[172:175], a[236:239], v[228:231]
    s_mov_b32 exec_hi, 0
    buffer_store_dwordx4 a[252:255], v250, s[20:23], s57 offen nt
    s_mov_b32 exec_hi, -1
    v_mfma_f32_16x16x32_bf16 v[228:231], a[176:179], a[240:243], v[228:231]
    v_mfma_f32_16x16x32_bf16 v[228:231], a[180:183], a[244:247], v[228:231]
    ds_read_b128 a[252:255], v252 offset:6144
    v_mfma_f32_16x16x32_bf16 v[228:231], a[184:187], a[216:219], v[228:231]
    s_mov_b32 exec_hi, 0
    buffer_store_dwordx2 v[254:255], v251, s[20:23], s57 offen offset:256 nt
    s_mov_b32 exec_hi, -1
    v_mfma_f32_16x16x32_bf16 v[228:231], a[188:191], a[220:223], v[228:231]
    ds_read_b64 v[254:255], v253 offset:6400
    v_cvt_pk_bf16_f32 v236, v236, v237
    v_mfma_f32_16x16x32_bf16 v[232:235], a[192:195], a[232:235], 0
    s_waitcnt lgkmcnt(2)
    v_cvt_pk_bf16_f32 v237, v238, v239
    v_or3_b32 v225, v196, v197, v198
    v_mfma_f32_16x16x32_bf16 v[232:235], a[196:199], a[236:239], v[232:235]
    ds_write_b64 v249, v[236:237] offset:12288
    v_mfma_f32_16x16x32_bf16 v[232:235], a[200:203], a[240:243], v[232:235]
    v_cvt_pk_bf16_f32 v228, v228, v229
    v_cvt_pk_bf16_f32 v229, v230, v231
    v_mfma_f32_16x16x32_bf16 v[232:235], a[204:207], a[244:247], v[232:235]
    ds_write_b64 v249, v[228:229] offset:12416
    v_mfma_f32_16x16x32_bf16 v[232:235], a[208:211], a[216:219], v[232:235]
    v_or_b32 v225, v225, v199
    s_waitcnt lgkmcnt(3)
    v_mfma_f32_16x16x32_bf16 v[232:235], a[212:215], a[220:223], v[232:235]
    buffer_store_dwordx4 a[252:255], v250, s[20:23], s52 offen nt
    v_readfirstlane_b32 s47, v225
    s_waitcnt lgkmcnt(2)
    s_nop 4
    v_cvt_pk_bf16_f32 v232, v232, v233
    v_cvt_pk_bf16_f32 v233, v234, v235
    ds_write_b64 v249, v[232:233] offset:12544
    buffer_store_dwordx2 v[254:255], v251, s[20:23], s52 offen offset:256 nt
    s_waitcnt lgkmcnt(0)
    s_barrier
    ds_read_b128 a[252:255], v252 offset:12288
    ds_read_b64 v[254:255], v253 offset:12544
    s_waitcnt lgkmcnt(1)
    s_mov_b32 exec_hi, s54
    buffer_store_dwordx4 a[252:255], v250, s[20:23], s55 offen nt
    s_mov_b32 exec_hi, -1
    s_waitcnt lgkmcnt(0)
    s_mov_b32 exec_hi, s54
    buffer_store_dwordx2 v[254:255], v251, s[20:23], s55 offen offset:256 nt
    s_mov_b32 exec_hi, -1
    s_nop 4
    s_cmp_lg_u32 s47, 0
    s_cbranch_scc1 L_safe
L_exit:
    s_endpgm
L_safe:
    s_waitcnt vmcnt(0) lgkmcnt(0)
    s_nop 7
    s_barrier
    v_mbcnt_lo_u32_b32 v1, -1, 0
    v_mbcnt_hi_u32_b32 v1, -1, v1
    s_lshl_b32 s51, s28, 1
    s_add_u32 s50, s31, 0xfffffe80
    s_mul_i32 s52, s36, 0x1d00
    v_lshrrev_b32 v2, 3, v1
    v_and_b32 v3, 7, v1
    v_xor_b32 v3, s51, v3
    v_lshl_add_u32 v4, v2, 7, s52
    v_mul_u32_u24 v8, 11, v2
    v_bfe_u32 v9, v8, 6, 1
    v_lshrrev_b32 v8, 5, v8
    v_xor_b32 v9, v3, v9
    v_mad_i32_i24 v8, v8, s50, v4
    v_lshl_add_u32 v168, v9, 4, v8
    v_add_u32 v8, 8, v2
    v_mul_u32_u24 v8, 11, v8
    v_bfe_u32 v9, v8, 6, 1
    v_lshrrev_b32 v8, 5, v8
    v_xor_b32 v9, v3, v9
    v_mad_i32_i24 v8, v8, s50, v4
    v_lshl_add_u32 v169, v9, 4, v8
    v_add_u32 v8, 16, v2
    v_mul_u32_u24 v8, 11, v8
    v_bfe_u32 v9, v8, 6, 1
    v_lshrrev_b32 v8, 5, v8
    v_xor_b32 v9, v3, v9
    v_mad_i32_i24 v8, v8, s50, v4
    v_lshl_add_u32 v170, v9, 4, v8
    s_movk_i32 s53, 0x480
    s_movk_i32 s54, -96
    v_lshrrev_b32 v10, 1, v1
    v_lshlrev_b32 v12, 4, v1
    v_mul_u32_u24 v8, 43, v10
    v_lshrrev_b32 v9, 8, v8
    v_lshrrev_b32 v8, 7, v8
    v_and_b32 v9, 4, v9
    v_xor_b32 v9, v8, v9
    v_mad_i32_i24 v8, v8, s54, v12
    v_mad_u32_u24 v172, v9, s53, v8
    v_add_u32 v8, 32, v10
    v_mul_u32_u24 v8, 43, v8
    v_lshrrev_b32 v9, 8, v8
    v_lshrrev_b32 v8, 7, v8
    v_and_b32 v9, 4, v9
    v_xor_b32 v9, v8, v9
    v_mad_i32_i24 v8, v8, s54, v12
    v_mad_u32_u24 v173, v9, s53, v8
    v_add_u32 v8, 64, v10
    v_mul_u32_u24 v8, 43, v8
    v_lshrrev_b32 v9, 8, v8
    v_lshrrev_b32 v8, 7, v8
    v_and_b32 v9, 4, v9
    v_xor_b32 v9, v8, v9
    v_mad_i32_i24 v8, v8, s54, v12
    v_mad_u32_u24 v174, v9, s53, v8
L_safe2:
    s_add_u32 s59, s40, s45
    s_add_u32 m0, s46, 0xc00
    s_add_u32 s60, s39, 0x180
    buffer_load_dwordx4 v168, s[4:7], s59 offen lds
    s_add_u32 m0, s29, 0
    s_add_u32 s52, s40, 0
    buffer_load_dwordx4 v172, s[8:11], s60 offen lds
    s_add_u32 m0, s46, 0xc00
    v_add_u32 v5, s52, v168
    buffer_load_dwordx4 v169, s[4:7], s59 offen offset:1024 lds
    s_add_u32 m0, s29, 0
    v_max_i32 v5, 0, v5
    buffer_load_dwordx4 v173, s[8:11], s60 offen offset:1024 lds
    s_add_u32 m0, s46, 0xc00
    s_add_u32 s53, s40, 0x400
    buffer_load_dwordx4 v170, s[4:7], s59 offen offset:2048 lds
    s_add_u32 m0, s29, 0
    v_add_u32 v6, s53, v169
    buffer_load_dwordx4 v174, s[8:11], s60 offen offset:2048 lds
    s_add_u32 m0, s46, 0
    v_max_i32 v6, 0, v6
    buffer_load_dwordx4 v5, s[4:7], 0 offen lds
    s_add_u32 m0, s46, 0x400
    s_add_u32 s54, s40, 0x800
    buffer_load_dwordx4 v6, s[4:7], 0 offen lds
    v_add_u32 v7, s54, v170
    v_max_i32 v7, 0, v7
    s_add_u32 m0, s46, 0x800
    s_add_u32 s61, s39, 0x9180
    buffer_load_dwordx4 v7, s[4:7], 0 offen lds
    s_add_u32 m0, s29, 0xc00
    s_add_u32 s62, s39, 0x12180
    buffer_load_dwordx4 v172, s[8:11], s61 offen lds
    buffer_load_dwordx4 v173, s[8:11], s61 offen offset:1024 lds
    buffer_load_dwordx4 v174, s[8:11], s61 offen offset:2048 lds
    s_add_u32 m0, s29, 0x1800
    s_add_u32 s63, s39, 0x1b180
    s_add_u32 s59, s41, s45
    s_add_u32 s60, s39, 0x24180
    s_add_u32 s61, s39, 0x2d180
    s_and_b32 s65, s48, 0xfff0
    s_lshl1_add_u32 s58, s45, s40
    v_and_b32 v13, 15, v1
    v_lshrrev_b32 v14, 4, v1
    v_lshrrev_b32 v15, 2, v13
    v_and_b32 v16, 3, v13
    v_and_b32 v17, 1, v14
    v_lshl_add_u32 v18, v14, 3, v15
    v_xor_b32 v19, 0, v17
    v_lshl_add_u32 v19, v19, 2, v18
    v_mul_u32_u24 v19, 0x60, v19
    v_lshl_add_u32 v19, v16, 3, v19
    v_add_u32 v249, s29, v19
    v_xor_b32 v19, 1, v17
    v_lshl_add_u32 v19, v19, 2, v18
    v_mul_u32_u24 v19, 0x60, v19
    v_lshl_add_u32 v19, v16, 3, v19
    v_add_u32 v250, s29, v19
    v_mov_b32 v17, v15
    v_and_b32 v18, 3, v17
    v_mul_u32_u24 v17, 0x1e00, v17
    v_lshlrev_b32 v18, 1, v18
    v_bfe_u32 v241, v16, 1, 1
    v_or_b32 v18, v18, v241
    v_xor_b32 v18, v18, v14
    v_lshl_add_u32 v17, v18, 4, v17
    v_mul_u32_u24 v18, 0x180, v16
    v_add_u32 v240, v17, v18
    v_xor_b32 v241, 64, v240
    s_add_u32 s55, s28, 3
    s_mul_i32 s56, s31, 3
    s_mul_i32 s55, s55, s30
    s_add_u32 s55, s55, s56
    s_add_u32 s55, s55, s32
    s_add_u32 s57, s28, 3
    s_mul_i32 s51, s31, 7
    s_mul_i32 s57, s57, s30
    s_add_u32 s57, s57, s51
    s_add_u32 s57, s57, s32
    s_add_u32 s52, s28, 3
    s_mul_i32 s53, s31, 11
    s_mul_i32 s52, s52, s30
    s_add_u32 s52, s52, s53
    s_add_u32 s52, s52, s32
    s_add_u32 s54, s28, 7
    s_mul_i32 s54, s54, s30
    s_add_u32 s56, s28, 7
    s_mul_i32 s56, s56, s30
    s_add_u32 s51, s28, 7
    s_mul_i32 s51, s51, s30
    s_add_u32 s53, s28, 3
    s_mul_i32 s53, s53, s30
    buffer_load_dwordx4 v172, s[8:11], s62 offen lds
    buffer_load_dwordx4 v173, s[8:11], s62 offen offset:1024 lds
    buffer_load_dwordx4 v174, s[8:11], s62 offen offset:2048 lds
    s_add_u32 m0, s46, 0x7800
    s_add_u32 s62, s39, 0x300
    buffer_load_dwordx4 v168, s[4:7], s41 offen lds
    buffer_load_dwordx4 v169, s[4:7], s41 offen offset:1024 lds
    s_waitcnt vmcnt(12)
    s_barrier
    ds_read_b128 a[216:219], v240 offset:3072
    ds_read_b128 a[220:223], v240 offset:4608
    ds_read_b128 a[240:243], v241 offset:3072
    ds_read_b128 a[244:247], v241 offset:4608
    buffer_load_dwordx4 v170, s[4:7], s41 offen offset:2048 lds
    s_add_u32 m0, s29, 0x2400
    s_waitcnt vmcnt(12)
    ds_read_b64_tr_b16 a[0:1], v249 offset:0
    ds_read_b64_tr_b16 a[2:3], v250 offset:0
    ds_read_b64_tr_b16 a[24:25], v249 offset:32
    ds_read_b64_tr_b16 a[26:27], v250 offset:32
    ds_read_b64_tr_b16 a[48:49], v249 offset:64
    ds_read_b64_tr_b16 a[50:51], v250 offset:64
    buffer_load_dwordx4 v172, s[8:11], s63 offen lds
    buffer_load_dwordx4 v173, s[8:11], s63 offen offset:1024 lds
    s_waitcnt lgkmcnt(4)
    v_mfma_f32_16x16x32_bf16 v[180:183], a[0:3], a[216:219], 0
    v_mfma_f32_16x16x32_bf16 v[192:195], a[0:3], a[220:223], 0
    s_waitcnt lgkmcnt(2)
    v_mfma_f32_16x16x32_bf16 v[184:187], a[24:27], a[216:219], 0
    s_waitcnt lgkmcnt(0)
    v_mfma_f32_16x16x32_bf16 v[188:191], a[48:51], a[216:219], 0
    buffer_load_dwordx4 v174, s[8:11], s63 offen offset:2048 lds
    s_add_u32 m0, s46, 0x8400
    v_mfma_f32_16x16x32_bf16 v[196:199], a[24:27], a[220:223], 0
    s_add_u32 s63, s39, 0x9300
    s_waitcnt vmcnt(12)
    s_barrier
    v_mfma_f32_16x16x32_bf16 v[200:203], a[48:51], a[220:223], 0
    ds_read_b128 a[224:227], v240 offset:0
    ds_read_b128 a[228:231], v240 offset:1536
    ds_read_b128 a[232:235], v241 offset:0
    ds_read_b128 a[236:239], v241 offset:1536
    ds_read_b128 a[216:219], v240 offset:128
    ds_read_b128 a[220:223], v240 offset:1664
    buffer_load_dwordx4 v168, s[4:7], s59 offen lds
    buffer_load_dwordx4 v169, s[4:7], s59 offen offset:1024 lds
    s_waitcnt lgkmcnt(5)
    v_mfma_f32_16x16x32_bf16 v[204:207], a[0:3], a[224:227], 0
    v_mfma_f32_16x16x32_bf16 v[208:211], a[24:27], a[224:227], 0
    s_waitcnt lgkmcnt(4)
    v_mfma_f32_16x16x32_bf16 v[212:215], a[48:51], a[224:227], 0
    ds_read_b128 a[224:227], v240 offset:3200
    buffer_load_dwordx4 v170, s[4:7], s59 offen offset:2048 lds
    v_mfma_f32_16x16x32_bf16 v[216:219], a[0:3], a[228:231], 0
    s_add_u32 m0, s29, 0
    s_add_u32 s59, s42, s45
    s_waitcnt vmcnt(12)
    v_mfma_f32_16x16x32_bf16 v[220:223], a[24:27], a[228:231], 0
    ds_read_b64_tr_b16 a[4:5], v249 offset:3072
    ds_read_b64_tr_b16 a[6:7], v250 offset:3072
    v_mfma_f32_16x16x32_bf16 v[224:227], a[48:51], a[228:231], 0
    ds_read_b64_tr_b16 a[28:29], v249 offset:3104
    ds_read_b64_tr_b16 a[30:31], v250 offset:3104
    ds_read_b64_tr_b16 a[52:53], v249 offset:3136
    ds_read_b64_tr_b16 a[54:55], v250 offset:3136
    ds_read_b128 a[228:231], v240 offset:4736
    buffer_load_dwordx4 v172, s[8:11], s60 offen lds
    buffer_load_dwordx4 v173, s[8:11], s60 offen offset:1024 lds
    s_waitcnt lgkmcnt(5)
    v_mfma_f32_16x16x32_bf16 v[204:207], a[4:7], a[232:235], v[204:207]
    v_mfma_f32_16x16x32_bf16 v[216:219], a[4:7], a[236:239], v[216:219]
    s_waitcnt lgkmcnt(3)
    v_mfma_f32_16x16x32_bf16 v[208:211], a[28:31], a[232:235], v[208:211]
    s_waitcnt lgkmcnt(1)
    v_mfma_f32_16x16x32_bf16 v[212:215], a[52:55], a[232:235], v[212:215]
    buffer_load_dwordx4 v174, s[8:11], s60 offen offset:2048 lds
    s_add_u32 m0, s29, 0xc00
    v_mfma_f32_16x16x32_bf16 v[220:223], a[28:31], a[236:239], v[220:223]
    s_add_u32 s60, s39, 0x12300
    s_waitcnt vmcnt(12)
    v_mfma_f32_16x16x32_bf16 v[224:227], a[52:55], a[236:239], v[224:227]
    ds_read_b64_tr_b16 a[8:9], v249 offset:6144
    ds_read_b64_tr_b16 a[10:11], v250 offset:6144
    v_mfma_f32_16x16x32_bf16 v[180:183], a[4:7], a[240:243], v[180:183]
    ds_read_b64_tr_b16 a[32:33], v249 offset:6176
    ds_read_b64_tr_b16 a[34:35], v250 offset:6176
    v_mfma_f32_16x16x32_bf16 v[184:187], a[28:31], a[240:243], v[184:187]
    buffer_load_dwordx4 v172, s[8:11], s61 offen lds
    ds_read_b64_tr_b16 a[56:57], v249 offset:6208
    v_mfma_f32_16x16x32_bf16 v[188:191], a[52:55], a[240:243], v[188:191]
    ds_read_b64_tr_b16 a[58:59], v250 offset:6208
    v_mfma_f32_16x16x32_bf16 v[192:195], a[4:7], a[244:247], v[192:195]
    v_mfma_f32_16x16x32_bf16 v[196:199], a[28:31], a[244:247], v[196:199]
    v_mfma_f32_16x16x32_bf16 v[200:203], a[52:55], a[244:247], v[200:203]
    buffer_load_dwordx4 v173, s[8:11], s61 offen offset:1024 lds
    s_waitcnt lgkmcnt(4)
    v_mfma_f32_16x16x32_bf16 v[204:207], a[8:11], a[216:219], v[204:207]
    v_mfma_f32_16x16x32_bf16 v[216:219], a[8:11], a[220:223], v[216:219]
    s_waitcnt lgkmcnt(2)
    v_mfma_f32_16x16x32_bf16 v[208:211], a[32:35], a[216:219], v[208:211]
    buffer_load_dwordx4 v174, s[8:11], s61 offen offset:2048 lds
    s_add_u32 m0, s37, 0xd80
    v_mfma_f32_16x16x32_bf16 v[220:223], a[32:35], a[220:223], v[220:223]
    s_add_u32 s61, s39, 0x1b300
    s_waitcnt vmcnt(12) lgkmcnt(0)
    s_barrier
    v_mfma_f32_16x16x32_bf16 v[212:215], a[56:59], a[216:219], v[212:215]
    ds_read_b128 a[232:235], v240 offset:30720
    ds_read_b128 a[236:239], v240 offset:32256
    v_mfma_f32_16x16x32_bf16 v[224:227], a[56:59], a[220:223], v[224:227]
    ds_read_b128 a[240:243], v241 offset:30720
    ds_read_b128 a[244:247], v241 offset:32256
    v_mfma_f32_16x16x32_bf16 v[180:183], a[8:11], a[224:227], v[180:183]
    buffer_load_dwordx4 v12, s[16:19], s65 offen lds
    s_add_u32 m0, s29, 0x1800
    v_mfma_f32_16x16x32_bf16 v[184:187], a[32:35], a[224:227], v[184:187]
    ds_read_b128 a[216:219], v240 offset:30848
    ds_read_b128 a[220:223], v240 offset:32384
    v_mfma_f32_16x16x32_bf16 v[188:191], a[56:59], a[224:227], v[188:191]
    ds_read_b128 a[224:227], v241 offset:128
    v_mfma_f32_16x16x32_bf16 v[192:195], a[8:11], a[228:231], v[192:195]
    v_mfma_f32_16x16x32_bf16 v[196:199], a[32:35], a[228:231], v[196:199]
    buffer_load_dwordx4 v172, s[8:11], s62 offen lds
    v_mfma_f32_16x16x32_bf16 v[200:203], a[56:59], a[228:231], v[200:203]
    ds_read_b128 a[228:231], v241 offset:1664
    s_waitcnt lgkmcnt(7)
    v_mfma_f32_16x16x32_bf16 v[228:231], a[0:3], a[232:235], 0
    v_mfma_f32_16x16x32_bf16 v[232:235], a[24:27], a[232:235], 0
    s_waitcnt lgkmcnt(6)
    v_mfma_f32_16x16x32_bf16 v[236:239], a[48:51], a[232:235], 0
    buffer_load_dwordx4 v173, s[8:11], s62 offen offset:1024 lds
    s_waitcnt vmcnt(12) lgkmcnt(5)
    v_mfma_f32_16x16x32_bf16 v[138:141], a[0:3], a[236:239], 0
    ds_read_b64_tr_b16 a[12:13], v249 offset:9216
    ds_read_b64_tr_b16 a[14:15], v250 offset:9216
    v_mfma_f32_16x16x32_bf16 v[142:145], a[24:27], a[236:239], 0
    ds_read_b64_tr_b16 a[36:37], v249 offset:9248
    ds_read_b64_tr_b16 a[38:39], v250 offset:9248
    v_mfma_f32_16x16x32_bf16 v[146:149], a[48:51], a[236:239], 0
    ds_read_b64_tr_b16 a[60:61], v249 offset:9280
    ds_read_b64_tr_b16 a[62:63], v250 offset:9280
    v_mfma_f32_16x16x32_bf16 v[228:231], a[4:7], a[240:243], v[228:231]
    ds_read_b128 a[232:235], v241 offset:3200
    buffer_load_dwordx4 v174, s[8:11], s62 offen offset:2048 lds
    v_mfma_f32_16x16x32_bf16 v[232:235], a[28:31], a[240:243], v[232:235]
    s_add_u32 m0, s29, 0x2400
    s_add_u32 s62, s39, 0x24300
    s_add_u32 s50, s31, 0xfffffe80
    v_mfma_f32_16x16x32_bf16 v[236:239], a[52:55], a[240:243], v[236:239]
    s_waitcnt lgkmcnt(10)
    ds_read_b128 a[236:239], v241 offset:4736
    v_mfma_f32_16x16x32_bf16 v[138:141], a[4:7], a[244:247], v[138:141]
    ds_read_b128 a[240:243], v241 offset:30848
    v_add_u32 v8, 4, v2
    v_mfma_f32_16x16x32_bf16 v[142:145], a[28:31], a[244:247], v[142:145]
    s_and_b32 s66, s28, 1
    v_mul_u32_u24 v8, 11, v8
    v_bfe_u32 v9, v8, 6, 1
    v_mfma_f32_16x16x32_bf16 v[146:149], a[52:55], a[244:247], v[146:149]
    ds_read_b128 a[244:247], v241 offset:32384
    v_lshrrev_b32 v8, 5, v8
    v_mfma_f32_16x16x32_bf16 v[228:231], a[8:11], a[216:219], v[228:231]
    s_lshl_b32 s66, s66, 2
    v_xor_b32 v9, v3, v9
    v_mad_i32_i24 v8, v8, s50, v4
    v_mfma_f32_16x16x32_bf16 v[232:235], a[32:35], a[216:219], v[232:235]
    s_lshr_b32 s67, s28, 1
    v_lshl_add_u32 v171, v9, 4, v8
    s_waitcnt lgkmcnt(4)
    v_mfma_f32_16x16x32_bf16 v[236:239], a[56:59], a[216:219], v[236:239]
    buffer_load_dwordx4 v172, s[8:11], s63 offen lds
    v_mbcnt_lo_u32_b32 v67, -1, 0
    v_mfma_f32_16x16x32_bf16 v[138:141], a[8:11], a[220:223], v[138:141]
    s_waitcnt vmcnt(11) lgkmcnt(3)
    s_barrier
    v_mbcnt_hi_u32_b32 v67, -1, v67
    v_mfma_f32_16x16x32_bf16 v[142:145], a[32:35], a[220:223], v[142:145]
    ds_read_b128 a[216:219], v240 offset:33792
    v_lshrrev_b32 v68, 1, v67
    v_mfma_f32_16x16x32_bf16 v[146:149], a[56:59], a[220:223], v[146:149]
    ds_read_b128 a[220:223], v240 offset:35328
    v_add_u32 v68, 0, v68
    v_mfma_f32_16x16x32_bf16 v[204:207], a[12:15], a[224:227], v[204:207]
    buffer_load_dwordx4 v173, s[8:11], s63 offen offset:1024 lds
    v_mul_u32_u24 v69, 43, v68
    v_mfma_f32_16x16x32_bf16 v[208:211], a[36:39], a[224:227], v[208:211]
    s_lshl_b32 s67, s67, 3
    v_lshrrev_b32 v70, 8, v69
    v_lshrrev_b32 v69, 7, v69
    v_mfma_f32_16x16x32_bf16 v[212:215], a[60:63], a[224:227], v[212:215]
    ds_read_b128 a[224:227], v241 offset:33792
    v_mad_i32_i24 v68, v69, -3, v68
    v_mfma_f32_16x16x32_bf16 v[216:219], a[12:15], a[228:231], v[216:219]
    s_mul_i32 s64, s35, 0xfc0
    v_and_b32 v70, 4, v70
    v_xor_b32 v69, v69, v70
    v_mfma_f32_16x16x32_bf16 v[220:223], a[36:39], a[228:231], v[220:223]
    buffer_load_dwordx4 v174, s[8:11], s63 offen offset:2048 lds
    s_add_u32 m0, s29, 0
    v_mfma_f32_16x16x32_bf16 v[224:227], a[60:63], a[228:231], v[224:227]
    s_add_u32 s63, s39, 0x2d300
    ds_read_b128 a[228:231], v241 offset:35328
    v_mfma_f32_16x16x32_bf16 v[180:183], a[12:15], a[232:235], v[180:183]
    s_add_u32 s64, s64, s37
    v_and_b32 v70, 4, v69
    v_mul_u32_u24 v252, 24, v70
    v_mfma_f32_16x16x32_bf16 v[184:187], a[36:39], a[232:235], v[184:187]
    s_waitcnt lgkmcnt(3)
    v_lshrrev_b32 v70, 3, v69
    v_lshl_add_u32 v252, v70, 2, v252
    v_mfma_f32_16x16x32_bf16 v[188:191], a[60:63], a[232:235], v[188:191]
    ds_read_b128 a[232:235], v240 offset:33920
    v_and_or_b32 v252, v69, 3, v252
    v_mfma_f32_16x16x32_bf16 v[192:195], a[12:15], a[236:239], v[192:195]
    s_waitcnt lgkmcnt(3)
    v_mad_u32_u24 v252, v252, 3, v68
    v_and_b32 v70, 1, v67
    v_mfma_f32_16x16x32_bf16 v[196:199], a[36:39], a[236:239], v[196:199]
    s_waitcnt vmcnt(10)
    ds_read_b64_tr_b16 a[16:17], v249 offset:0
    v_mfma_f32_16x16x32_bf16 v[200:203], a[60:63], a[236:239], v[200:203]
    ds_read_b64_tr_b16 a[18:19], v250 offset:0
    ds_read_b64_tr_b16 a[40:41], v249 offset:32
    v_mfma_f32_16x16x32_bf16 v[228:231], a[12:15], a[240:243], v[228:231]
    ds_read_b64_tr_b16 a[42:43], v250 offset:32
    ds_read_b64_tr_b16 a[64:65], v249 offset:64
    v_mfma_f32_16x16x32_bf16 v[232:235], a[36:39], a[240:243], v[232:235]
    ds_read_b64_tr_b16 a[66:67], v250 offset:64
    ds_read_b128 a[236:239], v240 offset:35456
    v_mfma_f32_16x16x32_bf16 v[236:239], a[60:63], a[240:243], v[236:239]
    ds_read_b128 a[240:243], v241 offset:33920
    v_lshl_add_u32 v252, v252, 3, v70
    v_mfma_f32_16x16x32_bf16 v[138:141], a[12:15], a[244:247], v[138:141]
    v_lshlrev_b32 v252, 4, v252
    v_lshrrev_b32 v68, 1, v67
    v_mfma_f32_16x16x32_bf16 v[142:145], a[36:39], a[244:247], v[142:145]
    v_add_u32 v68, 32, v68
    v_mul_u32_u24 v69, 43, v68
    v_mfma_f32_16x16x32_bf16 v[146:149], a[60:63], a[244:247], v[146:149]
    ds_read_b128 a[244:247], v241 offset:35456
    v_lshrrev_b32 v70, 8, v69
    v_mfma_f32_16x16x32_bf16 v[150:153], a[0:3], a[216:219], 0
    s_waitcnt lgkmcnt(11)
    v_lshrrev_b32 v69, 7, v69
    v_mad_i32_i24 v68, v69, -3, v68
    v_mfma_f32_16x16x32_bf16 v[154:157], a[24:27], a[216:219], 0
    v_and_b32 v70, 4, v70
    v_xor_b32 v69, v69, v70
    v_mfma_f32_16x16x32_bf16 v[158:161], a[48:51], a[216:219], 0
    ds_read_b128 a[216:219], v240 offset:256
    v_and_b32 v70, 4, v69
    v_mfma_f32_16x16x32_bf16 v[162:165], a[0:3], a[220:223], 0
    s_waitcnt lgkmcnt(10)
    s_waitcnt lgkmcnt(4)
    v_mul_u32_u24 v253, 24, v70
    v_mfma_f32_16x16x32_bf16 v[24:27], a[24:27], a[220:223], 0
    buffer_load_dwordx4 v172, s[8:11], s60 offen lds
    v_lshrrev_b32 v70, 3, v69
    v_mfma_f32_16x16x32_bf16 v[54:57], a[48:51], a[220:223], 0
    s_waitcnt vmcnt(8)
    ds_read_b64_tr_b16 a[20:21], v249 offset:3072
    v_mfma_f32_16x16x32_bf16 v[150:153], a[4:7], a[224:227], v[150:153]
    ds_read_b64_tr_b16 a[22:23], v250 offset:3072
    ds_read_b64_tr_b16 a[44:45], v249 offset:3104
    v_mfma_f32_16x16x32_bf16 v[154:157], a[28:31], a[224:227], v[154:157]
    ds_read_b64_tr_b16 a[46:47], v250 offset:3104
    ds_read_b64_tr_b16 a[68:69], v249 offset:3136
    v_mfma_f32_16x16x32_bf16 v[158:161], a[52:55], a[224:227], v[158:161]
    buffer_load_dwordx4 v173, s[8:11], s60 offen offset:1024 lds
    ds_read_b64_tr_b16 a[70:71], v250 offset:3136
    v_mfma_f32_16x16x32_bf16 v[162:165], a[4:7], a[228:231], v[162:165]
    ds_read_b128 a[220:223], v240 offset:1792
    ds_read_b128 a[224:227], v240 offset:3328
    v_mfma_f32_16x16x32_bf16 v[24:27], a[28:31], a[228:231], v[24:27]
    s_waitcnt lgkmcnt(8)
    v_lshl_add_u32 v253, v70, 2, v253
    v_and_or_b32 v253, v69, 3, v253
    v_mfma_f32_16x16x32_bf16 v[54:57], a[52:55], a[228:231], v[54:57]
    ds_read_b128 a[228:231], v240 offset:4864
    v_mad_u32_u24 v253, v253, 3, v68
    v_mfma_f32_16x16x32_bf16 v[150:153], a[8:11], a[232:235], v[150:153]
    buffer_load_dwordx4 v174, s[8:11], s60 offen offset:2048 lds
    s_add_u32 m0, s29, 0xc00
    v_mfma_f32_16x16x32_bf16 v[154:157], a[32:35], a[232:235], v[154:157]
    s_add_u32 s60, s39, 0
    v_and_b32 v70, 1, v67
    v_lshl_add_u32 v253, v253, 3, v70
    v_mfma_f32_16x16x32_bf16 v[158:161], a[56:59], a[232:235], v[158:161]
    ds_read_b128 a[232:235], v240 offset:30976
    v_lshlrev_b32 v253, 4, v253
    v_mfma_f32_16x16x32_bf16 v[162:165], a[8:11], a[236:239], v[162:165]
    v_add_u32 v253, 0xfffffc00, v253
    v_add_u32 v17, 3, v15
    v_mfma_f32_16x16x32_bf16 v[24:27], a[32:35], a[236:239], v[24:27]
    v_add_u32 v19, 3, v16
    s_waitcnt lgkmcnt(4)
    v_mfma_f32_16x16x32_bf16 v[54:57], a[56:59], a[236:239], v[54:57]
    buffer_load_dwordx4 v172, s[8:11], s61 offen lds
    ds_read_b128 a[236:239], v240 offset:32512
    v_mfma_f32_16x16x32_bf16 v[150:153], a[12:15], a[240:243], v[150:153]
    s_waitcnt lgkmcnt(4)
    v_and_b32 v18, 3, v17
    v_mul_u32_u24 v17, 0x1e00, v17
    v_mfma_f32_16x16x32_bf16 v[154:157], a[36:39], a[240:243], v[154:157]
    s_waitcnt lgkmcnt(3)
    v_lshlrev_b32 v18, 1, v18
    v_bfe_u32 v243, v19, 1, 1
    v_mfma_f32_16x16x32_bf16 v[158:161], a[60:63], a[240:243], v[158:161]
    ds_read_b128 a[240:243], v240 offset:34048
    v_or_b32 v18, v18, v243
    v_mfma_f32_16x16x32_bf16 v[162:165], a[12:15], a[244:247], v[162:165]
    buffer_load_dwordx4 v173, s[8:11], s61 offen offset:1024 lds
    v_xor_b32 v18, v18, v14
    v_mfma_f32_16x16x32_bf16 v[24:27], a[36:39], a[244:247], v[24:27]
    s_waitcnt lgkmcnt(3)
    s_waitcnt vmcnt(8) lgkmcnt(2)
    v_lshl_add_u32 v17, v18, 4, v17
    v_mfma_f32_16x16x32_bf16 v[54:57], a[60:63], a[244:247], v[54:57]
    ds_read_b64_tr_b16 a[72:73], v249 offset:6144
    ds_read_b64_tr_b16 a[74:75], v250 offset:6144
    v_mfma_f32_16x16x32_bf16 v[204:207], a[16:19], a[216:219], v[204:207]
    ds_read_b64_tr_b16 a[96:97], v249 offset:6176
    ds_read_b64_tr_b16 a[98:99], v250 offset:6176
    v_mfma_f32_16x16x32_bf16 v[208:211], a[40:43], a[216:219], v[208:211]
    buffer_load_dwordx4 v174, s[8:11], s61 offen offset:2048 lds
    s_add_u32 m0, s29, 0x1800
    v_mfma_f32_16x16x32_bf16 v[212:215], a[64:67], a[216:219], v[212:215]
    s_add_u32 s61, s39, 0x9000
    ds_read_b64_tr_b16 a[120:121], v249 offset:6208
    v_mfma_f32_16x16x32_bf16 v[216:219], a[16:19], a[220:223], v[216:219]
    ds_read_b64_tr_b16 a[122:123], v250 offset:6208
    ds_read_b128 a[244:247], v240 offset:35584
    v_mfma_f32_16x16x32_bf16 v[220:223], a[40:43], a[220:223], v[220:223]
    ds_read_b128 a[216:219], v241 offset:256
    v_mul_u32_u24 v18, 0x180, v19
    v_mfma_f32_16x16x32_bf16 v[224:227], a[64:67], a[220:223], v[224:227]
    ds_read_b128 a[220:223], v241 offset:1792
    v_add_u32 v242, v17, v18
    v_mfma_f32_16x16x32_bf16 v[180:183], a[16:19], a[224:227], v[180:183]
    s_waitcnt lgkmcnt(9)
    v_xor_b32 v243, 64, v242
    v_accvgpr_write_b32 a252, v168
    v_mfma_f32_16x16x32_bf16 v[184:187], a[40:43], a[224:227], v[184:187]
    v_accvgpr_read_b32 v254, a252
    v_accvgpr_write_b32 a253, v169
    v_mfma_f32_16x16x32_bf16 v[188:191], a[64:67], a[224:227], v[188:191]
    ds_read_b128 a[224:227], v241 offset:3328
    v_accvgpr_read_b32 v255, a253
    v_mfma_f32_16x16x32_bf16 v[192:195], a[16:19], a[228:231], v[192:195]
    v_accvgpr_write_b32 a254, v170
    v_accvgpr_write_b32 a255, v171
    v_mfma_f32_16x16x32_bf16 v[196:199], a[40:43], a[228:231], v[196:199]
    v_mov_b32 v17, 0x3f803f80
    v_accvgpr_write_b32 a248, v17
    v_mfma_f32_16x16x32_bf16 v[200:203], a[64:67], a[228:231], v[200:203]
    ds_read_b128 a[228:231], v241 offset:4864
    s_waitcnt lgkmcnt(5)
    v_mfma_f32_16x16x32_bf16 v[228:231], a[16:19], a[232:235], v[228:231]
    buffer_load_dwordx4 v172, s[8:11], s62 offen lds
    s_waitcnt vmcnt(7) lgkmcnt(4)
    v_mfma_f32_16x16x32_bf16 v[232:235], a[40:43], a[232:235], v[232:235]
    ds_read_b64_tr_b16 a[76:77], v249 offset:9216
    ds_read_b64_tr_b16 a[78:79], v250 offset:9216
    v_mfma_f32_16x16x32_bf16 v[236:239], a[64:67], a[232:235], v[236:239]
    ds_read_b64_tr_b16 a[100:101], v249 offset:9248
    ds_read_b64_tr_b16 a[102:103], v250 offset:9248
    v_mfma_f32_16x16x32_bf16 v[138:141], a[16:19], a[236:239], v[138:141]
    ds_read_b64_tr_b16 a[124:125], v249 offset:9280
    ds_read_b64_tr_b16 a[126:127], v250 offset:9280
    v_mfma_f32_16x16x32_bf16 v[142:145], a[40:43], a[236:239], v[142:145]
    buffer_load_dwordx4 v173, s[8:11], s62 offen offset:1024 lds
    ds_read_b128 a[232:235], v241 offset:30976
    v_mfma_f32_16x16x32_bf16 v[146:149], a[64:67], a[236:239], v[146:149]
    ds_read_b128 a[236:239], v241 offset:32512
    v_accvgpr_write_b32 a249, v17
    v_mfma_f32_16x16x32_bf16 v[150:153], a[16:19], a[240:243], v[150:153]
    s_waitcnt lgkmcnt(9)
    v_accvgpr_write_b32 a250, v17
    v_accvgpr_write_b32 a251, v17
    v_mfma_f32_16x16x32_bf16 v[154:157], a[40:43], a[240:243], v[154:157]
    s_waitcnt lgkmcnt(8)
    v_mov_b32 v248, 0
    v_lshrrev_b32 v18, 1, v13
    v_mfma_f32_16x16x32_bf16 v[158:161], a[64:67], a[240:243], v[158:161]
    buffer_load_dwordx4 v174, s[8:11], s62 offen offset:2048 lds
    s_add_u32 m0, s29, 0x2400
    v_mfma_f32_16x16x32_bf16 v[162:165], a[16:19], a[244:247], v[162:165]
    s_add_u32 s62, s39, 0x12000
    ds_read_b128 a[240:243], v241 offset:34048
    v_mfma_f32_16x16x32_bf16 v[24:27], a[40:43], a[244:247], v[24:27]
    v_xor_b32 v18, v14, v18
    v_xor_b32 v18, s66, v18
    v_mfma_f32_16x16x32_bf16 v[54:57], a[64:67], a[244:247], v[54:57]
    ds_read_b128 a[244:247], v241 offset:35584
    s_waitcnt lgkmcnt(4)
    v_mfma_f32_16x16x32_bf16 v[204:207], a[20:23], a[216:219], v[204:207]
    buffer_load_dwordx4 v172, s[8:11], s63 offen lds
    v_mul_u32_u24 v17, 0x180, v13
    v_mfma_f32_16x16x32_bf16 v[208:211], a[44:47], a[216:219], v[208:211]
    s_lshl_b32 s66, s36, 1
    v_lshl_add_u32 v17, v18, 4, v17
    v_add_u32 v17, s67, v17
    v_mfma_f32_16x16x32_bf16 v[212:215], a[68:71], a[216:219], v[212:215]
    ds_read_b128 a[216:219], v240 offset:0
    v_cvt_pk_bf16_f32 v102, v204, v205
    v_mfma_f32_16x16x32_bf16 v[216:219], a[20:23], a[220:223], v[216:219]
    s_mul_i32 s67, s36, 3
    v_cvt_pk_bf16_f32 v103, v206, v207
    v_cvt_pk_bf16_f32 v104, v208, v209
    v_mfma_f32_16x16x32_bf16 v[220:223], a[44:47], a[220:223], v[220:223]
    buffer_load_dwordx4 v173, s[8:11], s63 offen offset:1024 lds
    v_cvt_pk_bf16_f32 v105, v210, v211
    v_mfma_f32_16x16x32_bf16 v[224:227], a[68:71], a[220:223], v[224:227]
    s_sub_u32 s66, 1, s66
    v_cvt_pk_bf16_f32 v106, v212, v213
    v_cvt_pk_bf16_f32 v107, v214, v215
    v_mfma_f32_16x16x32_bf16 v[180:183], a[20:23], a[224:227], v[180:183]
    s_waitcnt lgkmcnt(2)
    v_cvt_pk_bf16_f32 v108, v216, v217
    v_cvt_pk_bf16_f32 v109, v218, v219
    v_mfma_f32_16x16x32_bf16 v[184:187], a[44:47], a[224:227], v[184:187]
    v_cvt_pk_bf16_f32 v110, v220, v221
    v_cvt_pk_bf16_f32 v111, v222, v223
    v_mfma_f32_16x16x32_bf16 v[188:191], a[68:71], a[224:227], v[188:191]
    buffer_load_dwordx4 v174, s[8:11], s63 offen offset:2048 lds
    s_add_u32 m0, s46, 0x1800
    v_mfma_f32_16x16x32_bf16 v[192:195], a[20:23], a[228:231], v[192:195]
    s_add_u32 s63, s39, 0x1b000
    v_cvt_pk_bf16_f32 v112, v224, v225
    v_cvt_pk_bf16_f32 v113, v226, v227
    v_mfma_f32_16x16x32_bf16 v[196:199], a[44:47], a[228:231], v[196:199]
    s_waitcnt lgkmcnt(1)
    v_cvt_pk_bf16_f32 v90, v180, v181
    v_cvt_pk_bf16_f32 v91, v182, v183
    v_mfma_f32_16x16x32_bf16 v[200:203], a[68:71], a[228:231], v[200:203]
    s_waitcnt lgkmcnt(0)
    v_cvt_pk_bf16_f32 v92, v184, v185
    v_cvt_pk_bf16_f32 v93, v186, v187
    v_mfma_f32_16x16x32_bf16 v[228:231], a[20:23], a[232:235], v[228:231]
    buffer_load_dwordx4 v168, s[4:7], s58 offen lds
    v_cvt_pk_bf16_f32 v94, v188, v189
    v_mfma_f32_16x16x32_bf16 v[232:235], a[44:47], a[232:235], v[232:235]
    v_cvt_pk_bf16_f32 v95, v190, v191
    v_cvt_pk_bf16_f32 v96, v192, v193
    v_mfma_f32_16x16x32_bf16 v[236:239], a[68:71], a[232:235], v[236:239]
    s_waitcnt vmcnt(10)
    ds_read_b64_tr_b16 a[80:81], v249 offset:0
    v_mfma_f32_16x16x32_bf16 v[138:141], a[20:23], a[236:239], v[138:141]
    ds_read_b64_tr_b16 a[82:83], v250 offset:0
    ds_read_b64_tr_b16 a[104:105], v249 offset:32
    v_mfma_f32_16x16x32_bf16 v[142:145], a[44:47], a[236:239], v[142:145]
    buffer_load_dwordx4 v171, s[4:7], s58 offen offset:512 lds
    s_lshl1_add_u32 s58, s45, s41
    v_mfma_f32_16x16x32_bf16 v[146:149], a[68:71], a[236:239], v[146:149]
    s_add_u32 m0, s46, 0x9000
    ds_read_b64_tr_b16 a[106:107], v250 offset:32
    v_mfma_f32_16x16x32_bf16 v[150:153], a[20:23], a[240:243], v[150:153]
    ds_read_b64_tr_b16 a[128:129], v249 offset:64
    ds_read_b64_tr_b16 a[130:131], v250 offset:64
    v_mfma_f32_16x16x32_bf16 v[154:157], a[44:47], a[240:243], v[154:157]
    v_cvt_pk_bf16_f32 v97, v194, v195
    v_cvt_pk_bf16_f32 v98, v196, v197
    v_mfma_f32_16x16x32_bf16 v[158:161], a[68:71], a[240:243], v[158:161]
    buffer_load_dwordx4 v168, s[4:7], s58 offen lds
    v_cvt_pk_bf16_f32 v99, v198, v199
    v_mfma_f32_16x16x32_bf16 v[162:165], a[20:23], a[244:247], v[162:165]
    v_cvt_pk_bf16_f32 v100, v200, v201
    v_cvt_pk_bf16_f32 v101, v202, v203
    v_mfma_f32_16x16x32_bf16 v[24:27], a[44:47], a[244:247], v[24:27]
    v_cvt_pk_bf16_f32 v114, v228, v229
    v_cvt_pk_bf16_f32 v115, v230, v231
    v_mfma_f32_16x16x32_bf16 v[54:57], a[68:71], a[244:247], v[54:57]
    v_cvt_pk_bf16_f32 v116, v232, v233
    v_cvt_pk_bf16_f32 v117, v234, v235
    v_mfma_f32_16x16x32_bf16 v[84:87], a[216:219], a[72:75], 0
    buffer_load_dwordx4 v171, s[4:7], s58 offen offset:512 lds
    s_add_u32 m0, s46, 0xf000
    v_mfma_f32_16x16x32_bf16 v[204:207], a[216:219], a[96:99], 0
    s_lshl1_add_u32 s58, s45, s42
    v_cvt_pk_bf16_f32 v118, v236, v237
    v_cvt_pk_bf16_f32 v119, v238, v239
    v_mfma_f32_16x16x32_bf16 v[208:211], a[216:219], a[120:123], 0
    v_cvt_pk_bf16_f32 v120, v138, v139
    v_cvt_pk_bf16_f32 v121, v140, v141
    v_cvt_pk_bf16_f32 v122, v142, v143
    v_cvt_pk_bf16_f32 v123, v144, v145
    s_waitcnt vmcnt(10)
    ds_read_b64_tr_b16 a[84:85], v249 offset:3072
    buffer_load_dwordx4 v168, s[4:7], s42 offen lds
    ds_read_b64_tr_b16 a[86:87], v250 offset:3072
    ds_read_b64_tr_b16 a[108:109], v249 offset:3104
    ds_read_b64_tr_b16 a[110:111], v250 offset:3104
    ds_read_b64_tr_b16 a[132:133], v249 offset:3136
    ds_read_b64_tr_b16 a[134:135], v250 offset:3136
    v_cvt_pk_bf16_f32 v124, v146, v147
    v_cvt_pk_bf16_f32 v125, v148, v149
    v_cvt_pk_bf16_f32 v126, v150, v151
    v_cvt_pk_bf16_f32 v127, v152, v153
    v_cvt_pk_bf16_f32 v128, v154, v155
    v_cvt_pk_bf16_f32 v129, v156, v157
    v_cvt_pk_bf16_f32 v130, v158, v159
    v_cvt_pk_bf16_f32 v131, v160, v161
    buffer_load_dwordx4 v169, s[4:7], s42 offen offset:1024 lds
    v_cvt_pk_bf16_f32 v132, v162, v163
    v_cvt_pk_bf16_f32 v133, v164, v165
    v_cvt_pk_bf16_f32 v134, v24, v25
    v_cvt_pk_bf16_f32 v135, v26, v27
    v_cvt_pk_bf16_f32 v136, v54, v55
    v_cvt_pk_bf16_f32 v137, v56, v57
    ds_read_b128 a[220:223], v240 offset:1536
    ds_read_b128 a[224:227], v240 offset:3072
    ds_read_b128 a[228:231], v240 offset:4608
    ds_read_b128 a[232:235], v240 offset:30720
    ds_read_b128 a[236:239], v240 offset:32256
    ds_read_b128 a[240:243], v240 offset:33792
    ds_read_b128 a[244:247], v240 offset:35328
    ds_read_b128 a[216:219], v241 offset:0
    v_add_u32 v247, 0x7800, v17
    v_add_u32 v251, 0x1e000, v17
    v_sub_u32 v17, v14, v15
    buffer_load_dwordx4 v170, s[4:7], s42 offen offset:2048 lds
    s_add_u32 m0, s46, 0xfc00
    v_mul_i32_i24 v17, 0x1c0, v17
    v_lshlrev_b32 v18, 4, v16
    v_sub_u32 v17, v17, v18
    v_add_u32 v17, s37, v17
    v_max_u32 v18, s33, v15
    v_sub_u32 v18, v14, v18
    v_add_u32 v244, 0, v18
    v_cmp_gt_u32 vcc, 7, v244
    v_add_u32 v244, 0xfffdc870, v17
    v_add_u32 v245, 4, v18
    v_cndmask_b32 v244, 0, v244, vcc
    v_add_u32 v244, 0x237c0, v244
    v_cmp_gt_u32 vcc, 7, v245
    buffer_load_dwordx4 v168, s[4:7], s59 offen lds
    s_waitcnt lgkmcnt(7)
    v_mfma_f32_16x16x32_bf16 v[212:215], a[220:223], a[72:75], 0
    v_add_u32 v245, 0xfffdcf70, v17
    v_cndmask_b32 v245, 0, v245, vcc
    v_mfma_f32_16x16x32_bf16 v[216:219], a[220:223], a[96:99], 0
    s_waitcnt lgkmcnt(6)
    v_add_u32 v245, 0x237c0, v245
    v_add_u32 v246, 8, v18
    v_mfma_f32_16x16x32_bf16 v[220:223], a[220:223], a[120:123], 0
    ds_read_b128 a[220:223], v241 offset:1536
    v_cmp_gt_u32 vcc, 7, v246
    v_mfma_f32_16x16x32_bf16 v[224:227], a[224:227], a[72:75], 0
    s_waitcnt lgkmcnt(5)
    buffer_load_dwordx4 v169, s[4:7], s59 offen offset:1024 lds
    v_mfma_f32_16x16x32_bf16 v[180:183], a[224:227], a[96:99], 0
    s_waitcnt vmcnt(12) lgkmcnt(4)
    ds_read_b64_tr_b16 a[88:89], v249 offset:6144
    v_mfma_f32_16x16x32_bf16 v[184:187], a[224:227], a[120:123], 0
    ds_read_b64_tr_b16 a[90:91], v250 offset:6144
    ds_read_b64_tr_b16 a[112:113], v249 offset:6176
    v_mfma_f32_16x16x32_bf16 v[188:191], a[228:231], a[72:75], 0
    ds_read_b64_tr_b16 a[114:115], v250 offset:6176
    ds_read_b64_tr_b16 a[136:137], v249 offset:6208
    v_mfma_f32_16x16x32_bf16 v[192:195], a[228:231], a[96:99], 0
    ds_read_b64_tr_b16 a[138:139], v250 offset:6208
    buffer_load_dwordx4 v170, s[4:7], s59 offen offset:2048 lds
    v_mfma_f32_16x16x32_bf16 v[196:199], a[228:231], a[120:123], 0
    s_add_u32 m0, s46, 0x10800
    ds_read_b128 a[224:227], v241 offset:3072
    v_mfma_f32_16x16x32_bf16 v[200:203], a[232:235], a[72:75], 0
    ds_read_b128 a[228:231], v241 offset:4608
    s_add_u32 s59, s43, s45
    v_mfma_f32_16x16x32_bf16 v[228:231], a[232:235], a[96:99], 0
    s_waitcnt lgkmcnt(8)
    v_add_u32 v246, 0xfffdd670, v17
    v_cndmask_b32 v246, 0, v246, vcc
    v_mfma_f32_16x16x32_bf16 v[232:235], a[232:235], a[120:123], 0
    ds_read_b128 a[232:235], v241 offset:30720
    v_add_u32 v246, 0x237c0, v246
    v_mfma_f32_16x16x32_bf16 v[236:239], a[236:239], a[72:75], 0
    buffer_load_dwordx4 v168, s[4:7], s58 offen lds
    v_min_u32 v20, 55, v1
    v_mfma_f32_16x16x32_bf16 v[138:141], a[236:239], a[96:99], 0
    v_lshlrev_b32 v62, 3, v20
    v_add_u32 v62, s64, v62
    v_mfma_f32_16x16x32_bf16 v[142:145], a[236:239], a[120:123], 0
    ds_read_b128 a[236:239], v241 offset:32256
    v_lshrrev_b32 v21, 1, v20
    v_mfma_f32_16x16x32_bf16 v[146:149], a[240:243], a[72:75], 0
    s_and_b32 s64, s48, 15
    v_and_b32 v20, 1, v20
    v_lshlrev_b32 v20, 1, v20
    v_mfma_f32_16x16x32_bf16 v[150:153], a[240:243], a[96:99], 0
    buffer_load_dwordx4 v171, s[4:7], s58 offen offset:512 lds
    s_add_u32 m0, s29, 0
    v_mfma_f32_16x16x32_bf16 v[154:157], a[240:243], a[120:123], 0
    s_waitcnt vmcnt(12) lgkmcnt(3)
    ds_read_b64_tr_b16 a[92:93], v249 offset:9216
    v_mfma_f32_16x16x32_bf16 v[158:161], a[244:247], a[72:75], 0
    ds_read_b64_tr_b16 a[94:95], v250 offset:9216
    ds_read_b64_tr_b16 a[116:117], v249 offset:9248
    v_mfma_f32_16x16x32_bf16 v[162:165], a[244:247], a[96:99], 0
    ds_read_b64_tr_b16 a[118:119], v250 offset:9248
    ds_read_b64_tr_b16 a[140:141], v249 offset:9280
    v_mfma_f32_16x16x32_bf16 v[24:27], a[244:247], a[120:123], 0
    ds_read_b64_tr_b16 a[142:143], v250 offset:9280
    buffer_load_dwordx4 v172, s[8:11], s60 offen lds
    v_mfma_f32_16x16x32_bf16 v[84:87], a[216:219], a[76:79], v[84:87]
    ds_read_b128 a[240:243], v241 offset:33792
    ds_read_b128 a[244:247], v241 offset:35328
    v_mfma_f32_16x16x32_bf16 v[204:207], a[216:219], a[100:103], v[204:207]
    s_lshl1_add_u32 s58, s45, s43
    v_add_u32 v22, -12, v21
    v_cmp_lt_u32 vcc, 11, v21
    v_mfma_f32_16x16x32_bf16 v[208:211], a[216:219], a[124:127], v[208:211]
    ds_read_b128 a[216:219], v240 offset:128
    v_cndmask_b32 v22, v21, v22, vcc
    v_mfma_f32_16x16x32_bf16 v[212:215], a[220:223], a[76:79], v[212:215]
    s_add_u32 s64, s64, s37
    v_mov_b32 v23, s34
    v_cndmask_b32 v23, 0, v23, vcc
    v_mfma_f32_16x16x32_bf16 v[216:219], a[220:223], a[100:103], v[216:219]
    s_waitcnt lgkmcnt(9)
    v_add_u32 v63, 0, v20
    v_add3_u32 v64, v22, v63, -6
    v_mfma_f32_16x16x32_bf16 v[220:223], a[220:223], a[124:127], v[220:223]
    ds_read_b128 a[220:223], v240 offset:1664
    v_add_u32 v65, 3, v64
    v_mfma_f32_16x16x32_bf16 v[224:227], a[224:227], a[76:79], v[224:227]
    buffer_load_dwordx4 v173, s[8:11], s60 offen offset:1024 lds
    v_and_b32 v66, 12, v22
    v_mfma_f32_16x16x32_bf16 v[180:183], a[224:227], a[100:103], v[180:183]
    v_add3_u32 v66, v66, v63, -3
    v_cmp_ne_u32 vcc, 0, v23
    v_mfma_f32_16x16x32_bf16 v[184:187], a[224:227], a[124:127], v[184:187]
    ds_read_b128 a[224:227], v240 offset:3200
    v_cndmask_b32 v65, v65, v66, vcc
    v_mfma_f32_16x16x32_bf16 v[188:191], a[228:231], a[76:79], v[188:191]
    s_waitcnt lgkmcnt(4)
    v_cmp_gt_u32 vcc, 7, v65
    v_mul_i32_i24 v64, s66, v64
    v_mfma_f32_16x16x32_bf16 v[192:195], a[228:231], a[100:103], v[192:195]
    s_waitcnt lgkmcnt(3)
    v_add_lshl_u32 v64, v64, 6, 1
    v_cndmask_b32 v50, 0, v64, vcc
    v_mfma_f32_16x16x32_bf16 v[196:199], a[228:231], a[124:127], v[196:199]
    ds_read_b128 a[228:231], v240 offset:4736
    v_mov_b32 v64, 0x3fb8aa3b
    v_mfma_f32_16x16x32_bf16 v[200:203], a[232:235], a[76:79], v[200:203]
    s_waitcnt lgkmcnt(3)
    s_waitcnt vmcnt(10)
    s_barrier
    v_mfma_f32_16x16x32_bf16 v[228:231], a[232:235], a[100:103], v[228:231]
    buffer_load_dwordx4 v174, s[8:11], s60 offen offset:2048 lds
    s_add_u32 m0, s29, 0xc00
    v_mfma_f32_16x16x32_bf16 v[232:235], a[232:235], a[124:127], v[232:235]
    s_add_u32 s60, s39, 0x24000
    ds_read_b128 a[232:235], v240 offset:30848
    v_mfma_f32_16x16x32_bf16 v[236:239], a[236:239], a[76:79], v[236:239]
    s_waitcnt lgkmcnt(3)
    v_cndmask_b32 v52, 0, v64, vcc
    v_mov_b32 v64, 0
    v_mfma_f32_16x16x32_bf16 v[138:141], a[236:239], a[100:103], v[138:141]
    v_mov_b32 v65, 0xf149f2ca
    v_cndmask_b32 v60, v65, v64, vcc
    v_mfma_f32_16x16x32_bf16 v[142:145], a[236:239], a[124:127], v[142:145]
    ds_read_b128 a[236:239], v240 offset:32384
    v_add_u32 v63, 1, v20
    v_mfma_f32_16x16x32_bf16 v[146:149], a[240:243], a[76:79], v[146:149]
    s_waitcnt lgkmcnt(3)
    v_add3_u32 v64, v22, v63, -6
    v_add_u32 v65, 3, v64
    v_mfma_f32_16x16x32_bf16 v[150:153], a[240:243], a[100:103], v[150:153]
    v_and_b32 v66, 12, v22
    v_add3_u32 v66, v66, v63, -3
    v_mfma_f32_16x16x32_bf16 v[154:157], a[240:243], a[124:127], v[154:157]
    buffer_load_dwordx4 v172, s[8:11], s61 offen lds
    ds_read_b128 a[240:243], v240 offset:33920
    v_mfma_f32_16x16x32_bf16 v[158:161], a[244:247], a[76:79], v[158:161]
    s_waitcnt lgkmcnt(3)
    v_cmp_ne_u32 vcc, 0, v23
    v_mul_i32_i24 v64, s66, v64
    v_mfma_f32_16x16x32_bf16 v[162:165], a[244:247], a[100:103], v[162:165]
    s_mul_i32 s66, s28, 0xffffee00
    v_cndmask_b32 v65, v65, v66, vcc
    v_cmp_gt_u32 vcc, 7, v65
    v_mfma_f32_16x16x32_bf16 v[24:27], a[244:247], a[124:127], v[24:27]
    ds_read_b128 a[244:247], v240 offset:35456
    v_add_lshl_u32 v64, v64, 6, 1
    v_mfma_f32_16x16x32_bf16 v[84:87], a[216:219], a[80:83], v[84:87]
    s_waitcnt lgkmcnt(3)
    v_cndmask_b32 v51, 0, v64, vcc
    v_mov_b32 v64, 0x3fb8aa3b
    v_mfma_f32_16x16x32_bf16 v[204:207], a[216:219], a[104:107], v[204:207]
    v_cndmask_b32 v53, 0, v64, vcc
    v_mov_b32 v64, 0
    v_mfma_f32_16x16x32_bf16 v[208:211], a[216:219], a[128:131], v[208:211]
    ds_read_b128 a[216:219], v241 offset:128
    v_mov_b32 v65, 0xf149f2ca
    v_mfma_f32_16x16x32_bf16 v[212:215], a[220:223], a[80:83], v[212:215]
    s_waitcnt lgkmcnt(3)
    v_cndmask_b32 v61, v65, v64, vcc
    s_mov_b32 vcc_lo, 0xcccccccc
    v_mfma_f32_16x16x32_bf16 v[216:219], a[220:223], a[104:107], v[216:219]
    s_mov_b32 vcc_hi, 0xcccccccc
    v_add_u32 v50, s64, v50
    v_add_u32 v51, s64, v51
    v_mfma_f32_16x16x32_bf16 v[220:223], a[220:223], a[128:131], v[220:223]
    ds_read_b128 a[220:223], v241 offset:1664
    ds_read_u16 v30, v50 offset:3456
    v_mfma_f32_16x16x32_bf16 v[224:227], a[224:227], a[80:83], v[224:227]
    ds_read_u16 v31, v51 offset:3456
    ds_read_u16 v32, v50 offset:3482
    v_mfma_f32_16x16x32_bf16 v[180:183], a[224:227], a[104:107], v[180:183]
    ds_read_u16 v33, v51 offset:3482
    ds_read_u16 v34, v50 offset:3508
    v_mfma_f32_16x16x32_bf16 v[184:187], a[224:227], a[128:131], v[184:187]
    ds_read_b128 a[224:227], v241 offset:3200
    ds_read_u16 v35, v51 offset:3508
    v_mfma_f32_16x16x32_bf16 v[188:191], a[228:231], a[80:83], v[188:191]
    ds_read_u16 v36, v50 offset:3534
    ds_read_u16 v37, v51 offset:3534
    v_mfma_f32_16x16x32_bf16 v[192:195], a[228:231], a[104:107], v[192:195]
    ds_read_u16 v38, v50 offset:3560
    ds_read_u16 v39, v51 offset:3560
    v_mfma_f32_16x16x32_bf16 v[196:199], a[228:231], a[128:131], v[196:199]
    ds_read_b128 a[228:231], v241 offset:4736
    ds_read_u16 v40, v50 offset:3586
    v_mfma_f32_16x16x32_bf16 v[200:203], a[232:235], a[80:83], v[200:203]
    s_waitcnt lgkmcnt(14)
    v_mov_b32 v64, 0xf149f2ca
    v_mov_b32 v65, 0xf149f2ca
    v_mfma_f32_16x16x32_bf16 v[228:231], a[232:235], a[104:107], v[228:231]
    ds_read_u16 v41, v51 offset:3586
    ds_read_u16 v42, v50 offset:3612
    v_mfma_f32_16x16x32_bf16 v[232:235], a[232:235], a[128:131], v[232:235]
    ds_read_b128 a[232:235], v241 offset:30848
    ds_read_u16 v43, v51 offset:3612
    v_mfma_f32_16x16x32_bf16 v[236:239], a[236:239], a[80:83], v[236:239]
    ds_read_u16 v44, v50 offset:3638
    ds_read_u16 v45, v51 offset:3638
    v_mfma_f32_16x16x32_bf16 v[138:141], a[236:239], a[104:107], v[138:141]
    ds_read_u16 v46, v50 offset:3664
    ds_read_u16 v47, v51 offset:3664
    v_mfma_f32_16x16x32_bf16 v[142:145], a[236:239], a[128:131], v[142:145]
    ds_read_b128 a[236:239], v241 offset:32384
    ds_read_u16 v48, v50 offset:3690
    v_mfma_f32_16x16x32_bf16 v[146:149], a[240:243], a[80:83], v[146:149]
    ds_read_u16 v49, v51 offset:3690
    s_waitcnt lgkmcnt(13)
    v_mfma_f32_16x16x32_bf16 v[150:153], a[240:243], a[104:107], v[150:153]
    s_waitcnt lgkmcnt(12)
    v_lshlrev_b32 v30, 16, v30
    v_fma_f32 v30, v30, v52, v60
    v_mfma_f32_16x16x32_bf16 v[154:157], a[240:243], a[128:131], v[154:157]
    ds_read_b128 a[240:243], v241 offset:33920
    v_lshlrev_b32 v31, 16, v31
    v_mfma_f32_16x16x32_bf16 v[158:161], a[244:247], a[80:83], v[158:161]
    s_waitcnt lgkmcnt(11)
    v_fma_f32 v31, v31, v53, v61
    v_lshlrev_b32 v32, 16, v32
    v_mfma_f32_16x16x32_bf16 v[162:165], a[244:247], a[104:107], v[162:165]
    ds_write_b64 v62, v[30:31] offset:0
    v_mfma_f32_16x16x32_bf16 v[24:27], a[244:247], a[128:131], v[24:27]
    ds_read_b128 a[244:247], v241 offset:35456
    v_add_u32 v62, s49, v62
    v_mfma_f32_16x16x32_bf16 v[84:87], a[216:219], a[84:87], v[84:87]
    s_waitcnt lgkmcnt(7)
    v_fma_f32 v32, v32, v52, v60
    v_lshlrev_b32 v33, 16, v33
    v_mfma_f32_16x16x32_bf16 v[204:207], a[216:219], a[108:111], v[204:207]
    s_waitcnt lgkmcnt(6)
    v_fma_f32 v33, v33, v53, v61
    v_lshlrev_b32 v34, 16, v34
    v_mfma_f32_16x16x32_bf16 v[208:211], a[216:219], a[132:135], v[208:211]
    ds_read_b128 a[216:219], v240 offset:256
    v_fma_f32 v34, v34, v52, v60
    v_mfma_f32_16x16x32_bf16 v[212:215], a[220:223], a[84:87], v[212:215]
    ds_write_b64 v62, v[32:33] offset:0
    v_mfma_f32_16x16x32_bf16 v[216:219], a[220:223], a[108:111], v[216:219]
    s_waitcnt lgkmcnt(4)
    v_add_u32 v62, s49, v62
    v_lshlrev_b32 v35, 16, v35
    v_mfma_f32_16x16x32_bf16 v[220:223], a[220:223], a[132:135], v[220:223]
    ds_read_b128 a[220:223], v240 offset:1792
    v_fma_f32 v35, v35, v53, v61
    v_mfma_f32_16x16x32_bf16 v[224:227], a[224:227], a[84:87], v[224:227]
    ds_write_b64 v62, v[34:35] offset:0
    v_mfma_f32_16x16x32_bf16 v[180:183], a[224:227], a[108:111], v[180:183]
    s_waitcnt lgkmcnt(4)
    v_add_u32 v62, s49, v62
    v_lshlrev_b32 v36, 16, v36
    v_mfma_f32_16x16x32_bf16 v[184:187], a[224:227], a[132:135], v[184:187]
    ds_read_b128 a[224:227], v240 offset:3328
    v_fma_f32 v36, v36, v52, v60
    v_mfma_f32_16x16x32_bf16 v[188:191], a[228:231], a[84:87], v[188:191]
    v_lshlrev_b32 v37, 16, v37
    v_fma_f32 v37, v37, v53, v61
    v_mfma_f32_16x16x32_bf16 v[192:195], a[228:231], a[108:111], v[192:195]
    ds_write_b64 v62, v[36:37] offset:0
    v_mfma_f32_16x16x32_bf16 v[196:199], a[228:231], a[132:135], v[196:199]
    ds_read_b128 a[228:231], v240 offset:4864
    v_add_u32 v62, s49, v62
    v_mfma_f32_16x16x32_bf16 v[200:203], a[232:235], a[84:87], v[200:203]
    s_waitcnt lgkmcnt(6)
    v_lshlrev_b32 v38, 16, v38
    v_fma_f32 v38, v38, v52, v60
    v_mfma_f32_16x16x32_bf16 v[228:231], a[232:235], a[108:111], v[228:231]
    s_waitcnt lgkmcnt(4)
    v_lshlrev_b32 v39, 16, v39
    v_fma_f32 v39, v39, v53, v61
    v_mfma_f32_16x16x32_bf16 v[232:235], a[232:235], a[132:135], v[232:235]
    ds_read_b128 a[232:235], v240 offset:30976
    v_lshlrev_b32 v40, 16, v40
    v_mfma_f32_16x16x32_bf16 v[236:239], a[236:239], a[84:87], v[236:239]
    ds_write_b64 v62, v[38:39] offset:0
    v_mfma_f32_16x16x32_bf16 v[138:141], a[236:239], a[108:111], v[138:141]
    s_waitcnt lgkmcnt(4)
    v_add_u32 v62, s49, v62
    v_fma_f32 v40, v40, v52, v60
    v_mfma_f32_16x16x32_bf16 v[142:145], a[236:239], a[132:135], v[142:145]
    ds_read_b128 a[236:239], v240 offset:32512
    v_lshlrev_b32 v41, 16, v41
    v_mfma_f32_16x16x32_bf16 v[146:149], a[240:243], a[84:87], v[146:149]
    v_fma_f32 v41, v41, v53, v61
    v_lshlrev_b32 v42, 16, v42
    v_mfma_f32_16x16x32_bf16 v[150:153], a[240:243], a[108:111], v[150:153]
    ds_write_b64 v62, v[40:41] offset:0
    v_mfma_f32_16x16x32_bf16 v[154:157], a[240:243], a[132:135], v[154:157]
    ds_read_b128 a[240:243], v240 offset:34048
    v_add_u32 v62, s49, v62
    v_mfma_f32_16x16x32_bf16 v[158:161], a[244:247], a[84:87], v[158:161]
    s_waitcnt lgkmcnt(5)
    v_fma_f32 v42, v42, v52, v60
    v_lshlrev_b32 v43, 16, v43
    v_mfma_f32_16x16x32_bf16 v[162:165], a[244:247], a[108:111], v[162:165]
    s_waitcnt lgkmcnt(4)
    v_fma_f32 v43, v43, v53, v61
    v_lshlrev_b32 v44, 16, v44
    v_mfma_f32_16x16x32_bf16 v[24:27], a[244:247], a[132:135], v[24:27]
    ds_read_b128 a[244:247], v240 offset:35584
    v_fma_f32 v44, v44, v52, v60
    v_mfma_f32_16x16x32_bf16 v[84:87], a[216:219], a[88:91], v[84:87]
    ds_write_b64 v62, v[42:43] offset:0
    v_mfma_f32_16x16x32_bf16 v[204:207], a[216:219], a[112:115], v[204:207]
    s_waitcnt lgkmcnt(4)
    v_add_u32 v62, s49, v62
    v_lshlrev_b32 v45, 16, v45
    v_mfma_f32_16x16x32_bf16 v[208:211], a[216:219], a[136:139], v[208:211]
    ds_read_b128 a[216:219], v241 offset:256
    v_fma_f32 v45, v45, v53, v61
    v_mfma_f32_16x16x32_bf16 v[212:215], a[220:223], a[88:91], v[212:215]
    ds_write_b64 v62, v[44:45] offset:0
    v_mfma_f32_16x16x32_bf16 v[216:219], a[220:223], a[112:115], v[216:219]
    s_waitcnt lgkmcnt(4)
    v_add_u32 v62, s49, v62
    v_lshlrev_b32 v46, 16, v46
    v_mfma_f32_16x16x32_bf16 v[220:223], a[220:223], a[136:139], v[220:223]
    ds_read_b128 a[220:223], v241 offset:1792
    v_fma_f32 v46, v46, v52, v60
    v_mfma_f32_16x16x32_bf16 v[224:227], a[224:227], a[88:91], v[224:227]
    v_lshlrev_b32 v47, 16, v47
    v_fma_f32 v47, v47, v53, v61
    v_mfma_f32_16x16x32_bf16 v[180:183], a[224:227], a[112:115], v[180:183]
    ds_write_b64 v62, v[46:47] offset:0
    v_mfma_f32_16x16x32_bf16 v[184:187], a[224:227], a[136:139], v[184:187]
    ds_read_b128 a[224:227], v241 offset:3328
    v_add_u32 v62, s49, v62
    v_mfma_f32_16x16x32_bf16 v[188:191], a[228:231], a[88:91], v[188:191]
    s_waitcnt lgkmcnt(6)
    v_lshlrev_b32 v48, 16, v48
    v_fma_f32 v48, v48, v52, v60
    v_mfma_f32_16x16x32_bf16 v[192:195], a[228:231], a[112:115], v[192:195]
    s_waitcnt lgkmcnt(4)
    v_lshlrev_b32 v49, 16, v49
    v_fma_f32 v49, v49, v53, v61
    v_mfma_f32_16x16x32_bf16 v[196:199], a[228:231], a[136:139], v[196:199]
    ds_read_b128 a[228:231], v241 offset:4864
    v_lshlrev_b32 v63, 3, v1
    v_mfma_f32_16x16x32_bf16 v[200:203], a[232:235], a[88:91], v[200:203]
    ds_write_b64 v62, v[48:49] offset:0
    v_mfma_f32_16x16x32_bf16 v[228:231], a[232:235], a[112:115], v[228:231]
    s_waitcnt lgkmcnt(4)
    v_add_u32 v62, s49, v62
    v_add_u32 v63, 0x237c0, v63
    v_mfma_f32_16x16x32_bf16 v[232:235], a[232:235], a[136:139], v[232:235]
    ds_read_b128 a[232:235], v241 offset:30976
    v_mfma_f32_16x16x32_bf16 v[236:239], a[236:239], a[88:91], v[236:239]
    ds_write_b64 v63, v[64:65] offset:0
    v_mfma_f32_16x16x32_bf16 v[138:141], a[236:239], a[112:115], v[138:141]
    s_waitcnt lgkmcnt(4)
    v_mfma_f32_16x16x32_bf16 v[142:145], a[236:239], a[136:139], v[142:145]
    ds_read_b128 a[236:239], v241 offset:32512
    v_mfma_f32_16x16x32_bf16 v[146:149], a[240:243], a[88:91], v[146:149]
    v_mfma_f32_16x16x32_bf16 v[150:153], a[240:243], a[112:115], v[150:153]
    s_waitcnt lgkmcnt(4)
    v_mfma_f32_16x16x32_bf16 v[154:157], a[240:243], a[136:139], v[154:157]
    ds_read_b128 a[240:243], v241 offset:34048
    v_mfma_f32_16x16x32_bf16 v[158:161], a[244:247], a[88:91], v[158:161]
    v_mfma_f32_16x16x32_bf16 v[162:165], a[244:247], a[112:115], v[162:165]
    s_waitcnt lgkmcnt(3)
    v_mfma_f32_16x16x32_bf16 v[24:27], a[244:247], a[136:139], v[24:27]
    ds_read_b128 a[244:247], v241 offset:35584
    v_mfma_f32_16x16x32_bf16 v[84:87], a[216:219], a[92:95], v[84:87]
    v_mfma_f32_16x16x32_bf16 v[204:207], a[216:219], a[116:119], v[204:207]
    v_mfma_f32_16x16x32_bf16 v[208:211], a[216:219], a[140:143], v[208:211]
    ds_read_b128 a[216:219], v240 offset:6144
    s_waitcnt lgkmcnt(3)
    v_mfma_f32_16x16x32_bf16 v[212:215], a[220:223], a[92:95], v[212:215]
    v_mfma_f32_16x16x32_bf16 v[216:219], a[220:223], a[116:119], v[216:219]
    v_mfma_f32_16x16x32_bf16 v[220:223], a[220:223], a[140:143], v[220:223]
    ds_read_b128 a[220:223], v241 offset:6144
    v_cvt_pk_bf16_f32 v0, v84, v85
    v_mfma_f32_16x16x32_bf16 v[224:227], a[224:227], a[92:95], v[224:227]
    s_waitcnt lgkmcnt(3)
    v_cvt_pk_bf16_f32 v3, v86, v87
    v_cvt_pk_bf16_f32 v30, v204, v205
    v_mfma_f32_16x16x32_bf16 v[180:183], a[224:227], a[116:119], v[180:183]
    v_cvt_pk_bf16_f32 v33, v206, v207
    v_cvt_pk_bf16_f32 v60, v208, v209
    v_mfma_f32_16x16x32_bf16 v[184:187], a[224:227], a[140:143], v[184:187]
    s_waitcnt lgkmcnt(2)
    v_cvt_pk_bf16_f32 v63, v210, v211
    v_cvt_pk_bf16_f32 v6, v212, v213
    v_mfma_f32_16x16x32_bf16 v[188:191], a[228:231], a[92:95], v[188:191]
    v_cvt_pk_bf16_f32 v9, v214, v215
    v_cvt_pk_bf16_f32 v36, v216, v217
    v_mfma_f32_16x16x32_bf16 v[192:195], a[228:231], a[116:119], v[192:195]
    v_cvt_pk_bf16_f32 v39, v218, v219
    v_cvt_pk_bf16_f32 v66, v220, v221
    v_mfma_f32_16x16x32_bf16 v[196:199], a[228:231], a[140:143], v[196:199]
    v_cvt_pk_bf16_f32 v69, v222, v223
    v_cvt_pk_bf16_f32 v12, v224, v225
    v_mfma_f32_16x16x32_bf16 v[200:203], a[232:235], a[92:95], v[200:203]
    v_cvt_pk_bf16_f32 v15, v226, v227
    v_cvt_pk_bf16_f32 v42, v180, v181
    v_mfma_f32_16x16x32_bf16 v[228:231], a[232:235], a[116:119], v[228:231]
    v_cvt_pk_bf16_f32 v45, v182, v183
    v_cvt_pk_bf16_f32 v72, v184, v185
    v_mfma_f32_16x16x32_bf16 v[232:235], a[232:235], a[140:143], v[232:235]
    v_cvt_pk_bf16_f32 v75, v186, v187
    v_cvt_pk_bf16_f32 v18, v188, v189
    v_mfma_f32_16x16x32_bf16 v[236:239], a[236:239], a[92:95], v[236:239]
    v_cvt_pk_bf16_f32 v21, v190, v191
    v_cvt_pk_bf16_f32 v48, v192, v193
    v_mfma_f32_16x16x32_bf16 v[138:141], a[236:239], a[116:119], v[138:141]
    v_cvt_pk_bf16_f32 v51, v194, v195
    v_cvt_pk_bf16_f32 v78, v196, v197
    v_mfma_f32_16x16x32_bf16 v[142:145], a[236:239], a[140:143], v[142:145]
    v_cvt_pk_bf16_f32 v81, v198, v199
    v_cvt_pk_bf16_f32 v1, v200, v201
    v_mfma_f32_16x16x32_bf16 v[146:149], a[240:243], a[92:95], v[146:149]
    v_cvt_pk_bf16_f32 v4, v202, v203
    v_cvt_pk_bf16_f32 v31, v228, v229
    v_mfma_f32_16x16x32_bf16 v[150:153], a[240:243], a[116:119], v[150:153]
    v_cvt_pk_bf16_f32 v34, v230, v231
    v_cvt_pk_bf16_f32 v61, v232, v233
    v_mfma_f32_16x16x32_bf16 v[154:157], a[240:243], a[140:143], v[154:157]
    buffer_load_dwordx4 v173, s[8:11], s61 offen offset:1024 lds
    v_cvt_pk_bf16_f32 v64, v234, v235
    v_mfma_f32_16x16x32_bf16 v[158:161], a[244:247], a[92:95], v[158:161]
    s_waitcnt lgkmcnt(0)
    v_cvt_pk_bf16_f32 v7, v236, v237
    v_cvt_pk_bf16_f32 v10, v238, v239
    v_mfma_f32_16x16x32_bf16 v[162:165], a[244:247], a[116:119], v[162:165]
    v_cvt_pk_bf16_f32 v37, v138, v139
    v_cvt_pk_bf16_f32 v40, v140, v141
    v_mfma_f32_16x16x32_bf16 v[24:27], a[244:247], a[140:143], v[24:27]
    v_cvt_pk_bf16_f32 v67, v142, v143
    v_cvt_pk_bf16_f32 v70, v144, v145
    v_mfma_f32_16x16x32_bf16 v[228:231], a[0:3], a[216:219], 0
    v_cvt_pk_bf16_f32 v13, v146, v147
    v_cvt_pk_bf16_f32 v16, v148, v149
    v_mfma_f32_16x16x32_bf16 v[228:231], a[4:7], a[220:223], v[228:231]
    v_cvt_pk_bf16_f32 v43, v150, v151
    v_cvt_pk_bf16_f32 v46, v152, v153
    v_mfma_f32_16x16x32_bf16 v[232:235], a[24:27], a[216:219], 0
    v_cvt_pk_bf16_f32 v73, v154, v155
    v_cvt_pk_bf16_f32 v76, v156, v157
    v_mfma_f32_16x16x32_bf16 v[232:235], a[28:31], a[220:223], v[232:235]
    buffer_load_dwordx4 v174, s[8:11], s61 offen offset:2048 lds
    s_add_u32 m0, s29, 0x1800
    v_mfma_f32_16x16x32_bf16 v[236:239], a[48:51], a[216:219], 0
    s_add_u32 s61, s39, 0x2d000
    v_cvt_pk_bf16_f32 v19, v158, v159
    v_cvt_pk_bf16_f32 v22, v160, v161
    v_mfma_f32_16x16x32_bf16 v[236:239], a[52:55], a[220:223], v[236:239]
    v_cvt_pk_bf16_f32 v49, v162, v163
    v_cvt_pk_bf16_f32 v52, v164, v165
    v_cvt_pk_bf16_f32 v79, v24, v25
    v_cvt_pk_bf16_f32 v82, v26, v27
    ds_read_b128 a[224:227], v240 offset:6272
    ds_read_b128 a[228:231], v241 offset:6272
    ds_read_b128 a[232:235], v240 offset:6400
    ds_read_b128 a[236:239], v241 offset:6400
    ds_read_b128 a[240:243], v240 offset:36864
    ds_read_b128 a[244:247], v241 offset:36864
    ds_read_b128 v[196:199], v244 offset:192
    ds_read_b128 v[200:203], v245 offset:192
    ds_read_b128 v[204:207], v246 offset:192
    ds_read_b128 v[208:211], v244 offset:256
    buffer_load_dwordx4 v172, s[8:11], s62 offen lds
    v_mov_b32 v195, 0
    s_waitcnt lgkmcnt(9)
    v_mfma_f32_16x16x32_bf16 v[228:231], a[8:11], a[224:227], v[228:231]
    s_waitcnt vmcnt(10)
    s_barrier
    s_waitcnt lgkmcnt(8)
    v_mfma_f32_16x16x32_bf16 v[228:231], a[12:15], a[228:231], v[228:231]
    v_mfma_f32_16x16x32_bf16 v[232:235], a[32:35], a[224:227], v[232:235]
    buffer_load_dwordx4 v173, s[8:11], s62 offen offset:1024 lds
    s_waitcnt lgkmcnt(7)
    v_mfma_f32_16x16x32_bf16 v[228:231], a[16:19], a[232:235], v[228:231]
    s_waitcnt lgkmcnt(6)
    v_mfma_f32_16x16x32_bf16 v[228:231], a[20:23], a[236:239], v[228:231]
    v_mfma_f32_16x16x32_bf16 v[232:235], a[36:39], a[228:231], v[232:235]
    v_mfma_f32_16x16x32_bf16 v[232:235], a[40:43], a[232:235], v[232:235]
    v_mfma_f32_16x16x32_bf16 v[232:235], a[44:47], a[236:239], v[232:235]
    v_mfma_f32_16x16x32_bf16 v[236:239], a[56:59], a[224:227], v[236:239]
    v_mfma_f32_16x16x32_bf16 v[236:239], a[60:63], a[228:231], v[236:239]
    buffer_load_dwordx4 v174, s[8:11], s62 offen offset:2048 lds
    s_add_u32 m0, s29, 0x2400
    v_mfma_f32_16x16x32_bf16 v[236:239], a[64:67], a[232:235], v[236:239]
    s_lshl_b32 s62, s28, 5
    s_add_u32 s62, s62, 0
    v_cvt_pk_bf16_f32 v138, v228, v229
    v_mfma_f32_16x16x32_bf16 v[236:239], a[68:71], a[236:239], v[236:239]
    v_cvt_pk_bf16_f32 v139, v230, v231
    v_cvt_pk_bf16_f32 v140, v232, v233
    v_mfma_f32_16x16x32_bf16 v[228:231], a[216:219], a[72:75], 0
    v_cvt_pk_bf16_f32 v141, v234, v235
    v_mfma_f32_16x16x32_bf16 v[228:231], a[220:223], a[76:79], v[228:231]
    v_mfma_f32_16x16x32_bf16 v[228:231], a[224:227], a[80:83], v[228:231]
    v_mfma_f32_16x16x32_bf16 v[228:231], a[228:231], a[84:87], v[228:231]
    v_mfma_f32_16x16x32_bf16 v[228:231], a[232:235], a[88:91], v[228:231]
    buffer_load_dwordx4 v172, s[8:11], s63 offen lds
    v_cvt_pk_bf16_f32 v142, v236, v237
    v_mfma_f32_16x16x32_bf16 v[228:231], a[236:239], a[92:95], v[228:231]
    v_cvt_pk_bf16_f32 v143, v238, v239
    v_mfma_f32_16x16x32_bf16 v[232:235], a[216:219], a[96:99], 0
    v_mfma_f32_16x16x32_bf16 v[232:235], a[220:223], a[100:103], v[232:235]
    v_mfma_f32_16x16x32_bf16 v[232:235], a[224:227], a[104:107], v[232:235]
    v_mfma_f32_16x16x32_bf16 v[232:235], a[228:231], a[108:111], v[232:235]
    v_mfma_f32_16x16x32_bf16 v[232:235], a[232:235], a[112:115], v[232:235]
    v_mfma_f32_16x16x32_bf16 v[232:235], a[236:239], a[116:119], v[232:235]
    buffer_load_dwordx4 v173, s[8:11], s63 offen offset:1024 lds
    v_cvt_pk_bf16_f32 v24, v228, v229
    v_mfma_f32_16x16x32_bf16 v[236:239], a[216:219], a[120:123], 0
    ds_read_b128 a[216:219], v240 offset:36992
    v_cvt_pk_bf16_f32 v27, v230, v231
    v_mfma_f32_16x16x32_bf16 v[236:239], a[220:223], a[124:127], v[236:239]
    ds_read_b128 a[220:223], v241 offset:36992
    s_waitcnt lgkmcnt(2)
    v_mfma_f32_16x16x32_bf16 v[236:239], a[224:227], a[128:131], v[236:239]
    s_waitcnt vmcnt(8)
    ds_read_b64_tr_b16 a[144:145], v249 offset:0
    v_mfma_f32_16x16x32_bf16 v[236:239], a[228:231], a[132:135], v[236:239]
    ds_read_b64_tr_b16 a[146:147], v250 offset:0
    ds_read_b64_tr_b16 a[168:169], v249 offset:32
    v_mfma_f32_16x16x32_bf16 v[236:239], a[232:235], a[136:139], v[236:239]
    ds_read_b64_tr_b16 a[170:171], v250 offset:32
    ds_read_b64_tr_b16 a[192:193], v249 offset:64
    v_mfma_f32_16x16x32_bf16 v[236:239], a[236:239], a[140:143], v[236:239]
    ds_read_b64_tr_b16 a[194:195], v250 offset:64
    buffer_load_dwordx4 v174, s[8:11], s63 offen offset:2048 lds
    v_mfma_f32_16x16x32_bf16 v[228:231], a[0:3], a[240:243], 0
    s_add_u32 m0, s29, 0
    s_lshl_b32 s63, s28, 5
    s_add_u32 s63, s63, 0x4800
    v_mfma_f32_16x16x32_bf16 v[228:231], a[4:7], a[244:247], v[228:231]
    v_cvt_pk_bf16_f32 v54, v232, v233
    v_cvt_pk_bf16_f32 v57, v234, v235
    v_mfma_f32_16x16x32_bf16 v[232:235], a[24:27], a[240:243], 0
    s_waitcnt lgkmcnt(7)
    v_cvt_pk_bf16_f32 v84, v236, v237
    v_cvt_pk_bf16_f32 v87, v238, v239
    v_mfma_f32_16x16x32_bf16 v[228:231], a[8:11], a[216:219], v[228:231]
    ds_read_b128 a[224:227], v240 offset:37120
    ds_read_b128 a[228:231], v241 offset:37120
    v_mfma_f32_16x16x32_bf16 v[232:235], a[28:31], a[244:247], v[232:235]
    ds_read_b128 a[232:235], v240 offset:61440
    ds_read_b128 a[236:239], v241 offset:61440
    v_mfma_f32_16x16x32_bf16 v[232:235], a[32:35], a[216:219], v[232:235]
    s_waitcnt lgkmcnt(10)
    v_mfma_f32_16x16x32_bf16 v[228:231], a[12:15], a[220:223], v[228:231]
    v_mfma_f32_16x16x32_bf16 v[232:235], a[36:39], a[220:223], v[232:235]
    s_waitcnt lgkmcnt(4)
    buffer_load_dwordx4 v172, s[8:11], s60 offen lds
    v_mfma_f32_16x16x32_bf16 v[236:239], a[48:51], a[240:243], 0
    v_mfma_f32_16x16x32_bf16 v[236:239], a[52:55], a[244:247], v[236:239]
    s_waitcnt vmcnt(7)
    ds_read_b64_tr_b16 a[148:149], v249 offset:3072
    v_mfma_f32_16x16x32_bf16 v[236:239], a[56:59], a[216:219], v[236:239]
    ds_read_b64_tr_b16 a[150:151], v250 offset:3072
    ds_read_b64_tr_b16 a[172:173], v249 offset:3104
    v_mfma_f32_16x16x32_bf16 v[236:239], a[60:63], a[220:223], v[236:239]
    s_waitcnt lgkmcnt(6)
    ds_read_b64_tr_b16 a[174:175], v250 offset:3104
    v_mfma_f32_16x16x32_bf16 v[228:231], a[16:19], a[224:227], v[228:231]
    ds_read_b64_tr_b16 a[196:197], v249 offset:3136
    ds_read_b64_tr_b16 a[198:199], v250 offset:3136
    v_mfma_f32_16x16x32_bf16 v[232:235], a[40:43], a[224:227], v[232:235]
    s_waitcnt lgkmcnt(8)
    v_mfma_f32_16x16x32_bf16 v[228:231], a[20:23], a[228:231], v[228:231]
    buffer_load_dwordx4 v173, s[8:11], s60 offen offset:1024 lds
    v_mfma_f32_16x16x32_bf16 v[232:235], a[44:47], a[228:231], v[232:235]
    v_mfma_f32_16x16x32_bf16 v[236:239], a[64:67], a[224:227], v[236:239]
    v_mfma_f32_16x16x32_bf16 v[236:239], a[68:71], a[228:231], v[236:239]
    s_nop 3
    v_cvt_pk_bf16_f32 v144, v228, v229
    v_cvt_pk_bf16_f32 v145, v230, v231
    v_mfma_f32_16x16x32_bf16 v[228:231], a[240:243], a[72:75], 0
    v_cvt_pk_bf16_f32 v146, v232, v233
    v_cvt_pk_bf16_f32 v147, v234, v235
    v_mfma_f32_16x16x32_bf16 v[228:231], a[244:247], a[76:79], v[228:231]
    v_cvt_pk_bf16_f32 v148, v236, v237
    v_cvt_pk_bf16_f32 v149, v238, v239
    v_mfma_f32_16x16x32_bf16 v[228:231], a[216:219], a[80:83], v[228:231]
    buffer_load_dwordx4 v174, s[8:11], s60 offen offset:2048 lds
    s_add_u32 m0, s29, 0xc00
    v_mfma_f32_16x16x32_bf16 v[228:231], a[220:223], a[84:87], v[228:231]
    s_waitcnt lgkmcnt(0)
    s_lshl_b32 s60, s28, 5
    s_add_u32 s60, s60, 0x1800
    v_mfma_f32_16x16x32_bf16 v[228:231], a[224:227], a[88:91], v[228:231]
    v_mfma_f32_16x16x32_bf16 v[228:231], a[228:231], a[92:95], v[228:231]
    v_mfma_f32_16x16x32_bf16 v[232:235], a[240:243], a[96:99], 0
    v_mfma_f32_16x16x32_bf16 v[232:235], a[244:247], a[100:103], v[232:235]
    v_mfma_f32_16x16x32_bf16 v[232:235], a[216:219], a[104:107], v[232:235]
    v_mfma_f32_16x16x32_bf16 v[232:235], a[220:223], a[108:111], v[232:235]
    buffer_load_dwordx4 v172, s[8:11], s61 offen lds
    v_mfma_f32_16x16x32_bf16 v[232:235], a[224:227], a[112:115], v[232:235]
    s_waitcnt vmcnt(7)
    ds_read_b64_tr_b16 a[152:153], v249 offset:6144
    v_mfma_f32_16x16x32_bf16 v[232:235], a[228:231], a[116:119], v[232:235]
    ds_read_b64_tr_b16 a[154:155], v250 offset:6144
    ds_read_b64_tr_b16 a[176:177], v249 offset:6176
    v_mfma_f32_16x16x32_bf16 v[236:239], a[240:243], a[120:123], 0
    ds_read_b64_tr_b16 a[178:179], v250 offset:6176
    ds_read_b64_tr_b16 a[200:201], v249 offset:6208
    v_mfma_f32_16x16x32_bf16 v[236:239], a[244:247], a[124:127], v[236:239]
    ds_read_b64_tr_b16 a[202:203], v250 offset:6208
    v_cvt_pk_bf16_f32 v25, v228, v229
    v_mfma_f32_16x16x32_bf16 v[236:239], a[216:219], a[128:131], v[236:239]
    v_cvt_pk_bf16_f32 v28, v230, v231
    v_cvt_pk_bf16_f32 v55, v232, v233
    v_mfma_f32_16x16x32_bf16 v[236:239], a[220:223], a[132:135], v[236:239]
    ds_read_b128 a[240:243], v240 offset:61568
    buffer_load_dwordx4 v173, s[8:11], s61 offen offset:1024 lds
    v_mfma_f32_16x16x32_bf16 v[236:239], a[224:227], a[136:139], v[236:239]
    ds_read_b128 a[244:247], v241 offset:61568
    v_cvt_pk_bf16_f32 v58, v234, v235
    v_mfma_f32_16x16x32_bf16 v[236:239], a[228:231], a[140:143], v[236:239]
    ds_read_b128 a[216:219], v240 offset:61696
    ds_read_b128 a[220:223], v241 offset:61696
    v_mfma_f32_16x16x32_bf16 v[228:231], a[0:3], a[232:235], 0
    ds_read_b128 a[224:227], v240 offset:62976
    ds_read_b128 a[228:231], v241 offset:62976
    v_mfma_f32_16x16x32_bf16 v[228:231], a[4:7], a[236:239], v[228:231]
    v_mfma_f32_16x16x32_bf16 v[232:235], a[24:27], a[232:235], 0
    v_mfma_f32_16x16x32_bf16 v[232:235], a[28:31], a[236:239], v[232:235]
    v_cvt_pk_bf16_f32 v85, v236, v237
    v_cvt_pk_bf16_f32 v88, v238, v239
    v_mfma_f32_16x16x32_bf16 v[236:239], a[48:51], a[232:235], 0
    v_mfma_f32_16x16x32_bf16 v[236:239], a[52:55], a[236:239], v[236:239]
    s_waitcnt lgkmcnt(5)
    buffer_load_dwordx4 v174, s[8:11], s61 offen offset:2048 lds
    v_mfma_f32_16x16x32_bf16 v[228:231], a[8:11], a[240:243], v[228:231]
    s_lshl_b32 s61, s28, 5
    s_add_u32 s61, s61, 0x6000
    s_add_u32 m0, s46, 0x16800
    v_mfma_f32_16x16x32_bf16 v[232:235], a[32:35], a[240:243], v[232:235]
    s_waitcnt lgkmcnt(4)
    v_mfma_f32_16x16x32_bf16 v[228:231], a[12:15], a[244:247], v[228:231]
    s_waitcnt lgkmcnt(3)
    v_mfma_f32_16x16x32_bf16 v[228:231], a[16:19], a[216:219], v[228:231]
    s_waitcnt lgkmcnt(2)
    v_mfma_f32_16x16x32_bf16 v[228:231], a[20:23], a[220:223], v[228:231]
    v_mfma_f32_16x16x32_bf16 v[232:235], a[36:39], a[244:247], v[232:235]
    v_mfma_f32_16x16x32_bf16 v[232:235], a[40:43], a[216:219], v[232:235]
    s_waitcnt vmcnt(6)
    ds_read_b64_tr_b16 a[156:157], v249 offset:9216
    v_mfma_f32_16x16x32_bf16 v[232:235], a[44:47], a[220:223], v[232:235]
    ds_read_b64_tr_b16 a[158:159], v250 offset:9216
    ds_read_b64_tr_b16 a[180:181], v249 offset:9248
    v_mfma_f32_16x16x32_bf16 v[236:239], a[56:59], a[240:243], v[236:239]
    ds_read_b64_tr_b16 a[182:183], v250 offset:9248
    ds_read_b64_tr_b16 a[204:205], v249 offset:9280
    v_mfma_f32_16x16x32_bf16 v[236:239], a[60:63], a[244:247], v[236:239]
    ds_read_b64_tr_b16 a[206:207], v250 offset:9280
    v_cvt_pk_bf16_f32 v150, v228, v229
    v_mfma_f32_16x16x32_bf16 v[236:239], a[64:67], a[216:219], v[236:239]
    v_cvt_pk_bf16_f32 v151, v230, v231
    v_cvt_pk_bf16_f32 v152, v232, v233
    v_mfma_f32_16x16x32_bf16 v[236:239], a[68:71], a[220:223], v[236:239]
    v_cvt_pk_bf16_f32 v153, v234, v235
    v_mfma_f32_16x16x32_bf16 v[228:231], a[232:235], a[72:75], 0
    v_mfma_f32_16x16x32_bf16 v[228:231], a[236:239], a[76:79], v[228:231]
    v_mfma_f32_16x16x32_bf16 v[228:231], a[240:243], a[80:83], v[228:231]
    v_mfma_f32_16x16x32_bf16 v[228:231], a[244:247], a[84:87], v[228:231]
    v_mfma_f32_16x16x32_bf16 v[228:231], a[216:219], a[88:91], v[228:231]
    v_mfma_f32_16x16x32_bf16 v[228:231], a[220:223], a[92:95], v[228:231]
    v_mfma_f32_16x16x32_bf16 v[232:235], a[232:235], a[96:99], 0
    v_cvt_pk_bf16_f32 v154, v236, v237
    v_cvt_pk_bf16_f32 v155, v238, v239
    v_mfma_f32_16x16x32_bf16 v[232:235], a[236:239], a[100:103], v[232:235]
    v_mfma_f32_16x16x32_bf16 v[232:235], a[240:243], a[104:107], v[232:235]
    v_mfma_f32_16x16x32_bf16 v[232:235], a[244:247], a[108:111], v[232:235]
    v_mfma_f32_16x16x32_bf16 v[232:235], a[216:219], a[112:115], v[232:235]
    v_mfma_f32_16x16x32_bf16 v[232:235], a[220:223], a[116:119], v[232:235]
    v_cvt_pk_bf16_f32 v2, v228, v229
    v_cvt_pk_bf16_f32 v5, v230, v231
    v_mfma_f32_16x16x32_bf16 v[236:239], a[232:235], a[120:123], 0
    ds_read_b128 a[232:235], v240 offset:63104
    s_waitcnt lgkmcnt(1)
    v_mfma_f32_16x16x32_bf16 v[236:239], a[236:239], a[124:127], v[236:239]
    ds_read_b128 a[236:239], v241 offset:63104
    v_mfma_f32_16x16x32_bf16 v[236:239], a[240:243], a[128:131], v[236:239]
    v_cvt_pk_bf16_f32 v32, v232, v233
    v_cvt_pk_bf16_f32 v35, v234, v235
    v_mfma_f32_16x16x32_bf16 v[236:239], a[244:247], a[132:135], v[236:239]
    ds_read_b128 a[240:243], v240 offset:63232
    ds_read_b128 a[244:247], v241 offset:63232
    v_mfma_f32_16x16x32_bf16 v[236:239], a[216:219], a[136:139], v[236:239]
    s_waitcnt vmcnt(3)
    ds_read_b64_tr_b16 a[160:161], v249 offset:0
    v_mfma_f32_16x16x32_bf16 v[236:239], a[220:223], a[140:143], v[236:239]
    ds_read_b64_tr_b16 a[162:163], v250 offset:0
    ds_read_b64_tr_b16 a[184:185], v249 offset:32
    v_mfma_f32_16x16x32_bf16 v[228:231], a[0:3], a[224:227], 0
    ds_read_b64_tr_b16 a[186:187], v250 offset:32
    ds_read_b64_tr_b16 a[208:209], v249 offset:64
    v_mfma_f32_16x16x32_bf16 v[228:231], a[4:7], a[228:231], v[228:231]
    ds_read_b64_tr_b16 a[210:211], v250 offset:64
    ds_read_b128 a[216:219], v240 offset:64512
    v_mfma_f32_16x16x32_bf16 v[232:235], a[24:27], a[224:227], 0
    s_waitcnt lgkmcnt(10)
    v_cvt_pk_bf16_f32 v62, v236, v237
    v_cvt_pk_bf16_f32 v65, v238, v239
    v_mfma_f32_16x16x32_bf16 v[228:231], a[8:11], a[232:235], v[228:231]
    ds_read_b128 a[220:223], v241 offset:64512
    s_waitcnt lgkmcnt(10)
    v_mfma_f32_16x16x32_bf16 v[228:231], a[12:15], a[236:239], v[228:231]
    v_mfma_f32_16x16x32_bf16 v[232:235], a[28:31], a[228:231], v[232:235]
    s_waitcnt lgkmcnt(9)
    v_mfma_f32_16x16x32_bf16 v[228:231], a[16:19], a[240:243], v[228:231]
    s_waitcnt lgkmcnt(8)
    v_mfma_f32_16x16x32_bf16 v[228:231], a[20:23], a[244:247], v[228:231]
    v_mfma_f32_16x16x32_bf16 v[232:235], a[32:35], a[232:235], v[232:235]
    v_mfma_f32_16x16x32_bf16 v[232:235], a[36:39], a[236:239], v[232:235]
    v_mfma_f32_16x16x32_bf16 v[232:235], a[40:43], a[240:243], v[232:235]
    v_mfma_f32_16x16x32_bf16 v[232:235], a[44:47], a[244:247], v[232:235]
    v_mfma_f32_16x16x32_bf16 v[236:239], a[48:51], a[224:227], 0
    v_mfma_f32_16x16x32_bf16 v[236:239], a[52:55], a[228:231], v[236:239]
    v_mfma_f32_16x16x32_bf16 v[236:239], a[56:59], a[232:235], v[236:239]
    v_mfma_f32_16x16x32_bf16 v[236:239], a[60:63], a[236:239], v[236:239]
    v_cvt_pk_bf16_f32 v156, v228, v229
    v_cvt_pk_bf16_f32 v157, v230, v231
    v_mfma_f32_16x16x32_bf16 v[236:239], a[64:67], a[240:243], v[236:239]
    v_mfma_f32_16x16x32_bf16 v[236:239], a[68:71], a[244:247], v[236:239]
    v_cvt_pk_bf16_f32 v158, v232, v233
    v_cvt_pk_bf16_f32 v159, v234, v235
    v_mfma_f32_16x16x32_bf16 v[228:231], a[224:227], a[72:75], 0
    v_mfma_f32_16x16x32_bf16 v[228:231], a[228:231], a[76:79], v[228:231]
    s_waitcnt vmcnt(0)
    ds_read_b64_tr_b16 a[164:165], v249 offset:3072
    v_mfma_f32_16x16x32_bf16 v[228:231], a[232:235], a[80:83], v[228:231]
    ds_read_b64_tr_b16 a[166:167], v250 offset:3072
    ds_read_b64_tr_b16 a[188:189], v249 offset:3104
    v_mfma_f32_16x16x32_bf16 v[228:231], a[236:239], a[84:87], v[228:231]
    ds_read_b64_tr_b16 a[190:191], v250 offset:3104
    ds_read_b64_tr_b16 a[212:213], v249 offset:3136
    v_mfma_f32_16x16x32_bf16 v[228:231], a[240:243], a[88:91], v[228:231]
    ds_read_b64_tr_b16 a[214:215], v250 offset:3136
    v_cvt_pk_bf16_f32 v160, v236, v237
    v_mfma_f32_16x16x32_bf16 v[228:231], a[244:247], a[92:95], v[228:231]
    v_cvt_pk_bf16_f32 v161, v238, v239
    v_add_u32 v249, s66, v249
    v_mfma_f32_16x16x32_bf16 v[232:235], a[224:227], a[96:99], 0
    v_add_u32 v250, s66, v250
    s_lshl_b32 s66, s28, 1
    v_mfma_f32_16x16x32_bf16 v[232:235], a[228:231], a[100:103], v[232:235]
    v_mfma_f32_16x16x32_bf16 v[232:235], a[232:235], a[104:107], v[232:235]
    v_mfma_f32_16x16x32_bf16 v[232:235], a[236:239], a[108:111], v[232:235]
    v_cvt_pk_bf16_f32 v8, v228, v229
    v_cvt_pk_bf16_f32 v11, v230, v231
    v_mfma_f32_16x16x32_bf16 v[232:235], a[240:243], a[112:115], v[232:235]
    s_waitcnt lgkmcnt(6)
    v_mfma_f32_16x16x32_bf16 v[232:235], a[244:247], a[116:119], v[232:235]
    v_mfma_f32_16x16x32_bf16 v[236:239], a[224:227], a[120:123], 0
    ds_read_b128 a[224:227], v240 offset:64640
    s_waitcnt lgkmcnt(1)
    v_mfma_f32_16x16x32_bf16 v[236:239], a[228:231], a[124:127], v[236:239]
    ds_read_b128 a[228:231], v241 offset:64640
    s_barrier
    v_mfma_f32_16x16x32_bf16 v[236:239], a[232:235], a[128:131], v[236:239]
    ds_read_b128 a[232:235], v240 offset:64768
    v_cvt_pk_bf16_f32 v38, v232, v233
    v_mfma_f32_16x16x32_bf16 v[236:239], a[236:239], a[132:135], v[236:239]
    ds_read_b128 a[236:239], v241 offset:64768
    v_cvt_pk_bf16_f32 v41, v234, v235
    v_mfma_f32_16x16x32_bf16 v[236:239], a[240:243], a[136:139], v[236:239]
    ds_read_b128 a[240:243], v242 offset:0
    v_add_u32 v240, 0xf000, v240
    v_mfma_f32_16x16x32_bf16 v[236:239], a[244:247], a[140:143], v[236:239]
    ds_read_b128 a[244:247], v243 offset:0
    v_add_u32 v241, 0xf000, v241
    v_mfma_f32_16x16x32_bf16 v[228:231], a[0:3], a[216:219], 0
    buffer_load_dwordx4 v254, s[4:7], s43 offen lds
    v_accvgpr_read_b32 v254, a254
    v_mfma_f32_16x16x32_bf16 v[228:231], a[4:7], a[220:223], v[228:231]
    v_mfma_f32_16x16x32_bf16 v[232:235], a[24:27], a[216:219], 0
    v_mfma_f32_16x16x32_bf16 v[232:235], a[28:31], a[220:223], v[232:235]
    s_waitcnt lgkmcnt(5)
    v_cvt_pk_bf16_f32 v68, v236, v237
    v_cvt_pk_bf16_f32 v71, v238, v239
    v_mfma_f32_16x16x32_bf16 v[228:231], a[8:11], a[224:227], v[228:231]
    buffer_load_dwordx4 v255, s[4:7], s43 offen offset:1024 lds
    v_accvgpr_read_b32 v255, a252
    v_mfma_f32_16x16x32_bf16 v[232:235], a[32:35], a[224:227], v[232:235]
    s_waitcnt lgkmcnt(4)
    v_mfma_f32_16x16x32_bf16 v[228:231], a[12:15], a[228:231], v[228:231]
    s_waitcnt lgkmcnt(3)
    v_mfma_f32_16x16x32_bf16 v[228:231], a[16:19], a[232:235], v[228:231]
    s_waitcnt lgkmcnt(2)
    v_mfma_f32_16x16x32_bf16 v[228:231], a[20:23], a[236:239], v[228:231]
    buffer_load_dwordx4 v254, s[4:7], s43 offen offset:2048 lds
    s_add_u32 m0, s46, 0x17400
    v_mfma_f32_16x16x32_bf16 v[232:235], a[36:39], a[228:231], v[232:235]
    v_accvgpr_read_b32 v254, a253
    v_mfma_f32_16x16x32_bf16 v[232:235], a[40:43], a[232:235], v[232:235]
    v_mfma_f32_16x16x32_bf16 v[232:235], a[44:47], a[236:239], v[232:235]
    v_mfma_f32_16x16x32_bf16 v[236:239], a[48:51], a[216:219], 0
    buffer_load_dwordx4 v255, s[4:7], s59 offen lds
    v_cvt_pk_bf16_f32 v162, v228, v229
    v_mfma_f32_16x16x32_bf16 v[236:239], a[52:55], a[220:223], v[236:239]
    v_cvt_pk_bf16_f32 v163, v230, v231
    v_accvgpr_read_b32 v255, a254
    v_mfma_f32_16x16x32_bf16 v[236:239], a[56:59], a[224:227], v[236:239]
    v_mfma_f32_16x16x32_bf16 v[236:239], a[60:63], a[228:231], v[236:239]
    v_cvt_pk_bf16_f32 v164, v232, v233
    v_cvt_pk_bf16_f32 v165, v234, v235
    v_mfma_f32_16x16x32_bf16 v[236:239], a[64:67], a[232:235], v[236:239]
    buffer_load_dwordx4 v254, s[4:7], s59 offen offset:1024 lds
    v_accvgpr_read_b32 v254, a252
    v_mfma_f32_16x16x32_bf16 v[236:239], a[68:71], a[236:239], v[236:239]
    v_mfma_f32_16x16x32_bf16 v[228:231], a[216:219], a[72:75], 0
    v_mfma_f32_16x16x32_bf16 v[228:231], a[220:223], a[76:79], v[228:231]
    v_mfma_f32_16x16x32_bf16 v[228:231], a[224:227], a[80:83], v[228:231]
    buffer_load_dwordx4 v255, s[4:7], s59 offen offset:2048 lds
    s_add_u32 m0, s46, 0x18000
    v_mfma_f32_16x16x32_bf16 v[228:231], a[228:231], a[84:87], v[228:231]
    s_add_u32 s59, s44, s45
    v_accvgpr_read_b32 v255, a255
    v_cvt_pk_bf16_f32 v166, v236, v237
    v_mfma_f32_16x16x32_bf16 v[228:231], a[232:235], a[88:91], v[228:231]
    v_cvt_pk_bf16_f32 v167, v238, v239
    v_mfma_f32_16x16x32_bf16 v[228:231], a[236:239], a[92:95], v[228:231]
    v_mfma_f32_16x16x32_bf16 v[232:235], a[216:219], a[96:99], 0
    buffer_load_dwordx4 v254, s[4:7], s58 offen lds
    v_xor_b32 v254, 16, v242
    v_mfma_f32_16x16x32_bf16 v[232:235], a[220:223], a[100:103], v[232:235]
    v_add_u32 v254, 0x7500, v254
    v_cndmask_b32 v254, v242, v254, vcc
    v_mfma_f32_16x16x32_bf16 v[232:235], a[224:227], a[104:107], v[232:235]
    s_mov_b32 vcc_lo, 0x33333333
    v_cvt_pk_bf16_f32 v14, v228, v229
    v_cvt_pk_bf16_f32 v17, v230, v231
    v_mfma_f32_16x16x32_bf16 v[232:235], a[228:231], a[108:111], v[232:235]
    s_mov_b32 vcc_hi, 0x33333333
    s_waitcnt lgkmcnt(0)
    v_mfma_f32_16x16x32_bf16 v[232:235], a[232:235], a[112:115], v[232:235]
    buffer_load_dwordx4 v255, s[4:7], s58 offen offset:512 lds
    v_xor_b32 v255, 64, v254
    v_mfma_f32_16x16x32_bf16 v[232:235], a[236:239], a[116:119], v[232:235]
    s_add_u32 m0, s46, 0
    s_lshl1_add_u32 s58, s45, s44
    v_mfma_f32_16x16x32_bf16 v[236:239], a[216:219], a[120:123], 0
    ds_read_b128 a[216:219], v242 offset:128
    v_mfma_f32_16x16x32_bf16 v[236:239], a[220:223], a[124:127], v[236:239]
    ds_read_b128 a[220:223], v243 offset:128
    v_mfma_f32_16x16x32_bf16 v[236:239], a[224:227], a[128:131], v[236:239]
    ds_read_b128 a[224:227], v242 offset:256
    v_cvt_pk_bf16_f32 v44, v232, v233
    v_mfma_f32_16x16x32_bf16 v[236:239], a[228:231], a[132:135], v[236:239]
    ds_read_b128 a[228:231], v243 offset:256
    v_cvt_pk_bf16_f32 v47, v234, v235
    v_mfma_f32_16x16x32_bf16 v[236:239], a[232:235], a[136:139], v[236:239]
    ds_read_b128 a[232:235], v242 offset:1536
    v_mfma_f32_16x16x32_bf16 v[236:239], a[236:239], a[140:143], v[236:239]
    ds_read_b128 a[236:239], v243 offset:1536
    v_mfma_f32_16x16x32_bf16 v[228:231], a[144:147], a[240:243], 0
    v_mfma_f32_16x16x32_bf16 v[228:231], a[148:151], a[244:247], v[228:231]
    v_mfma_f32_16x16x32_bf16 v[232:235], a[168:171], a[240:243], 0
    v_mfma_f32_16x16x32_bf16 v[232:235], a[172:175], a[244:247], v[232:235]
    s_waitcnt lgkmcnt(5)
    v_mfma_f32_16x16x32_bf16 v[228:231], a[152:155], a[216:219], v[228:231]
    s_waitcnt lgkmcnt(4)
    v_cvt_pk_bf16_f32 v74, v236, v237
    v_cvt_pk_bf16_f32 v77, v238, v239
    v_mfma_f32_16x16x32_bf16 v[228:231], a[156:159], a[220:223], v[228:231]
    s_waitcnt lgkmcnt(3)
    v_mfma_f32_16x16x32_bf16 v[228:231], a[160:163], a[224:227], v[228:231]
    s_waitcnt lgkmcnt(2)
    v_mfma_f32_16x16x32_bf16 v[228:231], a[164:167], a[228:231], v[228:231]
    v_mfma_f32_16x16x32_bf16 v[232:235], a[176:179], a[216:219], v[232:235]
    v_mfma_f32_16x16x32_bf16 v[232:235], a[180:183], a[220:223], v[232:235]
    v_mfma_f32_16x16x32_bf16 v[232:235], a[184:187], a[224:227], v[232:235]
    v_mfma_f32_16x16x32_bf16 v[232:235], a[188:191], a[228:231], v[232:235]
    v_mfma_f32_16x16x32_bf16 v[236:239], a[192:195], a[240:243], 0
    ds_read_b128 a[240:243], v242 offset:1664
    v_mfma_f32_16x16x32_bf16 v[236:239], a[196:199], a[244:247], v[236:239]
    ds_read_b128 a[244:247], v243 offset:1664
    v_mul_f32 v228, s38, v228
    v_mfma_f32_16x16x32_bf16 v[236:239], a[200:203], a[216:219], v[236:239]
    v_mul_f32 v229, s38, v229
    v_mul_f32 v230, s38, v230
    v_mfma_f32_16x16x32_bf16 v[236:239], a[204:207], a[220:223], v[236:239]
    v_mul_f32 v231, s38, v231
    v_cvt_pk_bf16_f32 v168, v228, v229
    v_mfma_f32_16x16x32_bf16 v[236:239], a[208:211], a[224:227], v[236:239]
    v_cvt_pk_bf16_f32 v169, v230, v231
    v_mul_f32 v232, s3, v232
    v_mfma_f32_16x16x32_bf16 v[236:239], a[212:215], a[228:231], v[236:239]
    s_waitcnt lgkmcnt(2)
    v_mul_f32 v233, s3, v233
    v_mul_f32 v234, s3, v234
    v_mfma_f32_16x16x32_bf16 v[228:231], a[144:147], a[232:235], 0
    v_mul_f32 v235, s3, v235
    v_cvt_pk_bf16_f32 v170, v232, v233
    v_mfma_f32_16x16x32_bf16 v[228:231], a[148:151], a[236:239], v[228:231]
    v_cvt_pk_bf16_f32 v171, v234, v235
    v_mul_f32 v236, s38, v236
    v_mfma_f32_16x16x32_bf16 v[232:235], a[168:171], a[232:235], 0
    v_mul_f32 v237, s38, v237
    v_mul_f32 v238, s38, v238
    v_mfma_f32_16x16x32_bf16 v[196:199], v[102:105], v[168:171], v[196:199]
    s_waitcnt lgkmcnt(1)
    v_mul_f32 v239, s38, v239
    v_cvt_pk_bf16_f32 v172, v236, v237
    v_mfma_f32_16x16x32_bf16 v[200:203], v[114:117], v[168:171], v[200:203]
    ds_read_b128 a[216:219], v242 offset:1792
    v_cvt_pk_bf16_f32 v173, v238, v239
    v_mfma_f32_16x16x32_bf16 v[204:207], v[150:153], v[168:171], v[204:207]
    ds_read_b128 a[220:223], v243 offset:1792
    ds_read_b128 a[224:227], v240 offset:4608
    v_mfma_f32_16x16x32_bf16 v[196:199], v[104:107], v[170:173], v[196:199]
    ds_read_b128 a[228:231], v241 offset:4608
    v_mfma_f32_16x16x32_bf16 v[200:203], v[116:119], v[170:173], v[200:203]
    v_mfma_f32_16x16x32_bf16 v[204:207], v[152:155], v[170:173], v[204:207]
    v_mfma_f32_16x16x32_bf16 v[208:211], v[108:111], v[168:171], v[208:211]
    v_mfma_f32_16x16x32_bf16 v[208:211], v[110:113], v[170:173], v[208:211]
    v_mfma_f32_16x16x32_bf16 v[228:231], a[152:155], a[240:243], v[228:231]
    s_waitcnt lgkmcnt(4)
    v_mfma_f32_16x16x32_bf16 v[228:231], a[156:159], a[244:247], v[228:231]
    v_max_f32 v248, v196, v197
    v_max3_f32 v248, v248, v198, v199
    v_mfma_f32_16x16x32_bf16 v[232:235], a[172:175], a[236:239], v[232:235]
    ds_read_b128 v[196:199], v245 offset:256
    v_max3_f32 v248, v248, v200, v201
    v_mfma_f32_16x16x32_bf16 v[232:235], a[176:179], a[240:243], v[232:235]
    s_waitcnt lgkmcnt(4)
    v_max3_f32 v248, v248, v202, v203
    v_max3_f32 v248, v248, v204, v205
    v_mfma_f32_16x16x32_bf16 v[228:231], a[160:163], a[216:219], v[228:231]
    ds_read_b128 v[200:203], v246 offset:256
    v_max3_f32 v248, v248, v206, v207
    v_mfma_f32_16x16x32_bf16 v[232:235], a[180:183], a[244:247], v[232:235]
    ds_read_b128 v[204:207], v244 offset:320
    v_max3_f32 v248, v248, v208, v209
    v_mfma_f32_16x16x32_bf16 v[232:235], a[184:187], a[216:219], v[232:235]
    s_waitcnt lgkmcnt(5)
    v_max3_f32 v248, v248, v210, v211
    v_mfma_f32_16x16x32_bf16 v[228:231], a[164:167], a[220:223], v[228:231]
    ds_read_b128 v[208:211], v245 offset:320
    v_mfma_f32_16x16x32_bf16 v[232:235], a[188:191], a[220:223], v[232:235]
    v_mfma_f32_16x16x32_bf16 v[236:239], a[192:195], a[232:235], 0
    ds_read_b128 a[232:235], v240 offset:4736
    v_mfma_f32_16x16x32_bf16 v[236:239], a[196:199], a[236:239], v[236:239]
    ds_read_b128 a[236:239], v241 offset:4736
    s_waitcnt lgkmcnt(5)
    v_mfma_f32_16x16x32_bf16 v[196:199], v[120:123], v[168:171], v[196:199]
    v_mul_f32 v228, s38, v228
    v_mul_f32 v229, s38, v229
    v_mfma_f32_16x16x32_bf16 v[196:199], v[122:125], v[170:173], v[196:199]
    v_mul_f32 v230, s38, v230
    v_mul_f32 v231, s38, v231
    v_mfma_f32_16x16x32_bf16 v[236:239], a[200:203], a[240:243], v[236:239]
    s_waitcnt lgkmcnt(4)
    v_cvt_pk_bf16_f32 v174, v228, v229
    v_cvt_pk_bf16_f32 v175, v230, v231
    v_mfma_f32_16x16x32_bf16 v[200:203], v[156:159], v[168:171], v[200:203]
    s_waitcnt lgkmcnt(3)
    v_mul_f32 v232, s3, v232
    v_mul_f32 v233, s3, v233
    v_mfma_f32_16x16x32_bf16 v[200:203], v[158:161], v[170:173], v[200:203]
    v_mul_f32 v234, s3, v234
    v_mul_f32 v235, s3, v235
    v_mfma_f32_16x16x32_bf16 v[204:207], v[90:93], v[168:171], v[204:207]
    s_waitcnt lgkmcnt(2)
    v_cvt_pk_bf16_f32 v176, v232, v233
    v_cvt_pk_bf16_f32 v177, v234, v235
    v_mfma_f32_16x16x32_bf16 v[204:207], v[92:95], v[170:173], v[204:207]
    ds_read_b128 a[240:243], v240 offset:4864
    v_max3_f32 v248, v248, v196, v197
    v_mfma_f32_16x16x32_bf16 v[208:211], v[126:129], v[168:171], v[208:211]
    v_max3_f32 v248, v248, v198, v199
    v_max3_f32 v248, v248, v200, v201
    v_mfma_f32_16x16x32_bf16 v[208:211], v[128:131], v[170:173], v[208:211]
    ds_read_b128 v[196:199], v246 offset:320
    v_max3_f32 v248, v248, v202, v203
    v_mfma_f32_16x16x32_bf16 v[236:239], a[204:207], a[244:247], v[236:239]
    ds_read_b128 a[244:247], v241 offset:4864
    ds_read_b128 v[200:203], v244 offset:192
    v_mfma_f32_16x16x32_bf16 v[236:239], a[208:211], a[216:219], v[236:239]
    ds_read_b128 a[216:219], v242 offset:3072
    v_max3_f32 v248, v248, v204, v205
    v_mfma_f32_16x16x32_bf16 v[236:239], a[212:215], a[220:223], v[236:239]
    ds_read_b128 a[220:223], v243 offset:3072
    ds_read_b128 v[204:207], v245 offset:192
    v_mfma_f32_16x16x32_bf16 v[228:231], a[0:3], a[224:227], 0
    v_max3_f32 v248, v248, v208, v209
    v_mfma_f32_16x16x32_bf16 v[228:231], a[4:7], a[228:231], v[228:231]
    ds_read_b128 v[208:211], v246 offset:192
    s_waitcnt lgkmcnt(8)
    v_mfma_f32_16x16x32_bf16 v[228:231], a[8:11], a[232:235], v[228:231]
    v_mul_f32 v236, s38, v236
    v_mul_f32 v237, s38, v237
    v_mfma_f32_16x16x32_bf16 v[228:231], a[12:15], a[236:239], v[228:231]
    s_waitcnt lgkmcnt(7)
    v_mul_f32 v238, s38, v238
    v_mul_f32 v239, s38, v239
    v_mfma_f32_16x16x32_bf16 v[228:231], a[16:19], a[240:243], v[228:231]
    s_waitcnt lgkmcnt(6)
    v_cvt_pk_bf16_f32 v178, v236, v237
    v_cvt_pk_bf16_f32 v179, v238, v239
    v_mfma_f32_16x16x32_bf16 v[196:199], v[162:165], v[168:171], v[196:199]
    s_waitcnt lgkmcnt(5)
    v_mfma_f32_16x16x32_bf16 v[196:199], v[164:167], v[170:173], v[196:199]
    s_waitcnt lgkmcnt(4)
    v_mfma_f32_16x16x32_bf16 v[200:203], v[102:105], v[168:171], v[200:203]
    v_mfma_f32_16x16x32_bf16 v[200:203], v[104:107], v[170:173], v[200:203]
    v_mfma_f32_16x16x32_bf16 v[228:231], a[20:23], a[244:247], v[228:231]
    s_waitcnt lgkmcnt(1)
    v_mfma_f32_16x16x32_bf16 v[204:207], v[114:117], v[168:171], v[204:207]
    s_waitcnt lgkmcnt(0)
    v_mfma_f32_16x16x32_bf16 v[204:207], v[116:119], v[170:173], v[204:207]
    v_max3_f32 v248, v248, v196, v197
    v_mov_b32 v225, v248
    v_mfma_f32_16x16x32_bf16 v[208:211], v[150:153], v[168:171], v[208:211]
    ds_read_b128 v[196:199], v244 offset:256
    v_cvt_pk_bf16_f32 v102, v228, v229
    v_mfma_f32_16x16x32_bf16 v[208:211], v[152:155], v[170:173], v[208:211]
    v_cvt_pk_bf16_f32 v103, v230, v231
    v_permlane16_swap_b32 v248, v225
    v_mfma_f32_16x16x32_bf16 v[232:235], a[24:27], a[224:227], 0
    v_max_f32 v248, v248, v225
    v_mov_b32 v225, v248
    v_mfma_f32_16x16x32_bf16 v[232:235], a[28:31], a[228:231], v[232:235]
    v_mfma_f32_16x16x32_bf16 v[232:235], a[32:35], a[232:235], v[232:235]
    v_permlane32_swap_b32 v248, v225
    v_max_f32 v248, v248, v225
    v_mfma_f32_16x16x32_bf16 v[232:235], a[36:39], a[236:239], v[232:235]
    v_sub_f32 v200, v200, v248
    v_sub_f32 v201, v201, v248
    v_mfma_f32_16x16x32_bf16 v[232:235], a[40:43], a[240:243], v[232:235]
    v_exp_f32 v200, v200
    v_mfma_f32_16x16x32_bf16 v[232:235], a[44:47], a[244:247], v[232:235]
    v_exp_f32 v201, v201
    v_mfma_f32_16x16x32_bf16 v[236:239], a[48:51], a[224:227], 0
    v_sub_f32 v202, v202, v248
    v_sub_f32 v203, v203, v248
    v_mfma_f32_16x16x32_bf16 v[236:239], a[52:55], a[228:231], v[236:239]
    s_waitcnt lgkmcnt(0)
    v_exp_f32 v202, v202
    v_mfma_f32_16x16x32_bf16 v[196:199], v[108:111], v[168:171], v[196:199]
    v_cvt_pk_bf16_f32 v104, v232, v233
    v_cvt_pk_bf16_f32 v105, v234, v235
    v_mfma_f32_16x16x32_bf16 v[196:199], v[110:113], v[170:173], v[196:199]
    v_exp_f32 v203, v203
    v_mfma_f32_16x16x32_bf16 v[236:239], a[56:59], a[232:235], v[236:239]
    v_cvt_pk_bf16_f32 v180, v200, v201
    v_cvt_pk_bf16_f32 v183, v202, v203
    v_mfma_f32_16x16x32_bf16 v[236:239], a[60:63], a[236:239], v[236:239]
    ds_read_b128 v[200:203], v245 offset:256
    v_sub_f32 v204, v204, v248
    v_mfma_f32_16x16x32_bf16 v[236:239], a[64:67], a[240:243], v[236:239]
    v_exp_f32 v204, v204
    v_mfma_f32_16x16x32_bf16 v[236:239], a[68:71], a[244:247], v[236:239]
    v_sub_f32 v205, v205, v248
    v_sub_f32 v206, v206, v248
    v_mfma_f32_16x16x32_bf16 v[228:231], a[224:227], a[72:75], 0
    v_exp_f32 v205, v205
    v_mfma_f32_16x16x32_bf16 v[228:231], a[228:231], a[76:79], v[228:231]
    v_exp_f32 v206, v206
    v_mfma_f32_16x16x32_bf16 v[228:231], a[232:235], a[80:83], v[228:231]
    v_sub_f32 v207, v207, v248
    v_cvt_pk_bf16_f32 v106, v236, v237
    v_mfma_f32_16x16x32_bf16 v[228:231], a[236:239], a[84:87], v[228:231]
    v_cvt_pk_bf16_f32 v107, v238, v239
    v_cvt_pk_bf16_f32 v181, v204, v205
    v_mfma_f32_16x16x32_bf16 v[228:231], a[240:243], a[88:91], v[228:231]
    v_exp_f32 v207, v207
    v_mfma_f32_16x16x32_bf16 v[228:231], a[244:247], a[92:95], v[228:231]
    v_cvt_pk_bf16_f32 v184, v206, v207
    v_sub_f32 v208, v208, v248
    v_mfma_f32_16x16x32_bf16 v[232:235], a[224:227], a[96:99], 0
    ds_read_b128 v[204:207], v246 offset:256
    v_sub_f32 v209, v209, v248
    v_mfma_f32_16x16x32_bf16 v[232:235], a[228:231], a[100:103], v[232:235]
    s_waitcnt lgkmcnt(1)
    v_exp_f32 v208, v208
    v_mfma_f32_16x16x32_bf16 v[200:203], v[120:123], v[168:171], v[200:203]
    v_cvt_pk_bf16_f32 v20, v228, v229
    v_cvt_pk_bf16_f32 v23, v230, v231
    v_mfma_f32_16x16x32_bf16 v[200:203], v[122:125], v[170:173], v[200:203]
    v_exp_f32 v209, v209
    v_mfma_f32_16x16x32_bf16 v[232:235], a[232:235], a[104:107], v[232:235]
    v_sub_f32 v210, v210, v248
    v_sub_f32 v211, v211, v248
    v_mfma_f32_16x16x32_bf16 v[232:235], a[236:239], a[108:111], v[232:235]
    v_exp_f32 v210, v210
    v_mfma_f32_16x16x32_bf16 v[232:235], a[240:243], a[112:115], v[232:235]
    v_exp_f32 v211, v211
    v_mfma_f32_16x16x32_bf16 v[232:235], a[244:247], a[116:119], v[232:235]
    v_cvt_pk_bf16_f32 v182, v208, v209
    v_cvt_pk_bf16_f32 v185, v210, v211
    v_mfma_f32_16x16x32_bf16 v[236:239], a[224:227], a[120:123], 0
    ds_read_b128 a[224:227], v242 offset:3200
    ds_read_b128 v[208:211], v244 offset:320
    v_mfma_f32_16x16x32_bf16 v[212:215], v[0:3], v[180:183], 0
    s_waitcnt lgkmcnt(2)
    v_sub_f32 v196, v196, v248
    v_cvt_pk_bf16_f32 v50, v232, v233
    v_mfma_f32_16x16x32_bf16 v[216:219], v[30:33], v[180:183], 0
    v_cvt_pk_bf16_f32 v53, v234, v235
    v_sub_f32 v197, v197, v248
    v_mfma_f32_16x16x32_bf16 v[220:223], v[60:63], v[180:183], 0
    v_exp_f32 v196, v196
    v_mfma_f32_16x16x32_bf16 v[224:227], a[248:251], v[180:183], 0
    v_exp_f32 v197, v197
    v_mfma_f32_16x16x32_bf16 v[204:207], v[156:159], v[168:171], v[204:207]
    v_sub_f32 v198, v198, v248
    v_sub_f32 v199, v199, v248
    v_mfma_f32_16x16x32_bf16 v[204:207], v[158:161], v[170:173], v[204:207]
    v_exp_f32 v198, v198
    v_mfma_f32_16x16x32_bf16 v[236:239], a[228:231], a[124:127], v[236:239]
    ds_read_b128 a[228:231], v243 offset:3200
    v_cvt_pk_bf16_f32 v186, v196, v197
    v_mfma_f32_16x16x32_bf16 v[236:239], a[232:235], a[128:131], v[236:239]
    ds_read_b128 a[232:235], v242 offset:3328
    v_sub_f32 v200, v200, v248
    v_mfma_f32_16x16x32_bf16 v[236:239], a[236:239], a[132:135], v[236:239]
    ds_read_b128 a[236:239], v243 offset:3328
    v_sub_f32 v201, v201, v248
    v_mfma_f32_16x16x32_bf16 v[236:239], a[240:243], a[136:139], v[236:239]
    ds_read_b128 a[240:243], v240 offset:6144
    v_sub_f32 v202, v202, v248
    v_mfma_f32_16x16x32_bf16 v[236:239], a[244:247], a[140:143], v[236:239]
    ds_read_b128 a[244:247], v241 offset:6144
    v_sub_f32 v203, v203, v248
    v_mfma_f32_16x16x32_bf16 v[228:231], a[144:147], a[216:219], 0
    s_waitcnt lgkmcnt(5)
    v_exp_f32 v199, v199
    v_mfma_f32_16x16x32_bf16 v[208:211], v[90:93], v[168:171], v[208:211]
    v_cvt_pk_bf16_f32 v189, v198, v199
    v_sub_f32 v204, v204, v248
    v_mfma_f32_16x16x32_bf16 v[208:211], v[92:95], v[170:173], v[208:211]
    v_cvt_pk_bf16_f32 v80, v236, v237
    v_cvt_pk_bf16_f32 v83, v238, v239
    v_mfma_f32_16x16x32_bf16 v[228:231], a[148:151], a[220:223], v[228:231]
    ds_read_b128 v[196:199], v245 offset:320
    v_sub_f32 v205, v205, v248
    v_mfma_f32_16x16x32_bf16 v[228:231], a[152:155], a[224:227], v[228:231]
    s_waitcnt lgkmcnt(5)
    v_exp_f32 v200, v200
    v_mfma_f32_16x16x32_bf16 v[228:231], a[156:159], a[228:231], v[228:231]
    s_waitcnt lgkmcnt(4)
    v_exp_f32 v201, v201
    v_mfma_f32_16x16x32_bf16 v[228:231], a[160:163], a[232:235], v[228:231]
    s_waitcnt lgkmcnt(3)
    v_exp_f32 v202, v202
    v_mfma_f32_16x16x32_bf16 v[228:231], a[164:167], a[236:239], v[228:231]
    v_exp_f32 v203, v203
    v_mfma_f32_16x16x32_bf16 v[232:235], a[168:171], a[216:219], 0
    v_cvt_pk_bf16_f32 v187, v200, v201
    v_cvt_pk_bf16_f32 v190, v202, v203
    v_mfma_f32_16x16x32_bf16 v[232:235], a[172:175], a[220:223], v[232:235]
    ds_read_b128 v[200:203], v246 offset:320
    v_sub_f32 v206, v206, v248
    v_mfma_f32_16x16x32_bf16 v[212:215], v[4:7], v[184:187], v[212:215]
    v_mul_f32 v228, s38, v228
    v_mul_f32 v229, s38, v229
    v_mfma_f32_16x16x32_bf16 v[216:219], v[34:37], v[184:187], v[216:219]
    v_mul_f32 v230, s38, v230
    v_mul_f32 v231, s38, v231
    v_mfma_f32_16x16x32_bf16 v[220:223], v[64:67], v[184:187], v[220:223]
    s_waitcnt lgkmcnt(1)
    v_exp_f32 v204, v204
    v_mfma_f32_16x16x32_bf16 v[224:227], a[248:251], v[184:187], v[224:227]
    v_exp_f32 v205, v205
    v_mfma_f32_16x16x32_bf16 v[196:199], v[126:129], v[168:171], v[196:199]
    v_exp_f32 v206, v206
    v_mfma_f32_16x16x32_bf16 v[196:199], v[128:131], v[170:173], v[196:199]
    v_sub_f32 v207, v207, v248
    v_cvt_pk_bf16_f32 v188, v204, v205
    v_mfma_f32_16x16x32_bf16 v[232:235], a[176:179], a[224:227], v[232:235]
    v_exp_f32 v207, v207
    v_mfma_f32_16x16x32_bf16 v[232:235], a[180:183], a[228:231], v[232:235]
    v_cvt_pk_bf16_f32 v191, v206, v207
    v_sub_f32 v208, v208, v248
    v_mfma_f32_16x16x32_bf16 v[232:235], a[184:187], a[232:235], v[232:235]
    ds_read_b128 v[204:207], v244 offset:0
    v_sub_f32 v209, v209, v248
    v_mfma_f32_16x16x32_bf16 v[212:215], v[8:11], v[188:191], v[212:215]
    s_waitcnt lgkmcnt(1)
    v_exp_f32 v208, v208
    v_mfma_f32_16x16x32_bf16 v[216:219], v[38:41], v[188:191], v[216:219]
    v_exp_f32 v209, v209
    v_mfma_f32_16x16x32_bf16 v[220:223], v[68:71], v[188:191], v[220:223]
    v_cvt_pk_bf16_f32 v192, v208, v209
    v_sub_f32 v196, v196, v248
    v_mfma_f32_16x16x32_bf16 v[224:227], a[248:251], v[188:191], v[224:227]
    ds_read_b128 v[208:211], v245 offset:0
    v_sub_f32 v197, v197, v248
    v_mfma_f32_16x16x32_bf16 v[200:203], v[162:165], v[168:171], v[200:203]
    v_cvt_pk_bf16_f32 v168, v228, v229
    v_cvt_pk_bf16_f32 v169, v230, v231
    v_mfma_f32_16x16x32_bf16 v[200:203], v[164:167], v[170:173], v[200:203]
    v_exp_f32 v196, v196
    v_mfma_f32_16x16x32_bf16 v[232:235], a[188:191], a[236:239], v[232:235]
    v_exp_f32 v197, v197
    v_mfma_f32_16x16x32_bf16 v[236:239], a[192:195], a[216:219], 0
    ds_read_b128 a[216:219], v240 offset:6272
    v_cvt_pk_bf16_f32 v193, v196, v197
    v_mfma_f32_16x16x32_bf16 v[236:239], a[196:199], a[220:223], v[236:239]
    ds_read_b128 a[220:223], v241 offset:6272
    ds_read_b128 v[196:199], v246 offset:0
    v_mfma_f32_16x16x32_bf16 v[236:239], a[200:203], a[224:227], v[236:239]
    s_waitcnt lgkmcnt(4)
    v_mul_f32 v232, s3, v232
    v_mul_f32 v233, s3, v233
    v_mfma_f32_16x16x32_bf16 v[204:207], v[108:111], v[174:177], v[204:207]
    v_mul_f32 v234, s3, v234
    v_mul_f32 v235, s3, v235
    v_mfma_f32_16x16x32_bf16 v[204:207], v[110:113], v[176:179], v[204:207]
    v_cvt_pk_bf16_f32 v170, v232, v233
    v_cvt_pk_bf16_f32 v171, v234, v235
    v_mfma_f32_16x16x32_bf16 v[236:239], a[204:207], a[228:231], v[236:239]
    ds_read_b128 a[224:227], v240 offset:6400
    ds_read_b128 a[228:231], v241 offset:6400
    v_mfma_f32_16x16x32_bf16 v[236:239], a[208:211], a[232:235], v[236:239]
    ds_read_b128 a[232:235], v254 offset:4608
    v_sub_f32 v200, v200, v248
    v_mfma_f32_16x16x32_bf16 v[236:239], a[212:215], a[236:239], v[236:239]
    ds_read_b128 a[236:239], v255 offset:4608
    v_sub_f32 v201, v201, v248
    v_mfma_f32_16x16x32_bf16 v[228:231], a[0:3], a[240:243], 0
    s_waitcnt lgkmcnt(7)
    v_exp_f32 v200, v200
    v_mfma_f32_16x16x32_bf16 v[208:211], v[120:123], v[174:177], v[208:211]
    v_exp_f32 v201, v201
    v_mfma_f32_16x16x32_bf16 v[208:211], v[122:125], v[176:179], v[208:211]
    s_waitcnt lgkmcnt(4)
    v_mul_f32 v236, s38, v236
    v_mul_f32 v237, s38, v237
    v_mfma_f32_16x16x32_bf16 v[196:199], v[156:159], v[174:177], v[196:199]
    v_mul_f32 v238, s38, v238
    v_mul_f32 v239, s38, v239
    v_mfma_f32_16x16x32_bf16 v[196:199], v[158:161], v[176:179], v[196:199]
    v_cvt_pk_bf16_f32 v172, v236, v237
    v_cvt_pk_bf16_f32 v173, v238, v239
    v_mfma_f32_16x16x32_bf16 v[228:231], a[4:7], a[244:247], v[228:231]
    v_cvt_pk_bf16_f32 v194, v200, v201
    v_max_f32 v248, v204, v205
    v_mfma_f32_16x16x32_bf16 v[228:231], a[8:11], a[216:219], v[228:231]
    ds_read_b128 v[200:203], v244 offset:64
    v_max3_f32 v248, v248, v206, v207
    v_mfma_f32_16x16x32_bf16 v[212:215], v[12:15], v[192:195], v[212:215]
    ds_read_b128 v[204:207], v245 offset:64
    v_max3_f32 v248, v248, v208, v209
    v_mfma_f32_16x16x32_bf16 v[216:219], v[42:45], v[192:195], v[216:219]
    v_max3_f32 v248, v248, v210, v211
    v_max3_f32 v248, v248, v196, v197
    v_mfma_f32_16x16x32_bf16 v[220:223], v[72:75], v[192:195], v[220:223]
    ds_read_b128 v[208:211], v246 offset:64
    v_max3_f32 v248, v248, v198, v199
    v_mfma_f32_16x16x32_bf16 v[224:227], a[248:251], v[192:195], v[224:227]
    ds_read_b128 v[196:199], v244 offset:128
    v_mfma_f32_16x16x32_bf16 v[228:231], a[12:15], a[220:223], v[228:231]
    s_waitcnt lgkmcnt(7)
    v_mfma_f32_16x16x32_bf16 v[228:231], a[16:19], a[224:227], v[228:231]
    s_waitcnt lgkmcnt(6)
    v_mfma_f32_16x16x32_bf16 v[228:231], a[20:23], a[228:231], v[228:231]
    v_mfma_f32_16x16x32_bf16 v[232:235], a[24:27], a[240:243], 0
    v_mfma_f32_16x16x32_bf16 v[232:235], a[28:31], a[244:247], v[232:235]
    s_waitcnt lgkmcnt(3)
    v_rcp_f32 v225, v224
    v_mfma_f32_16x16x32_bf16 v[200:203], v[90:93], v[174:177], v[200:203]
    s_waitcnt lgkmcnt(2)
    v_mul_f32 v212, v212, v225
    v_mul_f32 v213, v213, v225
    v_mfma_f32_16x16x32_bf16 v[200:203], v[92:95], v[176:179], v[200:203]
    v_mul_f32 v214, v214, v225
    v_mul_f32 v215, v215, v225
    v_mfma_f32_16x16x32_bf16 v[204:207], v[126:129], v[174:177], v[204:207]
    s_waitcnt lgkmcnt(1)
    v_cvt_pk_bf16_f32 v212, v212, v213
    v_cvt_pk_bf16_f32 v213, v214, v215
    v_mfma_f32_16x16x32_bf16 v[204:207], v[128:131], v[176:179], v[204:207]
    ds_write_b64 v251, v[212:213] offset:0
    v_mfma_f32_16x16x32_bf16 v[208:211], v[162:165], v[174:177], v[208:211]
    s_waitcnt lgkmcnt(1)
    v_mul_f32 v216, v216, v225
    v_mul_f32 v217, v217, v225
    v_mfma_f32_16x16x32_bf16 v[208:211], v[164:167], v[176:179], v[208:211]
    v_mul_f32 v218, v218, v225
    v_mul_f32 v219, v219, v225
    v_mfma_f32_16x16x32_bf16 v[196:199], v[96:99], v[174:177], v[196:199]
    v_cvt_pk_bf16_f32 v216, v216, v217
    v_cvt_pk_bf16_f32 v217, v218, v219
    v_mfma_f32_16x16x32_bf16 v[196:199], v[98:101], v[176:179], v[196:199]
    ds_write_b64 v251, v[216:217] offset:128
    v_mfma_f32_16x16x32_bf16 v[232:235], a[32:35], a[216:219], v[232:235]
    v_mul_f32 v220, v220, v225
    v_mul_f32 v221, v221, v225
    v_mfma_f32_16x16x32_bf16 v[232:235], a[36:39], a[220:223], v[232:235]
    v_mul_f32 v222, v222, v225
    v_mul_f32 v223, v223, v225
    v_mfma_f32_16x16x32_bf16 v[232:235], a[40:43], a[224:227], v[232:235]
    v_cvt_pk_bf16_f32 v220, v220, v221
    v_cvt_pk_bf16_f32 v221, v222, v223
    v_mfma_f32_16x16x32_bf16 v[232:235], a[44:47], a[228:231], v[232:235]
    ds_write_b64 v251, v[220:221] offset:256
    v_mfma_f32_16x16x32_bf16 v[236:239], a[48:51], a[240:243], 0
    v_max3_f32 v248, v248, v200, v201
    v_max3_f32 v248, v248, v202, v203
    v_mfma_f32_16x16x32_bf16 v[236:239], a[52:55], a[244:247], v[236:239]
    ds_read_b128 v[200:203], v245 offset:128
    v_max3_f32 v248, v248, v204, v205
    v_mfma_f32_16x16x32_bf16 v[236:239], a[56:59], a[216:219], v[236:239]
    v_max3_f32 v248, v248, v206, v207
    v_max3_f32 v248, v248, v208, v209
    v_mfma_f32_16x16x32_bf16 v[236:239], a[60:63], a[220:223], v[236:239]
    ds_read_b128 v[204:207], v246 offset:128
    v_max3_f32 v248, v248, v210, v211
    v_mfma_f32_16x16x32_bf16 v[236:239], a[64:67], a[224:227], v[236:239]
    ds_read_b128 v[208:211], v244 offset:0
    v_max3_f32 v248, v248, v196, v197
    v_mfma_f32_16x16x32_bf16 v[236:239], a[68:71], a[228:231], v[236:239]
    ds_read_b128 v[196:199], v245 offset:0
    s_waitcnt lgkmcnt(3)
    v_mfma_f32_16x16x32_bf16 v[200:203], v[132:135], v[174:177], v[200:203]
    v_mfma_f32_16x16x32_bf16 v[200:203], v[134:137], v[176:179], v[200:203]
    s_nop 7
    s_waitcnt lgkmcnt(1)
    v_mfma_f32_16x16x32_bf16 v[204:207], v[102:105], v[174:177], v[204:207]
    s_waitcnt lgkmcnt(0)
    v_max3_f32 v248, v248, v200, v201
    v_mfma_f32_16x16x32_bf16 v[204:207], v[104:107], v[176:179], v[204:207]
    ds_read_b128 v[200:203], v246 offset:0
    v_mfma_f32_16x16x32_bf16 v[208:211], v[108:111], v[174:177], v[208:211]
    v_cvt_pk_bf16_f32 v108, v228, v229
    v_cvt_pk_bf16_f32 v109, v230, v231
    v_mfma_f32_16x16x32_bf16 v[208:211], v[110:113], v[176:179], v[208:211]
    v_cvt_pk_bf16_f32 v110, v232, v233
    v_cvt_pk_bf16_f32 v111, v234, v235
    v_mfma_f32_16x16x32_bf16 v[196:199], v[120:123], v[174:177], v[196:199]
    v_cvt_pk_bf16_f32 v112, v236, v237
    v_cvt_pk_bf16_f32 v113, v238, v239
    v_mfma_f32_16x16x32_bf16 v[196:199], v[122:125], v[176:179], v[196:199]
    v_max3_f32 v248, v248, v204, v205
    v_mov_b32 v225, v248
    v_mfma_f32_16x16x32_bf16 v[228:231], a[240:243], a[72:75], 0
    ds_read_b128 v[204:207], v244 offset:64
    v_permlane16_swap_b32 v248, v225
    v_mfma_f32_16x16x32_bf16 v[228:231], a[244:247], a[76:79], v[228:231]
    v_max_f32 v248, v248, v225
    v_mov_b32 v225, v248
    v_mfma_f32_16x16x32_bf16 v[228:231], a[216:219], a[80:83], v[228:231]
    v_mfma_f32_16x16x32_bf16 v[228:231], a[220:223], a[84:87], v[228:231]
    v_permlane32_swap_b32 v248, v225
    v_max_f32 v248, v248, v225
    v_mfma_f32_16x16x32_bf16 v[228:231], a[224:227], a[88:91], v[228:231]
    s_waitcnt lgkmcnt(1)
    v_sub_f32 v208, v208, v248
    v_sub_f32 v209, v209, v248
    v_mfma_f32_16x16x32_bf16 v[200:203], v[156:159], v[174:177], v[200:203]
    v_exp_f32 v208, v208
    v_mfma_f32_16x16x32_bf16 v[200:203], v[158:161], v[176:179], v[200:203]
    v_exp_f32 v209, v209
    v_mfma_f32_16x16x32_bf16 v[228:231], a[228:231], a[92:95], v[228:231]
    v_sub_f32 v210, v210, v248
    v_sub_f32 v211, v211, v248
    v_mfma_f32_16x16x32_bf16 v[232:235], a[240:243], a[96:99], 0
    v_exp_f32 v210, v210
    v_mfma_f32_16x16x32_bf16 v[232:235], a[244:247], a[100:103], v[232:235]
    s_waitcnt lgkmcnt(0)
    v_exp_f32 v211, v211
    v_mfma_f32_16x16x32_bf16 v[204:207], v[90:93], v[174:177], v[204:207]
    v_cvt_pk_bf16_f32 v26, v228, v229
    v_cvt_pk_bf16_f32 v29, v230, v231
    v_mfma_f32_16x16x32_bf16 v[204:207], v[92:95], v[176:179], v[204:207]
    v_cvt_pk_bf16_f32 v180, v208, v209
    v_cvt_pk_bf16_f32 v183, v210, v211
    v_mfma_f32_16x16x32_bf16 v[232:235], a[216:219], a[104:107], v[232:235]
    ds_read_b128 v[208:211], v245 offset:64
    v_sub_f32 v196, v196, v248
    v_mfma_f32_16x16x32_bf16 v[232:235], a[220:223], a[108:111], v[232:235]
    v_exp_f32 v196, v196
    v_mfma_f32_16x16x32_bf16 v[232:235], a[224:227], a[112:115], v[232:235]
    v_sub_f32 v197, v197, v248
    v_sub_f32 v198, v198, v248
    v_mfma_f32_16x16x32_bf16 v[232:235], a[228:231], a[116:119], v[232:235]
    v_exp_f32 v197, v197
    v_mfma_f32_16x16x32_bf16 v[236:239], a[240:243], a[120:123], 0
    ds_read_b128 a[240:243], v254 offset:4736
    v_sub_f32 v199, v199, v248
    v_mfma_f32_16x16x32_bf16 v[236:239], a[244:247], a[124:127], v[236:239]
    ds_read_b128 a[244:247], v255 offset:4736
    v_cvt_pk_bf16_f32 v181, v196, v197
    v_mfma_f32_16x16x32_bf16 v[236:239], a[216:219], a[128:131], v[236:239]
    v_cvt_pk_bf16_f32 v56, v232, v233
    v_cvt_pk_bf16_f32 v59, v234, v235
    v_mfma_f32_16x16x32_bf16 v[236:239], a[220:223], a[132:135], v[236:239]
    ds_read_b128 a[216:219], v254 offset:4864
    ds_read_b128 a[220:223], v255 offset:4864
    v_mfma_f32_16x16x32_bf16 v[236:239], a[224:227], a[136:139], v[236:239]
    v_exp_f32 v198, v198
    v_mfma_f32_16x16x32_bf16 v[236:239], a[228:231], a[140:143], v[236:239]
    s_waitcnt lgkmcnt(4)
    v_exp_f32 v199, v199
    v_mfma_f32_16x16x32_bf16 v[208:211], v[126:129], v[174:177], v[208:211]
    v_cvt_pk_bf16_f32 v184, v198, v199
    v_sub_f32 v200, v200, v248
    v_mfma_f32_16x16x32_bf16 v[208:211], v[128:131], v[176:179], v[208:211]
    ds_read_b128 v[196:199], v246 offset:64
    v_sub_f32 v201, v201, v248
    v_mfma_f32_16x16x32_bf16 v[228:231], a[144:147], a[232:235], 0
    v_cvt_pk_bf16_f32 v86, v236, v237
    v_cvt_pk_bf16_f32 v89, v238, v239
    v_mfma_f32_16x16x32_bf16 v[228:231], a[148:151], a[236:239], v[228:231]
    s_waitcnt lgkmcnt(4)
    v_exp_f32 v200, v200
    v_mfma_f32_16x16x32_bf16 v[228:231], a[152:155], a[240:243], v[228:231]
    s_waitcnt lgkmcnt(3)
    v_exp_f32 v201, v201
    v_mfma_f32_16x16x32_bf16 v[228:231], a[156:159], a[244:247], v[228:231]
    v_sub_f32 v202, v202, v248
    v_sub_f32 v203, v203, v248
    v_mfma_f32_16x16x32_bf16 v[232:235], a[168:171], a[232:235], 0
    s_waitcnt lgkmcnt(2)
    s_waitcnt vmcnt(5) lgkmcnt(1)
    s_barrier
    v_mfma_f32_16x16x32_bf16 v[228:231], a[160:163], a[216:219], v[228:231]
    ds_read_b128 a[224:227], v240 offset:30720
    ds_read_b128 a[228:231], v241 offset:30720
    v_mfma_f32_16x16x32_bf16 v[228:231], a[164:167], a[220:223], v[228:231]
    v_exp_f32 v202, v202
    v_mfma_f32_16x16x32_bf16 v[232:235], a[172:175], a[236:239], v[232:235]
    v_exp_f32 v203, v203
    v_mfma_f32_16x16x32_bf16 v[232:235], a[176:179], a[240:243], v[232:235]
    s_waitcnt lgkmcnt(2)
    v_cvt_pk_bf16_f32 v182, v200, v201
    v_cvt_pk_bf16_f32 v185, v202, v203
    v_mfma_f32_16x16x32_bf16 v[196:199], v[162:165], v[174:177], v[196:199]
    v_mul_f32 v228, s38, v228
    v_mul_f32 v229, s38, v229
    v_mfma_f32_16x16x32_bf16 v[212:215], v[6:9], v[180:183], 0
    v_mul_f32 v230, s38, v230
    v_mul_f32 v231, s38, v231
    v_mfma_f32_16x16x32_bf16 v[216:219], v[36:39], v[180:183], 0
    ds_read_b128 v[200:203], v244 offset:128
    v_sub_f32 v204, v204, v248
    v_mfma_f32_16x16x32_bf16 v[220:223], v[66:69], v[180:183], 0
    v_exp_f32 v204, v204
    v_mfma_f32_16x16x32_bf16 v[224:227], a[248:251], v[180:183], 0
    v_sub_f32 v205, v205, v248
    v_sub_f32 v206, v206, v248
    v_mfma_f32_16x16x32_bf16 v[196:199], v[164:167], v[176:179], v[196:199]
    v_exp_f32 v205, v205
    v_mfma_f32_16x16x32_bf16 v[232:235], a[180:183], a[244:247], v[232:235]
    v_exp_f32 v206, v206
    v_mfma_f32_16x16x32_bf16 v[232:235], a[184:187], a[216:219], v[232:235]
    v_sub_f32 v207, v207, v248
    v_cvt_pk_bf16_f32 v186, v204, v205
    v_mfma_f32_16x16x32_bf16 v[232:235], a[188:191], a[220:223], v[232:235]
    v_exp_f32 v207, v207
    v_mfma_f32_16x16x32_bf16 v[236:239], a[192:195], a[232:235], 0
    ds_read_b128 a[232:235], v240 offset:30848
    v_cvt_pk_bf16_f32 v189, v206, v207
    v_mfma_f32_16x16x32_bf16 v[236:239], a[196:199], a[236:239], v[236:239]
    ds_read_b128 a[236:239], v241 offset:30848
    ds_read_b128 v[204:207], v245 offset:128
    v_mfma_f32_16x16x32_bf16 v[236:239], a[200:203], a[240:243], v[236:239]
    s_waitcnt lgkmcnt(3)
    v_mul_f32 v232, s3, v232
    v_mul_f32 v233, s3, v233
    v_mfma_f32_16x16x32_bf16 v[200:203], v[96:99], v[174:177], v[200:203]
    v_mul_f32 v234, s3, v234
    v_mul_f32 v235, s3, v235
    v_mfma_f32_16x16x32_bf16 v[200:203], v[98:101], v[176:179], v[200:203]
    ds_read_b128 a[240:243], v240 offset:30976
    v_sub_f32 v208, v208, v248
    v_mfma_f32_16x16x32_bf16 v[236:239], a[204:207], a[244:247], v[236:239]
    ds_read_b128 a[244:247], v241 offset:30976
    v_sub_f32 v209, v209, v248
    v_mfma_f32_16x16x32_bf16 v[236:239], a[208:211], a[216:219], v[236:239]
    ds_read_b128 a[216:219], v242 offset:30720
    v_sub_f32 v210, v210, v248
    v_mfma_f32_16x16x32_bf16 v[236:239], a[212:215], a[220:223], v[236:239]
    ds_read_b128 a[220:223], v243 offset:30720
    v_exp_f32 v208, v208
    v_exp_f32 v209, v209
    v_exp_f32 v210, v210
    v_sub_f32 v211, v211, v248
    v_exp_f32 v211, v211
    v_cvt_pk_bf16_f32 v187, v208, v209
    v_cvt_pk_bf16_f32 v190, v210, v211
    s_waitcnt lgkmcnt(4)
    v_mfma_f32_16x16x32_bf16 v[212:215], v[10:13], v[184:187], v[212:215]
    v_mul_f32 v236, s38, v236
    v_mul_f32 v237, s38, v237
    v_mfma_f32_16x16x32_bf16 v[216:219], v[40:43], v[184:187], v[216:219]
    v_mul_f32 v238, s38, v238
    v_mul_f32 v239, s38, v239
    v_mfma_f32_16x16x32_bf16 v[220:223], v[70:73], v[184:187], v[220:223]
    ds_read_b128 v[208:211], v246 offset:128
    v_sub_f32 v196, v196, v248
    v_mfma_f32_16x16x32_bf16 v[224:227], a[248:251], v[184:187], v[224:227]
    v_exp_f32 v196, v196
    v_mfma_f32_16x16x32_bf16 v[204:207], v[132:135], v[174:177], v[204:207]
    v_sub_f32 v197, v197, v248
    v_sub_f32 v198, v198, v248
    v_mfma_f32_16x16x32_bf16 v[204:207], v[134:137], v[176:179], v[204:207]
    v_exp_f32 v197, v197
    v_exp_f32 v198, v198
    v_sub_f32 v199, v199, v248
    v_exp_f32 v199, v199
    v_cvt_pk_bf16_f32 v188, v196, v197
    v_cvt_pk_bf16_f32 v191, v198, v199
    ds_read_b128 v[196:199], v244 offset:0
    v_sub_f32 v200, v200, v248
    v_mfma_f32_16x16x32_bf16 v[212:215], v[14:17], v[188:191], v[212:215]
    v_exp_f32 v200, v200
    v_mfma_f32_16x16x32_bf16 v[216:219], v[44:47], v[188:191], v[216:219]
    v_sub_f32 v201, v201, v248
    v_sub_f32 v204, v204, v248
    v_mfma_f32_16x16x32_bf16 v[220:223], v[74:77], v[188:191], v[220:223]
    s_waitcnt lgkmcnt(1)
    v_exp_f32 v201, v201
    v_mfma_f32_16x16x32_bf16 v[224:227], a[248:251], v[188:191], v[224:227]
    v_cvt_pk_bf16_f32 v192, v200, v201
    v_sub_f32 v205, v205, v248
    v_mfma_f32_16x16x32_bf16 v[208:211], v[102:105], v[174:177], v[208:211]
    v_cvt_pk_bf16_f32 v174, v228, v229
    v_cvt_pk_bf16_f32 v175, v230, v231
    v_mfma_f32_16x16x32_bf16 v[208:211], v[104:107], v[176:179], v[208:211]
    ds_write_b64 v247, v[174:175] offset:0
    v_mfma_f32_16x16x32_bf16 v[228:231], a[0:3], a[224:227], 0
    v_cvt_pk_bf16_f32 v176, v232, v233
    v_cvt_pk_bf16_f32 v177, v234, v235
    v_mfma_f32_16x16x32_bf16 v[228:231], a[4:7], a[228:231], v[228:231]
    ds_write_b64 v247, v[176:177] offset:128
    v_mfma_f32_16x16x32_bf16 v[228:231], a[8:11], a[232:235], v[228:231]
    s_waitcnt lgkmcnt(2)
    v_cvt_pk_bf16_f32 v178, v236, v237
    v_cvt_pk_bf16_f32 v179, v238, v239
    v_mfma_f32_16x16x32_bf16 v[196:199], v[90:93], v[168:171], v[196:199]
    ds_write_b64 v247, v[178:179] offset:256
    v_mfma_f32_16x16x32_bf16 v[196:199], v[92:95], v[170:173], v[196:199]
    ds_read_b128 v[200:203], v245 offset:0
    v_sub_f32 v208, v208, v248
    v_mfma_f32_16x16x32_bf16 v[228:231], a[12:15], a[236:239], v[228:231]
    v_exp_f32 v204, v204
    v_mfma_f32_16x16x32_bf16 v[228:231], a[16:19], a[240:243], v[228:231]
    v_exp_f32 v205, v205
    v_mfma_f32_16x16x32_bf16 v[228:231], a[20:23], a[244:247], v[228:231]
    v_cvt_pk_bf16_f32 v193, v204, v205
    v_sub_f32 v209, v209, v248
    v_mfma_f32_16x16x32_bf16 v[232:235], a[24:27], a[224:227], 0
    ds_read_b128 v[204:207], v246 offset:0
    v_accvgpr_read_b32 v254, a252
    v_mfma_f32_16x16x32_bf16 v[232:235], a[28:31], a[228:231], v[232:235]
    v_exp_f32 v208, v208
    v_mfma_f32_16x16x32_bf16 v[232:235], a[32:35], a[232:235], v[232:235]
    v_exp_f32 v209, v209
    v_mfma_f32_16x16x32_bf16 v[232:235], a[36:39], a[236:239], v[232:235]
    buffer_load_dwordx4 v254, s[4:7], s44 offen lds
    v_cvt_pk_bf16_f32 v194, v208, v209
    v_mfma_f32_16x16x32_bf16 v[232:235], a[40:43], a[240:243], v[232:235]
    ds_read_b128 v[208:211], v244 offset:64
    v_accvgpr_read_b32 v255, a253
    v_mfma_f32_16x16x32_bf16 v[212:215], v[18:21], v[192:195], v[212:215]
    s_waitcnt lgkmcnt(2)
    v_accvgpr_read_b32 v254, a254
    v_max_f32 v248, v196, v197
    v_mfma_f32_16x16x32_bf16 v[216:219], v[48:51], v[192:195], v[216:219]
    v_max3_f32 v248, v248, v198, v199
    v_mfma_f32_16x16x32_bf16 v[220:223], v[78:81], v[192:195], v[220:223]
    ds_read_b128 v[196:199], v245 offset:64
    buffer_load_dwordx4 v255, s[4:7], s44 offen offset:1024 lds
    v_mfma_f32_16x16x32_bf16 v[224:227], a[248:251], v[192:195], v[224:227]
    v_accvgpr_read_b32 v255, a252
    s_waitcnt lgkmcnt(2)
    v_mfma_f32_16x16x32_bf16 v[200:203], v[126:129], v[168:171], v[200:203]
    v_mfma_f32_16x16x32_bf16 v[200:203], v[128:131], v[170:173], v[200:203]
    v_mfma_f32_16x16x32_bf16 v[204:207], v[162:165], v[168:171], v[204:207]
    buffer_load_dwordx4 v254, s[4:7], s44 offen offset:2048 lds
    s_add_u32 m0, s46, 0xc00
    v_mfma_f32_16x16x32_bf16 v[204:207], v[164:167], v[170:173], v[204:207]
    v_rcp_f32 v225, v224
    v_mfma_f32_16x16x32_bf16 v[232:235], a[44:47], a[244:247], v[232:235]
    s_waitcnt lgkmcnt(1)
    v_mul_f32 v212, v212, v225
    v_mul_f32 v213, v213, v225
    v_mfma_f32_16x16x32_bf16 v[208:211], v[96:99], v[168:171], v[208:211]
    v_mul_f32 v214, v214, v225
    v_mul_f32 v215, v215, v225
    v_mfma_f32_16x16x32_bf16 v[208:211], v[98:101], v[170:173], v[208:211]
    v_cvt_pk_bf16_f32 v212, v212, v213
    v_cvt_pk_bf16_f32 v213, v214, v215
    v_mfma_f32_16x16x32_bf16 v[236:239], a[48:51], a[224:227], 0
    ds_write_b64 v251, v[212:213] offset:6144
    v_mfma_f32_16x16x32_bf16 v[236:239], a[52:55], a[228:231], v[236:239]
    s_waitcnt lgkmcnt(1)
    v_mul_f32 v216, v216, v225
    v_mul_f32 v217, v217, v225
    v_mfma_f32_16x16x32_bf16 v[196:199], v[132:135], v[168:171], v[196:199]
    v_mul_f32 v218, v218, v225
    v_mul_f32 v219, v219, v225
    v_mfma_f32_16x16x32_bf16 v[196:199], v[134:137], v[170:173], v[196:199]
    v_cvt_pk_bf16_f32 v216, v216, v217
    v_cvt_pk_bf16_f32 v217, v218, v219
    v_mfma_f32_16x16x32_bf16 v[236:239], a[56:59], a[232:235], v[236:239]
    ds_write_b64 v251, v[216:217] offset:6272
    v_mfma_f32_16x16x32_bf16 v[236:239], a[60:63], a[236:239], v[236:239]
    v_mul_f32 v220, v220, v225
    v_mul_f32 v221, v221, v225
    v_mfma_f32_16x16x32_bf16 v[236:239], a[64:67], a[240:243], v[236:239]
    v_mul_f32 v222, v222, v225
    v_mul_f32 v223, v223, v225
    v_mfma_f32_16x16x32_bf16 v[236:239], a[68:71], a[244:247], v[236:239]
    v_cvt_pk_bf16_f32 v220, v220, v221
    v_cvt_pk_bf16_f32 v221, v222, v223
    ds_write_b64 v251, v[220:221] offset:6400
    buffer_load_dwordx4 v255, s[4:7], s59 offen lds
    v_accvgpr_read_b32 v254, a253
    v_accvgpr_read_b32 v255, a254
    v_max3_f32 v248, v248, v200, v201
    v_max3_f32 v248, v248, v202, v203
    ds_read_b128 v[200:203], v246 offset:64
    v_max3_f32 v248, v248, v204, v205
    v_max3_f32 v248, v248, v206, v207
    ds_read_b128 v[204:207], v244 offset:128
    v_max3_f32 v248, v248, v208, v209
    buffer_load_dwordx4 v254, s[4:7], s59 offen offset:1024 lds
    v_accvgpr_read_b32 v254, a252
    v_max3_f32 v248, v248, v210, v211
    ds_read_b128 v[208:211], v245 offset:128
    v_max3_f32 v248, v248, v196, v197
    v_max3_f32 v248, v248, v198, v199
    ds_read_b128 v[196:199], v246 offset:128
    buffer_load_dwordx4 v255, s[4:7], s59 offen offset:2048 lds
    s_add_u32 m0, s46, 0x1800
    v_accvgpr_read_b32 v255, a255
    s_waitcnt lgkmcnt(3)
    v_mfma_f32_16x16x32_bf16 v[200:203], v[102:105], v[168:171], v[200:203]
    v_mfma_f32_16x16x32_bf16 v[200:203], v[104:107], v[170:173], v[200:203]
    s_waitcnt lgkmcnt(2)
    v_mfma_f32_16x16x32_bf16 v[204:207], v[138:141], v[168:171], v[204:207]
    buffer_load_dwordx4 v254, s[4:7], s58 offen lds
    v_mfma_f32_16x16x32_bf16 v[204:207], v[140:143], v[170:173], v[204:207]
    s_waitcnt lgkmcnt(1)
    v_mfma_f32_16x16x32_bf16 v[208:211], v[144:147], v[168:171], v[208:211]
    v_mfma_f32_16x16x32_bf16 v[208:211], v[146:149], v[170:173], v[208:211]
    s_waitcnt lgkmcnt(0)
    v_max3_f32 v248, v248, v200, v201
    v_max3_f32 v248, v248, v202, v203
    v_mfma_f32_16x16x32_bf16 v[196:199], v[108:111], v[168:171], v[196:199]
    ds_read_b128 v[200:203], v244 offset:0
    buffer_load_dwordx4 v255, s[4:7], s58 offen offset:512 lds
    v_mfma_f32_16x16x32_bf16 v[196:199], v[110:113], v[170:173], v[196:199]
    s_add_u32 m0, s46, 0x16800
    v_max3_f32 v248, v248, v204, v205
    ds_read_b128 v[204:207], v245 offset:0
    v_max3_f32 v248, v248, v208, v209
    ds_read_b128 v[208:211], v246 offset:0
    s_nop 2
    v_max3_f32 v248, v248, v196, v197
    ds_read_b128 v[196:199], v244 offset:64
    v_mov_b32 v225, v248
    s_nop 1
    v_permlane16_swap_b32 v248, v225
    v_max_f32 v248, v248, v225
    v_mov_b32 v225, v248
    s_nop 1
    v_permlane32_swap_b32 v248, v225
    v_max_f32 v248, v248, v225
    s_waitcnt lgkmcnt(3)
    v_mfma_f32_16x16x32_bf16 v[200:203], v[90:93], v[168:171], v[200:203]
    v_cvt_pk_bf16_f32 v90, v228, v229
    v_cvt_pk_bf16_f32 v91, v230, v231
    v_mfma_f32_16x16x32_bf16 v[200:203], v[92:95], v[170:173], v[200:203]
    v_cvt_pk_bf16_f32 v92, v232, v233
    v_cvt_pk_bf16_f32 v93, v234, v235
    v_mfma_f32_16x16x32_bf16 v[228:231], a[224:227], a[72:75], 0
    s_waitcnt lgkmcnt(2)
    v_cvt_pk_bf16_f32 v94, v236, v237
    v_cvt_pk_bf16_f32 v95, v238, v239
    v_mfma_f32_16x16x32_bf16 v[204:207], v[126:129], v[168:171], v[204:207]
    s_waitcnt lgkmcnt(1)
    v_sub_f32 v200, v200, v248
    v_sub_f32 v201, v201, v248
    v_mfma_f32_16x16x32_bf16 v[204:207], v[128:131], v[170:173], v[204:207]
    v_exp_f32 v200, v200
    v_mfma_f32_16x16x32_bf16 v[208:211], v[162:165], v[168:171], v[208:211]
    s_waitcnt lgkmcnt(0)
    v_exp_f32 v201, v201
    v_mfma_f32_16x16x32_bf16 v[208:211], v[164:167], v[170:173], v[208:211]
    v_sub_f32 v202, v202, v248
    v_sub_f32 v203, v203, v248
    v_mfma_f32_16x16x32_bf16 v[196:199], v[96:99], v[168:171], v[196:199]
    v_exp_f32 v202, v202
    v_mfma_f32_16x16x32_bf16 v[196:199], v[98:101], v[170:173], v[196:199]
    v_exp_f32 v203, v203
    v_mfma_f32_16x16x32_bf16 v[228:231], a[228:231], a[76:79], v[228:231]
    v_cvt_pk_bf16_f32 v180, v200, v201
    v_cvt_pk_bf16_f32 v183, v202, v203
    v_mfma_f32_16x16x32_bf16 v[228:231], a[232:235], a[80:83], v[228:231]
    ds_read_b128 v[200:203], v245 offset:64
    v_sub_f32 v204, v204, v248
    v_mfma_f32_16x16x32_bf16 v[228:231], a[236:239], a[84:87], v[228:231]
    v_exp_f32 v204, v204
    v_mfma_f32_16x16x32_bf16 v[228:231], a[240:243], a[88:91], v[228:231]
    v_sub_f32 v205, v205, v248
    v_sub_f32 v206, v206, v248
    v_mfma_f32_16x16x32_bf16 v[228:231], a[244:247], a[92:95], v[228:231]
    v_exp_f32 v205, v205
    v_mfma_f32_16x16x32_bf16 v[232:235], a[224:227], a[96:99], 0
    v_exp_f32 v206, v206
    v_mfma_f32_16x16x32_bf16 v[232:235], a[228:231], a[100:103], v[232:235]
    v_sub_f32 v207, v207, v248
    v_cvt_pk_bf16_f32 v181, v204, v205
    v_mfma_f32_16x16x32_bf16 v[232:235], a[232:235], a[104:107], v[232:235]
    v_exp_f32 v207, v207
    v_mfma_f32_16x16x32_bf16 v[232:235], a[236:239], a[108:111], v[232:235]
    v_cvt_pk_bf16_f32 v0, v228, v229
    v_cvt_pk_bf16_f32 v3, v230, v231
    v_mfma_f32_16x16x32_bf16 v[232:235], a[240:243], a[112:115], v[232:235]
    v_cvt_pk_bf16_f32 v184, v206, v207
    v_sub_f32 v208, v208, v248
    v_mfma_f32_16x16x32_bf16 v[232:235], a[244:247], a[116:119], v[232:235]
    ds_read_b128 v[204:207], v246 offset:64
    v_sub_f32 v209, v209, v248
    v_mfma_f32_16x16x32_bf16 v[236:239], a[224:227], a[120:123], 0
    ds_read_b128 a[224:227], v242 offset:30848
    v_sub_f32 v210, v210, v248
    v_mfma_f32_16x16x32_bf16 v[236:239], a[228:231], a[124:127], v[236:239]
    ds_read_b128 a[228:231], v243 offset:30848
    v_sub_f32 v211, v211, v248
    v_mfma_f32_16x16x32_bf16 v[236:239], a[232:235], a[128:131], v[236:239]
    s_waitcnt lgkmcnt(3)
    v_cvt_pk_bf16_f32 v30, v232, v233
    v_cvt_pk_bf16_f32 v33, v234, v235
    v_mfma_f32_16x16x32_bf16 v[200:203], v[132:135], v[168:171], v[200:203]
    ds_read_b128 a[232:235], v242 offset:30976
    v_sub_f32 v196, v196, v248
    v_mfma_f32_16x16x32_bf16 v[200:203], v[134:137], v[170:173], v[200:203]
    v_exp_f32 v208, v208
    v_mfma_f32_16x16x32_bf16 v[236:239], a[236:239], a[132:135], v[236:239]
    ds_read_b128 a[236:239], v243 offset:30976
    v_sub_f32 v197, v197, v248
    v_mfma_f32_16x16x32_bf16 v[236:239], a[240:243], a[136:139], v[236:239]
    ds_read_b128 a[240:243], v240 offset:32256
    v_sub_f32 v198, v198, v248
    v_mfma_f32_16x16x32_bf16 v[236:239], a[244:247], a[140:143], v[236:239]
    ds_read_b128 a[244:247], v241 offset:32256
    v_sub_f32 v199, v199, v248
    v_mfma_f32_16x16x32_bf16 v[228:231], a[144:147], a[216:219], 0
    s_waitcnt lgkmcnt(6)
    v_exp_f32 v209, v209
    v_mfma_f32_16x16x32_bf16 v[204:207], v[102:105], v[168:171], v[204:207]
    v_exp_f32 v210, v210
    v_mfma_f32_16x16x32_bf16 v[204:207], v[104:107], v[170:173], v[204:207]
    v_cvt_pk_bf16_f32 v60, v236, v237
    v_cvt_pk_bf16_f32 v63, v238, v239
    v_mfma_f32_16x16x32_bf16 v[228:231], a[148:151], a[220:223], v[228:231]
    s_waitcnt lgkmcnt(5)
    v_exp_f32 v211, v211
    v_mfma_f32_16x16x32_bf16 v[228:231], a[152:155], a[224:227], v[228:231]
    s_waitcnt lgkmcnt(4)
    v_cvt_pk_bf16_f32 v182, v208, v209
    v_cvt_pk_bf16_f32 v185, v210, v211
    v_mfma_f32_16x16x32_bf16 v[228:231], a[156:159], a[228:231], v[228:231]
    ds_read_b128 v[208:211], v244 offset:128
    v_sub_f32 v200, v200, v248
    v_mfma_f32_16x16x32_bf16 v[212:215], v[12:15], v[180:183], 0
    s_waitcnt lgkmcnt(4)
    v_exp_f32 v196, v196
    v_mfma_f32_16x16x32_bf16 v[216:219], v[42:45], v[180:183], 0
    v_exp_f32 v197, v197
    v_mfma_f32_16x16x32_bf16 v[220:223], v[72:75], v[180:183], 0
    v_exp_f32 v198, v198
    v_mfma_f32_16x16x32_bf16 v[224:227], a[248:251], v[180:183], 0
    v_exp_f32 v199, v199
    v_mfma_f32_16x16x32_bf16 v[228:231], a[160:163], a[232:235], v[228:231]
    s_waitcnt lgkmcnt(3)
    v_cvt_pk_bf16_f32 v186, v196, v197
    v_cvt_pk_bf16_f32 v189, v198, v199
    v_mfma_f32_16x16x32_bf16 v[228:231], a[164:167], a[236:239], v[228:231]
    ds_read_b128 v[196:199], v245 offset:128
    v_sub_f32 v201, v201, v248
    v_mfma_f32_16x16x32_bf16 v[232:235], a[168:171], a[216:219], 0
    v_exp_f32 v200, v200
    v_mfma_f32_16x16x32_bf16 v[232:235], a[172:175], a[220:223], v[232:235]
    v_exp_f32 v201, v201
    v_mfma_f32_16x16x32_bf16 v[232:235], a[176:179], a[224:227], v[232:235]
    s_waitcnt lgkmcnt(1)
    v_mul_f32 v228, s38, v228
    v_mul_f32 v229, s38, v229
    v_mfma_f32_16x16x32_bf16 v[208:211], v[138:141], v[168:171], v[208:211]
    v_mul_f32 v230, s38, v230
    v_mul_f32 v231, s38, v231
    v_mfma_f32_16x16x32_bf16 v[208:211], v[140:143], v[170:173], v[208:211]
    v_sub_f32 v202, v202, v248
    v_sub_f32 v203, v203, v248
    v_mfma_f32_16x16x32_bf16 v[232:235], a[180:183], a[228:231], v[232:235]
    v_exp_f32 v202, v202
    v_mfma_f32_16x16x32_bf16 v[232:235], a[184:187], a[232:235], v[232:235]
    v_exp_f32 v203, v203
    v_mfma_f32_16x16x32_bf16 v[232:235], a[188:191], a[236:239], v[232:235]
    v_cvt_pk_bf16_f32 v187, v200, v201
    v_cvt_pk_bf16_f32 v190, v202, v203
    v_mfma_f32_16x16x32_bf16 v[236:239], a[192:195], a[216:219], 0
    ds_read_b128 a[216:219], v240 offset:32384
    ds_read_b128 v[200:203], v246 offset:128
    v_mfma_f32_16x16x32_bf16 v[212:215], v[16:19], v[184:187], v[212:215]
    s_waitcnt lgkmcnt(2)
    v_sub_f32 v204, v204, v248
    v_mul_f32 v232, s3, v232
    v_mfma_f32_16x16x32_bf16 v[216:219], v[46:49], v[184:187], v[216:219]
    v_mul_f32 v233, s3, v233
    v_mul_f32 v234, s3, v234
    v_mfma_f32_16x16x32_bf16 v[220:223], v[76:79], v[184:187], v[220:223]
    v_mul_f32 v235, s3, v235
    v_sub_f32 v205, v205, v248
    v_mfma_f32_16x16x32_bf16 v[224:227], a[248:251], v[184:187], v[224:227]
    v_exp_f32 v204, v204
    v_mfma_f32_16x16x32_bf16 v[196:199], v[144:147], v[168:171], v[196:199]
    v_exp_f32 v205, v205
    v_mfma_f32_16x16x32_bf16 v[196:199], v[146:149], v[170:173], v[196:199]
    v_sub_f32 v206, v206, v248
    v_sub_f32 v207, v207, v248
    v_mfma_f32_16x16x32_bf16 v[236:239], a[196:199], a[220:223], v[236:239]
    ds_read_b128 a[220:223], v241 offset:32384
    v_cvt_pk_bf16_f32 v188, v204, v205
    v_mfma_f32_16x16x32_bf16 v[236:239], a[200:203], a[224:227], v[236:239]
    ds_read_b128 a[224:227], v240 offset:32512
    v_sub_f32 v208, v208, v248
    v_mfma_f32_16x16x32_bf16 v[236:239], a[204:207], a[228:231], v[236:239]
    ds_read_b128 a[228:231], v241 offset:32512
    v_sub_f32 v209, v209, v248
    v_mfma_f32_16x16x32_bf16 v[236:239], a[208:211], a[232:235], v[236:239]
    ds_read_b128 a[232:235], v242 offset:32256
    v_sub_f32 v196, v196, v248
    v_mfma_f32_16x16x32_bf16 v[236:239], a[212:215], a[236:239], v[236:239]
    s_waitcnt lgkmcnt(4)
    ds_read_b128 a[236:239], v243 offset:32256
    v_mfma_f32_16x16x32_bf16 v[200:203], v[108:111], v[168:171], v[200:203]
    v_cvt_pk_bf16_f32 v168, v228, v229
    v_cvt_pk_bf16_f32 v169, v230, v231
    v_mfma_f32_16x16x32_bf16 v[200:203], v[110:113], v[170:173], v[200:203]
    v_cvt_pk_bf16_f32 v170, v232, v233
    v_cvt_pk_bf16_f32 v171, v234, v235
    v_mfma_f32_16x16x32_bf16 v[228:231], a[0:3], a[240:243], 0
    v_mul_f32 v236, s38, v236
    v_mul_f32 v237, s38, v237
    v_mfma_f32_16x16x32_bf16 v[228:231], a[4:7], a[244:247], v[228:231]
    v_mul_f32 v238, s38, v238
    v_mul_f32 v239, s38, v239
    v_mfma_f32_16x16x32_bf16 v[228:231], a[8:11], a[216:219], v[228:231]
    s_waitcnt lgkmcnt(4)
    v_cvt_pk_bf16_f32 v172, v236, v237
    v_cvt_pk_bf16_f32 v173, v238, v239
    v_mfma_f32_16x16x32_bf16 v[228:231], a[12:15], a[220:223], v[228:231]
    s_waitcnt lgkmcnt(3)
    v_exp_f32 v206, v206
    v_mfma_f32_16x16x32_bf16 v[228:231], a[16:19], a[224:227], v[228:231]
    s_waitcnt lgkmcnt(2)
    v_exp_f32 v207, v207
    v_mfma_f32_16x16x32_bf16 v[228:231], a[20:23], a[228:231], v[228:231]
    v_cvt_pk_bf16_f32 v191, v206, v207
    v_sub_f32 v197, v197, v248
    v_mfma_f32_16x16x32_bf16 v[232:235], a[24:27], a[240:243], 0
    ds_read_b128 v[204:207], v244 offset:0
    v_sub_f32 v200, v200, v248
    v_mfma_f32_16x16x32_bf16 v[212:215], v[20:23], v[188:191], v[212:215]
    v_exp_f32 v208, v208
    v_mfma_f32_16x16x32_bf16 v[216:219], v[50:53], v[188:191], v[216:219]
    v_exp_f32 v209, v209
    v_mfma_f32_16x16x32_bf16 v[220:223], v[80:83], v[188:191], v[220:223]
    v_cvt_pk_bf16_f32 v192, v208, v209
    v_sub_f32 v201, v201, v248
    v_mfma_f32_16x16x32_bf16 v[224:227], a[248:251], v[188:191], v[224:227]
    ds_read_b128 v[208:211], v245 offset:0
    v_mfma_f32_16x16x32_bf16 v[232:235], a[28:31], a[244:247], v[232:235]
    v_exp_f32 v196, v196
    v_mfma_f32_16x16x32_bf16 v[232:235], a[32:35], a[216:219], v[232:235]
    v_exp_f32 v197, v197
    v_mfma_f32_16x16x32_bf16 v[232:235], a[36:39], a[220:223], v[232:235]
    v_exp_f32 v200, v200
    v_mfma_f32_16x16x32_bf16 v[232:235], a[40:43], a[224:227], v[232:235]
    v_exp_f32 v201, v201
    v_mfma_f32_16x16x32_bf16 v[232:235], a[44:47], a[228:231], v[232:235]
    s_waitcnt lgkmcnt(1)
    v_cvt_pk_bf16_f32 v193, v196, v197
    v_cvt_pk_bf16_f32 v194, v200, v201
    v_mfma_f32_16x16x32_bf16 v[204:207], v[96:99], v[174:177], v[204:207]
    ds_read_b128 v[196:199], v246 offset:0
    ds_read_b128 v[200:203], v244 offset:64
    v_mfma_f32_16x16x32_bf16 v[212:215], v[24:27], v[192:195], v[212:215]
    v_mfma_f32_16x16x32_bf16 v[216:219], v[54:57], v[192:195], v[216:219]
    v_mfma_f32_16x16x32_bf16 v[220:223], v[84:87], v[192:195], v[220:223]
    s_waitcnt lgkmcnt(2)
    v_mfma_f32_16x16x32_bf16 v[224:227], a[248:251], v[192:195], v[224:227]
    v_mfma_f32_16x16x32_bf16 v[204:207], v[98:101], v[176:179], v[204:207]
    v_mfma_f32_16x16x32_bf16 v[208:211], v[132:135], v[174:177], v[208:211]
    v_mfma_f32_16x16x32_bf16 v[208:211], v[134:137], v[176:179], v[208:211]
    v_mfma_f32_16x16x32_bf16 v[236:239], a[48:51], a[240:243], 0
    v_mfma_f32_16x16x32_bf16 v[236:239], a[52:55], a[244:247], v[236:239]
    s_waitcnt lgkmcnt(1)
    s_waitcnt lgkmcnt(0)
    v_mfma_f32_16x16x32_bf16 v[196:199], v[102:105], v[174:177], v[196:199]
    v_rcp_f32 v225, v224
    v_mfma_f32_16x16x32_bf16 v[196:199], v[104:107], v[176:179], v[196:199]
    v_mul_f32 v212, v212, v225
    v_mul_f32 v213, v213, v225
    v_mfma_f32_16x16x32_bf16 v[200:203], v[138:141], v[174:177], v[200:203]
    v_mul_f32 v214, v214, v225
    v_mul_f32 v215, v215, v225
    v_mfma_f32_16x16x32_bf16 v[200:203], v[140:143], v[176:179], v[200:203]
    v_cvt_pk_bf16_f32 v212, v212, v213
    v_cvt_pk_bf16_f32 v213, v214, v215
    v_mfma_f32_16x16x32_bf16 v[236:239], a[56:59], a[216:219], v[236:239]
    ds_write_b64 v251, v[212:213] offset:12288
    v_mfma_f32_16x16x32_bf16 v[236:239], a[60:63], a[220:223], v[236:239]
    v_mul_f32 v216, v216, v225
    v_mul_f32 v217, v217, v225
    v_mfma_f32_16x16x32_bf16 v[236:239], a[64:67], a[224:227], v[236:239]
    v_mul_f32 v218, v218, v225
    v_mul_f32 v219, v219, v225
    v_mfma_f32_16x16x32_bf16 v[236:239], a[68:71], a[228:231], v[236:239]
    v_cvt_pk_bf16_f32 v216, v216, v217
    v_cvt_pk_bf16_f32 v217, v218, v219
    ds_write_b64 v251, v[216:217] offset:12416
    v_mul_f32 v220, v220, v225
    v_mul_f32 v221, v221, v225
    v_mul_f32 v222, v222, v225
    v_mul_f32 v223, v223, v225
    v_cvt_pk_bf16_f32 v220, v220, v221
    v_cvt_pk_bf16_f32 v221, v222, v223
    ds_write_b64 v251, v[220:221] offset:12544
    v_max_f32 v248, v204, v205
    v_max3_f32 v248, v248, v206, v207
    ds_read_b128 v[204:207], v245 offset:64
    v_max3_f32 v248, v248, v208, v209
    v_max3_f32 v248, v248, v210, v211
    ds_read_b128 v[208:211], v246 offset:64
    v_max3_f32 v248, v248, v196, v197
    v_max3_f32 v248, v248, v198, v199
    ds_read_b128 v[196:199], v244 offset:0
    v_max3_f32 v248, v248, v200, v201
    v_max3_f32 v248, v248, v202, v203
    ds_read_b128 v[200:203], v245 offset:0
    s_waitcnt lgkmcnt(3)
    v_mfma_f32_16x16x32_bf16 v[204:207], v[144:147], v[174:177], v[204:207]
    v_mfma_f32_16x16x32_bf16 v[204:207], v[146:149], v[176:179], v[204:207]
    s_waitcnt lgkmcnt(2)
    v_mfma_f32_16x16x32_bf16 v[208:211], v[108:111], v[174:177], v[208:211]
    s_waitcnt lgkmcnt(1)
    v_mfma_f32_16x16x32_bf16 v[208:211], v[110:113], v[176:179], v[208:211]
    v_mfma_f32_16x16x32_bf16 v[196:199], v[96:99], v[174:177], v[196:199]
    s_waitcnt lgkmcnt(0)
    v_cvt_pk_bf16_f32 v96, v228, v229
    v_cvt_pk_bf16_f32 v97, v230, v231
    v_mfma_f32_16x16x32_bf16 v[196:199], v[98:101], v[176:179], v[196:199]
    v_cvt_pk_bf16_f32 v98, v232, v233
    v_cvt_pk_bf16_f32 v99, v234, v235
    v_mfma_f32_16x16x32_bf16 v[200:203], v[132:135], v[174:177], v[200:203]
    v_cvt_pk_bf16_f32 v100, v236, v237
    v_cvt_pk_bf16_f32 v101, v238, v239
    v_mfma_f32_16x16x32_bf16 v[200:203], v[134:137], v[176:179], v[200:203]
    v_max3_f32 v248, v248, v204, v205
    v_max3_f32 v248, v248, v206, v207
    v_mfma_f32_16x16x32_bf16 v[228:231], a[240:243], a[72:75], 0
    ds_read_b128 v[204:207], v246 offset:0
    v_max3_f32 v248, v248, v208, v209
    v_mfma_f32_16x16x32_bf16 v[228:231], a[244:247], a[76:79], v[228:231]
    v_max3_f32 v248, v248, v210, v211
    v_mov_b32 v225, v248
    v_mfma_f32_16x16x32_bf16 v[228:231], a[216:219], a[80:83], v[228:231]
    ds_read_b128 v[208:211], v244 offset:64
    v_permlane16_swap_b32 v248, v225
    v_mfma_f32_16x16x32_bf16 v[228:231], a[220:223], a[84:87], v[228:231]
    v_max_f32 v248, v248, v225
    v_mov_b32 v225, v248
    v_mfma_f32_16x16x32_bf16 v[228:231], a[224:227], a[88:91], v[228:231]
    v_mfma_f32_16x16x32_bf16 v[228:231], a[228:231], a[92:95], v[228:231]
    v_permlane32_swap_b32 v248, v225
    v_max_f32 v248, v248, v225
    v_mfma_f32_16x16x32_bf16 v[232:235], a[240:243], a[96:99], 0
    v_sub_f32 v196, v196, v248
    v_sub_f32 v197, v197, v248
    v_mfma_f32_16x16x32_bf16 v[232:235], a[244:247], a[100:103], v[232:235]
    v_exp_f32 v196, v196
    v_mfma_f32_16x16x32_bf16 v[232:235], a[216:219], a[104:107], v[232:235]
    v_cvt_pk_bf16_f32 v6, v228, v229
    v_cvt_pk_bf16_f32 v9, v230, v231
    v_mfma_f32_16x16x32_bf16 v[232:235], a[220:223], a[108:111], v[232:235]
    s_waitcnt lgkmcnt(1)
    v_exp_f32 v197, v197
    v_mfma_f32_16x16x32_bf16 v[204:207], v[102:105], v[174:177], v[204:207]
    v_sub_f32 v198, v198, v248
    v_sub_f32 v199, v199, v248
    v_mfma_f32_16x16x32_bf16 v[204:207], v[104:107], v[176:179], v[204:207]
    s_waitcnt lgkmcnt(0)
    v_exp_f32 v198, v198
    v_mfma_f32_16x16x32_bf16 v[208:211], v[138:141], v[174:177], v[208:211]
    v_exp_f32 v199, v199
    v_mfma_f32_16x16x32_bf16 v[208:211], v[140:143], v[176:179], v[208:211]
    v_cvt_pk_bf16_f32 v180, v196, v197
    v_cvt_pk_bf16_f32 v183, v198, v199
    v_mfma_f32_16x16x32_bf16 v[232:235], a[224:227], a[112:115], v[232:235]
    ds_read_b128 v[196:199], v245 offset:64
    v_sub_f32 v200, v200, v248
    v_mfma_f32_16x16x32_bf16 v[232:235], a[228:231], a[116:119], v[232:235]
    v_exp_f32 v200, v200
    v_mfma_f32_16x16x32_bf16 v[236:239], a[240:243], a[120:123], 0
    ds_read_b128 a[240:243], v242 offset:32384
    v_sub_f32 v201, v201, v248
    v_mfma_f32_16x16x32_bf16 v[236:239], a[244:247], a[124:127], v[236:239]
    ds_read_b128 a[244:247], v243 offset:32384
    v_sub_f32 v202, v202, v248
    v_mfma_f32_16x16x32_bf16 v[236:239], a[216:219], a[128:131], v[236:239]
    v_cvt_pk_bf16_f32 v36, v232, v233
    v_cvt_pk_bf16_f32 v39, v234, v235
    v_mfma_f32_16x16x32_bf16 v[236:239], a[220:223], a[132:135], v[236:239]
    ds_read_b128 a[216:219], v242 offset:32512
    ds_read_b128 a[220:223], v243 offset:32512
    v_mfma_f32_16x16x32_bf16 v[236:239], a[224:227], a[136:139], v[236:239]
    ds_read_b128 a[224:227], v242 offset:33792
    v_sub_f32 v203, v203, v248
    v_mfma_f32_16x16x32_bf16 v[236:239], a[228:231], a[140:143], v[236:239]
    ds_read_b128 a[228:231], v243 offset:33792
    v_sub_f32 v204, v204, v248
    v_mfma_f32_16x16x32_bf16 v[228:231], a[144:147], a[232:235], 0
    v_exp_f32 v201, v201
    v_mfma_f32_16x16x32_bf16 v[228:231], a[148:151], a[236:239], v[228:231]
    s_waitcnt lgkmcnt(6)
    v_exp_f32 v202, v202
    v_mfma_f32_16x16x32_bf16 v[196:199], v[144:147], v[174:177], v[196:199]
    v_cvt_pk_bf16_f32 v66, v236, v237
    v_cvt_pk_bf16_f32 v69, v238, v239
    v_mfma_f32_16x16x32_bf16 v[196:199], v[146:149], v[176:179], v[196:199]
    s_waitcnt lgkmcnt(5)
    v_exp_f32 v203, v203
    v_mfma_f32_16x16x32_bf16 v[228:231], a[152:155], a[240:243], v[228:231]
    s_waitcnt lgkmcnt(4)
    v_cvt_pk_bf16_f32 v181, v200, v201
    v_cvt_pk_bf16_f32 v184, v202, v203
    v_mfma_f32_16x16x32_bf16 v[228:231], a[156:159], a[244:247], v[228:231]
    ds_read_b128 v[200:203], v246 offset:64
    v_sub_f32 v205, v205, v248
    v_mfma_f32_16x16x32_bf16 v[232:235], a[168:171], a[232:235], 0
    s_waitcnt lgkmcnt(4)
    v_exp_f32 v204, v204
    v_mfma_f32_16x16x32_bf16 v[228:231], a[160:163], a[216:219], v[228:231]
    s_waitcnt lgkmcnt(3)
    v_exp_f32 v205, v205
    v_mfma_f32_16x16x32_bf16 v[228:231], a[164:167], a[220:223], v[228:231]
    v_sub_f32 v206, v206, v248
    v_sub_f32 v207, v207, v248
    v_mfma_f32_16x16x32_bf16 v[232:235], a[172:175], a[236:239], v[232:235]
    v_exp_f32 v206, v206
    v_mfma_f32_16x16x32_bf16 v[232:235], a[176:179], a[240:243], v[232:235]
    v_exp_f32 v207, v207
    v_mfma_f32_16x16x32_bf16 v[232:235], a[180:183], a[244:247], v[232:235]
    v_cvt_pk_bf16_f32 v182, v204, v205
    v_mul_f32 v228, s38, v228
    v_mfma_f32_16x16x32_bf16 v[232:235], a[184:187], a[216:219], v[232:235]
    v_mul_f32 v229, s38, v229
    v_mul_f32 v230, s38, v230
    v_mfma_f32_16x16x32_bf16 v[212:215], v[18:21], v[180:183], 0
    v_mul_f32 v231, s38, v231
    v_cvt_pk_bf16_f32 v185, v206, v207
    v_mfma_f32_16x16x32_bf16 v[216:219], v[48:51], v[180:183], 0
    s_waitcnt lgkmcnt(0)
    v_sub_f32 v208, v208, v248
    v_sub_f32 v209, v209, v248
    v_mfma_f32_16x16x32_bf16 v[220:223], v[78:81], v[180:183], 0
    v_exp_f32 v208, v208
    v_mfma_f32_16x16x32_bf16 v[224:227], a[248:251], v[180:183], 0
    v_exp_f32 v209, v209
    v_mfma_f32_16x16x32_bf16 v[200:203], v[108:111], v[174:177], v[200:203]
    v_cvt_pk_bf16_f32 v174, v228, v229
    v_cvt_pk_bf16_f32 v175, v230, v231
    v_mfma_f32_16x16x32_bf16 v[200:203], v[110:113], v[176:179], v[200:203]
    v_sub_f32 v210, v210, v248
    v_sub_f32 v211, v211, v248
    v_mfma_f32_16x16x32_bf16 v[232:235], a[188:191], a[220:223], v[232:235]
    v_exp_f32 v210, v210
    v_mfma_f32_16x16x32_bf16 v[236:239], a[192:195], a[232:235], 0
    ds_read_b128 a[232:235], v242 offset:33920
    v_cvt_pk_bf16_f32 v186, v208, v209
    v_mfma_f32_16x16x32_bf16 v[236:239], a[196:199], a[236:239], v[236:239]
    ds_read_b128 a[236:239], v243 offset:33920
    v_sub_f32 v196, v196, v248
    v_mfma_f32_16x16x32_bf16 v[236:239], a[200:203], a[240:243], v[236:239]
    v_mul_f32 v232, s3, v232
    v_mul_f32 v233, s3, v233
    v_mfma_f32_16x16x32_bf16 v[236:239], a[204:207], a[244:247], v[236:239]
    v_mul_f32 v234, s3, v234
    v_mul_f32 v235, s3, v235
    v_mfma_f32_16x16x32_bf16 v[236:239], a[208:211], a[216:219], v[236:239]
    v_cvt_pk_bf16_f32 v176, v232, v233
    v_cvt_pk_bf16_f32 v177, v234, v235
    v_mfma_f32_16x16x32_bf16 v[236:239], a[212:215], a[220:223], v[236:239]
    ds_read_b128 a[240:243], v242 offset:34048
    ds_read_b128 a[244:247], v243 offset:34048
    v_mfma_f32_16x16x32_bf16 v[228:231], a[144:147], a[224:227], 0
    v_exp_f32 v211, v211
    v_mfma_f32_16x16x32_bf16 v[228:231], a[148:151], a[228:231], v[228:231]
    v_cvt_pk_bf16_f32 v189, v210, v211
    v_sub_f32 v197, v197, v248
    v_mfma_f32_16x16x32_bf16 v[232:235], a[168:171], a[224:227], 0
    v_mul_f32 v236, s38, v236
    v_mul_f32 v237, s38, v237
    v_mfma_f32_16x16x32_bf16 v[232:235], a[172:175], a[228:231], v[232:235]
    s_waitcnt lgkmcnt(3)
    v_mul_f32 v238, s38, v238
    v_mul_f32 v239, s38, v239
    v_mfma_f32_16x16x32_bf16 v[228:231], a[152:155], a[232:235], v[228:231]
    s_waitcnt lgkmcnt(2)
    v_cvt_pk_bf16_f32 v178, v236, v237
    v_cvt_pk_bf16_f32 v179, v238, v239
    v_mfma_f32_16x16x32_bf16 v[228:231], a[156:159], a[236:239], v[228:231]
    v_exp_f32 v196, v196
    v_mfma_f32_16x16x32_bf16 v[232:235], a[176:179], a[232:235], v[232:235]
    v_exp_f32 v197, v197
    v_mfma_f32_16x16x32_bf16 v[232:235], a[180:183], a[236:239], v[232:235]
    v_sub_f32 v198, v198, v248
    v_sub_f32 v199, v199, v248
    v_mfma_f32_16x16x32_bf16 v[236:239], a[192:195], a[224:227], 0
    s_waitcnt lgkmcnt(1)
    s_waitcnt vmcnt(8) lgkmcnt(0)
    s_barrier
    v_mfma_f32_16x16x32_bf16 v[228:231], a[160:163], a[240:243], v[228:231]
    ds_read_b128 a[216:219], v240 offset:33792
    ds_read_b128 a[220:223], v241 offset:33792
    v_mfma_f32_16x16x32_bf16 v[228:231], a[164:167], a[244:247], v[228:231]
    ds_read_b128 a[224:227], v240 offset:33920
    v_cvt_pk_bf16_f32 v187, v196, v197
    v_mfma_f32_16x16x32_bf16 v[232:235], a[184:187], a[240:243], v[232:235]
    v_exp_f32 v198, v198
    v_mfma_f32_16x16x32_bf16 v[212:215], v[22:25], v[184:187], v[212:215]
    v_exp_f32 v199, v199
    v_mfma_f32_16x16x32_bf16 v[216:219], v[52:55], v[184:187], v[216:219]
    v_cvt_pk_bf16_f32 v190, v198, v199
    v_mul_f32 v228, s38, v228
    v_mfma_f32_16x16x32_bf16 v[220:223], v[82:85], v[184:187], v[220:223]
    v_mul_f32 v229, s38, v229
    v_mul_f32 v230, s38, v230
    v_mfma_f32_16x16x32_bf16 v[224:227], a[248:251], v[184:187], v[224:227]
    v_mul_f32 v231, s38, v231
    v_cvt_pk_bf16_f32 v228, v228, v229
    v_mfma_f32_16x16x32_bf16 v[232:235], a[188:191], a[244:247], v[232:235]
    v_cvt_pk_bf16_f32 v229, v230, v231
    v_sub_f32 v200, v200, v248
    v_mfma_f32_16x16x32_bf16 v[236:239], a[196:199], a[228:231], v[236:239]
    ds_write_b64 v247, v[228:229] offset:18432
    v_mfma_f32_16x16x32_bf16 v[236:239], a[200:203], a[232:235], v[236:239]
    ds_read_b128 a[228:231], v241 offset:33920
    ds_read_b128 a[232:235], v240 offset:34048
    v_mfma_f32_16x16x32_bf16 v[236:239], a[204:207], a[236:239], v[236:239]
    s_waitcnt lgkmcnt(5)
    v_mul_f32 v232, s3, v232
    v_mul_f32 v233, s3, v233
    v_mfma_f32_16x16x32_bf16 v[236:239], a[208:211], a[240:243], v[236:239]
    v_mul_f32 v234, s3, v234
    v_mul_f32 v235, s3, v235
    v_mfma_f32_16x16x32_bf16 v[236:239], a[212:215], a[244:247], v[236:239]
    ds_read_b128 a[236:239], v241 offset:34048
    v_cvt_pk_bf16_f32 v232, v232, v233
    v_mfma_f32_16x16x32_bf16 v[228:231], a[0:3], a[216:219], 0
    s_waitcnt lgkmcnt(5)
    v_cvt_pk_bf16_f32 v233, v234, v235
    v_sub_f32 v201, v201, v248
    v_mfma_f32_16x16x32_bf16 v[228:231], a[4:7], a[220:223], v[228:231]
    s_waitcnt lgkmcnt(4)
    v_mul_f32 v236, s38, v236
    v_mul_f32 v237, s38, v237
    v_mfma_f32_16x16x32_bf16 v[228:231], a[8:11], a[224:227], v[228:231]
    ds_write_b64 v247, v[232:233] offset:18560
    v_mfma_f32_16x16x32_bf16 v[232:235], a[24:27], a[216:219], 0
    v_mul_f32 v238, s38, v238
    v_mul_f32 v239, s38, v239
    v_mfma_f32_16x16x32_bf16 v[232:235], a[28:31], a[220:223], v[232:235]
    ds_read_b128 a[240:243], v242 offset:61440
    v_cvt_pk_bf16_f32 v236, v236, v237
    v_mfma_f32_16x16x32_bf16 v[232:235], a[32:35], a[224:227], v[232:235]
    s_waitcnt lgkmcnt(4)
    v_cvt_pk_bf16_f32 v237, v238, v239
    v_sub_f32 v202, v202, v248
    v_mfma_f32_16x16x32_bf16 v[228:231], a[12:15], a[228:231], v[228:231]
    ds_write_b64 v247, v[236:237] offset:18688
    v_mfma_f32_16x16x32_bf16 v[232:235], a[36:39], a[228:231], v[232:235]
    ds_read_b128 a[244:247], v243 offset:61440
    v_sub_f32 v203, v203, v248
    v_mfma_f32_16x16x32_bf16 v[236:239], a[48:51], a[216:219], 0
    s_waitcnt lgkmcnt(5)
    v_exp_f32 v200, v200
    v_mfma_f32_16x16x32_bf16 v[228:231], a[16:19], a[232:235], v[228:231]
    s_waitcnt lgkmcnt(4)
    v_exp_f32 v201, v201
    v_mfma_f32_16x16x32_bf16 v[228:231], a[20:23], a[236:239], v[228:231]
    v_exp_f32 v202, v202
    v_mfma_f32_16x16x32_bf16 v[232:235], a[40:43], a[232:235], v[232:235]
    v_exp_f32 v203, v203
    v_mfma_f32_16x16x32_bf16 v[232:235], a[44:47], a[236:239], v[232:235]
    v_cvt_pk_bf16_f32 v188, v200, v201
    v_cvt_pk_bf16_f32 v191, v202, v203
    v_mfma_f32_16x16x32_bf16 v[236:239], a[52:55], a[220:223], v[236:239]
    v_mov_b32 v204, 0x237c0
    v_cvt_pk_bf16_f32 v138, v228, v229
    v_mfma_f32_16x16x32_bf16 v[212:215], v[26:29], v[188:191], v[212:215]
    v_cvt_pk_bf16_f32 v139, v230, v231
    v_add_u32 v205, 0xfffff900, v245
    v_mfma_f32_16x16x32_bf16 v[216:219], v[56:59], v[188:191], v[216:219]
    v_cvt_pk_bf16_f32 v140, v232, v233
    v_cvt_pk_bf16_f32 v141, v234, v235
    v_mfma_f32_16x16x32_bf16 v[220:223], v[86:89], v[188:191], v[220:223]
    v_add_u32 v246, 0x700, v245
    v_mfma_f32_16x16x32_bf16 v[224:227], a[248:251], v[188:191], v[224:227]
    v_mov_b32 v191, 0
    v_mfma_f32_16x16x32_bf16 v[236:239], a[56:59], a[224:227], v[236:239]
    v_mfma_f32_16x16x32_bf16 v[236:239], a[60:63], a[228:231], v[236:239]
    v_mfma_f32_16x16x32_bf16 v[236:239], a[64:67], a[232:235], v[236:239]
    v_mfma_f32_16x16x32_bf16 v[236:239], a[68:71], a[236:239], v[236:239]
    v_mfma_f32_16x16x32_bf16 v[228:231], a[216:219], a[72:75], 0
    v_mfma_f32_16x16x32_bf16 v[228:231], a[220:223], a[76:79], v[228:231]
    v_mfma_f32_16x16x32_bf16 v[228:231], a[224:227], a[80:83], v[228:231]
    v_rcp_f32 v225, v224
    v_mfma_f32_16x16x32_bf16 v[228:231], a[228:231], a[84:87], v[228:231]
    v_mov_b32 v226, 0x22e00
    v_cndmask_b32 v226, v226, v247, vcc
    v_mfma_f32_16x16x32_bf16 v[228:231], a[232:235], a[88:91], v[228:231]
    s_mov_b32 vcc_lo, 0x0
    v_cvt_pk_bf16_f32 v142, v236, v237
    v_cvt_pk_bf16_f32 v143, v238, v239
    v_mfma_f32_16x16x32_bf16 v[228:231], a[236:239], a[92:95], v[228:231]
    s_mov_b32 vcc_hi, 0xf0000
    v_mul_f32 v212, v212, v225
    v_mul_f32 v213, v213, v225
    v_mfma_f32_16x16x32_bf16 v[232:235], a[216:219], a[96:99], 0
    v_mul_f32 v214, v214, v225
    v_mul_f32 v215, v215, v225
    v_mfma_f32_16x16x32_bf16 v[232:235], a[220:223], a[100:103], v[232:235]
    v_cvt_pk_bf16_f32 v212, v212, v213
    v_cvt_pk_bf16_f32 v12, v228, v229
    v_mfma_f32_16x16x32_bf16 v[232:235], a[224:227], a[104:107], v[232:235]
    v_cvt_pk_bf16_f32 v15, v230, v231
    v_cvt_pk_bf16_f32 v213, v214, v215
    v_mfma_f32_16x16x32_bf16 v[232:235], a[228:231], a[108:111], v[232:235]
    ds_write_b64 v226, v[212:213] offset:0
    v_mfma_f32_16x16x32_bf16 v[232:235], a[232:235], a[112:115], v[232:235]
    s_waitcnt lgkmcnt(1)
    v_mul_f32 v216, v216, v225
    v_mul_f32 v217, v217, v225
    v_mfma_f32_16x16x32_bf16 v[232:235], a[236:239], a[116:119], v[232:235]
    v_mul_f32 v218, v218, v225
    v_mul_f32 v219, v219, v225
    v_mfma_f32_16x16x32_bf16 v[236:239], a[216:219], a[120:123], 0
    ds_read_b128 a[216:219], v242 offset:61568
    v_cvt_pk_bf16_f32 v216, v216, v217
    v_mfma_f32_16x16x32_bf16 v[236:239], a[220:223], a[124:127], v[236:239]
    ds_read_b128 a[220:223], v243 offset:61568
    v_cvt_pk_bf16_f32 v217, v218, v219
    v_mfma_f32_16x16x32_bf16 v[236:239], a[224:227], a[128:131], v[236:239]
    v_cvt_pk_bf16_f32 v42, v232, v233
    v_cvt_pk_bf16_f32 v45, v234, v235
    v_mfma_f32_16x16x32_bf16 v[236:239], a[228:231], a[132:135], v[236:239]
    ds_read_b128 a[224:227], v242 offset:61696
    ds_read_b128 a[228:231], v243 offset:61696
    v_mfma_f32_16x16x32_bf16 v[236:239], a[232:235], a[136:139], v[236:239]
    ds_read_b128 a[232:235], v242 offset:62976
    v_mul_f32 v220, v220, v225
    v_mfma_f32_16x16x32_bf16 v[236:239], a[236:239], a[140:143], v[236:239]
    ds_read_b128 a[236:239], v243 offset:62976
    v_mul_f32 v221, v221, v225
    v_mfma_f32_16x16x32_bf16 v[228:231], a[144:147], a[240:243], 0
    ds_write_b64 v226, v[216:217] offset:128
    v_mfma_f32_16x16x32_bf16 v[228:231], a[148:151], a[244:247], v[228:231]
    v_mul_f32 v222, v222, v225
    v_mul_f32 v223, v223, v225
    v_mfma_f32_16x16x32_bf16 v[232:235], a[168:171], a[240:243], 0
    s_waitcnt lgkmcnt(6)
    v_cvt_pk_bf16_f32 v72, v236, v237
    v_cvt_pk_bf16_f32 v75, v238, v239
    v_mfma_f32_16x16x32_bf16 v[228:231], a[152:155], a[216:219], v[228:231]
    s_waitcnt lgkmcnt(5)
    v_cvt_pk_bf16_f32 v220, v220, v221
    v_cvt_pk_bf16_f32 v221, v222, v223
    v_mfma_f32_16x16x32_bf16 v[228:231], a[156:159], a[220:223], v[228:231]
    ds_write_b64 v226, v[220:221] offset:256
    v_mfma_f32_16x16x32_bf16 v[232:235], a[172:175], a[244:247], v[232:235]
    s_waitcnt lgkmcnt(5)
    v_cndmask_b32 v244, v205, v244, vcc
    v_cndmask_b32 v245, v245, v204, vcc
    v_mfma_f32_16x16x32_bf16 v[228:231], a[160:163], a[224:227], v[228:231]
    ds_read_b128 v[208:211], v245 offset:192
    s_waitcnt vmcnt(0) lgkmcnt(5)
    v_mfma_f32_16x16x32_bf16 v[228:231], a[164:167], a[228:231], v[228:231]
    s_barrier
    s_mov_b32 vcc_lo, 0xff00fff0
    s_mov_b32 vcc_hi, 0xf000
    v_mfma_f32_16x16x32_bf16 v[232:235], a[176:179], a[216:219], v[232:235]
    v_cndmask_b32 v244, v244, v204, vcc
    s_mov_b32 vcc_lo, 0xfff00ff
    v_mfma_f32_16x16x32_bf16 v[232:235], a[180:183], a[220:223], v[232:235]
    ds_read_b128 v[200:203], v244 offset:256
    v_mul_f32 v228, s38, v228
    v_mfma_f32_16x16x32_bf16 v[232:235], a[184:187], a[224:227], v[232:235]
    s_mov_b32 vcc_hi, 0xffffffff
    v_mul_f32 v229, s38, v229
    v_mul_f32 v230, s38, v230
    v_mfma_f32_16x16x32_bf16 v[232:235], a[188:191], a[228:231], v[232:235]
    v_mul_f32 v231, s38, v231
    v_cvt_pk_bf16_f32 v228, v228, v229
    v_mfma_f32_16x16x32_bf16 v[236:239], a[192:195], a[240:243], 0
    ds_read_b128 a[240:243], v242 offset:63104
    v_cvt_pk_bf16_f32 v229, v230, v231
    v_mfma_f32_16x16x32_bf16 v[236:239], a[196:199], a[244:247], v[236:239]
    ds_write_b64 v247, v[228:229] offset:24576
    v_mfma_f32_16x16x32_bf16 v[236:239], a[200:203], a[216:219], v[236:239]
    s_waitcnt lgkmcnt(3)
    v_mul_f32 v232, s3, v232
    v_mul_f32 v233, s3, v233
    v_mfma_f32_16x16x32_bf16 v[208:211], v[150:153], v[168:171], v[208:211]
    v_mul_f32 v234, s3, v234
    v_mul_f32 v235, s3, v235
    v_mfma_f32_16x16x32_bf16 v[208:211], v[152:155], v[170:173], v[208:211]
    ds_read_b128 a[244:247], v243 offset:63104
    v_cvt_pk_bf16_f32 v232, v232, v233
    v_mfma_f32_16x16x32_bf16 v[236:239], a[204:207], a[220:223], v[236:239]
    ds_read_b128 a[216:219], v242 offset:63232
    v_cvt_pk_bf16_f32 v233, v234, v235
    v_mfma_f32_16x16x32_bf16 v[236:239], a[208:211], a[224:227], v[236:239]
    ds_write_b64 v247, v[232:233] offset:24704
    v_mfma_f32_16x16x32_bf16 v[236:239], a[212:215], a[228:231], v[236:239]
    ds_read_b128 a[220:223], v243 offset:63232
    ds_read_b128 a[224:227], v240 offset:35328
    v_mfma_f32_16x16x32_bf16 v[228:231], a[144:147], a[232:235], 0
    ds_read_b128 a[228:231], v241 offset:35328
    v_cndmask_b32 v246, v246, v204, vcc
    v_mfma_f32_16x16x32_bf16 v[228:231], a[148:151], a[236:239], v[228:231]
    ds_read_b128 v[204:207], v244 offset:192
    ds_read_b128 v[196:199], v246 offset:192
    v_mfma_f32_16x16x32_bf16 v[232:235], a[168:171], a[232:235], 0
    s_mov_b32 vcc_lo, 0xff00ff00
    v_mul_f32 v236, s38, v236
    v_mul_f32 v237, s38, v237
    v_mfma_f32_16x16x32_bf16 v[232:235], a[172:175], a[236:239], v[232:235]
    s_waitcnt lgkmcnt(9)
    v_mul_f32 v238, s38, v238
    v_mul_f32 v239, s38, v239
    v_mfma_f32_16x16x32_bf16 v[200:203], v[120:123], v[168:171], v[200:203]
    s_mov_b32 vcc_hi, 0xff00ff00
    v_cvt_pk_bf16_f32 v236, v236, v237
    v_cvt_pk_bf16_f32 v237, v238, v239
    v_mfma_f32_16x16x32_bf16 v[200:203], v[122:125], v[170:173], v[200:203]
    ds_write_b64 v247, v[236:237] offset:24832
    v_mfma_f32_16x16x32_bf16 v[228:231], a[152:155], a[240:243], v[228:231]
    s_waitcnt lgkmcnt(8)
    v_mfma_f32_16x16x32_bf16 v[228:231], a[156:159], a[244:247], v[228:231]
    s_waitcnt lgkmcnt(7)
    v_mfma_f32_16x16x32_bf16 v[228:231], a[160:163], a[216:219], v[228:231]
    s_waitcnt lgkmcnt(5)
    v_mfma_f32_16x16x32_bf16 v[228:231], a[164:167], a[220:223], v[228:231]
    v_mfma_f32_16x16x32_bf16 v[232:235], a[176:179], a[240:243], v[232:235]
    s_waitcnt lgkmcnt(2)
    v_mfma_f32_16x16x32_bf16 v[204:207], v[114:117], v[168:171], v[204:207]
    s_waitcnt lgkmcnt(1)
    v_mfma_f32_16x16x32_bf16 v[204:207], v[116:119], v[170:173], v[204:207]
    v_mfma_f32_16x16x32_bf16 v[196:199], v[90:93], v[168:171], v[196:199]
    v_mfma_f32_16x16x32_bf16 v[196:199], v[92:95], v[170:173], v[196:199]
    v_mfma_f32_16x16x32_bf16 v[232:235], a[180:183], a[244:247], v[232:235]
    v_mul_f32 v228, s38, v228
    v_mul_f32 v229, s38, v229
    v_mfma_f32_16x16x32_bf16 v[232:235], a[184:187], a[216:219], v[232:235]
    v_mul_f32 v230, s38, v230
    v_mul_f32 v231, s38, v231
    v_mfma_f32_16x16x32_bf16 v[232:235], a[188:191], a[220:223], v[232:235]
    v_cvt_pk_bf16_f32 v228, v228, v229
    v_cvt_pk_bf16_f32 v229, v230, v231
    v_mfma_f32_16x16x32_bf16 v[236:239], a[192:195], a[232:235], 0
    ds_write_b64 v247, v[228:229] offset:30720
    v_mfma_f32_16x16x32_bf16 v[236:239], a[196:199], a[236:239], v[236:239]
    ds_read_b128 a[232:235], v240 offset:35456
    ds_read_b128 a[236:239], v241 offset:35456
    v_mfma_f32_16x16x32_bf16 v[236:239], a[200:203], a[240:243], v[236:239]
    v_mul_f32 v232, s3, v232
    v_mul_f32 v233, s3, v233
    v_mfma_f32_16x16x32_bf16 v[236:239], a[204:207], a[244:247], v[236:239]
    v_mul_f32 v234, s3, v234
    v_mul_f32 v235, s3, v235
    v_mfma_f32_16x16x32_bf16 v[236:239], a[208:211], a[216:219], v[236:239]
    ds_read_b128 a[240:243], v240 offset:35584
    v_cvt_pk_bf16_f32 v232, v232, v233
    v_mfma_f32_16x16x32_bf16 v[236:239], a[212:215], a[220:223], v[236:239]
    ds_read_b128 a[244:247], v241 offset:35584
    v_cvt_pk_bf16_f32 v233, v234, v235
    v_mfma_f32_16x16x32_bf16 v[228:231], a[0:3], a[224:227], 0
    ds_write_b64 v247, v[232:233] offset:30848
    v_mfma_f32_16x16x32_bf16 v[228:231], a[4:7], a[228:231], v[228:231]
    ds_read_b128 a[216:219], v242 offset:64512
    ds_read_b128 a[220:223], v243 offset:64512
    v_mfma_f32_16x16x32_bf16 v[232:235], a[24:27], a[224:227], 0
    v_mul_f32 v236, s38, v236
    v_mul_f32 v237, s38, v237
    v_mfma_f32_16x16x32_bf16 v[232:235], a[28:31], a[228:231], v[232:235]
    s_waitcnt lgkmcnt(6)
    v_mul_f32 v238, s38, v238
    v_mul_f32 v239, s38, v239
    v_mfma_f32_16x16x32_bf16 v[228:231], a[8:11], a[232:235], v[228:231]
    s_waitcnt lgkmcnt(5)
    v_cvt_pk_bf16_f32 v236, v236, v237
    v_cvt_pk_bf16_f32 v237, v238, v239
    v_mfma_f32_16x16x32_bf16 v[228:231], a[12:15], a[236:239], v[228:231]
    ds_write_b64 v247, v[236:237] offset:30976
    v_mfma_f32_16x16x32_bf16 v[232:235], a[32:35], a[232:235], v[232:235]
    s_waitcnt lgkmcnt(5)
    v_max_f32 v248, v204, v205
    v_max3_f32 v248, v248, v206, v207
    v_mfma_f32_16x16x32_bf16 v[228:231], a[16:19], a[240:243], v[228:231]
    ds_read_b128 v[204:207], v245 offset:256
    v_max3_f32 v248, v248, v208, v209
    v_mfma_f32_16x16x32_bf16 v[232:235], a[36:39], a[236:239], v[232:235]
    s_waitcnt lgkmcnt(5)
    v_max3_f32 v248, v248, v210, v211
    v_max3_f32 v248, v248, v196, v197
    v_mfma_f32_16x16x32_bf16 v[228:231], a[20:23], a[244:247], v[228:231]
    ds_read_b128 v[208:211], v246 offset:256
    v_max3_f32 v248, v248, v198, v199
    v_mfma_f32_16x16x32_bf16 v[232:235], a[40:43], a[240:243], v[232:235]
    ds_read_b128 v[196:199], v244 offset:320
    v_max3_f32 v248, v248, v200, v201
    v_mfma_f32_16x16x32_bf16 v[232:235], a[44:47], a[244:247], v[232:235]
    v_max3_f32 v248, v248, v202, v203
    v_mfma_f32_16x16x32_bf16 v[236:239], a[48:51], a[224:227], 0
    ds_read_b128 v[200:203], v245 offset:320
    v_mfma_f32_16x16x32_bf16 v[236:239], a[52:55], a[228:231], v[236:239]
    v_mfma_f32_16x16x32_bf16 v[236:239], a[56:59], a[232:235], v[236:239]
    v_mfma_f32_16x16x32_bf16 v[236:239], a[60:63], a[236:239], v[236:239]
    v_mfma_f32_16x16x32_bf16 v[236:239], a[64:67], a[240:243], v[236:239]
    s_waitcnt lgkmcnt(3)
    v_mfma_f32_16x16x32_bf16 v[204:207], v[156:159], v[168:171], v[204:207]
    v_mfma_f32_16x16x32_bf16 v[204:207], v[158:161], v[170:173], v[204:207]
    s_waitcnt lgkmcnt(2)
    s_waitcnt lgkmcnt(1)
    v_mfma_f32_16x16x32_bf16 v[208:211], v[96:99], v[168:171], v[208:211]
    v_mfma_f32_16x16x32_bf16 v[208:211], v[98:101], v[170:173], v[208:211]
    v_mfma_f32_16x16x32_bf16 v[196:199], v[126:129], v[168:171], v[196:199]
    s_waitcnt lgkmcnt(0)
    v_mfma_f32_16x16x32_bf16 v[196:199], v[128:131], v[170:173], v[196:199]
    v_mfma_f32_16x16x32_bf16 v[200:203], v[162:165], v[168:171], v[200:203]
    v_max3_f32 v248, v248, v204, v205
    v_max3_f32 v248, v248, v206, v207
    v_mfma_f32_16x16x32_bf16 v[200:203], v[164:167], v[170:173], v[200:203]
    ds_read_b128 v[204:207], v246 offset:320
    v_max3_f32 v248, v248, v208, v209
    v_mfma_f32_16x16x32_bf16 v[236:239], a[68:71], a[244:247], v[236:239]
    v_max3_f32 v248, v248, v210, v211
    ds_read_b128 v[208:211], v244 offset:192
    v_max3_f32 v248, v248, v196, v197
    ds_read_b128 v[196:199], v245 offset:192
    s_nop 0
    v_max3_f32 v248, v248, v200, v201
    ds_read_b128 v[200:203], v246 offset:192
    s_waitcnt lgkmcnt(3)
    v_mfma_f32_16x16x32_bf16 v[204:207], v[138:141], v[168:171], v[204:207]
    v_mfma_f32_16x16x32_bf16 v[204:207], v[140:143], v[170:173], v[204:207]
    s_nop 7
    s_waitcnt lgkmcnt(1)
    v_mfma_f32_16x16x32_bf16 v[208:211], v[114:117], v[168:171], v[208:211]
    s_waitcnt lgkmcnt(0)
    v_cvt_pk_bf16_f32 v114, v228, v229
    v_cvt_pk_bf16_f32 v115, v230, v231
    v_mfma_f32_16x16x32_bf16 v[208:211], v[116:119], v[170:173], v[208:211]
    v_cvt_pk_bf16_f32 v116, v232, v233
    v_cvt_pk_bf16_f32 v117, v234, v235
    v_mfma_f32_16x16x32_bf16 v[196:199], v[150:153], v[168:171], v[196:199]
    v_cvt_pk_bf16_f32 v118, v236, v237
    v_cvt_pk_bf16_f32 v119, v238, v239
    v_mfma_f32_16x16x32_bf16 v[196:199], v[152:155], v[170:173], v[196:199]
    v_max3_f32 v248, v248, v204, v205
    v_mov_b32 v225, v248
    v_mfma_f32_16x16x32_bf16 v[200:203], v[90:93], v[168:171], v[200:203]
    ds_read_b128 v[204:207], v244 offset:256
    v_permlane16_swap_b32 v248, v225
    v_mfma_f32_16x16x32_bf16 v[200:203], v[92:95], v[170:173], v[200:203]
    v_max_f32 v248, v248, v225
    v_mov_b32 v225, v248
    v_mfma_f32_16x16x32_bf16 v[228:231], a[224:227], a[72:75], 0
    v_mfma_f32_16x16x32_bf16 v[228:231], a[228:231], a[76:79], v[228:231]
    v_permlane32_swap_b32 v248, v225
    v_max_f32 v248, v248, v225
    v_mfma_f32_16x16x32_bf16 v[228:231], a[232:235], a[80:83], v[228:231]
    v_sub_f32 v208, v208, v248
    v_sub_f32 v209, v209, v248
    v_mfma_f32_16x16x32_bf16 v[228:231], a[236:239], a[84:87], v[228:231]
    v_exp_f32 v208, v208
    v_mfma_f32_16x16x32_bf16 v[228:231], a[240:243], a[88:91], v[228:231]
    v_exp_f32 v209, v209
    v_mfma_f32_16x16x32_bf16 v[228:231], a[244:247], a[92:95], v[228:231]
    v_sub_f32 v210, v210, v248
    v_sub_f32 v211, v211, v248
    v_mfma_f32_16x16x32_bf16 v[232:235], a[224:227], a[96:99], 0
    v_exp_f32 v210, v210
    v_mfma_f32_16x16x32_bf16 v[232:235], a[228:231], a[100:103], v[232:235]
    s_waitcnt lgkmcnt(0)
    v_exp_f32 v211, v211
    v_mfma_f32_16x16x32_bf16 v[204:207], v[120:123], v[168:171], v[204:207]
    v_cvt_pk_bf16_f32 v18, v228, v229
    v_cvt_pk_bf16_f32 v21, v230, v231
    v_mfma_f32_16x16x32_bf16 v[204:207], v[122:125], v[170:173], v[204:207]
    v_cvt_pk_bf16_f32 v193, v208, v209
    v_cvt_pk_bf16_f32 v180, v210, v211
    v_mfma_f32_16x16x32_bf16 v[232:235], a[232:235], a[104:107], v[232:235]
    ds_read_b128 v[208:211], v245 offset:256
    v_sub_f32 v196, v196, v248
    v_mfma_f32_16x16x32_bf16 v[232:235], a[236:239], a[108:111], v[232:235]
    v_exp_f32 v196, v196
    v_mfma_f32_16x16x32_bf16 v[232:235], a[240:243], a[112:115], v[232:235]
    v_sub_f32 v197, v197, v248
    v_sub_f32 v198, v198, v248
    v_mfma_f32_16x16x32_bf16 v[232:235], a[244:247], a[116:119], v[232:235]
    v_exp_f32 v197, v197
    v_mfma_f32_16x16x32_bf16 v[236:239], a[224:227], a[120:123], 0
    ds_read_b128 a[224:227], v242 offset:64640
    v_sub_f32 v199, v199, v248
    v_mfma_f32_16x16x32_bf16 v[236:239], a[228:231], a[124:127], v[236:239]
    ds_read_b128 a[228:231], v243 offset:64640
    v_cvt_pk_bf16_f32 v194, v196, v197
    v_mfma_f32_16x16x32_bf16 v[236:239], a[232:235], a[128:131], v[236:239]
    v_cvt_pk_bf16_f32 v48, v232, v233
    v_cvt_pk_bf16_f32 v51, v234, v235
    v_mfma_f32_16x16x32_bf16 v[236:239], a[236:239], a[132:135], v[236:239]
    ds_read_b128 a[232:235], v242 offset:64768
    ds_read_b128 a[236:239], v243 offset:64768
    v_mfma_f32_16x16x32_bf16 v[236:239], a[240:243], a[136:139], v[236:239]
    v_add_u32 v242, 0xf000, v242
    v_add_u32 v243, 0xf000, v243
    v_mfma_f32_16x16x32_bf16 v[236:239], a[244:247], a[140:143], v[236:239]
    ds_read_b128 a[240:243], v242 offset:4608
    ds_read_b128 a[244:247], v243 offset:4608
    v_mfma_f32_16x16x32_bf16 v[228:231], a[144:147], a[216:219], 0
    s_waitcnt lgkmcnt(6)
    v_exp_f32 v198, v198
    v_mfma_f32_16x16x32_bf16 v[208:211], v[156:159], v[168:171], v[208:211]
    v_exp_f32 v199, v199
    v_mfma_f32_16x16x32_bf16 v[208:211], v[158:161], v[170:173], v[208:211]
    v_cvt_pk_bf16_f32 v78, v236, v237
    v_cvt_pk_bf16_f32 v81, v238, v239
    v_mfma_f32_16x16x32_bf16 v[228:231], a[148:151], a[220:223], v[228:231]
    s_waitcnt lgkmcnt(5)
    v_cvt_pk_bf16_f32 v181, v198, v199
    v_sub_f32 v200, v200, v248
    v_mfma_f32_16x16x32_bf16 v[228:231], a[152:155], a[224:227], v[228:231]
    ds_read_b128 v[196:199], v246 offset:256
    v_sub_f32 v201, v201, v248
    v_mfma_f32_16x16x32_bf16 v[232:235], a[168:171], a[216:219], 0
    s_waitcnt lgkmcnt(5)
    v_exp_f32 v200, v200
    v_mfma_f32_16x16x32_bf16 v[228:231], a[156:159], a[228:231], v[228:231]
    s_waitcnt lgkmcnt(4)
    v_exp_f32 v201, v201
    v_mfma_f32_16x16x32_bf16 v[228:231], a[160:163], a[232:235], v[228:231]
    s_waitcnt lgkmcnt(3)
    v_sub_f32 v202, v202, v248
    v_sub_f32 v203, v203, v248
    v_mfma_f32_16x16x32_bf16 v[228:231], a[164:167], a[236:239], v[228:231]
    v_exp_f32 v202, v202
    v_mfma_f32_16x16x32_bf16 v[232:235], a[172:175], a[220:223], v[232:235]
    v_exp_f32 v203, v203
    v_mfma_f32_16x16x32_bf16 v[232:235], a[176:179], a[224:227], v[232:235]
    v_cvt_pk_bf16_f32 v192, v200, v201
    v_cvt_pk_bf16_f32 v195, v202, v203
    v_mfma_f32_16x16x32_bf16 v[232:235], a[180:183], a[228:231], v[232:235]
    ds_read_b128 v[200:203], v244 offset:320
    v_mul_f32 v228, s38, v228
    v_mfma_f32_16x16x32_bf16 v[212:215], v[0:3], v[192:195], 0
    v_mul_f32 v229, s38, v229
    v_mul_f32 v230, s38, v230
    v_mfma_f32_16x16x32_bf16 v[216:219], v[30:33], v[192:195], 0
    s_waitcnt lgkmcnt(1)
    v_mul_f32 v231, s38, v231
    v_cvt_pk_bf16_f32 v228, v228, v229
    v_mfma_f32_16x16x32_bf16 v[220:223], v[60:63], v[192:195], 0
    v_cvt_pk_bf16_f32 v229, v230, v231
    v_sub_f32 v204, v204, v248
    v_mfma_f32_16x16x32_bf16 v[224:227], a[248:251], v[192:195], 0
    ds_write_b64 v247, v[228:229] offset:36864
    v_mfma_f32_16x16x32_bf16 v[196:199], v[96:99], v[168:171], v[196:199]
    v_exp_f32 v204, v204
    v_mfma_f32_16x16x32_bf16 v[196:199], v[98:101], v[170:173], v[196:199]
    v_sub_f32 v205, v205, v248
    v_sub_f32 v206, v206, v248
    v_mfma_f32_16x16x32_bf16 v[232:235], a[184:187], a[232:235], v[232:235]
    v_exp_f32 v205, v205
    v_mfma_f32_16x16x32_bf16 v[232:235], a[188:191], a[236:239], v[232:235]
    s_waitcnt lgkmcnt(1)
    v_exp_f32 v206, v206
    v_mfma_f32_16x16x32_bf16 v[200:203], v[126:129], v[168:171], v[200:203]
    v_sub_f32 v207, v207, v248
    v_cvt_pk_bf16_f32 v183, v204, v205
    v_mfma_f32_16x16x32_bf16 v[200:203], v[128:131], v[170:173], v[200:203]
    v_exp_f32 v207, v207
    v_mfma_f32_16x16x32_bf16 v[236:239], a[192:195], a[216:219], 0
    v_mul_f32 v232, s3, v232
    v_mul_f32 v233, s3, v233
    v_mfma_f32_16x16x32_bf16 v[236:239], a[196:199], a[220:223], v[236:239]
    v_mul_f32 v234, s3, v234
    v_mul_f32 v235, s3, v235
    v_mfma_f32_16x16x32_bf16 v[236:239], a[200:203], a[224:227], v[236:239]
    ds_read_b128 a[216:219], v242 offset:4736
    v_cvt_pk_bf16_f32 v232, v232, v233
    v_mfma_f32_16x16x32_bf16 v[236:239], a[204:207], a[228:231], v[236:239]
    ds_read_b128 a[220:223], v243 offset:4736
    v_cvt_pk_bf16_f32 v233, v234, v235
    v_mfma_f32_16x16x32_bf16 v[236:239], a[208:211], a[232:235], v[236:239]
    ds_write_b64 v247, v[232:233] offset:36992
    v_mfma_f32_16x16x32_bf16 v[236:239], a[212:215], a[236:239], v[236:239]
    ds_read_b128 a[224:227], v242 offset:4864
    ds_read_b128 a[228:231], v243 offset:4864
    v_mfma_f32_16x16x32_bf16 v[228:231], a[144:147], a[240:243], 0
    v_add_u32 v242, 0x7800, v242
    v_add_u32 v243, 0x4200, v243
    v_mfma_f32_16x16x32_bf16 v[228:231], a[148:151], a[244:247], v[228:231]
    v_cndmask_b32 v242, v242, v243, vcc
    v_add_u32 v243, 0xfffe2000, v242
    v_mfma_f32_16x16x32_bf16 v[232:235], a[168:171], a[240:243], 0
    s_mov_b32 vcc_lo, 0xf0f0f0f0
    v_mul_f32 v236, s38, v236
    v_mul_f32 v237, s38, v237
    v_mfma_f32_16x16x32_bf16 v[232:235], a[172:175], a[244:247], v[232:235]
    v_mul_f32 v238, s38, v238
    v_mul_f32 v239, s38, v239
    v_cvt_pk_bf16_f32 v236, v236, v237
    s_waitcnt lgkmcnt(4)
    v_mfma_f32_16x16x32_bf16 v[228:231], a[152:155], a[216:219], v[228:231]
    s_mov_b32 vcc_hi, 0xf0f0f0f0
    v_cvt_pk_bf16_f32 v237, v238, v239
    v_cndmask_b32 v242, v242, v243, vcc
    v_mfma_f32_16x16x32_bf16 v[232:235], a[176:179], a[216:219], v[232:235]
    s_waitcnt lgkmcnt(3)
    ds_read_b128 a[232:235], v242 offset:0
    v_mfma_f32_16x16x32_bf16 v[228:231], a[156:159], a[220:223], v[228:231]
    ds_write_b64 v247, v[236:237] offset:37120
    v_mfma_f32_16x16x32_bf16 v[232:235], a[180:183], a[220:223], v[232:235]
    s_mov_b32 vcc_lo, 0xcccccccc
    v_xor_b32 v243, 64, v242
    v_cvt_pk_bf16_f32 v186, v206, v207
    v_mfma_f32_16x16x32_bf16 v[236:239], a[192:195], a[240:243], 0
    ds_read_b128 a[236:239], v243 offset:0
    ds_read_b128 a[240:243], v242 offset:128
    v_mfma_f32_16x16x32_bf16 v[236:239], a[196:199], a[244:247], v[236:239]
    ds_read_b128 a[244:247], v243 offset:128
    ds_read_b128 v[204:207], v245 offset:320
    v_mfma_f32_16x16x32_bf16 v[236:239], a[200:203], a[216:219], v[236:239]
    ds_read_b128 a[216:219], v242 offset:256
    v_sub_f32 v208, v208, v248
    v_mfma_f32_16x16x32_bf16 v[236:239], a[204:207], a[220:223], v[236:239]
    s_waitcnt lgkmcnt(8)
    ds_read_b128 a[220:223], v243 offset:256
    v_mfma_f32_16x16x32_bf16 v[228:231], a[160:163], a[224:227], v[228:231]
    s_mov_b32 vcc_hi, 0xcccccccc
    v_exp_f32 v208, v208
    v_mfma_f32_16x16x32_bf16 v[232:235], a[184:187], a[224:227], v[232:235]
    s_waitcnt lgkmcnt(8)
    v_sub_f32 v209, v209, v248
    v_sub_f32 v210, v210, v248
    v_mfma_f32_16x16x32_bf16 v[228:231], a[164:167], a[228:231], v[228:231]
    v_exp_f32 v209, v209
    v_mfma_f32_16x16x32_bf16 v[232:235], a[188:191], a[228:231], v[232:235]
    v_exp_f32 v210, v210
    v_mfma_f32_16x16x32_bf16 v[236:239], a[208:211], a[224:227], v[236:239]
    ds_read_b128 a[224:227], v240 offset:36864
    v_sub_f32 v211, v211, v248
    v_mfma_f32_16x16x32_bf16 v[236:239], a[212:215], a[228:231], v[236:239]
    ds_read_b128 a[228:231], v241 offset:36864
    v_mul_f32 v228, s38, v228
    v_mul_f32 v229, s38, v229
    v_mul_f32 v230, s38, v230
    v_mul_f32 v231, s38, v231
    v_cvt_pk_bf16_f32 v228, v228, v229
    v_cvt_pk_bf16_f32 v229, v230, v231
    s_waitcnt lgkmcnt(4)
    v_mfma_f32_16x16x32_bf16 v[204:207], v[162:165], v[168:171], v[204:207]
    ds_write_b64 v247, v[228:229] offset:43008
    v_mfma_f32_16x16x32_bf16 v[204:207], v[164:167], v[170:173], v[204:207]
    v_mul_f32 v232, s3, v232
    v_mul_f32 v233, s3, v233
    v_mfma_f32_16x16x32_bf16 v[228:231], a[144:147], a[232:235], 0
    v_mul_f32 v234, s3, v234
    v_mul_f32 v235, s3, v235
    v_mfma_f32_16x16x32_bf16 v[228:231], a[148:151], a[236:239], v[228:231]
    v_cvt_pk_bf16_f32 v232, v232, v233
    v_cvt_pk_bf16_f32 v233, v234, v235
    v_mfma_f32_16x16x32_bf16 v[228:231], a[152:155], a[240:243], v[228:231]
    ds_write_b64 v247, v[232:233] offset:43136
    v_mfma_f32_16x16x32_bf16 v[228:231], a[156:159], a[244:247], v[228:231]
    s_waitcnt lgkmcnt(5)
    v_mul_f32 v236, s38, v236
    v_mul_f32 v237, s38, v237
    v_mfma_f32_16x16x32_bf16 v[228:231], a[160:163], a[216:219], v[228:231]
    s_waitcnt lgkmcnt(4)
    v_mul_f32 v238, s38, v238
    v_mul_f32 v239, s38, v239
    v_mfma_f32_16x16x32_bf16 v[228:231], a[164:167], a[220:223], v[228:231]
    v_cvt_pk_bf16_f32 v236, v236, v237
    v_cvt_pk_bf16_f32 v237, v238, v239
    v_mfma_f32_16x16x32_bf16 v[232:235], a[168:171], a[232:235], 0
    ds_write_b64 v247, v[236:237] offset:43264
    v_mfma_f32_16x16x32_bf16 v[232:235], a[172:175], a[236:239], v[232:235]
    v_exp_f32 v211, v211
    v_mfma_f32_16x16x32_bf16 v[232:235], a[176:179], a[240:243], v[232:235]
    v_cvt_pk_bf16_f32 v184, v208, v209
    v_mul_f32 v228, s38, v228
    v_mfma_f32_16x16x32_bf16 v[232:235], a[180:183], a[244:247], v[232:235]
    v_mul_f32 v229, s38, v229
    v_mul_f32 v230, s38, v230
    v_mfma_f32_16x16x32_bf16 v[232:235], a[184:187], a[216:219], v[232:235]
    v_mul_f32 v231, s38, v231
    v_cvt_pk_bf16_f32 v228, v228, v229
    v_mfma_f32_16x16x32_bf16 v[232:235], a[188:191], a[220:223], v[232:235]
    v_cvt_pk_bf16_f32 v229, v230, v231
    v_cvt_pk_bf16_f32 v187, v210, v211
    v_mfma_f32_16x16x32_bf16 v[236:239], a[192:195], a[232:235], 0
    ds_write_b64 v247, v[228:229] offset:49152
    v_mfma_f32_16x16x32_bf16 v[236:239], a[196:199], a[236:239], v[236:239]
    ds_read_b128 a[232:235], v240 offset:36992
    ds_read_b128 a[236:239], v241 offset:36992
    v_mfma_f32_16x16x32_bf16 v[236:239], a[200:203], a[240:243], v[236:239]
    s_waitcnt lgkmcnt(5)
    v_mul_f32 v232, s3, v232
    v_mul_f32 v233, s3, v233
    v_mfma_f32_16x16x32_bf16 v[236:239], a[204:207], a[244:247], v[236:239]
    v_mul_f32 v234, s3, v234
    v_mul_f32 v235, s3, v235
    v_mfma_f32_16x16x32_bf16 v[236:239], a[208:211], a[216:219], v[236:239]
    ds_read_b128 a[240:243], v240 offset:37120
    v_cvt_pk_bf16_f32 v232, v232, v233
    v_mfma_f32_16x16x32_bf16 v[236:239], a[212:215], a[220:223], v[236:239]
    ds_read_b128 a[244:247], v241 offset:37120
    v_cvt_pk_bf16_f32 v233, v234, v235
    v_mfma_f32_16x16x32_bf16 v[228:231], a[0:3], a[224:227], 0
    ds_write_b64 v247, v[232:233] offset:49280
    v_mfma_f32_16x16x32_bf16 v[228:231], a[4:7], a[228:231], v[228:231]
    ds_read_b128 a[216:219], v242 offset:3072
    ds_read_b128 a[220:223], v243 offset:3072
    v_mfma_f32_16x16x32_bf16 v[232:235], a[24:27], a[224:227], 0
    v_mul_f32 v236, s38, v236
    v_mul_f32 v237, s38, v237
    v_mfma_f32_16x16x32_bf16 v[232:235], a[28:31], a[228:231], v[232:235]
    s_waitcnt lgkmcnt(6)
    v_mul_f32 v238, s38, v238
    v_mul_f32 v239, s38, v239
    v_mfma_f32_16x16x32_bf16 v[228:231], a[8:11], a[232:235], v[228:231]
    s_waitcnt lgkmcnt(5)
    v_cvt_pk_bf16_f32 v236, v236, v237
    v_cvt_pk_bf16_f32 v237, v238, v239
    v_mfma_f32_16x16x32_bf16 v[228:231], a[12:15], a[236:239], v[228:231]
    ds_write_b64 v247, v[236:237] offset:49408
    v_mfma_f32_16x16x32_bf16 v[232:235], a[32:35], a[232:235], v[232:235]
    s_waitcnt lgkmcnt(5)
    v_add_u32 v240, 0xffff1000, v240
    v_add_u32 v241, 0xffff1000, v241
    v_mfma_f32_16x16x32_bf16 v[228:231], a[16:19], a[240:243], v[228:231]
    ds_read_b128 v[208:211], v246 offset:320
    v_sub_f32 v196, v196, v248
    v_mfma_f32_16x16x32_bf16 v[232:235], a[36:39], a[236:239], v[232:235]
    s_waitcnt lgkmcnt(5)
    v_exp_f32 v196, v196
    v_mfma_f32_16x16x32_bf16 v[228:231], a[20:23], a[244:247], v[228:231]
    v_sub_f32 v197, v197, v248
    v_sub_f32 v198, v198, v248
    v_mfma_f32_16x16x32_bf16 v[232:235], a[40:43], a[240:243], v[232:235]
    v_exp_f32 v197, v197
    v_mfma_f32_16x16x32_bf16 v[232:235], a[44:47], a[244:247], v[232:235]
    v_exp_f32 v198, v198
    v_mfma_f32_16x16x32_bf16 v[236:239], a[48:51], a[224:227], 0
    v_sub_f32 v199, v199, v248
    v_cvt_pk_bf16_f32 v182, v196, v197
    v_mfma_f32_16x16x32_bf16 v[236:239], a[52:55], a[228:231], v[236:239]
    v_exp_f32 v199, v199
    v_mfma_f32_16x16x32_bf16 v[212:215], v[4:7], v[180:183], v[212:215]
    v_cvt_pk_bf16_f32 v185, v198, v199
    v_sub_f32 v200, v200, v248
    v_mfma_f32_16x16x32_bf16 v[216:219], v[34:37], v[180:183], v[216:219]
    ds_read_b128 v[196:199], v244 offset:0
    v_sub_f32 v201, v201, v248
    v_mfma_f32_16x16x32_bf16 v[220:223], v[64:67], v[180:183], v[220:223]
    s_waitcnt lgkmcnt(1)
    v_exp_f32 v200, v200
    v_mfma_f32_16x16x32_bf16 v[224:227], a[248:251], v[180:183], v[224:227]
    v_exp_f32 v201, v201
    v_mfma_f32_16x16x32_bf16 v[212:215], v[8:11], v[184:187], v[212:215]
    v_cvt_pk_bf16_f32 v189, v200, v201
    v_sub_f32 v204, v204, v248
    v_mfma_f32_16x16x32_bf16 v[216:219], v[38:41], v[184:187], v[216:219]
    ds_read_b128 v[200:203], v245 offset:0
    v_sub_f32 v205, v205, v248
    v_mfma_f32_16x16x32_bf16 v[220:223], v[68:71], v[184:187], v[220:223]
    v_exp_f32 v204, v204
    v_mfma_f32_16x16x32_bf16 v[224:227], a[248:251], v[184:187], v[224:227]
    v_exp_f32 v205, v205
    v_mfma_f32_16x16x32_bf16 v[208:211], v[138:141], v[168:171], v[208:211]
    ds_read_b64 v[168:169], v247 offset:18432
    v_cvt_pk_bf16_f32 v190, v204, v205
    v_mfma_f32_16x16x32_bf16 v[208:211], v[140:143], v[170:173], v[208:211]
    ds_read_b128 v[204:207], v246 offset:0
    ds_read_b64 v[170:171], v247 offset:18560
    v_mfma_f32_16x16x32_bf16 v[236:239], a[56:59], a[232:235], v[236:239]
    ds_read_b64 v[172:173], v247 offset:18688
    s_waitcnt lgkmcnt(5)
    v_mfma_f32_16x16x32_bf16 v[196:199], v[120:123], v[174:177], v[196:199]
    v_mfma_f32_16x16x32_bf16 v[196:199], v[122:125], v[176:179], v[196:199]
    v_mfma_f32_16x16x32_bf16 v[236:239], a[60:63], a[236:239], v[236:239]
    v_sub_f32 v208, v208, v248
    v_sub_f32 v209, v209, v248
    v_mfma_f32_16x16x32_bf16 v[236:239], a[64:67], a[240:243], v[236:239]
    s_waitcnt lgkmcnt(4)
    v_exp_f32 v208, v208
    v_mfma_f32_16x16x32_bf16 v[200:203], v[156:159], v[174:177], v[200:203]
    v_exp_f32 v209, v209
    v_mfma_f32_16x16x32_bf16 v[200:203], v[158:161], v[176:179], v[200:203]
    v_cvt_pk_bf16_f32 v188, v208, v209
    v_max_f32 v248, v196, v197
    v_mfma_f32_16x16x32_bf16 v[236:239], a[68:71], a[244:247], v[236:239]
    ds_read_b128 v[208:211], v244 offset:64
    v_max3_f32 v248, v248, v198, v199
    v_mfma_f32_16x16x32_bf16 v[212:215], v[12:15], v[188:191], v[212:215]
    ds_read_b128 v[196:199], v245 offset:64
    s_waitcnt lgkmcnt(4)
    v_mfma_f32_16x16x32_bf16 v[216:219], v[42:45], v[188:191], v[216:219]
    v_max3_f32 v248, v248, v200, v201
    v_max3_f32 v248, v248, v202, v203
    v_mfma_f32_16x16x32_bf16 v[220:223], v[72:75], v[188:191], v[220:223]
    ds_read_b128 v[200:203], v246 offset:64
    v_mfma_f32_16x16x32_bf16 v[224:227], a[248:251], v[188:191], v[224:227]
    v_mfma_f32_16x16x32_bf16 v[204:207], v[96:99], v[174:177], v[204:207]
    v_mfma_f32_16x16x32_bf16 v[204:207], v[98:101], v[176:179], v[204:207]
    s_nop 5
    v_rcp_f32 v225, v224
    s_nop 0
    s_waitcnt lgkmcnt(2)
    v_mfma_f32_16x16x32_bf16 v[208:211], v[126:129], v[174:177], v[208:211]
    v_mul_f32 v212, v212, v225
    v_mul_f32 v213, v213, v225
    v_mfma_f32_16x16x32_bf16 v[208:211], v[128:131], v[176:179], v[208:211]
    s_waitcnt lgkmcnt(1)
    v_mul_f32 v214, v214, v225
    v_mul_f32 v215, v215, v225
    v_mfma_f32_16x16x32_bf16 v[196:199], v[162:165], v[174:177], v[196:199]
    v_cvt_pk_bf16_f32 v212, v212, v213
    v_cvt_pk_bf16_f32 v213, v214, v215
    v_mfma_f32_16x16x32_bf16 v[196:199], v[164:167], v[176:179], v[196:199]
    s_waitcnt lgkmcnt(0)
    v_mul_f32 v216, v216, v225
    v_mul_f32 v217, v217, v225
    v_mfma_f32_16x16x32_bf16 v[200:203], v[138:141], v[174:177], v[200:203]
    ds_write_b64 v247, v[212:213] offset:6144
    v_mfma_f32_16x16x32_bf16 v[200:203], v[140:143], v[176:179], v[200:203]
    v_mul_f32 v218, v218, v225
    v_mul_f32 v219, v219, v225
    v_cvt_pk_bf16_f32 v216, v216, v217
    v_cvt_pk_bf16_f32 v217, v218, v219
    ds_write_b64 v247, v[216:217] offset:6272
    v_mul_f32 v220, v220, v225
    v_mul_f32 v221, v221, v225
    v_mul_f32 v222, v222, v225
    v_mul_f32 v223, v223, v225
    v_cvt_pk_bf16_f32 v220, v220, v221
    v_cvt_pk_bf16_f32 v221, v222, v223
    ds_write_b64 v247, v[220:221] offset:6400
    v_max3_f32 v248, v248, v204, v205
    v_max3_f32 v248, v248, v206, v207
    ds_read_b128 v[204:207], v244 offset:128
    v_max3_f32 v248, v248, v208, v209
    v_max3_f32 v248, v248, v210, v211
    ds_read_b128 v[208:211], v245 offset:128
    v_max3_f32 v248, v248, v196, v197
    v_max3_f32 v248, v248, v198, v199
    ds_read_b128 v[196:199], v246 offset:128
    v_max3_f32 v248, v248, v200, v201
    v_max3_f32 v248, v248, v202, v203
    ds_read_b128 v[200:203], v244 offset:0
    s_waitcnt lgkmcnt(3)
    v_mfma_f32_16x16x32_bf16 v[204:207], v[132:135], v[174:177], v[204:207]
    v_mfma_f32_16x16x32_bf16 v[204:207], v[134:137], v[176:179], v[204:207]
    s_waitcnt lgkmcnt(2)
    v_mfma_f32_16x16x32_bf16 v[208:211], v[102:105], v[174:177], v[208:211]
    s_waitcnt lgkmcnt(1)
    v_mfma_f32_16x16x32_bf16 v[208:211], v[104:107], v[176:179], v[208:211]
    v_mfma_f32_16x16x32_bf16 v[196:199], v[114:117], v[174:177], v[196:199]
    s_waitcnt lgkmcnt(0)
    v_mfma_f32_16x16x32_bf16 v[196:199], v[116:119], v[176:179], v[196:199]
    v_mfma_f32_16x16x32_bf16 v[200:203], v[120:123], v[174:177], v[200:203]
    v_cvt_pk_bf16_f32 v120, v228, v229
    v_cvt_pk_bf16_f32 v121, v230, v231
    v_mfma_f32_16x16x32_bf16 v[200:203], v[122:125], v[176:179], v[200:203]
    v_cvt_pk_bf16_f32 v122, v232, v233
    v_cvt_pk_bf16_f32 v123, v234, v235
    v_mfma_f32_16x16x32_bf16 v[228:231], a[224:227], a[72:75], 0
    v_cvt_pk_bf16_f32 v124, v236, v237
    v_cvt_pk_bf16_f32 v125, v238, v239
    v_mfma_f32_16x16x32_bf16 v[228:231], a[228:231], a[76:79], v[228:231]
    v_max3_f32 v248, v248, v204, v205
    v_max3_f32 v248, v248, v208, v209
    v_mfma_f32_16x16x32_bf16 v[228:231], a[232:235], a[80:83], v[228:231]
    ds_read_b128 v[204:207], v245 offset:0
    ds_read_b128 v[208:211], v246 offset:0
    v_mfma_f32_16x16x32_bf16 v[228:231], a[236:239], a[84:87], v[228:231]
    v_max3_f32 v248, v248, v196, v197
    v_mov_b32 v225, v248
    v_mfma_f32_16x16x32_bf16 v[228:231], a[240:243], a[88:91], v[228:231]
    ds_read_b128 v[196:199], v244 offset:64
    v_permlane16_swap_b32 v248, v225
    v_mfma_f32_16x16x32_bf16 v[228:231], a[244:247], a[92:95], v[228:231]
    v_max_f32 v248, v248, v225
    v_mov_b32 v225, v248
    v_mfma_f32_16x16x32_bf16 v[232:235], a[224:227], a[96:99], 0
    v_mfma_f32_16x16x32_bf16 v[232:235], a[228:231], a[100:103], v[232:235]
    v_permlane32_swap_b32 v248, v225
    v_max_f32 v248, v248, v225
    v_mfma_f32_16x16x32_bf16 v[232:235], a[232:235], a[104:107], v[232:235]
    v_sub_f32 v200, v200, v248
    v_cvt_pk_bf16_f32 v24, v228, v229
    v_mfma_f32_16x16x32_bf16 v[232:235], a[236:239], a[108:111], v[232:235]
    v_cvt_pk_bf16_f32 v27, v230, v231
    v_mbcnt_lo_u32_b32 v228, -1, 0
    v_mfma_f32_16x16x32_bf16 v[232:235], a[240:243], a[112:115], v[232:235]
    v_mbcnt_hi_u32_b32 v228, -1, v228
    v_lshrrev_b32 v229, 1, v228
    v_mfma_f32_16x16x32_bf16 v[232:235], a[244:247], a[116:119], v[232:235]
    s_waitcnt lgkmcnt(2)
    v_add_u32 v229, 64, v229
    v_mul_u32_u24 v230, 43, v229
    v_mfma_f32_16x16x32_bf16 v[204:207], v[156:159], v[174:177], v[204:207]
    s_waitcnt lgkmcnt(1)
    v_lshrrev_b32 v231, 8, v230
    v_lshrrev_b32 v230, 7, v230
    v_mfma_f32_16x16x32_bf16 v[204:207], v[158:161], v[176:179], v[204:207]
    s_waitcnt lgkmcnt(0)
    v_cvt_pk_bf16_f32 v54, v232, v233
    v_cvt_pk_bf16_f32 v57, v234, v235
    v_mfma_f32_16x16x32_bf16 v[208:211], v[96:99], v[174:177], v[208:211]
    v_mad_i32_i24 v229, v230, -3, v229
    v_and_b32 v231, 4, v231
    v_mfma_f32_16x16x32_bf16 v[208:211], v[98:101], v[176:179], v[208:211]
    v_xor_b32 v230, v230, v231
    v_and_b32 v231, 4, v230
    v_mfma_f32_16x16x32_bf16 v[196:199], v[126:129], v[174:177], v[196:199]
    v_mul_u32_u24 v251, 24, v231
    v_lshrrev_b32 v231, 3, v230
    v_mfma_f32_16x16x32_bf16 v[196:199], v[128:131], v[176:179], v[196:199]
    v_lshl_add_u32 v251, v231, 2, v251
    v_and_or_b32 v251, v230, 3, v251
    v_mfma_f32_16x16x32_bf16 v[236:239], a[224:227], a[120:123], 0
    ds_read_b128 a[224:227], v242 offset:3200
    v_mad_u32_u24 v251, v251, 3, v229
    v_mfma_f32_16x16x32_bf16 v[236:239], a[228:231], a[124:127], v[236:239]
    ds_read_b128 a[228:231], v243 offset:3200
    v_and_b32 v231, 1, v228
    v_mfma_f32_16x16x32_bf16 v[236:239], a[232:235], a[128:131], v[236:239]
    ds_read_b128 a[232:235], v242 offset:3328
    v_lshl_add_u32 v251, v251, 3, v231
    v_mfma_f32_16x16x32_bf16 v[236:239], a[236:239], a[132:135], v[236:239]
    ds_read_b128 a[236:239], v243 offset:3328
    v_lshlrev_b32 v251, 4, v251
    v_mfma_f32_16x16x32_bf16 v[236:239], a[240:243], a[136:139], v[236:239]
    ds_read_b128 a[240:243], v240 offset:0
    v_add_u32 v251, 0xfffff800, v251
    v_mfma_f32_16x16x32_bf16 v[236:239], a[244:247], a[140:143], v[236:239]
    ds_read_b128 a[244:247], v241 offset:0
    v_sub_f32 v201, v201, v248
    v_mfma_f32_16x16x32_bf16 v[232:235], a[144:147], a[216:219], 0
    v_exp_f32 v200, v200
    v_mfma_f32_16x16x32_bf16 v[232:235], a[148:151], a[220:223], v[232:235]
    v_exp_f32 v201, v201
    v_mfma_f32_16x16x32_bf16 v[228:231], a[192:195], a[216:219], 0
    v_sub_f32 v202, v202, v248
    v_cvt_pk_bf16_f32 v84, v236, v237
    v_mfma_f32_16x16x32_bf16 v[228:231], a[196:199], a[220:223], v[228:231]
    s_waitcnt lgkmcnt(5)
    v_cvt_pk_bf16_f32 v87, v238, v239
    v_sub_f32 v203, v203, v248
    v_mfma_f32_16x16x32_bf16 v[232:235], a[152:155], a[224:227], v[232:235]
    s_waitcnt lgkmcnt(4)
    v_exp_f32 v202, v202
    v_mfma_f32_16x16x32_bf16 v[232:235], a[156:159], a[228:231], v[232:235]
    s_waitcnt lgkmcnt(3)
    s_waitcnt lgkmcnt(2)
    s_barrier
    v_mfma_f32_16x16x32_bf16 v[232:235], a[160:163], a[232:235], v[232:235]
    buffer_load_dwordx4 v252, s[12:15], s62 offen lds
    v_cvt_pk_bf16_f32 v193, v200, v201
    v_mfma_f32_16x16x32_bf16 v[232:235], a[164:167], a[236:239], v[232:235]
    v_exp_f32 v203, v203
    v_mfma_f32_16x16x32_bf16 v[236:239], a[168:171], a[216:219], 0
    ds_read_b128 a[216:219], v240 offset:128
    v_cvt_pk_bf16_f32 v180, v202, v203
    v_mfma_f32_16x16x32_bf16 v[236:239], a[172:175], a[220:223], v[236:239]
    ds_read_b128 a[220:223], v241 offset:128
    ds_read_b128 v[200:203], v245 offset:64
    v_mfma_f32_16x16x32_bf16 v[236:239], a[176:179], a[224:227], v[236:239]
    buffer_load_dwordx4 v253, s[12:15], s62 offen offset:1024 lds
    v_mul_f32 v232, s38, v232
    v_mfma_f32_16x16x32_bf16 v[236:239], a[180:183], a[228:231], v[236:239]
    v_mul_f32 v233, s38, v233
    v_mul_f32 v234, s38, v234
    v_mfma_f32_16x16x32_bf16 v[236:239], a[184:187], a[232:235], v[236:239]
    v_mul_f32 v235, s38, v235
    v_cvt_pk_bf16_f32 v232, v232, v233
    v_mfma_f32_16x16x32_bf16 v[236:239], a[188:191], a[236:239], v[236:239]
    v_cvt_pk_bf16_f32 v233, v234, v235
    v_sub_f32 v204, v204, v248
    v_mfma_f32_16x16x32_bf16 v[228:231], a[200:203], a[224:227], v[228:231]
    buffer_load_dwordx4 v251, s[12:15], s62 offen offset:2048 lds
    s_add_u32 m0, s46, 0x17400
    v_mfma_f32_16x16x32_bf16 v[228:231], a[204:207], a[228:231], v[228:231]
    s_lshl_b32 s62, s28, 5
    s_add_u32 s62, s62, 0x3000
    v_mul_f32 v236, s3, v236
    v_mfma_f32_16x16x32_bf16 v[228:231], a[208:211], a[232:235], v[228:231]
    ds_write_b64 v247, v[232:233] offset:55296
    v_mfma_f32_16x16x32_bf16 v[228:231], a[212:215], a[236:239], v[228:231]
    s_waitcnt lgkmcnt(4)
    v_mul_f32 v237, s3, v237
    v_mul_f32 v238, s3, v238
    v_mfma_f32_16x16x32_bf16 v[232:235], a[0:3], a[240:243], 0
    buffer_load_dwordx4 v252, s[12:15], s63 offen lds
    v_mul_f32 v239, s3, v239
    v_mfma_f32_16x16x32_bf16 v[232:235], a[4:7], a[244:247], v[232:235]
    s_waitcnt lgkmcnt(1)
    v_cvt_pk_bf16_f32 v236, v236, v237
    v_cvt_pk_bf16_f32 v237, v238, v239
    v_mfma_f32_16x16x32_bf16 v[200:203], v[162:165], v[174:177], v[200:203]
    ds_write_b64 v247, v[236:237] offset:55424
    v_mfma_f32_16x16x32_bf16 v[200:203], v[164:167], v[176:179], v[200:203]
    v_mul_f32 v228, s38, v228
    v_mul_f32 v229, s38, v229
    v_mfma_f32_16x16x32_bf16 v[232:235], a[8:11], a[216:219], v[232:235]
    buffer_load_dwordx4 v253, s[12:15], s63 offen offset:1024 lds
    v_mul_f32 v230, s38, v230
    v_mfma_f32_16x16x32_bf16 v[232:235], a[12:15], a[220:223], v[232:235]
    v_mul_f32 v231, s38, v231
    v_cvt_pk_bf16_f32 v228, v228, v229
    v_mfma_f32_16x16x32_bf16 v[236:239], a[24:27], a[240:243], 0
    ds_read_b128 a[224:227], v240 offset:256
    v_cvt_pk_bf16_f32 v229, v230, v231
    v_mfma_f32_16x16x32_bf16 v[236:239], a[28:31], a[244:247], v[236:239]
    ds_write_b64 v247, v[228:229] offset:55552
    v_mfma_f32_16x16x32_bf16 v[236:239], a[32:35], a[216:219], v[236:239]
    buffer_load_dwordx4 v251, s[12:15], s63 offen offset:2048 lds
    s_add_u32 m0, s46, 0x16800
    v_mfma_f32_16x16x32_bf16 v[236:239], a[36:39], a[220:223], v[236:239]
    s_lshl_b32 s63, s28, 5
    s_add_u32 s63, s63, 0x7800
    v_sub_f32 v205, v205, v248
    v_mfma_f32_16x16x32_bf16 v[228:231], a[48:51], a[240:243], 0
    ds_read_b128 a[228:231], v241 offset:256
    ds_read_b128 a[232:235], v240 offset:1536
    v_mfma_f32_16x16x32_bf16 v[228:231], a[52:55], a[244:247], v[228:231]
    ds_read_b128 a[236:239], v241 offset:1536
    v_sub_f32 v206, v206, v248
    v_mfma_f32_16x16x32_bf16 v[228:231], a[56:59], a[216:219], v[228:231]
    v_exp_f32 v204, v204
    v_mfma_f32_16x16x32_bf16 v[228:231], a[60:63], a[220:223], v[228:231]
    v_exp_f32 v205, v205
    v_exp_f32 v206, v206
    s_waitcnt lgkmcnt(4)
    v_mfma_f32_16x16x32_bf16 v[232:235], a[16:19], a[224:227], v[232:235]
    v_sub_f32 v207, v207, v248
    v_cvt_pk_bf16_f32 v194, v204, v205
    v_mfma_f32_16x16x32_bf16 v[236:239], a[40:43], a[224:227], v[236:239]
    v_exp_f32 v207, v207
    v_mfma_f32_16x16x32_bf16 v[228:231], a[64:67], a[224:227], v[228:231]
    v_cvt_pk_bf16_f32 v181, v206, v207
    ds_read_b128 v[204:207], v246 offset:64
    v_sub_f32 v208, v208, v248
    s_waitcnt lgkmcnt(3)
    v_mfma_f32_16x16x32_bf16 v[232:235], a[20:23], a[228:231], v[232:235]
    v_exp_f32 v208, v208
    v_mfma_f32_16x16x32_bf16 v[236:239], a[44:47], a[228:231], v[236:239]
    v_sub_f32 v209, v209, v248
    v_sub_f32 v210, v210, v248
    v_mfma_f32_16x16x32_bf16 v[228:231], a[68:71], a[228:231], v[228:231]
    v_exp_f32 v209, v209
    v_exp_f32 v210, v210
    v_sub_f32 v211, v211, v248
    v_exp_f32 v211, v211
    v_cvt_pk_bf16_f32 v192, v208, v209
    v_cvt_pk_bf16_f32 v195, v210, v211
    ds_read_b128 v[208:211], v244 offset:128
    v_sub_f32 v196, v196, v248
    v_mfma_f32_16x16x32_bf16 v[212:215], v[6:9], v[192:195], 0
    v_exp_f32 v196, v196
    v_mfma_f32_16x16x32_bf16 v[216:219], v[36:39], v[192:195], 0
    v_sub_f32 v197, v197, v248
    v_sub_f32 v198, v198, v248
    v_mfma_f32_16x16x32_bf16 v[220:223], v[66:69], v[192:195], 0
    s_waitcnt lgkmcnt(1)
    v_exp_f32 v197, v197
    v_mfma_f32_16x16x32_bf16 v[224:227], a[248:251], v[192:195], 0
    v_exp_f32 v198, v198
    v_mfma_f32_16x16x32_bf16 v[204:207], v[138:141], v[174:177], v[204:207]
    v_sub_f32 v199, v199, v248
    v_cvt_pk_bf16_f32 v183, v196, v197
    v_mfma_f32_16x16x32_bf16 v[204:207], v[140:143], v[176:179], v[204:207]
    v_exp_f32 v199, v199
    v_sub_f32 v200, v200, v248
    v_cvt_pk_bf16_f32 v186, v198, v199
    ds_read_b128 v[196:199], v245 offset:128
    v_exp_f32 v200, v200
    s_waitcnt lgkmcnt(1)
    v_mfma_f32_16x16x32_bf16 v[208:211], v[132:135], v[174:177], v[208:211]
    v_sub_f32 v201, v201, v248
    v_sub_f32 v202, v202, v248
    v_mfma_f32_16x16x32_bf16 v[208:211], v[134:137], v[176:179], v[208:211]
    v_exp_f32 v201, v201
    v_exp_f32 v202, v202
    v_sub_f32 v203, v203, v248
    v_exp_f32 v203, v203
    v_cvt_pk_bf16_f32 v184, v200, v201
    v_cvt_pk_bf16_f32 v187, v202, v203
    ds_read_b128 v[200:203], v246 offset:128
    v_sub_f32 v204, v204, v248
    v_exp_f32 v204, v204
    v_sub_f32 v205, v205, v248
    v_exp_f32 v205, v205
    v_sub_f32 v206, v206, v248
    v_exp_f32 v206, v206
    v_sub_f32 v207, v207, v248
    s_waitcnt lgkmcnt(1)
    v_mfma_f32_16x16x32_bf16 v[196:199], v[102:105], v[174:177], v[196:199]
    v_exp_f32 v207, v207
    v_mfma_f32_16x16x32_bf16 v[196:199], v[104:107], v[176:179], v[196:199]
    v_cvt_pk_bf16_f32 v182, v204, v205
    v_cvt_pk_bf16_f32 v185, v206, v207
    ds_read_b128 v[204:207], v244 offset:0
    v_mfma_f32_16x16x32_bf16 v[212:215], v[10:13], v[180:183], v[212:215]
    v_sub_f32 v208, v208, v248
    v_sub_f32 v209, v209, v248
    v_mfma_f32_16x16x32_bf16 v[216:219], v[40:43], v[180:183], v[216:219]
    v_exp_f32 v208, v208
    v_mfma_f32_16x16x32_bf16 v[220:223], v[70:73], v[180:183], v[220:223]
    s_waitcnt lgkmcnt(1)
    v_exp_f32 v209, v209
    v_mfma_f32_16x16x32_bf16 v[224:227], a[248:251], v[180:183], v[224:227]
    v_cvt_pk_bf16_f32 v189, v208, v209
    s_waitcnt vmcnt(3)
    v_mfma_f32_16x16x32_bf16 v[212:215], v[14:17], v[184:187], v[212:215]
    ds_read_b64_tr_b16 a[144:145], v249 offset:0
    ds_read_b64_tr_b16 a[146:147], v250 offset:0
    v_mfma_f32_16x16x32_bf16 v[216:219], v[44:47], v[184:187], v[216:219]
    ds_read_b64_tr_b16 a[168:169], v249 offset:32
    ds_read_b64_tr_b16 a[170:171], v250 offset:32
    v_mfma_f32_16x16x32_bf16 v[220:223], v[74:77], v[184:187], v[220:223]
    ds_read_b64_tr_b16 a[192:193], v249 offset:64
    ds_read_b64_tr_b16 a[194:195], v250 offset:64
    v_mfma_f32_16x16x32_bf16 v[224:227], a[248:251], v[184:187], v[224:227]
    ds_read_b128 v[208:211], v245 offset:0
    v_sub_f32 v196, v196, v248
    v_mfma_f32_16x16x32_bf16 v[200:203], v[114:117], v[174:177], v[200:203]
    ds_read_b64 v[174:175], v247 offset:0
    v_sub_f32 v197, v197, v248
    v_mfma_f32_16x16x32_bf16 v[200:203], v[116:119], v[176:179], v[200:203]
    s_waitcnt lgkmcnt(8)
    ds_read_b64 v[176:177], v247 offset:128
    v_mfma_f32_16x16x32_bf16 v[204:207], v[126:129], v[168:171], v[204:207]
    ds_read_b64 v[178:179], v247 offset:256
    v_mfma_f32_16x16x32_bf16 v[204:207], v[128:131], v[170:173], v[204:207]
    v_exp_f32 v196, v196
    v_exp_f32 v197, v197
    s_nop 0
    v_cvt_pk_bf16_f32 v190, v196, v197
    ds_read_b128 v[196:199], v246 offset:0
    v_sub_f32 v200, v200, v248
    v_exp_f32 v200, v200
    v_sub_f32 v201, v201, v248
    v_exp_f32 v201, v201
    s_waitcnt lgkmcnt(5)
    buffer_load_dwordx4 v252, s[12:15], s60 offen lds
    s_waitcnt lgkmcnt(4)
    v_mfma_f32_16x16x32_bf16 v[208:211], v[162:165], v[168:171], v[208:211]
    v_cvt_pk_bf16_f32 v188, v200, v201
    s_waitcnt vmcnt(1)
    v_mfma_f32_16x16x32_bf16 v[208:211], v[164:167], v[170:173], v[208:211]
    ds_read_b64_tr_b16 a[148:149], v249 offset:3072
    ds_read_b64_tr_b16 a[150:151], v250 offset:3072
    v_mfma_f32_16x16x32_bf16 v[212:215], v[18:21], v[188:191], v[212:215]
    ds_read_b64_tr_b16 a[172:173], v249 offset:3104
    ds_read_b64_tr_b16 a[174:175], v250 offset:3104
    v_mfma_f32_16x16x32_bf16 v[216:219], v[48:51], v[188:191], v[216:219]
    buffer_load_dwordx4 v253, s[12:15], s60 offen offset:1024 lds
    ds_read_b64_tr_b16 a[196:197], v249 offset:3136
    v_mfma_f32_16x16x32_bf16 v[220:223], v[78:81], v[188:191], v[220:223]
    ds_read_b64_tr_b16 a[198:199], v250 offset:3136
    ds_read_b128 v[200:203], v244 offset:64
    v_mfma_f32_16x16x32_bf16 v[224:227], a[248:251], v[188:191], v[224:227]
    s_waitcnt lgkmcnt(7)
    v_max_f32 v248, v204, v205
    v_max3_f32 v248, v248, v206, v207
    v_mfma_f32_16x16x32_bf16 v[196:199], v[138:141], v[168:171], v[196:199]
    ds_read_b128 v[204:207], v245 offset:64
    v_max3_f32 v248, v248, v208, v209
    v_mfma_f32_16x16x32_bf16 v[196:199], v[140:143], v[170:173], v[196:199]
    buffer_load_dwordx4 v251, s[12:15], s60 offen offset:2048 lds
    s_add_u32 m0, s46, 0x17400
    v_rcp_f32 v225, v224
    v_max3_f32 v248, v248, v210, v211
    ds_read_b128 v[208:211], v246 offset:64
    v_mul_f32 v212, v212, v225
    v_mul_f32 v213, v213, v225
    v_mul_f32 v214, v214, v225
    v_mul_f32 v215, v215, v225
    v_cvt_pk_bf16_f32 v212, v212, v213
    v_cvt_pk_bf16_f32 v213, v214, v215
    ds_write_b64 v247, v[212:213] offset:12288
    v_mul_f32 v216, v216, v225
    s_waitcnt lgkmcnt(4)
    buffer_load_dwordx4 v252, s[12:15], s61 offen lds
    v_mul_f32 v217, v217, v225
    s_waitcnt lgkmcnt(3)
    v_mfma_f32_16x16x32_bf16 v[200:203], v[132:135], v[168:171], v[200:203]
    v_mul_f32 v218, v218, v225
    v_mul_f32 v219, v219, v225
    v_mfma_f32_16x16x32_bf16 v[200:203], v[134:137], v[170:173], v[200:203]
    s_waitcnt lgkmcnt(2)
    v_cvt_pk_bf16_f32 v216, v216, v217
    v_cvt_pk_bf16_f32 v217, v218, v219
    v_mfma_f32_16x16x32_bf16 v[204:207], v[102:105], v[168:171], v[204:207]
    ds_write_b64 v247, v[216:217] offset:12416
    v_mfma_f32_16x16x32_bf16 v[204:207], v[104:107], v[170:173], v[204:207]
    s_waitcnt lgkmcnt(2)
    buffer_load_dwordx4 v253, s[12:15], s61 offen offset:1024 lds
    v_mfma_f32_16x16x32_bf16 v[208:211], v[114:117], v[168:171], v[208:211]
    v_mul_f32 v220, v220, v225
    v_mul_f32 v221, v221, v225
    v_mfma_f32_16x16x32_bf16 v[208:211], v[116:119], v[170:173], v[208:211]
    v_mul_f32 v222, v222, v225
    v_mul_f32 v223, v223, v225
    v_cvt_pk_bf16_f32 v220, v220, v221
    v_cvt_pk_bf16_f32 v221, v222, v223
    ds_write_b64 v247, v[220:221] offset:12544
    buffer_load_dwordx4 v251, s[12:15], s61 offen offset:2048 lds
    s_add_u32 m0, s46, 0x16800
    v_max3_f32 v248, v248, v196, v197
    v_max3_f32 v248, v248, v198, v199
    ds_read_b128 v[196:199], v244 offset:128
    v_max3_f32 v248, v248, v200, v201
    v_max3_f32 v248, v248, v202, v203
    ds_read_b128 v[200:203], v245 offset:128
    v_max3_f32 v248, v248, v204, v205
    v_max3_f32 v248, v248, v206, v207
    ds_read_b128 v[204:207], v246 offset:128
    v_max3_f32 v248, v248, v208, v209
    v_max3_f32 v248, v248, v210, v211
    ds_read_b128 v[208:211], v244 offset:0
    s_waitcnt lgkmcnt(3)
    v_mfma_f32_16x16x32_bf16 v[196:199], v[144:147], v[168:171], v[196:199]
    v_mfma_f32_16x16x32_bf16 v[196:199], v[146:149], v[170:173], v[196:199]
    s_waitcnt lgkmcnt(2)
    v_mfma_f32_16x16x32_bf16 v[200:203], v[108:111], v[168:171], v[200:203]
    s_waitcnt lgkmcnt(1)
    v_mfma_f32_16x16x32_bf16 v[200:203], v[110:113], v[170:173], v[200:203]
    v_mfma_f32_16x16x32_bf16 v[204:207], v[120:123], v[168:171], v[204:207]
    s_waitcnt lgkmcnt(0)
    v_mfma_f32_16x16x32_bf16 v[204:207], v[122:125], v[170:173], v[204:207]
    v_mfma_f32_16x16x32_bf16 v[208:211], v[126:129], v[168:171], v[208:211]
    v_cvt_pk_bf16_f32 v126, v232, v233
    v_cvt_pk_bf16_f32 v127, v234, v235
    v_mfma_f32_16x16x32_bf16 v[208:211], v[128:131], v[170:173], v[208:211]
    v_cvt_pk_bf16_f32 v128, v236, v237
    v_cvt_pk_bf16_f32 v129, v238, v239
    v_mfma_f32_16x16x32_bf16 v[232:235], a[240:243], a[72:75], 0
    v_cvt_pk_bf16_f32 v130, v228, v229
    v_cvt_pk_bf16_f32 v131, v230, v231
    v_mfma_f32_16x16x32_bf16 v[232:235], a[244:247], a[76:79], v[232:235]
    v_max3_f32 v248, v248, v196, v197
    v_max3_f32 v248, v248, v200, v201
    v_mfma_f32_16x16x32_bf16 v[232:235], a[216:219], a[80:83], v[232:235]
    ds_read_b128 v[196:199], v245 offset:0
    ds_read_b128 v[200:203], v246 offset:0
    v_mfma_f32_16x16x32_bf16 v[232:235], a[220:223], a[84:87], v[232:235]
    v_max3_f32 v248, v248, v204, v205
    v_mov_b32 v225, v248
    v_mfma_f32_16x16x32_bf16 v[232:235], a[224:227], a[88:91], v[232:235]
    ds_read_b128 v[204:207], v244 offset:64
    v_permlane16_swap_b32 v248, v225
    v_mfma_f32_16x16x32_bf16 v[232:235], a[228:231], a[92:95], v[232:235]
    v_max_f32 v248, v248, v225
    v_mov_b32 v225, v248
    v_mfma_f32_16x16x32_bf16 v[236:239], a[240:243], a[96:99], 0
    v_mfma_f32_16x16x32_bf16 v[236:239], a[244:247], a[100:103], v[236:239]
    v_permlane32_swap_b32 v248, v225
    v_max_f32 v248, v248, v225
    v_mfma_f32_16x16x32_bf16 v[236:239], a[216:219], a[104:107], v[236:239]
    v_sub_f32 v208, v208, v248
    v_cvt_pk_bf16_f32 v1, v232, v233
    v_mfma_f32_16x16x32_bf16 v[236:239], a[220:223], a[108:111], v[236:239]
    v_cvt_pk_bf16_f32 v4, v234, v235
    v_sub_f32 v209, v209, v248
    v_mfma_f32_16x16x32_bf16 v[236:239], a[224:227], a[112:115], v[236:239]
    v_exp_f32 v208, v208
    v_mfma_f32_16x16x32_bf16 v[236:239], a[228:231], a[116:119], v[236:239]
    s_waitcnt lgkmcnt(2)
    v_exp_f32 v209, v209
    v_mfma_f32_16x16x32_bf16 v[196:199], v[162:165], v[168:171], v[196:199]
    s_waitcnt lgkmcnt(1)
    v_sub_f32 v210, v210, v248
    v_sub_f32 v211, v211, v248
    v_mfma_f32_16x16x32_bf16 v[196:199], v[164:167], v[170:173], v[196:199]
    s_waitcnt lgkmcnt(0)
    v_cvt_pk_bf16_f32 v31, v236, v237
    v_cvt_pk_bf16_f32 v34, v238, v239
    v_mfma_f32_16x16x32_bf16 v[200:203], v[138:141], v[168:171], v[200:203]
    v_exp_f32 v210, v210
    v_mfma_f32_16x16x32_bf16 v[200:203], v[140:143], v[170:173], v[200:203]
    v_exp_f32 v211, v211
    v_mfma_f32_16x16x32_bf16 v[204:207], v[132:135], v[168:171], v[204:207]
    v_cvt_pk_bf16_f32 v193, v208, v209
    v_cvt_pk_bf16_f32 v180, v210, v211
    v_mfma_f32_16x16x32_bf16 v[204:207], v[134:137], v[170:173], v[204:207]
    ds_read_b128 v[208:211], v245 offset:64
    v_sub_f32 v196, v196, v248
    v_mfma_f32_16x16x32_bf16 v[228:231], a[240:243], a[120:123], 0
    s_waitcnt vmcnt(3)
    ds_read_b64_tr_b16 a[152:153], v249 offset:0
    v_mfma_f32_16x16x32_bf16 v[228:231], a[244:247], a[124:127], v[228:231]
    ds_read_b64_tr_b16 a[154:155], v250 offset:0
    ds_read_b64_tr_b16 a[176:177], v249 offset:32
    v_mfma_f32_16x16x32_bf16 v[228:231], a[216:219], a[128:131], v[228:231]
    ds_read_b64_tr_b16 a[178:179], v250 offset:32
    ds_read_b64_tr_b16 a[200:201], v249 offset:64
    v_mfma_f32_16x16x32_bf16 v[228:231], a[220:223], a[132:135], v[228:231]
    ds_read_b64_tr_b16 a[202:203], v250 offset:64
    ds_read_b128 a[240:243], v240 offset:1664
    v_mfma_f32_16x16x32_bf16 v[228:231], a[224:227], a[136:139], v[228:231]
    ds_read_b128 a[244:247], v241 offset:1664
    ds_read_b128 a[216:219], v240 offset:1792
    v_mfma_f32_16x16x32_bf16 v[228:231], a[228:231], a[140:143], v[228:231]
    ds_read_b128 a[220:223], v241 offset:1792
    ds_read_b128 a[224:227], v240 offset:3072
    v_mfma_f32_16x16x32_bf16 v[232:235], a[0:3], a[232:235], 0
    ds_read_b128 a[228:231], v241 offset:3072
    v_sub_f32 v197, v197, v248
    v_mfma_f32_16x16x32_bf16 v[232:235], a[4:7], a[236:239], v[232:235]
    s_waitcnt lgkmcnt(12)
    v_exp_f32 v196, v196
    v_mfma_f32_16x16x32_bf16 v[208:211], v[102:105], v[168:171], v[208:211]
    v_cvt_pk_bf16_f32 v61, v228, v229
    v_cvt_pk_bf16_f32 v64, v230, v231
    v_mfma_f32_16x16x32_bf16 v[208:211], v[104:107], v[170:173], v[208:211]
    v_exp_f32 v197, v197
    v_mfma_f32_16x16x32_bf16 v[236:239], a[24:27], a[232:235], 0
    v_sub_f32 v198, v198, v248
    v_sub_f32 v199, v199, v248
    v_mfma_f32_16x16x32_bf16 v[236:239], a[28:31], a[236:239], v[236:239]
    s_waitcnt lgkmcnt(6)
    buffer_load_dwordx4 v252, s[12:15], s62 offen lds
    v_mfma_f32_16x16x32_bf16 v[228:231], a[48:51], a[232:235], 0
    s_waitcnt lgkmcnt(5)
    v_exp_f32 v198, v198
    v_mfma_f32_16x16x32_bf16 v[232:235], a[8:11], a[240:243], v[232:235]
    s_waitcnt lgkmcnt(4)
    v_exp_f32 v199, v199
    v_mfma_f32_16x16x32_bf16 v[232:235], a[12:15], a[244:247], v[232:235]
    s_waitcnt vmcnt(1) lgkmcnt(3)
    ds_read_b64_tr_b16 a[156:157], v249 offset:3072
    v_mfma_f32_16x16x32_bf16 v[232:235], a[16:19], a[216:219], v[232:235]
    buffer_load_dwordx4 v253, s[12:15], s62 offen offset:1024 lds
    ds_read_b64_tr_b16 a[158:159], v250 offset:3072
    v_mfma_f32_16x16x32_bf16 v[236:239], a[32:35], a[240:243], v[236:239]
    ds_read_b64_tr_b16 a[180:181], v249 offset:3104
    ds_read_b64_tr_b16 a[182:183], v250 offset:3104
    v_mfma_f32_16x16x32_bf16 v[236:239], a[36:39], a[244:247], v[236:239]
    ds_read_b64_tr_b16 a[204:205], v249 offset:3136
    ds_read_b64_tr_b16 a[206:207], v250 offset:3136
    v_mfma_f32_16x16x32_bf16 v[236:239], a[40:43], a[216:219], v[236:239]
    s_waitcnt lgkmcnt(8)
    v_cvt_pk_bf16_f32 v194, v196, v197
    v_cvt_pk_bf16_f32 v181, v198, v199
    v_mfma_f32_16x16x32_bf16 v[232:235], a[20:23], a[220:223], v[232:235]
    buffer_load_dwordx4 v251, s[12:15], s62 offen offset:2048 lds
    s_add_u32 m0, s46, 0x17400
    v_mfma_f32_16x16x32_bf16 v[236:239], a[44:47], a[220:223], v[236:239]
    ds_read_b128 v[196:199], v246 offset:64
    v_sub_f32 v200, v200, v248
    v_mfma_f32_16x16x32_bf16 v[228:231], a[52:55], a[236:239], v[228:231]
    v_exp_f32 v200, v200
    v_mfma_f32_16x16x32_bf16 v[228:231], a[56:59], a[240:243], v[228:231]
    v_sub_f32 v201, v201, v248
    v_sub_f32 v202, v202, v248
    v_mfma_f32_16x16x32_bf16 v[228:231], a[60:63], a[244:247], v[228:231]
    v_exp_f32 v201, v201
    v_mfma_f32_16x16x32_bf16 v[228:231], a[64:67], a[216:219], v[228:231]
    v_exp_f32 v202, v202
    v_mfma_f32_16x16x32_bf16 v[228:231], a[68:71], a[220:223], v[228:231]
    v_sub_f32 v203, v203, v248
    v_exp_f32 v203, v203
    s_waitcnt lgkmcnt(1)
    buffer_load_dwordx4 v252, s[12:15], s63 offen lds
    v_cvt_pk_bf16_f32 v192, v200, v201
    v_cvt_pk_bf16_f32 v195, v202, v203
    ds_read_b128 v[200:203], v244 offset:128
    v_sub_f32 v204, v204, v248
    v_mfma_f32_16x16x32_bf16 v[212:215], v[12:15], v[192:195], 0
    s_waitcnt lgkmcnt(1)
    v_exp_f32 v204, v204
    v_mfma_f32_16x16x32_bf16 v[216:219], v[42:45], v[192:195], 0
    v_sub_f32 v205, v205, v248
    v_sub_f32 v206, v206, v248
    v_mfma_f32_16x16x32_bf16 v[220:223], v[72:75], v[192:195], 0
    buffer_load_dwordx4 v253, s[12:15], s63 offen offset:1024 lds
    v_sub_f32 v207, v207, v248
    v_mfma_f32_16x16x32_bf16 v[224:227], a[248:251], v[192:195], 0
    v_exp_f32 v205, v205
    v_mfma_f32_16x16x32_bf16 v[196:199], v[114:117], v[168:171], v[196:199]
    v_exp_f32 v206, v206
    v_mfma_f32_16x16x32_bf16 v[196:199], v[116:119], v[170:173], v[196:199]
    v_exp_f32 v207, v207
    buffer_load_dwordx4 v251, s[12:15], s63 offen offset:2048 lds
    v_cvt_pk_bf16_f32 v183, v204, v205
    v_cvt_pk_bf16_f32 v186, v206, v207
    ds_read_b128 v[204:207], v245 offset:128
    s_waitcnt lgkmcnt(1)
    v_mfma_f32_16x16x32_bf16 v[200:203], v[144:147], v[168:171], v[200:203]
    v_sub_f32 v208, v208, v248
    v_sub_f32 v209, v209, v248
    v_mfma_f32_16x16x32_bf16 v[200:203], v[146:149], v[170:173], v[200:203]
    v_exp_f32 v208, v208
    v_exp_f32 v209, v209
    v_sub_f32 v210, v210, v248
    v_exp_f32 v210, v210
    v_sub_f32 v211, v211, v248
    v_exp_f32 v211, v211
    v_cvt_pk_bf16_f32 v184, v208, v209
    v_cvt_pk_bf16_f32 v187, v210, v211
    ds_read_b128 v[208:211], v246 offset:128
    v_sub_f32 v196, v196, v248
    v_exp_f32 v196, v196
    v_sub_f32 v197, v197, v248
    v_exp_f32 v197, v197
    v_sub_f32 v198, v198, v248
    v_exp_f32 v198, v198
    s_waitcnt lgkmcnt(1)
    v_mfma_f32_16x16x32_bf16 v[204:207], v[108:111], v[168:171], v[204:207]
    v_sub_f32 v199, v199, v248
    v_cvt_pk_bf16_f32 v182, v196, v197
    v_mfma_f32_16x16x32_bf16 v[204:207], v[110:113], v[170:173], v[204:207]
    v_exp_f32 v199, v199
    v_mfma_f32_16x16x32_bf16 v[212:215], v[16:19], v[180:183], v[212:215]
    v_cvt_pk_bf16_f32 v185, v198, v199
    v_sub_f32 v200, v200, v248
    v_mfma_f32_16x16x32_bf16 v[216:219], v[46:49], v[180:183], v[216:219]
    ds_read_b128 v[196:199], v244 offset:32
    v_sub_f32 v201, v201, v248
    v_mfma_f32_16x16x32_bf16 v[220:223], v[76:79], v[180:183], v[220:223]
    v_exp_f32 v200, v200
    v_mfma_f32_16x16x32_bf16 v[224:227], a[248:251], v[180:183], v[224:227]
    s_waitcnt lgkmcnt(1)
    v_exp_f32 v201, v201
    v_mfma_f32_16x16x32_bf16 v[212:215], v[20:23], v[184:187], v[212:215]
    v_cvt_pk_bf16_f32 v189, v200, v201
    v_sub_f32 v204, v204, v248
    v_mfma_f32_16x16x32_bf16 v[216:219], v[50:53], v[184:187], v[216:219]
    ds_read_b128 v[200:203], v245 offset:32
    v_sub_f32 v205, v205, v248
    v_mfma_f32_16x16x32_bf16 v[220:223], v[80:83], v[184:187], v[220:223]
    v_exp_f32 v204, v204
    v_mfma_f32_16x16x32_bf16 v[224:227], a[248:251], v[184:187], v[224:227]
    v_exp_f32 v205, v205
    v_mfma_f32_16x16x32_bf16 v[208:211], v[120:123], v[168:171], v[208:211]
    ds_read_b64 v[168:169], v247 offset:24576
    v_cvt_pk_bf16_f32 v190, v204, v205
    v_mfma_f32_16x16x32_bf16 v[208:211], v[122:125], v[170:173], v[208:211]
    ds_read_b128 v[204:207], v246 offset:32
    s_waitcnt lgkmcnt(3)
    v_mfma_f32_16x16x32_bf16 v[196:199], v[132:135], v[174:177], v[196:199]
    ds_read_b64 v[170:171], v247 offset:24704
    ds_read_b64 v[172:173], v247 offset:24832
    v_mfma_f32_16x16x32_bf16 v[196:199], v[134:137], v[176:179], v[196:199]
    s_nop 1
    v_sub_f32 v208, v208, v248
    v_exp_f32 v208, v208
    v_sub_f32 v209, v209, v248
    v_exp_f32 v209, v209
    s_nop 0
    s_waitcnt lgkmcnt(4)
    v_mfma_f32_16x16x32_bf16 v[200:203], v[102:105], v[174:177], v[200:203]
    v_cvt_pk_bf16_f32 v188, v208, v209
    v_max_f32 v248, v196, v197
    v_mfma_f32_16x16x32_bf16 v[200:203], v[104:107], v[176:179], v[200:203]
    ds_read_b128 v[208:211], v244 offset:96
    v_max3_f32 v248, v248, v198, v199
    v_mfma_f32_16x16x32_bf16 v[212:215], v[24:27], v[188:191], v[212:215]
    ds_read_b128 v[196:199], v245 offset:96
    v_mfma_f32_16x16x32_bf16 v[216:219], v[54:57], v[188:191], v[216:219]
    v_mfma_f32_16x16x32_bf16 v[220:223], v[84:87], v[188:191], v[220:223]
    s_waitcnt lgkmcnt(4)
    v_mfma_f32_16x16x32_bf16 v[224:227], a[248:251], v[188:191], v[224:227]
    v_max3_f32 v248, v248, v200, v201
    v_max3_f32 v248, v248, v202, v203
    v_mfma_f32_16x16x32_bf16 v[204:207], v[114:117], v[174:177], v[204:207]
    ds_read_b128 v[200:203], v246 offset:96
    v_mfma_f32_16x16x32_bf16 v[204:207], v[116:119], v[176:179], v[204:207]
    s_nop 2
    v_rcp_f32 v225, v224
    s_nop 0
    v_mul_f32 v212, v212, v225
    v_mul_f32 v213, v213, v225
    v_mul_f32 v214, v214, v225
    s_waitcnt lgkmcnt(2)
    v_mfma_f32_16x16x32_bf16 v[208:211], v[144:147], v[174:177], v[208:211]
    s_waitcnt vmcnt(3)
    ds_read_b64_tr_b16 a[160:161], v249 offset:0
    v_mfma_f32_16x16x32_bf16 v[208:211], v[146:149], v[176:179], v[208:211]
    s_waitcnt lgkmcnt(2)
    ds_read_b64_tr_b16 a[162:163], v250 offset:0
    v_mfma_f32_16x16x32_bf16 v[196:199], v[108:111], v[174:177], v[196:199]
    ds_read_b64_tr_b16 a[184:185], v249 offset:32
    ds_read_b64_tr_b16 a[186:187], v250 offset:32
    v_mfma_f32_16x16x32_bf16 v[196:199], v[110:113], v[176:179], v[196:199]
    ds_read_b64_tr_b16 a[208:209], v249 offset:64
    ds_read_b64_tr_b16 a[210:211], v250 offset:64
    v_mul_f32 v215, v215, v225
    v_cvt_pk_bf16_f32 v212, v212, v213
    s_waitcnt lgkmcnt(6)
    v_mfma_f32_16x16x32_bf16 v[200:203], v[120:123], v[174:177], v[200:203]
    v_cvt_pk_bf16_f32 v213, v214, v215
    v_mul_f32 v216, v216, v225
    v_mfma_f32_16x16x32_bf16 v[200:203], v[122:125], v[176:179], v[200:203]
    ds_write_b64 v247, v[212:213] offset:18432
    v_mul_f32 v217, v217, v225
    v_mul_f32 v218, v218, v225
    v_mul_f32 v219, v219, v225
    v_cvt_pk_bf16_f32 v216, v216, v217
    v_cvt_pk_bf16_f32 v217, v218, v219
    ds_write_b64 v247, v[216:217] offset:18560
    v_mul_f32 v220, v220, v225
    v_mul_f32 v221, v221, v225
    v_mul_f32 v222, v222, v225
    v_mul_f32 v223, v223, v225
    v_cvt_pk_bf16_f32 v220, v220, v221
    v_cvt_pk_bf16_f32 v221, v222, v223
    ds_write_b64 v247, v[220:221] offset:18688
    v_max3_f32 v248, v248, v204, v205
    v_max3_f32 v248, v248, v206, v207
    ds_read_b128 v[204:207], v244 offset:32
    v_max3_f32 v248, v248, v208, v209
    v_max3_f32 v248, v248, v210, v211
    ds_read_b128 v[208:211], v245 offset:32
    v_max3_f32 v248, v248, v196, v197
    v_max3_f32 v248, v248, v198, v199
    s_waitcnt vmcnt(0)
    ds_read_b64_tr_b16 a[164:165], v249 offset:3072
    ds_read_b64_tr_b16 a[166:167], v250 offset:3072
    ds_read_b64_tr_b16 a[188:189], v249 offset:3104
    ds_read_b64_tr_b16 a[190:191], v250 offset:3104
    ds_read_b64_tr_b16 a[212:213], v249 offset:3136
    ds_read_b64_tr_b16 a[214:215], v250 offset:3136
    ds_read_b128 v[196:199], v246 offset:32
    v_max3_f32 v248, v248, v200, v201
    v_max3_f32 v248, v248, v202, v203
    ds_read_b128 v[200:203], v244 offset:96
    v_mov_b32 v225, v248
    s_nop 1
    v_permlane16_swap_b32 v248, v225
    v_max_f32 v248, v248, v225
    v_mov_b32 v225, v248
    s_nop 1
    s_waitcnt lgkmcnt(9)
    v_mfma_f32_16x16x32_bf16 v[204:207], v[132:135], v[174:177], v[204:207]
    v_cvt_pk_bf16_f32 v132, v232, v233
    v_cvt_pk_bf16_f32 v133, v234, v235
    v_mfma_f32_16x16x32_bf16 v[204:207], v[134:137], v[176:179], v[204:207]
    s_waitcnt lgkmcnt(8)
    v_cvt_pk_bf16_f32 v134, v236, v237
    v_cvt_pk_bf16_f32 v135, v238, v239
    v_mfma_f32_16x16x32_bf16 v[208:211], v[102:105], v[174:177], v[208:211]
    v_cvt_pk_bf16_f32 v136, v228, v229
    v_cvt_pk_bf16_f32 v137, v230, v231
    v_mfma_f32_16x16x32_bf16 v[208:211], v[104:107], v[176:179], v[208:211]
    v_permlane32_swap_b32 v248, v225
    v_max_f32 v248, v248, v225
    v_mfma_f32_16x16x32_bf16 v[232:235], a[232:235], a[72:75], 0
    v_sub_f32 v204, v204, v248
    s_waitcnt lgkmcnt(2)
    v_mfma_f32_16x16x32_bf16 v[232:235], a[236:239], a[76:79], v[232:235]
    s_barrier
    v_exp_f32 v204, v204
    v_mfma_f32_16x16x32_bf16 v[232:235], a[240:243], a[80:83], v[232:235]
    s_waitcnt lgkmcnt(1)
    v_sub_f32 v205, v205, v248
    v_sub_f32 v206, v206, v248
    v_mfma_f32_16x16x32_bf16 v[196:199], v[114:117], v[174:177], v[196:199]
    s_waitcnt lgkmcnt(0)
    v_exp_f32 v205, v205
    v_mfma_f32_16x16x32_bf16 v[196:199], v[116:119], v[176:179], v[196:199]
    v_exp_f32 v206, v206
    v_mfma_f32_16x16x32_bf16 v[200:203], v[144:147], v[174:177], v[200:203]
    v_sub_f32 v207, v207, v248
    v_cvt_pk_bf16_f32 v193, v204, v205
    v_mfma_f32_16x16x32_bf16 v[200:203], v[146:149], v[176:179], v[200:203]
    v_exp_f32 v207, v207
    v_mfma_f32_16x16x32_bf16 v[232:235], a[244:247], a[84:87], v[232:235]
    v_cvt_pk_bf16_f32 v180, v206, v207
    v_sub_f32 v208, v208, v248
    v_mfma_f32_16x16x32_bf16 v[232:235], a[216:219], a[88:91], v[232:235]
    ds_read_b128 v[204:207], v245 offset:96
    v_sub_f32 v209, v209, v248
    v_mfma_f32_16x16x32_bf16 v[232:235], a[220:223], a[92:95], v[232:235]
    v_exp_f32 v208, v208
    v_mfma_f32_16x16x32_bf16 v[236:239], a[232:235], a[96:99], 0
    v_exp_f32 v209, v209
    v_mfma_f32_16x16x32_bf16 v[236:239], a[236:239], a[100:103], v[236:239]
    v_sub_f32 v210, v210, v248
    v_sub_f32 v211, v211, v248
    v_mfma_f32_16x16x32_bf16 v[236:239], a[240:243], a[104:107], v[236:239]
    v_exp_f32 v210, v210
    v_mfma_f32_16x16x32_bf16 v[236:239], a[244:247], a[108:111], v[236:239]
    v_cvt_pk_bf16_f32 v7, v232, v233
    v_cvt_pk_bf16_f32 v10, v234, v235
    v_mfma_f32_16x16x32_bf16 v[236:239], a[216:219], a[112:115], v[236:239]
    v_exp_f32 v211, v211
    v_mfma_f32_16x16x32_bf16 v[236:239], a[220:223], a[116:119], v[236:239]
    v_cvt_pk_bf16_f32 v194, v208, v209
    v_cvt_pk_bf16_f32 v181, v210, v211
    v_mfma_f32_16x16x32_bf16 v[228:231], a[232:235], a[120:123], 0
    ds_read_b128 a[232:235], v240 offset:3200
    ds_read_b128 v[208:211], v246 offset:96
    v_mfma_f32_16x16x32_bf16 v[228:231], a[236:239], a[124:127], v[228:231]
    ds_read_b128 a[236:239], v241 offset:3200
    v_sub_f32 v196, v196, v248
    v_mfma_f32_16x16x32_bf16 v[228:231], a[240:243], a[128:131], v[228:231]
    s_waitcnt lgkmcnt(3)
    v_cvt_pk_bf16_f32 v37, v236, v237
    v_cvt_pk_bf16_f32 v40, v238, v239
    v_mfma_f32_16x16x32_bf16 v[204:207], v[108:111], v[174:177], v[204:207]
    ds_read_b128 a[240:243], v240 offset:3328
    v_sub_f32 v197, v197, v248
    v_mfma_f32_16x16x32_bf16 v[204:207], v[110:113], v[176:179], v[204:207]
    v_exp_f32 v196, v196
    v_mfma_f32_16x16x32_bf16 v[228:231], a[244:247], a[132:135], v[228:231]
    ds_read_b128 a[244:247], v241 offset:3328
    v_sub_f32 v198, v198, v248
    v_mfma_f32_16x16x32_bf16 v[228:231], a[216:219], a[136:139], v[228:231]
    ds_read_b128 a[216:219], v240 offset:4608
    v_sub_f32 v199, v199, v248
    v_mfma_f32_16x16x32_bf16 v[228:231], a[220:223], a[140:143], v[228:231]
    ds_read_b128 a[220:223], v241 offset:4608
    v_sub_f32 v200, v200, v248
    v_mfma_f32_16x16x32_bf16 v[232:235], a[0:3], a[224:227], 0
    v_exp_f32 v197, v197
    v_mfma_f32_16x16x32_bf16 v[232:235], a[4:7], a[228:231], v[232:235]
    s_waitcnt lgkmcnt(6)
    v_exp_f32 v198, v198
    v_mfma_f32_16x16x32_bf16 v[232:235], a[8:11], a[232:235], v[232:235]
    s_waitcnt lgkmcnt(5)
    v_cvt_pk_bf16_f32 v67, v228, v229
    v_cvt_pk_bf16_f32 v70, v230, v231
    v_mfma_f32_16x16x32_bf16 v[208:211], v[120:123], v[174:177], v[208:211]
    ds_read_b64 v[174:175], v247 offset:30720
    v_cvt_pk_bf16_f32 v192, v196, v197
    v_mfma_f32_16x16x32_bf16 v[208:211], v[122:125], v[176:179], v[208:211]
    ds_read_b64 v[176:177], v247 offset:30848
    ds_read_b64 v[178:179], v247 offset:30976
    v_mfma_f32_16x16x32_bf16 v[236:239], a[24:27], a[224:227], 0
    s_waitcnt lgkmcnt(7)
    v_exp_f32 v199, v199
    v_mfma_f32_16x16x32_bf16 v[232:235], a[12:15], a[236:239], v[232:235]
    s_waitcnt lgkmcnt(6)
    v_cvt_pk_bf16_f32 v195, v198, v199
    v_sub_f32 v201, v201, v248
    v_mfma_f32_16x16x32_bf16 v[232:235], a[16:19], a[240:243], v[232:235]
    ds_read_b128 v[196:199], v244 offset:192
    v_sub_f32 v202, v202, v248
    v_mfma_f32_16x16x32_bf16 v[212:215], v[18:21], v[192:195], 0
    s_waitcnt lgkmcnt(6)
    v_exp_f32 v200, v200
    v_mfma_f32_16x16x32_bf16 v[216:219], v[48:51], v[192:195], 0
    v_exp_f32 v201, v201
    v_mfma_f32_16x16x32_bf16 v[220:223], v[78:81], v[192:195], 0
    v_exp_f32 v202, v202
    v_mfma_f32_16x16x32_bf16 v[224:227], a[248:251], v[192:195], 0
    v_sub_f32 v203, v203, v248
    v_cvt_pk_bf16_f32 v183, v200, v201
    v_mfma_f32_16x16x32_bf16 v[232:235], a[20:23], a[244:247], v[232:235]
    v_exp_f32 v203, v203
    v_mfma_f32_16x16x32_bf16 v[236:239], a[28:31], a[228:231], v[236:239]
    v_cvt_pk_bf16_f32 v186, v202, v203
    v_sub_f32 v204, v204, v248
    v_mfma_f32_16x16x32_bf16 v[236:239], a[32:35], a[232:235], v[236:239]
    ds_read_b128 v[200:203], v245 offset:192
    v_sub_f32 v205, v205, v248
    v_mfma_f32_16x16x32_bf16 v[236:239], a[36:39], a[236:239], v[236:239]
    v_cvt_pk_bf16_f32 v144, v232, v233
    v_cvt_pk_bf16_f32 v145, v234, v235
    v_mfma_f32_16x16x32_bf16 v[236:239], a[40:43], a[240:243], v[236:239]
    s_waitcnt lgkmcnt(1)
    v_exp_f32 v204, v204
    v_mfma_f32_16x16x32_bf16 v[196:199], v[150:153], v[168:171], v[196:199]
    v_exp_f32 v205, v205
    v_mfma_f32_16x16x32_bf16 v[196:199], v[152:155], v[170:173], v[196:199]
    v_sub_f32 v206, v206, v248
    v_sub_f32 v207, v207, v248
    v_mfma_f32_16x16x32_bf16 v[236:239], a[44:47], a[244:247], v[236:239]
    v_exp_f32 v206, v206
    v_mfma_f32_16x16x32_bf16 v[228:231], a[48:51], a[224:227], 0
    v_exp_f32 v207, v207
    v_mfma_f32_16x16x32_bf16 v[228:231], a[52:55], a[228:231], v[228:231]
    v_cvt_pk_bf16_f32 v184, v204, v205
    v_cvt_pk_bf16_f32 v187, v206, v207
    v_mfma_f32_16x16x32_bf16 v[228:231], a[56:59], a[232:235], v[228:231]
    ds_read_b128 v[204:207], v246 offset:192
    v_cvt_pk_bf16_f32 v146, v236, v237
    v_mfma_f32_16x16x32_bf16 v[228:231], a[60:63], a[236:239], v[228:231]
    s_waitcnt lgkmcnt(1)
    v_cvt_pk_bf16_f32 v147, v238, v239
    v_sub_f32 v208, v208, v248
    v_mfma_f32_16x16x32_bf16 v[200:203], v[90:93], v[168:171], v[200:203]
    v_exp_f32 v208, v208
    v_mfma_f32_16x16x32_bf16 v[200:203], v[92:95], v[170:173], v[200:203]
    v_sub_f32 v209, v209, v248
    v_sub_f32 v210, v210, v248
    v_mfma_f32_16x16x32_bf16 v[228:231], a[64:67], a[240:243], v[228:231]
    v_exp_f32 v209, v209
    v_mfma_f32_16x16x32_bf16 v[228:231], a[68:71], a[244:247], v[228:231]
    v_exp_f32 v210, v210
    v_mfma_f32_16x16x32_bf16 v[232:235], a[224:227], a[72:75], 0
    v_sub_f32 v211, v211, v248
    v_cvt_pk_bf16_f32 v182, v208, v209
    v_mfma_f32_16x16x32_bf16 v[232:235], a[228:231], a[76:79], v[232:235]
    v_exp_f32 v211, v211
    v_mfma_f32_16x16x32_bf16 v[212:215], v[22:25], v[180:183], v[212:215]
    v_cvt_pk_bf16_f32 v185, v210, v211
    v_cvt_pk_bf16_f32 v148, v228, v229
    v_mfma_f32_16x16x32_bf16 v[216:219], v[52:55], v[180:183], v[216:219]
    ds_read_b128 v[208:211], v244 offset:256
    v_cvt_pk_bf16_f32 v149, v230, v231
    v_mfma_f32_16x16x32_bf16 v[220:223], v[82:85], v[180:183], v[220:223]
    s_waitcnt lgkmcnt(1)
    v_max_f32 v248, v196, v197
    v_max3_f32 v248, v248, v198, v199
    v_mfma_f32_16x16x32_bf16 v[224:227], a[248:251], v[180:183], v[224:227]
    ds_read_b128 v[196:199], v245 offset:256
    v_max3_f32 v248, v248, v200, v201
    v_mfma_f32_16x16x32_bf16 v[212:215], v[26:29], v[184:187], v[212:215]
    v_max3_f32 v248, v248, v202, v203
    v_mfma_f32_16x16x32_bf16 v[216:219], v[56:59], v[184:187], v[216:219]
    ds_read_b128 v[200:203], v246 offset:256
    v_mfma_f32_16x16x32_bf16 v[220:223], v[86:89], v[184:187], v[220:223]
    v_mfma_f32_16x16x32_bf16 v[224:227], a[248:251], v[184:187], v[224:227]
    v_mov_b32 v187, 0
    v_mfma_f32_16x16x32_bf16 v[204:207], v[126:129], v[168:171], v[204:207]
    v_mfma_f32_16x16x32_bf16 v[204:207], v[128:131], v[170:173], v[204:207]
    v_mfma_f32_16x16x32_bf16 v[232:235], a[232:235], a[80:83], v[232:235]
    s_waitcnt lgkmcnt(2)
    v_mfma_f32_16x16x32_bf16 v[208:211], v[156:159], v[168:171], v[208:211]
    v_mfma_f32_16x16x32_bf16 v[208:211], v[158:161], v[170:173], v[208:211]
    s_waitcnt lgkmcnt(1)
    v_rcp_f32 v225, v224
    v_mfma_f32_16x16x32_bf16 v[196:199], v[96:99], v[168:171], v[196:199]
    v_mov_b32 v226, 0x22e00
    v_cndmask_b32 v226, v226, v247, vcc
    v_mfma_f32_16x16x32_bf16 v[196:199], v[98:101], v[170:173], v[196:199]
    s_mov_b32 vcc_lo, 0xff00fff0
    v_mul_f32 v212, v212, v225
    v_mul_f32 v213, v213, v225
    v_mfma_f32_16x16x32_bf16 v[232:235], a[236:239], a[84:87], v[232:235]
    s_mov_b32 vcc_hi, 0xf000
    v_mul_f32 v214, v214, v225
    v_mul_f32 v215, v215, v225
    v_mfma_f32_16x16x32_bf16 v[232:235], a[240:243], a[88:91], v[232:235]
    s_waitcnt lgkmcnt(0)
    v_cvt_pk_bf16_f32 v212, v212, v213
    v_cvt_pk_bf16_f32 v213, v214, v215
    v_mfma_f32_16x16x32_bf16 v[200:203], v[132:135], v[168:171], v[200:203]
    ds_write_b64 v226, v[212:213] offset:0
    v_mfma_f32_16x16x32_bf16 v[200:203], v[134:137], v[170:173], v[200:203]
    v_mul_f32 v216, v216, v225
    v_mul_f32 v217, v217, v225
    v_mfma_f32_16x16x32_bf16 v[232:235], a[244:247], a[92:95], v[232:235]
    v_mul_f32 v218, v218, v225
    v_mul_f32 v219, v219, v225
    v_mfma_f32_16x16x32_bf16 v[236:239], a[224:227], a[96:99], 0
    v_cvt_pk_bf16_f32 v216, v216, v217
    v_cvt_pk_bf16_f32 v217, v218, v219
    v_mfma_f32_16x16x32_bf16 v[236:239], a[228:231], a[100:103], v[236:239]
    ds_write_b64 v226, v[216:217] offset:128
    v_mfma_f32_16x16x32_bf16 v[236:239], a[232:235], a[104:107], v[236:239]
    v_cvt_pk_bf16_f32 v13, v232, v233
    v_cvt_pk_bf16_f32 v16, v234, v235
    v_mfma_f32_16x16x32_bf16 v[236:239], a[236:239], a[108:111], v[236:239]
    v_mul_f32 v220, v220, v225
    v_mul_f32 v221, v221, v225
    v_mfma_f32_16x16x32_bf16 v[236:239], a[240:243], a[112:115], v[236:239]
    v_mul_f32 v222, v222, v225
    v_mul_f32 v223, v223, v225
    v_mfma_f32_16x16x32_bf16 v[236:239], a[244:247], a[116:119], v[236:239]
    v_cvt_pk_bf16_f32 v220, v220, v221
    v_cvt_pk_bf16_f32 v221, v222, v223
    v_mfma_f32_16x16x32_bf16 v[228:231], a[224:227], a[120:123], 0
    ds_read_b128 a[224:227], v240 offset:4736
    v_max3_f32 v248, v248, v204, v205
    v_mfma_f32_16x16x32_bf16 v[228:231], a[228:231], a[124:127], v[228:231]
    ds_read_b128 a[228:231], v241 offset:4736
    v_max3_f32 v248, v248, v206, v207
    v_mfma_f32_16x16x32_bf16 v[228:231], a[232:235], a[128:131], v[228:231]
    v_cvt_pk_bf16_f32 v43, v236, v237
    v_cvt_pk_bf16_f32 v46, v238, v239
    v_mfma_f32_16x16x32_bf16 v[228:231], a[236:239], a[132:135], v[228:231]
    ds_read_b128 a[232:235], v240 offset:4864
    ds_read_b128 a[236:239], v241 offset:4864
    v_mfma_f32_16x16x32_bf16 v[228:231], a[240:243], a[136:139], v[228:231]
    ds_read_b128 v[204:207], v244 offset:320
    v_max3_f32 v248, v248, v208, v209
    v_mfma_f32_16x16x32_bf16 v[228:231], a[244:247], a[140:143], v[228:231]
    ds_write_b64 v226, v[220:221] offset:256
    v_mfma_f32_16x16x32_bf16 v[232:235], a[0:3], a[216:219], 0
    v_max3_f32 v248, v248, v210, v211
    v_max3_f32 v248, v248, v196, v197
    v_mfma_f32_16x16x32_bf16 v[232:235], a[4:7], a[220:223], v[232:235]
    ds_read_b128 v[208:211], v245 offset:320
    v_max3_f32 v248, v248, v198, v199
    v_mfma_f32_16x16x32_bf16 v[236:239], a[24:27], a[216:219], 0
    s_waitcnt lgkmcnt(6)
    v_cvt_pk_bf16_f32 v73, v228, v229
    v_cvt_pk_bf16_f32 v76, v230, v231
    v_mfma_f32_16x16x32_bf16 v[232:235], a[8:11], a[224:227], v[232:235]
    ds_read_b128 v[196:199], v246 offset:320
    v_max3_f32 v248, v248, v200, v201
    v_mfma_f32_16x16x32_bf16 v[236:239], a[28:31], a[220:223], v[236:239]
    s_waitcnt lgkmcnt(6)
    v_max3_f32 v248, v248, v202, v203
    v_mfma_f32_16x16x32_bf16 v[232:235], a[12:15], a[228:231], v[232:235]
    ds_read_b128 v[200:203], v244 offset:192
    s_waitcnt lgkmcnt(6)
    v_mfma_f32_16x16x32_bf16 v[232:235], a[16:19], a[232:235], v[232:235]
    s_waitcnt lgkmcnt(5)
    v_mfma_f32_16x16x32_bf16 v[232:235], a[20:23], a[236:239], v[232:235]
    s_waitcnt lgkmcnt(4)
    v_mfma_f32_16x16x32_bf16 v[204:207], v[162:165], v[168:171], v[204:207]
    v_mfma_f32_16x16x32_bf16 v[204:207], v[164:167], v[170:173], v[204:207]
    v_mfma_f32_16x16x32_bf16 v[236:239], a[32:35], a[224:227], v[236:239]
    s_waitcnt lgkmcnt(2)
    v_mfma_f32_16x16x32_bf16 v[208:211], v[138:141], v[168:171], v[208:211]
    v_mfma_f32_16x16x32_bf16 v[208:211], v[140:143], v[170:173], v[208:211]
    s_waitcnt lgkmcnt(1)
    v_mfma_f32_16x16x32_bf16 v[196:199], v[144:147], v[168:171], v[196:199]
    v_mfma_f32_16x16x32_bf16 v[196:199], v[146:149], v[170:173], v[196:199]
    s_waitcnt lgkmcnt(0)
    v_max3_f32 v248, v248, v204, v205
    v_mfma_f32_16x16x32_bf16 v[200:203], v[150:153], v[168:171], v[200:203]
    v_cvt_pk_bf16_f32 v150, v232, v233
    v_cvt_pk_bf16_f32 v151, v234, v235
    v_mfma_f32_16x16x32_bf16 v[200:203], v[152:155], v[170:173], v[200:203]
    ds_read_b128 v[204:207], v245 offset:192
    v_max3_f32 v248, v248, v208, v209
    v_mfma_f32_16x16x32_bf16 v[236:239], a[36:39], a[228:231], v[236:239]
    ds_read_b128 v[208:211], v246 offset:192
    v_max3_f32 v248, v248, v196, v197
    v_mfma_f32_16x16x32_bf16 v[236:239], a[40:43], a[232:235], v[236:239]
    ds_read_b128 v[196:199], v244 offset:256
    v_mov_b32 v225, v248
    v_mfma_f32_16x16x32_bf16 v[236:239], a[44:47], a[236:239], v[236:239]
    v_mfma_f32_16x16x32_bf16 v[228:231], a[48:51], a[216:219], 0
    v_permlane16_swap_b32 v248, v225
    v_max_f32 v248, v248, v225
    v_mfma_f32_16x16x32_bf16 v[228:231], a[52:55], a[220:223], v[228:231]
    v_mov_b32 v225, v248
    v_mfma_f32_16x16x32_bf16 v[228:231], a[56:59], a[224:227], v[228:231]
    v_mfma_f32_16x16x32_bf16 v[228:231], a[60:63], a[228:231], v[228:231]
    v_permlane32_swap_b32 v248, v225
    v_cvt_pk_bf16_f32 v152, v236, v237
    v_mfma_f32_16x16x32_bf16 v[228:231], a[64:67], a[232:235], v[228:231]
    v_cvt_pk_bf16_f32 v153, v238, v239
    v_max_f32 v248, v248, v225
    v_mfma_f32_16x16x32_bf16 v[228:231], a[68:71], a[236:239], v[228:231]
    s_waitcnt lgkmcnt(2)
    v_sub_f32 v200, v200, v248
    v_sub_f32 v201, v201, v248
    v_mfma_f32_16x16x32_bf16 v[204:207], v[90:93], v[168:171], v[204:207]
    s_waitcnt lgkmcnt(1)
    v_exp_f32 v200, v200
    v_mfma_f32_16x16x32_bf16 v[204:207], v[92:95], v[170:173], v[204:207]
    s_waitcnt lgkmcnt(0)
    v_cvt_pk_bf16_f32 v154, v228, v229
    v_cvt_pk_bf16_f32 v155, v230, v231
    v_mfma_f32_16x16x32_bf16 v[208:211], v[126:129], v[168:171], v[208:211]
    v_exp_f32 v201, v201
    v_mfma_f32_16x16x32_bf16 v[208:211], v[128:131], v[170:173], v[208:211]
    v_sub_f32 v202, v202, v248
    v_sub_f32 v203, v203, v248
    v_mfma_f32_16x16x32_bf16 v[196:199], v[156:159], v[168:171], v[196:199]
    v_exp_f32 v202, v202
    v_mfma_f32_16x16x32_bf16 v[196:199], v[158:161], v[170:173], v[196:199]
    v_exp_f32 v203, v203
    v_mfma_f32_16x16x32_bf16 v[232:235], a[216:219], a[72:75], 0
    v_cvt_pk_bf16_f32 v190, v200, v201
    v_cvt_pk_bf16_f32 v193, v202, v203
    v_mfma_f32_16x16x32_bf16 v[232:235], a[220:223], a[76:79], v[232:235]
    ds_read_b128 v[200:203], v245 offset:256
    v_sub_f32 v204, v204, v248
    v_mfma_f32_16x16x32_bf16 v[232:235], a[224:227], a[80:83], v[232:235]
    v_exp_f32 v204, v204
    v_mfma_f32_16x16x32_bf16 v[232:235], a[228:231], a[84:87], v[232:235]
    v_sub_f32 v205, v205, v248
    v_sub_f32 v206, v206, v248
    v_mfma_f32_16x16x32_bf16 v[232:235], a[232:235], a[88:91], v[232:235]
    v_exp_f32 v205, v205
    v_mfma_f32_16x16x32_bf16 v[232:235], a[236:239], a[92:95], v[232:235]
    v_exp_f32 v206, v206
    v_mfma_f32_16x16x32_bf16 v[236:239], a[216:219], a[96:99], 0
    v_sub_f32 v207, v207, v248
    v_cvt_pk_bf16_f32 v188, v204, v205
    v_mfma_f32_16x16x32_bf16 v[236:239], a[220:223], a[100:103], v[236:239]
    v_exp_f32 v207, v207
    v_mfma_f32_16x16x32_bf16 v[236:239], a[224:227], a[104:107], v[236:239]
    v_cvt_pk_bf16_f32 v191, v206, v207
    v_cvt_pk_bf16_f32 v19, v232, v233
    v_mfma_f32_16x16x32_bf16 v[236:239], a[228:231], a[108:111], v[236:239]
    ds_read_b128 v[204:207], v246 offset:256
    v_cvt_pk_bf16_f32 v22, v234, v235
    v_mfma_f32_16x16x32_bf16 v[236:239], a[232:235], a[112:115], v[236:239]
    s_waitcnt lgkmcnt(1)
    v_mbcnt_lo_u32_b32 v232, -1, 0
    v_mbcnt_hi_u32_b32 v232, -1, v232
    v_mfma_f32_16x16x32_bf16 v[200:203], v[96:99], v[168:171], v[200:203]
    v_and_b32 v233, 15, v232
    v_lshrrev_b32 v232, 4, v232
    v_mfma_f32_16x16x32_bf16 v[200:203], v[98:101], v[170:173], v[200:203]
    v_lshrrev_b32 v234, 1, v233
    v_mul_u32_u24 v235, 0x180, v233
    v_mfma_f32_16x16x32_bf16 v[236:239], a[236:239], a[116:119], v[236:239]
    v_xor_b32 v243, v232, v234
    v_lshl_add_u32 v242, v243, 4, v235
    v_mfma_f32_16x16x32_bf16 v[228:231], a[216:219], a[120:123], 0
    v_xor_b32 v243, 64, v242
    v_add_u32 v242, 0x1e000, v242
    v_mfma_f32_16x16x32_bf16 v[228:231], a[220:223], a[124:127], v[228:231]
    ds_read_b128 a[240:243], v242 offset:0
    v_add_u32 v243, 0x1e000, v243
    v_mfma_f32_16x16x32_bf16 v[228:231], a[224:227], a[128:131], v[228:231]
    v_cvt_pk_bf16_f32 v49, v236, v237
    v_cvt_pk_bf16_f32 v52, v238, v239
    v_mfma_f32_16x16x32_bf16 v[228:231], a[228:231], a[132:135], v[228:231]
    ds_read_b128 a[244:247], v243 offset:0
    ds_read_b128 a[216:219], v242 offset:128
    v_mfma_f32_16x16x32_bf16 v[228:231], a[232:235], a[136:139], v[228:231]
    ds_read_b128 a[220:223], v243 offset:128
    ds_read_b128 a[224:227], v242 offset:256
    v_mfma_f32_16x16x32_bf16 v[228:231], a[236:239], a[140:143], v[228:231]
    s_waitcnt lgkmcnt(5)
    ds_read_b128 a[228:231], v243 offset:256
    v_mfma_f32_16x16x32_bf16 v[204:207], v[132:135], v[168:171], v[204:207]
    ds_read_b128 a[232:235], v242 offset:6144
    ds_read_b128 a[236:239], v243 offset:6144
    v_mfma_f32_16x16x32_bf16 v[204:207], v[134:137], v[170:173], v[204:207]
    v_lshrrev_b32 v249, 1, v232
    v_or_b32 v249, s66, v249
    v_cvt_pk_bf16_f32 v79, v228, v229
    v_cvt_pk_bf16_f32 v82, v230, v231
    v_mov_b32 v253, v249
    v_xor_b32 v249, v249, v234
    v_lshl_add_u32 v249, v249, 4, v235
    s_waitcnt lgkmcnt(7)
    v_mfma_f32_16x16x32_bf16 v[236:239], a[144:147], a[240:243], 0
    v_and_b32 v235, 1, v232
    v_lshl_add_u32 v249, v235, 3, v249
    v_mfma_f32_16x16x32_bf16 v[228:231], a[168:171], a[240:243], 0
    v_add_u32 v249, 0x16800, v249
    s_waitcnt lgkmcnt(6)
    v_mfma_f32_16x16x32_bf16 v[236:239], a[148:151], a[244:247], v[236:239]
    v_xor_b32 v250, s67, v232
    v_mul_u32_u24 v250, 0x300, v250
    v_mfma_f32_16x16x32_bf16 v[228:231], a[172:175], a[244:247], v[228:231]
    s_waitcnt lgkmcnt(5)
    s_mul_i32 s67, s28, 0x600
    s_add_u32 s67, s67, 0x16800
    v_mfma_f32_16x16x32_bf16 v[236:239], a[152:155], a[216:219], v[236:239]
    s_waitcnt lgkmcnt(4)
    v_mul_u32_u24 v232, 0x180, v232
    v_add_u32 v232, s67, v232
    v_mfma_f32_16x16x32_bf16 v[236:239], a[156:159], a[220:223], v[236:239]
    s_waitcnt lgkmcnt(3)
    v_lshlrev_b32 v235, 3, v235
    v_xor_b32 v252, v233, v235
    v_mfma_f32_16x16x32_bf16 v[236:239], a[160:163], a[224:227], v[236:239]
    s_waitcnt lgkmcnt(2)
    v_xor_b32 v252, v252, v253
    v_lshl_add_u32 v252, v252, 4, v232
    v_mfma_f32_16x16x32_bf16 v[236:239], a[164:167], a[228:231], v[236:239]
    v_xor_b32 v253, v253, v234
    v_lshl_add_u32 v253, v253, 4, v232
    v_mfma_f32_16x16x32_bf16 v[228:231], a[176:179], a[216:219], v[228:231]
    v_and_b32 v234, 1, v233
    v_lshl_add_u32 v253, v234, 3, v253
    v_mfma_f32_16x16x32_bf16 v[228:231], a[180:183], a[220:223], v[228:231]
    v_lshl_add_u32 v251, v233, 3, v250
    v_xor_b32 v233, v233, v235
    v_mfma_f32_16x16x32_bf16 v[228:231], a[184:187], a[224:227], v[228:231]
    v_cvt_pk_bf16_f32 v236, v236, v237
    v_cvt_pk_bf16_f32 v237, v238, v239
    v_mfma_f32_16x16x32_bf16 v[228:231], a[188:191], a[228:231], v[228:231]
    ds_write_b64 v249, v[236:237] offset:0
    s_waitcnt lgkmcnt(2)
    v_mfma_f32_16x16x32_bf16 v[236:239], a[144:147], a[232:235], 0
    s_waitcnt lgkmcnt(1)
    v_lshl_add_u32 v250, v233, 4, v250
    v_sub_f32 v208, v208, v248
    v_mfma_f32_16x16x32_bf16 v[232:235], a[192:195], a[240:243], 0
    ds_read_b128 a[240:243], v242 offset:6272
    v_cvt_pk_bf16_f32 v228, v228, v229
    v_mfma_f32_16x16x32_bf16 v[232:235], a[196:199], a[244:247], v[232:235]
    ds_read_b128 a[244:247], v243 offset:6272
    v_cvt_pk_bf16_f32 v229, v230, v231
    v_mfma_f32_16x16x32_bf16 v[232:235], a[200:203], a[216:219], v[232:235]
    ds_write_b64 v249, v[228:229] offset:128
    v_mfma_f32_16x16x32_bf16 v[232:235], a[204:207], a[220:223], v[232:235]
    ds_read_b128 a[216:219], v242 offset:6400
    ds_read_b128 a[220:223], v243 offset:6400
    v_mfma_f32_16x16x32_bf16 v[232:235], a[208:211], a[224:227], v[232:235]
    ds_read_b128 a[224:227], v242 offset:12288
    v_sub_f32 v209, v209, v248
    v_mfma_f32_16x16x32_bf16 v[232:235], a[212:215], a[228:231], v[232:235]
    ds_read_b128 a[228:231], v243 offset:12288
    v_sub_f32 v210, v210, v248
    v_mfma_f32_16x16x32_bf16 v[236:239], a[148:151], a[236:239], v[236:239]
    v_exp_f32 v208, v208
    v_mfma_f32_16x16x32_bf16 v[228:231], a[168:171], a[232:235], 0
    v_exp_f32 v209, v209
    v_mfma_f32_16x16x32_bf16 v[228:231], a[172:175], a[236:239], v[228:231]
    s_waitcnt lgkmcnt(6)
    v_cvt_pk_bf16_f32 v232, v232, v233
    v_cvt_pk_bf16_f32 v233, v234, v235
    v_mfma_f32_16x16x32_bf16 v[236:239], a[152:155], a[240:243], v[236:239]
    ds_write_b64 v249, v[232:233] offset:256
    v_mfma_f32_16x16x32_bf16 v[228:231], a[176:179], a[240:243], v[228:231]
    s_waitcnt lgkmcnt(6)
    v_exp_f32 v210, v210
    v_mfma_f32_16x16x32_bf16 v[236:239], a[156:159], a[244:247], v[236:239]
    v_sub_f32 v211, v211, v248
    v_cvt_pk_bf16_f32 v189, v208, v209
    v_mfma_f32_16x16x32_bf16 v[228:231], a[180:183], a[244:247], v[228:231]
    s_waitcnt lgkmcnt(4)
    v_exp_f32 v211, v211
    v_mfma_f32_16x16x32_bf16 v[212:215], v[0:3], v[188:191], 0
    v_cvt_pk_bf16_f32 v192, v210, v211
    v_sub_f32 v196, v196, v248
    v_mfma_f32_16x16x32_bf16 v[216:219], v[30:33], v[188:191], 0
    ds_read_b128 v[208:211], v244 offset:320
    v_sub_f32 v197, v197, v248
    v_mfma_f32_16x16x32_bf16 v[220:223], v[60:63], v[188:191], 0
    v_exp_f32 v196, v196
    v_mfma_f32_16x16x32_bf16 v[224:227], a[248:251], v[188:191], 0
    v_exp_f32 v197, v197
    v_mfma_f32_16x16x32_bf16 v[236:239], a[160:163], a[216:219], v[236:239]
    s_waitcnt lgkmcnt(4)
    v_sub_f32 v198, v198, v248
    v_sub_f32 v199, v199, v248
    v_mfma_f32_16x16x32_bf16 v[236:239], a[164:167], a[220:223], v[236:239]
    v_exp_f32 v198, v198
    v_mfma_f32_16x16x32_bf16 v[228:231], a[184:187], a[216:219], v[228:231]
    v_exp_f32 v199, v199
    v_mfma_f32_16x16x32_bf16 v[228:231], a[188:191], a[220:223], v[228:231]
    v_cvt_pk_bf16_f32 v180, v196, v197
    v_cvt_pk_bf16_f32 v183, v198, v199
    v_mfma_f32_16x16x32_bf16 v[232:235], a[192:195], a[232:235], 0
    ds_read_b128 a[232:235], v242 offset:12416
    v_cvt_pk_bf16_f32 v236, v236, v237
    v_mfma_f32_16x16x32_bf16 v[232:235], a[196:199], a[236:239], v[232:235]
    ds_read_b128 a[236:239], v243 offset:12416
    v_cvt_pk_bf16_f32 v237, v238, v239
    v_mfma_f32_16x16x32_bf16 v[232:235], a[200:203], a[240:243], v[232:235]
    ds_write_b64 v249, v[236:237] offset:6144
    v_mfma_f32_16x16x32_bf16 v[232:235], a[204:207], a[244:247], v[232:235]
    ds_read_b128 a[240:243], v242 offset:12544
    v_cvt_pk_bf16_f32 v228, v228, v229
    v_mfma_f32_16x16x32_bf16 v[232:235], a[208:211], a[216:219], v[232:235]
    ds_read_b128 a[244:247], v243 offset:12544
    v_cvt_pk_bf16_f32 v229, v230, v231
    v_mfma_f32_16x16x32_bf16 v[232:235], a[212:215], a[220:223], v[232:235]
    s_waitcnt lgkmcnt(5)
    v_add_u32 v242, 0xfffe9800, v242
    v_add_u32 v243, 0xfffe9800, v243
    v_mfma_f32_16x16x32_bf16 v[208:211], v[162:165], v[168:171], v[208:211]
    ds_write_b64 v249, v[228:229] offset:6272
    v_mfma_f32_16x16x32_bf16 v[208:211], v[164:167], v[170:173], v[208:211]
    ds_read_b128 a[216:219], v242 offset:6144
    ds_read_b128 a[220:223], v243 offset:6144
    v_mfma_f32_16x16x32_bf16 v[236:239], a[144:147], a[224:227], 0
    ds_read_b128 v[196:199], v245 offset:320
    v_cvt_pk_bf16_f32 v232, v232, v233
    v_mfma_f32_16x16x32_bf16 v[236:239], a[148:151], a[228:231], v[236:239]
    s_waitcnt lgkmcnt(8)
    v_cvt_pk_bf16_f32 v233, v234, v235
    v_sub_f32 v200, v200, v248
    v_mfma_f32_16x16x32_bf16 v[236:239], a[152:155], a[232:235], v[236:239]
    ds_write_b64 v249, v[232:233] offset:6400
    v_mfma_f32_16x16x32_bf16 v[228:231], a[168:171], a[224:227], 0
    s_waitcnt lgkmcnt(8)
    v_exp_f32 v200, v200
    v_mfma_f32_16x16x32_bf16 v[236:239], a[156:159], a[236:239], v[236:239]
    s_waitcnt lgkmcnt(6)
    v_sub_f32 v201, v201, v248
    v_sub_f32 v202, v202, v248
    v_mfma_f32_16x16x32_bf16 v[236:239], a[160:163], a[240:243], v[236:239]
    s_waitcnt lgkmcnt(5)
    v_exp_f32 v201, v201
    v_mfma_f32_16x16x32_bf16 v[236:239], a[164:167], a[244:247], v[236:239]
    v_exp_f32 v202, v202
    v_mfma_f32_16x16x32_bf16 v[228:231], a[172:175], a[228:231], v[228:231]
    v_sub_f32 v203, v203, v248
    v_cvt_pk_bf16_f32 v194, v200, v201
    v_mfma_f32_16x16x32_bf16 v[228:231], a[176:179], a[232:235], v[228:231]
    v_exp_f32 v203, v203
    v_mfma_f32_16x16x32_bf16 v[228:231], a[180:183], a[236:239], v[228:231]
    s_waitcnt lgkmcnt(1)
    v_cvt_pk_bf16_f32 v236, v236, v237
    v_cvt_pk_bf16_f32 v237, v238, v239
    v_mfma_f32_16x16x32_bf16 v[196:199], v[138:141], v[168:171], v[196:199]
    ds_write_b64 v249, v[236:237] offset:12288
    v_mfma_f32_16x16x32_bf16 v[196:199], v[140:143], v[170:173], v[196:199]
    v_cvt_pk_bf16_f32 v181, v202, v203
    v_sub_f32 v204, v204, v248
    v_mfma_f32_16x16x32_bf16 v[228:231], a[184:187], a[240:243], v[228:231]
    ds_read_b128 v[200:203], v246 offset:320
    v_sub_f32 v205, v205, v248
    v_mfma_f32_16x16x32_bf16 v[228:231], a[188:191], a[244:247], v[228:231]
    v_exp_f32 v204, v204
    v_mfma_f32_16x16x32_bf16 v[232:235], a[192:195], a[224:227], 0
    ds_read_b128 a[224:227], v242 offset:6272
    v_sub_f32 v206, v206, v248
    v_mfma_f32_16x16x32_bf16 v[232:235], a[196:199], a[228:231], v[232:235]
    ds_read_b128 a[228:231], v243 offset:6272
    v_sub_f32 v207, v207, v248
    v_mfma_f32_16x16x32_bf16 v[232:235], a[200:203], a[232:235], v[232:235]
    ds_read_b128 a[232:235], v242 offset:6400
    v_cvt_pk_bf16_f32 v228, v228, v229
    v_mfma_f32_16x16x32_bf16 v[232:235], a[204:207], a[236:239], v[232:235]
    ds_read_b128 a[236:239], v243 offset:6400
    v_cvt_pk_bf16_f32 v229, v230, v231
    v_mfma_f32_16x16x32_bf16 v[232:235], a[208:211], a[240:243], v[232:235]
    ds_write_b64 v249, v[228:229] offset:12416
    v_mfma_f32_16x16x32_bf16 v[232:235], a[212:215], a[244:247], v[232:235]
    ds_read_b128 a[240:243], v240 offset:6144
    ds_read_b128 a[244:247], v241 offset:6144
    v_mfma_f32_16x16x32_bf16 v[236:239], a[144:147], a[216:219], 0
    s_waitcnt lgkmcnt(7)
    v_exp_f32 v205, v205
    v_mfma_f32_16x16x32_bf16 v[200:203], v[144:147], v[168:171], v[200:203]
    ds_read_b64 v[168:169], v247 offset:36864
    v_cvt_pk_bf16_f32 v195, v204, v205
    v_mfma_f32_16x16x32_bf16 v[200:203], v[146:149], v[170:173], v[200:203]
    ds_read_b64 v[170:171], v247 offset:36992
    v_cvt_pk_bf16_f32 v232, v232, v233
    v_mfma_f32_16x16x32_bf16 v[212:215], v[4:7], v[192:195], v[212:215]
    ds_read_b64 v[172:173], v247 offset:37120
    v_cvt_pk_bf16_f32 v233, v234, v235
    v_mfma_f32_16x16x32_bf16 v[216:219], v[34:37], v[192:195], v[216:219]
    ds_write_b64 v249, v[232:233] offset:12544
    v_mfma_f32_16x16x32_bf16 v[220:223], v[64:67], v[192:195], v[220:223]
    v_exp_f32 v206, v206
    v_mfma_f32_16x16x32_bf16 v[224:227], a[248:251], v[192:195], v[224:227]
    v_exp_f32 v207, v207
    v_mfma_f32_16x16x32_bf16 v[236:239], a[148:151], a[220:223], v[236:239]
    s_waitcnt lgkmcnt(10)
    v_cvt_pk_bf16_f32 v182, v206, v207
    v_sub_f32 v208, v208, v248
    v_mfma_f32_16x16x32_bf16 v[236:239], a[152:155], a[224:227], v[236:239]
    ds_read_b128 v[204:207], v244 offset:0
    v_sub_f32 v209, v209, v248
    v_mfma_f32_16x16x32_bf16 v[212:215], v[8:11], v[180:183], v[212:215]
    s_waitcnt lgkmcnt(9)
    v_exp_f32 v208, v208
    v_mfma_f32_16x16x32_bf16 v[216:219], v[38:41], v[180:183], v[216:219]
    v_exp_f32 v209, v209
    v_mfma_f32_16x16x32_bf16 v[220:223], v[68:71], v[180:183], v[220:223]
    v_cvt_pk_bf16_f32 v186, v208, v209
    v_sub_f32 v196, v196, v248
    v_mfma_f32_16x16x32_bf16 v[224:227], a[248:251], v[180:183], v[224:227]
    ds_read_b128 v[208:211], v245 offset:0
    s_waitcnt lgkmcnt(2)
    v_mfma_f32_16x16x32_bf16 v[236:239], a[156:159], a[228:231], v[236:239]
    s_barrier
    ds_read_b128 a[252:255], v252 offset:0
    v_mfma_f32_16x16x32_bf16 v[236:239], a[160:163], a[232:235], v[236:239]
    ds_read_b64 v[254:255], v253 offset:256
    v_sub_f32 v197, v197, v248
    v_mfma_f32_16x16x32_bf16 v[236:239], a[164:167], a[236:239], v[236:239]
    v_exp_f32 v196, v196
    v_mfma_f32_16x16x32_bf16 v[228:231], a[168:171], a[216:219], 0
    v_exp_f32 v197, v197
    v_mfma_f32_16x16x32_bf16 v[228:231], a[172:175], a[220:223], v[228:231]
    s_waitcnt lgkmcnt(3)
    v_cvt_pk_bf16_f32 v184, v196, v197
    v_sub_f32 v200, v200, v248
    v_mfma_f32_16x16x32_bf16 v[204:207], v[156:159], v[174:177], v[204:207]
    ds_read_b128 v[196:199], v246 offset:0
    v_cvt_pk_bf16_f32 v236, v236, v237
    v_mfma_f32_16x16x32_bf16 v[204:207], v[158:161], v[176:179], v[204:207]
    v_cvt_pk_bf16_f32 v237, v238, v239
    v_sub_f32 v201, v201, v248
    v_mfma_f32_16x16x32_bf16 v[228:231], a[176:179], a[224:227], v[228:231]
    ds_write_b64 v249, v[236:237] offset:18432
    v_mfma_f32_16x16x32_bf16 v[228:231], a[180:183], a[228:231], v[228:231]
    s_waitcnt lgkmcnt(4)
    s_waitcnt lgkmcnt(3)
    v_mfma_f32_16x16x32_bf16 v[208:211], v[96:99], v[174:177], v[208:211]
    buffer_store_dwordx4 a[252:255], v250, s[20:23], s55 offen nt
    v_mfma_f32_16x16x32_bf16 v[208:211], v[98:101], v[176:179], v[208:211]
    s_waitcnt lgkmcnt(2)
    ds_read_b128 a[252:255], v252 offset:6144
    v_mfma_f32_16x16x32_bf16 v[228:231], a[184:187], a[232:235], v[228:231]
    v_exp_f32 v200, v200
    v_mfma_f32_16x16x32_bf16 v[228:231], a[188:191], a[236:239], v[228:231]
    buffer_store_dwordx2 v[254:255], v251, s[20:23], s55 offen offset:256 nt
    v_mfma_f32_16x16x32_bf16 v[232:235], a[192:195], a[216:219], 0
    ds_read_b128 a[216:219], v240 offset:6272
    ds_read_b64 v[254:255], v253 offset:6400
    v_mfma_f32_16x16x32_bf16 v[232:235], a[196:199], a[220:223], v[232:235]
    ds_read_b128 a[220:223], v241 offset:6272
    s_mul_i32 s55, s31, 3
    v_mfma_f32_16x16x32_bf16 v[232:235], a[200:203], a[224:227], v[232:235]
    ds_read_b128 a[224:227], v240 offset:6400
    v_cvt_pk_bf16_f32 v228, v228, v229
    v_mfma_f32_16x16x32_bf16 v[232:235], a[204:207], a[228:231], v[232:235]
    ds_read_b128 a[228:231], v241 offset:6400
    v_cvt_pk_bf16_f32 v229, v230, v231
    v_mfma_f32_16x16x32_bf16 v[232:235], a[208:211], a[232:235], v[232:235]
    ds_write_b64 v249, v[228:229] offset:18560
    v_mfma_f32_16x16x32_bf16 v[232:235], a[212:215], a[236:239], v[232:235]
    ds_read_b128 a[232:235], v242 offset:12288
    ds_read_b128 a[236:239], v243 offset:12288
    v_mfma_f32_16x16x32_bf16 v[236:239], a[0:3], a[240:243], 0
    s_waitcnt lgkmcnt(8)
    s_add_u32 s54, s54, s55
    s_add_u32 s54, s54, s32
    v_mfma_f32_16x16x32_bf16 v[196:199], v[132:135], v[174:177], v[196:199]
    buffer_store_dwordx4 a[252:255], v250, s[20:23], s57 offen nt
    v_mfma_f32_16x16x32_bf16 v[196:199], v[134:137], v[176:179], v[196:199]
    s_waitcnt lgkmcnt(6)
    v_cvt_pk_bf16_f32 v232, v232, v233
    v_cvt_pk_bf16_f32 v233, v234, v235
    v_mfma_f32_16x16x32_bf16 v[236:239], a[4:7], a[244:247], v[236:239]
    ds_write_b64 v249, v[232:233] offset:18688
    v_mfma_f32_16x16x32_bf16 v[236:239], a[8:11], a[216:219], v[236:239]
    buffer_store_dwordx2 v[254:255], v251, s[20:23], s57 offen offset:256 nt
    v_mfma_f32_16x16x32_bf16 v[228:231], a[24:27], a[240:243], 0
    ds_read_b128 a[252:255], v252 offset:12288
    ds_read_b64 v[254:255], v253 offset:12544
    v_mfma_f32_16x16x32_bf16 v[228:231], a[28:31], a[244:247], v[228:231]
    s_mul_i32 s57, s31, 7
    s_add_u32 s56, s56, s57
    s_add_u32 s56, s56, s32
    v_mfma_f32_16x16x32_bf16 v[228:231], a[32:35], a[216:219], v[228:231]
    s_add_u32 s55, s28, 7
    s_mul_i32 s55, s55, s30
    s_add_u32 s57, s28, 11
    v_mfma_f32_16x16x32_bf16 v[232:235], a[48:51], a[240:243], 0
    s_mul_i32 s57, s57, s30
    v_exp_f32 v201, v201
    v_mfma_f32_16x16x32_bf16 v[232:235], a[52:55], a[244:247], v[232:235]
    s_waitcnt lgkmcnt(6)
    v_cvt_pk_bf16_f32 v185, v200, v201
    v_max_f32 v248, v204, v205
    v_mfma_f32_16x16x32_bf16 v[236:239], a[12:15], a[220:223], v[236:239]
    ds_read_b128 v[200:203], v244 offset:64
    v_max3_f32 v248, v248, v206, v207
    v_mfma_f32_16x16x32_bf16 v[212:215], v[12:15], v[184:187], v[212:215]
    ds_read_b128 v[204:207], v245 offset:64
    v_max3_f32 v248, v248, v208, v209
    v_mfma_f32_16x16x32_bf16 v[216:219], v[42:45], v[184:187], v[216:219]
    v_max3_f32 v248, v248, v210, v211
    v_max3_f32 v248, v248, v196, v197
    v_mfma_f32_16x16x32_bf16 v[220:223], v[72:75], v[184:187], v[220:223]
    ds_read_b128 v[208:211], v246 offset:64
    s_waitcnt lgkmcnt(4)
    v_mfma_f32_16x16x32_bf16 v[224:227], a[248:251], v[184:187], v[224:227]
    buffer_store_dwordx4 a[252:255], v250, s[20:23], s52 offen nt
    v_mfma_f32_16x16x32_bf16 v[236:239], a[16:19], a[224:227], v[236:239]
    s_waitcnt lgkmcnt(3)
    v_max3_f32 v248, v248, v198, v199
    v_mfma_f32_16x16x32_bf16 v[236:239], a[20:23], a[228:231], v[236:239]
    ds_read_b128 v[196:199], v244 offset:128
    v_mfma_f32_16x16x32_bf16 v[228:231], a[36:39], a[220:223], v[228:231]
    buffer_store_dwordx2 v[254:255], v251, s[20:23], s52 offen offset:256 nt
    v_mfma_f32_16x16x32_bf16 v[228:231], a[40:43], a[224:227], v[228:231]
    s_mul_i32 s52, s31, 11
    s_add_u32 s51, s51, s52
    s_add_u32 s51, s51, s32
    v_mfma_f32_16x16x32_bf16 v[228:231], a[44:47], a[228:231], v[228:231]
    s_add_u32 s52, s28, 11
    s_mul_i32 s52, s52, s30
    s_waitcnt lgkmcnt(2)
    v_mfma_f32_16x16x32_bf16 v[200:203], v[162:165], v[174:177], v[200:203]
    v_rcp_f32 v225, v224
    v_mfma_f32_16x16x32_bf16 v[200:203], v[164:167], v[176:179], v[200:203]
    s_waitcnt lgkmcnt(1)
    v_mul_f32 v212, v212, v225
    v_mul_f32 v213, v213, v225
    v_mfma_f32_16x16x32_bf16 v[204:207], v[138:141], v[174:177], v[204:207]
    v_mul_f32 v214, v214, v225
    v_mul_f32 v215, v215, v225
    v_mfma_f32_16x16x32_bf16 v[204:207], v[140:143], v[176:179], v[204:207]
    v_cvt_pk_bf16_f32 v212, v212, v213
    v_cvt_pk_bf16_f32 v213, v214, v215
    v_mfma_f32_16x16x32_bf16 v[208:211], v[144:147], v[174:177], v[208:211]
    ds_write_b64 v247, v[212:213] offset:24576
    v_mfma_f32_16x16x32_bf16 v[208:211], v[146:149], v[176:179], v[208:211]
    s_waitcnt lgkmcnt(1)
    v_mul_f32 v216, v216, v225
    v_mul_f32 v217, v217, v225
    v_mfma_f32_16x16x32_bf16 v[196:199], v[102:105], v[174:177], v[196:199]
    v_mul_f32 v218, v218, v225
    v_mul_f32 v219, v219, v225
    v_mfma_f32_16x16x32_bf16 v[196:199], v[104:107], v[176:179], v[196:199]
    v_cvt_pk_bf16_f32 v216, v216, v217
    v_cvt_pk_bf16_f32 v217, v218, v219
    v_mfma_f32_16x16x32_bf16 v[232:235], a[56:59], a[216:219], v[232:235]
    ds_write_b64 v247, v[216:217] offset:24704
    v_mfma_f32_16x16x32_bf16 v[232:235], a[60:63], a[220:223], v[232:235]
    v_mul_f32 v220, v220, v225
    v_mul_f32 v221, v221, v225
    v_mfma_f32_16x16x32_bf16 v[232:235], a[64:67], a[224:227], v[232:235]
    v_mul_f32 v222, v222, v225
    v_mul_f32 v223, v223, v225
    v_mfma_f32_16x16x32_bf16 v[232:235], a[68:71], a[228:231], v[232:235]
    v_cvt_pk_bf16_f32 v220, v220, v221
    v_cvt_pk_bf16_f32 v221, v222, v223
    ds_write_b64 v247, v[220:221] offset:24832
    v_max3_f32 v248, v248, v200, v201
    v_max3_f32 v248, v248, v202, v203
    ds_read_b128 v[200:203], v245 offset:128
    v_max3_f32 v248, v248, v204, v205
    v_max3_f32 v248, v248, v206, v207
    ds_read_b128 v[204:207], v246 offset:128
    v_max3_f32 v248, v248, v208, v209
    v_max3_f32 v248, v248, v210, v211
    ds_read_b128 v[208:211], v244 offset:0
    v_max3_f32 v248, v248, v196, v197
    ds_read_b128 v[196:199], v245 offset:0
    s_waitcnt lgkmcnt(3)
    v_mfma_f32_16x16x32_bf16 v[200:203], v[114:117], v[174:177], v[200:203]
    v_mfma_f32_16x16x32_bf16 v[200:203], v[116:119], v[176:179], v[200:203]
    s_waitcnt lgkmcnt(2)
    v_mfma_f32_16x16x32_bf16 v[204:207], v[150:153], v[174:177], v[204:207]
    s_waitcnt lgkmcnt(1)
    v_mfma_f32_16x16x32_bf16 v[204:207], v[152:155], v[176:179], v[204:207]
    s_waitcnt lgkmcnt(0)
    v_mfma_f32_16x16x32_bf16 v[208:211], v[156:159], v[174:177], v[208:211]
    v_cvt_pk_bf16_f32 v156, v236, v237
    v_cvt_pk_bf16_f32 v157, v238, v239
    v_mfma_f32_16x16x32_bf16 v[208:211], v[158:161], v[176:179], v[208:211]
    v_cvt_pk_bf16_f32 v158, v228, v229
    v_cvt_pk_bf16_f32 v159, v230, v231
    v_mfma_f32_16x16x32_bf16 v[196:199], v[96:99], v[174:177], v[196:199]
    v_cvt_pk_bf16_f32 v160, v232, v233
    v_cvt_pk_bf16_f32 v161, v234, v235
    v_mfma_f32_16x16x32_bf16 v[196:199], v[98:101], v[176:179], v[196:199]
    v_max3_f32 v248, v248, v200, v201
    v_max3_f32 v248, v248, v204, v205
    v_mfma_f32_16x16x32_bf16 v[236:239], a[240:243], a[72:75], 0
    ds_read_b128 v[200:203], v246 offset:0
    ds_read_b128 v[204:207], v244 offset:64
    v_mfma_f32_16x16x32_bf16 v[236:239], a[244:247], a[76:79], v[236:239]
    v_mov_b32 v225, v248
    v_mfma_f32_16x16x32_bf16 v[236:239], a[216:219], a[80:83], v[236:239]
    v_mfma_f32_16x16x32_bf16 v[236:239], a[220:223], a[84:87], v[236:239]
    v_permlane16_swap_b32 v248, v225
    v_max_f32 v248, v248, v225
    v_mfma_f32_16x16x32_bf16 v[236:239], a[224:227], a[88:91], v[236:239]
    v_mov_b32 v225, v248
    v_mfma_f32_16x16x32_bf16 v[236:239], a[228:231], a[92:95], v[236:239]
    v_mfma_f32_16x16x32_bf16 v[228:231], a[240:243], a[96:99], 0
    v_permlane32_swap_b32 v248, v225
    v_max_f32 v248, v248, v225
    v_mfma_f32_16x16x32_bf16 v[228:231], a[244:247], a[100:103], v[228:231]
    v_sub_f32 v208, v208, v248
    v_sub_f32 v209, v209, v248
    v_mfma_f32_16x16x32_bf16 v[228:231], a[216:219], a[104:107], v[228:231]
    v_exp_f32 v208, v208
    v_mfma_f32_16x16x32_bf16 v[228:231], a[220:223], a[108:111], v[228:231]
    s_waitcnt lgkmcnt(1)
    v_cvt_pk_bf16_f32 v25, v236, v237
    v_cvt_pk_bf16_f32 v28, v238, v239
    v_mfma_f32_16x16x32_bf16 v[200:203], v[132:135], v[174:177], v[200:203]
    s_waitcnt lgkmcnt(0)
    v_exp_f32 v209, v209
    v_mfma_f32_16x16x32_bf16 v[200:203], v[134:137], v[176:179], v[200:203]
    v_sub_f32 v210, v210, v248
    v_sub_f32 v211, v211, v248
    v_mfma_f32_16x16x32_bf16 v[204:207], v[162:165], v[174:177], v[204:207]
    v_exp_f32 v210, v210
    v_mfma_f32_16x16x32_bf16 v[204:207], v[164:167], v[176:179], v[204:207]
    v_exp_f32 v211, v211
    v_mfma_f32_16x16x32_bf16 v[228:231], a[224:227], a[112:115], v[228:231]
    v_cvt_pk_bf16_f32 v190, v208, v209
    v_cvt_pk_bf16_f32 v193, v210, v211
    v_mfma_f32_16x16x32_bf16 v[228:231], a[228:231], a[116:119], v[228:231]
    ds_read_b128 v[208:211], v245 offset:64
    v_sub_f32 v196, v196, v248
    v_mfma_f32_16x16x32_bf16 v[232:235], a[240:243], a[120:123], 0
    ds_read_b128 a[240:243], v242 offset:12416
    v_sub_f32 v197, v197, v248
    v_mfma_f32_16x16x32_bf16 v[232:235], a[244:247], a[124:127], v[232:235]
    ds_read_b128 a[244:247], v243 offset:12416
    v_sub_f32 v198, v198, v248
    v_mfma_f32_16x16x32_bf16 v[232:235], a[216:219], a[128:131], v[232:235]
    v_cvt_pk_bf16_f32 v55, v228, v229
    v_cvt_pk_bf16_f32 v58, v230, v231
    v_mfma_f32_16x16x32_bf16 v[232:235], a[220:223], a[132:135], v[232:235]
    ds_read_b128 a[216:219], v242 offset:12544
    ds_read_b128 a[220:223], v243 offset:12544
    v_mfma_f32_16x16x32_bf16 v[232:235], a[224:227], a[136:139], v[232:235]
    ds_read_b128 a[224:227], v242 offset:18432
    v_sub_f32 v199, v199, v248
    v_mfma_f32_16x16x32_bf16 v[232:235], a[228:231], a[140:143], v[232:235]
    ds_read_b128 a[228:231], v243 offset:18432
    v_sub_f32 v200, v200, v248
    v_mfma_f32_16x16x32_bf16 v[236:239], a[144:147], a[232:235], 0
    v_exp_f32 v196, v196
    v_mfma_f32_16x16x32_bf16 v[236:239], a[148:151], a[236:239], v[236:239]
    v_exp_f32 v197, v197
    v_mfma_f32_16x16x32_bf16 v[228:231], a[168:171], a[232:235], 0
    s_waitcnt lgkmcnt(6)
    v_cvt_pk_bf16_f32 v85, v232, v233
    v_cvt_pk_bf16_f32 v88, v234, v235
    v_mfma_f32_16x16x32_bf16 v[208:211], v[138:141], v[174:177], v[208:211]
    s_waitcnt lgkmcnt(5)
    v_exp_f32 v198, v198
    v_mfma_f32_16x16x32_bf16 v[208:211], v[140:143], v[176:179], v[208:211]
    v_exp_f32 v199, v199
    v_mfma_f32_16x16x32_bf16 v[236:239], a[152:155], a[240:243], v[236:239]
    s_waitcnt lgkmcnt(4)
    v_cvt_pk_bf16_f32 v188, v196, v197
    v_cvt_pk_bf16_f32 v191, v198, v199
    v_mfma_f32_16x16x32_bf16 v[236:239], a[156:159], a[244:247], v[236:239]
    ds_read_b128 v[196:199], v246 offset:64
    v_sub_f32 v201, v201, v248
    v_mfma_f32_16x16x32_bf16 v[228:231], a[172:175], a[236:239], v[228:231]
    s_waitcnt lgkmcnt(4)
    v_exp_f32 v200, v200
    v_mfma_f32_16x16x32_bf16 v[236:239], a[160:163], a[216:219], v[236:239]
    s_waitcnt lgkmcnt(3)
    v_exp_f32 v201, v201
    v_mfma_f32_16x16x32_bf16 v[236:239], a[164:167], a[220:223], v[236:239]
    v_sub_f32 v202, v202, v248
    v_sub_f32 v203, v203, v248
    v_mfma_f32_16x16x32_bf16 v[228:231], a[176:179], a[240:243], v[228:231]
    v_exp_f32 v202, v202
    v_mfma_f32_16x16x32_bf16 v[228:231], a[180:183], a[244:247], v[228:231]
    v_exp_f32 v203, v203
    v_mfma_f32_16x16x32_bf16 v[228:231], a[184:187], a[216:219], v[228:231]
    v_cvt_pk_bf16_f32 v189, v200, v201
    v_cvt_pk_bf16_f32 v236, v236, v237
    v_mfma_f32_16x16x32_bf16 v[228:231], a[188:191], a[220:223], v[228:231]
    v_cvt_pk_bf16_f32 v237, v238, v239
    v_cvt_pk_bf16_f32 v192, v202, v203
    v_mfma_f32_16x16x32_bf16 v[212:215], v[6:9], v[188:191], 0
    ds_write_b64 v249, v[236:237] offset:24576
    v_mfma_f32_16x16x32_bf16 v[216:219], v[36:39], v[188:191], 0
    ds_read_b128 v[200:203], v244 offset:128
    v_sub_f32 v204, v204, v248
    v_mfma_f32_16x16x32_bf16 v[220:223], v[66:69], v[188:191], 0
    s_waitcnt lgkmcnt(2)
    v_cvt_pk_bf16_f32 v228, v228, v229
    v_cvt_pk_bf16_f32 v229, v230, v231
    v_mfma_f32_16x16x32_bf16 v[224:227], a[248:251], v[188:191], 0
    ds_write_b64 v249, v[228:229] offset:24704
    v_mfma_f32_16x16x32_bf16 v[196:199], v[144:147], v[174:177], v[196:199]
    v_exp_f32 v204, v204
    v_mfma_f32_16x16x32_bf16 v[196:199], v[146:149], v[176:179], v[196:199]
    v_sub_f32 v205, v205, v248
    v_sub_f32 v206, v206, v248
    v_mfma_f32_16x16x32_bf16 v[232:235], a[192:195], a[232:235], 0
    ds_read_b128 a[232:235], v242 offset:18560
    v_sub_f32 v207, v207, v248
    v_mfma_f32_16x16x32_bf16 v[232:235], a[196:199], a[236:239], v[232:235]
    ds_read_b128 a[236:239], v243 offset:18560
    v_sub_f32 v208, v208, v248
    v_mfma_f32_16x16x32_bf16 v[232:235], a[200:203], a[240:243], v[232:235]
    ds_read_b128 a[240:243], v242 offset:18688
    v_sub_f32 v209, v209, v248
    v_mfma_f32_16x16x32_bf16 v[232:235], a[204:207], a[244:247], v[232:235]
    ds_read_b128 a[244:247], v243 offset:18688
    v_sub_f32 v210, v210, v248
    v_mfma_f32_16x16x32_bf16 v[232:235], a[208:211], a[216:219], v[232:235]
    ds_read_b128 a[216:219], v242 offset:0
    v_sub_f32 v211, v211, v248
    v_mfma_f32_16x16x32_bf16 v[232:235], a[212:215], a[220:223], v[232:235]
    ds_read_b128 a[220:223], v243 offset:0
    v_sub_f32 v196, v196, v248
    v_mfma_f32_16x16x32_bf16 v[236:239], a[144:147], a[224:227], 0
    s_waitcnt lgkmcnt(7)
    v_exp_f32 v205, v205
    v_mfma_f32_16x16x32_bf16 v[200:203], v[102:105], v[174:177], v[200:203]
    v_exp_f32 v206, v206
    v_mfma_f32_16x16x32_bf16 v[200:203], v[104:107], v[176:179], v[200:203]
    v_cvt_pk_bf16_f32 v232, v232, v233
    v_cvt_pk_bf16_f32 v233, v234, v235
    v_mfma_f32_16x16x32_bf16 v[236:239], a[148:151], a[228:231], v[236:239]
    ds_write_b64 v249, v[232:233] offset:24832
    v_mfma_f32_16x16x32_bf16 v[228:231], a[168:171], a[224:227], 0
    s_waitcnt lgkmcnt(6)
    v_exp_f32 v207, v207
    v_mfma_f32_16x16x32_bf16 v[236:239], a[152:155], a[232:235], v[236:239]
    s_waitcnt lgkmcnt(5)
    v_cvt_pk_bf16_f32 v180, v204, v205
    v_cvt_pk_bf16_f32 v183, v206, v207
    v_mfma_f32_16x16x32_bf16 v[236:239], a[156:159], a[236:239], v[236:239]
    ds_read_b128 v[204:207], v245 offset:128
    v_sub_f32 v197, v197, v248
    v_mfma_f32_16x16x32_bf16 v[228:231], a[172:175], a[228:231], v[228:231]
    s_waitcnt lgkmcnt(5)
    v_exp_f32 v208, v208
    v_mfma_f32_16x16x32_bf16 v[236:239], a[160:163], a[240:243], v[236:239]
    s_waitcnt lgkmcnt(4)
    v_exp_f32 v209, v209
    v_mfma_f32_16x16x32_bf16 v[236:239], a[164:167], a[244:247], v[236:239]
    v_exp_f32 v210, v210
    v_mfma_f32_16x16x32_bf16 v[228:231], a[176:179], a[232:235], v[228:231]
    v_exp_f32 v211, v211
    v_mfma_f32_16x16x32_bf16 v[228:231], a[180:183], a[236:239], v[228:231]
    s_waitcnt lgkmcnt(1)
    s_barrier
    v_cvt_pk_bf16_f32 v194, v208, v209
    v_mfma_f32_16x16x32_bf16 v[228:231], a[184:187], a[240:243], v[228:231]
    ds_read_b128 a[252:255], v252 offset:18432
    v_cvt_pk_bf16_f32 v236, v236, v237
    v_mfma_f32_16x16x32_bf16 v[228:231], a[188:191], a[244:247], v[228:231]
    ds_read_b64 v[254:255], v253 offset:18688
    v_cvt_pk_bf16_f32 v237, v238, v239
    v_mfma_f32_16x16x32_bf16 v[232:235], a[192:195], a[224:227], 0
    ds_write_b64 v249, v[236:237] offset:0
    v_mfma_f32_16x16x32_bf16 v[232:235], a[196:199], a[228:231], v[232:235]
    ds_read_b128 a[224:227], v242 offset:128
    ds_read_b128 a[228:231], v243 offset:128
    v_mfma_f32_16x16x32_bf16 v[232:235], a[200:203], a[232:235], v[232:235]
    ds_read_b128 a[232:235], v242 offset:256
    v_cvt_pk_bf16_f32 v228, v228, v229
    v_mfma_f32_16x16x32_bf16 v[232:235], a[204:207], a[236:239], v[232:235]
    ds_read_b128 a[236:239], v243 offset:256
    v_cvt_pk_bf16_f32 v229, v230, v231
    v_mfma_f32_16x16x32_bf16 v[232:235], a[208:211], a[240:243], v[232:235]
    ds_write_b64 v249, v[228:229] offset:128
    v_mfma_f32_16x16x32_bf16 v[232:235], a[212:215], a[244:247], v[232:235]
    ds_read_b128 a[240:243], v242 offset:24576
    ds_read_b128 a[244:247], v243 offset:24576
    v_mfma_f32_16x16x32_bf16 v[236:239], a[144:147], a[216:219], 0
    s_waitcnt lgkmcnt(9)
    v_cvt_pk_bf16_f32 v181, v210, v211
    s_waitcnt lgkmcnt(8)
    v_mfma_f32_16x16x32_bf16 v[204:207], v[114:117], v[174:177], v[204:207]
    ds_read_b128 v[208:211], v246 offset:128
    v_cvt_pk_bf16_f32 v232, v232, v233
    v_mfma_f32_16x16x32_bf16 v[204:207], v[116:119], v[176:179], v[204:207]
    v_cvt_pk_bf16_f32 v233, v234, v235
    v_sub_f32 v198, v198, v248
    v_mfma_f32_16x16x32_bf16 v[236:239], a[148:151], a[220:223], v[236:239]
    ds_write_b64 v249, v[232:233] offset:256
    v_mfma_f32_16x16x32_bf16 v[228:231], a[168:171], a[216:219], 0
    buffer_store_dwordx4 a[252:255], v250, s[20:23], s54 offen nt
    v_mfma_f32_16x16x32_bf16 v[228:231], a[172:175], a[220:223], v[228:231]
    s_waitcnt lgkmcnt(8)
    ds_read_b128 a[252:255], v252 offset:24576
    v_mfma_f32_16x16x32_bf16 v[236:239], a[152:155], a[224:227], v[236:239]
    s_waitcnt lgkmcnt(8)
    v_exp_f32 v196, v196
    v_mfma_f32_16x16x32_bf16 v[236:239], a[156:159], a[228:231], v[236:239]
    buffer_store_dwordx2 v[254:255], v251, s[20:23], s54 offen offset:256 nt
    v_mfma_f32_16x16x32_bf16 v[228:231], a[176:179], a[224:227], v[228:231]
    ds_read_b64 v[254:255], v253 offset:24832
    s_mul_i32 s54, s31, 15
    v_mfma_f32_16x16x32_bf16 v[228:231], a[180:183], a[228:231], v[228:231]
    s_add_u32 s53, s53, s54
    s_add_u32 s53, s53, s32
    s_add_u32 s54, s28, 11
    v_mfma_f32_16x16x32_bf16 v[232:235], a[192:195], a[216:219], 0
    ds_read_b128 a[216:219], v242 offset:24704
    s_mul_i32 s54, s54, s30
    v_mfma_f32_16x16x32_bf16 v[232:235], a[196:199], a[220:223], v[232:235]
    ds_read_b128 a[220:223], v243 offset:24704
    v_sub_f32 v199, v199, v248
    v_mfma_f32_16x16x32_bf16 v[232:235], a[200:203], a[224:227], v[232:235]
    ds_read_b128 a[224:227], v242 offset:24832
    v_sub_f32 v200, v200, v248
    v_mfma_f32_16x16x32_bf16 v[232:235], a[204:207], a[228:231], v[232:235]
    s_waitcnt lgkmcnt(6)
    ds_read_b128 a[228:231], v243 offset:24832
    v_mfma_f32_16x16x32_bf16 v[208:211], v[150:153], v[174:177], v[208:211]
    s_waitcnt lgkmcnt(5)
    ds_read_b64 v[174:175], v247 offset:43008
    v_mfma_f32_16x16x32_bf16 v[208:211], v[152:155], v[176:179], v[208:211]
    buffer_store_dwordx4 a[252:255], v250, s[20:23], s56 offen nt
    v_mfma_f32_16x16x32_bf16 v[236:239], a[160:163], a[232:235], v[236:239]
    s_waitcnt lgkmcnt(5)
    ds_read_b64 v[176:177], v247 offset:43136
    v_mfma_f32_16x16x32_bf16 v[236:239], a[164:167], a[236:239], v[236:239]
    ds_read_b64 v[178:179], v247 offset:43264
    v_sub_f32 v201, v201, v248
    v_mfma_f32_16x16x32_bf16 v[228:231], a[184:187], a[232:235], v[228:231]
    buffer_store_dwordx2 v[254:255], v251, s[20:23], s56 offen offset:256 nt
    v_mfma_f32_16x16x32_bf16 v[228:231], a[188:191], a[236:239], v[228:231]
    s_mul_i32 s56, s31, 13
    s_add_u32 s55, s55, s56
    s_add_u32 s55, s55, s32
    v_mfma_f32_16x16x32_bf16 v[232:235], a[208:211], a[232:235], v[232:235]
    s_add_u32 s56, s28, 11
    v_cvt_pk_bf16_f32 v236, v236, v237
    v_cvt_pk_bf16_f32 v237, v238, v239
    v_mfma_f32_16x16x32_bf16 v[232:235], a[212:215], a[236:239], v[232:235]
    ds_write_b64 v249, v[236:237] offset:6144
    v_cvt_pk_bf16_f32 v228, v228, v229
    v_cvt_pk_bf16_f32 v229, v230, v231
    ds_write_b64 v249, v[228:229] offset:6272
    s_mul_i32 s56, s56, s30
    v_exp_f32 v197, v197
    v_exp_f32 v198, v198
    v_exp_f32 v199, v199
    v_cvt_pk_bf16_f32 v232, v232, v233
    v_cvt_pk_bf16_f32 v233, v234, v235
    ds_write_b64 v249, v[232:233] offset:6400
    v_cvt_pk_bf16_f32 v195, v196, v197
    v_cvt_pk_bf16_f32 v182, v198, v199
    ds_read_b128 v[196:199], v244 offset:0
    v_mfma_f32_16x16x32_bf16 v[212:215], v[10:13], v[192:195], v[212:215]
    v_exp_f32 v200, v200
    v_mfma_f32_16x16x32_bf16 v[216:219], v[40:43], v[192:195], v[216:219]
    v_exp_f32 v201, v201
    v_mfma_f32_16x16x32_bf16 v[220:223], v[70:73], v[192:195], v[220:223]
    v_cvt_pk_bf16_f32 v186, v200, v201
    v_sub_f32 v204, v204, v248
    v_mfma_f32_16x16x32_bf16 v[224:227], a[248:251], v[192:195], v[224:227]
    ds_read_b128 v[200:203], v245 offset:0
    v_sub_f32 v205, v205, v248
    v_mfma_f32_16x16x32_bf16 v[212:215], v[14:17], v[180:183], v[212:215]
    v_exp_f32 v204, v204
    v_mfma_f32_16x16x32_bf16 v[216:219], v[44:47], v[180:183], v[216:219]
    v_exp_f32 v205, v205
    v_mfma_f32_16x16x32_bf16 v[220:223], v[74:77], v[180:183], v[220:223]
    v_cvt_pk_bf16_f32 v184, v204, v205
    v_sub_f32 v208, v208, v248
    v_mfma_f32_16x16x32_bf16 v[224:227], a[248:251], v[180:183], v[224:227]
    ds_read_b128 v[204:207], v246 offset:0
    s_waitcnt lgkmcnt(2)
    v_mfma_f32_16x16x32_bf16 v[196:199], v[162:165], v[168:171], v[196:199]
    v_exp_f32 v208, v208
    v_mfma_f32_16x16x32_bf16 v[196:199], v[164:167], v[170:173], v[196:199]
    v_sub_f32 v209, v209, v248
    v_exp_f32 v209, v209
    s_nop 0
    v_cvt_pk_bf16_f32 v185, v208, v209
    ds_read_b128 v[208:211], v244 offset:64
    s_waitcnt lgkmcnt(2)
    v_mfma_f32_16x16x32_bf16 v[212:215], v[18:21], v[184:187], v[212:215]
    v_mfma_f32_16x16x32_bf16 v[216:219], v[48:51], v[184:187], v[216:219]
    v_max_f32 v248, v196, v197
    v_max3_f32 v248, v248, v198, v199
    v_mfma_f32_16x16x32_bf16 v[220:223], v[78:81], v[184:187], v[220:223]
    ds_read_b128 v[196:199], v245 offset:64
    v_mfma_f32_16x16x32_bf16 v[224:227], a[248:251], v[184:187], v[224:227]
    v_mfma_f32_16x16x32_bf16 v[200:203], v[138:141], v[168:171], v[200:203]
    s_waitcnt lgkmcnt(2)
    v_mfma_f32_16x16x32_bf16 v[200:203], v[140:143], v[170:173], v[200:203]
    v_mfma_f32_16x16x32_bf16 v[204:207], v[144:147], v[168:171], v[204:207]
    v_mfma_f32_16x16x32_bf16 v[204:207], v[146:149], v[170:173], v[204:207]
    s_nop 2
    s_waitcnt lgkmcnt(1)
    v_mfma_f32_16x16x32_bf16 v[208:211], v[102:105], v[168:171], v[208:211]
    v_rcp_f32 v225, v224
    v_mfma_f32_16x16x32_bf16 v[208:211], v[104:107], v[170:173], v[208:211]
    v_mul_f32 v212, v212, v225
    v_mul_f32 v213, v213, v225
    v_mul_f32 v214, v214, v225
    s_waitcnt lgkmcnt(0)
    v_mfma_f32_16x16x32_bf16 v[196:199], v[114:117], v[168:171], v[196:199]
    v_mul_f32 v215, v215, v225
    v_cvt_pk_bf16_f32 v212, v212, v213
    v_mfma_f32_16x16x32_bf16 v[196:199], v[116:119], v[170:173], v[196:199]
    v_cvt_pk_bf16_f32 v213, v214, v215
    ds_write_b64 v247, v[212:213] offset:30720
    v_mul_f32 v216, v216, v225
    v_mul_f32 v217, v217, v225
    v_mul_f32 v218, v218, v225
    v_mul_f32 v219, v219, v225
    v_cvt_pk_bf16_f32 v216, v216, v217
    v_cvt_pk_bf16_f32 v217, v218, v219
    ds_write_b64 v247, v[216:217] offset:30848
    v_mul_f32 v220, v220, v225
    v_mul_f32 v221, v221, v225
    v_mul_f32 v222, v222, v225
    v_mul_f32 v223, v223, v225
    v_cvt_pk_bf16_f32 v220, v220, v221
    v_cvt_pk_bf16_f32 v221, v222, v223
    ds_write_b64 v247, v[220:221] offset:30976
    v_max3_f32 v248, v248, v200, v201
    v_max3_f32 v248, v248, v202, v203
    ds_read_b128 v[200:203], v246 offset:64
    v_max3_f32 v248, v248, v204, v205
    v_max3_f32 v248, v248, v206, v207
    ds_read_b128 v[204:207], v244 offset:128
    v_max3_f32 v248, v248, v208, v209
    v_max3_f32 v248, v248, v210, v211
    ds_read_b128 v[208:211], v245 offset:128
    v_max3_f32 v248, v248, v196, v197
    v_max3_f32 v248, v248, v198, v199
    ds_read_b128 v[196:199], v246 offset:128
    s_waitcnt lgkmcnt(3)
    v_mfma_f32_16x16x32_bf16 v[200:203], v[150:153], v[168:171], v[200:203]
    v_mfma_f32_16x16x32_bf16 v[200:203], v[152:155], v[170:173], v[200:203]
    s_waitcnt lgkmcnt(2)
    v_mfma_f32_16x16x32_bf16 v[204:207], v[108:111], v[168:171], v[204:207]
    s_waitcnt lgkmcnt(1)
    v_mfma_f32_16x16x32_bf16 v[204:207], v[110:113], v[170:173], v[204:207]
    v_mfma_f32_16x16x32_bf16 v[208:211], v[120:123], v[168:171], v[208:211]
    s_waitcnt lgkmcnt(0)
    v_mfma_f32_16x16x32_bf16 v[208:211], v[122:125], v[170:173], v[208:211]
    v_mfma_f32_16x16x32_bf16 v[196:199], v[156:159], v[168:171], v[196:199]
    v_max3_f32 v248, v248, v200, v201
    v_max3_f32 v248, v248, v202, v203
    v_mfma_f32_16x16x32_bf16 v[196:199], v[158:161], v[170:173], v[196:199]
    ds_read_b128 v[200:203], v244 offset:0
    v_max3_f32 v248, v248, v204, v205
    ds_read_b128 v[204:207], v245 offset:0
    s_nop 0
    v_max3_f32 v248, v248, v208, v209
    ds_read_b128 v[208:211], v246 offset:0
    s_nop 1
    v_max3_f32 v248, v248, v196, v197
    ds_read_b128 v[196:199], v244 offset:64
    v_mov_b32 v225, v248
    s_nop 1
    v_permlane16_swap_b32 v248, v225
    v_max_f32 v248, v248, v225
    v_mov_b32 v225, v248
    s_nop 1
    v_permlane32_swap_b32 v248, v225
    v_max_f32 v248, v248, v225
    s_waitcnt lgkmcnt(3)
    v_mfma_f32_16x16x32_bf16 v[200:203], v[162:165], v[168:171], v[200:203]
    v_mfma_f32_16x16x32_bf16 v[200:203], v[164:167], v[170:173], v[200:203]
    s_waitcnt lgkmcnt(2)
    v_mfma_f32_16x16x32_bf16 v[204:207], v[138:141], v[168:171], v[204:207]
    s_waitcnt lgkmcnt(1)
    v_mfma_f32_16x16x32_bf16 v[204:207], v[140:143], v[170:173], v[204:207]
    v_mfma_f32_16x16x32_bf16 v[208:211], v[144:147], v[168:171], v[208:211]
    s_waitcnt lgkmcnt(0)
    v_mfma_f32_16x16x32_bf16 v[208:211], v[146:149], v[170:173], v[208:211]
    v_mfma_f32_16x16x32_bf16 v[196:199], v[102:105], v[168:171], v[196:199]
    v_sub_f32 v200, v200, v248
    v_sub_f32 v201, v201, v248
    v_mfma_f32_16x16x32_bf16 v[196:199], v[104:107], v[170:173], v[196:199]
    v_exp_f32 v200, v200
    v_exp_f32 v201, v201
    v_sub_f32 v202, v202, v248
    v_exp_f32 v202, v202
    v_sub_f32 v203, v203, v248
    v_exp_f32 v203, v203
    v_cvt_pk_bf16_f32 v190, v200, v201
    v_cvt_pk_bf16_f32 v193, v202, v203
    ds_read_b128 v[200:203], v245 offset:64
    v_sub_f32 v204, v204, v248
    v_exp_f32 v204, v204
    v_sub_f32 v205, v205, v248
    v_exp_f32 v205, v205
    v_sub_f32 v206, v206, v248
    v_exp_f32 v206, v206
    v_sub_f32 v207, v207, v248
    v_exp_f32 v207, v207
    v_cvt_pk_bf16_f32 v188, v204, v205
    v_cvt_pk_bf16_f32 v191, v206, v207
    ds_read_b128 v[204:207], v246 offset:64
    v_sub_f32 v208, v208, v248
    v_exp_f32 v208, v208
    v_sub_f32 v209, v209, v248
    v_exp_f32 v209, v209
    v_sub_f32 v210, v210, v248
    v_exp_f32 v210, v210
    v_sub_f32 v211, v211, v248
    v_exp_f32 v211, v211
    v_cvt_pk_bf16_f32 v189, v208, v209
    v_cvt_pk_bf16_f32 v192, v210, v211
    s_waitcnt lgkmcnt(1)
    v_mfma_f32_16x16x32_bf16 v[212:215], v[12:15], v[188:191], 0
    ds_read_b128 v[208:211], v244 offset:128
    v_sub_f32 v196, v196, v248
    v_mfma_f32_16x16x32_bf16 v[216:219], v[42:45], v[188:191], 0
    v_exp_f32 v196, v196
    v_mfma_f32_16x16x32_bf16 v[220:223], v[72:75], v[188:191], 0
    v_sub_f32 v197, v197, v248
    v_sub_f32 v198, v198, v248
    v_mfma_f32_16x16x32_bf16 v[224:227], a[248:251], v[188:191], 0
    v_exp_f32 v197, v197
    v_mfma_f32_16x16x32_bf16 v[200:203], v[114:117], v[168:171], v[200:203]
    s_waitcnt lgkmcnt(1)
    v_exp_f32 v198, v198
    v_mfma_f32_16x16x32_bf16 v[200:203], v[116:119], v[170:173], v[200:203]
    v_sub_f32 v199, v199, v248
    v_cvt_pk_bf16_f32 v180, v196, v197
    v_mfma_f32_16x16x32_bf16 v[204:207], v[150:153], v[168:171], v[204:207]
    v_exp_f32 v199, v199
    v_mfma_f32_16x16x32_bf16 v[204:207], v[152:155], v[170:173], v[204:207]
    v_cvt_pk_bf16_f32 v183, v198, v199
    ds_read_b128 v[196:199], v245 offset:128
    s_waitcnt lgkmcnt(1)
    v_mfma_f32_16x16x32_bf16 v[208:211], v[108:111], v[168:171], v[208:211]
    v_sub_f32 v200, v200, v248
    v_sub_f32 v201, v201, v248
    v_mfma_f32_16x16x32_bf16 v[208:211], v[110:113], v[170:173], v[208:211]
    v_exp_f32 v200, v200
    v_exp_f32 v201, v201
    v_sub_f32 v202, v202, v248
    v_exp_f32 v202, v202
    v_sub_f32 v203, v203, v248
    v_exp_f32 v203, v203
    v_cvt_pk_bf16_f32 v194, v200, v201
    v_cvt_pk_bf16_f32 v181, v202, v203
    ds_read_b128 v[200:203], v246 offset:128
    v_sub_f32 v204, v204, v248
    v_exp_f32 v204, v204
    v_sub_f32 v205, v205, v248
    v_exp_f32 v205, v205
    v_sub_f32 v206, v206, v248
    v_exp_f32 v206, v206
    s_waitcnt lgkmcnt(1)
    v_mfma_f32_16x16x32_bf16 v[196:199], v[120:123], v[168:171], v[196:199]
    v_sub_f32 v207, v207, v248
    v_cvt_pk_bf16_f32 v195, v204, v205
    v_mfma_f32_16x16x32_bf16 v[196:199], v[122:125], v[170:173], v[196:199]
    v_exp_f32 v207, v207
    v_mfma_f32_16x16x32_bf16 v[212:215], v[16:19], v[192:195], v[212:215]
    v_cvt_pk_bf16_f32 v182, v206, v207
    v_sub_f32 v208, v208, v248
    v_mfma_f32_16x16x32_bf16 v[216:219], v[46:49], v[192:195], v[216:219]
    ds_read_b128 v[204:207], v244 offset:0
    v_sub_f32 v209, v209, v248
    v_mfma_f32_16x16x32_bf16 v[220:223], v[76:79], v[192:195], v[220:223]
    v_exp_f32 v208, v208
    v_mfma_f32_16x16x32_bf16 v[224:227], a[248:251], v[192:195], v[224:227]
    s_waitcnt lgkmcnt(1)
    v_exp_f32 v209, v209
    v_mfma_f32_16x16x32_bf16 v[212:215], v[20:23], v[180:183], v[212:215]
    v_cvt_pk_bf16_f32 v186, v208, v209
    v_sub_f32 v196, v196, v248
    v_mfma_f32_16x16x32_bf16 v[216:219], v[50:53], v[180:183], v[216:219]
    ds_read_b128 v[208:211], v245 offset:0
    v_sub_f32 v197, v197, v248
    v_mfma_f32_16x16x32_bf16 v[220:223], v[80:83], v[180:183], v[220:223]
    v_exp_f32 v196, v196
    v_mfma_f32_16x16x32_bf16 v[224:227], a[248:251], v[180:183], v[224:227]
    v_exp_f32 v197, v197
    v_mfma_f32_16x16x32_bf16 v[200:203], v[156:159], v[168:171], v[200:203]
    ds_read_b64 v[168:169], v247 offset:49152
    v_cvt_pk_bf16_f32 v184, v196, v197
    v_mfma_f32_16x16x32_bf16 v[200:203], v[158:161], v[170:173], v[200:203]
    ds_read_b128 v[196:199], v246 offset:0
    s_waitcnt lgkmcnt(3)
    v_mfma_f32_16x16x32_bf16 v[204:207], v[102:105], v[174:177], v[204:207]
    ds_read_b64 v[170:171], v247 offset:49280
    ds_read_b64 v[172:173], v247 offset:49408
    v_mfma_f32_16x16x32_bf16 v[204:207], v[104:107], v[176:179], v[204:207]
    s_nop 1
    v_sub_f32 v200, v200, v248
    v_exp_f32 v200, v200
    v_sub_f32 v201, v201, v248
    v_exp_f32 v201, v201
    s_nop 0
    s_waitcnt lgkmcnt(4)
    v_mfma_f32_16x16x32_bf16 v[208:211], v[114:117], v[174:177], v[208:211]
    v_cvt_pk_bf16_f32 v185, v200, v201
    v_max_f32 v248, v204, v205
    v_mfma_f32_16x16x32_bf16 v[208:211], v[116:119], v[176:179], v[208:211]
    ds_read_b128 v[200:203], v244 offset:64
    v_max3_f32 v248, v248, v206, v207
    v_mfma_f32_16x16x32_bf16 v[212:215], v[24:27], v[184:187], v[212:215]
    ds_read_b128 v[204:207], v245 offset:64
    v_mfma_f32_16x16x32_bf16 v[216:219], v[54:57], v[184:187], v[216:219]
    v_mfma_f32_16x16x32_bf16 v[220:223], v[84:87], v[184:187], v[220:223]
    s_waitcnt lgkmcnt(4)
    v_mfma_f32_16x16x32_bf16 v[224:227], a[248:251], v[184:187], v[224:227]
    v_max3_f32 v248, v248, v208, v209
    v_max3_f32 v248, v248, v210, v211
    v_mfma_f32_16x16x32_bf16 v[196:199], v[150:153], v[174:177], v[196:199]
    ds_read_b128 v[208:211], v246 offset:64
    v_mov_b32 v186, 0
    v_mfma_f32_16x16x32_bf16 v[196:199], v[152:155], v[176:179], v[196:199]
    s_nop 1
    v_rcp_f32 v225, v224
    s_nop 0
    v_mul_f32 v212, v212, v225
    v_mul_f32 v213, v213, v225
    v_mul_f32 v214, v214, v225
    v_mul_f32 v215, v215, v225
    s_waitcnt lgkmcnt(2)
    v_mfma_f32_16x16x32_bf16 v[200:203], v[108:111], v[174:177], v[200:203]
    v_cvt_pk_bf16_f32 v212, v212, v213
    v_cvt_pk_bf16_f32 v213, v214, v215
    v_mfma_f32_16x16x32_bf16 v[200:203], v[110:113], v[176:179], v[200:203]
    s_waitcnt lgkmcnt(1)
    v_mul_f32 v216, v216, v225
    v_mul_f32 v217, v217, v225
    v_mfma_f32_16x16x32_bf16 v[204:207], v[120:123], v[174:177], v[204:207]
    ds_write_b64 v247, v[212:213] offset:36864
    v_mfma_f32_16x16x32_bf16 v[204:207], v[122:125], v[176:179], v[204:207]
    v_mul_f32 v218, v218, v225
    v_mul_f32 v219, v219, v225
    v_cvt_pk_bf16_f32 v216, v216, v217
    v_cvt_pk_bf16_f32 v217, v218, v219
    s_waitcnt lgkmcnt(1)
    v_mfma_f32_16x16x32_bf16 v[208:211], v[156:159], v[174:177], v[208:211]
    ds_write_b64 v247, v[216:217] offset:36992
    v_mfma_f32_16x16x32_bf16 v[208:211], v[158:161], v[176:179], v[208:211]
    v_mul_f32 v220, v220, v225
    v_mul_f32 v221, v221, v225
    v_mul_f32 v222, v222, v225
    v_mul_f32 v223, v223, v225
    v_cvt_pk_bf16_f32 v220, v220, v221
    v_cvt_pk_bf16_f32 v221, v222, v223
    ds_write_b64 v247, v[220:221] offset:37120
    v_max3_f32 v248, v248, v196, v197
    v_max3_f32 v248, v248, v198, v199
    ds_read_b128 v[196:199], v244 offset:0
    v_max3_f32 v248, v248, v200, v201
    v_max3_f32 v248, v248, v202, v203
    ds_read_b128 v[200:203], v245 offset:0
    v_max3_f32 v248, v248, v204, v205
    v_max3_f32 v248, v248, v206, v207
    ds_read_b128 v[204:207], v246 offset:0
    v_max3_f32 v248, v248, v208, v209
    v_max3_f32 v248, v248, v210, v211
    ds_read_b128 v[208:211], v244 offset:64
    v_mov_b32 v225, v248
    s_nop 1
    v_permlane16_swap_b32 v248, v225
    v_max_f32 v248, v248, v225
    v_mov_b32 v225, v248
    s_nop 1
    v_permlane32_swap_b32 v248, v225
    v_max_f32 v248, v248, v225
    s_waitcnt lgkmcnt(3)
    v_mfma_f32_16x16x32_bf16 v[196:199], v[102:105], v[174:177], v[196:199]
    v_mfma_f32_16x16x32_bf16 v[196:199], v[104:107], v[176:179], v[196:199]
    s_waitcnt lgkmcnt(2)
    v_mfma_f32_16x16x32_bf16 v[200:203], v[114:117], v[174:177], v[200:203]
    s_waitcnt lgkmcnt(1)
    v_mfma_f32_16x16x32_bf16 v[200:203], v[116:119], v[176:179], v[200:203]
    v_mfma_f32_16x16x32_bf16 v[204:207], v[150:153], v[174:177], v[204:207]
    s_waitcnt lgkmcnt(0)
    v_mfma_f32_16x16x32_bf16 v[204:207], v[152:155], v[176:179], v[204:207]
    v_mfma_f32_16x16x32_bf16 v[208:211], v[108:111], v[174:177], v[208:211]
    v_sub_f32 v196, v196, v248
    v_sub_f32 v197, v197, v248
    v_mfma_f32_16x16x32_bf16 v[208:211], v[110:113], v[176:179], v[208:211]
    v_exp_f32 v196, v196
    v_exp_f32 v197, v197
    v_sub_f32 v198, v198, v248
    v_exp_f32 v198, v198
    v_sub_f32 v199, v199, v248
    v_exp_f32 v199, v199
    v_cvt_pk_bf16_f32 v190, v196, v197
    v_cvt_pk_bf16_f32 v193, v198, v199
    ds_read_b128 v[196:199], v245 offset:64
    v_sub_f32 v200, v200, v248
    v_exp_f32 v200, v200
    v_sub_f32 v201, v201, v248
    v_exp_f32 v201, v201
    v_sub_f32 v202, v202, v248
    v_exp_f32 v202, v202
    v_sub_f32 v203, v203, v248
    v_exp_f32 v203, v203
    v_cvt_pk_bf16_f32 v188, v200, v201
    v_cvt_pk_bf16_f32 v191, v202, v203
    ds_read_b128 v[200:203], v246 offset:64
    v_sub_f32 v204, v204, v248
    v_exp_f32 v204, v204
    v_sub_f32 v205, v205, v248
    v_exp_f32 v205, v205
    v_sub_f32 v206, v206, v248
    v_exp_f32 v206, v206
    v_sub_f32 v207, v207, v248
    v_exp_f32 v207, v207
    v_cvt_pk_bf16_f32 v189, v204, v205
    v_cvt_pk_bf16_f32 v192, v206, v207
    s_waitcnt lgkmcnt(1)
    v_mfma_f32_16x16x32_bf16 v[212:215], v[18:21], v[188:191], 0
    v_sub_f32 v208, v208, v248
    v_sub_f32 v209, v209, v248
    v_mfma_f32_16x16x32_bf16 v[216:219], v[48:51], v[188:191], 0
    v_exp_f32 v208, v208
    v_mfma_f32_16x16x32_bf16 v[220:223], v[78:81], v[188:191], 0
    v_exp_f32 v209, v209
    v_mfma_f32_16x16x32_bf16 v[224:227], a[248:251], v[188:191], 0
    v_sub_f32 v210, v210, v248
    v_sub_f32 v211, v211, v248
    v_mfma_f32_16x16x32_bf16 v[196:199], v[120:123], v[174:177], v[196:199]
    s_waitcnt lgkmcnt(0)
    v_exp_f32 v210, v210
    v_mfma_f32_16x16x32_bf16 v[196:199], v[122:125], v[176:179], v[196:199]
    v_exp_f32 v211, v211
    v_mfma_f32_16x16x32_bf16 v[200:203], v[156:159], v[174:177], v[200:203]
    ds_read_b64 v[174:175], v247 offset:55296
    v_cvt_pk_bf16_f32 v180, v208, v209
    v_mfma_f32_16x16x32_bf16 v[200:203], v[158:161], v[176:179], v[200:203]
    ds_read_b64 v[176:177], v247 offset:55424
    ds_read_b64 v[178:179], v247 offset:55552
    v_cvt_pk_bf16_f32 v183, v210, v211
    v_sub_f32 v196, v196, v248
    v_exp_f32 v196, v196
    v_sub_f32 v197, v197, v248
    v_exp_f32 v197, v197
    v_sub_f32 v198, v198, v248
    v_exp_f32 v198, v198
    v_sub_f32 v199, v199, v248
    v_exp_f32 v199, v199
    v_cvt_pk_bf16_f32 v194, v196, v197
    v_cvt_pk_bf16_f32 v181, v198, v199
    v_sub_f32 v200, v200, v248
    v_exp_f32 v200, v200
    v_sub_f32 v201, v201, v248
    v_exp_f32 v201, v201
    v_sub_f32 v202, v202, v248
    v_exp_f32 v202, v202
    v_sub_f32 v203, v203, v248
    v_exp_f32 v203, v203
    v_cvt_pk_bf16_f32 v195, v200, v201
    v_cvt_pk_bf16_f32 v182, v202, v203
    v_mov_b32 v204, 0x237c0
    v_mfma_f32_16x16x32_bf16 v[212:215], v[22:25], v[192:195], v[212:215]
    v_add_u32 v205, 0xfffff900, v245
    v_cndmask_b32 v205, v244, v205, vcc
    v_mfma_f32_16x16x32_bf16 v[216:219], v[52:55], v[192:195], v[216:219]
    s_mov_b32 vcc_lo, 0xff00ff00
    v_add_u32 v206, 0xc0, v205
    v_add_u32 v205, 0x340, v205
    v_mfma_f32_16x16x32_bf16 v[220:223], v[82:85], v[192:195], v[220:223]
    s_mov_b32 vcc_hi, 0xff00ff00
    v_cndmask_b32 v244, v206, v205, vcc
    v_add_u32 v245, 0x700, v244
    v_mfma_f32_16x16x32_bf16 v[224:227], a[248:251], v[192:195], v[224:227]
    s_mov_b32 vcc_lo, 0xf0f0
    s_mov_b32 vcc_hi, 0x0
    v_cndmask_b32 v244, v244, v204, vcc
    v_mfma_f32_16x16x32_bf16 v[212:215], v[26:29], v[180:183], v[212:215]
    ds_read_b128 v[196:199], v244 offset:64
    s_mov_b32 vcc_lo, 0x0
    v_mfma_f32_16x16x32_bf16 v[216:219], v[56:59], v[180:183], v[216:219]
    s_mov_b32 vcc_hi, 0xf0f0000
    v_cndmask_b32 v245, v245, v204, vcc
    v_mov_b32 v189, 0
    v_mfma_f32_16x16x32_bf16 v[220:223], v[86:89], v[180:183], v[220:223]
    ds_read_b128 v[204:207], v244 offset:0
    ds_read_b128 v[208:211], v245 offset:0
    v_mfma_f32_16x16x32_bf16 v[224:227], a[248:251], v[180:183], v[224:227]
    ds_read_b128 v[200:203], v245 offset:64
    v_mov_b32 v192, 0
    v_mov_b32 v195, 0
    v_mov_b32 v182, 0
    s_mov_b32 vcc_lo, 0xff000f
    s_mov_b32 vcc_hi, 0xff00ff
    s_nop 1
    v_rcp_f32 v225, v224
    s_nop 0
    v_mul_f32 v212, v212, v225
    v_mul_f32 v213, v213, v225
    v_mul_f32 v214, v214, v225
    v_mul_f32 v215, v215, v225
    v_cvt_pk_bf16_f32 v212, v212, v213
    v_cvt_pk_bf16_f32 v213, v214, v215
    ds_write_b64 v247, v[212:213] offset:43008
    s_waitcnt lgkmcnt(4)
    v_mfma_f32_16x16x32_bf16 v[196:199], v[96:99], v[168:171], v[196:199]
    v_mul_f32 v216, v216, v225
    v_mul_f32 v217, v217, v225
    v_mfma_f32_16x16x32_bf16 v[196:199], v[98:101], v[170:173], v[196:199]
    s_waitcnt lgkmcnt(3)
    v_mul_f32 v218, v218, v225
    v_mul_f32 v219, v219, v225
    v_mfma_f32_16x16x32_bf16 v[204:207], v[90:93], v[168:171], v[204:207]
    s_waitcnt lgkmcnt(2)
    v_cvt_pk_bf16_f32 v216, v216, v217
    v_cvt_pk_bf16_f32 v217, v218, v219
    v_mfma_f32_16x16x32_bf16 v[204:207], v[92:95], v[170:173], v[204:207]
    ds_write_b64 v247, v[216:217] offset:43136
    v_mfma_f32_16x16x32_bf16 v[208:211], v[126:129], v[168:171], v[208:211]
    s_waitcnt lgkmcnt(2)
    v_mul_f32 v220, v220, v225
    v_mul_f32 v221, v221, v225
    v_mfma_f32_16x16x32_bf16 v[208:211], v[128:131], v[170:173], v[208:211]
    v_mul_f32 v222, v222, v225
    v_mul_f32 v223, v223, v225
    v_mfma_f32_16x16x32_bf16 v[200:203], v[132:135], v[168:171], v[200:203]
    v_cvt_pk_bf16_f32 v220, v220, v221
    v_cvt_pk_bf16_f32 v221, v222, v223
    v_mfma_f32_16x16x32_bf16 v[200:203], v[134:137], v[170:173], v[200:203]
    ds_write_b64 v247, v[220:221] offset:43264
    v_mfma_f32_16x16x32_bf16 v[236:239], a[144:147], a[240:243], 0
    v_max_f32 v248, v204, v205
    v_max3_f32 v248, v248, v206, v207
    v_mfma_f32_16x16x32_bf16 v[236:239], a[148:151], a[244:247], v[236:239]
    ds_read_b128 v[204:207], v244 offset:128
    v_max3_f32 v248, v248, v208, v209
    v_mfma_f32_16x16x32_bf16 v[236:239], a[152:155], a[216:219], v[236:239]
    v_max3_f32 v248, v248, v210, v211
    v_max3_f32 v248, v248, v196, v197
    v_mfma_f32_16x16x32_bf16 v[236:239], a[156:159], a[220:223], v[236:239]
    ds_read_b128 v[208:211], v245 offset:128
    v_max3_f32 v248, v248, v198, v199
    v_mfma_f32_16x16x32_bf16 v[236:239], a[160:163], a[224:227], v[236:239]
    ds_read_b128 v[196:199], v244 offset:192
    v_max3_f32 v248, v248, v200, v201
    v_mfma_f32_16x16x32_bf16 v[236:239], a[164:167], a[228:231], v[236:239]
    v_max3_f32 v248, v248, v202, v203
    v_mfma_f32_16x16x32_bf16 v[228:231], a[168:171], a[240:243], 0
    ds_read_b128 v[200:203], v245 offset:192
    v_mfma_f32_16x16x32_bf16 v[228:231], a[172:175], a[244:247], v[228:231]
    v_mfma_f32_16x16x32_bf16 v[228:231], a[176:179], a[216:219], v[228:231]
    v_mfma_f32_16x16x32_bf16 v[228:231], a[180:183], a[220:223], v[228:231]
    v_mfma_f32_16x16x32_bf16 v[228:231], a[184:187], a[224:227], v[228:231]
    s_waitcnt lgkmcnt(3)
    v_cvt_pk_bf16_f32 v236, v236, v237
    v_cvt_pk_bf16_f32 v237, v238, v239
    v_mfma_f32_16x16x32_bf16 v[204:207], v[138:141], v[168:171], v[204:207]
    ds_write_b64 v249, v[236:237] offset:12288
    v_mfma_f32_16x16x32_bf16 v[204:207], v[140:143], v[170:173], v[204:207]
    s_waitcnt lgkmcnt(2)
    v_mfma_f32_16x16x32_bf16 v[208:211], v[144:147], v[168:171], v[208:211]
    v_mfma_f32_16x16x32_bf16 v[208:211], v[146:149], v[170:173], v[208:211]
    s_waitcnt lgkmcnt(1)
    v_mfma_f32_16x16x32_bf16 v[196:199], v[114:117], v[168:171], v[196:199]
    v_mfma_f32_16x16x32_bf16 v[196:199], v[116:119], v[170:173], v[196:199]
    v_mfma_f32_16x16x32_bf16 v[200:203], v[150:153], v[168:171], v[200:203]
    v_mfma_f32_16x16x32_bf16 v[200:203], v[152:155], v[170:173], v[200:203]
    v_max3_f32 v248, v248, v204, v205
    v_max3_f32 v248, v248, v206, v207
    v_mfma_f32_16x16x32_bf16 v[228:231], a[188:191], a[228:231], v[228:231]
    ds_read_b128 v[204:207], v244 offset:0
    v_max3_f32 v248, v248, v208, v209
    v_mfma_f32_16x16x32_bf16 v[232:235], a[192:195], a[240:243], 0
    v_max3_f32 v248, v248, v210, v211
    v_max3_f32 v248, v248, v196, v197
    v_mfma_f32_16x16x32_bf16 v[232:235], a[196:199], a[244:247], v[232:235]
    ds_read_b128 v[208:211], v245 offset:0
    ds_read_b128 v[196:199], v244 offset:64
    v_mfma_f32_16x16x32_bf16 v[232:235], a[200:203], a[216:219], v[232:235]
    v_cvt_pk_bf16_f32 v228, v228, v229
    v_cvt_pk_bf16_f32 v229, v230, v231
    v_mfma_f32_16x16x32_bf16 v[232:235], a[204:207], a[220:223], v[232:235]
    ds_write_b64 v249, v[228:229] offset:12416
    v_mfma_f32_16x16x32_bf16 v[232:235], a[208:211], a[224:227], v[232:235]
    v_max3_f32 v248, v248, v200, v201
    v_mov_b32 v225, v248
    v_mfma_f32_16x16x32_bf16 v[232:235], a[212:215], a[228:231], v[232:235]
    ds_read_b128 v[200:203], v245 offset:64
    v_permlane16_swap_b32 v248, v225
    v_max_f32 v248, v248, v225
    v_mov_b32 v225, v248
    s_nop 1
    v_permlane32_swap_b32 v248, v225
    s_waitcnt lgkmcnt(4)
    v_mfma_f32_16x16x32_bf16 v[204:207], v[90:93], v[168:171], v[204:207]
    v_cvt_pk_bf16_f32 v232, v232, v233
    v_cvt_pk_bf16_f32 v233, v234, v235
    v_mfma_f32_16x16x32_bf16 v[204:207], v[92:95], v[170:173], v[204:207]
    ds_write_b64 v249, v[232:233] offset:12544
    s_waitcnt lgkmcnt(4)
    v_mfma_f32_16x16x32_bf16 v[208:211], v[126:129], v[168:171], v[208:211]
    s_waitcnt lgkmcnt(3)
    v_max_f32 v248, v248, v225
    v_mfma_f32_16x16x32_bf16 v[208:211], v[128:131], v[170:173], v[208:211]
    v_mfma_f32_16x16x32_bf16 v[196:199], v[96:99], v[168:171], v[196:199]
    v_mfma_f32_16x16x32_bf16 v[196:199], v[98:101], v[170:173], v[196:199]
    v_sub_f32 v204, v204, v248
    s_waitcnt lgkmcnt(1)
    v_mfma_f32_16x16x32_bf16 v[200:203], v[132:135], v[168:171], v[200:203]
    v_exp_f32 v204, v204
    v_mfma_f32_16x16x32_bf16 v[200:203], v[134:137], v[170:173], v[200:203]
    v_sub_f32 v205, v205, v248
    v_exp_f32 v205, v205
    v_sub_f32 v206, v206, v248
    v_exp_f32 v206, v206
    s_waitcnt lgkmcnt(0)
    s_barrier
    ds_read_b128 a[232:235], v242 offset:30720
    ds_read_b128 a[236:239], v243 offset:30720
    ds_read_b128 a[240:243], v242 offset:30848
    ds_read_b128 a[244:247], v243 offset:30848
    ds_read_b128 a[216:219], v242 offset:30976
    ds_read_b128 a[220:223], v243 offset:30976
    ds_read_b128 a[224:227], v242 offset:36864
    ds_read_b128 a[228:231], v243 offset:36864
    ds_read_b128 a[252:255], v252 offset:0
    ds_read_b64 v[254:255], v253 offset:256
    v_sub_f32 v207, v207, v248
    v_exp_f32 v207, v207
    v_cvt_pk_bf16_f32 v184, v204, v205
    v_cvt_pk_bf16_f32 v187, v206, v207
    ds_read_b128 v[204:207], v244 offset:128
    v_sub_f32 v208, v208, v248
    v_exp_f32 v208, v208
    v_sub_f32 v209, v209, v248
    v_exp_f32 v209, v209
    v_sub_f32 v210, v210, v248
    v_exp_f32 v210, v210
    v_sub_f32 v211, v211, v248
    v_exp_f32 v211, v211
    s_waitcnt lgkmcnt(10)
    v_mfma_f32_16x16x32_bf16 v[236:239], a[144:147], a[232:235], 0
    v_cvt_pk_bf16_f32 v185, v208, v209
    v_cvt_pk_bf16_f32 v188, v210, v211
    v_mfma_f32_16x16x32_bf16 v[228:231], a[168:171], a[232:235], 0
    ds_read_b128 v[208:211], v245 offset:128
    v_sub_f32 v196, v196, v248
    v_mfma_f32_16x16x32_bf16 v[212:215], v[0:3], v[184:187], 0
    s_waitcnt lgkmcnt(10)
    v_exp_f32 v196, v196
    v_mfma_f32_16x16x32_bf16 v[216:219], v[30:33], v[184:187], 0
    v_sub_f32 v197, v197, v248
    v_sub_f32 v198, v198, v248
    v_mfma_f32_16x16x32_bf16 v[220:223], v[60:63], v[184:187], 0
    v_exp_f32 v197, v197
    v_mfma_f32_16x16x32_bf16 v[224:227], a[248:251], v[184:187], 0
    v_exp_f32 v198, v198
    v_mfma_f32_16x16x32_bf16 v[236:239], a[148:151], a[236:239], v[236:239]
    s_waitcnt lgkmcnt(9)
    v_sub_f32 v199, v199, v248
    v_cvt_pk_bf16_f32 v190, v196, v197
    v_mfma_f32_16x16x32_bf16 v[236:239], a[152:155], a[240:243], v[236:239]
    s_waitcnt lgkmcnt(8)
    v_exp_f32 v199, v199
    v_mfma_f32_16x16x32_bf16 v[236:239], a[156:159], a[244:247], v[236:239]
    s_waitcnt lgkmcnt(2)
    v_cvt_pk_bf16_f32 v193, v198, v199
    v_sub_f32 v200, v200, v248
    v_mfma_f32_16x16x32_bf16 v[236:239], a[160:163], a[216:219], v[236:239]
    ds_read_b128 v[196:199], v244 offset:192
    v_sub_f32 v201, v201, v248
    v_mfma_f32_16x16x32_bf16 v[236:239], a[164:167], a[220:223], v[236:239]
    buffer_store_dwordx4 a[252:255], v250, s[20:23], s51 offen nt
    v_mfma_f32_16x16x32_bf16 v[228:231], a[172:175], a[236:239], v[228:231]
    s_waitcnt lgkmcnt(1)
    ds_read_b128 a[252:255], v252 offset:6144
    v_mfma_f32_16x16x32_bf16 v[204:207], v[138:141], v[168:171], v[204:207]
    v_exp_f32 v200, v200
    v_mfma_f32_16x16x32_bf16 v[204:207], v[140:143], v[170:173], v[204:207]
    buffer_store_dwordx2 v[254:255], v251, s[20:23], s51 offen offset:256 nt
    v_mfma_f32_16x16x32_bf16 v[208:211], v[144:147], v[168:171], v[208:211]
    ds_read_b64 v[254:255], v253 offset:6400
    v_cvt_pk_bf16_f32 v236, v236, v237
    v_mfma_f32_16x16x32_bf16 v[208:211], v[146:149], v[170:173], v[208:211]
    s_mul_i32 s51, s31, 3
    v_cvt_pk_bf16_f32 v237, v238, v239
    s_add_u32 s57, s57, s51
    v_mfma_f32_16x16x32_bf16 v[228:231], a[176:179], a[240:243], v[228:231]
    ds_write_b64 v249, v[236:237] offset:18432
    v_mfma_f32_16x16x32_bf16 v[228:231], a[180:183], a[244:247], v[228:231]
    s_add_u32 s57, s57, s32
    s_and_b32 s51, s28, 1
    s_add_u32 s51, s51, 15
    v_mfma_f32_16x16x32_bf16 v[228:231], a[184:187], a[216:219], v[228:231]
    s_mul_i32 s51, s51, s30
    v_exp_f32 v201, v201
    v_mfma_f32_16x16x32_bf16 v[228:231], a[188:191], a[220:223], v[228:231]
    s_waitcnt lgkmcnt(2)
    v_sub_f32 v202, v202, v248
    v_sub_f32 v203, v203, v248
    v_mfma_f32_16x16x32_bf16 v[196:199], v[114:117], v[168:171], v[196:199]
    s_mov_b32 exec_hi, 0
    buffer_store_dwordx4 a[252:255], v250, s[20:23], s53 offen nt
    s_mov_b32 exec_hi, -1
    v_mfma_f32_16x16x32_bf16 v[196:199], v[116:119], v[170:173], v[196:199]
    v_exp_f32 v202, v202
    v_mfma_f32_16x16x32_bf16 v[232:235], a[192:195], a[232:235], 0
    ds_read_b128 a[232:235], v242 offset:36992
    v_cvt_pk_bf16_f32 v228, v228, v229
    v_mfma_f32_16x16x32_bf16 v[232:235], a[196:199], a[236:239], v[232:235]
    ds_read_b128 a[236:239], v243 offset:36992
    v_cvt_pk_bf16_f32 v229, v230, v231
    v_mfma_f32_16x16x32_bf16 v[232:235], a[200:203], a[240:243], v[232:235]
    ds_write_b64 v249, v[228:229] offset:18560
    v_mfma_f32_16x16x32_bf16 v[232:235], a[204:207], a[244:247], v[232:235]
    ds_read_b128 a[240:243], v242 offset:37120
    ds_read_b128 a[244:247], v243 offset:37120
    v_mfma_f32_16x16x32_bf16 v[232:235], a[208:211], a[216:219], v[232:235]
    ds_read_b128 a[216:219], v242 offset:43008
    s_waitcnt lgkmcnt(7)
    v_mfma_f32_16x16x32_bf16 v[232:235], a[212:215], a[220:223], v[232:235]
    ds_read_b128 a[220:223], v243 offset:43008
    s_mov_b32 exec_hi, 0
    buffer_store_dwordx2 v[254:255], v251, s[20:23], s53 offen offset:256 nt
    s_mov_b32 exec_hi, -1
    s_mul_i32 s53, s31, 7
    s_add_u32 s52, s52, s53
    s_add_u32 s52, s52, s32
    s_lshr_b32 s53, s28, 1
    s_sub_u32 s53, s53, 1
    v_exp_f32 v203, v203
    v_cvt_pk_bf16_f32 v232, v232, v233
    v_cvt_pk_bf16_f32 v233, v234, v235
    ds_write_b64 v249, v[232:233] offset:18688
    s_mov_b32 exec_lo, 0
    buffer_store_dwordx4 a[252:255], v250, s[20:23], s55 offen nt
    s_mov_b32 exec_lo, -1
    v_cvt_pk_bf16_f32 v191, v200, v201
    v_cvt_pk_bf16_f32 v194, v202, v203
    ds_read_b128 v[200:203], v245 offset:192
    v_mfma_f32_16x16x32_bf16 v[212:215], v[4:7], v[188:191], v[212:215]
    ds_read_b128 a[252:255], v252 offset:12288
    v_sub_f32 v204, v204, v248
    v_mfma_f32_16x16x32_bf16 v[216:219], v[34:37], v[188:191], v[216:219]
    s_mov_b32 exec_lo, 0
    buffer_store_dwordx2 v[254:255], v251, s[20:23], s55 offen offset:256 nt
    s_mov_b32 exec_lo, -1
    v_mfma_f32_16x16x32_bf16 v[220:223], v[64:67], v[188:191], v[220:223]
    ds_read_b64 v[254:255], v253 offset:12544
    s_mul_i32 s55, s31, 11
    v_mfma_f32_16x16x32_bf16 v[224:227], a[248:251], v[188:191], v[224:227]
    s_add_u32 s54, s54, s55
    s_add_u32 s54, s54, s32
    s_lshr_b32 s55, s28, 1
    v_mfma_f32_16x16x32_bf16 v[212:215], v[8:11], v[192:195], v[212:215]
    s_lshl2_add_u32 s55, s55, 11
    s_mul_i32 s55, s55, s31
    v_sub_f32 v205, v205, v248
    v_mfma_f32_16x16x32_bf16 v[216:219], v[38:41], v[192:195], v[216:219]
    v_exp_f32 v204, v204
    v_mfma_f32_16x16x32_bf16 v[220:223], v[68:71], v[192:195], v[220:223]
    v_exp_f32 v205, v205
    v_mfma_f32_16x16x32_bf16 v[224:227], a[248:251], v[192:195], v[224:227]
    v_sub_f32 v206, v206, v248
    s_waitcnt lgkmcnt(2)
    v_mfma_f32_16x16x32_bf16 v[200:203], v[150:153], v[168:171], v[200:203]
    v_exp_f32 v206, v206
    v_mfma_f32_16x16x32_bf16 v[200:203], v[152:155], v[170:173], v[200:203]
    s_waitcnt lgkmcnt(1)
    buffer_store_dwordx4 a[252:255], v250, s[20:23], s57 offen nt
    s_waitcnt lgkmcnt(0)
    v_sub_f32 v207, v207, v248
    v_exp_f32 v207, v207
    v_cvt_pk_bf16_f32 v180, v204, v205
    v_cvt_pk_bf16_f32 v183, v206, v207
    v_sub_f32 v208, v208, v248
    v_exp_f32 v208, v208
    buffer_store_dwordx2 v[254:255], v251, s[20:23], s57 offen offset:256 nt
    s_mul_i32 s57, s31, 15
    s_add_u32 s56, s56, s57
    s_add_u32 s56, s56, s32
    v_sub_f32 v209, v209, v248
    v_exp_f32 v209, v209
    v_sub_f32 v210, v210, v248
    v_exp_f32 v210, v210
    v_sub_f32 v211, v211, v248
    v_exp_f32 v211, v211
    v_cvt_pk_bf16_f32 v181, v208, v209
    v_cvt_pk_bf16_f32 v184, v210, v211
    v_sub_f32 v196, v196, v248
    v_mfma_f32_16x16x32_bf16 v[212:215], v[12:15], v[180:183], v[212:215]
    v_exp_f32 v196, v196
    v_mfma_f32_16x16x32_bf16 v[216:219], v[42:45], v[180:183], v[216:219]
    v_sub_f32 v197, v197, v248
    v_sub_f32 v200, v200, v248
    v_mfma_f32_16x16x32_bf16 v[220:223], v[72:75], v[180:183], v[220:223]
    v_exp_f32 v197, v197
    v_mfma_f32_16x16x32_bf16 v[224:227], a[248:251], v[180:183], v[224:227]
    v_cvt_pk_bf16_f32 v186, v196, v197
    v_exp_f32 v200, v200
    v_sub_f32 v201, v201, v248
    v_exp_f32 v201, v201
    v_mov_b32 v185, 0
    v_cvt_pk_bf16_f32 v187, v200, v201
    v_add_u32 v204, 0xffffff40, v244
    v_cndmask_b32 v244, v244, v204, vcc
    v_mfma_f32_16x16x32_bf16 v[212:215], v[16:19], v[184:187], v[212:215]
    ds_read_b128 v[196:199], v244 offset:64
    v_add_u32 v205, 0xffffff40, v245
    v_mfma_f32_16x16x32_bf16 v[216:219], v[46:49], v[184:187], v[216:219]
    s_mov_b32 vcc_lo, 0xff00ff
    s_mov_b32 vcc_hi, 0xf000ff
    v_cndmask_b32 v245, v245, v205, vcc
    v_mfma_f32_16x16x32_bf16 v[220:223], v[76:79], v[184:187], v[220:223]
    ds_read_b128 v[204:207], v244 offset:0
    ds_read_b128 v[208:211], v245 offset:0
    v_mfma_f32_16x16x32_bf16 v[224:227], a[248:251], v[184:187], v[224:227]
    ds_read_b128 v[200:203], v245 offset:64
    v_mov_b32 v190, 0
    v_mov_b32 v193, 0
    v_mov_b32 v180, 0
    v_mov_b32 v183, 0
    v_mov_b32 v186, 0
    s_nop 1
    v_rcp_f32 v225, v224
    s_nop 0
    v_mul_f32 v212, v212, v225
    v_mul_f32 v213, v213, v225
    v_mul_f32 v214, v214, v225
    v_mul_f32 v215, v215, v225
    v_cvt_pk_bf16_f32 v212, v212, v213
    v_cvt_pk_bf16_f32 v213, v214, v215
    ds_write_b64 v247, v[212:213] offset:49152
    s_waitcnt lgkmcnt(4)
    v_mfma_f32_16x16x32_bf16 v[196:199], v[114:117], v[174:177], v[196:199]
    v_mul_f32 v216, v216, v225
    v_mul_f32 v217, v217, v225
    v_mfma_f32_16x16x32_bf16 v[196:199], v[116:119], v[176:179], v[196:199]
    s_waitcnt lgkmcnt(3)
    v_mul_f32 v218, v218, v225
    v_mul_f32 v219, v219, v225
    v_mfma_f32_16x16x32_bf16 v[204:207], v[138:141], v[174:177], v[204:207]
    s_waitcnt lgkmcnt(2)
    v_cvt_pk_bf16_f32 v216, v216, v217
    v_cvt_pk_bf16_f32 v217, v218, v219
    v_mfma_f32_16x16x32_bf16 v[204:207], v[140:143], v[176:179], v[204:207]
    ds_write_b64 v247, v[216:217] offset:49280
    v_mfma_f32_16x16x32_bf16 v[208:211], v[144:147], v[174:177], v[208:211]
    s_waitcnt lgkmcnt(2)
    v_mul_f32 v220, v220, v225
    v_mul_f32 v221, v221, v225
    v_mfma_f32_16x16x32_bf16 v[208:211], v[146:149], v[176:179], v[208:211]
    v_mul_f32 v222, v222, v225
    v_mul_f32 v223, v223, v225
    v_mfma_f32_16x16x32_bf16 v[200:203], v[150:153], v[174:177], v[200:203]
    v_cvt_pk_bf16_f32 v220, v220, v221
    v_cvt_pk_bf16_f32 v221, v222, v223
    v_mfma_f32_16x16x32_bf16 v[200:203], v[152:155], v[176:179], v[200:203]
    ds_write_b64 v247, v[220:221] offset:49408
    v_mfma_f32_16x16x32_bf16 v[236:239], a[144:147], a[224:227], 0
    v_max_f32 v248, v204, v205
    v_max3_f32 v248, v248, v206, v207
    v_mfma_f32_16x16x32_bf16 v[236:239], a[148:151], a[228:231], v[236:239]
    ds_read_b128 v[204:207], v244 offset:128
    v_max3_f32 v248, v248, v208, v209
    v_mfma_f32_16x16x32_bf16 v[236:239], a[152:155], a[232:235], v[236:239]
    v_max3_f32 v248, v248, v210, v211
    v_max3_f32 v248, v248, v196, v197
    v_mfma_f32_16x16x32_bf16 v[236:239], a[156:159], a[236:239], v[236:239]
    ds_read_b128 v[208:211], v245 offset:128
    v_max3_f32 v248, v248, v198, v199
    v_mfma_f32_16x16x32_bf16 v[236:239], a[160:163], a[240:243], v[236:239]
    ds_read_b128 v[196:199], v244 offset:0
    v_max3_f32 v248, v248, v200, v201
    v_mfma_f32_16x16x32_bf16 v[236:239], a[164:167], a[244:247], v[236:239]
    v_max3_f32 v248, v248, v202, v203
    v_mfma_f32_16x16x32_bf16 v[228:231], a[168:171], a[224:227], 0
    ds_read_b128 v[200:203], v245 offset:0
    v_mfma_f32_16x16x32_bf16 v[228:231], a[172:175], a[228:231], v[228:231]
    v_mfma_f32_16x16x32_bf16 v[228:231], a[176:179], a[232:235], v[228:231]
    v_mfma_f32_16x16x32_bf16 v[228:231], a[180:183], a[236:239], v[228:231]
    v_mfma_f32_16x16x32_bf16 v[228:231], a[184:187], a[240:243], v[228:231]
    s_waitcnt lgkmcnt(3)
    v_cvt_pk_bf16_f32 v236, v236, v237
    v_cvt_pk_bf16_f32 v237, v238, v239
    v_mfma_f32_16x16x32_bf16 v[204:207], v[120:123], v[174:177], v[204:207]
    ds_write_b64 v249, v[236:237] offset:24576
    v_mfma_f32_16x16x32_bf16 v[204:207], v[122:125], v[176:179], v[204:207]
    s_waitcnt lgkmcnt(2)
    v_mfma_f32_16x16x32_bf16 v[208:211], v[156:159], v[174:177], v[208:211]
    v_mfma_f32_16x16x32_bf16 v[208:211], v[158:161], v[176:179], v[208:211]
    s_waitcnt lgkmcnt(1)
    v_mfma_f32_16x16x32_bf16 v[196:199], v[138:141], v[174:177], v[196:199]
    v_mfma_f32_16x16x32_bf16 v[196:199], v[140:143], v[176:179], v[196:199]
    v_mfma_f32_16x16x32_bf16 v[200:203], v[144:147], v[174:177], v[200:203]
    v_mfma_f32_16x16x32_bf16 v[200:203], v[146:149], v[176:179], v[200:203]
    v_max3_f32 v248, v248, v204, v205
    v_max3_f32 v248, v248, v206, v207
    v_mfma_f32_16x16x32_bf16 v[228:231], a[188:191], a[244:247], v[228:231]
    ds_read_b128 v[204:207], v244 offset:64
    v_max3_f32 v248, v248, v208, v209
    v_mfma_f32_16x16x32_bf16 v[232:235], a[192:195], a[224:227], 0
    ds_read_b128 a[224:227], v242 offset:43136
    v_max3_f32 v248, v248, v210, v211
    v_mfma_f32_16x16x32_bf16 v[232:235], a[196:199], a[228:231], v[232:235]
    ds_read_b128 a[228:231], v243 offset:43136
    ds_read_b128 v[208:211], v245 offset:64
    v_mfma_f32_16x16x32_bf16 v[232:235], a[200:203], a[232:235], v[232:235]
    ds_read_b128 a[232:235], v242 offset:43264
    v_cvt_pk_bf16_f32 v228, v228, v229
    v_mfma_f32_16x16x32_bf16 v[232:235], a[204:207], a[236:239], v[232:235]
    ds_read_b128 a[236:239], v243 offset:43264
    v_cvt_pk_bf16_f32 v229, v230, v231
    v_mfma_f32_16x16x32_bf16 v[232:235], a[208:211], a[240:243], v[232:235]
    ds_write_b64 v249, v[228:229] offset:24704
    v_mfma_f32_16x16x32_bf16 v[232:235], a[212:215], a[244:247], v[232:235]
    v_mov_b32 v225, v248
    v_mfma_f32_16x16x32_bf16 v[236:239], a[144:147], a[216:219], 0
    v_mfma_f32_16x16x32_bf16 v[236:239], a[148:151], a[220:223], v[236:239]
    s_waitcnt lgkmcnt(6)
    v_permlane16_swap_b32 v248, v225
    v_max_f32 v248, v248, v225
    v_mfma_f32_16x16x32_bf16 v[204:207], v[114:117], v[174:177], v[204:207]
    s_waitcnt lgkmcnt(5)
    v_cvt_pk_bf16_f32 v232, v232, v233
    v_cvt_pk_bf16_f32 v233, v234, v235
    v_mfma_f32_16x16x32_bf16 v[204:207], v[116:119], v[176:179], v[204:207]
    ds_write_b64 v249, v[232:233] offset:24832
    v_mfma_f32_16x16x32_bf16 v[236:239], a[152:155], a[224:227], v[236:239]
    s_waitcnt lgkmcnt(4)
    v_mov_b32 v225, v248
    v_mfma_f32_16x16x32_bf16 v[208:211], v[150:153], v[174:177], v[208:211]
    v_mfma_f32_16x16x32_bf16 v[208:211], v[152:155], v[176:179], v[208:211]
    v_permlane32_swap_b32 v248, v225
    v_max_f32 v248, v248, v225
    v_mfma_f32_16x16x32_bf16 v[236:239], a[156:159], a[228:231], v[236:239]
    s_waitcnt lgkmcnt(3)
    v_sub_f32 v196, v196, v248
    v_sub_f32 v197, v197, v248
    v_mfma_f32_16x16x32_bf16 v[236:239], a[160:163], a[232:235], v[236:239]
    s_waitcnt lgkmcnt(2)
    v_exp_f32 v196, v196
    v_mfma_f32_16x16x32_bf16 v[236:239], a[164:167], a[236:239], v[236:239]
    v_exp_f32 v197, v197
    v_mfma_f32_16x16x32_bf16 v[228:231], a[168:171], a[216:219], 0
    v_sub_f32 v198, v198, v248
    v_sub_f32 v199, v199, v248
    v_mfma_f32_16x16x32_bf16 v[228:231], a[172:175], a[220:223], v[228:231]
    s_waitcnt lgkmcnt(0)
    s_barrier
    v_cvt_pk_bf16_f32 v188, v196, v197
    v_mfma_f32_16x16x32_bf16 v[228:231], a[176:179], a[224:227], v[228:231]
    ds_read_b128 a[240:243], v242 offset:49152
    v_cvt_pk_bf16_f32 v236, v236, v237
    v_mfma_f32_16x16x32_bf16 v[228:231], a[180:183], a[228:231], v[228:231]
    ds_read_b128 a[244:247], v243 offset:49152
    v_cvt_pk_bf16_f32 v237, v238, v239
    v_mfma_f32_16x16x32_bf16 v[228:231], a[184:187], a[232:235], v[228:231]
    ds_write_b64 v249, v[236:237] offset:0
    v_mfma_f32_16x16x32_bf16 v[228:231], a[188:191], a[236:239], v[228:231]
    ds_read_b128 a[252:255], v252 offset:18432
    ds_read_b64 v[254:255], v253 offset:18688
    v_mfma_f32_16x16x32_bf16 v[232:235], a[192:195], a[216:219], 0
    ds_read_b128 a[216:219], v242 offset:49280
    v_sub_f32 v200, v200, v248
    v_mfma_f32_16x16x32_bf16 v[232:235], a[196:199], a[220:223], v[232:235]
    ds_read_b128 a[220:223], v243 offset:49280
    v_sub_f32 v201, v201, v248
    v_mfma_f32_16x16x32_bf16 v[232:235], a[200:203], a[224:227], v[232:235]
    ds_read_b128 a[224:227], v242 offset:49408
    v_cvt_pk_bf16_f32 v228, v228, v229
    v_mfma_f32_16x16x32_bf16 v[232:235], a[204:207], a[228:231], v[232:235]
    ds_read_b128 a[228:231], v243 offset:49408
    v_cvt_pk_bf16_f32 v229, v230, v231
    v_mfma_f32_16x16x32_bf16 v[232:235], a[208:211], a[232:235], v[232:235]
    ds_write_b64 v249, v[228:229] offset:128
    v_mfma_f32_16x16x32_bf16 v[232:235], a[212:215], a[236:239], v[232:235]
    s_waitcnt lgkmcnt(9)
    v_exp_f32 v198, v198
    v_mfma_f32_16x16x32_bf16 v[236:239], a[144:147], a[240:243], 0
    s_waitcnt lgkmcnt(8)
    v_exp_f32 v199, v199
    v_mfma_f32_16x16x32_bf16 v[236:239], a[148:151], a[244:247], v[236:239]
    v_cvt_pk_bf16_f32 v191, v198, v199
    s_waitcnt lgkmcnt(6)
    v_mfma_f32_16x16x32_bf16 v[228:231], a[168:171], a[240:243], 0
    ds_read_b128 v[196:199], v244 offset:128
    v_cvt_pk_bf16_f32 v232, v232, v233
    v_mfma_f32_16x16x32_bf16 v[228:231], a[172:175], a[244:247], v[228:231]
    s_waitcnt lgkmcnt(5)
    v_cvt_pk_bf16_f32 v233, v234, v235
    v_sub_f32 v202, v202, v248
    v_mfma_f32_16x16x32_bf16 v[236:239], a[152:155], a[216:219], v[236:239]
    ds_write_b64 v249, v[232:233] offset:256
    v_mfma_f32_16x16x32_bf16 v[228:231], a[176:179], a[216:219], v[228:231]
    buffer_store_dwordx4 a[252:255], v250, s[20:23], s52 offen nt
    v_mfma_f32_16x16x32_bf16 v[232:235], a[192:195], a[240:243], 0
    s_waitcnt lgkmcnt(5)
    ds_read_b128 a[252:255], v252 offset:24576
    v_mfma_f32_16x16x32_bf16 v[236:239], a[156:159], a[220:223], v[236:239]
    s_waitcnt lgkmcnt(5)
    v_exp_f32 v200, v200
    v_mfma_f32_16x16x32_bf16 v[236:239], a[160:163], a[224:227], v[236:239]
    buffer_store_dwordx2 v[254:255], v251, s[20:23], s52 offen offset:256 nt
    v_mfma_f32_16x16x32_bf16 v[228:231], a[180:183], a[220:223], v[228:231]
    ds_read_b64 v[254:255], v253 offset:24832
    s_lshr_b32 s52, s28, 1
    v_mfma_f32_16x16x32_bf16 v[228:231], a[184:187], a[224:227], v[228:231]
    s_lshl2_add_u32 s52, s52, 3
    s_mul_i32 s52, s52, s31
    s_add_u32 s51, s51, s52
    v_mfma_f32_16x16x32_bf16 v[232:235], a[196:199], a[244:247], v[232:235]
    s_add_u32 s51, s51, s32
    v_exp_f32 v201, v201
    v_mfma_f32_16x16x32_bf16 v[232:235], a[200:203], a[216:219], v[232:235]
    s_waitcnt lgkmcnt(3)
    v_exp_f32 v202, v202
    v_mfma_f32_16x16x32_bf16 v[196:199], v[120:123], v[174:177], v[196:199]
    v_sub_f32 v203, v203, v248
    v_cvt_pk_bf16_f32 v189, v200, v201
    v_mfma_f32_16x16x32_bf16 v[196:199], v[122:125], v[176:179], v[196:199]
    v_exp_f32 v203, v203
    v_mfma_f32_16x16x32_bf16 v[212:215], v[12:15], v[188:191], 0
    s_waitcnt lgkmcnt(1)
    v_cvt_pk_bf16_f32 v192, v202, v203
    v_sub_f32 v204, v204, v248
    v_mfma_f32_16x16x32_bf16 v[216:219], v[42:45], v[188:191], 0
    ds_read_b128 v[200:203], v245 offset:128
    v_sub_f32 v205, v205, v248
    v_mfma_f32_16x16x32_bf16 v[220:223], v[72:75], v[188:191], 0
    buffer_store_dwordx4 a[252:255], v250, s[20:23], s54 offen nt
    v_mfma_f32_16x16x32_bf16 v[224:227], a[248:251], v[188:191], 0
    s_waitcnt lgkmcnt(1)
    v_exp_f32 v204, v204
    v_mfma_f32_16x16x32_bf16 v[236:239], a[164:167], a[228:231], v[236:239]
    v_exp_f32 v205, v205
    v_mfma_f32_16x16x32_bf16 v[228:231], a[188:191], a[228:231], v[228:231]
    buffer_store_dwordx2 v[254:255], v251, s[20:23], s54 offen offset:256 nt
    v_mfma_f32_16x16x32_bf16 v[232:235], a[204:207], a[220:223], v[232:235]
    s_and_b32 s54, s28, 1
    s_add_u32 s54, s54, 15
    s_mul_i32 s54, s54, s30
    v_mfma_f32_16x16x32_bf16 v[232:235], a[208:211], a[224:227], v[232:235]
    s_add_u32 s54, s54, s55
    v_cvt_pk_bf16_f32 v236, v236, v237
    v_cvt_pk_bf16_f32 v237, v238, v239
    v_mfma_f32_16x16x32_bf16 v[232:235], a[212:215], a[228:231], v[232:235]
    ds_write_b64 v249, v[236:237] offset:6144
    s_waitcnt lgkmcnt(1)
    v_mfma_f32_16x16x32_bf16 v[200:203], v[156:159], v[174:177], v[200:203]
    s_add_u32 s54, s54, s32
    v_cvt_pk_bf16_f32 v228, v228, v229
    v_cvt_pk_bf16_f32 v229, v230, v231
    v_mfma_f32_16x16x32_bf16 v[200:203], v[158:161], v[176:179], v[200:203]
    ds_write_b64 v249, v[228:229] offset:6272
    v_cvt_pk_bf16_f32 v232, v232, v233
    v_cvt_pk_bf16_f32 v233, v234, v235
    ds_write_b64 v249, v[232:233] offset:6400
    v_sub_f32 v206, v206, v248
    v_exp_f32 v206, v206
    v_sub_f32 v207, v207, v248
    v_exp_f32 v207, v207
    v_cvt_pk_bf16_f32 v194, v204, v205
    v_cvt_pk_bf16_f32 v181, v206, v207
    v_sub_f32 v208, v208, v248
    v_exp_f32 v208, v208
    v_sub_f32 v209, v209, v248
    v_exp_f32 v209, v209
    v_sub_f32 v210, v210, v248
    v_exp_f32 v210, v210
    v_sub_f32 v211, v211, v248
    v_exp_f32 v211, v211
    v_cvt_pk_bf16_f32 v195, v208, v209
    v_cvt_pk_bf16_f32 v182, v210, v211
    v_sub_f32 v196, v196, v248
    v_mfma_f32_16x16x32_bf16 v[212:215], v[16:19], v[192:195], v[212:215]
    v_exp_f32 v196, v196
    v_mfma_f32_16x16x32_bf16 v[216:219], v[46:49], v[192:195], v[216:219]
    v_sub_f32 v197, v197, v248
    v_sub_f32 v198, v198, v248
    v_mfma_f32_16x16x32_bf16 v[220:223], v[76:79], v[192:195], v[220:223]
    v_exp_f32 v197, v197
    v_mfma_f32_16x16x32_bf16 v[224:227], a[248:251], v[192:195], v[224:227]
    v_exp_f32 v198, v198
    v_mfma_f32_16x16x32_bf16 v[212:215], v[20:23], v[180:183], v[212:215]
    v_sub_f32 v199, v199, v248
    v_cvt_pk_bf16_f32 v184, v196, v197
    v_mfma_f32_16x16x32_bf16 v[216:219], v[50:53], v[180:183], v[216:219]
    v_exp_f32 v199, v199
    v_mfma_f32_16x16x32_bf16 v[220:223], v[80:83], v[180:183], v[220:223]
    v_cvt_pk_bf16_f32 v187, v198, v199
    v_sub_f32 v200, v200, v248
    v_mfma_f32_16x16x32_bf16 v[224:227], a[248:251], v[180:183], v[224:227]
    v_exp_f32 v200, v200
    v_sub_f32 v201, v201, v248
    v_exp_f32 v201, v201
    v_sub_f32 v202, v202, v248
    v_exp_f32 v202, v202
    v_sub_f32 v203, v203, v248
    v_exp_f32 v203, v203
    v_cvt_pk_bf16_f32 v185, v200, v201
    v_cvt_pk_bf16_f32 v188, v202, v203
    v_mov_b32 v189, 0
    v_mfma_f32_16x16x32_bf16 v[212:215], v[24:27], v[184:187], v[212:215]
    v_mov_b32 v191, 0
    v_mfma_f32_16x16x32_bf16 v[216:219], v[54:57], v[184:187], v[216:219]
    v_mfma_f32_16x16x32_bf16 v[220:223], v[84:87], v[184:187], v[220:223]
    v_mfma_f32_16x16x32_bf16 v[224:227], a[248:251], v[184:187], v[224:227]
    v_mfma_f32_16x16x32_bf16 v[212:215], v[28:31], v[188:191], v[212:215]
    v_mfma_f32_16x16x32_bf16 v[216:219], v[58:61], v[188:191], v[216:219]
    v_mfma_f32_16x16x32_bf16 v[220:223], v[88:91], v[188:191], v[220:223]
    v_mfma_f32_16x16x32_bf16 v[224:227], a[248:251], v[188:191], v[224:227]
    s_nop 7
    v_rcp_f32 v225, v224
    s_nop 0
    v_mul_f32 v212, v212, v225
    v_mul_f32 v213, v213, v225
    v_mul_f32 v214, v214, v225
    v_mul_f32 v215, v215, v225
    v_cvt_pk_bf16_f32 v212, v212, v213
    v_cvt_pk_bf16_f32 v213, v214, v215
    ds_write_b64 v247, v[212:213] offset:55296
    v_mul_f32 v216, v216, v225
    v_mul_f32 v217, v217, v225
    v_mul_f32 v218, v218, v225
    v_mul_f32 v219, v219, v225
    v_cvt_pk_bf16_f32 v216, v216, v217
    v_cvt_pk_bf16_f32 v217, v218, v219
    ds_write_b64 v247, v[216:217] offset:55424
    v_mul_f32 v220, v220, v225
    v_mul_f32 v221, v221, v225
    v_mul_f32 v222, v222, v225
    v_mul_f32 v223, v223, v225
    v_cvt_pk_bf16_f32 v220, v220, v221
    v_cvt_pk_bf16_f32 v221, v222, v223
    ds_write_b64 v247, v[220:221] offset:55552
    s_waitcnt lgkmcnt(0)
    s_barrier
    ds_read_b128 a[232:235], v242 offset:55296
    ds_read_b128 a[236:239], v243 offset:55296
    ds_read_b128 a[240:243], v242 offset:55424
    ds_read_b128 a[244:247], v243 offset:55424
    ds_read_b128 a[216:219], v242 offset:55552
    ds_read_b128 a[220:223], v243 offset:55552
    ds_read_b128 a[252:255], v252 offset:0
    ds_read_b64 v[254:255], v253 offset:256
    s_waitcnt lgkmcnt(7)
    v_mfma_f32_16x16x32_bf16 v[236:239], a[144:147], a[232:235], 0
    v_mfma_f32_16x16x32_bf16 v[228:231], a[168:171], a[232:235], 0
    s_waitcnt lgkmcnt(6)
    v_mfma_f32_16x16x32_bf16 v[236:239], a[148:151], a[236:239], v[236:239]
    s_waitcnt lgkmcnt(5)
    v_mfma_f32_16x16x32_bf16 v[236:239], a[152:155], a[240:243], v[236:239]
    s_waitcnt lgkmcnt(4)
    v_mfma_f32_16x16x32_bf16 v[236:239], a[156:159], a[244:247], v[236:239]
    s_waitcnt lgkmcnt(3)
    v_mfma_f32_16x16x32_bf16 v[236:239], a[160:163], a[216:219], v[236:239]
    s_waitcnt lgkmcnt(2)
    v_mfma_f32_16x16x32_bf16 v[236:239], a[164:167], a[220:223], v[236:239]
    s_waitcnt lgkmcnt(0)
    v_mfma_f32_16x16x32_bf16 v[228:231], a[172:175], a[236:239], v[228:231]
    s_mov_b32 exec_hi, 0
    buffer_store_dwordx4 a[252:255], v250, s[20:23], s56 offen nt
    s_mov_b32 exec_hi, -1
    v_mfma_f32_16x16x32_bf16 v[228:231], a[176:179], a[240:243], v[228:231]
    v_mfma_f32_16x16x32_bf16 v[228:231], a[180:183], a[244:247], v[228:231]
    ds_read_b128 a[252:255], v252 offset:6144
    v_mfma_f32_16x16x32_bf16 v[228:231], a[184:187], a[216:219], v[228:231]
    s_mov_b32 exec_hi, 0
    buffer_store_dwordx2 v[254:255], v251, s[20:23], s56 offen offset:256 nt
    s_mov_b32 exec_hi, -1
    v_mfma_f32_16x16x32_bf16 v[228:231], a[188:191], a[220:223], v[228:231]
    ds_read_b64 v[254:255], v253 offset:6400
    v_cvt_pk_bf16_f32 v236, v236, v237
    v_mfma_f32_16x16x32_bf16 v[232:235], a[192:195], a[232:235], 0
    v_cvt_pk_bf16_f32 v237, v238, v239
    v_mfma_f32_16x16x32_bf16 v[232:235], a[196:199], a[236:239], v[232:235]
    ds_write_b64 v249, v[236:237] offset:12288
    v_mfma_f32_16x16x32_bf16 v[232:235], a[200:203], a[240:243], v[232:235]
    v_mfma_f32_16x16x32_bf16 v[232:235], a[204:207], a[244:247], v[232:235]
    v_cvt_pk_bf16_f32 v228, v228, v229
    v_cvt_pk_bf16_f32 v229, v230, v231
    v_mfma_f32_16x16x32_bf16 v[232:235], a[208:211], a[216:219], v[232:235]
    ds_write_b64 v249, v[228:229] offset:12416
    v_mfma_f32_16x16x32_bf16 v[232:235], a[212:215], a[220:223], v[232:235]
    s_waitcnt lgkmcnt(3)
    buffer_store_dwordx4 a[252:255], v250, s[20:23], s51 offen nt
    s_waitcnt lgkmcnt(2)
    s_nop 4
    v_cvt_pk_bf16_f32 v232, v232, v233
    v_cvt_pk_bf16_f32 v233, v234, v235
    ds_write_b64 v249, v[232:233] offset:12544
    buffer_store_dwordx2 v[254:255], v251, s[20:23], s51 offen offset:256 nt
    s_waitcnt lgkmcnt(0)
    s_barrier
    ds_read_b128 a[252:255], v252 offset:12288
    ds_read_b64 v[254:255], v253 offset:12544
    s_waitcnt lgkmcnt(1)
    s_mov_b32 exec_hi, s53
    buffer_store_dwordx4 a[252:255], v250, s[20:23], s54 offen nt
    s_mov_b32 exec_hi, -1
    s_waitcnt lgkmcnt(0)
    s_mov_b32 exec_hi, s53
    buffer_store_dwordx2 v[254:255], v251, s[20:23], s54 offen offset:256 nt
    s_mov_b32 exec_hi, -1
    s_endpgm
.section .rodata,"a"
.p2align 6
.amdhsa_kernel standalone__neighborhood_dinat__vision_kernel
  .amdhsa_next_free_vgpr 512
  .amdhsa_next_free_sgpr 102
  .amdhsa_accum_offset 256
  .amdhsa_group_segment_fixed_size 0
  .amdhsa_kernarg_size 56
  .amdhsa_user_sgpr_count 2
  .amdhsa_user_sgpr_kernarg_segment_ptr 1
  .amdhsa_system_sgpr_workgroup_id_x 1
.end_amdhsa_kernel
```

```asm
; @launch grid=(256,1,1) block=(256,1,1) lds=163840
.amdgcn_target "amdgcn-amd-amdhsa--gfx950"
.text
.globl standalone__neighborhood_dinat__vision_kernel
.p2align 12
.p2align 8
.type standalone__neighborhood_dinat__vision_kernel,@function
standalone__neighborhood_dinat__vision_kernel:
    s_cmpk_ge_u32 s2, 0x100
    s_cbranch_scc1 L_exit
    s_load_dwordx2 s[4:5], s[0:1], 0
    s_load_dwordx2 s[8:9], s[0:1], 8
    s_load_dwordx2 s[12:13], s[0:1], 16
    s_load_dwordx2 s[16:17], s[0:1], 24
    s_load_dwordx2 s[20:21], s[0:1], 32
    s_getpc_b64 s[68:69]
    v_lshrrev_b32 v4, 6, v0
    s_bfe_u32 s65, s2, 0x30003
    v_readfirstlane_b32 s28, v4
    s_lshl_b32 s66, s65, 13
    v_lshl_add_u32 v0, v0, 5, s66
    global_load_dword v11, v0, s[68:69]
    s_lshr_b32 s66, s2, 6
    s_and_b32 s67, s2, 1
    s_lshl2_add_u32 s64, s67, s66
    s_mov_b32 s30, 0x2a000
    s_mul_i32 s66, s64, 14
    s_bitcmp1_b32 s64, 0
    s_cselect_b32 s67, 16, -3
    s_cselect_b32 s35, -1, 1
    s_add_u32 s66, s66, s67
    s_mul_i32 s32, s66, s30
    s_mul_i32 s40, s30, 0x6f
    s_mul_i32 s30, s30, s35
    s_mul_i32 s66, s65, 28
    s_cmp_eq_u32 s65, 7
    s_cselect_b32 s36, 1, 0
    s_cselect_b32 s67, 18, -6
    s_cselect_b32 s31, -3, 3
    s_add_u32 s66, s66, s67
    s_bfe_u32 s67, s2, 0x10001
    s_add_u32 s66, s66, s67
    s_bfe_u32 s67, s2, 0x10002
    s_mulk_i32 s67, 0xe0
    s_add_u32 s66, s66, s67
    s_mulk_i32 s66, 0x180
    s_lshl_b32 s67, s36, 11
    s_sub_u32 s66, s66, s67
    s_lshl_b32 s45, s31, 11
    s_lshl_b32 s31, s31, 8
    s_mul_i32 s67, s30, s28
    s_add_u32 s67, s67, s32
    s_add_u32 s32, s32, s66
    s_min_i32 s40, s40, s67
    s_max_i32 s40, s40, 0
    s_add_u32 s40, s40, s66
    s_add_u32 s67, s67, s66
    s_lshl2_add_u32 s41, s30, s67
    s_mul_i32 s46, s28, 0x1e00
    s_mul_i32 s29, s28, 0x3000
    s_add_u32 s29, s29, 0x16800
    s_mul_i32 s39, s28, 0x60
    s_mov_b32 s6, 0x1260000
    s_mov_b32 s7, 0x20000
    s_mov_b32 s10, 0x36000
    s_mov_b32 s11, 0x20000
    v_mbcnt_lo_u32_b32 v1, -1, 0
    v_mbcnt_hi_u32_b32 v1, -1, v1
    s_lshl_b32 s51, s28, 1
    s_add_u32 s50, s31, 0xfffffe80
    s_mul_i32 s52, s36, 0x1d00
    v_lshrrev_b32 v2, 3, v1
    v_and_b32 v3, 7, v1
    v_xor_b32 v3, s51, v3
    v_lshl_add_u32 v4, v2, 7, s52
    v_mul_u32_u24 v8, 11, v2
    v_bfe_u32 v9, v8, 6, 1
    v_lshrrev_b32 v8, 5, v8
    v_xor_b32 v9, v3, v9
    v_mad_i32_i24 v8, v8, s50, v4
    v_lshl_add_u32 v168, v9, 4, v8
    v_add_u32 v8, 8, v2
    v_mul_u32_u24 v8, 11, v8
    v_bfe_u32 v9, v8, 6, 1
    v_lshrrev_b32 v8, 5, v8
    v_xor_b32 v9, v3, v9
    v_mad_i32_i24 v8, v8, s50, v4
    v_lshl_add_u32 v169, v9, 4, v8
    v_add_u32 v8, 16, v2
    v_mul_u32_u24 v8, 11, v8
    v_bfe_u32 v9, v8, 6, 1
    v_lshrrev_b32 v8, 5, v8
    v_xor_b32 v9, v3, v9
    v_mad_i32_i24 v8, v8, s50, v4
    v_lshl_add_u32 v170, v9, 4, v8
    s_movk_i32 s53, 0x480
    s_movk_i32 s54, -96
    v_lshrrev_b32 v10, 1, v1
    v_lshlrev_b32 v12, 4, v1
    v_mul_u32_u24 v8, 43, v10
    v_lshrrev_b32 v9, 8, v8
    v_lshrrev_b32 v8, 7, v8
    v_and_b32 v9, 4, v9
    v_xor_b32 v9, v8, v9
    v_mad_i32_i24 v8, v8, s54, v12
    v_mad_u32_u24 v172, v9, s53, v8
    v_add_u32 v8, 32, v10
    v_mul_u32_u24 v8, 43, v8
    v_lshrrev_b32 v9, 8, v8
    v_lshrrev_b32 v8, 7, v8
    v_and_b32 v9, 4, v9
    v_xor_b32 v9, v8, v9
    v_mad_i32_i24 v8, v8, s54, v12
    v_mad_u32_u24 v173, v9, s53, v8
    v_add_u32 v8, 64, v10
    v_mul_u32_u24 v8, 43, v8
    v_lshrrev_b32 v9, 8, v8
    v_lshrrev_b32 v8, 7, v8
    v_and_b32 v9, 4, v9
    v_xor_b32 v9, v8, v9
    v_mad_i32_i24 v8, v8, s54, v12
    v_mad_u32_u24 v174, v9, s53, v8
    s_waitcnt lgkmcnt(0)
    s_add_u32 m0, s46, 0xc00
    s_add_u32 s59, s40, s45
    buffer_load_dwordx4 v168, s[4:7], s59 offen lds
    s_add_u32 m0, s29, 0
    s_add_u32 s60, s39, 0x180
    buffer_load_dwordx4 v172, s[8:11], s60 offen lds
    s_add_u32 m0, s46, 0xc00
    s_add_u32 s52, s40, 0
    buffer_load_dwordx4 v169, s[4:7], s59 offen offset:1024 lds
    s_add_u32 m0, s29, 0
    v_add_u32 v5, s52, v168
    buffer_load_dwordx4 v173, s[8:11], s60 offen offset:1024 lds
    s_add_u32 m0, s46, 0xc00
    v_max_i32 v5, 0, v5
    buffer_load_dwordx4 v170, s[4:7], s59 offen offset:2048 lds
    s_add_u32 m0, s29, 0
    s_add_u32 s53, s40, 0x400
    buffer_load_dwordx4 v174, s[8:11], s60 offen offset:2048 lds
    s_add_u32 m0, s46, 0
    v_add_u32 v6, s53, v169
    buffer_load_dwordx4 v5, s[4:7], 0 offen lds
    s_add_u32 m0, s46, 0x400
    v_max_i32 v6, 0, v6
    buffer_load_dwordx4 v6, s[4:7], 0 offen lds
    s_add_u32 s54, s40, 0x800
    s_add_u32 m0, s46, 0x800
    v_add_u32 v7, s54, v170
    v_max_i32 v7, 0, v7
    buffer_load_dwordx4 v7, s[4:7], 0 offen lds
    s_add_u32 m0, s29, 0xc00
    s_add_u32 s61, s39, 0x9180
    buffer_load_dwordx4 v172, s[8:11], s61 offen lds
    buffer_load_dwordx4 v173, s[8:11], s61 offen offset:1024 lds
    buffer_load_dwordx4 v174, s[8:11], s61 offen offset:2048 lds
    s_add_u32 m0, s29, 0x1800
    s_mov_b32 s33, 0
    s_add_u32 s66, s64, 1
    s_and_b32 s66, s66, 6
    s_cselect_b32 s33, 0, 3
    s_add_u32 s66, s65, 1
    s_and_b32 s66, s66, 6
    s_cselect_b32 s34, 0, 1
    s_cmp_lt_i32 s30, 0
    s_cselect_b32 s35, 1, 0
    s_cselect_b32 s49, -1, 1
    s_mul_i32 s49, s49, 0x1c0
    s_cselect_b32 s48, 0, 0x4e
    s_mul_i32 s66, s28, 0x152
    s_add_u32 s48, s48, s66
    s_lshl2_add_u32 s42, s30, s41
    s_lshl2_add_u32 s43, s30, s42
    s_lshl2_add_u32 s44, s30, s43
    s_mul_i32 s66, s36, 0x1400
    s_add_u32 s32, s32, s66
    s_mul_i32 s37, s28, 0x1180
    s_add_u32 s37, s37, 0x239c0
    s_mov_b32 s38, 0x3e553b95
    s_mov_b32 s3, 0x3dd53b95
    s_mov_b32 s14, 0x12000
    s_mov_b32 s15, 0x20000
    s_mov_b32 s18, 0x548
    s_mov_b32 s19, 0x20000
    s_mov_b32 s22, 0x1260000
    s_mov_b32 s23, 0x20000
    s_mov_b32 s26, 0x1000000
    s_mov_b32 s27, 0x20000
    s_add_u32 s62, s39, 0x12180
    s_add_u32 s63, s39, 0x1b180
    v_and_b32 v13, 15, v1
    v_lshrrev_b32 v14, 4, v1
    v_lshrrev_b32 v15, 2, v13
    v_and_b32 v17, 1, v14
    v_lshl_add_u32 v18, v14, 3, v15
    v_xor_b32 v19, 0, v17
    v_lshl_add_u32 v19, v19, 2, v18
    v_and_b32 v16, 3, v13
    v_mul_u32_u24 v19, 0x60, v19
    v_lshl_add_u32 v19, v16, 3, v19
    v_add_u32 v249, s29, v19
    v_xor_b32 v19, 1, v17
    v_lshl_add_u32 v19, v19, 2, v18
    v_mov_b32 v17, v15
    v_and_b32 v18, 3, v17
    v_lshlrev_b32 v18, 1, v18
    v_bfe_u32 v241, v16, 1, 1
    v_or_b32 v18, v18, v241
    v_mul_u32_u24 v17, 0x1e00, v17
    v_xor_b32 v18, v18, v14
    v_lshl_add_u32 v17, v18, 4, v17
    v_mul_u32_u24 v19, 0x60, v19
    v_mul_u32_u24 v18, 0x180, v16
    v_lshl_add_u32 v19, v16, 3, v19
    v_add_u32 v240, v17, v18
    v_add_u32 v250, s29, v19
    v_xor_b32 v241, 64, v240
    s_add_u32 s59, s41, s45
    s_add_u32 s60, s39, 0x24180
    s_add_u32 s61, s39, 0x2d180
    s_and_b32 s65, s48, 0xfff0
    s_lshr_b32 s55, s2, 3
    s_lshl2_add_u32 s55, s55, s28
    s_mul_i32 s55, s55, 0x240
    s_lshl1_add_u32 s58, s45, s40
    s_add_u32 s56, s28, 3
    s_mul_i32 s57, s31, 3
    s_mul_i32 s56, s56, s30
    s_add_u32 s56, s56, s57
    s_add_u32 s56, s56, s32
    s_add_u32 s51, s28, 3
    s_mul_i32 s52, s31, 11
    s_mul_i32 s51, s51, s30
    s_add_u32 s51, s51, s52
    s_add_u32 s51, s51, s32
    s_add_u32 s53, s28, 3
    s_mul_i32 s54, s31, 7
    s_mul_i32 s53, s53, s30
    s_add_u32 s53, s53, s54
    s_add_u32 s53, s53, s32
    s_add_u32 s57, s28, 7
    s_mul_i32 s57, s57, s30
    s_add_u32 s52, s28, 7
    s_mul_i32 s52, s52, s30
    s_add_u32 s54, s28, 11
    s_mul_i32 s54, s54, s30
    buffer_load_dwordx4 v172, s[8:11], s62 offen lds
    s_mov_b64 exec, 0
    s_cmp_eq_u32 s28, 0
    s_cbranch_scc1 L_h1
    s_cmp_eq_u32 s28, 1
    s_cbranch_scc1 L_h2
    s_cmp_eq_u32 s28, 2
    s_cbranch_scc1 L_h3
    s_branch L_h4
    L_hback:
    s_mov_b64 exec, -1
    buffer_load_dwordx4 v173, s[8:11], s62 offen offset:1024 lds
    buffer_load_dwordx4 v174, s[8:11], s62 offen offset:2048 lds
    s_add_u32 m0, s46, 0x7800
    s_add_u32 s62, s39, 0x300
    buffer_load_dwordx4 v168, s[4:7], s41 offen lds
    buffer_load_dwordx4 v169, s[4:7], s41 offen offset:1024 lds
    s_waitcnt vmcnt(12)
    s_barrier
    ds_read_b128 a[216:219], v240 offset:3072
    ds_read_b128 a[220:223], v240 offset:4608
    ds_read_b128 a[240:243], v241 offset:3072
    buffer_load_dwordx4 v170, s[4:7], s41 offen offset:2048 lds
    s_add_u32 m0, s29, 0x2400
    s_waitcnt vmcnt(12)
    ds_read_b64_tr_b16 a[0:1], v249 offset:0
    ds_read_b64_tr_b16 a[2:3], v250 offset:0
    ds_read_b64_tr_b16 a[24:25], v249 offset:32
    ds_read_b64_tr_b16 a[26:27], v250 offset:32
    ds_read_b64_tr_b16 a[48:49], v249 offset:64
    ds_read_b64_tr_b16 a[50:51], v250 offset:64
    ds_read_b128 a[244:247], v241 offset:4608
    buffer_load_dwordx4 v172, s[8:11], s63 offen lds
    buffer_load_dwordx4 v173, s[8:11], s63 offen offset:1024 lds
    s_waitcnt lgkmcnt(5)
    v_mfma_f32_16x16x32_bf16 v[180:183], a[0:3], a[216:219], 0
    v_mfma_f32_16x16x32_bf16 v[192:195], a[0:3], a[220:223], 0
    s_waitcnt lgkmcnt(3)
    v_mfma_f32_16x16x32_bf16 v[184:187], a[24:27], a[216:219], 0
    s_waitcnt lgkmcnt(1)
    v_mfma_f32_16x16x32_bf16 v[188:191], a[48:51], a[216:219], 0
    buffer_load_dwordx4 v174, s[8:11], s63 offen offset:2048 lds
    s_waitcnt vmcnt(12)
    v_mfma_f32_16x16x32_bf16 v[196:199], a[24:27], a[220:223], 0
    s_barrier
    v_mfma_f32_16x16x32_bf16 v[200:203], a[48:51], a[220:223], 0
    s_add_u32 m0, s46, 0x8400
    ds_read_b128 a[224:227], v240 offset:0
    ds_read_b128 a[228:231], v240 offset:1536
    buffer_load_dwordx4 v168, s[4:7], s59 offen lds
    ds_read_b128 a[232:235], v241 offset:0
    ds_read_b128 a[236:239], v241 offset:1536
    ds_read_b128 a[216:219], v240 offset:128
    ds_read_b128 a[220:223], v240 offset:1664
    s_add_u32 s63, s39, 0x9300
    buffer_load_dwordx4 v169, s[4:7], s59 offen offset:1024 lds
    s_waitcnt lgkmcnt(5)
    v_mfma_f32_16x16x32_bf16 v[204:207], a[0:3], a[224:227], 0
    v_mfma_f32_16x16x32_bf16 v[208:211], a[24:27], a[224:227], 0
    s_waitcnt vmcnt(11) lgkmcnt(4)
    ds_read_b64_tr_b16 a[4:5], v249 offset:3072
    v_mfma_f32_16x16x32_bf16 v[212:215], a[48:51], a[224:227], 0
    ds_read_b64_tr_b16 a[6:7], v250 offset:3072
    ds_read_b64_tr_b16 a[28:29], v249 offset:3104
    v_mfma_f32_16x16x32_bf16 v[216:219], a[0:3], a[228:231], 0
    ds_read_b64_tr_b16 a[30:31], v250 offset:3104
    buffer_load_dwordx4 v170, s[4:7], s59 offen offset:2048 lds
    v_mfma_f32_16x16x32_bf16 v[220:223], a[24:27], a[228:231], 0
    ds_read_b64_tr_b16 a[52:53], v249 offset:3136
    ds_read_b64_tr_b16 a[54:55], v250 offset:3136
    v_mfma_f32_16x16x32_bf16 v[224:227], a[48:51], a[228:231], 0
    ds_read_b128 a[224:227], v240 offset:3200
    ds_read_b128 a[228:231], v240 offset:4736
    s_add_u32 m0, s29, 0
    s_add_u32 s59, s42, s45
    buffer_load_dwordx4 v172, s[8:11], s60 offen lds
    s_waitcnt lgkmcnt(6)
    v_mfma_f32_16x16x32_bf16 v[204:207], a[4:7], a[232:235], v[204:207]
    v_mfma_f32_16x16x32_bf16 v[216:219], a[4:7], a[236:239], v[216:219]
    s_waitcnt lgkmcnt(4)
    buffer_load_dwordx4 v173, s[8:11], s60 offen offset:1024 lds
    v_mfma_f32_16x16x32_bf16 v[208:211], a[28:31], a[232:235], v[208:211]
    v_mfma_f32_16x16x32_bf16 v[220:223], a[28:31], a[236:239], v[220:223]
    s_waitcnt lgkmcnt(2)
    s_waitcnt vmcnt(11)
    ds_read_b64_tr_b16 a[8:9], v249 offset:6144
    v_mfma_f32_16x16x32_bf16 v[212:215], a[52:55], a[232:235], v[212:215]
    ds_read_b64_tr_b16 a[10:11], v250 offset:6144
    ds_read_b64_tr_b16 a[32:33], v249 offset:6176
    v_mfma_f32_16x16x32_bf16 v[224:227], a[52:55], a[236:239], v[224:227]
    ds_read_b64_tr_b16 a[34:35], v250 offset:6176
    ds_read_b64_tr_b16 a[56:57], v249 offset:6208
    v_mfma_f32_16x16x32_bf16 v[180:183], a[4:7], a[240:243], v[180:183]
    ds_read_b64_tr_b16 a[58:59], v250 offset:6208
    buffer_load_dwordx4 v174, s[8:11], s60 offen offset:2048 lds
    v_mfma_f32_16x16x32_bf16 v[184:187], a[28:31], a[240:243], v[184:187]
    s_add_u32 m0, s29, 0xc00
    s_add_u32 s60, s39, 0x12300
    v_mfma_f32_16x16x32_bf16 v[188:191], a[52:55], a[240:243], v[188:191]
    s_waitcnt lgkmcnt(6)
    v_mfma_f32_16x16x32_bf16 v[192:195], a[4:7], a[244:247], v[192:195]
    v_mfma_f32_16x16x32_bf16 v[196:199], a[28:31], a[244:247], v[196:199]
    buffer_load_dwordx4 v172, s[8:11], s61 offen lds
    v_mfma_f32_16x16x32_bf16 v[200:203], a[52:55], a[244:247], v[200:203]
    s_waitcnt lgkmcnt(4)
    v_mfma_f32_16x16x32_bf16 v[204:207], a[8:11], a[216:219], v[204:207]
    v_mfma_f32_16x16x32_bf16 v[216:219], a[8:11], a[220:223], v[216:219]
    s_waitcnt lgkmcnt(2)
    v_mfma_f32_16x16x32_bf16 v[208:211], a[32:35], a[216:219], v[208:211]
    s_waitcnt lgkmcnt(0)
    buffer_load_dwordx4 v173, s[8:11], s61 offen offset:1024 lds
    v_mfma_f32_16x16x32_bf16 v[212:215], a[56:59], a[216:219], v[212:215]
    v_mfma_f32_16x16x32_bf16 v[220:223], a[32:35], a[220:223], v[220:223]
    s_waitcnt vmcnt(11)
    s_barrier
    v_mfma_f32_16x16x32_bf16 v[224:227], a[56:59], a[220:223], v[224:227]
    ds_read_b128 a[232:235], v240 offset:30720
    ds_read_b128 a[236:239], v240 offset:32256
    v_mfma_f32_16x16x32_bf16 v[180:183], a[8:11], a[224:227], v[180:183]
    ds_read_b128 a[240:243], v241 offset:30720
    v_add_u32 v8, 4, v2
    v_mfma_f32_16x16x32_bf16 v[184:187], a[32:35], a[224:227], v[184:187]
    ds_read_b128 a[244:247], v241 offset:32256
    v_mul_u32_u24 v8, 11, v8
    v_mfma_f32_16x16x32_bf16 v[188:191], a[56:59], a[224:227], v[188:191]
    ds_read_b128 a[216:219], v240 offset:30848
    v_bfe_u32 v9, v8, 6, 1
    v_mfma_f32_16x16x32_bf16 v[192:195], a[8:11], a[228:231], v[192:195]
    ds_read_b128 a[220:223], v240 offset:32384
    v_lshrrev_b32 v8, 5, v8
    v_mfma_f32_16x16x32_bf16 v[196:199], a[32:35], a[228:231], v[196:199]
    ds_read_b128 a[224:227], v241 offset:128
    v_xor_b32 v9, v3, v9
    v_mfma_f32_16x16x32_bf16 v[200:203], a[56:59], a[228:231], v[200:203]
    ds_read_b128 a[228:231], v241 offset:1664
    buffer_load_dwordx4 v174, s[8:11], s61 offen offset:2048 lds
    s_add_u32 m0, s37, 0xd80
    s_add_u32 s61, s39, 0x1b300
    s_add_u32 s50, s31, 0xfffffe80
    v_mad_i32_i24 v8, v8, s50, v4
    s_waitcnt lgkmcnt(7)
    v_mfma_f32_16x16x32_bf16 v[228:231], a[0:3], a[232:235], 0
    s_and_b32 s66, s28, 1
    v_lshl_add_u32 v171, v9, 4, v8
    s_waitcnt lgkmcnt(6)
    v_mfma_f32_16x16x32_bf16 v[232:235], a[24:27], a[232:235], 0
    s_lshl_b32 s66, s66, 2
    v_add_u32 v17, 3, v15
    v_add_u32 v19, 3, v16
    v_mfma_f32_16x16x32_bf16 v[236:239], a[48:51], a[232:235], 0
    s_waitcnt lgkmcnt(5)
    v_and_b32 v18, 3, v17
    v_lshlrev_b32 v18, 1, v18
    v_mfma_f32_16x16x32_bf16 v[138:141], a[0:3], a[236:239], 0
    ds_read_b128 a[232:235], v241 offset:3200
    v_bfe_u32 v243, v19, 1, 1
    v_mfma_f32_16x16x32_bf16 v[142:145], a[24:27], a[236:239], 0
    s_waitcnt vmcnt(9)
    ds_read_b64_tr_b16 a[12:13], v249 offset:9216
    v_mfma_f32_16x16x32_bf16 v[146:149], a[48:51], a[236:239], 0
    s_waitcnt lgkmcnt(6)
    ds_read_b64_tr_b16 a[14:15], v250 offset:9216
    v_mfma_f32_16x16x32_bf16 v[228:231], a[4:7], a[240:243], v[228:231]
    ds_read_b64_tr_b16 a[36:37], v249 offset:9248
    ds_read_b64_tr_b16 a[38:39], v250 offset:9248
    v_mfma_f32_16x16x32_bf16 v[232:235], a[28:31], a[240:243], v[232:235]
    ds_read_b64_tr_b16 a[60:61], v249 offset:9280
    ds_read_b64_tr_b16 a[62:63], v250 offset:9280
    v_mfma_f32_16x16x32_bf16 v[236:239], a[52:55], a[240:243], v[236:239]
    s_waitcnt lgkmcnt(10)
    v_or_b32 v18, v18, v243
    v_mul_u32_u24 v17, 0x1e00, v17
    v_mfma_f32_16x16x32_bf16 v[138:141], a[4:7], a[244:247], v[138:141]
    s_waitcnt lgkmcnt(9)
    v_xor_b32 v18, v18, v14
    v_lshl_add_u32 v17, v18, 4, v17
    v_mfma_f32_16x16x32_bf16 v[142:145], a[28:31], a[244:247], v[142:145]
    ds_read_b128 a[236:239], v241 offset:4736
    v_mul_u32_u24 v18, 0x180, v19
    v_mfma_f32_16x16x32_bf16 v[146:149], a[52:55], a[244:247], v[146:149]
    ds_read_b128 a[240:243], v241 offset:30848
    v_add_u32 v242, v17, v18
    v_mfma_f32_16x16x32_bf16 v[228:231], a[8:11], a[216:219], v[228:231]
    ds_read_b128 a[244:247], v241 offset:32384
    v_mov_b32 v17, 0x3f803f80
    v_mfma_f32_16x16x32_bf16 v[232:235], a[32:35], a[216:219], v[232:235]
    buffer_load_dwordx4 v12, s[16:19], s65 offen lds
    v_lshrrev_b32 v18, 1, v13
    v_mfma_f32_16x16x32_bf16 v[236:239], a[56:59], a[216:219], v[236:239]
    s_waitcnt lgkmcnt(7)
    v_accvgpr_write_b32 a248, v17
    v_accvgpr_write_b32 a249, v17
    v_mfma_f32_16x16x32_bf16 v[138:141], a[8:11], a[220:223], v[138:141]
    s_waitcnt lgkmcnt(5)
    v_accvgpr_write_b32 a250, v17
    v_accvgpr_write_b32 a251, v17
    v_mfma_f32_16x16x32_bf16 v[142:145], a[32:35], a[220:223], v[142:145]
    s_waitcnt lgkmcnt(3)
    v_xor_b32 v18, v14, v18
    v_xor_b32 v18, s66, v18
    v_mfma_f32_16x16x32_bf16 v[146:149], a[56:59], a[220:223], v[146:149]
    buffer_load_dword v11, v12, s[12:15], s55 offen
    v_mul_u32_u24 v17, 0x180, v13
    v_mfma_f32_16x16x32_bf16 v[204:207], a[12:15], a[224:227], v[204:207]
    s_add_u32 m0, s29, 0x1800
    v_lshl_add_u32 v17, v18, 4, v17
    v_lshlrev_b32 v18, 4, v16
    v_mfma_f32_16x16x32_bf16 v[208:211], a[36:39], a[224:227], v[208:211]
    s_lshr_b32 s67, s28, 1
    v_min_u32 v20, 55, v1
    v_lshrrev_b32 v21, 1, v20
    v_mfma_f32_16x16x32_bf16 v[212:215], a[60:63], a[224:227], v[212:215]
    s_lshl_b32 s67, s67, 3
    v_add_u32 v17, s67, v17
    v_add_u32 v247, 0x7800, v17
    v_mfma_f32_16x16x32_bf16 v[216:219], a[12:15], a[228:231], v[216:219]
    buffer_load_dwordx4 v172, s[8:11], s62 offen lds
    v_add_u32 v251, 0x1e000, v17
    v_mfma_f32_16x16x32_bf16 v[220:223], a[36:39], a[228:231], v[220:223]
    s_waitcnt vmcnt(9)
    s_barrier
    v_mfma_f32_16x16x32_bf16 v[224:227], a[60:63], a[228:231], v[224:227]
    s_waitcnt lgkmcnt(1)
    ds_read_b128 a[216:219], v240 offset:33792
    v_mfma_f32_16x16x32_bf16 v[180:183], a[12:15], a[232:235], v[180:183]
    ds_read_b128 a[220:223], v240 offset:35328
    v_sub_u32 v17, v14, v15
    v_mfma_f32_16x16x32_bf16 v[184:187], a[36:39], a[232:235], v[184:187]
    s_waitcnt lgkmcnt(2)
    v_mul_i32_i24 v17, 0x1c0, v17
    v_sub_u32 v17, v17, v18
    v_mfma_f32_16x16x32_bf16 v[188:191], a[60:63], a[232:235], v[188:191]
    ds_read_b128 a[224:227], v241 offset:33792
    v_max_u32 v18, s33, v15
    v_mfma_f32_16x16x32_bf16 v[192:195], a[12:15], a[236:239], v[192:195]
    ds_read_b128 a[228:231], v241 offset:35328
    v_sub_u32 v18, v14, v18
    v_mfma_f32_16x16x32_bf16 v[196:199], a[36:39], a[236:239], v[196:199]
    buffer_load_dwordx4 v173, s[8:11], s62 offen offset:1024 lds
    v_add_u32 v244, 0, v18
    v_mfma_f32_16x16x32_bf16 v[200:203], a[60:63], a[236:239], v[200:203]
    ds_read_b128 a[232:235], v240 offset:33920
    v_cmp_gt_u32 vcc, 7, v244
    v_mfma_f32_16x16x32_bf16 v[228:231], a[12:15], a[240:243], v[228:231]
    ds_read_b128 a[236:239], v240 offset:35456
    v_add_u32 v17, s37, v17
    v_mfma_f32_16x16x32_bf16 v[232:235], a[36:39], a[240:243], v[232:235]
    s_lshl_b32 s66, s36, 1
    v_add_u32 v244, 0xfffdc870, v17
    v_cndmask_b32 v244, 0, v244, vcc
    v_mfma_f32_16x16x32_bf16 v[236:239], a[60:63], a[240:243], v[236:239]
    s_waitcnt lgkmcnt(5)
    v_add_u32 v245, 4, v18
    v_cmp_gt_u32 vcc, 7, v245
    v_mfma_f32_16x16x32_bf16 v[138:141], a[12:15], a[244:247], v[138:141]
    buffer_load_dwordx4 v174, s[8:11], s62 offen offset:2048 lds
    v_add_u32 v245, 0xfffdcf70, v17
    v_mfma_f32_16x16x32_bf16 v[142:145], a[36:39], a[244:247], v[142:145]
    ds_read_b128 a[240:243], v241 offset:33920
    v_cndmask_b32 v245, 0, v245, vcc
    v_mfma_f32_16x16x32_bf16 v[146:149], a[60:63], a[244:247], v[146:149]
    s_waitcnt lgkmcnt(5)
    v_add_u32 v246, 8, v18
    v_cmp_gt_u32 vcc, 7, v246
    v_mfma_f32_16x16x32_bf16 v[150:153], a[0:3], a[216:219], 0
    ds_read_b128 a[244:247], v241 offset:35456
    v_add_u32 v246, 0xfffdd670, v17
    v_mfma_f32_16x16x32_bf16 v[154:157], a[24:27], a[216:219], 0
    s_add_u32 m0, s29, 0x2400
    v_cndmask_b32 v246, 0, v246, vcc
    v_cmp_lt_u32 vcc, 11, v21
    v_mfma_f32_16x16x32_bf16 v[158:161], a[48:51], a[216:219], 0
    s_waitcnt lgkmcnt(5)
    v_lshlrev_b32 v62, 3, v20
    v_add_u32 v22, -12, v21
    v_mfma_f32_16x16x32_bf16 v[162:165], a[0:3], a[220:223], 0
    ds_read_b128 a[216:219], v240 offset:256
    v_mov_b32 v23, s34
    v_mfma_f32_16x16x32_bf16 v[24:27], a[24:27], a[220:223], 0
    buffer_load_dwordx4 v172, s[8:11], s63 offen lds
    s_waitcnt lgkmcnt(5)
    v_mfma_f32_16x16x32_bf16 v[54:57], a[48:51], a[220:223], 0
    ds_read_b128 a[220:223], v240 offset:1792
    v_and_b32 v20, 1, v20
    v_mfma_f32_16x16x32_bf16 v[150:153], a[4:7], a[224:227], v[150:153]
    s_add_u32 s62, s39, 0x24300
    s_waitcnt lgkmcnt(5)
    v_cndmask_b32 v22, v21, v22, vcc
    v_mfma_f32_16x16x32_bf16 v[154:157], a[28:31], a[224:227], v[154:157]
    s_sub_u32 s66, 1, s66
    v_cndmask_b32 v23, 0, v23, vcc
    v_lshlrev_b32 v20, 1, v20
    v_mfma_f32_16x16x32_bf16 v[158:161], a[52:55], a[224:227], v[158:161]
    ds_read_b128 a[224:227], v240 offset:3328
    v_cmp_ne_u32 vcc, 0, v23
    v_mfma_f32_16x16x32_bf16 v[162:165], a[4:7], a[228:231], v[162:165]
    s_waitcnt lgkmcnt(5)
    v_add_u32 v63, 0, v20
    v_add3_u32 v64, v22, v63, -6
L_h1:
    s_cbranch_execz L_h5
    v_mfma_f32_16x16x32_bf16 v[24:27], a[28:31], a[228:231], v[24:27]
    s_waitcnt vmcnt(9)
    ds_read_b64_tr_b16 a[16:17], v249 offset:0
    v_mfma_f32_16x16x32_bf16 v[54:57], a[52:55], a[228:231], v[54:57]
    ds_read_b64_tr_b16 a[18:19], v250 offset:0
    ds_read_b64_tr_b16 a[40:41], v249 offset:32
    v_mfma_f32_16x16x32_bf16 v[150:153], a[8:11], a[232:235], v[150:153]
    ds_read_b64_tr_b16 a[42:43], v250 offset:32
    ds_read_b64_tr_b16 a[64:65], v249 offset:64
    v_mfma_f32_16x16x32_bf16 v[154:157], a[32:35], a[232:235], v[154:157]
    ds_read_b64_tr_b16 a[66:67], v250 offset:64
    s_waitcnt lgkmcnt(9)
    v_mfma_f32_16x16x32_bf16 v[158:161], a[56:59], a[232:235], v[158:161]
    ds_read_b128 a[228:231], v240 offset:4864
    v_and_b32 v66, 12, v22
    v_mfma_f32_16x16x32_bf16 v[162:165], a[8:11], a[236:239], v[162:165]
    buffer_load_dwordx4 v173, s[8:11], s63 offen offset:1024 lds
    v_add_u32 v65, 3, v64
    v_mfma_f32_16x16x32_bf16 v[24:27], a[32:35], a[236:239], v[24:27]
    ds_read_b128 a[232:235], v240 offset:30976
    v_add3_u32 v66, v66, v63, -3
    v_mfma_f32_16x16x32_bf16 v[54:57], a[56:59], a[236:239], v[54:57]
    ds_read_b128 a[236:239], v240 offset:32512
    v_cndmask_b32 v65, v65, v66, vcc
    v_mfma_f32_16x16x32_bf16 v[150:153], a[12:15], a[240:243], v[150:153]
    s_mul_i32 s64, s35, 0xfc0
    v_cmp_gt_u32 vcc, 7, v65
    v_mul_i32_i24 v64, s66, v64
    v_mfma_f32_16x16x32_bf16 v[154:157], a[36:39], a[240:243], v[154:157]
    buffer_load_dwordx4 v174, s[8:11], s63 offen offset:2048 lds
    v_add_lshl_u32 v64, v64, 6, 1
    v_mfma_f32_16x16x32_bf16 v[158:161], a[60:63], a[240:243], v[158:161]
    s_waitcnt lgkmcnt(7)
    v_cndmask_b32 v50, 0, v64, vcc
    v_mov_b32 v64, 0x3fb8aa3b
    v_mfma_f32_16x16x32_bf16 v[162:165], a[12:15], a[244:247], v[162:165]
    s_waitcnt lgkmcnt(5)
    v_cndmask_b32 v52, 0, v64, vcc
    v_mov_b32 v64, 0
    v_mfma_f32_16x16x32_bf16 v[24:27], a[36:39], a[244:247], v[24:27]
    s_waitcnt lgkmcnt(3)
    v_mov_b32 v65, 0xf149f2ca
    v_cndmask_b32 v60, v65, v64, vcc
    v_mfma_f32_16x16x32_bf16 v[54:57], a[60:63], a[244:247], v[54:57]
    ds_read_b128 a[240:243], v240 offset:34048
    v_cmp_ne_u32 vcc, 0, v23
    v_mfma_f32_16x16x32_bf16 v[204:207], a[16:19], a[216:219], v[204:207]
    ds_read_b128 a[244:247], v240 offset:35584
    v_add_u32 v63, 1, v20
    v_mfma_f32_16x16x32_bf16 v[208:211], a[40:43], a[216:219], v[208:211]
    s_add_u32 m0, s29, 0
    v_add3_u32 v64, v22, v63, -6
    v_and_b32 v66, 12, v22
    v_mfma_f32_16x16x32_bf16 v[212:215], a[64:67], a[216:219], v[212:215]
    ds_read_b128 a[216:219], v241 offset:256
    v_add_u32 v65, 3, v64
    v_mfma_f32_16x16x32_bf16 v[216:219], a[16:19], a[220:223], v[216:219]
    buffer_load_dwordx4 v172, s[8:11], s60 offen lds
    s_waitcnt lgkmcnt(5)
    v_mfma_f32_16x16x32_bf16 v[220:223], a[40:43], a[220:223], v[220:223]
    s_add_u32 s63, s39, 0x2d300
    v_add3_u32 v66, v66, v63, -3
    v_cndmask_b32 v65, v65, v66, vcc
    v_mfma_f32_16x16x32_bf16 v[224:227], a[64:67], a[220:223], v[224:227]
    ds_read_b128 a[220:223], v241 offset:1792
    v_cmp_gt_u32 vcc, 7, v65
    v_mfma_f32_16x16x32_bf16 v[180:183], a[16:19], a[224:227], v[180:183]
    s_waitcnt lgkmcnt(5)
    v_mul_i32_i24 v64, s66, v64
    v_add_lshl_u32 v64, v64, 6, 1
    v_mfma_f32_16x16x32_bf16 v[184:187], a[40:43], a[224:227], v[184:187]
    s_waitcnt lgkmcnt(4)
    v_cndmask_b32 v51, 0, v64, vcc
    v_mov_b32 v64, 0x3fb8aa3b
    v_mfma_f32_16x16x32_bf16 v[188:191], a[64:67], a[224:227], v[188:191]
    ds_read_b128 a[224:227], v241 offset:3328
    v_cndmask_b32 v53, 0, v64, vcc
    v_mfma_f32_16x16x32_bf16 v[192:195], a[16:19], a[228:231], v[192:195]
    buffer_load_dwordx4 v173, s[8:11], s60 offen offset:1024 lds
    v_mov_b32 v64, 0
    v_mfma_f32_16x16x32_bf16 v[196:199], a[40:43], a[228:231], v[196:199]
    s_waitcnt vmcnt(10)
    ds_read_b64_tr_b16 a[20:21], v249 offset:3072
    v_mfma_f32_16x16x32_bf16 v[200:203], a[64:67], a[228:231], v[200:203]
    ds_read_b64_tr_b16 a[22:23], v250 offset:3072
    ds_read_b64_tr_b16 a[44:45], v249 offset:3104
    v_mfma_f32_16x16x32_bf16 v[228:231], a[16:19], a[232:235], v[228:231]
    ds_read_b64_tr_b16 a[46:47], v250 offset:3104
    ds_read_b64_tr_b16 a[68:69], v249 offset:3136
    v_mfma_f32_16x16x32_bf16 v[232:235], a[40:43], a[232:235], v[232:235]
    ds_read_b64_tr_b16 a[70:71], v250 offset:3136
    s_waitcnt lgkmcnt(9)
    v_mfma_f32_16x16x32_bf16 v[236:239], a[64:67], a[232:235], v[236:239]
    ds_read_b128 a[228:231], v241 offset:4864
    v_mov_b32 v65, 0xf149f2ca
    v_mfma_f32_16x16x32_bf16 v[138:141], a[16:19], a[236:239], v[138:141]
    ds_read_b128 a[232:235], v241 offset:30976
    v_cndmask_b32 v61, v65, v64, vcc
    v_mfma_f32_16x16x32_bf16 v[142:145], a[40:43], a[236:239], v[142:145]
    buffer_load_dwordx4 v174, s[8:11], s60 offen offset:2048 lds
    v_lshlrev_b32 v63, 3, v1
    v_mfma_f32_16x16x32_bf16 v[146:149], a[64:67], a[236:239], v[146:149]
    ds_read_b128 a[236:239], v241 offset:32512
    v_mov_b32 v64, 0xf149f2ca
    v_mfma_f32_16x16x32_bf16 v[150:153], a[16:19], a[240:243], v[150:153]
    s_add_u32 m0, s29, 0xc00
    v_mov_b32 v65, 0xf149f2ca
    v_add_u32 v63, 0x237c0, v63
    v_mfma_f32_16x16x32_bf16 v[154:157], a[40:43], a[240:243], v[154:157]
    s_add_u32 s64, s64, s37
    v_add_u32 v62, s64, v62
    v_mbcnt_lo_u32_b32 v67, -1, 0
    v_mfma_f32_16x16x32_bf16 v[158:161], a[64:67], a[240:243], v[158:161]
    s_waitcnt lgkmcnt(7)
    v_mbcnt_hi_u32_b32 v67, -1, v67
    v_lshrrev_b32 v68, 1, v67
    v_mfma_f32_16x16x32_bf16 v[162:165], a[16:19], a[244:247], v[162:165]
    s_waitcnt lgkmcnt(5)
    v_add_u32 v68, 0, v68
    v_mul_u32_u24 v69, 43, v68
    v_mfma_f32_16x16x32_bf16 v[24:27], a[40:43], a[244:247], v[24:27]
    s_waitcnt lgkmcnt(3)
    v_lshrrev_b32 v70, 8, v69
    v_lshrrev_b32 v69, 7, v69
    v_mfma_f32_16x16x32_bf16 v[54:57], a[64:67], a[244:247], v[54:57]
    ds_read_b128 a[240:243], v241 offset:34048
    v_mad_i32_i24 v68, v69, -3, v68
    v_mfma_f32_16x16x32_bf16 v[204:207], a[20:23], a[216:219], v[204:207]
    ds_read_b128 a[244:247], v241 offset:35584
    v_and_b32 v70, 4, v70
    v_mfma_f32_16x16x32_bf16 v[208:211], a[44:47], a[216:219], v[208:211]
    buffer_load_dwordx4 v172, s[8:11], s61 offen lds
    v_xor_b32 v69, v69, v70
    v_mfma_f32_16x16x32_bf16 v[212:215], a[68:71], a[216:219], v[212:215]
    ds_read_b128 a[216:219], v240 offset:0
    v_and_b32 v70, 4, v69
    v_mfma_f32_16x16x32_bf16 v[216:219], a[20:23], a[220:223], v[216:219]
    s_and_b32 s64, s48, 15
    s_waitcnt lgkmcnt(5)
    v_cvt_pk_bf16_f32 v102, v204, v205
    v_mfma_f32_16x16x32_bf16 v[220:223], a[44:47], a[220:223], v[220:223]
    s_add_u32 s64, s64, s37
    v_cvt_pk_bf16_f32 v103, v206, v207
    v_cvt_pk_bf16_f32 v104, v208, v209
    v_mfma_f32_16x16x32_bf16 v[224:227], a[68:71], a[220:223], v[224:227]
    s_waitcnt lgkmcnt(4)
    v_cvt_pk_bf16_f32 v105, v210, v211
    v_cvt_pk_bf16_f32 v106, v212, v213
    v_mfma_f32_16x16x32_bf16 v[180:183], a[20:23], a[224:227], v[180:183]
    ds_read_b128 a[220:223], v240 offset:1536
    v_cvt_pk_bf16_f32 v107, v214, v215
    v_mfma_f32_16x16x32_bf16 v[184:187], a[44:47], a[224:227], v[184:187]
    s_waitcnt lgkmcnt(4)
    v_cvt_pk_bf16_f32 v108, v216, v217
    v_cvt_pk_bf16_f32 v109, v218, v219
    v_mfma_f32_16x16x32_bf16 v[188:191], a[68:71], a[224:227], v[188:191]
    ds_read_b128 a[224:227], v240 offset:3072
    v_cvt_pk_bf16_f32 v110, v220, v221
    v_mfma_f32_16x16x32_bf16 v[192:195], a[20:23], a[228:231], v[192:195]
    buffer_load_dwordx4 v173, s[8:11], s61 offen offset:1024 lds
    v_cvt_pk_bf16_f32 v111, v222, v223
    v_mfma_f32_16x16x32_bf16 v[196:199], a[44:47], a[228:231], v[196:199]
    s_waitcnt vmcnt(8)
    ds_read_b64_tr_b16 a[72:73], v249 offset:6144
    v_mfma_f32_16x16x32_bf16 v[200:203], a[68:71], a[228:231], v[200:203]
    ds_read_b64_tr_b16 a[74:75], v250 offset:6144
    ds_read_b64_tr_b16 a[96:97], v249 offset:6176
    v_mfma_f32_16x16x32_bf16 v[228:231], a[20:23], a[232:235], v[228:231]
    ds_read_b64_tr_b16 a[98:99], v250 offset:6176
    ds_read_b64_tr_b16 a[120:121], v249 offset:6208
    v_mfma_f32_16x16x32_bf16 v[232:235], a[44:47], a[232:235], v[232:235]
    ds_read_b64_tr_b16 a[122:123], v250 offset:6208
    s_waitcnt lgkmcnt(9)
    v_mfma_f32_16x16x32_bf16 v[236:239], a[68:71], a[232:235], v[236:239]
    ds_read_b128 a[228:231], v240 offset:4608
    v_cvt_pk_bf16_f32 v112, v224, v225
    v_mfma_f32_16x16x32_bf16 v[138:141], a[20:23], a[236:239], v[138:141]
    ds_read_b128 a[232:235], v240 offset:30720
    v_cvt_pk_bf16_f32 v113, v226, v227
    v_mfma_f32_16x16x32_bf16 v[142:145], a[44:47], a[236:239], v[142:145]
    buffer_load_dwordx4 v174, s[8:11], s61 offen offset:2048 lds
    v_cvt_pk_bf16_f32 v90, v180, v181
    v_mfma_f32_16x16x32_bf16 v[146:149], a[68:71], a[236:239], v[146:149]
    ds_read_b128 a[236:239], v240 offset:32256
    v_cvt_pk_bf16_f32 v91, v182, v183
    v_mfma_f32_16x16x32_bf16 v[150:153], a[20:23], a[240:243], v[150:153]
    s_add_u32 m0, s29, 0x1800
    v_cvt_pk_bf16_f32 v92, v184, v185
    v_cvt_pk_bf16_f32 v93, v186, v187
    v_mfma_f32_16x16x32_bf16 v[154:157], a[44:47], a[240:243], v[154:157]
    s_add_u32 s60, s39, 0
    v_cvt_pk_bf16_f32 v94, v188, v189
    v_cvt_pk_bf16_f32 v95, v190, v191
    v_mfma_f32_16x16x32_bf16 v[158:161], a[68:71], a[240:243], v[158:161]
    s_waitcnt lgkmcnt(7)
    v_cvt_pk_bf16_f32 v96, v192, v193
    v_cvt_pk_bf16_f32 v97, v194, v195
    v_mfma_f32_16x16x32_bf16 v[162:165], a[20:23], a[244:247], v[162:165]
    s_waitcnt lgkmcnt(5)
    v_cvt_pk_bf16_f32 v98, v196, v197
    v_cvt_pk_bf16_f32 v99, v198, v199
    v_mfma_f32_16x16x32_bf16 v[24:27], a[44:47], a[244:247], v[24:27]
    s_waitcnt lgkmcnt(3)
    v_cvt_pk_bf16_f32 v100, v200, v201
    v_cvt_pk_bf16_f32 v101, v202, v203
    v_mfma_f32_16x16x32_bf16 v[54:57], a[68:71], a[244:247], v[54:57]
    ds_read_b128 a[240:243], v240 offset:33792
    v_cvt_pk_bf16_f32 v114, v228, v229
    v_mfma_f32_16x16x32_bf16 v[84:87], a[216:219], a[72:75], 0
    ds_read_b128 a[244:247], v240 offset:35328
    v_cvt_pk_bf16_f32 v115, v230, v231
    v_mfma_f32_16x16x32_bf16 v[204:207], a[216:219], a[96:99], 0
    buffer_load_dwordx4 v172, s[8:11], s62 offen lds
    v_cvt_pk_bf16_f32 v116, v232, v233
    v_mfma_f32_16x16x32_bf16 v[208:211], a[216:219], a[120:123], 0
    ds_read_b128 a[216:219], v241 offset:0
    v_cvt_pk_bf16_f32 v117, v234, v235
    v_mfma_f32_16x16x32_bf16 v[212:215], a[220:223], a[72:75], 0
    s_add_u32 s61, s39, 0x9000
    s_waitcnt lgkmcnt(5)
    v_cvt_pk_bf16_f32 v118, v236, v237
    v_mfma_f32_16x16x32_bf16 v[216:219], a[220:223], a[96:99], 0
    s_mov_b32 vcc_lo, 0xcccccccc
    v_cvt_pk_bf16_f32 v119, v238, v239
    v_cvt_pk_bf16_f32 v120, v138, v139
    v_mfma_f32_16x16x32_bf16 v[220:223], a[220:223], a[120:123], 0
    s_waitcnt lgkmcnt(4)
    v_cvt_pk_bf16_f32 v121, v140, v141
    v_cvt_pk_bf16_f32 v122, v142, v143
    v_mfma_f32_16x16x32_bf16 v[224:227], a[224:227], a[72:75], 0
    ds_read_b128 a[220:223], v241 offset:1536
    v_cvt_pk_bf16_f32 v123, v144, v145
    v_mfma_f32_16x16x32_bf16 v[180:183], a[224:227], a[96:99], 0
    s_waitcnt lgkmcnt(4)
    v_cvt_pk_bf16_f32 v124, v146, v147
    v_cvt_pk_bf16_f32 v125, v148, v149
    v_mfma_f32_16x16x32_bf16 v[184:187], a[224:227], a[120:123], 0
    buffer_load_dwordx4 v173, s[8:11], s62 offen offset:1024 lds
    v_cvt_pk_bf16_f32 v126, v150, v151
    v_mfma_f32_16x16x32_bf16 v[188:191], a[228:231], a[72:75], 0
    s_mov_b32 vcc_hi, 0xcccccccc
    v_cvt_pk_bf16_f32 v127, v152, v153
    v_cvt_pk_bf16_f32 v128, v154, v155
    v_mfma_f32_16x16x32_bf16 v[192:195], a[228:231], a[96:99], 0
    s_waitcnt vmcnt(8)
    ds_read_b64_tr_b16 a[76:77], v249 offset:9216
    v_mfma_f32_16x16x32_bf16 v[196:199], a[228:231], a[120:123], 0
    ds_read_b64_tr_b16 a[78:79], v250 offset:9216
    ds_read_b64_tr_b16 a[100:101], v249 offset:9248
    v_mfma_f32_16x16x32_bf16 v[200:203], a[232:235], a[72:75], 0
    ds_read_b64_tr_b16 a[102:103], v250 offset:9248
    ds_read_b64_tr_b16 a[124:125], v249 offset:9280
    v_mfma_f32_16x16x32_bf16 v[228:231], a[232:235], a[96:99], 0
    ds_read_b64_tr_b16 a[126:127], v250 offset:9280
    s_waitcnt lgkmcnt(8)
    v_mfma_f32_16x16x32_bf16 v[232:235], a[232:235], a[120:123], 0
    ds_read_b128 a[224:227], v241 offset:3072
    v_cvt_pk_bf16_f32 v129, v156, v157
    v_mfma_f32_16x16x32_bf16 v[236:239], a[236:239], a[72:75], 0
    s_mul_i32 s66, s28, 0xffffee00
    v_cvt_pk_bf16_f32 v130, v158, v159
    v_cvt_pk_bf16_f32 v131, v160, v161
    v_mfma_f32_16x16x32_bf16 v[138:141], a[236:239], a[96:99], 0
    s_mul_i32 s67, s36, 3
    v_cvt_pk_bf16_f32 v132, v162, v163
    v_cvt_pk_bf16_f32 v133, v164, v165
    v_mfma_f32_16x16x32_bf16 v[142:145], a[236:239], a[120:123], 0
    buffer_load_dwordx4 v174, s[8:11], s62 offen offset:2048 lds
    v_cvt_pk_bf16_f32 v134, v24, v25
    v_mfma_f32_16x16x32_bf16 v[146:149], a[240:243], a[72:75], 0
    ds_read_b128 a[228:231], v241 offset:4608
    v_cvt_pk_bf16_f32 v135, v26, v27
    v_mfma_f32_16x16x32_bf16 v[150:153], a[240:243], a[96:99], 0
    s_add_u32 m0, s29, 0x2400
    v_add_u32 v50, s64, v50
    v_add_u32 v51, s64, v51
    v_mfma_f32_16x16x32_bf16 v[154:157], a[240:243], a[120:123], 0
    s_waitcnt lgkmcnt(6)
    v_mul_u32_u24 v252, 24, v70
    v_lshrrev_b32 v70, 3, v69
    v_mfma_f32_16x16x32_bf16 v[158:161], a[244:247], a[72:75], 0
    s_waitcnt lgkmcnt(4)
    v_lshl_add_u32 v252, v70, 2, v252
    v_and_or_b32 v252, v69, 3, v252
    v_mfma_f32_16x16x32_bf16 v[162:165], a[244:247], a[96:99], 0
    s_waitcnt lgkmcnt(2)
    ds_read_b128 a[232:235], v241 offset:30720
    v_mfma_f32_16x16x32_bf16 v[24:27], a[244:247], a[120:123], 0
    buffer_load_dwordx4 v172, s[8:11], s63 offen lds
    v_mad_u32_u24 v252, v252, 3, v68
    v_mfma_f32_16x16x32_bf16 v[84:87], a[216:219], a[76:79], v[84:87]
    ds_read_b128 a[236:239], v241 offset:32256
    v_lshrrev_b32 v68, 1, v67
    v_mfma_f32_16x16x32_bf16 v[204:207], a[216:219], a[100:103], v[204:207]
    ds_read_b128 a[240:243], v241 offset:33792
    v_and_b32 v70, 1, v67
    v_mfma_f32_16x16x32_bf16 v[208:211], a[216:219], a[124:127], v[208:211]
    s_waitcnt lgkmcnt(4)
    v_add_u32 v68, 32, v68
    v_lshl_add_u32 v252, v252, 3, v70
    v_mfma_f32_16x16x32_bf16 v[212:215], a[220:223], a[76:79], v[212:215]
    buffer_load_dwordx4 v173, s[8:11], s63 offen offset:1024 lds
    v_mul_u32_u24 v69, 43, v68
    v_mfma_f32_16x16x32_bf16 v[216:219], a[220:223], a[100:103], v[216:219]
    ds_read_b128 a[244:247], v241 offset:35328
    v_lshrrev_b32 v70, 8, v69
    v_mfma_f32_16x16x32_bf16 v[220:223], a[220:223], a[124:127], v[220:223]
    s_waitcnt lgkmcnt(4)
    v_lshrrev_b32 v69, 7, v69
    v_mad_i32_i24 v68, v69, -3, v68
    v_mfma_f32_16x16x32_bf16 v[224:227], a[224:227], a[76:79], v[224:227]
    ds_read_b128 a[216:219], v240 offset:128
    v_and_b32 v70, 4, v70
    v_mfma_f32_16x16x32_bf16 v[180:183], a[224:227], a[100:103], v[180:183]
    buffer_load_dwordx4 v174, s[8:11], s63 offen offset:2048 lds
    v_xor_b32 v69, v69, v70
    v_mfma_f32_16x16x32_bf16 v[184:187], a[224:227], a[124:127], v[184:187]
    s_waitcnt lgkmcnt(4)
    v_and_b32 v70, 4, v69
    v_mul_u32_u24 v253, 24, v70
    v_mfma_f32_16x16x32_bf16 v[188:191], a[228:231], a[76:79], v[188:191]
    s_add_u32 m0, s46, 0x1800
    v_lshrrev_b32 v70, 3, v69
    v_lshl_add_u32 v253, v70, 2, v253
    v_mfma_f32_16x16x32_bf16 v[192:195], a[228:231], a[100:103], v[192:195]
    s_waitcnt vmcnt(9)
    ds_read_b64_tr_b16 a[80:81], v249 offset:0
    v_mfma_f32_16x16x32_bf16 v[196:199], a[228:231], a[124:127], v[196:199]
    s_waitcnt lgkmcnt(4)
    ds_read_b64_tr_b16 a[82:83], v250 offset:0
    v_mfma_f32_16x16x32_bf16 v[200:203], a[232:235], a[76:79], v[200:203]
    ds_read_b64_tr_b16 a[104:105], v249 offset:32
    ds_read_b64_tr_b16 a[106:107], v250 offset:32
    v_mfma_f32_16x16x32_bf16 v[228:231], a[232:235], a[100:103], v[228:231]
    buffer_load_dwordx4 v168, s[4:7], s58 offen lds
    ds_read_b64_tr_b16 a[128:129], v249 offset:64
    v_mfma_f32_16x16x32_bf16 v[232:235], a[232:235], a[124:127], v[232:235]
    ds_read_b64_tr_b16 a[130:131], v250 offset:64
    s_waitcnt lgkmcnt(8)
    v_mfma_f32_16x16x32_bf16 v[236:239], a[236:239], a[76:79], v[236:239]
    ds_read_b128 a[220:223], v240 offset:1664
    v_and_b32 v70, 1, v67
    v_mfma_f32_16x16x32_bf16 v[138:141], a[236:239], a[100:103], v[138:141]
    ds_read_b128 a[224:227], v240 offset:3200
    buffer_load_dwordx4 v171, s[4:7], s58 offen offset:512 lds
    v_mfma_f32_16x16x32_bf16 v[142:145], a[236:239], a[124:127], v[142:145]
    s_waitcnt lgkmcnt(9)
    v_cvt_pk_bf16_f32 v136, v54, v55
    v_cvt_pk_bf16_f32 v137, v56, v57
    v_mfma_f32_16x16x32_bf16 v[146:149], a[240:243], a[76:79], v[146:149]
    ds_read_b128 a[228:231], v240 offset:4736
    v_and_or_b32 v253, v69, 3, v253
    v_mfma_f32_16x16x32_bf16 v[150:153], a[240:243], a[100:103], v[150:153]
    s_add_u32 m0, s46, 0x9000
    v_mad_u32_u24 v253, v253, 3, v68
    v_lshl_add_u32 v253, v253, 3, v70
    v_mfma_f32_16x16x32_bf16 v[154:157], a[240:243], a[124:127], v[154:157]
    s_waitcnt lgkmcnt(7)
    s_lshl1_add_u32 s58, s45, s41
    buffer_load_dwordx4 v168, s[4:7], s58 offen lds
    v_mfma_f32_16x16x32_bf16 v[158:161], a[244:247], a[76:79], v[158:161]
    s_waitcnt lgkmcnt(5)
    v_xor_b32 v243, 64, v242
    v_add_u32 v244, 0x237c0, v244
    v_mfma_f32_16x16x32_bf16 v[162:165], a[244:247], a[100:103], v[162:165]
    s_waitcnt lgkmcnt(3)
    ds_read_b128 a[232:235], v240 offset:30848
    v_mfma_f32_16x16x32_bf16 v[24:27], a[244:247], a[124:127], v[24:27]
    s_waitcnt lgkmcnt(3)
    v_add_u32 v245, 0x237c0, v245
    v_add_u32 v246, 0x237c0, v246
    v_mfma_f32_16x16x32_bf16 v[84:87], a[216:219], a[80:83], v[84:87]
    buffer_load_dwordx4 v171, s[4:7], s58 offen offset:512 lds
    v_accvgpr_write_b32 a252, v168
    v_mfma_f32_16x16x32_bf16 v[204:207], a[216:219], a[104:107], v[204:207]
    ds_read_b128 a[236:239], v240 offset:32384
    v_accvgpr_write_b32 a253, v169
    v_mfma_f32_16x16x32_bf16 v[208:211], a[216:219], a[128:131], v[208:211]
    s_waitcnt lgkmcnt(3)
    v_accvgpr_write_b32 a254, v170
    v_accvgpr_write_b32 a255, v171
    v_mfma_f32_16x16x32_bf16 v[212:215], a[220:223], a[80:83], v[212:215]
    ds_read_b128 a[240:243], v240 offset:33920
    v_accvgpr_read_b32 v254, a252
    v_mfma_f32_16x16x32_bf16 v[216:219], a[220:223], a[104:107], v[216:219]
    s_add_u32 m0, s46, 0xf000
    v_accvgpr_read_b32 v255, a253
    v_mov_b32 v248, 0
    v_mfma_f32_16x16x32_bf16 v[220:223], a[220:223], a[128:131], v[220:223]
    s_waitcnt lgkmcnt(3)
    buffer_load_dwordx4 v168, s[4:7], s42 offen lds
    v_mfma_f32_16x16x32_bf16 v[224:227], a[224:227], a[80:83], v[224:227]
    ds_read_b128 a[244:247], v240 offset:35456
    v_lshlrev_b32 v252, 4, v252
    v_mfma_f32_16x16x32_bf16 v[180:183], a[224:227], a[104:107], v[180:183]
    ds_read_b128 a[216:219], v241 offset:128
    v_lshlrev_b32 v253, 4, v253
    v_mfma_f32_16x16x32_bf16 v[184:187], a[224:227], a[128:131], v[184:187]
    s_waitcnt lgkmcnt(4)
    v_add_u32 v253, 0xfffffc00, v253
    s_lshl1_add_u32 s58, s45, s42
    v_mfma_f32_16x16x32_bf16 v[188:191], a[228:231], a[80:83], v[188:191]
    buffer_load_dwordx4 v169, s[4:7], s42 offen offset:1024 lds
    ds_read_b128 a[220:223], v241 offset:1664
    v_mfma_f32_16x16x32_bf16 v[192:195], a[228:231], a[104:107], v[192:195]
    s_waitcnt vmcnt(12)
    ds_read_b64_tr_b16 a[84:85], v249 offset:3072
    v_mfma_f32_16x16x32_bf16 v[196:199], a[228:231], a[128:131], v[196:199]
    s_waitcnt lgkmcnt(5)
    ds_read_b64_tr_b16 a[86:87], v250 offset:3072
    v_mfma_f32_16x16x32_bf16 v[200:203], a[232:235], a[80:83], v[200:203]
    ds_read_b64_tr_b16 a[108:109], v249 offset:3104
    ds_read_b64_tr_b16 a[110:111], v250 offset:3104
    v_mfma_f32_16x16x32_bf16 v[228:231], a[232:235], a[104:107], v[228:231]
    ds_read_b64_tr_b16 a[132:133], v249 offset:3136
    ds_read_b64_tr_b16 a[134:135], v250 offset:3136
    v_mfma_f32_16x16x32_bf16 v[232:235], a[232:235], a[128:131], v[232:235]
    s_waitcnt lgkmcnt(9)
    buffer_load_dwordx4 v170, s[4:7], s42 offen offset:2048 lds
    v_mfma_f32_16x16x32_bf16 v[236:239], a[236:239], a[80:83], v[236:239]
    ds_read_b128 a[224:227], v241 offset:3200
    s_add_u32 m0, s46, 0xfc00
    v_mfma_f32_16x16x32_bf16 v[138:141], a[236:239], a[104:107], v[138:141]
    ds_read_b128 a[228:231], v241 offset:4736
    ds_read_b128 a[232:235], v241 offset:30848
    v_mfma_f32_16x16x32_bf16 v[142:145], a[236:239], a[128:131], v[142:145]
    s_waitcnt lgkmcnt(11)
    ds_read_b128 a[236:239], v241 offset:32384
    v_mfma_f32_16x16x32_bf16 v[146:149], a[240:243], a[80:83], v[146:149]
    buffer_load_dwordx4 v168, s[4:7], s59 offen lds
    ds_read_u16 v30, v50 offset:3456
    v_mfma_f32_16x16x32_bf16 v[150:153], a[240:243], a[104:107], v[150:153]
    ds_read_u16 v31, v51 offset:3456
    ds_read_u16 v32, v50 offset:3482
    v_mfma_f32_16x16x32_bf16 v[154:157], a[240:243], a[128:131], v[154:157]
    s_waitcnt lgkmcnt(11)
    ds_read_b128 a[240:243], v241 offset:33920
    v_mfma_f32_16x16x32_bf16 v[158:161], a[244:247], a[80:83], v[158:161]
    s_waitcnt lgkmcnt(10)
    buffer_load_dwordx4 v169, s[4:7], s59 offen offset:1024 lds
    v_mfma_f32_16x16x32_bf16 v[162:165], a[244:247], a[104:107], v[162:165]
    s_waitcnt lgkmcnt(8)
    ds_read_u16 v33, v51 offset:3482
    v_mfma_f32_16x16x32_bf16 v[24:27], a[244:247], a[128:131], v[24:27]
    ds_read_b128 a[244:247], v241 offset:35456
    ds_read_u16 v34, v50 offset:3508
    v_mfma_f32_16x16x32_bf16 v[84:87], a[216:219], a[84:87], v[84:87]
    ds_read_u16 v35, v51 offset:3508
    ds_read_u16 v37, v51 offset:3534
    v_mfma_f32_16x16x32_bf16 v[204:207], a[216:219], a[108:111], v[204:207]
    ds_read_u16 v39, v51 offset:3560
    ds_read_u16 v41, v51 offset:3586
    v_mfma_f32_16x16x32_bf16 v[208:211], a[216:219], a[132:135], v[208:211]
    s_waitcnt lgkmcnt(14)
    ds_read_b128 a[216:219], v240 offset:256
    v_mfma_f32_16x16x32_bf16 v[212:215], a[220:223], a[84:87], v[212:215]
    ds_read_u16 v43, v51 offset:3612
    ds_read_u16 v45, v51 offset:3638
    v_mfma_f32_16x16x32_bf16 v[216:219], a[220:223], a[108:111], v[216:219]
    ds_read_u16 v47, v51 offset:3664
    ds_read_u16 v49, v51 offset:3690
    v_mfma_f32_16x16x32_bf16 v[220:223], a[220:223], a[132:135], v[220:223]
    ds_read_b128 a[220:223], v240 offset:1792
    buffer_load_dwordx4 v170, s[4:7], s59 offen offset:2048 lds
    v_mfma_f32_16x16x32_bf16 v[224:227], a[224:227], a[84:87], v[224:227]
    s_add_u32 m0, s46, 0x10800
    ds_read_u16 v36, v50 offset:3534
    v_mfma_f32_16x16x32_bf16 v[180:183], a[224:227], a[108:111], v[180:183]
    s_waitcnt lgkmcnt(15)
    v_lshlrev_b32 v30, 16, v30
    v_lshlrev_b32 v31, 16, v31
    v_mfma_f32_16x16x32_bf16 v[184:187], a[224:227], a[132:135], v[184:187]
    s_waitcnt lgkmcnt(14)
    v_fma_f32 v30, v30, v52, v60
    v_fma_f32 v31, v31, v53, v61
    v_mfma_f32_16x16x32_bf16 v[188:191], a[228:231], a[84:87], v[188:191]
    ds_read_b128 a[224:227], v240 offset:3328
    v_lshlrev_b32 v32, 16, v32
    v_mfma_f32_16x16x32_bf16 v[192:195], a[228:231], a[108:111], v[192:195]
    s_waitcnt vmcnt(13) lgkmcnt(14)
    ds_read_b64_tr_b16 a[88:89], v249 offset:6144
    v_mfma_f32_16x16x32_bf16 v[196:199], a[228:231], a[132:135], v[196:199]
    ds_read_b64_tr_b16 a[90:91], v250 offset:6144
    ds_read_b64_tr_b16 a[112:113], v249 offset:6176
    v_mfma_f32_16x16x32_bf16 v[200:203], a[232:235], a[84:87], v[200:203]
    ds_read_b64_tr_b16 a[114:115], v250 offset:6176
    ds_read_b64_tr_b16 a[136:137], v249 offset:6208
    v_mfma_f32_16x16x32_bf16 v[228:231], a[232:235], a[108:111], v[228:231]
    ds_read_b64_tr_b16 a[138:139], v250 offset:6208
    v_lshlrev_b32 v33, 16, v33
    v_mfma_f32_16x16x32_bf16 v[232:235], a[232:235], a[132:135], v[232:235]
    s_waitcnt lgkmcnt(14)
    v_fma_f32 v32, v32, v52, v60
    v_fma_f32 v33, v33, v53, v61
    v_mfma_f32_16x16x32_bf16 v[236:239], a[236:239], a[84:87], v[236:239]
    ds_read_b128 a[228:231], v240 offset:4864
    v_lshlrev_b32 v34, 16, v34
    v_mfma_f32_16x16x32_bf16 v[138:141], a[236:239], a[108:111], v[138:141]
    ds_read_b128 a[232:235], v240 offset:30976
    v_lshlrev_b32 v35, 16, v35
    v_mfma_f32_16x16x32_bf16 v[142:145], a[236:239], a[132:135], v[142:145]
    ds_read_b128 a[236:239], v240 offset:32512
    v_fma_f32 v34, v34, v52, v60
    v_mfma_f32_16x16x32_bf16 v[146:149], a[240:243], a[84:87], v[146:149]
    buffer_load_dwordx4 v168, s[4:7], s58 offen lds
    v_fma_f32 v35, v35, v53, v61
    v_mfma_f32_16x16x32_bf16 v[150:153], a[240:243], a[108:111], v[150:153]
    ds_read_u16 v38, v50 offset:3560
    v_lshlrev_b32 v37, 16, v37
    v_mfma_f32_16x16x32_bf16 v[154:157], a[240:243], a[132:135], v[154:157]
    s_waitcnt lgkmcnt(8)
    v_lshlrev_b32 v39, 16, v39
    v_lshlrev_b32 v41, 16, v41
    v_mfma_f32_16x16x32_bf16 v[158:161], a[244:247], a[84:87], v[158:161]
    s_waitcnt lgkmcnt(6)
    v_lshlrev_b32 v43, 16, v43
    v_lshlrev_b32 v45, 16, v45
    v_mfma_f32_16x16x32_bf16 v[162:165], a[244:247], a[108:111], v[162:165]
    s_waitcnt lgkmcnt(4)
    v_lshlrev_b32 v47, 16, v47
    v_lshlrev_b32 v49, 16, v49
    v_mfma_f32_16x16x32_bf16 v[24:27], a[244:247], a[132:135], v[24:27]
    ds_read_b128 a[240:243], v240 offset:34048
    v_fma_f32 v37, v37, v53, v61
    v_mfma_f32_16x16x32_bf16 v[84:87], a[216:219], a[88:91], v[84:87]
    ds_read_b128 a[244:247], v240 offset:35584
    v_fma_f32 v39, v39, v53, v61
    v_mfma_f32_16x16x32_bf16 v[204:207], a[216:219], a[112:115], v[204:207]
    ds_read_u16 v40, v50 offset:3586
    v_fma_f32 v41, v41, v53, v61
    v_mfma_f32_16x16x32_bf16 v[208:211], a[216:219], a[136:139], v[208:211]
    ds_read_b128 a[216:219], v241 offset:256
    v_fma_f32 v43, v43, v53, v61
    v_mfma_f32_16x16x32_bf16 v[212:215], a[220:223], a[88:91], v[212:215]
    ds_read_u16 v42, v50 offset:3612
    v_fma_f32 v45, v45, v53, v61
    v_mfma_f32_16x16x32_bf16 v[216:219], a[220:223], a[112:115], v[216:219]
    ds_read_u16 v44, v50 offset:3638
    s_waitcnt lgkmcnt(9)
    v_mfma_f32_16x16x32_bf16 v[220:223], a[220:223], a[136:139], v[220:223]
    ds_read_b128 a[220:223], v241 offset:1792
    v_fma_f32 v47, v47, v53, v61
    v_mfma_f32_16x16x32_bf16 v[224:227], a[224:227], a[88:91], v[224:227]
    s_waitcnt lgkmcnt(9)
    v_fma_f32 v49, v49, v53, v61
    v_lshlrev_b32 v36, 16, v36
    v_mfma_f32_16x16x32_bf16 v[180:183], a[224:227], a[112:115], v[180:183]
    s_waitcnt lgkmcnt(8)
    v_fma_f32 v36, v36, v52, v60
    s_add_u32 s62, s39, 0x12000
    v_mfma_f32_16x16x32_bf16 v[184:187], a[224:227], a[136:139], v[184:187]
    ds_read_b128 a[224:227], v241 offset:3328
    ds_read_u16 v46, v50 offset:3664
    v_mfma_f32_16x16x32_bf16 v[188:191], a[228:231], a[88:91], v[188:191]
    ds_read_u16 v48, v50 offset:3690
    buffer_load_dwordx4 v171, s[4:7], s58 offen offset:512 lds
    v_mfma_f32_16x16x32_bf16 v[192:195], a[228:231], a[112:115], v[192:195]
    s_waitcnt vmcnt(12) lgkmcnt(10)
    ds_read_b64_tr_b16 a[92:93], v249 offset:9216
    v_mfma_f32_16x16x32_bf16 v[196:199], a[228:231], a[136:139], v[196:199]
    ds_read_b64_tr_b16 a[94:95], v250 offset:9216
    ds_read_b64_tr_b16 a[116:117], v249 offset:9248
    v_mfma_f32_16x16x32_bf16 v[200:203], a[232:235], a[88:91], v[200:203]
    ds_read_b64_tr_b16 a[118:119], v250 offset:9248
    ds_read_b64_tr_b16 a[140:141], v249 offset:9280
    v_mfma_f32_16x16x32_bf16 v[228:231], a[232:235], a[112:115], v[228:231]
    ds_read_b64_tr_b16 a[142:143], v250 offset:9280
    s_waitcnt lgkmcnt(13)
    v_mfma_f32_16x16x32_bf16 v[232:235], a[232:235], a[136:139], v[232:235]
    ds_read_b128 a[228:231], v241 offset:4864
    v_lshlrev_b32 v38, 16, v38
    v_mfma_f32_16x16x32_bf16 v[236:239], a[236:239], a[88:91], v[236:239]
    ds_read_b128 a[232:235], v241 offset:30976
    v_fma_f32 v38, v38, v52, v60
    v_mfma_f32_16x16x32_bf16 v[138:141], a[236:239], a[112:115], v[138:141]
    ds_write_b64 v62, v[30:31] offset:0
    v_mfma_f32_16x16x32_bf16 v[142:145], a[236:239], a[136:139], v[142:145]
    ds_read_b128 a[236:239], v241 offset:32512
    v_add_u32 v62, s49, v62
    v_mfma_f32_16x16x32_bf16 v[146:149], a[240:243], a[88:91], v[146:149]
L_h2:
    s_cbranch_execz L_h6
    ds_write_b64 v62, v[32:33] offset:0
    v_mfma_f32_16x16x32_bf16 v[150:153], a[240:243], a[112:115], v[150:153]
    s_add_u32 m0, s29, 0
    v_add_u32 v62, s49, v62
    v_lshlrev_b32 v40, 16, v40
    v_mfma_f32_16x16x32_bf16 v[154:157], a[240:243], a[136:139], v[154:157]
    s_waitcnt lgkmcnt(9)
    v_fma_f32 v40, v40, v52, v60
    v_lshlrev_b32 v42, 16, v42
    v_mfma_f32_16x16x32_bf16 v[158:161], a[244:247], a[88:91], v[158:161]
    s_waitcnt lgkmcnt(7)
    v_fma_f32 v42, v42, v52, v60
    v_lshlrev_b32 v44, 16, v44
    v_mfma_f32_16x16x32_bf16 v[162:165], a[244:247], a[112:115], v[162:165]
    s_waitcnt lgkmcnt(5)
    v_fma_f32 v44, v44, v52, v60
    v_lshlrev_b32 v46, 16, v46
    v_mfma_f32_16x16x32_bf16 v[24:27], a[244:247], a[136:139], v[24:27]
    ds_read_b128 a[240:243], v241 offset:34048
    v_fma_f32 v46, v46, v52, v60
    v_mfma_f32_16x16x32_bf16 v[84:87], a[216:219], a[92:95], v[84:87]
    ds_read_b128 a[244:247], v241 offset:35584
    v_lshlrev_b32 v48, 16, v48
    v_mfma_f32_16x16x32_bf16 v[204:207], a[216:219], a[116:119], v[204:207]
    ds_write_b64 v62, v[34:35] offset:0
    v_mfma_f32_16x16x32_bf16 v[208:211], a[216:219], a[140:143], v[208:211]
    ds_write_b64 v63, v[64:65] offset:0
    v_mfma_f32_16x16x32_bf16 v[212:215], a[220:223], a[92:95], v[212:215]
    s_waitcnt lgkmcnt(8)
    v_add_u32 v62, s49, v62
    v_cvt_pk_bf16_f32 v0, v84, v85
    v_mfma_f32_16x16x32_bf16 v[216:219], a[220:223], a[116:119], v[216:219]
    s_waitcnt lgkmcnt(7)
    v_cvt_pk_bf16_f32 v3, v86, v87
    v_fma_f32 v48, v48, v52, v60
    v_mfma_f32_16x16x32_bf16 v[220:223], a[220:223], a[140:143], v[220:223]
    buffer_load_dwordx4 v172, s[8:11], s60 offen lds
    v_cvt_pk_bf16_f32 v30, v204, v205
    v_mfma_f32_16x16x32_bf16 v[224:227], a[224:227], a[92:95], v[224:227]
    s_waitcnt lgkmcnt(5)
    v_cvt_pk_bf16_f32 v33, v206, v207
    v_cvt_pk_bf16_f32 v60, v208, v209
    v_mfma_f32_16x16x32_bf16 v[180:183], a[224:227], a[116:119], v[180:183]
    ds_write_b64 v62, v[36:37] offset:0
    v_mfma_f32_16x16x32_bf16 v[184:187], a[224:227], a[140:143], v[184:187]
    s_add_u32 s63, s39, 0x1b000
    v_add_u32 v62, s49, v62
    v_cvt_pk_bf16_f32 v63, v210, v211
    v_mfma_f32_16x16x32_bf16 v[188:191], a[228:231], a[92:95], v[188:191]
    ds_write_b64 v62, v[38:39] offset:0
    v_mfma_f32_16x16x32_bf16 v[192:195], a[228:231], a[116:119], v[192:195]
    s_waitcnt vmcnt(9)
    s_barrier
    v_mfma_f32_16x16x32_bf16 v[196:199], a[228:231], a[140:143], v[196:199]
    ds_read_b128 a[216:219], v240 offset:6144
    v_add_u32 v62, s49, v62
    v_mfma_f32_16x16x32_bf16 v[200:203], a[232:235], a[92:95], v[200:203]
    s_waitcnt lgkmcnt(4)
    v_cvt_pk_bf16_f32 v72, v184, v185
    v_cvt_pk_bf16_f32 v6, v212, v213
    v_mfma_f32_16x16x32_bf16 v[228:231], a[232:235], a[116:119], v[228:231]
    ds_read_b128 a[220:223], v241 offset:6144
    v_cvt_pk_bf16_f32 v78, v196, v197
    v_mfma_f32_16x16x32_bf16 v[232:235], a[232:235], a[140:143], v[232:235]
    ds_read_b128 a[224:227], v240 offset:6272
    v_cvt_pk_bf16_f32 v81, v198, v199
    v_mfma_f32_16x16x32_bf16 v[236:239], a[236:239], a[92:95], v[236:239]
    ds_read_b128 a[228:231], v241 offset:6272
    v_cvt_pk_bf16_f32 v1, v200, v201
    v_mfma_f32_16x16x32_bf16 v[138:141], a[236:239], a[116:119], v[138:141]
    s_add_u32 s59, s43, s45
    v_cvt_pk_bf16_f32 v31, v228, v229
    v_cvt_pk_bf16_f32 v34, v230, v231
    v_mfma_f32_16x16x32_bf16 v[142:145], a[236:239], a[140:143], v[142:145]
    ds_read_b128 a[232:235], v240 offset:6400
    v_cvt_pk_bf16_f32 v61, v232, v233
    v_mfma_f32_16x16x32_bf16 v[146:149], a[240:243], a[92:95], v[146:149]
    ds_read_b128 a[236:239], v241 offset:6400
    v_cvt_pk_bf16_f32 v64, v234, v235
    v_mfma_f32_16x16x32_bf16 v[150:153], a[240:243], a[116:119], v[150:153]
    s_lshl1_add_u32 s58, s45, s43
    v_cvt_pk_bf16_f32 v7, v236, v237
    v_cvt_pk_bf16_f32 v10, v238, v239
    v_mfma_f32_16x16x32_bf16 v[154:157], a[240:243], a[140:143], v[154:157]
    s_waitcnt lgkmcnt(5)
    v_cvt_pk_bf16_f32 v37, v138, v139
    v_cvt_pk_bf16_f32 v67, v142, v143
    v_mfma_f32_16x16x32_bf16 v[158:161], a[244:247], a[92:95], v[158:161]
    buffer_load_dwordx4 v173, s[8:11], s60 offen offset:1024 lds
    v_cvt_pk_bf16_f32 v70, v144, v145
    v_mfma_f32_16x16x32_bf16 v[162:165], a[244:247], a[116:119], v[162:165]
    ds_write_b64 v62, v[40:41] offset:0
    v_mfma_f32_16x16x32_bf16 v[24:27], a[244:247], a[140:143], v[24:27]
    ds_read_b128 a[240:243], v240 offset:36864
    v_cvt_pk_bf16_f32 v40, v140, v141
    v_mfma_f32_16x16x32_bf16 v[228:231], a[0:3], a[216:219], 0
    s_waitcnt lgkmcnt(6)
    v_add_u32 v62, s49, v62
    v_cvt_pk_bf16_f32 v13, v146, v147
    v_mfma_f32_16x16x32_bf16 v[228:231], a[4:7], a[220:223], v[228:231]
    ds_read_b128 a[244:247], v241 offset:36864
    v_cvt_pk_bf16_f32 v79, v24, v25
    v_mfma_f32_16x16x32_bf16 v[232:235], a[24:27], a[216:219], 0
    s_waitcnt lgkmcnt(6)
    v_cvt_pk_bf16_f32 v82, v26, v27
    v_cvt_pk_bf16_f32 v16, v148, v149
    v_mfma_f32_16x16x32_bf16 v[228:231], a[8:11], a[224:227], v[228:231]
    ds_write_b64 v62, v[42:43] offset:0
    v_mfma_f32_16x16x32_bf16 v[232:235], a[28:31], a[220:223], v[232:235]
    s_waitcnt lgkmcnt(6)
    v_add_u32 v62, s49, v62
    v_cvt_pk_bf16_f32 v43, v150, v151
    v_mfma_f32_16x16x32_bf16 v[228:231], a[12:15], a[228:231], v[228:231]
    buffer_load_dwordx4 v174, s[8:11], s60 offen offset:2048 lds
    v_cvt_pk_bf16_f32 v73, v154, v155
    v_mfma_f32_16x16x32_bf16 v[232:235], a[32:35], a[224:227], v[232:235]
    s_waitcnt lgkmcnt(5)
    v_cvt_pk_bf16_f32 v76, v156, v157
    v_cvt_pk_bf16_f32 v19, v158, v159
    v_mfma_f32_16x16x32_bf16 v[228:231], a[16:19], a[232:235], v[228:231]
    s_waitcnt lgkmcnt(4)
    v_cvt_pk_bf16_f32 v22, v160, v161
    v_cvt_pk_bf16_f32 v52, v164, v165
    v_mfma_f32_16x16x32_bf16 v[228:231], a[20:23], a[236:239], v[228:231]
    s_add_u32 m0, s29, 0xc00
    v_cvt_pk_bf16_f32 v4, v202, v203
    v_cvt_pk_bf16_f32 v42, v180, v181
    v_mfma_f32_16x16x32_bf16 v[232:235], a[36:39], a[228:231], v[232:235]
    ds_write_b64 v62, v[44:45] offset:0
    v_mfma_f32_16x16x32_bf16 v[232:235], a[40:43], a[232:235], v[232:235]
    s_add_u32 s60, s39, 0x24000
    v_add_u32 v62, s49, v62
    v_cvt_pk_bf16_f32 v138, v228, v229
    v_mfma_f32_16x16x32_bf16 v[232:235], a[44:47], a[236:239], v[232:235]
    s_add_u32 s55, s28, 7
    v_cvt_pk_bf16_f32 v139, v230, v231
    v_cvt_pk_bf16_f32 v45, v182, v183
    v_mfma_f32_16x16x32_bf16 v[236:239], a[48:51], a[216:219], 0
    buffer_load_dwordx4 v172, s[8:11], s61 offen lds
    v_cvt_pk_bf16_f32 v9, v214, v215
    v_mfma_f32_16x16x32_bf16 v[236:239], a[52:55], a[220:223], v[236:239]
    ds_write_b64 v62, v[46:47] offset:0
    v_mfma_f32_16x16x32_bf16 v[236:239], a[56:59], a[224:227], v[236:239]
    s_mul_i32 s55, s55, s30
    v_cvt_pk_bf16_f32 v140, v232, v233
    v_cvt_pk_bf16_f32 v141, v234, v235
    v_mfma_f32_16x16x32_bf16 v[236:239], a[60:63], a[228:231], v[236:239]
    s_waitcnt lgkmcnt(2)
    v_cvt_pk_bf16_f32 v46, v152, v153
    v_add_u32 v62, s49, v62
    v_mfma_f32_16x16x32_bf16 v[236:239], a[64:67], a[232:235], v[236:239]
    ds_write_b64 v62, v[48:49] offset:0
    v_mfma_f32_16x16x32_bf16 v[236:239], a[68:71], a[236:239], v[236:239]
    v_add_u32 v62, s49, v62
    v_cvt_pk_bf16_f32 v49, v162, v163
    v_mfma_f32_16x16x32_bf16 v[228:231], a[216:219], a[72:75], 0
    ds_read_b128 v[196:199], v244 offset:192
    v_cvt_pk_bf16_f32 v36, v216, v217
    v_mfma_f32_16x16x32_bf16 v[228:231], a[220:223], a[76:79], v[228:231]
    ds_read_b128 v[200:203], v245 offset:192
    v_cvt_pk_bf16_f32 v39, v218, v219
    v_mfma_f32_16x16x32_bf16 v[228:231], a[224:227], a[80:83], v[228:231]
    v_cvt_pk_bf16_f32 v142, v236, v237
    v_cvt_pk_bf16_f32 v143, v238, v239
    v_mfma_f32_16x16x32_bf16 v[228:231], a[228:231], a[84:87], v[228:231]
    ds_read_b128 v[204:207], v246 offset:192
    v_cvt_pk_bf16_f32 v66, v220, v221
    v_mfma_f32_16x16x32_bf16 v[228:231], a[232:235], a[88:91], v[228:231]
    ds_read_b128 v[208:211], v244 offset:256
    v_cvt_pk_bf16_f32 v69, v222, v223
    v_mfma_f32_16x16x32_bf16 v[228:231], a[236:239], a[92:95], v[228:231]
    v_cvt_pk_bf16_f32 v12, v224, v225
    v_cvt_pk_bf16_f32 v15, v226, v227
    v_mfma_f32_16x16x32_bf16 v[232:235], a[216:219], a[96:99], 0
    v_cvt_pk_bf16_f32 v75, v186, v187
    v_cvt_pk_bf16_f32 v18, v188, v189
    v_mfma_f32_16x16x32_bf16 v[232:235], a[220:223], a[100:103], v[232:235]
    v_cvt_pk_bf16_f32 v21, v190, v191
    v_cvt_pk_bf16_f32 v48, v192, v193
    v_mfma_f32_16x16x32_bf16 v[232:235], a[224:227], a[104:107], v[232:235]
    buffer_load_dwordx4 v173, s[8:11], s61 offen offset:1024 lds
    v_cvt_pk_bf16_f32 v24, v228, v229
    v_mfma_f32_16x16x32_bf16 v[232:235], a[228:231], a[108:111], v[232:235]
    v_cvt_pk_bf16_f32 v27, v230, v231
    v_cvt_pk_bf16_f32 v51, v194, v195
    v_mfma_f32_16x16x32_bf16 v[232:235], a[232:235], a[112:115], v[232:235]
    s_waitcnt lgkmcnt(3)
    v_mov_b32 v195, 0
    v_mfma_f32_16x16x32_bf16 v[232:235], a[236:239], a[116:119], v[232:235]
    s_waitcnt lgkmcnt(2)
    v_mfma_f32_16x16x32_bf16 v[236:239], a[216:219], a[120:123], 0
    ds_read_b128 a[216:219], v240 offset:36992
    v_mfma_f32_16x16x32_bf16 v[236:239], a[220:223], a[124:127], v[236:239]
    ds_read_b128 a[220:223], v241 offset:36992
    v_mfma_f32_16x16x32_bf16 v[236:239], a[224:227], a[128:131], v[236:239]
    ds_read_b128 a[224:227], v240 offset:37120
    v_mfma_f32_16x16x32_bf16 v[236:239], a[228:231], a[132:135], v[236:239]
    ds_read_b128 a[228:231], v241 offset:37120
    v_cvt_pk_bf16_f32 v54, v232, v233
    v_mfma_f32_16x16x32_bf16 v[236:239], a[232:235], a[136:139], v[236:239]
    buffer_load_dwordx4 v174, s[8:11], s61 offen offset:2048 lds
    v_cvt_pk_bf16_f32 v57, v234, v235
    v_mfma_f32_16x16x32_bf16 v[236:239], a[236:239], a[140:143], v[236:239]
    s_add_u32 m0, s29, 0x1800
    s_add_u32 s61, s39, 0x2d000
    v_mfma_f32_16x16x32_bf16 v[228:231], a[0:3], a[240:243], 0
    s_waitcnt lgkmcnt(4)
    v_mfma_f32_16x16x32_bf16 v[228:231], a[4:7], a[244:247], v[228:231]
    v_mfma_f32_16x16x32_bf16 v[232:235], a[24:27], a[240:243], 0
    v_mfma_f32_16x16x32_bf16 v[232:235], a[28:31], a[244:247], v[232:235]
    s_waitcnt lgkmcnt(3)
    v_cvt_pk_bf16_f32 v84, v236, v237
    v_cvt_pk_bf16_f32 v87, v238, v239
    v_mfma_f32_16x16x32_bf16 v[228:231], a[8:11], a[216:219], v[228:231]
    s_waitcnt lgkmcnt(2)
    v_mfma_f32_16x16x32_bf16 v[228:231], a[12:15], a[220:223], v[228:231]
    s_waitcnt lgkmcnt(1)
    buffer_load_dwordx4 v172, s[8:11], s62 offen lds
    v_mfma_f32_16x16x32_bf16 v[228:231], a[16:19], a[224:227], v[228:231]
    s_waitcnt lgkmcnt(0)
    v_mfma_f32_16x16x32_bf16 v[228:231], a[20:23], a[228:231], v[228:231]
    v_mfma_f32_16x16x32_bf16 v[232:235], a[32:35], a[216:219], v[232:235]
    v_mfma_f32_16x16x32_bf16 v[232:235], a[36:39], a[220:223], v[232:235]
    v_mfma_f32_16x16x32_bf16 v[232:235], a[40:43], a[224:227], v[232:235]
    v_mfma_f32_16x16x32_bf16 v[232:235], a[44:47], a[228:231], v[232:235]
    v_mfma_f32_16x16x32_bf16 v[236:239], a[48:51], a[240:243], 0
    buffer_load_dwordx4 v173, s[8:11], s62 offen offset:1024 lds
    v_mfma_f32_16x16x32_bf16 v[236:239], a[52:55], a[244:247], v[236:239]
    v_mfma_f32_16x16x32_bf16 v[236:239], a[56:59], a[216:219], v[236:239]
    v_cvt_pk_bf16_f32 v144, v228, v229
    v_cvt_pk_bf16_f32 v145, v230, v231
    v_mfma_f32_16x16x32_bf16 v[236:239], a[60:63], a[220:223], v[236:239]
    v_mfma_f32_16x16x32_bf16 v[236:239], a[64:67], a[224:227], v[236:239]
    v_cvt_pk_bf16_f32 v146, v232, v233
    v_cvt_pk_bf16_f32 v147, v234, v235
    v_mfma_f32_16x16x32_bf16 v[236:239], a[68:71], a[228:231], v[236:239]
    v_mfma_f32_16x16x32_bf16 v[228:231], a[240:243], a[72:75], 0
    v_mfma_f32_16x16x32_bf16 v[228:231], a[244:247], a[76:79], v[228:231]
    buffer_load_dwordx4 v174, s[8:11], s62 offen offset:2048 lds
    s_add_u32 m0, s29, 0x2400
    v_mfma_f32_16x16x32_bf16 v[228:231], a[216:219], a[80:83], v[228:231]
    s_lshl_b32 s62, s28, 5
    s_add_u32 s62, s62, 0
    v_mfma_f32_16x16x32_bf16 v[228:231], a[220:223], a[84:87], v[228:231]
    v_cvt_pk_bf16_f32 v148, v236, v237
    v_cvt_pk_bf16_f32 v149, v238, v239
    v_mfma_f32_16x16x32_bf16 v[228:231], a[224:227], a[88:91], v[228:231]
    s_waitcnt vmcnt(12)
    s_barrier
    v_mfma_f32_16x16x32_bf16 v[228:231], a[228:231], a[92:95], v[228:231]
    ds_read_b128 a[232:235], v240 offset:61440
    ds_read_b128 a[236:239], v241 offset:61440
    v_mfma_f32_16x16x32_bf16 v[232:235], a[240:243], a[96:99], 0
    buffer_load_dwordx4 v172, s[8:11], s63 offen lds
    v_mfma_f32_16x16x32_bf16 v[232:235], a[244:247], a[100:103], v[232:235]
    v_mfma_f32_16x16x32_bf16 v[232:235], a[216:219], a[104:107], v[232:235]
    v_mfma_f32_16x16x32_bf16 v[232:235], a[220:223], a[108:111], v[232:235]
    v_mfma_f32_16x16x32_bf16 v[232:235], a[224:227], a[112:115], v[232:235]
    v_cvt_pk_bf16_f32 v25, v228, v229
    v_cvt_pk_bf16_f32 v28, v230, v231
    v_mfma_f32_16x16x32_bf16 v[232:235], a[228:231], a[116:119], v[232:235]
    v_mfma_f32_16x16x32_bf16 v[236:239], a[240:243], a[120:123], 0
    ds_read_b128 a[240:243], v240 offset:61568
    v_mfma_f32_16x16x32_bf16 v[236:239], a[244:247], a[124:127], v[236:239]
    ds_read_b128 a[244:247], v241 offset:61568
    buffer_load_dwordx4 v173, s[8:11], s63 offen offset:1024 lds
    v_mfma_f32_16x16x32_bf16 v[236:239], a[216:219], a[128:131], v[236:239]
    ds_read_b128 a[216:219], v240 offset:61696
    s_waitcnt lgkmcnt(4)
    v_mfma_f32_16x16x32_bf16 v[236:239], a[220:223], a[132:135], v[236:239]
    ds_read_b128 a[220:223], v241 offset:61696
    v_cvt_pk_bf16_f32 v55, v232, v233
    v_mfma_f32_16x16x32_bf16 v[236:239], a[224:227], a[136:139], v[236:239]
    ds_read_b128 a[224:227], v240 offset:62976
    v_cvt_pk_bf16_f32 v58, v234, v235
    v_mfma_f32_16x16x32_bf16 v[236:239], a[228:231], a[140:143], v[236:239]
    ds_read_b128 a[228:231], v241 offset:62976
    v_mfma_f32_16x16x32_bf16 v[228:231], a[0:3], a[232:235], 0
    s_waitcnt lgkmcnt(6)
    v_mfma_f32_16x16x32_bf16 v[228:231], a[4:7], a[236:239], v[228:231]
    s_waitcnt vmcnt(8)
    ds_read_b64_tr_b16 a[144:145], v249 offset:0
    v_mfma_f32_16x16x32_bf16 v[232:235], a[24:27], a[232:235], 0
    s_waitcnt lgkmcnt(6)
    ds_read_b64_tr_b16 a[146:147], v250 offset:0
    v_mfma_f32_16x16x32_bf16 v[228:231], a[8:11], a[240:243], v[228:231]
    s_waitcnt lgkmcnt(6)
    ds_read_b64_tr_b16 a[168:169], v249 offset:32
    v_mfma_f32_16x16x32_bf16 v[228:231], a[12:15], a[244:247], v[228:231]
    ds_read_b64_tr_b16 a[170:171], v250 offset:32
    ds_read_b64_tr_b16 a[192:193], v249 offset:64
    v_mfma_f32_16x16x32_bf16 v[232:235], a[28:31], a[236:239], v[232:235]
    ds_read_b64_tr_b16 a[194:195], v250 offset:64
    s_waitcnt lgkmcnt(9)
    v_mfma_f32_16x16x32_bf16 v[228:231], a[16:19], a[216:219], v[228:231]
    s_waitcnt lgkmcnt(8)
    buffer_load_dwordx4 v174, s[8:11], s63 offen offset:2048 lds
    v_mfma_f32_16x16x32_bf16 v[228:231], a[20:23], a[220:223], v[228:231]
    s_add_u32 m0, s29, 0
    v_cvt_pk_bf16_f32 v85, v236, v237
    v_cvt_pk_bf16_f32 v88, v238, v239
    v_mfma_f32_16x16x32_bf16 v[232:235], a[32:35], a[240:243], v[232:235]
    s_lshl_b32 s63, s28, 5
    s_add_u32 s63, s63, 0x4800
    v_mfma_f32_16x16x32_bf16 v[232:235], a[36:39], a[244:247], v[232:235]
    s_waitcnt lgkmcnt(6)
    v_cvt_pk_bf16_f32 v150, v228, v229
    v_cvt_pk_bf16_f32 v151, v230, v231
    v_mfma_f32_16x16x32_bf16 v[232:235], a[40:43], a[216:219], v[232:235]
    v_mfma_f32_16x16x32_bf16 v[232:235], a[44:47], a[220:223], v[232:235]
    s_waitcnt lgkmcnt(5)
    v_mfma_f32_16x16x32_bf16 v[236:239], a[48:51], a[232:235], 0
    s_waitcnt lgkmcnt(4)
    v_mfma_f32_16x16x32_bf16 v[236:239], a[52:55], a[236:239], v[236:239]
    s_waitcnt lgkmcnt(3)
    s_waitcnt lgkmcnt(0)
    buffer_load_dwordx4 v172, s[8:11], s60 offen lds
    v_mfma_f32_16x16x32_bf16 v[236:239], a[56:59], a[240:243], v[236:239]
    v_cvt_pk_bf16_f32 v152, v232, v233
    v_cvt_pk_bf16_f32 v153, v234, v235
    v_mfma_f32_16x16x32_bf16 v[236:239], a[60:63], a[244:247], v[236:239]
    v_mfma_f32_16x16x32_bf16 v[236:239], a[64:67], a[216:219], v[236:239]
    v_mfma_f32_16x16x32_bf16 v[236:239], a[68:71], a[220:223], v[236:239]
    v_mfma_f32_16x16x32_bf16 v[228:231], a[232:235], a[72:75], 0
    v_mfma_f32_16x16x32_bf16 v[228:231], a[236:239], a[76:79], v[228:231]
    v_mfma_f32_16x16x32_bf16 v[228:231], a[240:243], a[80:83], v[228:231]
    buffer_load_dwordx4 v173, s[8:11], s60 offen offset:1024 lds
    v_mfma_f32_16x16x32_bf16 v[228:231], a[244:247], a[84:87], v[228:231]
    v_mfma_f32_16x16x32_bf16 v[228:231], a[216:219], a[88:91], v[228:231]
    s_waitcnt vmcnt(8)
    ds_read_b64_tr_b16 a[148:149], v249 offset:3072
    v_mfma_f32_16x16x32_bf16 v[228:231], a[220:223], a[92:95], v[228:231]
    ds_read_b64_tr_b16 a[150:151], v250 offset:3072
    ds_read_b64_tr_b16 a[172:173], v249 offset:3104
    v_mfma_f32_16x16x32_bf16 v[232:235], a[232:235], a[96:99], 0
    ds_read_b64_tr_b16 a[174:175], v250 offset:3104
    ds_read_b64_tr_b16 a[196:197], v249 offset:3136
    v_mfma_f32_16x16x32_bf16 v[232:235], a[236:239], a[100:103], v[232:235]
    ds_read_b64_tr_b16 a[198:199], v250 offset:3136
    v_cvt_pk_bf16_f32 v154, v236, v237
    v_mfma_f32_16x16x32_bf16 v[232:235], a[240:243], a[104:107], v[232:235]
    v_cvt_pk_bf16_f32 v155, v238, v239
    v_cvt_pk_bf16_f32 v2, v228, v229
    v_mfma_f32_16x16x32_bf16 v[232:235], a[244:247], a[108:111], v[232:235]
    buffer_load_dwordx4 v174, s[8:11], s60 offen offset:2048 lds
    v_cvt_pk_bf16_f32 v5, v230, v231
    v_mfma_f32_16x16x32_bf16 v[232:235], a[216:219], a[112:115], v[232:235]
    s_add_u32 m0, s29, 0xc00
    s_lshl_b32 s60, s28, 5
    s_add_u32 s60, s60, 0x1800
    v_mfma_f32_16x16x32_bf16 v[232:235], a[220:223], a[116:119], v[232:235]
    v_mfma_f32_16x16x32_bf16 v[236:239], a[232:235], a[120:123], 0
    ds_read_b128 a[232:235], v240 offset:63104
    v_mfma_f32_16x16x32_bf16 v[236:239], a[236:239], a[124:127], v[236:239]
    ds_read_b128 a[236:239], v241 offset:63104
    v_mfma_f32_16x16x32_bf16 v[236:239], a[240:243], a[128:131], v[236:239]
    ds_read_b128 a[240:243], v240 offset:63232
    v_mfma_f32_16x16x32_bf16 v[236:239], a[244:247], a[132:135], v[236:239]
    ds_read_b128 a[244:247], v241 offset:63232
    s_waitcnt lgkmcnt(4)
    v_mfma_f32_16x16x32_bf16 v[236:239], a[216:219], a[136:139], v[236:239]
    buffer_load_dwordx4 v172, s[8:11], s61 offen lds
    v_cvt_pk_bf16_f32 v32, v232, v233
    v_mfma_f32_16x16x32_bf16 v[236:239], a[220:223], a[140:143], v[236:239]
    ds_read_b128 a[216:219], v240 offset:64512
    v_cvt_pk_bf16_f32 v35, v234, v235
    v_mfma_f32_16x16x32_bf16 v[228:231], a[0:3], a[224:227], 0
    ds_read_b128 a[220:223], v241 offset:64512
    v_mfma_f32_16x16x32_bf16 v[228:231], a[4:7], a[228:231], v[228:231]
    v_mfma_f32_16x16x32_bf16 v[232:235], a[24:27], a[224:227], 0
    v_mfma_f32_16x16x32_bf16 v[232:235], a[28:31], a[228:231], v[232:235]
    s_waitcnt vmcnt(7) lgkmcnt(5)
    v_cvt_pk_bf16_f32 v62, v236, v237
    v_cvt_pk_bf16_f32 v65, v238, v239
    v_mfma_f32_16x16x32_bf16 v[228:231], a[8:11], a[232:235], v[228:231]
    s_waitcnt lgkmcnt(4)
    ds_read_b64_tr_b16 a[152:153], v249 offset:6144
    v_mfma_f32_16x16x32_bf16 v[228:231], a[12:15], a[236:239], v[228:231]
    s_waitcnt lgkmcnt(4)
    buffer_load_dwordx4 v173, s[8:11], s61 offen offset:1024 lds
    v_mfma_f32_16x16x32_bf16 v[228:231], a[16:19], a[240:243], v[228:231]
    s_waitcnt lgkmcnt(3)
    ds_read_b64_tr_b16 a[154:155], v250 offset:6144
    v_mfma_f32_16x16x32_bf16 v[228:231], a[20:23], a[244:247], v[228:231]
    ds_read_b64_tr_b16 a[176:177], v249 offset:6176
    ds_read_b64_tr_b16 a[178:179], v250 offset:6176
    v_mfma_f32_16x16x32_bf16 v[232:235], a[32:35], a[232:235], v[232:235]
    ds_read_b64_tr_b16 a[200:201], v249 offset:6208
    ds_read_b64_tr_b16 a[202:203], v250 offset:6208
    v_mfma_f32_16x16x32_bf16 v[232:235], a[36:39], a[236:239], v[232:235]
    s_waitcnt lgkmcnt(6)
    v_mfma_f32_16x16x32_bf16 v[232:235], a[40:43], a[240:243], v[232:235]
    v_cvt_pk_bf16_f32 v156, v228, v229
    v_cvt_pk_bf16_f32 v157, v230, v231
    v_mfma_f32_16x16x32_bf16 v[232:235], a[44:47], a[244:247], v[232:235]
    v_mfma_f32_16x16x32_bf16 v[236:239], a[48:51], a[224:227], 0
    buffer_load_dwordx4 v174, s[8:11], s61 offen offset:2048 lds
    s_add_u32 m0, s46, 0x16800
    v_mfma_f32_16x16x32_bf16 v[236:239], a[52:55], a[228:231], v[236:239]
    s_lshl_b32 s61, s28, 5
    s_add_u32 s61, s61, 0x6000
    v_mfma_f32_16x16x32_bf16 v[236:239], a[56:59], a[232:235], v[236:239]
    s_waitcnt lgkmcnt(5)
    v_cvt_pk_bf16_f32 v158, v232, v233
    v_cvt_pk_bf16_f32 v159, v234, v235
    v_mfma_f32_16x16x32_bf16 v[236:239], a[60:63], a[236:239], v[236:239]
    v_mfma_f32_16x16x32_bf16 v[236:239], a[64:67], a[240:243], v[236:239]
    s_waitcnt lgkmcnt(3)
    v_mfma_f32_16x16x32_bf16 v[236:239], a[68:71], a[244:247], v[236:239]
    s_waitcnt lgkmcnt(2)
    v_mfma_f32_16x16x32_bf16 v[228:231], a[224:227], a[72:75], 0
    s_waitcnt lgkmcnt(0)
    v_mfma_f32_16x16x32_bf16 v[228:231], a[228:231], a[76:79], v[228:231]
    v_mfma_f32_16x16x32_bf16 v[228:231], a[232:235], a[80:83], v[228:231]
    v_mfma_f32_16x16x32_bf16 v[228:231], a[236:239], a[84:87], v[228:231]
    v_mfma_f32_16x16x32_bf16 v[228:231], a[240:243], a[88:91], v[228:231]
    v_mfma_f32_16x16x32_bf16 v[228:231], a[244:247], a[92:95], v[228:231]
    v_cvt_pk_bf16_f32 v160, v236, v237
    v_cvt_pk_bf16_f32 v161, v238, v239
    v_mfma_f32_16x16x32_bf16 v[232:235], a[224:227], a[96:99], 0
    v_mfma_f32_16x16x32_bf16 v[232:235], a[228:231], a[100:103], v[232:235]
    v_mfma_f32_16x16x32_bf16 v[232:235], a[232:235], a[104:107], v[232:235]
    v_mfma_f32_16x16x32_bf16 v[232:235], a[236:239], a[108:111], v[232:235]
    v_mfma_f32_16x16x32_bf16 v[232:235], a[240:243], a[112:115], v[232:235]
    v_mfma_f32_16x16x32_bf16 v[232:235], a[244:247], a[116:119], v[232:235]
    v_cvt_pk_bf16_f32 v8, v228, v229
    v_cvt_pk_bf16_f32 v11, v230, v231
    v_mfma_f32_16x16x32_bf16 v[236:239], a[224:227], a[120:123], 0
    ds_read_b128 a[224:227], v240 offset:64640
    v_mfma_f32_16x16x32_bf16 v[236:239], a[228:231], a[124:127], v[236:239]
    ds_read_b128 a[228:231], v241 offset:64640
    v_mfma_f32_16x16x32_bf16 v[236:239], a[232:235], a[128:131], v[236:239]
    ds_read_b128 a[232:235], v240 offset:64768
    v_cvt_pk_bf16_f32 v38, v232, v233
    v_mfma_f32_16x16x32_bf16 v[236:239], a[236:239], a[132:135], v[236:239]
    ds_read_b128 a[236:239], v241 offset:64768
    v_cvt_pk_bf16_f32 v41, v234, v235
    v_mfma_f32_16x16x32_bf16 v[236:239], a[240:243], a[136:139], v[236:239]
    ds_read_b128 a[240:243], v242 offset:0
    v_add_u32 v240, 0xf000, v240
    v_mfma_f32_16x16x32_bf16 v[236:239], a[244:247], a[140:143], v[236:239]
    ds_read_b128 a[244:247], v243 offset:0
    v_add_u32 v241, 0xf000, v241
    v_mfma_f32_16x16x32_bf16 v[228:231], a[0:3], a[216:219], 0
    v_mfma_f32_16x16x32_bf16 v[228:231], a[4:7], a[220:223], v[228:231]
    v_mfma_f32_16x16x32_bf16 v[232:235], a[24:27], a[216:219], 0
    v_mfma_f32_16x16x32_bf16 v[232:235], a[28:31], a[220:223], v[232:235]
    s_waitcnt vmcnt(6) lgkmcnt(5)
    ds_read_b64_tr_b16 a[156:157], v249 offset:9216
    v_mfma_f32_16x16x32_bf16 v[228:231], a[8:11], a[224:227], v[228:231]
    s_waitcnt lgkmcnt(5)
    v_cvt_pk_bf16_f32 v68, v236, v237
    v_cvt_pk_bf16_f32 v71, v238, v239
    v_mfma_f32_16x16x32_bf16 v[228:231], a[12:15], a[228:231], v[228:231]
    s_waitcnt lgkmcnt(4)
    ds_read_b64_tr_b16 a[158:159], v250 offset:9216
    v_mfma_f32_16x16x32_bf16 v[228:231], a[16:19], a[232:235], v[228:231]
    s_waitcnt lgkmcnt(4)
    ds_read_b64_tr_b16 a[180:181], v249 offset:9248
    v_mfma_f32_16x16x32_bf16 v[228:231], a[20:23], a[236:239], v[228:231]
    ds_read_b64_tr_b16 a[182:183], v250 offset:9248
    ds_read_b64_tr_b16 a[204:205], v249 offset:9280
    v_mfma_f32_16x16x32_bf16 v[232:235], a[32:35], a[224:227], v[232:235]
    ds_read_b64_tr_b16 a[206:207], v250 offset:9280
    v_mfma_f32_16x16x32_bf16 v[232:235], a[36:39], a[228:231], v[232:235]
    s_waitcnt lgkmcnt(6)
    v_mfma_f32_16x16x32_bf16 v[232:235], a[40:43], a[232:235], v[232:235]
    v_mfma_f32_16x16x32_bf16 v[232:235], a[44:47], a[236:239], v[232:235]
    v_cvt_pk_bf16_f32 v162, v228, v229
    v_cvt_pk_bf16_f32 v163, v230, v231
    v_mfma_f32_16x16x32_bf16 v[236:239], a[48:51], a[216:219], 0
    v_mfma_f32_16x16x32_bf16 v[236:239], a[52:55], a[220:223], v[236:239]
    s_waitcnt lgkmcnt(5)
    v_mfma_f32_16x16x32_bf16 v[236:239], a[56:59], a[224:227], v[236:239]
    v_mfma_f32_16x16x32_bf16 v[236:239], a[60:63], a[228:231], v[236:239]
    s_waitcnt lgkmcnt(4)
    v_cvt_pk_bf16_f32 v164, v232, v233
    v_cvt_pk_bf16_f32 v165, v234, v235
    v_mfma_f32_16x16x32_bf16 v[236:239], a[64:67], a[232:235], v[236:239]
    s_waitcnt lgkmcnt(3)
    v_mfma_f32_16x16x32_bf16 v[236:239], a[68:71], a[236:239], v[236:239]
    s_waitcnt lgkmcnt(1)
    v_mfma_f32_16x16x32_bf16 v[228:231], a[216:219], a[72:75], 0
    s_waitcnt lgkmcnt(0)
    v_mfma_f32_16x16x32_bf16 v[228:231], a[220:223], a[76:79], v[228:231]
    v_mfma_f32_16x16x32_bf16 v[228:231], a[224:227], a[80:83], v[228:231]
    v_mfma_f32_16x16x32_bf16 v[228:231], a[228:231], a[84:87], v[228:231]
    v_mfma_f32_16x16x32_bf16 v[228:231], a[232:235], a[88:91], v[228:231]
    v_mfma_f32_16x16x32_bf16 v[228:231], a[236:239], a[92:95], v[228:231]
    v_cvt_pk_bf16_f32 v166, v236, v237
    v_cvt_pk_bf16_f32 v167, v238, v239
    v_mfma_f32_16x16x32_bf16 v[232:235], a[216:219], a[96:99], 0
    v_mfma_f32_16x16x32_bf16 v[232:235], a[220:223], a[100:103], v[232:235]
    v_mfma_f32_16x16x32_bf16 v[232:235], a[224:227], a[104:107], v[232:235]
    v_mfma_f32_16x16x32_bf16 v[232:235], a[228:231], a[108:111], v[232:235]
    v_mfma_f32_16x16x32_bf16 v[232:235], a[232:235], a[112:115], v[232:235]
    s_waitcnt vmcnt(3)
    ds_read_b64_tr_b16 a[160:161], v249 offset:0
    v_mfma_f32_16x16x32_bf16 v[232:235], a[236:239], a[116:119], v[232:235]
    ds_read_b64_tr_b16 a[162:163], v250 offset:0
    s_waitcnt vmcnt(0)
    v_mfma_f32_16x16x32_bf16 v[236:239], a[216:219], a[120:123], 0
    ds_read_b128 a[216:219], v242 offset:128
    ds_read_b64_tr_b16 a[164:165], v249 offset:3072
    v_mfma_f32_16x16x32_bf16 v[236:239], a[220:223], a[124:127], v[236:239]
    ds_read_b128 a[220:223], v243 offset:128
    ds_read_b64_tr_b16 a[166:167], v250 offset:3072
    v_mfma_f32_16x16x32_bf16 v[236:239], a[224:227], a[128:131], v[236:239]
    ds_read_b128 a[224:227], v242 offset:256
    v_cvt_pk_bf16_f32 v14, v228, v229
    v_mfma_f32_16x16x32_bf16 v[236:239], a[228:231], a[132:135], v[236:239]
    ds_read_b128 a[228:231], v243 offset:256
    v_cvt_pk_bf16_f32 v17, v230, v231
    v_mfma_f32_16x16x32_bf16 v[236:239], a[232:235], a[136:139], v[236:239]
    ds_read_b64_tr_b16 a[184:185], v249 offset:32
    ds_read_b64_tr_b16 a[186:187], v250 offset:32
    v_mfma_f32_16x16x32_bf16 v[236:239], a[236:239], a[140:143], v[236:239]
    ds_read_b64_tr_b16 a[188:189], v249 offset:3104
    ds_read_b64_tr_b16 a[190:191], v250 offset:3104
    v_mfma_f32_16x16x32_bf16 v[228:231], a[144:147], a[240:243], 0
    v_cvt_pk_bf16_f32 v44, v232, v233
    v_cvt_pk_bf16_f32 v47, v234, v235
    v_mfma_f32_16x16x32_bf16 v[228:231], a[148:151], a[244:247], v[228:231]
    ds_read_b64_tr_b16 a[208:209], v249 offset:64
    s_waitcnt lgkmcnt(10)
    v_mfma_f32_16x16x32_bf16 v[228:231], a[152:155], a[216:219], v[228:231]
    ds_read_b64_tr_b16 a[210:211], v250 offset:64
    v_cvt_pk_bf16_f32 v74, v236, v237
    v_mfma_f32_16x16x32_bf16 v[232:235], a[168:171], a[240:243], 0
    s_waitcnt lgkmcnt(9)
    ds_read_b64_tr_b16 a[212:213], v249 offset:3136
    v_mfma_f32_16x16x32_bf16 v[228:231], a[156:159], a[220:223], v[228:231]
    ds_read_b64_tr_b16 a[214:215], v250 offset:3136
    s_waitcnt lgkmcnt(9)
    v_mfma_f32_16x16x32_bf16 v[228:231], a[160:163], a[224:227], v[228:231]
    ds_read_b128 a[232:235], v242 offset:1536
    s_waitcnt lgkmcnt(9)
    v_mfma_f32_16x16x32_bf16 v[228:231], a[164:167], a[228:231], v[228:231]
    ds_read_b128 a[236:239], v243 offset:1536
    v_cvt_pk_bf16_f32 v77, v238, v239
    v_mfma_f32_16x16x32_bf16 v[232:235], a[172:175], a[244:247], v[232:235]
    s_waitcnt lgkmcnt(9)
    v_add_u32 v249, s66, v249
    v_add_u32 v250, s66, v250
    v_mfma_f32_16x16x32_bf16 v[232:235], a[176:179], a[216:219], v[232:235]
    s_lshl_b32 s66, s28, 1
    v_mul_f32 v228, s38, v228
    v_mul_f32 v229, s38, v229
    v_mfma_f32_16x16x32_bf16 v[232:235], a[180:183], a[220:223], v[232:235]
    s_waitcnt lgkmcnt(8)
    v_mul_f32 v230, s38, v230
    v_mul_f32 v231, s38, v231
    v_mfma_f32_16x16x32_bf16 v[232:235], a[184:187], a[224:227], v[232:235]
    s_waitcnt lgkmcnt(6)
    v_cvt_pk_bf16_f32 v168, v228, v229
    v_cvt_pk_bf16_f32 v169, v230, v231
    v_mfma_f32_16x16x32_bf16 v[232:235], a[188:191], a[228:231], v[232:235]
    s_waitcnt lgkmcnt(5)
    v_mfma_f32_16x16x32_bf16 v[236:239], a[192:195], a[240:243], 0
    ds_read_b128 a[240:243], v242 offset:1664
    v_mfma_f32_16x16x32_bf16 v[236:239], a[196:199], a[244:247], v[236:239]
    ds_read_b128 a[244:247], v243 offset:1664
L_h3:
    s_cbranch_execz L_h7
    v_mfma_f32_16x16x32_bf16 v[236:239], a[200:203], a[216:219], v[236:239]
    s_waitcnt lgkmcnt(3)
    ds_read_b128 a[216:219], v242 offset:1792
    v_mfma_f32_16x16x32_bf16 v[236:239], a[204:207], a[220:223], v[236:239]
    s_barrier
    v_mfma_f32_16x16x32_bf16 v[236:239], a[208:211], a[224:227], v[236:239]
    s_barrier
    v_mfma_f32_16x16x32_bf16 v[236:239], a[212:215], a[228:231], v[236:239]
    s_waitcnt lgkmcnt(3)
    v_mul_f32 v232, s3, v232
    v_mul_f32 v233, s3, v233
    v_mfma_f32_16x16x32_bf16 v[228:231], a[144:147], a[232:235], 0
    v_mul_f32 v234, s3, v234
    v_mul_f32 v235, s3, v235
    v_mfma_f32_16x16x32_bf16 v[228:231], a[148:151], a[236:239], v[228:231]
    s_waitcnt lgkmcnt(2)
    v_cvt_pk_bf16_f32 v170, v232, v233
    v_cvt_pk_bf16_f32 v171, v234, v235
    v_mfma_f32_16x16x32_bf16 v[228:231], a[152:155], a[240:243], v[228:231]
    ds_read_b128 a[220:223], v243 offset:1792
    v_mul_f32 v236, s38, v236
    v_mfma_f32_16x16x32_bf16 v[196:199], v[102:105], v[168:171], v[196:199]
    s_waitcnt lgkmcnt(1)
    v_mul_f32 v237, s38, v237
    v_mul_f32 v238, s38, v238
    v_mfma_f32_16x16x32_bf16 v[200:203], v[114:117], v[168:171], v[200:203]
    v_mul_f32 v239, s38, v239
    v_cvt_pk_bf16_f32 v172, v236, v237
    v_mfma_f32_16x16x32_bf16 v[204:207], v[150:153], v[168:171], v[204:207]
    ds_read_b128 a[224:227], v240 offset:4608
    v_cvt_pk_bf16_f32 v173, v238, v239
    v_mfma_f32_16x16x32_bf16 v[208:211], v[108:111], v[168:171], v[208:211]
    ds_read_b128 a[228:231], v241 offset:4608
    buffer_load_dwordx4 v254, s[4:7], s43 offen lds
    v_mfma_f32_16x16x32_bf16 v[196:199], v[104:107], v[170:173], v[196:199]
    v_accvgpr_read_b32 v254, a254
    v_mfma_f32_16x16x32_bf16 v[200:203], v[116:119], v[170:173], v[200:203]
    v_mfma_f32_16x16x32_bf16 v[204:207], v[152:155], v[170:173], v[204:207]
    v_mfma_f32_16x16x32_bf16 v[208:211], v[110:113], v[170:173], v[208:211]
    buffer_load_dwordx4 v255, s[4:7], s43 offen offset:1024 lds
    v_accvgpr_read_b32 v255, a252
    v_mfma_f32_16x16x32_bf16 v[228:231], a[156:159], a[244:247], v[228:231]
    v_mfma_f32_16x16x32_bf16 v[228:231], a[160:163], a[216:219], v[228:231]
    s_waitcnt lgkmcnt(2)
    v_exp_f32 v196, v196
    v_mfma_f32_16x16x32_bf16 v[228:231], a[164:167], a[220:223], v[228:231]
    v_exp_f32 v197, v197
    v_mfma_f32_16x16x32_bf16 v[232:235], a[168:171], a[232:235], 0
    v_exp_f32 v198, v198
    v_mfma_f32_16x16x32_bf16 v[232:235], a[172:175], a[236:239], v[232:235]
    s_waitcnt lgkmcnt(1)
    v_exp_f32 v199, v199
    v_mfma_f32_16x16x32_bf16 v[232:235], a[176:179], a[240:243], v[232:235]
    s_waitcnt lgkmcnt(0)
    v_cvt_pk_bf16_f32 v180, v196, v197
    v_cvt_pk_bf16_f32 v183, v198, v199
    v_mfma_f32_16x16x32_bf16 v[232:235], a[180:183], a[244:247], v[232:235]
    ds_read_b128 v[196:199], v245 offset:256
    v_mul_f32 v228, s38, v228
    v_mfma_f32_16x16x32_bf16 v[232:235], a[184:187], a[216:219], v[232:235]
    v_mul_f32 v229, s38, v229
    v_mul_f32 v230, s38, v230
    v_mfma_f32_16x16x32_bf16 v[232:235], a[188:191], a[220:223], v[232:235]
    v_mul_f32 v231, s38, v231
    v_cvt_pk_bf16_f32 v174, v228, v229
    v_mfma_f32_16x16x32_bf16 v[236:239], a[192:195], a[232:235], 0
    ds_read_b128 a[232:235], v240 offset:4736
    v_cvt_pk_bf16_f32 v175, v230, v231
    v_mfma_f32_16x16x32_bf16 v[236:239], a[196:199], a[236:239], v[236:239]
    ds_read_b128 a[236:239], v241 offset:4736
    buffer_load_dwordx4 v254, s[4:7], s43 offen offset:2048 lds
    v_mfma_f32_16x16x32_bf16 v[236:239], a[200:203], a[240:243], v[236:239]
    ds_read_b128 a[240:243], v240 offset:4864
    v_mul_f32 v232, s3, v232
    v_mfma_f32_16x16x32_bf16 v[236:239], a[204:207], a[244:247], v[236:239]
    ds_read_b128 a[244:247], v241 offset:4864
    v_mul_f32 v233, s3, v233
    v_mfma_f32_16x16x32_bf16 v[236:239], a[208:211], a[216:219], v[236:239]
    s_add_u32 m0, s46, 0x17400
    v_mul_f32 v234, s3, v234
    v_mul_f32 v235, s3, v235
    v_mfma_f32_16x16x32_bf16 v[236:239], a[212:215], a[220:223], v[236:239]
    s_waitcnt lgkmcnt(4)
    v_cvt_pk_bf16_f32 v176, v232, v233
    v_cvt_pk_bf16_f32 v177, v234, v235
    v_mfma_f32_16x16x32_bf16 v[196:199], v[120:123], v[168:171], v[196:199]
    v_exp_f32 v200, v200
    v_mfma_f32_16x16x32_bf16 v[196:199], v[122:125], v[170:173], v[196:199]
    v_exp_f32 v201, v201
    v_mfma_f32_16x16x32_bf16 v[228:231], a[0:3], a[224:227], 0
    v_exp_f32 v202, v202
    v_mfma_f32_16x16x32_bf16 v[228:231], a[4:7], a[228:231], v[228:231]
    s_waitcnt lgkmcnt(3)
    v_exp_f32 v203, v203
    v_mfma_f32_16x16x32_bf16 v[228:231], a[8:11], a[232:235], v[228:231]
    s_waitcnt lgkmcnt(2)
    v_cvt_pk_bf16_f32 v181, v200, v201
    v_cvt_pk_bf16_f32 v184, v202, v203
    v_mfma_f32_16x16x32_bf16 v[228:231], a[12:15], a[236:239], v[228:231]
    s_waitcnt lgkmcnt(1)
    v_mul_f32 v236, s38, v236
    v_mul_f32 v237, s38, v237
    v_mfma_f32_16x16x32_bf16 v[228:231], a[16:19], a[240:243], v[228:231]
    s_waitcnt lgkmcnt(0)
    v_mul_f32 v238, s38, v238
    v_mul_f32 v239, s38, v239
    v_mfma_f32_16x16x32_bf16 v[228:231], a[20:23], a[244:247], v[228:231]
    ds_read_b128 v[200:203], v246 offset:256
    v_cvt_pk_bf16_f32 v178, v236, v237
    v_mfma_f32_16x16x32_bf16 v[232:235], a[24:27], a[224:227], 0
    ds_read_b128 a[216:219], v242 offset:3072
    v_cvt_pk_bf16_f32 v179, v238, v239
    v_mfma_f32_16x16x32_bf16 v[232:235], a[28:31], a[228:231], v[232:235]
    v_exp_f32 v204, v204
    v_mfma_f32_16x16x32_bf16 v[232:235], a[32:35], a[232:235], v[232:235]
    v_exp_f32 v205, v205
    v_mfma_f32_16x16x32_bf16 v[232:235], a[36:39], a[236:239], v[232:235]
    v_cvt_pk_bf16_f32 v182, v204, v205
    v_cvt_pk_bf16_f32 v102, v228, v229
    v_mfma_f32_16x16x32_bf16 v[232:235], a[40:43], a[240:243], v[232:235]
    v_exp_f32 v206, v206
    v_mfma_f32_16x16x32_bf16 v[212:215], v[0:3], v[180:183], 0
    v_exp_f32 v207, v207
    v_mfma_f32_16x16x32_bf16 v[216:219], v[30:33], v[180:183], 0
    v_cvt_pk_bf16_f32 v185, v206, v207
    v_cvt_pk_bf16_f32 v103, v230, v231
    v_mfma_f32_16x16x32_bf16 v[220:223], v[60:63], v[180:183], 0
    ds_read_b128 v[204:207], v244 offset:320
    v_accvgpr_read_b32 v254, a253
    v_mfma_f32_16x16x32_bf16 v[224:227], a[248:251], v[180:183], 0
    v_exp_f32 v208, v208
    v_mfma_f32_16x16x32_bf16 v[232:235], a[44:47], a[244:247], v[232:235]
    s_waitcnt lgkmcnt(2)
    v_exp_f32 v209, v209
    v_mfma_f32_16x16x32_bf16 v[200:203], v[156:159], v[168:171], v[200:203]
    s_waitcnt lgkmcnt(1)
    v_exp_f32 v210, v210
    v_mfma_f32_16x16x32_bf16 v[200:203], v[158:161], v[170:173], v[200:203]
    v_exp_f32 v211, v211
    v_mfma_f32_16x16x32_bf16 v[236:239], a[48:51], a[224:227], 0
    v_cvt_pk_bf16_f32 v186, v208, v209
    v_cvt_pk_bf16_f32 v189, v210, v211
    v_mfma_f32_16x16x32_bf16 v[236:239], a[52:55], a[228:231], v[236:239]
    ds_read_b128 v[208:211], v245 offset:320
    v_cvt_pk_bf16_f32 v104, v232, v233
    v_mfma_f32_16x16x32_bf16 v[236:239], a[56:59], a[232:235], v[236:239]
    v_exp_f32 v196, v196
    v_mfma_f32_16x16x32_bf16 v[236:239], a[60:63], a[236:239], v[236:239]
    v_exp_f32 v197, v197
    v_mfma_f32_16x16x32_bf16 v[236:239], a[64:67], a[240:243], v[236:239]
    s_waitcnt lgkmcnt(1)
    v_cvt_pk_bf16_f32 v187, v196, v197
    v_cvt_pk_bf16_f32 v105, v234, v235
    v_mfma_f32_16x16x32_bf16 v[204:207], v[90:93], v[168:171], v[204:207]
    v_exp_f32 v198, v198
    v_mfma_f32_16x16x32_bf16 v[212:215], v[4:7], v[184:187], v[212:215]
    v_exp_f32 v199, v199
    v_mfma_f32_16x16x32_bf16 v[216:219], v[34:37], v[184:187], v[216:219]
    ds_read_b128 a[220:223], v243 offset:3072
    v_cvt_pk_bf16_f32 v190, v198, v199
    v_mfma_f32_16x16x32_bf16 v[220:223], v[64:67], v[184:187], v[220:223]
    ds_read_b128 v[196:199], v246 offset:320
    buffer_load_dwordx4 v255, s[4:7], s59 offen lds
    v_mfma_f32_16x16x32_bf16 v[224:227], a[248:251], v[184:187], v[224:227]
    v_exp_f32 v200, v200
    v_mfma_f32_16x16x32_bf16 v[204:207], v[92:95], v[170:173], v[204:207]
    v_exp_f32 v201, v201
    v_mfma_f32_16x16x32_bf16 v[236:239], a[68:71], a[244:247], v[236:239]
    s_waitcnt lgkmcnt(2)
    v_exp_f32 v202, v202
    v_mfma_f32_16x16x32_bf16 v[208:211], v[126:129], v[168:171], v[208:211]
    v_exp_f32 v203, v203
    v_mfma_f32_16x16x32_bf16 v[208:211], v[128:131], v[170:173], v[208:211]
    v_cvt_pk_bf16_f32 v188, v200, v201
    v_cvt_pk_bf16_f32 v191, v202, v203
    v_mfma_f32_16x16x32_bf16 v[228:231], a[224:227], a[72:75], 0
    ds_read_b128 v[200:203], v244 offset:0
    v_cvt_pk_bf16_f32 v106, v236, v237
    v_mfma_f32_16x16x32_bf16 v[212:215], v[8:11], v[188:191], v[212:215]
    v_exp_f32 v204, v204
    v_mfma_f32_16x16x32_bf16 v[216:219], v[38:41], v[188:191], v[216:219]
    v_exp_f32 v205, v205
    v_mfma_f32_16x16x32_bf16 v[220:223], v[68:71], v[188:191], v[220:223]
    s_waitcnt lgkmcnt(2)
    v_cvt_pk_bf16_f32 v192, v204, v205
    v_cvt_pk_bf16_f32 v107, v238, v239
    v_mfma_f32_16x16x32_bf16 v[224:227], a[248:251], v[188:191], v[224:227]
    s_waitcnt lgkmcnt(1)
    ds_read_b128 v[204:207], v245 offset:0
    v_mfma_f32_16x16x32_bf16 v[196:199], v[162:165], v[168:171], v[196:199]
    v_exp_f32 v208, v208
    v_mfma_f32_16x16x32_bf16 v[196:199], v[164:167], v[170:173], v[196:199]
    v_exp_f32 v209, v209
    v_mfma_f32_16x16x32_bf16 v[228:231], a[228:231], a[76:79], v[228:231]
    buffer_load_dwordx4 v254, s[4:7], s59 offen offset:1024 lds
    v_cvt_pk_bf16_f32 v193, v208, v209
    v_mfma_f32_16x16x32_bf16 v[228:231], a[232:235], a[80:83], v[228:231]
    ds_read_b128 v[208:211], v246 offset:0
    s_waitcnt lgkmcnt(2)
    v_mfma_f32_16x16x32_bf16 v[200:203], v[108:111], v[174:177], v[200:203]
    v_exp_f32 v196, v196
    v_mfma_f32_16x16x32_bf16 v[200:203], v[110:113], v[176:179], v[200:203]
    v_exp_f32 v197, v197
    v_mfma_f32_16x16x32_bf16 v[228:231], a[236:239], a[84:87], v[228:231]
    v_cvt_pk_bf16_f32 v194, v196, v197
    v_accvgpr_read_b32 v255, a254
    v_mfma_f32_16x16x32_bf16 v[228:231], a[240:243], a[88:91], v[228:231]
    ds_read_b128 v[196:199], v244 offset:64
    v_accvgpr_read_b32 v254, a252
    v_mfma_f32_16x16x32_bf16 v[212:215], v[12:15], v[192:195], v[212:215]
    s_waitcnt lgkmcnt(2)
    v_exp_f32 v200, v200
    v_mfma_f32_16x16x32_bf16 v[216:219], v[42:45], v[192:195], v[216:219]
    v_exp_f32 v201, v201
    v_mfma_f32_16x16x32_bf16 v[220:223], v[72:75], v[192:195], v[220:223]
    v_exp_f32 v202, v202
    v_mfma_f32_16x16x32_bf16 v[224:227], a[248:251], v[192:195], v[224:227]
    v_exp_f32 v203, v203
    v_mfma_f32_16x16x32_bf16 v[204:207], v[120:123], v[174:177], v[204:207]
    v_cvt_pk_bf16_f32 v180, v200, v201
    v_cvt_pk_bf16_f32 v183, v202, v203
    v_mfma_f32_16x16x32_bf16 v[204:207], v[122:125], v[176:179], v[204:207]
    ds_read_b128 v[200:203], v245 offset:64
    buffer_load_dwordx4 v255, s[4:7], s59 offen offset:2048 lds
    v_mfma_f32_16x16x32_bf16 v[228:231], a[244:247], a[92:95], v[228:231]
    s_add_u32 m0, s46, 0x18000
    v_rcp_f32 v225, v224
    v_mfma_f32_16x16x32_bf16 v[232:235], a[224:227], a[96:99], 0
    s_waitcnt lgkmcnt(2)
    v_mul_f32 v212, v212, v225
    v_mul_f32 v213, v213, v225
    v_mfma_f32_16x16x32_bf16 v[208:211], v[156:159], v[174:177], v[208:211]
    s_add_u32 s59, s44, s45
    v_cvt_pk_bf16_f32 v20, v228, v229
    v_cvt_pk_bf16_f32 v23, v230, v231
    v_mfma_f32_16x16x32_bf16 v[208:211], v[158:161], v[176:179], v[208:211]
    s_waitcnt lgkmcnt(1)
    v_exp_f32 v204, v204
    v_mfma_f32_16x16x32_bf16 v[196:199], v[90:93], v[174:177], v[196:199]
    v_exp_f32 v205, v205
    v_mfma_f32_16x16x32_bf16 v[196:199], v[92:95], v[176:179], v[196:199]
    v_exp_f32 v206, v206
    v_mfma_f32_16x16x32_bf16 v[232:235], a[228:231], a[100:103], v[232:235]
    v_exp_f32 v207, v207
    v_mfma_f32_16x16x32_bf16 v[232:235], a[232:235], a[104:107], v[232:235]
    v_cvt_pk_bf16_f32 v181, v204, v205
    v_cvt_pk_bf16_f32 v184, v206, v207
    v_mfma_f32_16x16x32_bf16 v[232:235], a[236:239], a[108:111], v[232:235]
    ds_read_b128 v[204:207], v246 offset:64
    v_mul_f32 v214, v214, v225
    v_mfma_f32_16x16x32_bf16 v[232:235], a[240:243], a[112:115], v[232:235]
    s_waitcnt lgkmcnt(1)
    v_exp_f32 v208, v208
    v_mfma_f32_16x16x32_bf16 v[200:203], v[126:129], v[174:177], v[200:203]
    v_exp_f32 v209, v209
    v_mfma_f32_16x16x32_bf16 v[200:203], v[128:131], v[176:179], v[200:203]
    v_exp_f32 v210, v210
    v_mfma_f32_16x16x32_bf16 v[232:235], a[244:247], a[116:119], v[232:235]
    v_exp_f32 v211, v211
    v_mfma_f32_16x16x32_bf16 v[236:239], a[224:227], a[120:123], 0
    ds_read_b128 a[224:227], v242 offset:3200
    v_cvt_pk_bf16_f32 v182, v208, v209
    v_mfma_f32_16x16x32_bf16 v[236:239], a[228:231], a[124:127], v[236:239]
    ds_read_b128 a[228:231], v243 offset:3200
    v_mul_f32 v215, v215, v225
    v_mfma_f32_16x16x32_bf16 v[236:239], a[232:235], a[128:131], v[236:239]
    ds_read_b128 a[232:235], v242 offset:3328
    v_cvt_pk_bf16_f32 v50, v232, v233
    v_mfma_f32_16x16x32_bf16 v[236:239], a[236:239], a[132:135], v[236:239]
    ds_read_b128 a[236:239], v243 offset:3328
    v_cvt_pk_bf16_f32 v53, v234, v235
    v_mfma_f32_16x16x32_bf16 v[236:239], a[240:243], a[136:139], v[236:239]
    ds_read_b128 a[240:243], v240 offset:6144
    v_cvt_pk_bf16_f32 v212, v212, v213
    v_mfma_f32_16x16x32_bf16 v[236:239], a[244:247], a[140:143], v[236:239]
    ds_read_b128 a[244:247], v241 offset:6144
    v_cvt_pk_bf16_f32 v185, v210, v211
    v_mfma_f32_16x16x32_bf16 v[228:231], a[144:147], a[216:219], 0
    ds_read_b128 v[208:211], v244 offset:128
    v_cvt_pk_bf16_f32 v213, v214, v215
    v_mfma_f32_16x16x32_bf16 v[228:231], a[148:151], a[220:223], v[228:231]
    ds_write_b64 v251, v[212:213] offset:0
    v_mfma_f32_16x16x32_bf16 v[212:215], v[6:9], v[180:183], 0
    s_waitcnt lgkmcnt(7)
    v_cvt_pk_bf16_f32 v80, v236, v237
    v_cvt_pk_bf16_f32 v83, v238, v239
    v_mfma_f32_16x16x32_bf16 v[204:207], v[162:165], v[174:177], v[204:207]
    v_mul_f32 v216, v216, v225
    v_mul_f32 v217, v217, v225
    v_mfma_f32_16x16x32_bf16 v[204:207], v[164:167], v[176:179], v[204:207]
    v_mul_f32 v218, v218, v225
    v_mul_f32 v219, v219, v225
    v_mfma_f32_16x16x32_bf16 v[228:231], a[152:155], a[224:227], v[228:231]
    s_waitcnt lgkmcnt(6)
    v_cvt_pk_bf16_f32 v216, v216, v217
    v_cvt_pk_bf16_f32 v217, v218, v219
    v_mfma_f32_16x16x32_bf16 v[228:231], a[156:159], a[228:231], v[228:231]
    s_waitcnt lgkmcnt(5)
    v_mul_f32 v220, v220, v225
    v_mul_f32 v221, v221, v225
    v_mfma_f32_16x16x32_bf16 v[228:231], a[160:163], a[232:235], v[228:231]
    s_waitcnt lgkmcnt(4)
    v_mul_f32 v222, v222, v225
    v_mul_f32 v223, v223, v225
    v_mfma_f32_16x16x32_bf16 v[228:231], a[164:167], a[236:239], v[228:231]
    ds_write_b64 v251, v[216:217] offset:128
    v_mfma_f32_16x16x32_bf16 v[216:219], v[36:39], v[180:183], 0
    s_waitcnt lgkmcnt(2)
    v_cvt_pk_bf16_f32 v220, v220, v221
    v_cvt_pk_bf16_f32 v221, v222, v223
    v_mfma_f32_16x16x32_bf16 v[208:211], v[96:99], v[174:177], v[208:211]
    ds_write_b64 v251, v[220:221] offset:256
    v_mfma_f32_16x16x32_bf16 v[220:223], v[66:69], v[180:183], 0
    v_mul_f32 v228, s38, v228
    v_mul_f32 v229, s38, v229
    v_mfma_f32_16x16x32_bf16 v[208:211], v[98:101], v[176:179], v[208:211]
    v_mul_f32 v230, s38, v230
    v_mul_f32 v231, s38, v231
    v_mfma_f32_16x16x32_bf16 v[232:235], a[168:171], a[216:219], 0
    v_cvt_pk_bf16_f32 v168, v228, v229
    v_cvt_pk_bf16_f32 v169, v230, v231
    v_mfma_f32_16x16x32_bf16 v[232:235], a[172:175], a[220:223], v[232:235]
    buffer_load_dwordx4 v254, s[4:7], s58 offen lds
    v_max3_f32 v248, v248, v224, v225
    v_mfma_f32_16x16x32_bf16 v[224:227], a[248:251], v[180:183], 0
    v_exp_f32 v196, v196
    v_mfma_f32_16x16x32_bf16 v[232:235], a[176:179], a[224:227], v[232:235]
    v_exp_f32 v197, v197
    v_mfma_f32_16x16x32_bf16 v[232:235], a[180:183], a[228:231], v[232:235]
    v_exp_f32 v198, v198
    v_mfma_f32_16x16x32_bf16 v[232:235], a[184:187], a[232:235], v[232:235]
    v_exp_f32 v199, v199
    v_mfma_f32_16x16x32_bf16 v[232:235], a[188:191], a[236:239], v[232:235]
    v_cvt_pk_bf16_f32 v186, v196, v197
    v_cvt_pk_bf16_f32 v189, v198, v199
    v_mfma_f32_16x16x32_bf16 v[236:239], a[192:195], a[216:219], 0
    ds_read_b128 a[216:219], v240 offset:6272
    v_xor_b32 v254, 16, v242
    v_mfma_f32_16x16x32_bf16 v[236:239], a[196:199], a[220:223], v[236:239]
    ds_read_b128 a[220:223], v241 offset:6272
    v_add_u32 v254, 0x7500, v254
    v_mfma_f32_16x16x32_bf16 v[236:239], a[200:203], a[224:227], v[236:239]
    ds_read_b128 a[224:227], v240 offset:6400
    v_mul_f32 v232, s3, v232
    v_mfma_f32_16x16x32_bf16 v[236:239], a[204:207], a[228:231], v[236:239]
    ds_read_b128 a[228:231], v241 offset:6400
    v_mul_f32 v233, s3, v233
    v_mfma_f32_16x16x32_bf16 v[236:239], a[208:211], a[232:235], v[236:239]
    v_mul_f32 v234, s3, v234
    v_mul_f32 v235, s3, v235
    v_mfma_f32_16x16x32_bf16 v[236:239], a[212:215], a[236:239], v[236:239]
    v_cvt_pk_bf16_f32 v170, v232, v233
    v_cvt_pk_bf16_f32 v171, v234, v235
    v_mfma_f32_16x16x32_bf16 v[228:231], a[0:3], a[240:243], 0
    ds_read_b128 v[196:199], v245 offset:128
    v_cndmask_b32 v254, v242, v254, vcc
    v_mfma_f32_16x16x32_bf16 v[228:231], a[4:7], a[244:247], v[228:231]
    s_mov_b32 vcc_lo, 0x33333333
    v_exp_f32 v200, v200
    v_mfma_f32_16x16x32_bf16 v[232:235], a[24:27], a[240:243], 0
    s_mov_b32 vcc_hi, 0x33333333
    s_waitcnt lgkmcnt(4)
    v_mul_f32 v236, s38, v236
    v_mfma_f32_16x16x32_bf16 v[228:231], a[8:11], a[216:219], v[228:231]
    v_mul_f32 v237, s38, v237
    s_waitcnt lgkmcnt(3)
    v_mfma_f32_16x16x32_bf16 v[228:231], a[12:15], a[220:223], v[228:231]
    v_mul_f32 v238, s38, v238
    s_waitcnt lgkmcnt(2)
    v_mfma_f32_16x16x32_bf16 v[228:231], a[16:19], a[224:227], v[228:231]
    v_mul_f32 v239, s38, v239
    s_waitcnt lgkmcnt(1)
    v_mfma_f32_16x16x32_bf16 v[228:231], a[20:23], a[228:231], v[228:231]
    v_cvt_pk_bf16_f32 v172, v236, v237
    v_cvt_pk_bf16_f32 v173, v238, v239
    v_mfma_f32_16x16x32_bf16 v[232:235], a[28:31], a[244:247], v[232:235]
    v_exp_f32 v201, v201
    v_mfma_f32_16x16x32_bf16 v[232:235], a[32:35], a[216:219], v[232:235]
    ds_read_b128 a[232:235], v254 offset:4608
    v_cvt_pk_bf16_f32 v187, v200, v201
    v_mfma_f32_16x16x32_bf16 v[232:235], a[36:39], a[220:223], v[232:235]
    v_exp_f32 v202, v202
    v_mfma_f32_16x16x32_bf16 v[212:215], v[10:13], v[184:187], v[212:215]
    s_waitcnt lgkmcnt(1)
    v_exp_f32 v203, v203
    v_mfma_f32_16x16x32_bf16 v[216:219], v[40:43], v[184:187], v[216:219]
    v_cvt_pk_bf16_f32 v190, v202, v203
    v_cvt_pk_bf16_f32 v108, v228, v229
    v_mfma_f32_16x16x32_bf16 v[220:223], v[70:73], v[184:187], v[220:223]
    ds_read_b128 v[200:203], v246 offset:128
    v_cvt_pk_bf16_f32 v109, v230, v231
    v_mfma_f32_16x16x32_bf16 v[224:227], a[248:251], v[184:187], v[224:227]
    v_exp_f32 v204, v204
    v_mfma_f32_16x16x32_bf16 v[196:199], v[132:135], v[174:177], v[196:199]
    v_exp_f32 v205, v205
    v_mfma_f32_16x16x32_bf16 v[196:199], v[134:137], v[176:179], v[196:199]
    v_exp_f32 v206, v206
    v_mfma_f32_16x16x32_bf16 v[232:235], a[40:43], a[224:227], v[232:235]
    v_exp_f32 v207, v207
    v_mfma_f32_16x16x32_bf16 v[232:235], a[44:47], a[228:231], v[232:235]
    v_cvt_pk_bf16_f32 v188, v204, v205
    v_cvt_pk_bf16_f32 v191, v206, v207
    v_mfma_f32_16x16x32_bf16 v[236:239], a[48:51], a[240:243], 0
    ds_read_b128 v[204:207], v244 offset:0
    v_accvgpr_read_b32 v255, a255
    v_mfma_f32_16x16x32_bf16 v[212:215], v[14:17], v[188:191], v[212:215]
    s_waitcnt lgkmcnt(2)
    v_exp_f32 v208, v208
    v_mfma_f32_16x16x32_bf16 v[216:219], v[44:47], v[188:191], v[216:219]
    v_exp_f32 v209, v209
    v_mfma_f32_16x16x32_bf16 v[220:223], v[74:77], v[188:191], v[220:223]
    v_cvt_pk_bf16_f32 v192, v208, v209
    v_cvt_pk_bf16_f32 v110, v232, v233
    v_mfma_f32_16x16x32_bf16 v[224:227], a[248:251], v[188:191], v[224:227]
    ds_read_b128 v[208:211], v245 offset:0
    v_cvt_pk_bf16_f32 v111, v234, v235
    v_mfma_f32_16x16x32_bf16 v[236:239], a[52:55], a[244:247], v[236:239]
    s_waitcnt lgkmcnt(2)
    v_exp_f32 v196, v196
    v_mfma_f32_16x16x32_bf16 v[200:203], v[102:105], v[174:177], v[200:203]
    v_exp_f32 v197, v197
    v_mfma_f32_16x16x32_bf16 v[200:203], v[104:107], v[176:179], v[200:203]
    buffer_load_dwordx4 v255, s[4:7], s58 offen offset:512 lds
    v_cvt_pk_bf16_f32 v193, v196, v197
    v_mfma_f32_16x16x32_bf16 v[236:239], a[56:59], a[216:219], v[236:239]
    ds_read_b128 v[196:199], v246 offset:0
    v_xor_b32 v255, 64, v254
    v_mfma_f32_16x16x32_bf16 v[236:239], a[60:63], a[220:223], v[236:239]
    s_waitcnt lgkmcnt(2)
    ds_read_b128 a[236:239], v255 offset:4608
    v_mfma_f32_16x16x32_bf16 v[204:207], v[90:93], v[168:171], v[204:207]
    s_add_u32 m0, s46, 0
    v_exp_f32 v200, v200
    v_mfma_f32_16x16x32_bf16 v[204:207], v[92:95], v[170:173], v[204:207]
    s_lshl1_add_u32 s58, s45, s44
    v_exp_f32 v201, v201
    v_mfma_f32_16x16x32_bf16 v[236:239], a[64:67], a[224:227], v[236:239]
    v_cvt_pk_bf16_f32 v194, v200, v201
    v_mfma_f32_16x16x32_bf16 v[236:239], a[68:71], a[228:231], v[236:239]
    ds_read_b128 v[200:203], v244 offset:64
    v_mfma_f32_16x16x32_bf16 v[212:215], v[18:21], v[192:195], v[212:215]
    s_waitcnt lgkmcnt(3)
    v_exp_f32 v204, v204
    v_mfma_f32_16x16x32_bf16 v[216:219], v[48:51], v[192:195], v[216:219]
    v_exp_f32 v205, v205
    v_mfma_f32_16x16x32_bf16 v[220:223], v[78:81], v[192:195], v[220:223]
    v_exp_f32 v206, v206
    v_mfma_f32_16x16x32_bf16 v[224:227], a[248:251], v[192:195], v[224:227]
    v_exp_f32 v207, v207
    v_mfma_f32_16x16x32_bf16 v[208:211], v[126:129], v[168:171], v[208:211]
    s_waitcnt lgkmcnt(2)
    v_cvt_pk_bf16_f32 v180, v204, v205
    v_cvt_pk_bf16_f32 v183, v206, v207
    v_mfma_f32_16x16x32_bf16 v[208:211], v[128:131], v[170:173], v[208:211]
    ds_read_b128 v[204:207], v245 offset:64
    v_cvt_pk_bf16_f32 v112, v236, v237
    v_mfma_f32_16x16x32_bf16 v[196:199], v[162:165], v[168:171], v[196:199]
    s_waitcnt lgkmcnt(2)
    v_rcp_f32 v225, v224
    v_mfma_f32_16x16x32_bf16 v[196:199], v[164:167], v[170:173], v[196:199]
    v_cvt_pk_bf16_f32 v113, v238, v239
    v_mul_f32 v212, v212, v225
    v_mfma_f32_16x16x32_bf16 v[228:231], a[240:243], a[72:75], 0
    v_exp_f32 v208, v208
    v_mfma_f32_16x16x32_bf16 v[228:231], a[244:247], a[76:79], v[228:231]
    s_waitcnt lgkmcnt(1)
    v_exp_f32 v209, v209
    v_mfma_f32_16x16x32_bf16 v[200:203], v[96:99], v[168:171], v[200:203]
    v_exp_f32 v210, v210
    v_mfma_f32_16x16x32_bf16 v[200:203], v[98:101], v[170:173], v[200:203]
    v_exp_f32 v211, v211
    v_mfma_f32_16x16x32_bf16 v[228:231], a[216:219], a[80:83], v[228:231]
    v_cvt_pk_bf16_f32 v181, v208, v209
    v_cvt_pk_bf16_f32 v184, v210, v211
    v_mfma_f32_16x16x32_bf16 v[228:231], a[220:223], a[84:87], v[228:231]
    ds_read_b128 v[208:211], v246 offset:64
    v_mul_f32 v213, v213, v225
    v_mfma_f32_16x16x32_bf16 v[228:231], a[224:227], a[88:91], v[228:231]
    v_exp_f32 v196, v196
    v_mfma_f32_16x16x32_bf16 v[228:231], a[228:231], a[92:95], v[228:231]
    s_waitcnt lgkmcnt(1)
    v_exp_f32 v197, v197
    v_mfma_f32_16x16x32_bf16 v[204:207], v[132:135], v[168:171], v[204:207]
    v_cvt_pk_bf16_f32 v182, v196, v197
    v_mul_f32 v214, v214, v225
    v_mfma_f32_16x16x32_bf16 v[204:207], v[134:137], v[170:173], v[204:207]
    v_mul_f32 v215, v215, v225
    v_cvt_pk_bf16_f32 v212, v212, v213
    v_mfma_f32_16x16x32_bf16 v[232:235], a[240:243], a[96:99], 0
    v_cvt_pk_bf16_f32 v26, v228, v229
    v_cvt_pk_bf16_f32 v29, v230, v231
    v_mfma_f32_16x16x32_bf16 v[232:235], a[244:247], a[100:103], v[232:235]
    v_cvt_pk_bf16_f32 v213, v214, v215
    v_mul_f32 v216, v216, v225
    v_mfma_f32_16x16x32_bf16 v[232:235], a[216:219], a[104:107], v[232:235]
    ds_write_b64 v251, v[212:213] offset:6144
    v_mfma_f32_16x16x32_bf16 v[212:215], v[12:15], v[180:183], 0
    v_exp_f32 v198, v198
    v_mfma_f32_16x16x32_bf16 v[232:235], a[220:223], a[108:111], v[232:235]
    v_exp_f32 v199, v199
    v_mfma_f32_16x16x32_bf16 v[232:235], a[224:227], a[112:115], v[232:235]
    s_waitcnt lgkmcnt(1)
    v_mul_f32 v217, v217, v225
    v_mul_f32 v218, v218, v225
    v_mfma_f32_16x16x32_bf16 v[208:211], v[102:105], v[168:171], v[208:211]
    v_mul_f32 v219, v219, v225
    v_cvt_pk_bf16_f32 v216, v216, v217
    v_mfma_f32_16x16x32_bf16 v[208:211], v[104:107], v[170:173], v[208:211]
    v_cvt_pk_bf16_f32 v185, v198, v199
    v_cvt_pk_bf16_f32 v217, v218, v219
    v_mfma_f32_16x16x32_bf16 v[232:235], a[228:231], a[116:119], v[232:235]
    ds_read_b128 v[196:199], v244 offset:128
    v_mul_f32 v220, v220, v225
    v_mfma_f32_16x16x32_bf16 v[236:239], a[240:243], a[120:123], 0
    ds_read_b128 a[240:243], v254 offset:4736
    v_mul_f32 v221, v221, v225
    v_mfma_f32_16x16x32_bf16 v[236:239], a[244:247], a[124:127], v[236:239]
    ds_read_b128 a[244:247], v255 offset:4736
    v_mul_f32 v222, v222, v225
    v_mfma_f32_16x16x32_bf16 v[236:239], a[216:219], a[128:131], v[236:239]
    ds_read_b128 a[216:219], v254 offset:4864
    v_cvt_pk_bf16_f32 v56, v232, v233
    v_mfma_f32_16x16x32_bf16 v[236:239], a[220:223], a[132:135], v[236:239]
    ds_read_b128 a[220:223], v255 offset:4864
    v_cvt_pk_bf16_f32 v59, v234, v235
    v_mfma_f32_16x16x32_bf16 v[236:239], a[224:227], a[136:139], v[236:239]
    ds_read_b128 a[224:227], v242 offset:30720
    v_mul_f32 v223, v223, v225
    v_mfma_f32_16x16x32_bf16 v[236:239], a[228:231], a[140:143], v[236:239]
    ds_read_b128 a[228:231], v243 offset:30720
    v_cvt_pk_bf16_f32 v220, v220, v221
    v_mfma_f32_16x16x32_bf16 v[228:231], a[144:147], a[232:235], 0
    ds_write_b64 v251, v[216:217] offset:6272
    v_mfma_f32_16x16x32_bf16 v[216:219], v[42:45], v[180:183], 0
    v_cvt_pk_bf16_f32 v221, v222, v223
    v_max3_f32 v248, v248, v224, v225
    v_mfma_f32_16x16x32_bf16 v[224:227], a[248:251], v[180:183], 0
    v_cvt_pk_bf16_f32 v86, v236, v237
    v_cvt_pk_bf16_f32 v89, v238, v239
    v_mfma_f32_16x16x32_bf16 v[228:231], a[148:151], a[236:239], v[228:231]
    s_waitcnt lgkmcnt(6)
    v_exp_f32 v200, v200
    v_mfma_f32_16x16x32_bf16 v[196:199], v[138:141], v[168:171], v[196:199]
    ds_write_b64 v251, v[220:221] offset:6400
    v_mfma_f32_16x16x32_bf16 v[220:223], v[72:75], v[180:183], 0
    s_waitcnt lgkmcnt(5)
    v_exp_f32 v201, v201
    v_mfma_f32_16x16x32_bf16 v[196:199], v[140:143], v[170:173], v[196:199]
    s_waitcnt lgkmcnt(4)
    v_exp_f32 v202, v202
    v_mfma_f32_16x16x32_bf16 v[228:231], a[152:155], a[240:243], v[228:231]
    s_waitcnt vmcnt(5)
    v_exp_f32 v203, v203
    v_mfma_f32_16x16x32_bf16 v[228:231], a[156:159], a[244:247], v[228:231]
    s_barrier
    v_mfma_f32_16x16x32_bf16 v[228:231], a[160:163], a[216:219], v[228:231]
    s_waitcnt lgkmcnt(1)
    v_cvt_pk_bf16_f32 v186, v200, v201
    v_cvt_pk_bf16_f32 v189, v202, v203
    v_mfma_f32_16x16x32_bf16 v[228:231], a[164:167], a[220:223], v[228:231]
    ds_read_b128 v[200:203], v245 offset:128
    v_accvgpr_read_b32 v254, a252
    v_mfma_f32_16x16x32_bf16 v[232:235], a[168:171], a[232:235], 0
    v_exp_f32 v204, v204
    v_mfma_f32_16x16x32_bf16 v[232:235], a[172:175], a[236:239], v[232:235]
    v_exp_f32 v205, v205
    v_mfma_f32_16x16x32_bf16 v[232:235], a[176:179], a[240:243], v[232:235]
    v_exp_f32 v206, v206
    v_mfma_f32_16x16x32_bf16 v[232:235], a[180:183], a[244:247], v[232:235]
    v_mul_f32 v228, s38, v228
    v_mul_f32 v229, s38, v229
    v_mfma_f32_16x16x32_bf16 v[232:235], a[184:187], a[216:219], v[232:235]
    v_mul_f32 v230, s38, v230
    v_mul_f32 v231, s38, v231
    v_mfma_f32_16x16x32_bf16 v[232:235], a[188:191], a[220:223], v[232:235]
    v_cvt_pk_bf16_f32 v174, v228, v229
    v_cvt_pk_bf16_f32 v175, v230, v231
    v_mfma_f32_16x16x32_bf16 v[236:239], a[192:195], a[232:235], 0
    ds_read_b128 a[232:235], v242 offset:30848
    v_cvt_pk_bf16_f32 v187, v204, v205
    v_mfma_f32_16x16x32_bf16 v[236:239], a[196:199], a[236:239], v[236:239]
    ds_read_b128 a[236:239], v243 offset:30848
    v_accvgpr_read_b32 v255, a253
    v_mfma_f32_16x16x32_bf16 v[212:215], v[16:19], v[184:187], v[212:215]
    v_mul_f32 v232, s3, v232
    v_mul_f32 v233, s3, v233
    v_mfma_f32_16x16x32_bf16 v[216:219], v[46:49], v[184:187], v[216:219]
    s_waitcnt lgkmcnt(2)
    v_mul_f32 v234, s3, v234
    v_mul_f32 v235, s3, v235
    v_mfma_f32_16x16x32_bf16 v[220:223], v[76:79], v[184:187], v[220:223]
    v_cvt_pk_bf16_f32 v176, v232, v233
    v_cvt_pk_bf16_f32 v177, v234, v235
    v_mfma_f32_16x16x32_bf16 v[224:227], a[248:251], v[184:187], v[224:227]
    v_exp_f32 v207, v207
    v_mfma_f32_16x16x32_bf16 v[200:203], v[144:147], v[168:171], v[200:203]
    buffer_load_dwordx4 v254, s[4:7], s44 offen lds
    v_cvt_pk_bf16_f32 v190, v206, v207
    v_mfma_f32_16x16x32_bf16 v[200:203], v[146:149], v[170:173], v[200:203]
    ds_read_b128 v[204:207], v246 offset:128
    v_accvgpr_read_b32 v254, a254
    v_mfma_f32_16x16x32_bf16 v[236:239], a[200:203], a[240:243], v[236:239]
    ds_read_b128 a[240:243], v242 offset:30976
    v_mfma_f32_16x16x32_bf16 v[236:239], a[204:207], a[244:247], v[236:239]
    ds_read_b128 a[244:247], v243 offset:30976
    v_mfma_f32_16x16x32_bf16 v[236:239], a[208:211], a[216:219], v[236:239]
    ds_read_b128 a[216:219], v240 offset:32256
    buffer_load_dwordx4 v255, s[4:7], s44 offen offset:1024 lds
    v_mfma_f32_16x16x32_bf16 v[236:239], a[212:215], a[220:223], v[236:239]
    ds_read_b128 a[220:223], v241 offset:32256
    v_accvgpr_read_b32 v255, a252
    v_mfma_f32_16x16x32_bf16 v[228:231], a[144:147], a[224:227], 0
    s_waitcnt lgkmcnt(5)
    v_exp_f32 v208, v208
    v_mfma_f32_16x16x32_bf16 v[228:231], a[148:151], a[228:231], v[228:231]
L_h4:
    s_cbranch_execz L_h8
    v_exp_f32 v209, v209
    v_mfma_f32_16x16x32_bf16 v[228:231], a[152:155], a[232:235], v[228:231]
    v_mul_f32 v236, s38, v236
    v_mul_f32 v237, s38, v237
    v_mfma_f32_16x16x32_bf16 v[228:231], a[156:159], a[236:239], v[228:231]
    v_mul_f32 v238, s38, v238
    v_mul_f32 v239, s38, v239
    v_mfma_f32_16x16x32_bf16 v[232:235], a[168:171], a[224:227], 0
    s_waitcnt lgkmcnt(3)
    v_cvt_pk_bf16_f32 v178, v236, v237
    v_cvt_pk_bf16_f32 v179, v238, v239
    v_mfma_f32_16x16x32_bf16 v[204:207], v[108:111], v[168:171], v[204:207]
    v_exp_f32 v210, v210
    v_mfma_f32_16x16x32_bf16 v[204:207], v[110:113], v[170:173], v[204:207]
    v_exp_f32 v211, v211
    v_mfma_f32_16x16x32_bf16 v[228:231], a[160:163], a[240:243], v[228:231]
    s_waitcnt lgkmcnt(2)
    v_cvt_pk_bf16_f32 v188, v208, v209
    v_cvt_pk_bf16_f32 v191, v210, v211
    v_mfma_f32_16x16x32_bf16 v[228:231], a[164:167], a[244:247], v[228:231]
    ds_read_b128 v[208:211], v244 offset:0
    buffer_load_dwordx4 v254, s[4:7], s44 offen offset:2048 lds
    v_mfma_f32_16x16x32_bf16 v[212:215], v[20:23], v[188:191], v[212:215]
    s_add_u32 m0, s46, 0xc00
    v_exp_f32 v196, v196
    v_mfma_f32_16x16x32_bf16 v[216:219], v[50:53], v[188:191], v[216:219]
    s_waitcnt lgkmcnt(1)
    v_exp_f32 v197, v197
    v_mfma_f32_16x16x32_bf16 v[220:223], v[80:83], v[188:191], v[220:223]
    v_cvt_pk_bf16_f32 v192, v196, v197
    v_mul_f32 v228, s38, v228
    v_mfma_f32_16x16x32_bf16 v[224:227], a[248:251], v[188:191], v[224:227]
    ds_read_b128 v[196:199], v245 offset:0
    v_mul_f32 v229, s38, v229
    v_mfma_f32_16x16x32_bf16 v[232:235], a[172:175], a[228:231], v[232:235]
    v_mul_f32 v230, s38, v230
    v_mul_f32 v231, s38, v231
    v_mfma_f32_16x16x32_bf16 v[232:235], a[176:179], a[232:235], v[232:235]
    v_cvt_pk_bf16_f32 v168, v228, v229
    v_cvt_pk_bf16_f32 v169, v230, v231
    v_mfma_f32_16x16x32_bf16 v[232:235], a[180:183], a[236:239], v[232:235]
    v_exp_f32 v200, v200
    v_mfma_f32_16x16x32_bf16 v[232:235], a[184:187], a[240:243], v[232:235]
    v_exp_f32 v201, v201
    v_mfma_f32_16x16x32_bf16 v[232:235], a[188:191], a[244:247], v[232:235]
    buffer_load_dwordx4 v255, s[4:7], s59 offen lds
    v_cvt_pk_bf16_f32 v193, v200, v201
    v_mfma_f32_16x16x32_bf16 v[236:239], a[192:195], a[224:227], 0
    ds_read_b128 a[224:227], v240 offset:32384
    v_accvgpr_read_b32 v254, a253
    v_mfma_f32_16x16x32_bf16 v[236:239], a[196:199], a[228:231], v[236:239]
    ds_read_b128 a[228:231], v241 offset:32384
    v_accvgpr_read_b32 v255, a254
    v_mfma_f32_16x16x32_bf16 v[236:239], a[200:203], a[232:235], v[236:239]
    ds_read_b128 v[200:203], v246 offset:0
    v_mul_f32 v232, s3, v232
    v_mfma_f32_16x16x32_bf16 v[236:239], a[204:207], a[236:239], v[236:239]
    s_waitcnt lgkmcnt(4)
    v_exp_f32 v204, v204
    v_mfma_f32_16x16x32_bf16 v[208:211], v[96:99], v[174:177], v[208:211]
    ds_read_b128 a[232:235], v240 offset:32512
    v_mul_f32 v233, s3, v233
    v_mfma_f32_16x16x32_bf16 v[208:211], v[98:101], v[176:179], v[208:211]
    ds_read_b128 a[236:239], v241 offset:32512
    v_mul_f32 v234, s3, v234
    v_mfma_f32_16x16x32_bf16 v[236:239], a[208:211], a[240:243], v[236:239]
    s_waitcnt lgkmcnt(5)
    v_exp_f32 v205, v205
    v_mfma_f32_16x16x32_bf16 v[196:199], v[132:135], v[174:177], v[196:199]
    v_cvt_pk_bf16_f32 v194, v204, v205
    v_mul_f32 v235, s3, v235
    v_mfma_f32_16x16x32_bf16 v[196:199], v[134:137], v[176:179], v[196:199]
    ds_read_b128 v[204:207], v244 offset:64
    v_cvt_pk_bf16_f32 v170, v232, v233
    v_mfma_f32_16x16x32_bf16 v[212:215], v[24:27], v[192:195], v[212:215]
    v_exp_f32 v208, v208
    v_mfma_f32_16x16x32_bf16 v[216:219], v[54:57], v[192:195], v[216:219]
    s_waitcnt lgkmcnt(5)
    v_exp_f32 v209, v209
    v_mfma_f32_16x16x32_bf16 v[220:223], v[84:87], v[192:195], v[220:223]
    s_waitcnt lgkmcnt(4)
    v_exp_f32 v210, v210
    v_mfma_f32_16x16x32_bf16 v[224:227], a[248:251], v[192:195], v[224:227]
    s_waitcnt lgkmcnt(3)
    v_exp_f32 v211, v211
    v_mfma_f32_16x16x32_bf16 v[200:203], v[102:105], v[174:177], v[200:203]
    v_cvt_pk_bf16_f32 v180, v208, v209
    v_cvt_pk_bf16_f32 v183, v210, v211
    v_mfma_f32_16x16x32_bf16 v[200:203], v[104:107], v[176:179], v[200:203]
    ds_read_b128 v[208:211], v245 offset:64
    v_cvt_pk_bf16_f32 v171, v234, v235
    v_mfma_f32_16x16x32_bf16 v[236:239], a[212:215], a[244:247], v[236:239]
    s_waitcnt lgkmcnt(2)
    v_exp_f32 v196, v196
    v_mfma_f32_16x16x32_bf16 v[228:231], a[0:3], a[216:219], 0
    v_exp_f32 v197, v197
    v_mfma_f32_16x16x32_bf16 v[228:231], a[4:7], a[220:223], v[228:231]
    v_exp_f32 v198, v198
    v_mfma_f32_16x16x32_bf16 v[228:231], a[8:11], a[224:227], v[228:231]
    s_waitcnt lgkmcnt(1)
    v_mul_f32 v236, s38, v236
    v_mul_f32 v237, s38, v237
    v_mfma_f32_16x16x32_bf16 v[204:207], v[138:141], v[174:177], v[204:207]
    v_mul_f32 v238, s38, v238
    v_mul_f32 v239, s38, v239
    v_mfma_f32_16x16x32_bf16 v[204:207], v[140:143], v[176:179], v[204:207]
    v_cvt_pk_bf16_f32 v172, v236, v237
    v_cvt_pk_bf16_f32 v173, v238, v239
    v_mfma_f32_16x16x32_bf16 v[228:231], a[12:15], a[228:231], v[228:231]
    v_exp_f32 v199, v199
    v_mfma_f32_16x16x32_bf16 v[228:231], a[16:19], a[232:235], v[228:231]
    v_cvt_pk_bf16_f32 v181, v196, v197
    v_cvt_pk_bf16_f32 v184, v198, v199
    v_mfma_f32_16x16x32_bf16 v[228:231], a[20:23], a[236:239], v[228:231]
    ds_read_b128 v[196:199], v246 offset:64
    v_add_u32 v246, 0x700, v245
    v_mfma_f32_16x16x32_bf16 v[232:235], a[24:27], a[216:219], 0
    s_waitcnt lgkmcnt(1)
    v_rcp_f32 v225, v224
    v_mfma_f32_16x16x32_bf16 v[208:211], v[144:147], v[174:177], v[208:211]
    v_exp_f32 v200, v200
    v_mfma_f32_16x16x32_bf16 v[208:211], v[146:149], v[176:179], v[208:211]
    v_cvt_pk_bf16_f32 v90, v228, v229
    v_cvt_pk_bf16_f32 v91, v230, v231
    v_mfma_f32_16x16x32_bf16 v[232:235], a[28:31], a[220:223], v[232:235]
    v_exp_f32 v201, v201
    v_mfma_f32_16x16x32_bf16 v[232:235], a[32:35], a[224:227], v[232:235]
    v_mul_f32 v212, v212, v225
    v_mul_f32 v213, v213, v225
    v_mfma_f32_16x16x32_bf16 v[232:235], a[36:39], a[228:231], v[232:235]
    v_cvt_pk_bf16_f32 v182, v200, v201
    v_mul_f32 v214, v214, v225
    v_mfma_f32_16x16x32_bf16 v[232:235], a[40:43], a[232:235], v[232:235]
    v_mul_f32 v215, v215, v225
    v_cvt_pk_bf16_f32 v212, v212, v213
    v_mfma_f32_16x16x32_bf16 v[232:235], a[44:47], a[236:239], v[232:235]
    v_cvt_pk_bf16_f32 v213, v214, v215
    v_mul_f32 v216, v216, v225
    v_mfma_f32_16x16x32_bf16 v[236:239], a[48:51], a[216:219], 0
    ds_write_b64 v251, v[212:213] offset:12288
    v_mfma_f32_16x16x32_bf16 v[212:215], v[18:21], v[180:183], 0
    s_waitcnt lgkmcnt(1)
    v_mul_f32 v217, v217, v225
    v_mul_f32 v218, v218, v225
    v_mfma_f32_16x16x32_bf16 v[196:199], v[108:111], v[174:177], v[196:199]
    v_cvt_pk_bf16_f32 v92, v232, v233
    v_cvt_pk_bf16_f32 v93, v234, v235
    v_mfma_f32_16x16x32_bf16 v[196:199], v[110:113], v[176:179], v[196:199]
    v_mul_f32 v219, v219, v225
    v_cvt_pk_bf16_f32 v216, v216, v217
    v_mfma_f32_16x16x32_bf16 v[236:239], a[52:55], a[220:223], v[236:239]
    v_cvt_pk_bf16_f32 v217, v218, v219
    v_mul_f32 v220, v220, v225
    v_mfma_f32_16x16x32_bf16 v[236:239], a[56:59], a[224:227], v[236:239]
    ds_write_b64 v251, v[216:217] offset:12416
    v_mfma_f32_16x16x32_bf16 v[216:219], v[48:51], v[180:183], 0
    v_mul_f32 v221, v221, v225
    v_mul_f32 v222, v222, v225
    v_mfma_f32_16x16x32_bf16 v[236:239], a[60:63], a[228:231], v[236:239]
    v_mul_f32 v223, v223, v225
    v_cvt_pk_bf16_f32 v220, v220, v221
    v_mfma_f32_16x16x32_bf16 v[236:239], a[64:67], a[232:235], v[236:239]
    ds_read_b128 a[240:243], v240 offset:30720
    v_cvt_pk_bf16_f32 v221, v222, v223
    v_mfma_f32_16x16x32_bf16 v[236:239], a[68:71], a[236:239], v[236:239]
    ds_write_b64 v251, v[220:221] offset:12544
    v_mfma_f32_16x16x32_bf16 v[220:223], v[78:81], v[180:183], 0
    ds_read_b128 a[244:247], v241 offset:30720
    v_max3_f32 v248, v248, v224, v225
    v_mfma_f32_16x16x32_bf16 v[224:227], a[248:251], v[180:183], 0
    v_exp_f32 v202, v202
    v_mfma_f32_16x16x32_bf16 v[228:231], a[216:219], a[72:75], 0
    v_exp_f32 v203, v203
    v_mfma_f32_16x16x32_bf16 v[228:231], a[220:223], a[76:79], v[228:231]
    v_cvt_pk_bf16_f32 v94, v236, v237
    v_cvt_pk_bf16_f32 v95, v238, v239
    v_mfma_f32_16x16x32_bf16 v[228:231], a[224:227], a[80:83], v[228:231]
    v_exp_f32 v204, v204
    v_mfma_f32_16x16x32_bf16 v[228:231], a[228:231], a[84:87], v[228:231]
    v_exp_f32 v205, v205
    v_mfma_f32_16x16x32_bf16 v[228:231], a[232:235], a[88:91], v[228:231]
    v_exp_f32 v208, v208
    v_mfma_f32_16x16x32_bf16 v[228:231], a[236:239], a[92:95], v[228:231]
    v_exp_f32 v209, v209
    v_mfma_f32_16x16x32_bf16 v[232:235], a[216:219], a[96:99], 0
    s_waitcnt lgkmcnt(2)
    v_cvt_pk_bf16_f32 v185, v202, v203
    v_cvt_pk_bf16_f32 v186, v204, v205
    v_mfma_f32_16x16x32_bf16 v[232:235], a[220:223], a[100:103], v[232:235]
    v_cvt_pk_bf16_f32 v187, v208, v209
    v_mov_b32 v200, 0x237c0
    v_mfma_f32_16x16x32_bf16 v[232:235], a[224:227], a[104:107], v[232:235]
    s_waitcnt lgkmcnt(0)
    v_cvt_pk_bf16_f32 v6, v228, v229
    v_cvt_pk_bf16_f32 v9, v230, v231
    v_mfma_f32_16x16x32_bf16 v[212:215], v[22:25], v[184:187], v[212:215]
    v_exp_f32 v206, v206
    v_mfma_f32_16x16x32_bf16 v[216:219], v[52:55], v[184:187], v[216:219]
    v_exp_f32 v207, v207
    v_mfma_f32_16x16x32_bf16 v[220:223], v[82:85], v[184:187], v[220:223]
    v_exp_f32 v210, v210
    v_mfma_f32_16x16x32_bf16 v[224:227], a[248:251], v[184:187], v[224:227]
    v_exp_f32 v211, v211
    v_mfma_f32_16x16x32_bf16 v[232:235], a[228:231], a[108:111], v[232:235]
    v_exp_f32 v196, v196
    v_mfma_f32_16x16x32_bf16 v[232:235], a[232:235], a[112:115], v[232:235]
    v_exp_f32 v197, v197
    v_mfma_f32_16x16x32_bf16 v[232:235], a[236:239], a[116:119], v[232:235]
    v_exp_f32 v198, v198
    v_mfma_f32_16x16x32_bf16 v[236:239], a[216:219], a[120:123], 0
    ds_read_b128 a[216:219], v240 offset:30848
    v_cvt_pk_bf16_f32 v189, v206, v207
    v_mfma_f32_16x16x32_bf16 v[236:239], a[220:223], a[124:127], v[236:239]
    ds_read_b128 a[220:223], v241 offset:30848
    v_cvt_pk_bf16_f32 v190, v210, v211
    v_mfma_f32_16x16x32_bf16 v[236:239], a[224:227], a[128:131], v[236:239]
    ds_read_b128 a[224:227], v240 offset:30976
    v_cvt_pk_bf16_f32 v36, v232, v233
    v_mfma_f32_16x16x32_bf16 v[236:239], a[228:231], a[132:135], v[236:239]
    ds_read_b128 a[228:231], v241 offset:30976
    v_cvt_pk_bf16_f32 v39, v234, v235
    v_mfma_f32_16x16x32_bf16 v[236:239], a[232:235], a[136:139], v[236:239]
    v_exp_f32 v199, v199
    v_mfma_f32_16x16x32_bf16 v[236:239], a[236:239], a[140:143], v[236:239]
    v_cvt_pk_bf16_f32 v188, v196, v197
    v_cvt_pk_bf16_f32 v191, v198, v199
    v_mfma_f32_16x16x32_bf16 v[228:231], a[0:3], a[240:243], 0
    ds_read_b128 a[232:235], v242 offset:32256
    v_add_u32 v201, 0xfffff900, v245
    v_mfma_f32_16x16x32_bf16 v[212:215], v[26:29], v[188:191], v[212:215]
    ds_read_b128 a[236:239], v243 offset:32256
    buffer_load_dwordx4 v254, s[4:7], s59 offen offset:1024 lds
    v_mfma_f32_16x16x32_bf16 v[216:219], v[56:59], v[188:191], v[216:219]
    v_cvt_pk_bf16_f32 v66, v236, v237
    v_cvt_pk_bf16_f32 v69, v238, v239
    v_mfma_f32_16x16x32_bf16 v[220:223], v[86:89], v[188:191], v[220:223]
    ds_write_b64 v247, v[174:175] offset:0
    v_mfma_f32_16x16x32_bf16 v[224:227], a[248:251], v[188:191], v[224:227]
    ds_write_b64 v247, v[176:177] offset:128
    v_mfma_f32_16x16x32_bf16 v[228:231], a[4:7], a[244:247], v[228:231]
    s_waitcnt lgkmcnt(7)
    v_accvgpr_read_b32 v254, a252
    v_mov_b32 v191, 0
    v_mfma_f32_16x16x32_bf16 v[228:231], a[8:11], a[216:219], v[228:231]
    s_waitcnt lgkmcnt(6)
    buffer_load_dwordx4 v255, s[4:7], s59 offen offset:2048 lds
    v_mfma_f32_16x16x32_bf16 v[228:231], a[12:15], a[220:223], v[228:231]
    s_waitcnt lgkmcnt(5)
    v_mov_b32 v226, 0x22e00
    v_cndmask_b32 v226, v226, v247, vcc
    v_mfma_f32_16x16x32_bf16 v[228:231], a[16:19], a[224:227], v[228:231]
    s_waitcnt lgkmcnt(4)
    v_rcp_f32 v225, v224
    v_mfma_f32_16x16x32_bf16 v[228:231], a[20:23], a[228:231], v[228:231]
    s_mov_b32 vcc_lo, 0x0
    v_mul_f32 v212, v212, v225
    v_mul_f32 v213, v213, v225
    v_mfma_f32_16x16x32_bf16 v[232:235], a[24:27], a[240:243], 0
    s_mov_b32 vcc_hi, 0xf0000
    v_cndmask_b32 v245, v245, v200, vcc
    v_cndmask_b32 v244, v201, v244, vcc
    v_mfma_f32_16x16x32_bf16 v[232:235], a[28:31], a[244:247], v[232:235]
    s_mov_b32 vcc_lo, 0xff00fff0
    v_cvt_pk_bf16_f32 v96, v228, v229
    v_cvt_pk_bf16_f32 v97, v230, v231
    v_mfma_f32_16x16x32_bf16 v[232:235], a[32:35], a[216:219], v[232:235]
    ds_read_b128 v[204:207], v245 offset:192
    v_mul_f32 v214, v214, v225
    v_mfma_f32_16x16x32_bf16 v[232:235], a[36:39], a[220:223], v[232:235]
    s_mov_b32 vcc_hi, 0xf000
    v_cndmask_b32 v244, v244, v200, vcc
    v_mul_f32 v215, v215, v225
    v_mfma_f32_16x16x32_bf16 v[232:235], a[40:43], a[224:227], v[232:235]
    ds_read_b128 v[196:199], v244 offset:256
    v_cvt_pk_bf16_f32 v212, v212, v213
    v_mfma_f32_16x16x32_bf16 v[232:235], a[44:47], a[228:231], v[232:235]
    s_mov_b32 vcc_lo, 0xfff00ff
    v_mul_f32 v216, v216, v225
    v_mul_f32 v217, v217, v225
    v_mfma_f32_16x16x32_bf16 v[236:239], a[48:51], a[240:243], 0
    s_mov_b32 vcc_hi, 0xffffffff
    v_cndmask_b32 v246, v246, v200, vcc
    v_cvt_pk_bf16_f32 v213, v214, v215
    v_mfma_f32_16x16x32_bf16 v[236:239], a[52:55], a[244:247], v[236:239]
    s_add_u32 m0, s46, 0x1800
    v_cvt_pk_bf16_f32 v98, v232, v233
    v_cvt_pk_bf16_f32 v99, v234, v235
    v_mfma_f32_16x16x32_bf16 v[236:239], a[56:59], a[216:219], v[236:239]
    ds_read_b128 v[200:203], v244 offset:192
    v_mul_f32 v218, v218, v225
    v_mfma_f32_16x16x32_bf16 v[236:239], a[60:63], a[220:223], v[236:239]
    ds_read_b128 v[208:211], v246 offset:192
    v_mul_f32 v219, v219, v225
    v_mfma_f32_16x16x32_bf16 v[236:239], a[64:67], a[224:227], v[236:239]
    ds_write_b64 v247, v[178:179] offset:256
    v_mfma_f32_16x16x32_bf16 v[236:239], a[68:71], a[228:231], v[236:239]
    s_mov_b32 vcc_lo, 0xff00ff00
    v_cvt_pk_bf16_f32 v216, v216, v217
    v_mul_f32 v220, v220, v225
    v_mfma_f32_16x16x32_bf16 v[228:231], a[240:243], a[72:75], 0
    s_mov_b32 vcc_hi, 0xff00ff00
    v_mul_f32 v221, v221, v225
    v_cvt_pk_bf16_f32 v217, v218, v219
    v_mfma_f32_16x16x32_bf16 v[228:231], a[244:247], a[76:79], v[228:231]
    s_waitcnt lgkmcnt(4)
    v_cvt_pk_bf16_f32 v100, v236, v237
    v_cvt_pk_bf16_f32 v101, v238, v239
    v_mfma_f32_16x16x32_bf16 v[204:207], v[150:153], v[168:171], v[204:207]
    ds_write_b64 v226, v[212:213] offset:0
    v_mfma_f32_16x16x32_bf16 v[204:207], v[152:155], v[170:173], v[204:207]
    s_waitcnt lgkmcnt(4)
    v_mul_f32 v222, v222, v225
    v_mul_f32 v223, v223, v225
    v_mfma_f32_16x16x32_bf16 v[196:199], v[120:123], v[168:171], v[196:199]
    v_cvt_pk_bf16_f32 v220, v220, v221
    v_cvt_pk_bf16_f32 v221, v222, v223
    v_mfma_f32_16x16x32_bf16 v[196:199], v[122:125], v[170:173], v[196:199]
    ds_write_b64 v226, v[216:217] offset:128
    v_mfma_f32_16x16x32_bf16 v[228:231], a[216:219], a[80:83], v[228:231]
    s_waitcnt lgkmcnt(3)
    v_exp_f32 v204, v204
    v_mfma_f32_16x16x32_bf16 v[200:203], v[114:117], v[168:171], v[200:203]
    v_exp_f32 v205, v205
    v_mfma_f32_16x16x32_bf16 v[200:203], v[116:119], v[170:173], v[200:203]
    v_exp_f32 v206, v206
    v_mfma_f32_16x16x32_bf16 v[208:211], v[96:99], v[168:171], v[208:211]
    v_exp_f32 v207, v207
    v_mfma_f32_16x16x32_bf16 v[208:211], v[98:101], v[170:173], v[208:211]
    v_cvt_pk_bf16_f32 v194, v204, v205
    v_cvt_pk_bf16_f32 v181, v206, v207
    v_mfma_f32_16x16x32_bf16 v[228:231], a[220:223], a[84:87], v[228:231]
    ds_read_b128 v[204:207], v246 offset:256
    v_max3_f32 v248, v248, v224, v225
    v_mfma_f32_16x16x32_bf16 v[228:231], a[224:227], a[88:91], v[228:231]
    v_exp_f32 v200, v200
    v_mfma_f32_16x16x32_bf16 v[228:231], a[228:231], a[92:95], v[228:231]
    v_exp_f32 v201, v201
    v_mfma_f32_16x16x32_bf16 v[232:235], a[240:243], a[96:99], 0
    v_exp_f32 v202, v202
    v_mfma_f32_16x16x32_bf16 v[232:235], a[244:247], a[100:103], v[232:235]
    v_exp_f32 v203, v203
    v_mfma_f32_16x16x32_bf16 v[232:235], a[216:219], a[104:107], v[232:235]
    v_cvt_pk_bf16_f32 v193, v200, v201
    v_cvt_pk_bf16_f32 v180, v202, v203
    v_mfma_f32_16x16x32_bf16 v[232:235], a[220:223], a[108:111], v[232:235]
    v_cvt_pk_bf16_f32 v0, v228, v229
    v_cvt_pk_bf16_f32 v3, v230, v231
    v_mfma_f32_16x16x32_bf16 v[232:235], a[224:227], a[112:115], v[232:235]
    ds_read_b128 v[200:203], v245 offset:256
    v_accvgpr_read_b32 v255, a255
    v_mfma_f32_16x16x32_bf16 v[232:235], a[228:231], a[116:119], v[232:235]
    ds_write_b64 v226, v[220:221] offset:256
    v_mfma_f32_16x16x32_bf16 v[236:239], a[240:243], a[120:123], 0
    ds_read_b128 a[240:243], v242 offset:32384
    buffer_load_dwordx4 v254, s[4:7], s58 offen lds
    v_mfma_f32_16x16x32_bf16 v[236:239], a[244:247], a[124:127], v[236:239]
    ds_read_b128 a[244:247], v243 offset:32384
    v_mfma_f32_16x16x32_bf16 v[236:239], a[216:219], a[128:131], v[236:239]
    ds_read_b128 a[216:219], v242 offset:32512
    v_cvt_pk_bf16_f32 v30, v232, v233
    v_mfma_f32_16x16x32_bf16 v[236:239], a[220:223], a[132:135], v[236:239]
    ds_read_b128 a[220:223], v243 offset:32512
    v_cvt_pk_bf16_f32 v33, v234, v235
    v_mfma_f32_16x16x32_bf16 v[236:239], a[224:227], a[136:139], v[236:239]
    ds_read_b128 a[224:227], v242 offset:33792
    s_waitcnt lgkmcnt(7)
    v_mfma_f32_16x16x32_bf16 v[204:207], v[90:93], v[168:171], v[204:207]
    v_exp_f32 v208, v208
    v_mfma_f32_16x16x32_bf16 v[204:207], v[92:95], v[170:173], v[204:207]
    v_exp_f32 v209, v209
    v_mfma_f32_16x16x32_bf16 v[236:239], a[228:231], a[140:143], v[236:239]
    ds_read_b128 a[228:231], v243 offset:33792
    v_cvt_pk_bf16_f32 v192, v208, v209
    v_mfma_f32_16x16x32_bf16 v[228:231], a[144:147], a[232:235], 0
    s_waitcnt lgkmcnt(7)
    v_exp_f32 v210, v210
    v_mfma_f32_16x16x32_bf16 v[200:203], v[156:159], v[168:171], v[200:203]
    v_exp_f32 v211, v211
    v_mfma_f32_16x16x32_bf16 v[200:203], v[158:161], v[170:173], v[200:203]
    s_waitcnt lgkmcnt(5)
    v_cvt_pk_bf16_f32 v60, v236, v237
    v_cvt_pk_bf16_f32 v63, v238, v239
    v_mfma_f32_16x16x32_bf16 v[228:231], a[148:151], a[236:239], v[228:231]
    buffer_load_dwordx4 v255, s[4:7], s58 offen offset:512 lds
    v_cvt_pk_bf16_f32 v195, v210, v211
    v_mfma_f32_16x16x32_bf16 v[228:231], a[152:155], a[240:243], v[228:231]
    s_waitcnt lgkmcnt(4)
    v_exp_f32 v196, v196
    v_mfma_f32_16x16x32_bf16 v[212:215], v[0:3], v[192:195], 0
    ds_read_b128 v[208:211], v244 offset:320
    s_add_u32 m0, s46, 0x16800
    v_mfma_f32_16x16x32_bf16 v[216:219], v[30:33], v[192:195], 0
    s_waitcnt lgkmcnt(2)
    v_exp_f32 v197, v197
    v_mfma_f32_16x16x32_bf16 v[220:223], v[60:63], v[192:195], 0
    v_exp_f32 v198, v198
    v_mfma_f32_16x16x32_bf16 v[224:227], a[248:251], v[192:195], 0
    v_exp_f32 v199, v199
    v_mfma_f32_16x16x32_bf16 v[228:231], a[156:159], a[244:247], v[228:231]
    s_waitcnt lgkmcnt(1)
    v_cvt_pk_bf16_f32 v183, v196, v197
    v_cvt_pk_bf16_f32 v186, v198, v199
    v_mfma_f32_16x16x32_bf16 v[228:231], a[160:163], a[216:219], v[228:231]
    ds_read_b128 v[196:199], v245 offset:320
    v_mfma_f32_16x16x32_bf16 v[228:231], a[164:167], a[220:223], v[228:231]
    v_exp_f32 v200, v200
    v_mfma_f32_16x16x32_bf16 v[232:235], a[168:171], a[232:235], 0
    v_exp_f32 v201, v201
    v_mfma_f32_16x16x32_bf16 v[232:235], a[172:175], a[236:239], v[232:235]
    v_exp_f32 v202, v202
    v_mfma_f32_16x16x32_bf16 v[232:235], a[176:179], a[240:243], v[232:235]
    v_exp_f32 v203, v203
    v_mfma_f32_16x16x32_bf16 v[232:235], a[180:183], a[244:247], v[232:235]
    s_waitcnt lgkmcnt(1)
    v_mul_f32 v228, s38, v228
    v_mul_f32 v229, s38, v229
    v_mfma_f32_16x16x32_bf16 v[208:211], v[126:129], v[168:171], v[208:211]
    v_mul_f32 v230, s38, v230
    v_mul_f32 v231, s38, v231
    v_mfma_f32_16x16x32_bf16 v[208:211], v[128:131], v[170:173], v[208:211]
    v_cvt_pk_bf16_f32 v174, v228, v229
    v_cvt_pk_bf16_f32 v175, v230, v231
    v_mfma_f32_16x16x32_bf16 v[232:235], a[184:187], a[216:219], v[232:235]
    v_cvt_pk_bf16_f32 v184, v200, v201
    v_cvt_pk_bf16_f32 v187, v202, v203
    v_mfma_f32_16x16x32_bf16 v[232:235], a[188:191], a[220:223], v[232:235]
    v_exp_f32 v204, v204
    v_mfma_f32_16x16x32_bf16 v[236:239], a[192:195], a[232:235], 0
    ds_read_b128 a[232:235], v242 offset:33920
    ds_read_b128 v[200:203], v246 offset:320
    v_mfma_f32_16x16x32_bf16 v[236:239], a[196:199], a[236:239], v[236:239]
    ds_read_b128 a[236:239], v243 offset:33920
    v_mfma_f32_16x16x32_bf16 v[236:239], a[200:203], a[240:243], v[236:239]
    ds_read_b128 a[240:243], v242 offset:34048
    v_mul_f32 v232, s3, v232
    v_mfma_f32_16x16x32_bf16 v[236:239], a[204:207], a[244:247], v[236:239]
    s_waitcnt lgkmcnt(4)
    v_mul_f32 v233, s3, v233
    v_mul_f32 v234, s3, v234
    v_mfma_f32_16x16x32_bf16 v[196:199], v[162:165], v[168:171], v[196:199]
    v_mul_f32 v235, s3, v235
    v_cvt_pk_bf16_f32 v176, v232, v233
    v_mfma_f32_16x16x32_bf16 v[196:199], v[164:167], v[170:173], v[196:199]
    ds_read_b128 a[244:247], v243 offset:34048
    v_cvt_pk_bf16_f32 v177, v234, v235
    v_mfma_f32_16x16x32_bf16 v[236:239], a[208:211], a[216:219], v[236:239]
    v_exp_f32 v205, v205
    v_mfma_f32_16x16x32_bf16 v[236:239], a[212:215], a[220:223], v[236:239]
    v_exp_f32 v206, v206
    v_mfma_f32_16x16x32_bf16 v[228:231], a[144:147], a[224:227], 0
    v_exp_f32 v207, v207
    v_mfma_f32_16x16x32_bf16 v[228:231], a[148:151], a[228:231], v[228:231]
    s_waitcnt lgkmcnt(4)
    v_cvt_pk_bf16_f32 v182, v204, v205
    v_cvt_pk_bf16_f32 v185, v206, v207
    v_mfma_f32_16x16x32_bf16 v[228:231], a[152:155], a[232:235], v[228:231]
    s_waitcnt lgkmcnt(2)
    v_mul_f32 v236, s38, v236
    v_mul_f32 v237, s38, v237
    v_mfma_f32_16x16x32_bf16 v[212:215], v[4:7], v[180:183], v[212:215]
    v_mul_f32 v238, s38, v238
    v_mul_f32 v239, s38, v239
    v_mfma_f32_16x16x32_bf16 v[216:219], v[34:37], v[180:183], v[216:219]
    v_cvt_pk_bf16_f32 v178, v236, v237
    v_cvt_pk_bf16_f32 v179, v238, v239
    v_mfma_f32_16x16x32_bf16 v[220:223], v[64:67], v[180:183], v[220:223]
    ds_read_b128 v[204:207], v244 offset:0
    s_waitcnt vmcnt(10) lgkmcnt(1)
    v_mfma_f32_16x16x32_bf16 v[224:227], a[248:251], v[180:183], v[224:227]
    s_barrier
    v_mfma_f32_16x16x32_bf16 v[212:215], v[8:11], v[184:187], v[212:215]
    ds_read_b128 a[216:219], v240 offset:33792
    ds_read_b128 a[220:223], v241 offset:33792
    v_mfma_f32_16x16x32_bf16 v[216:219], v[38:41], v[184:187], v[216:219]
    v_exp_f32 v208, v208
    v_mfma_f32_16x16x32_bf16 v[220:223], v[68:71], v[184:187], v[220:223]
    v_exp_f32 v209, v209
    v_mfma_f32_16x16x32_bf16 v[224:227], a[248:251], v[184:187], v[224:227]
    v_exp_f32 v196, v196
    v_mfma_f32_16x16x32_bf16 v[228:231], a[156:159], a[236:239], v[228:231]
    v_exp_f32 v197, v197
    v_mfma_f32_16x16x32_bf16 v[228:231], a[160:163], a[240:243], v[228:231]
    v_cvt_pk_bf16_f32 v189, v208, v209
    v_cvt_pk_bf16_f32 v190, v196, v197
    v_mfma_f32_16x16x32_bf16 v[228:231], a[164:167], a[244:247], v[228:231]
    ds_read_b128 v[208:211], v245 offset:0
    ds_read_b128 v[196:199], v246 offset:0
    v_mfma_f32_16x16x32_bf16 v[232:235], a[168:171], a[224:227], 0
    s_waitcnt lgkmcnt(4)
    v_mfma_f32_16x16x32_bf16 v[204:207], v[120:123], v[174:177], v[204:207]
    v_mfma_f32_16x16x32_bf16 v[204:207], v[122:125], v[176:179], v[204:207]
    s_waitcnt lgkmcnt(3)
    v_mfma_f32_16x16x32_bf16 v[232:235], a[172:175], a[228:231], v[232:235]
    s_waitcnt lgkmcnt(2)
    v_mul_f32 v228, s38, v228
    v_mul_f32 v229, s38, v229
    v_mfma_f32_16x16x32_bf16 v[232:235], a[176:179], a[232:235], v[232:235]
    v_mul_f32 v230, s38, v230
    v_mul_f32 v231, s38, v231
    v_mfma_f32_16x16x32_bf16 v[232:235], a[180:183], a[236:239], v[232:235]
    v_cvt_pk_bf16_f32 v228, v228, v229
    v_cvt_pk_bf16_f32 v229, v230, v231
    v_mfma_f32_16x16x32_bf16 v[232:235], a[184:187], a[240:243], v[232:235]
    ds_write_b64 v247, v[228:229] offset:18432
    v_mfma_f32_16x16x32_bf16 v[232:235], a[188:191], a[244:247], v[232:235]
    v_exp_f32 v204, v204
    v_mfma_f32_16x16x32_bf16 v[236:239], a[192:195], a[224:227], 0
    ds_read_b128 a[224:227], v240 offset:33920
    v_mfma_f32_16x16x32_bf16 v[236:239], a[196:199], a[228:231], v[236:239]
    ds_read_b128 a[228:231], v241 offset:33920
    v_mfma_f32_16x16x32_bf16 v[236:239], a[200:203], a[232:235], v[236:239]
    ds_read_b128 a[232:235], v240 offset:34048
    v_mfma_f32_16x16x32_bf16 v[236:239], a[204:207], a[236:239], v[236:239]
    ds_read_b128 a[236:239], v241 offset:34048
    v_mul_f32 v232, s3, v232
    v_mfma_f32_16x16x32_bf16 v[236:239], a[208:211], a[240:243], v[236:239]
    s_waitcnt lgkmcnt(6)
    v_mul_f32 v233, s3, v233
    v_mul_f32 v234, s3, v234
    v_mfma_f32_16x16x32_bf16 v[208:211], v[156:159], v[174:177], v[208:211]
    s_waitcnt lgkmcnt(5)
    v_mul_f32 v235, s3, v235
    v_cvt_pk_bf16_f32 v232, v232, v233
    v_mfma_f32_16x16x32_bf16 v[208:211], v[158:161], v[176:179], v[208:211]
    ds_read_b128 a[240:243], v242 offset:61440
    v_cvt_pk_bf16_f32 v233, v234, v235
    v_mfma_f32_16x16x32_bf16 v[196:199], v[90:93], v[174:177], v[196:199]
    ds_write_b64 v247, v[232:233] offset:18560
    v_mfma_f32_16x16x32_bf16 v[196:199], v[92:95], v[176:179], v[196:199]
    v_exp_f32 v205, v205
    v_mfma_f32_16x16x32_bf16 v[236:239], a[212:215], a[244:247], v[236:239]
    v_exp_f32 v206, v206
    v_mfma_f32_16x16x32_bf16 v[228:231], a[0:3], a[216:219], 0
    s_waitcnt lgkmcnt(5)
    v_exp_f32 v207, v207
    v_mfma_f32_16x16x32_bf16 v[228:231], a[4:7], a[220:223], v[228:231]
    s_waitcnt lgkmcnt(4)
    v_cvt_pk_bf16_f32 v193, v204, v205
    v_cvt_pk_bf16_f32 v180, v206, v207
    v_mfma_f32_16x16x32_bf16 v[228:231], a[8:11], a[224:227], v[228:231]
    s_waitcnt lgkmcnt(3)
    v_mul_f32 v236, s38, v236
    v_mul_f32 v237, s38, v237
    v_mfma_f32_16x16x32_bf16 v[228:231], a[12:15], a[228:231], v[228:231]
    s_waitcnt lgkmcnt(2)
    v_mul_f32 v238, s38, v238
    v_mul_f32 v239, s38, v239
    v_mfma_f32_16x16x32_bf16 v[228:231], a[16:19], a[232:235], v[228:231]
    ds_read_b128 v[204:207], v245 offset:64
    v_cvt_pk_bf16_f32 v236, v236, v237
    v_mfma_f32_16x16x32_bf16 v[228:231], a[20:23], a[236:239], v[228:231]
    ds_read_b128 a[244:247], v243 offset:61440
    v_cvt_pk_bf16_f32 v237, v238, v239
    v_mfma_f32_16x16x32_bf16 v[232:235], a[24:27], a[216:219], 0
    ds_write_b64 v247, v[236:237] offset:18688
    v_mfma_f32_16x16x32_bf16 v[232:235], a[28:31], a[220:223], v[232:235]
    s_waitcnt lgkmcnt(3)
    v_exp_f32 v208, v208
    v_mfma_f32_16x16x32_bf16 v[232:235], a[32:35], a[224:227], v[232:235]
    v_cvt_pk_bf16_f32 v138, v228, v229
    v_cvt_pk_bf16_f32 v139, v230, v231
    v_mfma_f32_16x16x32_bf16 v[232:235], a[36:39], a[228:231], v[232:235]
    v_exp_f32 v209, v209
    v_mfma_f32_16x16x32_bf16 v[232:235], a[40:43], a[232:235], v[232:235]
    v_exp_f32 v210, v210
    v_mfma_f32_16x16x32_bf16 v[232:235], a[44:47], a[236:239], v[232:235]
    v_exp_f32 v211, v211
    v_mfma_f32_16x16x32_bf16 v[236:239], a[48:51], a[216:219], 0
    v_cvt_pk_bf16_f32 v194, v208, v209
    v_cvt_pk_bf16_f32 v181, v210, v211
    v_mfma_f32_16x16x32_bf16 v[236:239], a[52:55], a[220:223], v[236:239]
    ds_read_b128 v[208:211], v246 offset:64
    v_mfma_f32_16x16x32_bf16 v[236:239], a[56:59], a[224:227], v[236:239]
    s_waitcnt lgkmcnt(3)
    v_cvt_pk_bf16_f32 v140, v232, v233
    v_cvt_pk_bf16_f32 v141, v234, v235
    v_mfma_f32_16x16x32_bf16 v[204:207], v[162:165], v[174:177], v[204:207]
    s_waitcnt lgkmcnt(2)
    v_exp_f32 v196, v196
    v_mfma_f32_16x16x32_bf16 v[200:203], v[138:141], v[168:171], v[200:203]
    v_exp_f32 v197, v197
    v_mfma_f32_16x16x32_bf16 v[204:207], v[164:167], v[176:179], v[204:207]
    v_exp_f32 v198, v198
    v_mfma_f32_16x16x32_bf16 v[236:239], a[60:63], a[228:231], v[236:239]
    v_exp_f32 v199, v199
    v_mfma_f32_16x16x32_bf16 v[236:239], a[64:67], a[232:235], v[236:239]
    v_cvt_pk_bf16_f32 v192, v196, v197
    v_cvt_pk_bf16_f32 v195, v198, v199
    v_mfma_f32_16x16x32_bf16 v[236:239], a[68:71], a[236:239], v[236:239]
    ds_read_b128 v[196:199], v244 offset:128
    ds_read_b64 v[168:169], v247 offset:18432
    v_mfma_f32_16x16x32_bf16 v[228:231], a[216:219], a[72:75], 0
    v_exp_f32 v204, v204
    v_mfma_f32_16x16x32_bf16 v[228:231], a[220:223], a[76:79], v[228:231]
    v_exp_f32 v205, v205
    v_mfma_f32_16x16x32_bf16 v[228:231], a[224:227], a[80:83], v[228:231]
    s_waitcnt lgkmcnt(2)
    v_cvt_pk_bf16_f32 v142, v236, v237
    v_cvt_pk_bf16_f32 v143, v238, v239
    v_mfma_f32_16x16x32_bf16 v[208:211], v[138:141], v[174:177], v[208:211]
    v_exp_f32 v206, v206
    v_mfma_f32_16x16x32_bf16 v[200:203], v[140:143], v[170:173], v[200:203]
    v_exp_f32 v207, v207
    v_mfma_f32_16x16x32_bf16 v[208:211], v[140:143], v[176:179], v[208:211]
    v_cvt_pk_bf16_f32 v184, v204, v205
    v_cvt_pk_bf16_f32 v187, v206, v207
    v_mfma_f32_16x16x32_bf16 v[228:231], a[228:231], a[84:87], v[228:231]
    ds_read_b128 v[204:207], v246 offset:128
    ds_read_b64 v[170:171], v247 offset:18560
    v_mfma_f32_16x16x32_bf16 v[228:231], a[232:235], a[88:91], v[228:231]
L_h5:
    s_cbranch_execz L_h9
    v_exp_f32 v200, v200
    v_mfma_f32_16x16x32_bf16 v[228:231], a[236:239], a[92:95], v[228:231]
    s_waitcnt lgkmcnt(3)
    v_exp_f32 v201, v201
    v_mfma_f32_16x16x32_bf16 v[196:199], v[132:135], v[174:177], v[196:199]
    ds_read_b64 v[172:173], v247 offset:18688
    v_cvt_pk_bf16_f32 v188, v200, v201
    v_mfma_f32_16x16x32_bf16 v[196:199], v[134:137], v[176:179], v[196:199]
    ds_read_b128 v[200:203], v244 offset:64
    v_mfma_f32_16x16x32_bf16 v[224:227], a[248:251], v[188:191], v[224:227]
    s_waitcnt lgkmcnt(4)
    v_cvt_pk_bf16_f32 v12, v228, v229
    v_cvt_pk_bf16_f32 v15, v230, v231
    v_mfma_f32_16x16x32_bf16 v[232:235], a[216:219], a[96:99], 0
    v_exp_f32 v208, v208
    v_mfma_f32_16x16x32_bf16 v[212:215], v[12:15], v[188:191], v[212:215]
    v_exp_f32 v209, v209
    v_mfma_f32_16x16x32_bf16 v[232:235], a[220:223], a[100:103], v[232:235]
    v_rcp_f32 v225, v224
    v_mfma_f32_16x16x32_bf16 v[232:235], a[224:227], a[104:107], v[232:235]
    v_max3_f32 v248, v248, v224, v225
    v_cvt_pk_bf16_f32 v182, v208, v209
    v_mfma_f32_16x16x32_bf16 v[232:235], a[228:231], a[108:111], v[232:235]
    s_waitcnt lgkmcnt(2)
    v_mul_f32 v212, v212, v225
    v_mul_f32 v213, v213, v225
    v_mfma_f32_16x16x32_bf16 v[232:235], a[232:235], a[112:115], v[232:235]
    v_mul_f32 v214, v214, v225
    v_mul_f32 v215, v215, v225
    v_mfma_f32_16x16x32_bf16 v[232:235], a[236:239], a[116:119], v[232:235]
    v_cvt_pk_bf16_f32 v212, v212, v213
    s_waitcnt lgkmcnt(0)
    v_mfma_f32_16x16x32_bf16 v[200:203], v[126:129], v[174:177], v[200:203]
    v_exp_f32 v210, v210
    v_mfma_f32_16x16x32_bf16 v[200:203], v[128:131], v[176:179], v[200:203]
    v_exp_f32 v211, v211
    v_mfma_f32_16x16x32_bf16 v[236:239], a[216:219], a[120:123], 0
    ds_read_b128 a[216:219], v242 offset:61568
    v_cvt_pk_bf16_f32 v42, v232, v233
    v_mfma_f32_16x16x32_bf16 v[236:239], a[220:223], a[124:127], v[236:239]
    ds_read_b128 a[220:223], v243 offset:61568
    v_cvt_pk_bf16_f32 v45, v234, v235
    v_mfma_f32_16x16x32_bf16 v[236:239], a[224:227], a[128:131], v[236:239]
    ds_read_b128 a[224:227], v242 offset:61696
    v_cvt_pk_bf16_f32 v213, v214, v215
    v_mfma_f32_16x16x32_bf16 v[216:219], v[42:45], v[188:191], v[216:219]
    ds_write_b64 v247, v[212:213] offset:6144
    v_mfma_f32_16x16x32_bf16 v[212:215], v[6:9], v[192:195], 0
    v_exp_f32 v200, v200
    v_mfma_f32_16x16x32_bf16 v[236:239], a[228:231], a[132:135], v[236:239]
    ds_read_b128 a[228:231], v243 offset:61696
    v_cvt_pk_bf16_f32 v185, v210, v211
    v_mfma_f32_16x16x32_bf16 v[236:239], a[232:235], a[136:139], v[236:239]
    ds_read_b128 a[232:235], v242 offset:64512
    v_mul_f32 v216, v216, v225
    v_mfma_f32_16x16x32_bf16 v[236:239], a[236:239], a[140:143], v[236:239]
    ds_read_b128 a[236:239], v243 offset:64512
    v_mul_f32 v217, v217, v225
    v_mfma_f32_16x16x32_bf16 v[228:231], a[144:147], a[240:243], 0
    v_mul_f32 v218, v218, v225
    v_mul_f32 v219, v219, v225
    v_mfma_f32_16x16x32_bf16 v[228:231], a[148:151], a[244:247], v[228:231]
    s_waitcnt lgkmcnt(6)
    v_cvt_pk_bf16_f32 v216, v216, v217
    v_cvt_pk_bf16_f32 v72, v236, v237
    v_mfma_f32_16x16x32_bf16 v[228:231], a[152:155], a[216:219], v[228:231]
    s_waitcnt lgkmcnt(5)
    v_cvt_pk_bf16_f32 v75, v238, v239
    v_cvt_pk_bf16_f32 v217, v218, v219
    v_mfma_f32_16x16x32_bf16 v[228:231], a[156:159], a[220:223], v[228:231]
    s_waitcnt lgkmcnt(4)
    v_exp_f32 v201, v201
    v_mfma_f32_16x16x32_bf16 v[220:223], v[72:75], v[188:191], v[220:223]
    ds_write_b64 v247, v[216:217] offset:6272
    v_mfma_f32_16x16x32_bf16 v[216:219], v[36:39], v[192:195], 0
    v_exp_f32 v202, v202
    v_mfma_f32_16x16x32_bf16 v[228:231], a[160:163], a[224:227], v[228:231]
    s_waitcnt lgkmcnt(3)
    v_exp_f32 v203, v203
    v_mfma_f32_16x16x32_bf16 v[228:231], a[164:167], a[228:231], v[228:231]
    v_cvt_pk_bf16_f32 v183, v200, v201
    v_mul_f32 v220, v220, v225
    v_mfma_f32_16x16x32_bf16 v[232:235], a[168:171], a[240:243], 0
    s_waitcnt lgkmcnt(2)
    v_mul_f32 v221, v221, v225
    v_mul_f32 v222, v222, v225
    v_mfma_f32_16x16x32_bf16 v[212:215], v[10:13], v[180:183], v[212:215]
    s_waitcnt lgkmcnt(1)
    v_mul_f32 v228, s38, v228
    v_mul_f32 v229, s38, v229
    v_mfma_f32_16x16x32_bf16 v[216:219], v[40:43], v[180:183], v[216:219]
    v_mul_f32 v230, s38, v230
    v_mul_f32 v231, s38, v231
    v_mfma_f32_16x16x32_bf16 v[232:235], a[172:175], a[244:247], v[232:235]
    v_cvt_pk_bf16_f32 v228, v228, v229
    v_cvt_pk_bf16_f32 v229, v230, v231
    v_mfma_f32_16x16x32_bf16 v[232:235], a[176:179], a[216:219], v[232:235]
    ds_write_b64 v247, v[228:229] offset:24576
    v_mfma_f32_16x16x32_bf16 v[232:235], a[180:183], a[220:223], v[232:235]
    v_mul_f32 v223, v223, v225
    v_cvt_pk_bf16_f32 v220, v220, v221
    v_mfma_f32_16x16x32_bf16 v[224:227], a[248:251], v[192:195], 0
    v_cvt_pk_bf16_f32 v221, v222, v223
    v_cvt_pk_bf16_f32 v186, v202, v203
    v_mfma_f32_16x16x32_bf16 v[224:227], a[248:251], v[180:183], v[224:227]
    ds_write_b64 v247, v[220:221] offset:6400
    v_mfma_f32_16x16x32_bf16 v[220:223], v[66:69], v[192:195], 0
    ds_read_b128 v[200:203], v245 offset:128
    ds_read_b128 v[208:211], v244 offset:0
    v_mfma_f32_16x16x32_bf16 v[220:223], v[70:73], v[180:183], v[220:223]
    v_exp_f32 v196, v196
    v_mfma_f32_16x16x32_bf16 v[212:215], v[14:17], v[184:187], v[212:215]
    v_exp_f32 v197, v197
    v_mfma_f32_16x16x32_bf16 v[216:219], v[44:47], v[184:187], v[216:219]
    v_cvt_pk_bf16_f32 v189, v196, v197
    v_mfma_f32_16x16x32_bf16 v[220:223], v[74:77], v[184:187], v[220:223]
    ds_read_b128 v[196:199], v245 offset:0
    v_mfma_f32_16x16x32_bf16 v[224:227], a[248:251], v[184:187], v[224:227]
    v_mfma_f32_16x16x32_bf16 v[232:235], a[184:187], a[224:227], v[232:235]
    v_mfma_f32_16x16x32_bf16 v[232:235], a[188:191], a[228:231], v[232:235]
    v_mfma_f32_16x16x32_bf16 v[236:239], a[192:195], a[240:243], 0
    ds_read_b128 a[240:243], v242 offset:64640
    v_mfma_f32_16x16x32_bf16 v[236:239], a[196:199], a[244:247], v[236:239]
    ds_read_b128 a[244:247], v243 offset:64640
    v_mfma_f32_16x16x32_bf16 v[236:239], a[200:203], a[216:219], v[236:239]
    ds_read_b128 a[216:219], v242 offset:64768
    v_add_u32 v242, 0xf000, v242
    v_mfma_f32_16x16x32_bf16 v[236:239], a[204:207], a[220:223], v[236:239]
    ds_read_b128 a[220:223], v243 offset:64768
    v_mul_f32 v232, s3, v232
    v_mfma_f32_16x16x32_bf16 v[236:239], a[208:211], a[224:227], v[236:239]
    s_waitcnt lgkmcnt(5)
    v_mul_f32 v233, s3, v233
    v_mul_f32 v234, s3, v234
    v_mfma_f32_16x16x32_bf16 v[200:203], v[102:105], v[174:177], v[200:203]
    v_mul_f32 v235, s3, v235
    v_cvt_pk_bf16_f32 v232, v232, v233
    v_mfma_f32_16x16x32_bf16 v[200:203], v[104:107], v[176:179], v[200:203]
    ds_read_b128 a[224:227], v240 offset:35328
    v_cvt_pk_bf16_f32 v233, v234, v235
    v_mfma_f32_16x16x32_bf16 v[208:211], v[126:129], v[168:171], v[208:211]
    ds_write_b64 v247, v[232:233] offset:24704
    v_mfma_f32_16x16x32_bf16 v[208:211], v[128:131], v[170:173], v[208:211]
    s_waitcnt lgkmcnt(6)
    v_add_u32 v243, 0xf000, v243
    v_mfma_f32_16x16x32_bf16 v[196:199], v[162:165], v[168:171], v[196:199]
    v_exp_f32 v200, v200
    v_mfma_f32_16x16x32_bf16 v[196:199], v[164:167], v[170:173], v[196:199]
    s_waitcnt lgkmcnt(5)
    v_exp_f32 v201, v201
    v_mfma_f32_16x16x32_bf16 v[236:239], a[212:215], a[228:231], v[236:239]
    ds_read_b128 a[228:231], v241 offset:35328
    v_cvt_pk_bf16_f32 v190, v200, v201
    v_mfma_f32_16x16x32_bf16 v[228:231], a[144:147], a[232:235], 0
    ds_read_b128 v[200:203], v246 offset:0
    v_mfma_f32_16x16x32_bf16 v[228:231], a[148:151], a[236:239], v[228:231]
    s_waitcnt lgkmcnt(4)
    v_exp_f32 v208, v208
    v_mfma_f32_16x16x32_bf16 v[228:231], a[152:155], a[240:243], v[228:231]
    v_mul_f32 v236, s38, v236
    v_mul_f32 v237, s38, v237
    v_mfma_f32_16x16x32_bf16 v[228:231], a[156:159], a[244:247], v[228:231]
    v_mul_f32 v238, s38, v238
    v_mul_f32 v239, s38, v239
    v_mfma_f32_16x16x32_bf16 v[228:231], a[160:163], a[216:219], v[228:231]
    s_waitcnt lgkmcnt(3)
    v_cvt_pk_bf16_f32 v236, v236, v237
    v_cvt_pk_bf16_f32 v237, v238, v239
    v_mfma_f32_16x16x32_bf16 v[228:231], a[164:167], a[220:223], v[228:231]
    ds_write_b64 v247, v[236:237] offset:24832
    v_mfma_f32_16x16x32_bf16 v[232:235], a[168:171], a[232:235], 0
    v_exp_f32 v209, v209
    v_mfma_f32_16x16x32_bf16 v[232:235], a[172:175], a[236:239], v[232:235]
    v_exp_f32 v210, v210
    v_mfma_f32_16x16x32_bf16 v[232:235], a[176:179], a[240:243], v[232:235]
    v_exp_f32 v211, v211
    v_mfma_f32_16x16x32_bf16 v[232:235], a[180:183], a[244:247], v[232:235]
    s_waitcnt lgkmcnt(2)
    v_mul_f32 v228, s38, v228
    v_mul_f32 v229, s38, v229
    v_mfma_f32_16x16x32_bf16 v[232:235], a[184:187], a[216:219], v[232:235]
    s_waitcnt lgkmcnt(1)
    v_mul_f32 v230, s38, v230
    v_mul_f32 v231, s38, v231
    v_mfma_f32_16x16x32_bf16 v[200:203], v[138:141], v[168:171], v[200:203]
    v_cvt_pk_bf16_f32 v228, v228, v229
    v_cvt_pk_bf16_f32 v229, v230, v231
    v_mfma_f32_16x16x32_bf16 v[200:203], v[140:143], v[170:173], v[200:203]
    ds_write_b64 v247, v[228:229] offset:36864
    v_mfma_f32_16x16x32_bf16 v[232:235], a[188:191], a[220:223], v[232:235]
    v_cvt_pk_bf16_f32 v193, v208, v209
    v_cvt_pk_bf16_f32 v180, v210, v211
    v_mfma_f32_16x16x32_bf16 v[236:239], a[192:195], a[232:235], 0
    ds_read_b128 a[232:235], v240 offset:35456
    ds_read_b128 v[208:211], v245 offset:64
    v_mfma_f32_16x16x32_bf16 v[236:239], a[196:199], a[236:239], v[236:239]
    ds_read_b128 a[236:239], v241 offset:35456
    v_mfma_f32_16x16x32_bf16 v[236:239], a[200:203], a[240:243], v[236:239]
    v_mul_f32 v232, s3, v232
    v_mul_f32 v233, s3, v233
    v_mfma_f32_16x16x32_bf16 v[236:239], a[204:207], a[244:247], v[236:239]
    v_mul_f32 v234, s3, v234
    v_mul_f32 v235, s3, v235
    v_mfma_f32_16x16x32_bf16 v[236:239], a[208:211], a[216:219], v[236:239]
    ds_read_b128 a[240:243], v240 offset:35584
    v_cvt_pk_bf16_f32 v232, v232, v233
    v_mfma_f32_16x16x32_bf16 v[236:239], a[212:215], a[220:223], v[236:239]
    ds_read_b128 a[244:247], v241 offset:35584
    v_cvt_pk_bf16_f32 v233, v234, v235
    v_mfma_f32_16x16x32_bf16 v[228:231], a[0:3], a[224:227], 0
    ds_write_b64 v247, v[232:233] offset:36992
    v_mfma_f32_16x16x32_bf16 v[228:231], a[4:7], a[228:231], v[228:231]
    v_exp_f32 v196, v196
    v_mfma_f32_16x16x32_bf16 v[232:235], a[24:27], a[224:227], 0
    s_waitcnt lgkmcnt(5)
    v_mul_f32 v236, s38, v236
    v_mul_f32 v237, s38, v237
    v_mfma_f32_16x16x32_bf16 v[228:231], a[8:11], a[232:235], v[228:231]
    v_mul_f32 v238, s38, v238
    v_mul_f32 v239, s38, v239
    v_mfma_f32_16x16x32_bf16 v[232:235], a[28:31], a[228:231], v[232:235]
    s_waitcnt lgkmcnt(3)
    v_cvt_pk_bf16_f32 v236, v236, v237
    v_cvt_pk_bf16_f32 v237, v238, v239
    v_mfma_f32_16x16x32_bf16 v[208:211], v[102:105], v[168:171], v[208:211]
    ds_write_b64 v247, v[236:237] offset:37120
    v_mfma_f32_16x16x32_bf16 v[208:211], v[104:107], v[170:173], v[208:211]
    s_waitcnt vmcnt(0)
    v_exp_f32 v197, v197
    v_mfma_f32_16x16x32_bf16 v[228:231], a[12:15], a[236:239], v[228:231]
    s_waitcnt lgkmcnt(3)
    v_exp_f32 v198, v198
    v_mfma_f32_16x16x32_bf16 v[228:231], a[16:19], a[240:243], v[228:231]
    s_waitcnt lgkmcnt(2)
    v_exp_f32 v199, v199
    v_mfma_f32_16x16x32_bf16 v[228:231], a[20:23], a[244:247], v[228:231]
    s_barrier
    v_mfma_f32_16x16x32_bf16 v[232:235], a[32:35], a[232:235], v[232:235]
    ds_read_b128 a[216:219], v242 offset:4608
    v_cvt_pk_bf16_f32 v194, v196, v197
    v_mfma_f32_16x16x32_bf16 v[232:235], a[36:39], a[236:239], v[232:235]
    ds_read_b128 a[220:223], v243 offset:4608
    v_cvt_pk_bf16_f32 v181, v198, v199
    v_mfma_f32_16x16x32_bf16 v[232:235], a[40:43], a[240:243], v[232:235]
    v_cvt_pk_bf16_f32 v114, v228, v229
    v_cvt_pk_bf16_f32 v115, v230, v231
    v_mfma_f32_16x16x32_bf16 v[232:235], a[44:47], a[244:247], v[232:235]
    ds_read_b128 v[196:199], v246 offset:64
    v_mfma_f32_16x16x32_bf16 v[236:239], a[48:51], a[224:227], 0
    v_exp_f32 v200, v200
    v_mfma_f32_16x16x32_bf16 v[236:239], a[52:55], a[228:231], v[236:239]
    v_exp_f32 v201, v201
    v_mfma_f32_16x16x32_bf16 v[236:239], a[56:59], a[232:235], v[236:239]
    v_exp_f32 v202, v202
    v_mfma_f32_16x16x32_bf16 v[236:239], a[60:63], a[236:239], v[236:239]
    v_cvt_pk_bf16_f32 v116, v232, v233
    v_cvt_pk_bf16_f32 v117, v234, v235
    v_mfma_f32_16x16x32_bf16 v[236:239], a[64:67], a[240:243], v[236:239]
    v_exp_f32 v203, v203
    v_mfma_f32_16x16x32_bf16 v[204:207], v[114:117], v[174:177], v[204:207]
    v_cvt_pk_bf16_f32 v192, v200, v201
    v_cvt_pk_bf16_f32 v195, v202, v203
    v_mfma_f32_16x16x32_bf16 v[236:239], a[68:71], a[244:247], v[236:239]
    ds_read_b128 v[200:203], v244 offset:128
    ds_read_b64 v[174:175], v247 offset:0
    v_mfma_f32_16x16x32_bf16 v[228:231], a[224:227], a[72:75], 0
    s_waitcnt lgkmcnt(3)
    v_exp_f32 v208, v208
    v_mfma_f32_16x16x32_bf16 v[228:231], a[228:231], a[76:79], v[228:231]
    v_exp_f32 v209, v209
    v_mfma_f32_16x16x32_bf16 v[228:231], a[232:235], a[80:83], v[228:231]
    s_waitcnt lgkmcnt(2)
    v_cvt_pk_bf16_f32 v118, v236, v237
    v_cvt_pk_bf16_f32 v119, v238, v239
    v_mfma_f32_16x16x32_bf16 v[196:199], v[114:117], v[168:171], v[196:199]
    v_exp_f32 v210, v210
    v_mfma_f32_16x16x32_bf16 v[204:207], v[116:119], v[176:179], v[204:207]
    v_exp_f32 v211, v211
    v_mfma_f32_16x16x32_bf16 v[196:199], v[116:119], v[170:173], v[196:199]
    v_cvt_pk_bf16_f32 v184, v208, v209
    v_cvt_pk_bf16_f32 v187, v210, v211
    v_mfma_f32_16x16x32_bf16 v[228:231], a[236:239], a[84:87], v[228:231]
    ds_read_b128 v[208:211], v246 offset:128
    ds_read_b64 v[176:177], v247 offset:128
    v_mfma_f32_16x16x32_bf16 v[228:231], a[240:243], a[88:91], v[228:231]
    v_exp_f32 v204, v204
    v_mfma_f32_16x16x32_bf16 v[228:231], a[244:247], a[92:95], v[228:231]
    s_waitcnt lgkmcnt(3)
    v_exp_f32 v205, v205
    v_mfma_f32_16x16x32_bf16 v[200:203], v[144:147], v[168:171], v[200:203]
    ds_read_b64 v[178:179], v247 offset:256
    v_cvt_pk_bf16_f32 v188, v204, v205
    v_mfma_f32_16x16x32_bf16 v[200:203], v[146:149], v[170:173], v[200:203]
    ds_read_b128 v[204:207], v244 offset:64
    v_mfma_f32_16x16x32_bf16 v[224:227], a[248:251], v[188:191], v[224:227]
    s_waitcnt lgkmcnt(4)
    v_cvt_pk_bf16_f32 v18, v228, v229
    v_cvt_pk_bf16_f32 v21, v230, v231
    v_mfma_f32_16x16x32_bf16 v[232:235], a[224:227], a[96:99], 0
    v_exp_f32 v196, v196
    v_mfma_f32_16x16x32_bf16 v[212:215], v[18:21], v[188:191], v[212:215]
    v_exp_f32 v197, v197
    v_mfma_f32_16x16x32_bf16 v[232:235], a[228:231], a[100:103], v[232:235]
    v_rcp_f32 v225, v224
    v_mfma_f32_16x16x32_bf16 v[232:235], a[232:235], a[104:107], v[232:235]
    v_max3_f32 v248, v248, v224, v225
    v_cvt_pk_bf16_f32 v182, v196, v197
    v_mfma_f32_16x16x32_bf16 v[232:235], a[236:239], a[108:111], v[232:235]
    s_waitcnt lgkmcnt(2)
    v_mul_f32 v212, v212, v225
    v_mul_f32 v213, v213, v225
    v_mfma_f32_16x16x32_bf16 v[232:235], a[240:243], a[112:115], v[232:235]
    v_mul_f32 v214, v214, v225
    v_mul_f32 v215, v215, v225
    v_mfma_f32_16x16x32_bf16 v[232:235], a[244:247], a[116:119], v[232:235]
    v_cvt_pk_bf16_f32 v212, v212, v213
    s_waitcnt lgkmcnt(0)
    v_mfma_f32_16x16x32_bf16 v[204:207], v[132:135], v[168:171], v[204:207]
    v_exp_f32 v198, v198
    v_mfma_f32_16x16x32_bf16 v[204:207], v[134:137], v[170:173], v[204:207]
    v_exp_f32 v199, v199
    v_mfma_f32_16x16x32_bf16 v[236:239], a[224:227], a[120:123], 0
    ds_read_b128 a[224:227], v242 offset:4736
    v_cvt_pk_bf16_f32 v48, v232, v233
    v_mfma_f32_16x16x32_bf16 v[236:239], a[228:231], a[124:127], v[236:239]
    ds_read_b128 a[228:231], v243 offset:4736
    v_cvt_pk_bf16_f32 v51, v234, v235
    v_mfma_f32_16x16x32_bf16 v[236:239], a[232:235], a[128:131], v[236:239]
    ds_read_b128 a[232:235], v242 offset:4864
    v_cvt_pk_bf16_f32 v213, v214, v215
    v_mfma_f32_16x16x32_bf16 v[216:219], v[48:51], v[188:191], v[216:219]
    ds_write_b64 v247, v[212:213] offset:12288
    v_mfma_f32_16x16x32_bf16 v[212:215], v[12:15], v[192:195], 0
    v_exp_f32 v204, v204
    v_mfma_f32_16x16x32_bf16 v[236:239], a[236:239], a[132:135], v[236:239]
    ds_read_b128 a[236:239], v243 offset:4864
    v_cvt_pk_bf16_f32 v185, v198, v199
    v_mfma_f32_16x16x32_bf16 v[236:239], a[240:243], a[136:139], v[236:239]
    ds_read_b128 a[240:243], v242 offset:1536
    v_mul_f32 v216, v216, v225
    v_mfma_f32_16x16x32_bf16 v[236:239], a[244:247], a[140:143], v[236:239]
    ds_read_b128 a[244:247], v243 offset:1536
    v_mul_f32 v217, v217, v225
    v_mfma_f32_16x16x32_bf16 v[228:231], a[144:147], a[216:219], 0
    v_mul_f32 v218, v218, v225
    v_mul_f32 v219, v219, v225
    v_mfma_f32_16x16x32_bf16 v[228:231], a[148:151], a[220:223], v[228:231]
    s_waitcnt lgkmcnt(6)
    v_cvt_pk_bf16_f32 v216, v216, v217
    v_cvt_pk_bf16_f32 v78, v236, v237
    v_mfma_f32_16x16x32_bf16 v[228:231], a[152:155], a[224:227], v[228:231]
    s_waitcnt lgkmcnt(5)
    v_cvt_pk_bf16_f32 v81, v238, v239
    v_cvt_pk_bf16_f32 v217, v218, v219
    v_mfma_f32_16x16x32_bf16 v[228:231], a[156:159], a[228:231], v[228:231]
    s_waitcnt lgkmcnt(4)
    v_exp_f32 v205, v205
    v_mfma_f32_16x16x32_bf16 v[220:223], v[78:81], v[188:191], v[220:223]
    ds_write_b64 v247, v[216:217] offset:12416
    v_mfma_f32_16x16x32_bf16 v[216:219], v[42:45], v[192:195], 0
    v_exp_f32 v206, v206
    v_mfma_f32_16x16x32_bf16 v[228:231], a[160:163], a[232:235], v[228:231]
    s_waitcnt lgkmcnt(3)
    v_exp_f32 v207, v207
    v_mfma_f32_16x16x32_bf16 v[228:231], a[164:167], a[236:239], v[228:231]
    v_cvt_pk_bf16_f32 v183, v204, v205
    v_mul_f32 v220, v220, v225
    v_mfma_f32_16x16x32_bf16 v[232:235], a[168:171], a[216:219], 0
    s_waitcnt lgkmcnt(2)
    v_mul_f32 v221, v221, v225
    v_mul_f32 v222, v222, v225
    v_mfma_f32_16x16x32_bf16 v[212:215], v[16:19], v[180:183], v[212:215]
    s_waitcnt lgkmcnt(1)
    v_mul_f32 v228, s38, v228
    v_mul_f32 v229, s38, v229
    v_mfma_f32_16x16x32_bf16 v[216:219], v[46:49], v[180:183], v[216:219]
    v_mul_f32 v230, s38, v230
    v_mul_f32 v231, s38, v231
    v_mfma_f32_16x16x32_bf16 v[232:235], a[172:175], a[220:223], v[232:235]
    v_cvt_pk_bf16_f32 v228, v228, v229
    v_cvt_pk_bf16_f32 v229, v230, v231
    v_mfma_f32_16x16x32_bf16 v[232:235], a[176:179], a[224:227], v[232:235]
    ds_write_b64 v247, v[228:229] offset:43008
    v_mfma_f32_16x16x32_bf16 v[232:235], a[180:183], a[228:231], v[232:235]
    v_mul_f32 v223, v223, v225
    v_cvt_pk_bf16_f32 v220, v220, v221
    v_mfma_f32_16x16x32_bf16 v[224:227], a[248:251], v[192:195], 0
    v_cvt_pk_bf16_f32 v221, v222, v223
    v_cvt_pk_bf16_f32 v186, v206, v207
    v_mfma_f32_16x16x32_bf16 v[224:227], a[248:251], v[180:183], v[224:227]
    ds_write_b64 v247, v[220:221] offset:12544
    v_mfma_f32_16x16x32_bf16 v[220:223], v[72:75], v[192:195], 0
    ds_read_b128 v[204:207], v245 offset:128
    ds_read_b128 v[196:199], v244 offset:32
    v_mfma_f32_16x16x32_bf16 v[220:223], v[76:79], v[180:183], v[220:223]
    v_exp_f32 v200, v200
    v_mfma_f32_16x16x32_bf16 v[212:215], v[20:23], v[184:187], v[212:215]
    v_exp_f32 v201, v201
    v_mfma_f32_16x16x32_bf16 v[216:219], v[50:53], v[184:187], v[216:219]
    v_cvt_pk_bf16_f32 v189, v200, v201
    v_mfma_f32_16x16x32_bf16 v[220:223], v[80:83], v[184:187], v[220:223]
    ds_read_b128 v[200:203], v245 offset:32
    v_mfma_f32_16x16x32_bf16 v[224:227], a[248:251], v[184:187], v[224:227]
    v_mfma_f32_16x16x32_bf16 v[232:235], a[184:187], a[232:235], v[232:235]
    v_mfma_f32_16x16x32_bf16 v[232:235], a[188:191], a[236:239], v[232:235]
    v_mfma_f32_16x16x32_bf16 v[236:239], a[192:195], a[216:219], 0
    ds_read_b128 a[216:219], v242 offset:1664
    v_mfma_f32_16x16x32_bf16 v[236:239], a[196:199], a[220:223], v[236:239]
    ds_read_b128 a[220:223], v243 offset:1664
    v_mfma_f32_16x16x32_bf16 v[236:239], a[200:203], a[224:227], v[236:239]
    ds_read_b128 a[224:227], v242 offset:1792
    v_add_u32 v242, 0x7800, v242
    v_mfma_f32_16x16x32_bf16 v[236:239], a[204:207], a[228:231], v[236:239]
    s_waitcnt lgkmcnt(4)
    v_mul_f32 v232, s3, v232
    v_mul_f32 v233, s3, v233
    v_mfma_f32_16x16x32_bf16 v[204:207], v[108:111], v[168:171], v[204:207]
    v_mul_f32 v234, s3, v234
    v_mul_f32 v235, s3, v235
    v_mfma_f32_16x16x32_bf16 v[204:207], v[110:113], v[170:173], v[204:207]
    ds_read_b128 a[228:231], v243 offset:1792
    v_cvt_pk_bf16_f32 v232, v232, v233
    v_mfma_f32_16x16x32_bf16 v[196:199], v[132:135], v[174:177], v[196:199]
    s_waitcnt lgkmcnt(4)
    v_cvt_pk_bf16_f32 v233, v234, v235
    v_add_u32 v243, 0x4200, v243
    v_mfma_f32_16x16x32_bf16 v[196:199], v[134:137], v[176:179], v[196:199]
    ds_write_b64 v247, v[232:233] offset:43136
    v_mfma_f32_16x16x32_bf16 v[200:203], v[102:105], v[174:177], v[200:203]
    v_cndmask_b32 v242, v242, v243, vcc
    s_mov_b32 vcc_lo, 0xf0f0f0f0
    v_mfma_f32_16x16x32_bf16 v[200:203], v[104:107], v[176:179], v[200:203]
    s_mov_b32 vcc_hi, 0xf0f0f0f0
    v_add_u32 v243, 0xfffe2000, v242
    v_cndmask_b32 v242, v242, v243, vcc
    v_mfma_f32_16x16x32_bf16 v[236:239], a[208:211], a[232:235], v[236:239]
    ds_read_b128 a[232:235], v242 offset:0
    v_xor_b32 v243, 64, v242
    v_mfma_f32_16x16x32_bf16 v[236:239], a[212:215], a[236:239], v[236:239]
    ds_read_b128 a[236:239], v243 offset:0
    s_mov_b32 vcc_lo, 0xcccccccc
    v_mfma_f32_16x16x32_bf16 v[228:231], a[144:147], a[240:243], 0
    s_mov_b32 vcc_hi, 0xcccccccc
    v_exp_f32 v204, v204
    v_mfma_f32_16x16x32_bf16 v[228:231], a[148:151], a[244:247], v[228:231]
    s_waitcnt lgkmcnt(6)
    v_exp_f32 v205, v205
    v_mfma_f32_16x16x32_bf16 v[228:231], a[152:155], a[216:219], v[228:231]
    s_waitcnt lgkmcnt(5)
    v_mul_f32 v236, s38, v236
    v_mul_f32 v237, s38, v237
    v_mfma_f32_16x16x32_bf16 v[228:231], a[156:159], a[220:223], v[228:231]
    s_waitcnt lgkmcnt(4)
    v_mul_f32 v238, s38, v238
    v_mul_f32 v239, s38, v239
    v_mfma_f32_16x16x32_bf16 v[228:231], a[160:163], a[224:227], v[228:231]
    s_waitcnt lgkmcnt(3)
    v_cvt_pk_bf16_f32 v236, v236, v237
    v_cvt_pk_bf16_f32 v237, v238, v239
    v_mfma_f32_16x16x32_bf16 v[228:231], a[164:167], a[228:231], v[228:231]
    ds_write_b64 v247, v[236:237] offset:43264
    v_mfma_f32_16x16x32_bf16 v[232:235], a[168:171], a[240:243], 0
    v_exp_f32 v196, v196
    v_mfma_f32_16x16x32_bf16 v[232:235], a[172:175], a[244:247], v[232:235]
    v_exp_f32 v197, v197
    v_mfma_f32_16x16x32_bf16 v[232:235], a[176:179], a[216:219], v[232:235]
    s_waitcnt lgkmcnt(2)
    v_cvt_pk_bf16_f32 v190, v204, v205
    v_mul_f32 v228, s38, v228
    v_mfma_f32_16x16x32_bf16 v[232:235], a[180:183], a[220:223], v[232:235]
    s_waitcnt lgkmcnt(1)
    v_mul_f32 v229, s38, v229
    v_mul_f32 v230, s38, v230
    v_mfma_f32_16x16x32_bf16 v[232:235], a[184:187], a[224:227], v[232:235]
    v_mul_f32 v231, s38, v231
    v_cvt_pk_bf16_f32 v228, v228, v229
    v_mfma_f32_16x16x32_bf16 v[232:235], a[188:191], a[228:231], v[232:235]
    ds_read_b128 v[204:207], v246 offset:32
    v_cvt_pk_bf16_f32 v229, v230, v231
    v_mfma_f32_16x16x32_bf16 v[236:239], a[192:195], a[240:243], 0
    ds_read_b128 a[240:243], v242 offset:128
    v_cvt_pk_bf16_f32 v193, v196, v197
    v_mfma_f32_16x16x32_bf16 v[236:239], a[196:199], a[244:247], v[236:239]
    ds_read_b128 a[244:247], v243 offset:128
    v_mfma_f32_16x16x32_bf16 v[236:239], a[200:203], a[216:219], v[236:239]
    ds_read_b128 a[216:219], v242 offset:256
    v_mul_f32 v232, s3, v232
    v_mfma_f32_16x16x32_bf16 v[236:239], a[204:207], a[220:223], v[236:239]
    ds_read_b128 a[220:223], v243 offset:256
    v_mul_f32 v233, s3, v233
    v_mfma_f32_16x16x32_bf16 v[236:239], a[208:211], a[224:227], v[236:239]
    ds_write_b64 v247, v[228:229] offset:30720
    v_mfma_f32_16x16x32_bf16 v[236:239], a[212:215], a[228:231], v[236:239]
    v_mul_f32 v234, s3, v234
    v_mul_f32 v235, s3, v235
    v_mfma_f32_16x16x32_bf16 v[228:231], a[144:147], a[232:235], 0
    ds_read_b128 a[224:227], v240 offset:36864
    v_cvt_pk_bf16_f32 v232, v232, v233
    v_mfma_f32_16x16x32_bf16 v[228:231], a[148:151], a[236:239], v[228:231]
    s_waitcnt lgkmcnt(6)
    v_cvt_pk_bf16_f32 v233, v234, v235
    v_mul_f32 v236, s38, v236
    v_mfma_f32_16x16x32_bf16 v[204:207], v[114:117], v[174:177], v[204:207]
    s_waitcnt lgkmcnt(5)
    ds_read_b128 a[228:231], v241 offset:36864
    v_mfma_f32_16x16x32_bf16 v[204:207], v[116:119], v[176:179], v[204:207]
    ds_write_b64 v247, v[232:233] offset:30848
    v_mfma_f32_16x16x32_bf16 v[228:231], a[152:155], a[240:243], v[228:231]
    s_waitcnt lgkmcnt(6)
    v_mul_f32 v237, s38, v237
    v_mul_f32 v238, s38, v238
    v_mfma_f32_16x16x32_bf16 v[228:231], a[156:159], a[244:247], v[228:231]
    s_waitcnt lgkmcnt(5)
    v_mul_f32 v239, s38, v239
    v_cvt_pk_bf16_f32 v236, v236, v237
    v_mfma_f32_16x16x32_bf16 v[228:231], a[160:163], a[216:219], v[228:231]
    s_waitcnt lgkmcnt(4)
    v_cvt_pk_bf16_f32 v237, v238, v239
    v_mfma_f32_16x16x32_bf16 v[228:231], a[164:167], a[220:223], v[228:231]
    ds_write_b64 v247, v[236:237] offset:30976
    v_mfma_f32_16x16x32_bf16 v[232:235], a[168:171], a[232:235], 0
    v_exp_f32 v198, v198
    v_mfma_f32_16x16x32_bf16 v[232:235], a[172:175], a[236:239], v[232:235]
    s_waitcnt lgkmcnt(3)
    v_exp_f32 v199, v199
    v_mfma_f32_16x16x32_bf16 v[232:235], a[176:179], a[240:243], v[232:235]
    v_exp_f32 v200, v200
    v_mfma_f32_16x16x32_bf16 v[232:235], a[180:183], a[244:247], v[232:235]
    v_mul_f32 v228, s38, v228
    v_mul_f32 v229, s38, v229
    v_mfma_f32_16x16x32_bf16 v[232:235], a[184:187], a[216:219], v[232:235]
    s_waitcnt lgkmcnt(2)
    v_mul_f32 v230, s38, v230
    v_mul_f32 v231, s38, v231
    v_mfma_f32_16x16x32_bf16 v[232:235], a[188:191], a[220:223], v[232:235]
    v_cvt_pk_bf16_f32 v228, v228, v229
    v_cvt_pk_bf16_f32 v229, v230, v231
    v_mfma_f32_16x16x32_bf16 v[236:239], a[192:195], a[232:235], 0
    ds_read_b128 a[232:235], v240 offset:36992
    v_cvt_pk_bf16_f32 v180, v198, v199
    v_mfma_f32_16x16x32_bf16 v[236:239], a[196:199], a[236:239], v[236:239]
    ds_read_b128 a[236:239], v241 offset:36992
    ds_read_b128 v[196:199], v245 offset:96
    v_mfma_f32_16x16x32_bf16 v[236:239], a[200:203], a[240:243], v[236:239]
    ds_read_b128 a[240:243], v240 offset:37120
    v_mul_f32 v232, s3, v232
    v_mfma_f32_16x16x32_bf16 v[236:239], a[204:207], a[244:247], v[236:239]
    ds_read_b128 a[244:247], v241 offset:37120
    v_mul_f32 v233, s3, v233
    v_mfma_f32_16x16x32_bf16 v[236:239], a[208:211], a[216:219], v[236:239]
    ds_write_b64 v247, v[228:229] offset:49152
    v_mfma_f32_16x16x32_bf16 v[236:239], a[212:215], a[220:223], v[236:239]
    v_mul_f32 v234, s3, v234
    v_mul_f32 v235, s3, v235
    v_mfma_f32_16x16x32_bf16 v[228:231], a[0:3], a[224:227], 0
    ds_read_b128 a[216:219], v242 offset:3072
    v_cvt_pk_bf16_f32 v232, v232, v233
    v_mfma_f32_16x16x32_bf16 v[228:231], a[4:7], a[228:231], v[228:231]
    ds_read_b128 a[220:223], v243 offset:3072
    v_cvt_pk_bf16_f32 v233, v234, v235
    s_waitcnt lgkmcnt(7)
    v_mfma_f32_16x16x32_bf16 v[228:231], a[8:11], a[232:235], v[228:231]
    ds_write_b64 v247, v[232:233] offset:49280
    v_mfma_f32_16x16x32_bf16 v[232:235], a[24:27], a[224:227], 0
    s_waitcnt lgkmcnt(7)
    v_mul_f32 v236, s38, v236
    v_mul_f32 v237, s38, v237
    v_mfma_f32_16x16x32_bf16 v[228:231], a[12:15], a[236:239], v[228:231]
    v_mul_f32 v238, s38, v238
    s_waitcnt lgkmcnt(5)
    v_mfma_f32_16x16x32_bf16 v[196:199], v[108:111], v[174:177], v[196:199]
    v_mul_f32 v239, s38, v239
    v_cvt_pk_bf16_f32 v236, v236, v237
    v_mfma_f32_16x16x32_bf16 v[196:199], v[110:113], v[176:179], v[196:199]
    v_cvt_pk_bf16_f32 v237, v238, v239
    v_add_u32 v240, 0xffff1000, v240
    v_mfma_f32_16x16x32_bf16 v[228:231], a[16:19], a[240:243], v[228:231]
    s_waitcnt lgkmcnt(4)
    v_exp_f32 v201, v201
    v_mfma_f32_16x16x32_bf16 v[228:231], a[20:23], a[244:247], v[228:231]
    ds_write_b64 v247, v[236:237] offset:49408
    v_mfma_f32_16x16x32_bf16 v[232:235], a[28:31], a[228:231], v[232:235]
    s_waitcnt lgkmcnt(3)
    v_add_u32 v241, 0xffff1000, v241
    v_cvt_pk_bf16_f32 v194, v200, v201
    v_mfma_f32_16x16x32_bf16 v[232:235], a[32:35], a[232:235], v[232:235]
    s_waitcnt lgkmcnt(2)
    v_exp_f32 v202, v202
    v_mfma_f32_16x16x32_bf16 v[232:235], a[36:39], a[236:239], v[232:235]
    v_cvt_pk_bf16_f32 v120, v228, v229
    v_cvt_pk_bf16_f32 v121, v230, v231
    v_mfma_f32_16x16x32_bf16 v[232:235], a[40:43], a[240:243], v[232:235]
    v_exp_f32 v203, v203
    v_mfma_f32_16x16x32_bf16 v[232:235], a[44:47], a[244:247], v[232:235]
    v_exp_f32 v204, v204
    v_mfma_f32_16x16x32_bf16 v[236:239], a[48:51], a[224:227], 0
    v_exp_f32 v205, v205
    v_mfma_f32_16x16x32_bf16 v[236:239], a[52:55], a[228:231], v[236:239]
    v_cvt_pk_bf16_f32 v181, v202, v203
    v_cvt_pk_bf16_f32 v192, v204, v205
    v_mfma_f32_16x16x32_bf16 v[236:239], a[56:59], a[232:235], v[236:239]
    ds_read_b128 v[200:203], v246 offset:96
    v_cvt_pk_bf16_f32 v122, v232, v233
    v_mfma_f32_16x16x32_bf16 v[236:239], a[60:63], a[236:239], v[236:239]
    v_cvt_pk_bf16_f32 v123, v234, v235
    v_mfma_f32_16x16x32_bf16 v[236:239], a[64:67], a[240:243], v[236:239]
    v_exp_f32 v206, v206
    v_mfma_f32_16x16x32_bf16 v[208:211], v[120:123], v[168:171], v[208:211]
    v_exp_f32 v207, v207
    v_mfma_f32_16x16x32_bf16 v[236:239], a[68:71], a[244:247], v[236:239]
    ds_read_b64 v[168:169], v247 offset:24576
    v_cvt_pk_bf16_f32 v195, v206, v207
    v_mfma_f32_16x16x32_bf16 v[228:231], a[224:227], a[72:75], 0
    ds_read_b128 v[204:207], v244 offset:192
    v_mfma_f32_16x16x32_bf16 v[228:231], a[228:231], a[76:79], v[228:231]
L_h6:
    s_cbranch_execz L_hback
    v_exp_f32 v196, v196
    v_mfma_f32_16x16x32_bf16 v[228:231], a[232:235], a[80:83], v[228:231]
    v_exp_f32 v197, v197
    v_mfma_f32_16x16x32_bf16 v[228:231], a[236:239], a[84:87], v[228:231]
    v_cvt_pk_bf16_f32 v124, v236, v237
    v_cvt_pk_bf16_f32 v125, v238, v239
    v_mfma_f32_16x16x32_bf16 v[228:231], a[240:243], a[88:91], v[228:231]
    v_exp_f32 v198, v198
    v_mfma_f32_16x16x32_bf16 v[208:211], v[122:125], v[170:173], v[208:211]
    ds_read_b64 v[170:171], v247 offset:24704
    v_cvt_pk_bf16_f32 v184, v196, v197
    v_mfma_f32_16x16x32_bf16 v[228:231], a[244:247], a[92:95], v[228:231]
    ds_read_b64 v[172:173], v247 offset:24832
    v_mfma_f32_16x16x32_bf16 v[232:235], a[224:227], a[96:99], 0
    s_waitcnt lgkmcnt(4)
    v_exp_f32 v199, v199
    v_mfma_f32_16x16x32_bf16 v[200:203], v[120:123], v[174:177], v[200:203]
    v_exp_f32 v208, v208
    v_mfma_f32_16x16x32_bf16 v[200:203], v[122:125], v[176:179], v[200:203]
    s_waitcnt lgkmcnt(3)
    v_cvt_pk_bf16_f32 v24, v228, v229
    v_mbcnt_lo_u32_b32 v228, -1, 0
    v_mfma_f32_16x16x32_bf16 v[232:235], a[228:231], a[100:103], v[232:235]
    s_waitcnt lgkmcnt(2)
    v_mbcnt_hi_u32_b32 v228, -1, v228
    v_lshrrev_b32 v229, 1, v228
    v_mfma_f32_16x16x32_bf16 v[232:235], a[232:235], a[104:107], v[232:235]
    v_cvt_pk_bf16_f32 v27, v230, v231
    v_add_u32 v229, 64, v229
    v_mfma_f32_16x16x32_bf16 v[232:235], a[236:239], a[108:111], v[232:235]
    v_mul_u32_u24 v230, 43, v229
    v_lshrrev_b32 v231, 8, v230
    v_mfma_f32_16x16x32_bf16 v[232:235], a[240:243], a[112:115], v[232:235]
    v_lshrrev_b32 v230, 7, v230
    v_mad_i32_i24 v229, v230, -3, v229
    v_mfma_f32_16x16x32_bf16 v[232:235], a[244:247], a[116:119], v[232:235]
    v_and_b32 v231, 4, v231
    v_xor_b32 v230, v230, v231
    v_mfma_f32_16x16x32_bf16 v[236:239], a[224:227], a[120:123], 0
    ds_read_b128 a[224:227], v242 offset:3200
    v_and_b32 v231, 4, v230
    v_mfma_f32_16x16x32_bf16 v[236:239], a[228:231], a[124:127], v[236:239]
    ds_read_b128 a[228:231], v243 offset:3200
    v_mul_u32_u24 v251, 24, v231
    v_mfma_f32_16x16x32_bf16 v[236:239], a[232:235], a[128:131], v[236:239]
    ds_read_b128 a[232:235], v242 offset:3328
    v_cvt_pk_bf16_f32 v54, v232, v233
    v_mfma_f32_16x16x32_bf16 v[236:239], a[236:239], a[132:135], v[236:239]
    ds_read_b128 a[236:239], v243 offset:3328
    v_cvt_pk_bf16_f32 v57, v234, v235
    v_mfma_f32_16x16x32_bf16 v[236:239], a[240:243], a[136:139], v[236:239]
    ds_read_b128 a[240:243], v240 offset:1536
    v_lshrrev_b32 v231, 3, v230
    v_mfma_f32_16x16x32_bf16 v[236:239], a[244:247], a[140:143], v[236:239]
    ds_read_b128 a[244:247], v241 offset:1536
    v_lshl_add_u32 v251, v231, 2, v251
    v_mfma_f32_16x16x32_bf16 v[232:235], a[144:147], a[216:219], 0
    s_waitcnt lgkmcnt(6)
    v_and_or_b32 v251, v230, 3, v251
    v_mad_u32_u24 v251, v251, 3, v229
    v_mfma_f32_16x16x32_bf16 v[204:207], v[150:153], v[168:171], v[204:207]
    v_and_b32 v231, 1, v228
    v_lshl_add_u32 v251, v251, 3, v231
    v_mfma_f32_16x16x32_bf16 v[204:207], v[152:155], v[170:173], v[204:207]
    v_cvt_pk_bf16_f32 v84, v236, v237
    v_cvt_pk_bf16_f32 v87, v238, v239
    v_mfma_f32_16x16x32_bf16 v[232:235], a[148:151], a[220:223], v[232:235]
    s_waitcnt lgkmcnt(5)
    v_exp_f32 v209, v209
    v_mfma_f32_16x16x32_bf16 v[232:235], a[152:155], a[224:227], v[232:235]
    s_waitcnt lgkmcnt(4)
    v_cvt_pk_bf16_f32 v188, v208, v209
    v_lshlrev_b32 v251, 4, v251
    v_mfma_f32_16x16x32_bf16 v[232:235], a[156:159], a[228:231], v[232:235]
    ds_read_b128 v[208:211], v244 offset:96
    s_waitcnt lgkmcnt(3)
    v_mfma_f32_16x16x32_bf16 v[212:215], v[24:27], v[188:191], v[212:215]
    s_barrier
    v_mfma_f32_16x16x32_bf16 v[216:219], v[54:57], v[188:191], v[216:219]
    buffer_load_dwordx4 v252, s[12:15], s62 offen lds
    v_add_u32 v251, 0xfffff800, v251
    v_mfma_f32_16x16x32_bf16 v[220:223], v[84:87], v[188:191], v[220:223]
    s_waitcnt lgkmcnt(1)
    v_exp_f32 v200, v200
    v_mfma_f32_16x16x32_bf16 v[224:227], a[248:251], v[188:191], v[224:227]
    v_exp_f32 v201, v201
    v_mfma_f32_16x16x32_bf16 v[232:235], a[160:163], a[232:235], v[232:235]
    v_cvt_pk_bf16_f32 v187, v198, v199
    v_cvt_pk_bf16_f32 v182, v200, v201
    v_mfma_f32_16x16x32_bf16 v[232:235], a[164:167], a[236:239], v[232:235]
    buffer_load_dwordx4 v253, s[12:15], s62 offen offset:1024 lds
    ds_read_b128 v[196:199], v246 offset:192
    v_mfma_f32_16x16x32_bf16 v[236:239], a[168:171], a[216:219], 0
    s_waitcnt lgkmcnt(1)
    v_rcp_f32 v225, v224
    v_mfma_f32_16x16x32_bf16 v[208:211], v[144:147], v[174:177], v[208:211]
    v_mul_f32 v212, v212, v225
    v_mul_f32 v213, v213, v225
    v_mfma_f32_16x16x32_bf16 v[208:211], v[146:149], v[176:179], v[208:211]
    v_mul_f32 v232, s38, v232
    v_mul_f32 v233, s38, v233
    v_mfma_f32_16x16x32_bf16 v[236:239], a[172:175], a[220:223], v[236:239]
    buffer_load_dwordx4 v251, s[12:15], s62 offen offset:2048 lds
    s_add_u32 m0, s46, 0x17400
    v_mfma_f32_16x16x32_bf16 v[236:239], a[176:179], a[224:227], v[236:239]
    s_lshl_b32 s62, s28, 5
    v_mul_f32 v234, s38, v234
    v_mul_f32 v235, s38, v235
    v_mfma_f32_16x16x32_bf16 v[236:239], a[180:183], a[228:231], v[236:239]
    s_add_u32 s62, s62, 0x3000
    v_cvt_pk_bf16_f32 v232, v232, v233
    v_cvt_pk_bf16_f32 v233, v234, v235
    v_mfma_f32_16x16x32_bf16 v[236:239], a[184:187], a[232:235], v[236:239]
    ds_write_b64 v247, v[232:233] offset:55296
    v_mfma_f32_16x16x32_bf16 v[236:239], a[188:191], a[236:239], v[236:239]
    buffer_load_dwordx4 v252, s[12:15], s63 offen lds
    v_mul_f32 v214, v214, v225
    v_mfma_f32_16x16x32_bf16 v[228:231], a[192:195], a[216:219], 0
    ds_read_b128 a[216:219], v240 offset:1664
    v_mul_f32 v215, v215, v225
    v_mfma_f32_16x16x32_bf16 v[228:231], a[196:199], a[220:223], v[228:231]
    ds_read_b128 a[220:223], v241 offset:1664
    v_cvt_pk_bf16_f32 v212, v212, v213
    v_mfma_f32_16x16x32_bf16 v[228:231], a[200:203], a[224:227], v[228:231]
    ds_read_b128 a[224:227], v240 offset:1792
    v_mul_f32 v236, s3, v236
    v_mfma_f32_16x16x32_bf16 v[228:231], a[204:207], a[228:231], v[228:231]
    buffer_load_dwordx4 v253, s[12:15], s63 offen offset:1024 lds
    v_mul_f32 v237, s3, v237
    v_mfma_f32_16x16x32_bf16 v[228:231], a[208:211], a[232:235], v[228:231]
    s_waitcnt lgkmcnt(4)
    v_mul_f32 v238, s3, v238
    v_mul_f32 v239, s3, v239
    v_mfma_f32_16x16x32_bf16 v[228:231], a[212:215], a[236:239], v[228:231]
    ds_read_b128 a[228:231], v241 offset:1792
    v_cvt_pk_bf16_f32 v236, v236, v237
    v_mfma_f32_16x16x32_bf16 v[232:235], a[0:3], a[240:243], 0
    ds_read_b128 a[232:235], v240 offset:0
    v_cvt_pk_bf16_f32 v237, v238, v239
    v_mfma_f32_16x16x32_bf16 v[232:235], a[4:7], a[244:247], v[232:235]
    buffer_load_dwordx4 v251, s[12:15], s63 offen offset:2048 lds
    ds_write_b64 v247, v[236:237] offset:55424
    v_mfma_f32_16x16x32_bf16 v[236:239], a[24:27], a[240:243], 0
    s_waitcnt lgkmcnt(5)
    v_mul_f32 v228, s38, v228
    v_mul_f32 v229, s38, v229
    v_mfma_f32_16x16x32_bf16 v[232:235], a[8:11], a[216:219], v[232:235]
    s_waitcnt lgkmcnt(4)
    v_mul_f32 v230, s38, v230
    v_mul_f32 v231, s38, v231
    v_mfma_f32_16x16x32_bf16 v[232:235], a[12:15], a[220:223], v[232:235]
    s_waitcnt lgkmcnt(3)
    v_cvt_pk_bf16_f32 v228, v228, v229
    v_cvt_pk_bf16_f32 v229, v230, v231
    v_mfma_f32_16x16x32_bf16 v[232:235], a[16:19], a[224:227], v[232:235]
    ds_write_b64 v247, v[228:229] offset:55552
    v_mfma_f32_16x16x32_bf16 v[236:239], a[28:31], a[244:247], v[236:239]
    ds_read_b128 a[236:239], v241 offset:0
    s_waitcnt lgkmcnt(4)
    v_mfma_f32_16x16x32_bf16 v[232:235], a[20:23], a[228:231], v[232:235]
    s_add_u32 m0, s46, 0x16800
    v_cvt_pk_bf16_f32 v213, v214, v215
    v_mul_f32 v216, v216, v225
    v_mfma_f32_16x16x32_bf16 v[236:239], a[32:35], a[216:219], v[236:239]
    ds_write_b64 v247, v[212:213] offset:18432
    v_mfma_f32_16x16x32_bf16 v[212:215], v[18:21], v[192:195], 0
    s_lshl_b32 s63, s28, 5
    v_mul_f32 v217, v217, v225
    v_cvt_pk_bf16_f32 v126, v232, v233
    v_mfma_f32_16x16x32_bf16 v[236:239], a[36:39], a[220:223], v[236:239]
    s_add_u32 s63, s63, 0x7800
    v_cvt_pk_bf16_f32 v127, v234, v235
    v_mul_f32 v218, v218, v225
    v_mfma_f32_16x16x32_bf16 v[236:239], a[40:43], a[224:227], v[236:239]
    s_waitcnt lgkmcnt(3)
    v_mul_f32 v219, v219, v225
    v_cvt_pk_bf16_f32 v216, v216, v217
    v_mfma_f32_16x16x32_bf16 v[236:239], a[44:47], a[228:231], v[236:239]
    v_cvt_pk_bf16_f32 v217, v218, v219
    v_mul_f32 v220, v220, v225
    v_mfma_f32_16x16x32_bf16 v[228:231], a[48:51], a[240:243], 0
    ds_write_b64 v247, v[216:217] offset:18560
    v_mfma_f32_16x16x32_bf16 v[216:219], v[48:51], v[192:195], 0
    v_mul_f32 v221, v221, v225
    v_mul_f32 v222, v222, v225
    v_mfma_f32_16x16x32_bf16 v[228:231], a[52:55], a[244:247], v[228:231]
    s_waitcnt lgkmcnt(2)
    v_cvt_pk_bf16_f32 v128, v236, v237
    v_cvt_pk_bf16_f32 v129, v238, v239
    v_mfma_f32_16x16x32_bf16 v[228:231], a[56:59], a[216:219], v[228:231]
    v_mul_f32 v223, v223, v225
    v_cvt_pk_bf16_f32 v220, v220, v221
    v_mfma_f32_16x16x32_bf16 v[228:231], a[60:63], a[220:223], v[228:231]
    v_cvt_pk_bf16_f32 v221, v222, v223
    v_max3_f32 v248, v248, v224, v225
    v_mfma_f32_16x16x32_bf16 v[224:227], a[248:251], v[192:195], 0
    ds_write_b64 v247, v[220:221] offset:18688
    v_mfma_f32_16x16x32_bf16 v[220:223], v[78:81], v[192:195], 0
    v_exp_f32 v208, v208
    v_mfma_f32_16x16x32_bf16 v[228:231], a[64:67], a[224:227], v[228:231]
    v_exp_f32 v209, v209
    v_mfma_f32_16x16x32_bf16 v[228:231], a[68:71], a[228:231], v[228:231]
    v_exp_f32 v210, v210
    v_mfma_f32_16x16x32_bf16 v[232:235], a[240:243], a[72:75], 0
    v_exp_f32 v211, v211
    v_mfma_f32_16x16x32_bf16 v[232:235], a[244:247], a[76:79], v[232:235]
    v_cvt_pk_bf16_f32 v183, v208, v209
    v_cvt_pk_bf16_f32 v186, v210, v211
    v_mfma_f32_16x16x32_bf16 v[232:235], a[216:219], a[80:83], v[232:235]
    ds_read_b128 v[208:211], v245 offset:192
    v_cvt_pk_bf16_f32 v130, v228, v229
    v_mfma_f32_16x16x32_bf16 v[212:215], v[22:25], v[180:183], v[212:215]
    ds_read_b64 v[174:175], v247 offset:30720
    v_cvt_pk_bf16_f32 v131, v230, v231
    v_mfma_f32_16x16x32_bf16 v[216:219], v[52:55], v[180:183], v[216:219]
    v_exp_f32 v202, v202
    v_mfma_f32_16x16x32_bf16 v[220:223], v[82:85], v[180:183], v[220:223]
    v_exp_f32 v203, v203
    v_mfma_f32_16x16x32_bf16 v[224:227], a[248:251], v[180:183], v[224:227]
    ds_read_b64 v[176:177], v247 offset:30848
    v_cvt_pk_bf16_f32 v185, v202, v203
    v_mfma_f32_16x16x32_bf16 v[232:235], a[220:223], a[84:87], v[232:235]
    ds_read_b128 v[200:203], v244 offset:256
    ds_read_b64 v[178:179], v247 offset:30976
    v_mfma_f32_16x16x32_bf16 v[212:215], v[26:29], v[184:187], v[212:215]
    v_exp_f32 v204, v204
    v_mfma_f32_16x16x32_bf16 v[216:219], v[56:59], v[184:187], v[216:219]
    v_exp_f32 v205, v205
    v_mfma_f32_16x16x32_bf16 v[220:223], v[86:89], v[184:187], v[220:223]
    v_exp_f32 v206, v206
    v_mfma_f32_16x16x32_bf16 v[224:227], a[248:251], v[184:187], v[224:227]
    v_exp_f32 v207, v207
    v_mfma_f32_16x16x32_bf16 v[232:235], a[224:227], a[88:91], v[232:235]
    s_waitcnt lgkmcnt(4)
    v_cvt_pk_bf16_f32 v190, v204, v205
    v_cvt_pk_bf16_f32 v193, v206, v207
    v_mfma_f32_16x16x32_bf16 v[208:211], v[96:99], v[168:171], v[208:211]
    ds_read_b128 v[204:207], v245 offset:256
    v_mov_b32 v187, 0
    v_mfma_f32_16x16x32_bf16 v[208:211], v[98:101], v[170:173], v[208:211]
    s_waitcnt lgkmcnt(4)
    v_rcp_f32 v225, v224
    v_mfma_f32_16x16x32_bf16 v[232:235], a[228:231], a[92:95], v[232:235]
    v_mul_f32 v212, v212, v225
    s_waitcnt vmcnt(3)
    v_mfma_f32_16x16x32_bf16 v[236:239], a[240:243], a[96:99], 0
    ds_read_b64_tr_b16 a[144:145], v249 offset:0
    ds_read_b64_tr_b16 a[146:147], v250 offset:0
    v_mfma_f32_16x16x32_bf16 v[236:239], a[244:247], a[100:103], v[236:239]
    ds_read_b64_tr_b16 a[168:169], v249 offset:32
    ds_read_b64_tr_b16 a[170:171], v250 offset:32
    v_mfma_f32_16x16x32_bf16 v[236:239], a[216:219], a[104:107], v[236:239]
    s_waitcnt lgkmcnt(5)
    v_cvt_pk_bf16_f32 v7, v232, v233
    v_cvt_pk_bf16_f32 v10, v234, v235
    v_mfma_f32_16x16x32_bf16 v[200:203], v[156:159], v[168:171], v[200:203]
    ds_read_b64_tr_b16 a[192:193], v249 offset:64
    ds_read_b64_tr_b16 a[194:195], v250 offset:64
    v_mfma_f32_16x16x32_bf16 v[200:203], v[158:161], v[170:173], v[200:203]
    v_exp_f32 v208, v208
    v_mfma_f32_16x16x32_bf16 v[236:239], a[220:223], a[108:111], v[236:239]
    v_exp_f32 v209, v209
    v_mfma_f32_16x16x32_bf16 v[236:239], a[224:227], a[112:115], v[236:239]
    s_waitcnt lgkmcnt(6)
    v_exp_f32 v210, v210
    v_mfma_f32_16x16x32_bf16 v[204:207], v[90:93], v[168:171], v[204:207]
    v_exp_f32 v211, v211
    v_mfma_f32_16x16x32_bf16 v[204:207], v[92:95], v[170:173], v[204:207]
    v_cvt_pk_bf16_f32 v188, v208, v209
    v_cvt_pk_bf16_f32 v191, v210, v211
    v_mfma_f32_16x16x32_bf16 v[236:239], a[228:231], a[116:119], v[236:239]
    ds_read_b128 v[208:211], v246 offset:256
    v_mul_f32 v213, v213, v225
    v_mfma_f32_16x16x32_bf16 v[228:231], a[240:243], a[120:123], 0
    ds_read_b128 a[240:243], v240 offset:128
    v_mov_b32 v226, 0x22e00
    v_mfma_f32_16x16x32_bf16 v[228:231], a[244:247], a[124:127], v[228:231]
    ds_read_b128 a[244:247], v241 offset:128
    s_waitcnt lgkmcnt(3)
    v_mfma_f32_16x16x32_bf16 v[228:231], a[216:219], a[128:131], v[228:231]
    ds_read_b128 a[216:219], v240 offset:256
    v_cvt_pk_bf16_f32 v37, v236, v237
    v_mfma_f32_16x16x32_bf16 v[228:231], a[220:223], a[132:135], v[228:231]
    ds_read_b128 a[220:223], v241 offset:256
    v_cvt_pk_bf16_f32 v40, v238, v239
    v_mfma_f32_16x16x32_bf16 v[228:231], a[224:227], a[136:139], v[228:231]
    buffer_load_dwordx4 v252, s[12:15], s60 offen lds
    s_waitcnt vmcnt(1)
    v_mfma_f32_16x16x32_bf16 v[228:231], a[228:231], a[140:143], v[228:231]
    ds_read_b64_tr_b16 a[148:149], v249 offset:3072
    ds_read_b64_tr_b16 a[150:151], v250 offset:3072
    v_mfma_f32_16x16x32_bf16 v[232:235], a[0:3], a[232:235], 0
    ds_read_b64_tr_b16 a[172:173], v249 offset:3104
    ds_read_b64_tr_b16 a[174:175], v250 offset:3104
    v_mfma_f32_16x16x32_bf16 v[232:235], a[4:7], a[236:239], v[232:235]
    ds_read_b64_tr_b16 a[196:197], v249 offset:3136
    ds_read_b64_tr_b16 a[198:199], v250 offset:3136
    v_mfma_f32_16x16x32_bf16 v[236:239], a[24:27], a[232:235], 0
    s_waitcnt lgkmcnt(9)
    buffer_load_dwordx4 v253, s[12:15], s60 offen offset:1024 lds
    v_mfma_f32_16x16x32_bf16 v[208:211], v[126:129], v[168:171], v[208:211]
    v_cvt_pk_bf16_f32 v67, v228, v229
    v_cvt_pk_bf16_f32 v70, v230, v231
    v_mfma_f32_16x16x32_bf16 v[208:211], v[128:131], v[170:173], v[208:211]
    ds_read_b128 a[224:227], v240 offset:3072
    v_mul_f32 v214, v214, v225
    v_mfma_f32_16x16x32_bf16 v[232:235], a[8:11], a[240:243], v[232:235]
    s_waitcnt lgkmcnt(9)
    v_mul_f32 v215, v215, v225
    v_cvt_pk_bf16_f32 v212, v212, v213
    v_mfma_f32_16x16x32_bf16 v[232:235], a[12:15], a[244:247], v[232:235]
    s_waitcnt lgkmcnt(8)
    buffer_load_dwordx4 v251, s[12:15], s60 offen offset:2048 lds
    v_mfma_f32_16x16x32_bf16 v[232:235], a[16:19], a[216:219], v[232:235]
    s_waitcnt lgkmcnt(7)
    s_add_u32 m0, s46, 0x17400
    v_cndmask_b32 v226, v226, v247, vcc
    v_mfma_f32_16x16x32_bf16 v[232:235], a[20:23], a[220:223], v[232:235]
    ds_read_b128 a[228:231], v241 offset:3072
    v_cvt_pk_bf16_f32 v213, v214, v215
    v_mfma_f32_16x16x32_bf16 v[236:239], a[28:31], a[236:239], v[236:239]
    ds_write_b64 v226, v[212:213] offset:0
    v_mfma_f32_16x16x32_bf16 v[236:239], a[32:35], a[240:243], v[236:239]
    s_waitcnt lgkmcnt(3)
    buffer_load_dwordx4 v252, s[12:15], s61 offen lds
    v_mfma_f32_16x16x32_bf16 v[236:239], a[36:39], a[244:247], v[236:239]
    s_mov_b32 vcc_lo, 0xff00fff0
    v_cvt_pk_bf16_f32 v132, v232, v233
    v_cvt_pk_bf16_f32 v133, v234, v235
    v_mfma_f32_16x16x32_bf16 v[236:239], a[40:43], a[216:219], v[236:239]
    s_mov_b32 vcc_hi, 0xf000
    v_mul_f32 v216, v216, v225
    v_mul_f32 v217, v217, v225
    v_mfma_f32_16x16x32_bf16 v[236:239], a[44:47], a[220:223], v[236:239]
    v_mul_f32 v218, v218, v225
    v_mul_f32 v219, v219, v225
    v_mfma_f32_16x16x32_bf16 v[228:231], a[48:51], a[232:235], 0
    buffer_load_dwordx4 v253, s[12:15], s61 offen offset:1024 lds
    v_cvt_pk_bf16_f32 v216, v216, v217
    v_mfma_f32_16x16x32_bf16 v[228:231], a[52:55], a[236:239], v[228:231]
    s_waitcnt lgkmcnt(2)
    v_cvt_pk_bf16_f32 v217, v218, v219
    v_cvt_pk_bf16_f32 v134, v236, v237
    v_mfma_f32_16x16x32_bf16 v[228:231], a[56:59], a[240:243], v[228:231]
    v_cvt_pk_bf16_f32 v135, v238, v239
    v_mul_f32 v220, v220, v225
    v_mfma_f32_16x16x32_bf16 v[228:231], a[60:63], a[244:247], v[228:231]
    ds_write_b64 v226, v[216:217] offset:128
    v_mfma_f32_16x16x32_bf16 v[196:199], v[132:135], v[168:171], v[196:199]
    buffer_load_dwordx4 v251, s[12:15], s61 offen offset:2048 lds
    v_mul_f32 v221, v221, v225
    v_mfma_f32_16x16x32_bf16 v[228:231], a[64:67], a[216:219], v[228:231]
    s_add_u32 m0, s46, 0x16800
    v_mul_f32 v222, v222, v225
    v_mul_f32 v223, v223, v225
    v_mfma_f32_16x16x32_bf16 v[228:231], a[68:71], a[220:223], v[228:231]
    s_waitcnt lgkmcnt(1)
    v_cvt_pk_bf16_f32 v220, v220, v221
    v_cvt_pk_bf16_f32 v221, v222, v223
    v_mfma_f32_16x16x32_bf16 v[232:235], a[232:235], a[72:75], 0
    ds_write_b64 v226, v[220:221] offset:256
    v_mfma_f32_16x16x32_bf16 v[232:235], a[236:239], a[76:79], v[232:235]
    v_exp_f32 v200, v200
    v_mfma_f32_16x16x32_bf16 v[232:235], a[240:243], a[80:83], v[232:235]
    v_cvt_pk_bf16_f32 v136, v228, v229
    v_cvt_pk_bf16_f32 v137, v230, v231
    v_mfma_f32_16x16x32_bf16 v[232:235], a[244:247], a[84:87], v[232:235]
    v_exp_f32 v201, v201
    v_mfma_f32_16x16x32_bf16 v[196:199], v[134:137], v[170:173], v[196:199]
    v_max3_f32 v248, v248, v224, v225
    v_cvt_pk_bf16_f32 v180, v200, v201
    v_mfma_f32_16x16x32_bf16 v[232:235], a[216:219], a[88:91], v[232:235]
    v_exp_f32 v202, v202
    v_mfma_f32_16x16x32_bf16 v[232:235], a[220:223], a[92:95], v[232:235]
    v_exp_f32 v203, v203
    v_mfma_f32_16x16x32_bf16 v[236:239], a[232:235], a[96:99], 0
    v_exp_f32 v204, v204
    v_mfma_f32_16x16x32_bf16 v[236:239], a[236:239], a[100:103], v[236:239]
    v_exp_f32 v196, v196
    v_mfma_f32_16x16x32_bf16 v[236:239], a[240:243], a[104:107], v[236:239]
    v_exp_f32 v197, v197
    v_mfma_f32_16x16x32_bf16 v[236:239], a[244:247], a[108:111], v[236:239]
    v_cvt_pk_bf16_f32 v1, v232, v233
    v_cvt_pk_bf16_f32 v4, v234, v235
    v_mfma_f32_16x16x32_bf16 v[236:239], a[216:219], a[112:115], v[236:239]
    v_cvt_pk_bf16_f32 v189, v196, v197
    v_cvt_pk_bf16_f32 v183, v202, v203
    v_mfma_f32_16x16x32_bf16 v[236:239], a[220:223], a[116:119], v[236:239]
    v_exp_f32 v198, v198
    v_mfma_f32_16x16x32_bf16 v[212:215], v[0:3], v[188:191], 0
    v_exp_f32 v199, v199
    v_mfma_f32_16x16x32_bf16 v[224:227], a[248:251], v[188:191], 0
    ds_read_b128 v[200:203], v245 offset:320
    v_cvt_pk_bf16_f32 v192, v198, v199
    v_mfma_f32_16x16x32_bf16 v[228:231], a[232:235], a[120:123], 0
    ds_read_b128 a[232:235], v240 offset:3200
    v_cvt_pk_bf16_f32 v31, v236, v237
    v_mfma_f32_16x16x32_bf16 v[228:231], a[236:239], a[124:127], v[228:231]
    ds_read_b128 a[236:239], v241 offset:3200
    v_cvt_pk_bf16_f32 v34, v238, v239
    v_mfma_f32_16x16x32_bf16 v[216:219], v[30:33], v[188:191], 0
    ds_read_b128 v[196:199], v244 offset:320
    v_mfma_f32_16x16x32_bf16 v[228:231], a[240:243], a[128:131], v[228:231]
    ds_read_b128 a[240:243], v240 offset:3328
    v_mfma_f32_16x16x32_bf16 v[228:231], a[244:247], a[132:135], v[228:231]
    ds_read_b128 a[244:247], v241 offset:3328
    v_mfma_f32_16x16x32_bf16 v[228:231], a[216:219], a[136:139], v[228:231]
    ds_read_b128 a[216:219], v240 offset:4608
    v_mfma_f32_16x16x32_bf16 v[228:231], a[220:223], a[140:143], v[228:231]
    ds_read_b128 a[220:223], v241 offset:4608
    v_mfma_f32_16x16x32_bf16 v[232:235], a[0:3], a[224:227], 0
    v_exp_f32 v205, v205
    v_mfma_f32_16x16x32_bf16 v[232:235], a[4:7], a[228:231], v[232:235]
    v_exp_f32 v208, v208
    v_mfma_f32_16x16x32_bf16 v[236:239], a[24:27], a[224:227], 0
    s_waitcnt lgkmcnt(6)
    v_exp_f32 v209, v209
    v_mfma_f32_16x16x32_bf16 v[200:203], v[138:141], v[168:171], v[200:203]
    v_cvt_pk_bf16_f32 v61, v228, v229
    v_cvt_pk_bf16_f32 v64, v230, v231
    v_mfma_f32_16x16x32_bf16 v[200:203], v[140:143], v[170:173], v[200:203]
    s_waitcnt lgkmcnt(5)
    v_cvt_pk_bf16_f32 v194, v204, v205
    v_cvt_pk_bf16_f32 v195, v208, v209
    v_mfma_f32_16x16x32_bf16 v[220:223], v[60:63], v[188:191], 0
    s_waitcnt lgkmcnt(4)
    v_exp_f32 v206, v206
    v_mfma_f32_16x16x32_bf16 v[212:215], v[4:7], v[192:195], v[212:215]
    s_waitcnt lgkmcnt(3)
    v_exp_f32 v207, v207
    v_mfma_f32_16x16x32_bf16 v[216:219], v[34:37], v[192:195], v[216:219]
    s_waitcnt lgkmcnt(2)
    v_exp_f32 v210, v210
    v_mfma_f32_16x16x32_bf16 v[220:223], v[64:67], v[192:195], v[220:223]
    s_waitcnt lgkmcnt(1)
    v_exp_f32 v211, v211
    v_mfma_f32_16x16x32_bf16 v[224:227], a[248:251], v[192:195], v[224:227]
    s_waitcnt lgkmcnt(0)
    v_cvt_pk_bf16_f32 v181, v206, v207
    v_cvt_pk_bf16_f32 v182, v210, v211
    v_mfma_f32_16x16x32_bf16 v[196:199], v[162:165], v[168:171], v[196:199]
    ds_read_b128 v[204:207], v246 offset:320
    ds_read_b128 v[208:211], v244 offset:0
    v_mfma_f32_16x16x32_bf16 v[212:215], v[8:11], v[180:183], v[212:215]
    v_exp_f32 v200, v200
    v_mfma_f32_16x16x32_bf16 v[216:219], v[38:41], v[180:183], v[216:219]
    v_exp_f32 v201, v201
    v_mfma_f32_16x16x32_bf16 v[220:223], v[68:71], v[180:183], v[220:223]
    s_waitcnt vmcnt(3)
    ds_read_b64_tr_b16 a[152:153], v249 offset:0
    v_mfma_f32_16x16x32_bf16 v[224:227], a[248:251], v[180:183], v[224:227]
    ds_read_b64_tr_b16 a[154:155], v250 offset:0
    ds_read_b64_tr_b16 a[176:177], v249 offset:32
    v_mfma_f32_16x16x32_bf16 v[196:199], v[164:167], v[170:173], v[196:199]
    ds_read_b64_tr_b16 a[178:179], v250 offset:32
    ds_read_b64_tr_b16 a[200:201], v249 offset:64
    v_mfma_f32_16x16x32_bf16 v[232:235], a[8:11], a[232:235], v[232:235]
    ds_read_b64_tr_b16 a[202:203], v250 offset:64
    v_cvt_pk_bf16_f32 v184, v200, v201
    v_mfma_f32_16x16x32_bf16 v[232:235], a[12:15], a[236:239], v[232:235]
    ds_read_b128 v[200:203], v246 offset:0
    v_mfma_f32_16x16x32_bf16 v[232:235], a[16:19], a[240:243], v[232:235]
    v_exp_f32 v196, v196
    v_mfma_f32_16x16x32_bf16 v[232:235], a[20:23], a[244:247], v[232:235]
    s_waitcnt lgkmcnt(8)
    v_exp_f32 v197, v197
    v_mfma_f32_16x16x32_bf16 v[236:239], a[28:31], a[228:231], v[236:239]
    s_waitcnt lgkmcnt(7)
    v_cvt_pk_bf16_f32 v186, v196, v197
    v_mfma_f32_16x16x32_bf16 v[208:211], v[156:159], v[174:177], v[208:211]
    ds_read_b128 v[196:199], v245 offset:0
    v_mfma_f32_16x16x32_bf16 v[208:211], v[158:161], v[176:179], v[208:211]
    v_cvt_pk_bf16_f32 v144, v232, v233
    v_cvt_pk_bf16_f32 v145, v234, v235
    v_mfma_f32_16x16x32_bf16 v[236:239], a[32:35], a[232:235], v[236:239]
    s_waitcnt lgkmcnt(6)
    v_mfma_f32_16x16x32_bf16 v[236:239], a[36:39], a[236:239], v[236:239]
    s_waitcnt lgkmcnt(5)
    s_waitcnt lgkmcnt(2)
    buffer_load_dwordx4 v252, s[12:15], s62 offen lds
    v_mfma_f32_16x16x32_bf16 v[236:239], a[40:43], a[240:243], v[236:239]
    s_waitcnt vmcnt(1)
    ds_read_b64_tr_b16 a[156:157], v249 offset:3072
    v_mfma_f32_16x16x32_bf16 v[236:239], a[44:47], a[244:247], v[236:239]
    ds_read_b64_tr_b16 a[158:159], v250 offset:3072
    ds_read_b64_tr_b16 a[180:181], v249 offset:3104
    v_mfma_f32_16x16x32_bf16 v[228:231], a[48:51], a[224:227], 0
    ds_read_b64_tr_b16 a[182:183], v250 offset:3104
    ds_read_b64_tr_b16 a[204:205], v249 offset:3136
    v_mfma_f32_16x16x32_bf16 v[228:231], a[52:55], a[228:231], v[228:231]
    ds_read_b64_tr_b16 a[206:207], v250 offset:3136
    buffer_load_dwordx4 v253, s[12:15], s62 offen offset:1024 lds
    v_mfma_f32_16x16x32_bf16 v[228:231], a[56:59], a[232:235], v[228:231]
    s_waitcnt lgkmcnt(7)
    v_cvt_pk_bf16_f32 v146, v236, v237
    v_cvt_pk_bf16_f32 v147, v238, v239
    v_mfma_f32_16x16x32_bf16 v[200:203], v[126:129], v[174:177], v[200:203]
    s_waitcnt lgkmcnt(6)
    v_exp_f32 v208, v208
    v_mfma_f32_16x16x32_bf16 v[204:207], v[144:147], v[168:171], v[204:207]
    v_exp_f32 v209, v209
    v_mfma_f32_16x16x32_bf16 v[196:199], v[90:93], v[174:177], v[196:199]
    buffer_load_dwordx4 v251, s[12:15], s62 offen offset:2048 lds
    s_add_u32 m0, s46, 0x17400
    v_mfma_f32_16x16x32_bf16 v[196:199], v[92:95], v[176:179], v[196:199]
    v_exp_f32 v210, v210
    v_mfma_f32_16x16x32_bf16 v[200:203], v[128:131], v[176:179], v[200:203]
    s_waitcnt lgkmcnt(5)
    v_exp_f32 v211, v211
    v_mfma_f32_16x16x32_bf16 v[228:231], a[60:63], a[236:239], v[228:231]
    s_waitcnt lgkmcnt(4)
    v_cvt_pk_bf16_f32 v190, v208, v209
    v_cvt_pk_bf16_f32 v193, v210, v211
    v_mfma_f32_16x16x32_bf16 v[228:231], a[64:67], a[240:243], v[228:231]
    s_waitcnt lgkmcnt(0)
    buffer_load_dwordx4 v252, s[12:15], s63 offen lds
    v_mfma_f32_16x16x32_bf16 v[228:231], a[68:71], a[244:247], v[228:231]
    ds_read_b128 v[208:211], v245 offset:64
    ds_read_b64 v[168:169], v247 offset:36864
    v_mfma_f32_16x16x32_bf16 v[232:235], a[224:227], a[72:75], 0
    v_exp_f32 v196, v196
    v_mfma_f32_16x16x32_bf16 v[232:235], a[228:231], a[76:79], v[232:235]
    v_exp_f32 v197, v197
    v_mfma_f32_16x16x32_bf16 v[232:235], a[232:235], a[80:83], v[232:235]
    buffer_load_dwordx4 v253, s[12:15], s63 offen offset:1024 lds
    v_cvt_pk_bf16_f32 v148, v228, v229
    v_mfma_f32_16x16x32_bf16 v[232:235], a[236:239], a[84:87], v[232:235]
    v_cvt_pk_bf16_f32 v149, v230, v231
    v_cvt_pk_bf16_f32 v188, v196, v197
    v_mfma_f32_16x16x32_bf16 v[232:235], a[240:243], a[88:91], v[232:235]
    v_exp_f32 v198, v198
    v_mfma_f32_16x16x32_bf16 v[204:207], v[146:149], v[170:173], v[204:207]
    v_exp_f32 v199, v199
    v_mfma_f32_16x16x32_bf16 v[232:235], a[244:247], a[92:95], v[232:235]
    buffer_load_dwordx4 v251, s[12:15], s63 offen offset:2048 lds
    v_cvt_pk_bf16_f32 v191, v198, v199
    v_mfma_f32_16x16x32_bf16 v[236:239], a[224:227], a[96:99], 0
    ds_read_b128 v[196:199], v246 offset:64
    ds_read_b64 v[170:171], v247 offset:36992
    v_mfma_f32_16x16x32_bf16 v[236:239], a[228:231], a[100:103], v[236:239]
    s_waitcnt lgkmcnt(3)
    v_exp_f32 v204, v204
    v_mfma_f32_16x16x32_bf16 v[208:211], v[138:141], v[174:177], v[208:211]
    s_waitcnt lgkmcnt(2)
    v_cvt_pk_bf16_f32 v13, v232, v233
    v_cvt_pk_bf16_f32 v16, v234, v235
    v_mfma_f32_16x16x32_bf16 v[208:211], v[140:143], v[176:179], v[208:211]
    v_exp_f32 v205, v205
    v_mfma_f32_16x16x32_bf16 v[236:239], a[232:235], a[104:107], v[236:239]
    ds_read_b64 v[172:173], v247 offset:37120
    v_cvt_pk_bf16_f32 v185, v204, v205
    v_mfma_f32_16x16x32_bf16 v[236:239], a[236:239], a[108:111], v[236:239]
    ds_read_b128 v[204:207], v244 offset:64
    v_mfma_f32_16x16x32_bf16 v[212:215], v[12:15], v[184:187], v[212:215]
    v_exp_f32 v200, v200
    v_mfma_f32_16x16x32_bf16 v[224:227], a[248:251], v[184:187], v[224:227]
    v_exp_f32 v201, v201
    v_mfma_f32_16x16x32_bf16 v[236:239], a[240:243], a[112:115], v[236:239]
    v_exp_f32 v202, v202
    v_mfma_f32_16x16x32_bf16 v[236:239], a[244:247], a[116:119], v[236:239]
    v_exp_f32 v203, v203
    v_mfma_f32_16x16x32_bf16 v[228:231], a[224:227], a[120:123], 0
    ds_read_b128 a[224:227], v240 offset:4736
    v_cvt_pk_bf16_f32 v189, v200, v201
    v_mfma_f32_16x16x32_bf16 v[228:231], a[228:231], a[124:127], v[228:231]
    ds_read_b128 a[228:231], v241 offset:4736
    v_cvt_pk_bf16_f32 v192, v202, v203
    v_mfma_f32_16x16x32_bf16 v[228:231], a[232:235], a[128:131], v[228:231]
    ds_read_b128 a[232:235], v240 offset:4864
    v_cvt_pk_bf16_f32 v43, v236, v237
    v_mfma_f32_16x16x32_bf16 v[228:231], a[236:239], a[132:135], v[228:231]
    ds_read_b128 a[236:239], v241 offset:4864
    v_cvt_pk_bf16_f32 v46, v238, v239
    v_mfma_f32_16x16x32_bf16 v[216:219], v[42:45], v[184:187], v[216:219]
    s_waitcnt lgkmcnt(6)
    v_rcp_f32 v225, v224
    v_mfma_f32_16x16x32_bf16 v[196:199], v[144:147], v[174:177], v[196:199]
    s_waitcnt lgkmcnt(4)
    v_mul_f32 v212, v212, v225
    v_mul_f32 v213, v213, v225
    v_mfma_f32_16x16x32_bf16 v[204:207], v[162:165], v[174:177], v[204:207]
    v_mul_f32 v214, v214, v225
    v_mul_f32 v215, v215, v225
    v_mfma_f32_16x16x32_bf16 v[204:207], v[164:167], v[176:179], v[204:207]
    ds_read_b128 v[200:203], v244 offset:128
    v_cvt_pk_bf16_f32 v212, v212, v213
    v_mfma_f32_16x16x32_bf16 v[196:199], v[146:149], v[176:179], v[196:199]
    v_cvt_pk_bf16_f32 v213, v214, v215
    v_mul_f32 v216, v216, v225
    v_mfma_f32_16x16x32_bf16 v[228:231], a[240:243], a[136:139], v[228:231]
    ds_write_b64 v247, v[212:213] offset:24576
    v_mfma_f32_16x16x32_bf16 v[212:215], v[6:9], v[188:191], 0
    s_waitcnt lgkmcnt(5)
L_h7:
    s_cbranch_execz L_hback
    v_mul_f32 v217, v217, v225
    v_mul_f32 v218, v218, v225
    v_mfma_f32_16x16x32_bf16 v[228:231], a[244:247], a[140:143], v[228:231]
    s_waitcnt lgkmcnt(4)
    v_mul_f32 v219, v219, v225
    v_cvt_pk_bf16_f32 v216, v216, v217
    v_mfma_f32_16x16x32_bf16 v[232:235], a[0:3], a[216:219], 0
    s_waitcnt lgkmcnt(3)
    v_cvt_pk_bf16_f32 v217, v218, v219
    v_max3_f32 v248, v248, v224, v225
    v_mfma_f32_16x16x32_bf16 v[232:235], a[4:7], a[220:223], v[232:235]
    s_waitcnt lgkmcnt(2)
    v_cvt_pk_bf16_f32 v73, v228, v229
    v_cvt_pk_bf16_f32 v76, v230, v231
    v_mfma_f32_16x16x32_bf16 v[232:235], a[8:11], a[224:227], v[232:235]
    ds_write_b64 v247, v[216:217] offset:24704
    v_mfma_f32_16x16x32_bf16 v[220:223], v[72:75], v[184:187], v[220:223]
    v_exp_f32 v204, v204
    v_mfma_f32_16x16x32_bf16 v[216:219], v[36:39], v[188:191], 0
    s_waitcnt lgkmcnt(2)
    v_exp_f32 v205, v205
    v_mfma_f32_16x16x32_bf16 v[200:203], v[102:105], v[174:177], v[200:203]
    v_exp_f32 v206, v206
    v_mfma_f32_16x16x32_bf16 v[200:203], v[104:107], v[176:179], v[200:203]
    v_exp_f32 v207, v207
    v_mfma_f32_16x16x32_bf16 v[232:235], a[12:15], a[228:231], v[232:235]
    v_mul_f32 v220, v220, v225
    v_mul_f32 v221, v221, v225
    v_mfma_f32_16x16x32_bf16 v[232:235], a[16:19], a[232:235], v[232:235]
    v_mul_f32 v222, v222, v225
    v_mul_f32 v223, v223, v225
    v_mfma_f32_16x16x32_bf16 v[224:227], a[248:251], v[188:191], 0
    v_cvt_pk_bf16_f32 v220, v220, v221
    v_cvt_pk_bf16_f32 v221, v222, v223
    v_mfma_f32_16x16x32_bf16 v[232:235], a[20:23], a[236:239], v[232:235]
    ds_write_b64 v247, v[220:221] offset:24832
    v_mfma_f32_16x16x32_bf16 v[220:223], v[66:69], v[188:191], 0
    v_cvt_pk_bf16_f32 v180, v204, v205
    v_cvt_pk_bf16_f32 v183, v206, v207
    v_mfma_f32_16x16x32_bf16 v[236:239], a[24:27], a[216:219], 0
    ds_read_b128 v[204:207], v245 offset:128
    v_mfma_f32_16x16x32_bf16 v[236:239], a[28:31], a[220:223], v[236:239]
    v_exp_f32 v208, v208
    v_mfma_f32_16x16x32_bf16 v[236:239], a[32:35], a[224:227], v[236:239]
    v_cvt_pk_bf16_f32 v150, v232, v233
    v_cvt_pk_bf16_f32 v151, v234, v235
    v_mfma_f32_16x16x32_bf16 v[236:239], a[36:39], a[228:231], v[236:239]
    v_exp_f32 v209, v209
    v_mfma_f32_16x16x32_bf16 v[236:239], a[40:43], a[232:235], v[236:239]
    v_exp_f32 v196, v196
    v_mfma_f32_16x16x32_bf16 v[236:239], a[44:47], a[236:239], v[236:239]
    v_exp_f32 v197, v197
    v_mfma_f32_16x16x32_bf16 v[228:231], a[48:51], a[216:219], 0
    v_cvt_pk_bf16_f32 v194, v208, v209
    v_cvt_pk_bf16_f32 v195, v196, v197
    v_mfma_f32_16x16x32_bf16 v[228:231], a[52:55], a[220:223], v[228:231]
    v_exp_f32 v210, v210
    v_mfma_f32_16x16x32_bf16 v[212:215], v[10:13], v[192:195], v[212:215]
    v_exp_f32 v211, v211
    v_mfma_f32_16x16x32_bf16 v[216:219], v[40:43], v[192:195], v[216:219]
    v_cvt_pk_bf16_f32 v152, v236, v237
    v_cvt_pk_bf16_f32 v153, v238, v239
    v_mfma_f32_16x16x32_bf16 v[220:223], v[70:73], v[192:195], v[220:223]
    s_waitcnt lgkmcnt(0)
    v_exp_f32 v198, v198
    v_mfma_f32_16x16x32_bf16 v[224:227], a[248:251], v[192:195], v[224:227]
    v_exp_f32 v199, v199
    v_mfma_f32_16x16x32_bf16 v[204:207], v[114:117], v[174:177], v[204:207]
    v_cvt_pk_bf16_f32 v181, v210, v211
    v_cvt_pk_bf16_f32 v182, v198, v199
    v_mfma_f32_16x16x32_bf16 v[204:207], v[116:119], v[176:179], v[204:207]
    ds_read_b128 v[208:211], v246 offset:128
    ds_read_b128 v[196:199], v244 offset:0
    v_mfma_f32_16x16x32_bf16 v[212:215], v[14:17], v[180:183], v[212:215]
    s_waitcnt vmcnt(3)
    ds_read_b64_tr_b16 a[160:161], v249 offset:0
    v_mfma_f32_16x16x32_bf16 v[216:219], v[44:47], v[180:183], v[216:219]
    ds_read_b64_tr_b16 a[162:163], v250 offset:0
    ds_read_b64_tr_b16 a[184:185], v249 offset:32
    v_mfma_f32_16x16x32_bf16 v[220:223], v[74:77], v[180:183], v[220:223]
    s_waitcnt vmcnt(0)
    ds_read_b64_tr_b16 a[164:165], v249 offset:3072
    v_mfma_f32_16x16x32_bf16 v[224:227], a[248:251], v[180:183], v[224:227]
    ds_read_b64_tr_b16 a[166:167], v250 offset:3072
    ds_read_b64_tr_b16 a[186:187], v250 offset:32
    v_mfma_f32_16x16x32_bf16 v[228:231], a[56:59], a[224:227], v[228:231]
    ds_read_b64_tr_b16 a[188:189], v249 offset:3104
    ds_read_b64_tr_b16 a[190:191], v250 offset:3104
    v_mfma_f32_16x16x32_bf16 v[228:231], a[60:63], a[228:231], v[228:231]
    ds_read_b64_tr_b16 a[208:209], v249 offset:64
    ds_read_b64_tr_b16 a[210:211], v250 offset:64
    v_mfma_f32_16x16x32_bf16 v[228:231], a[64:67], a[232:235], v[228:231]
    ds_read_b64_tr_b16 a[212:213], v249 offset:3136
    ds_read_b64_tr_b16 a[214:215], v250 offset:3136
    v_mfma_f32_16x16x32_bf16 v[228:231], a[68:71], a[236:239], v[228:231]
    s_waitcnt lgkmcnt(13)
    v_exp_f32 v200, v200
    v_mfma_f32_16x16x32_bf16 v[208:211], v[150:153], v[174:177], v[208:211]
    s_waitcnt lgkmcnt(12)
    v_exp_f32 v201, v201
    v_mfma_f32_16x16x32_bf16 v[196:199], v[162:165], v[168:171], v[196:199]
    ds_read_b64 v[174:175], v247 offset:43008
    v_cvt_pk_bf16_f32 v186, v200, v201
    v_mfma_f32_16x16x32_bf16 v[196:199], v[164:167], v[170:173], v[196:199]
    s_waitcnt lgkmcnt(10)
    v_cvt_pk_bf16_f32 v154, v228, v229
    v_cvt_pk_bf16_f32 v155, v230, v231
    v_mfma_f32_16x16x32_bf16 v[232:235], a[216:219], a[72:75], 0
    ds_read_b128 v[200:203], v245 offset:0
    v_mfma_f32_16x16x32_bf16 v[208:211], v[152:155], v[176:179], v[208:211]
    s_waitcnt lgkmcnt(8)
    v_exp_f32 v204, v204
    v_mfma_f32_16x16x32_bf16 v[232:235], a[220:223], a[76:79], v[232:235]
    s_waitcnt lgkmcnt(7)
    v_exp_f32 v205, v205
    v_mfma_f32_16x16x32_bf16 v[232:235], a[224:227], a[80:83], v[232:235]
    ds_read_b64 v[176:177], v247 offset:43136
    v_cvt_pk_bf16_f32 v184, v204, v205
    v_mfma_f32_16x16x32_bf16 v[232:235], a[228:231], a[84:87], v[232:235]
    s_waitcnt lgkmcnt(3)
    s_barrier
    v_mfma_f32_16x16x32_bf16 v[232:235], a[232:235], a[88:91], v[232:235]
    v_exp_f32 v208, v208
    v_mfma_f32_16x16x32_bf16 v[232:235], a[236:239], a[92:95], v[232:235]
    s_waitcnt lgkmcnt(2)
    v_exp_f32 v209, v209
    v_mfma_f32_16x16x32_bf16 v[236:239], a[216:219], a[96:99], 0
    ds_read_b128 v[204:207], v246 offset:0
    v_cvt_pk_bf16_f32 v185, v208, v209
    v_mfma_f32_16x16x32_bf16 v[236:239], a[220:223], a[100:103], v[236:239]
    ds_read_b128 v[208:211], v244 offset:64
    ds_read_b64 v[178:179], v247 offset:43264
    v_mfma_f32_16x16x32_bf16 v[224:227], a[248:251], v[184:187], v[224:227]
    s_waitcnt lgkmcnt(4)
    v_cvt_pk_bf16_f32 v19, v232, v233
    v_mbcnt_lo_u32_b32 v232, -1, 0
    v_mfma_f32_16x16x32_bf16 v[200:203], v[138:141], v[168:171], v[200:203]
    v_mbcnt_hi_u32_b32 v232, -1, v232
    v_cvt_pk_bf16_f32 v22, v234, v235
    v_mfma_f32_16x16x32_bf16 v[212:215], v[18:21], v[184:187], v[212:215]
    s_waitcnt lgkmcnt(3)
    v_and_b32 v233, 15, v232
    v_lshrrev_b32 v232, 4, v232
    v_mfma_f32_16x16x32_bf16 v[200:203], v[140:143], v[170:173], v[200:203]
    v_lshrrev_b32 v234, 1, v233
    v_mul_u32_u24 v235, 0x180, v233
    v_mfma_f32_16x16x32_bf16 v[236:239], a[224:227], a[104:107], v[236:239]
    v_xor_b32 v243, v232, v234
    v_lshl_add_u32 v242, v243, 4, v235
    v_mfma_f32_16x16x32_bf16 v[236:239], a[228:231], a[108:111], v[236:239]
    v_xor_b32 v243, 64, v242
    v_add_u32 v242, 0x1e000, v242
    v_mfma_f32_16x16x32_bf16 v[236:239], a[232:235], a[112:115], v[236:239]
    ds_read_b128 a[240:243], v242 offset:0
    v_add_u32 v243, 0x1e000, v243
    v_mfma_f32_16x16x32_bf16 v[236:239], a[236:239], a[116:119], v[236:239]
    ds_read_b128 a[244:247], v243 offset:0
    v_lshrrev_b32 v249, 1, v232
    v_mfma_f32_16x16x32_bf16 v[228:231], a[216:219], a[120:123], 0
    ds_read_b128 a[216:219], v242 offset:128
    v_or_b32 v249, s66, v249
    v_mfma_f32_16x16x32_bf16 v[228:231], a[220:223], a[124:127], v[228:231]
    ds_read_b128 a[220:223], v243 offset:128
    v_mov_b32 v253, v249
    v_mfma_f32_16x16x32_bf16 v[228:231], a[224:227], a[128:131], v[228:231]
    ds_read_b128 a[224:227], v242 offset:256
    v_cvt_pk_bf16_f32 v49, v236, v237
    v_mfma_f32_16x16x32_bf16 v[228:231], a[228:231], a[132:135], v[228:231]
    ds_read_b128 a[228:231], v243 offset:256
    v_cvt_pk_bf16_f32 v52, v238, v239
    v_mfma_f32_16x16x32_bf16 v[216:219], v[48:51], v[184:187], v[216:219]
    s_waitcnt lgkmcnt(7)
    v_xor_b32 v249, v249, v234
    v_lshl_add_u32 v249, v249, 4, v235
    v_mfma_f32_16x16x32_bf16 v[204:207], v[144:147], v[168:171], v[204:207]
    s_waitcnt lgkmcnt(6)
    v_and_b32 v235, 1, v232
    v_lshl_add_u32 v249, v235, 3, v249
    v_mfma_f32_16x16x32_bf16 v[204:207], v[146:149], v[170:173], v[204:207]
    v_lshlrev_b32 v235, 3, v235
    s_waitcnt lgkmcnt(5)
    v_mfma_f32_16x16x32_bf16 v[208:211], v[102:105], v[168:171], v[208:211]
    v_xor_b32 v250, s67, v232
    v_xor_b32 v252, v233, v235
    v_mfma_f32_16x16x32_bf16 v[208:211], v[104:107], v[170:173], v[208:211]
    s_mul_i32 s67, s28, 0x600
    v_xor_b32 v252, v252, v253
    v_mul_u32_u24 v250, 0x300, v250
    v_mfma_f32_16x16x32_bf16 v[228:231], a[232:235], a[136:139], v[228:231]
    ds_read_b128 a[232:235], v242 offset:12288
    s_add_u32 s67, s67, 0x16800
    v_mfma_f32_16x16x32_bf16 v[228:231], a[236:239], a[140:143], v[228:231]
    ds_read_b128 a[236:239], v243 offset:12288
    v_mul_u32_u24 v232, 0x180, v232
    v_mfma_f32_16x16x32_bf16 v[236:239], a[144:147], a[240:243], 0
    s_waitcnt lgkmcnt(6)
    v_xor_b32 v253, v253, v234
    v_add_u32 v249, 0x16800, v249
    v_mfma_f32_16x16x32_bf16 v[236:239], a[148:151], a[244:247], v[236:239]
    s_waitcnt lgkmcnt(5)
    v_cvt_pk_bf16_f32 v79, v228, v229
    v_cvt_pk_bf16_f32 v82, v230, v231
    v_mfma_f32_16x16x32_bf16 v[236:239], a[152:155], a[216:219], v[236:239]
    s_waitcnt lgkmcnt(4)
    v_add_u32 v232, s67, v232
    v_and_b32 v234, 1, v233
    v_mfma_f32_16x16x32_bf16 v[220:223], v[78:81], v[184:187], v[220:223]
    s_lshl2_add_u32 s67, s28, 0x23000
    v_lshl_add_u32 v251, v233, 3, v250
    v_lshl_add_u32 v253, v253, 4, v232
    v_mfma_f32_16x16x32_bf16 v[236:239], a[156:159], a[220:223], v[236:239]
    s_waitcnt lgkmcnt(3)
    v_xor_b32 v233, v233, v235
    v_lshl_add_u32 v252, v252, 4, v232
    v_mfma_f32_16x16x32_bf16 v[236:239], a[160:163], a[224:227], v[236:239]
    s_waitcnt lgkmcnt(2)
    v_lshl_add_u32 v253, v234, 3, v253
    v_lshl_add_u32 v250, v233, 4, v250
    v_mfma_f32_16x16x32_bf16 v[236:239], a[164:167], a[228:231], v[236:239]
    v_exp_f32 v196, v196
    v_mfma_f32_16x16x32_bf16 v[228:231], a[168:171], a[240:243], 0
    v_exp_f32 v197, v197
    v_mfma_f32_16x16x32_bf16 v[228:231], a[172:175], a[244:247], v[228:231]
    s_waitcnt lgkmcnt(1)
    v_exp_f32 v198, v198
    v_mfma_f32_16x16x32_bf16 v[228:231], a[176:179], a[216:219], v[228:231]
    s_waitcnt lgkmcnt(0)
    v_cvt_pk_bf16_f32 v236, v236, v237
    v_cvt_pk_bf16_f32 v237, v238, v239
    v_mfma_f32_16x16x32_bf16 v[228:231], a[180:183], a[220:223], v[228:231]
    ds_write_b64 v249, v[236:237] offset:0
    v_mfma_f32_16x16x32_bf16 v[228:231], a[184:187], a[224:227], v[228:231]
    v_exp_f32 v199, v199
    v_mfma_f32_16x16x32_bf16 v[228:231], a[188:191], a[228:231], v[228:231]
    v_cvt_pk_bf16_f32 v190, v196, v197
    v_cvt_pk_bf16_f32 v193, v198, v199
    v_mfma_f32_16x16x32_bf16 v[232:235], a[192:195], a[240:243], 0
    ds_read_b128 a[240:243], v242 offset:12416
    ds_read_b128 v[196:199], v245 offset:64
    v_mfma_f32_16x16x32_bf16 v[232:235], a[196:199], a[244:247], v[232:235]
    ds_read_b128 a[244:247], v243 offset:12416
    v_mfma_f32_16x16x32_bf16 v[232:235], a[200:203], a[216:219], v[232:235]
    ds_read_b128 a[216:219], v242 offset:12544
    v_cvt_pk_bf16_f32 v228, v228, v229
    v_mfma_f32_16x16x32_bf16 v[232:235], a[204:207], a[220:223], v[232:235]
    ds_read_b128 a[220:223], v243 offset:12544
    v_cvt_pk_bf16_f32 v229, v230, v231
    v_mfma_f32_16x16x32_bf16 v[232:235], a[208:211], a[224:227], v[232:235]
    ds_write_b64 v249, v[228:229] offset:128
    v_mfma_f32_16x16x32_bf16 v[232:235], a[212:215], a[228:231], v[232:235]
    ds_read_b128 a[224:227], v240 offset:6144
    ds_read_b128 a[228:231], v241 offset:6144
    v_mfma_f32_16x16x32_bf16 v[236:239], a[144:147], a[232:235], 0
    v_rcp_f32 v225, v224
    v_mfma_f32_16x16x32_bf16 v[236:239], a[148:151], a[236:239], v[236:239]
    v_exp_f32 v200, v200
    v_mfma_f32_16x16x32_bf16 v[228:231], a[168:171], a[232:235], 0
    s_waitcnt lgkmcnt(7)
    v_cvt_pk_bf16_f32 v232, v232, v233
    v_cvt_pk_bf16_f32 v233, v234, v235
    v_mfma_f32_16x16x32_bf16 v[236:239], a[152:155], a[240:243], v[236:239]
    ds_write_b64 v249, v[232:233] offset:256
    v_mfma_f32_16x16x32_bf16 v[228:231], a[172:175], a[236:239], v[228:231]
    s_waitcnt lgkmcnt(6)
    v_exp_f32 v201, v201
    v_mfma_f32_16x16x32_bf16 v[196:199], v[114:117], v[168:171], v[196:199]
    v_exp_f32 v202, v202
    v_mfma_f32_16x16x32_bf16 v[196:199], v[116:119], v[170:173], v[196:199]
    s_waitcnt lgkmcnt(5)
    v_exp_f32 v203, v203
    v_mfma_f32_16x16x32_bf16 v[236:239], a[156:159], a[244:247], v[236:239]
    s_waitcnt lgkmcnt(4)
    v_exp_f32 v204, v204
    v_mfma_f32_16x16x32_bf16 v[236:239], a[160:163], a[216:219], v[236:239]
    v_exp_f32 v205, v205
    v_mfma_f32_16x16x32_bf16 v[236:239], a[164:167], a[220:223], v[236:239]
    s_waitcnt lgkmcnt(2)
    v_mul_f32 v212, v212, v225
    v_mul_f32 v213, v213, v225
    v_mfma_f32_16x16x32_bf16 v[228:231], a[176:179], a[240:243], v[228:231]
    s_waitcnt lgkmcnt(1)
    v_cvt_pk_bf16_f32 v188, v200, v201
    v_cvt_pk_bf16_f32 v191, v202, v203
    v_mfma_f32_16x16x32_bf16 v[228:231], a[180:183], a[244:247], v[228:231]
    v_cvt_pk_bf16_f32 v236, v236, v237
    v_cvt_pk_bf16_f32 v237, v238, v239
    v_mfma_f32_16x16x32_bf16 v[228:231], a[184:187], a[216:219], v[228:231]
    ds_write_b64 v249, v[236:237] offset:6144
    v_mfma_f32_16x16x32_bf16 v[228:231], a[188:191], a[220:223], v[228:231]
    v_cvt_pk_bf16_f32 v189, v204, v205
    v_mul_f32 v214, v214, v225
    v_mfma_f32_16x16x32_bf16 v[232:235], a[192:195], a[232:235], 0
    ds_read_b128 a[232:235], v240 offset:6272
    v_mul_f32 v215, v215, v225
    v_mfma_f32_16x16x32_bf16 v[232:235], a[196:199], a[236:239], v[232:235]
    ds_read_b128 a[236:239], v241 offset:6272
    v_cvt_pk_bf16_f32 v212, v212, v213
    v_mfma_f32_16x16x32_bf16 v[232:235], a[200:203], a[240:243], v[232:235]
    ds_read_b128 a[240:243], v240 offset:6400
    v_cvt_pk_bf16_f32 v228, v228, v229
    v_mfma_f32_16x16x32_bf16 v[232:235], a[204:207], a[244:247], v[232:235]
    ds_read_b128 a[244:247], v241 offset:6400
    v_cvt_pk_bf16_f32 v229, v230, v231
    v_mfma_f32_16x16x32_bf16 v[232:235], a[208:211], a[216:219], v[232:235]
    ds_write_b64 v249, v[228:229] offset:6272
    v_mfma_f32_16x16x32_bf16 v[232:235], a[212:215], a[220:223], v[232:235]
    ds_read_b128 a[216:219], v242 offset:6144
    v_cvt_pk_bf16_f32 v213, v214, v215
    v_mfma_f32_16x16x32_bf16 v[236:239], a[0:3], a[224:227], 0
    ds_read_b128 a[220:223], v243 offset:6144
    v_mul_f32 v216, v216, v225
    v_mfma_f32_16x16x32_bf16 v[236:239], a[4:7], a[228:231], v[236:239]
    ds_read_b128 v[200:203], v246 offset:64
    v_mul_f32 v217, v217, v225
    v_mfma_f32_16x16x32_bf16 v[228:231], a[24:27], a[224:227], 0
    s_waitcnt lgkmcnt(7)
    v_cvt_pk_bf16_f32 v232, v232, v233
    v_cvt_pk_bf16_f32 v233, v234, v235
    v_mfma_f32_16x16x32_bf16 v[236:239], a[8:11], a[232:235], v[236:239]
    s_waitcnt lgkmcnt(6)
    v_mul_f32 v218, v218, v225
    v_mul_f32 v219, v219, v225
    v_mfma_f32_16x16x32_bf16 v[236:239], a[12:15], a[236:239], v[236:239]
    s_waitcnt lgkmcnt(5)
    v_cvt_pk_bf16_f32 v216, v216, v217
    v_cvt_pk_bf16_f32 v217, v218, v219
    v_mfma_f32_16x16x32_bf16 v[236:239], a[16:19], a[240:243], v[236:239]
    s_waitcnt lgkmcnt(4)
    v_mul_f32 v220, v220, v225
    v_mul_f32 v221, v221, v225
    v_mfma_f32_16x16x32_bf16 v[236:239], a[20:23], a[244:247], v[236:239]
    ds_write_b64 v249, v[232:233] offset:6400
    v_mfma_f32_16x16x32_bf16 v[228:231], a[28:31], a[228:231], v[228:231]
    ds_write_b64 v247, v[212:213] offset:30720
    v_mfma_f32_16x16x32_bf16 v[212:215], v[12:15], v[188:191], 0
    ds_write_b64 v247, v[216:217] offset:30848
    v_mfma_f32_16x16x32_bf16 v[216:219], v[42:45], v[188:191], 0
    s_waitcnt lgkmcnt(4)
    v_mul_f32 v222, v222, v225
    v_cvt_pk_bf16_f32 v156, v236, v237
    v_mfma_f32_16x16x32_bf16 v[228:231], a[32:35], a[232:235], v[228:231]
    s_waitcnt lgkmcnt(3)
    v_cvt_pk_bf16_f32 v157, v238, v239
    v_mul_f32 v223, v223, v225
    v_mfma_f32_16x16x32_bf16 v[200:203], v[150:153], v[168:171], v[200:203]
    v_cvt_pk_bf16_f32 v220, v220, v221
    v_cvt_pk_bf16_f32 v221, v222, v223
    v_mfma_f32_16x16x32_bf16 v[200:203], v[152:155], v[170:173], v[200:203]
    ds_write_b64 v247, v[220:221] offset:30976
    v_mfma_f32_16x16x32_bf16 v[220:223], v[72:75], v[188:191], 0
    v_exp_f32 v206, v206
    v_mfma_f32_16x16x32_bf16 v[228:231], a[36:39], a[236:239], v[228:231]
    v_exp_f32 v207, v207
    v_mfma_f32_16x16x32_bf16 v[228:231], a[40:43], a[240:243], v[228:231]
    v_max3_f32 v248, v248, v224, v225
    v_cvt_pk_bf16_f32 v192, v206, v207
    v_mfma_f32_16x16x32_bf16 v[224:227], a[248:251], v[188:191], 0
    ds_read_b128 v[204:207], v244 offset:128
    v_mfma_f32_16x16x32_bf16 v[228:231], a[44:47], a[244:247], v[228:231]
    v_exp_f32 v208, v208
    v_mfma_f32_16x16x32_bf16 v[232:235], a[48:51], a[224:227], 0
    v_exp_f32 v209, v209
    v_mfma_f32_16x16x32_bf16 v[232:235], a[52:55], a[228:231], v[232:235]
    s_waitcnt lgkmcnt(4)
    v_exp_f32 v210, v210
    v_mfma_f32_16x16x32_bf16 v[232:235], a[56:59], a[232:235], v[232:235]
    s_barrier
    v_mfma_f32_16x16x32_bf16 v[232:235], a[60:63], a[236:239], v[232:235]
    v_cvt_pk_bf16_f32 v158, v228, v229
    v_cvt_pk_bf16_f32 v159, v230, v231
    v_mfma_f32_16x16x32_bf16 v[232:235], a[64:67], a[240:243], v[232:235]
    v_exp_f32 v211, v211
    v_mfma_f32_16x16x32_bf16 v[232:235], a[68:71], a[244:247], v[232:235]
    v_cvt_pk_bf16_f32 v180, v208, v209
    v_cvt_pk_bf16_f32 v183, v210, v211
    v_mfma_f32_16x16x32_bf16 v[236:239], a[224:227], a[72:75], 0
    ds_read_b128 v[208:211], v245 offset:128
    ds_read_b128 a[252:255], v252 offset:0
    v_mfma_f32_16x16x32_bf16 v[236:239], a[228:231], a[76:79], v[236:239]
    s_waitcnt lgkmcnt(2)
    v_exp_f32 v196, v196
    v_mfma_f32_16x16x32_bf16 v[204:207], v[108:111], v[168:171], v[204:207]
    v_cvt_pk_bf16_f32 v160, v232, v233
    v_cvt_pk_bf16_f32 v161, v234, v235
    v_mfma_f32_16x16x32_bf16 v[204:207], v[110:113], v[170:173], v[204:207]
    v_exp_f32 v197, v197
    v_mfma_f32_16x16x32_bf16 v[236:239], a[232:235], a[80:83], v[236:239]
    v_exp_f32 v198, v198
    v_mfma_f32_16x16x32_bf16 v[236:239], a[236:239], a[84:87], v[236:239]
    v_exp_f32 v199, v199
    v_mfma_f32_16x16x32_bf16 v[236:239], a[240:243], a[88:91], v[236:239]
    v_cvt_pk_bf16_f32 v194, v196, v197
    v_cvt_pk_bf16_f32 v181, v198, v199
    v_mfma_f32_16x16x32_bf16 v[236:239], a[244:247], a[92:95], v[236:239]
    ds_read_b128 v[196:199], v246 offset:128
    ds_read_b64 v[254:255], v253 offset:256
    v_mfma_f32_16x16x32_bf16 v[228:231], a[224:227], a[96:99], 0
    v_exp_f32 v200, v200
    v_mfma_f32_16x16x32_bf16 v[228:231], a[228:231], a[100:103], v[228:231]
    s_waitcnt lgkmcnt(3)
    v_exp_f32 v201, v201
    v_mfma_f32_16x16x32_bf16 v[208:211], v[120:123], v[168:171], v[208:211]
    s_waitcnt lgkmcnt(2)
    v_cvt_pk_bf16_f32 v25, v236, v237
    v_cvt_pk_bf16_f32 v28, v238, v239
    v_mfma_f32_16x16x32_bf16 v[208:211], v[122:125], v[170:173], v[208:211]
    v_exp_f32 v202, v202
    v_mfma_f32_16x16x32_bf16 v[228:231], a[232:235], a[104:107], v[228:231]
    v_exp_f32 v203, v203
    v_mfma_f32_16x16x32_bf16 v[228:231], a[236:239], a[108:111], v[228:231]
    v_cvt_pk_bf16_f32 v195, v200, v201
    v_cvt_pk_bf16_f32 v182, v202, v203
    v_mfma_f32_16x16x32_bf16 v[228:231], a[240:243], a[112:115], v[228:231]
    ds_read_b128 v[200:203], v244 offset:0
    v_mfma_f32_16x16x32_bf16 v[212:215], v[16:19], v[192:195], v[212:215]
    v_exp_f32 v204, v204
    v_mfma_f32_16x16x32_bf16 v[216:219], v[46:49], v[192:195], v[216:219]
    v_exp_f32 v205, v205
    v_mfma_f32_16x16x32_bf16 v[220:223], v[76:79], v[192:195], v[220:223]
    s_waitcnt lgkmcnt(1)
    v_exp_f32 v208, v208
    v_mfma_f32_16x16x32_bf16 v[224:227], a[248:251], v[192:195], v[224:227]
    v_exp_f32 v209, v209
    v_mfma_f32_16x16x32_bf16 v[212:215], v[20:23], v[180:183], v[212:215]
    v_cvt_pk_bf16_f32 v186, v204, v205
    v_cvt_pk_bf16_f32 v184, v208, v209
    v_mfma_f32_16x16x32_bf16 v[216:219], v[50:53], v[180:183], v[216:219]
    ds_read_b128 v[204:207], v245 offset:0
    ds_read_b128 v[208:211], v246 offset:0
    v_mfma_f32_16x16x32_bf16 v[220:223], v[80:83], v[180:183], v[220:223]
    buffer_store_dwordx4 a[252:255], v250, s[20:23], s56 offen nt
    v_mfma_f32_16x16x32_bf16 v[224:227], a[248:251], v[180:183], v[224:227]
    v_mfma_f32_16x16x32_bf16 v[196:199], v[156:159], v[168:171], v[196:199]
    ds_read_b64 v[168:169], v247 offset:49152
    ds_read_b128 a[252:255], v252 offset:6144
    v_mfma_f32_16x16x32_bf16 v[196:199], v[158:161], v[170:173], v[196:199]
    ds_read_b64 v[170:171], v247 offset:49280
    ds_read_b64 v[172:173], v247 offset:49408
    v_mfma_f32_16x16x32_bf16 v[228:231], a[244:247], a[116:119], v[228:231]
    buffer_store_dwordx2 v[254:255], v251, s[20:23], s56 offen offset:256 nt
    v_mfma_f32_16x16x32_bf16 v[232:235], a[224:227], a[120:123], 0
    ds_read_b128 a[224:227], v242 offset:6272
    s_waitcnt lgkmcnt(7)
    v_mfma_f32_16x16x32_bf16 v[200:203], v[102:105], v[174:177], v[200:203]
    s_mul_i32 s56, s31, 7
    v_exp_f32 v196, v196
    v_mfma_f32_16x16x32_bf16 v[200:203], v[104:107], v[176:179], v[200:203]
    s_add_u32 s55, s55, s56
    v_cvt_pk_bf16_f32 v55, v228, v229
    v_cvt_pk_bf16_f32 v58, v230, v231
    v_mfma_f32_16x16x32_bf16 v[232:235], a[228:231], a[124:127], v[232:235]
    ds_read_b128 a[228:231], v243 offset:6272
    ds_read_b64 v[254:255], v253 offset:6400
    v_mfma_f32_16x16x32_bf16 v[232:235], a[232:235], a[128:131], v[232:235]
    ds_read_b128 a[232:235], v242 offset:6400
    v_add_u32 v242, 0xfffe9800, v242
    v_mfma_f32_16x16x32_bf16 v[232:235], a[236:239], a[132:135], v[232:235]
    ds_read_b128 a[236:239], v243 offset:6400
    v_add_u32 v243, 0xfffe9800, v243
    v_mfma_f32_16x16x32_bf16 v[232:235], a[240:243], a[136:139], v[232:235]
    ds_read_b128 a[240:243], v242 offset:12288
    s_waitcnt lgkmcnt(10)
    v_mfma_f32_16x16x32_bf16 v[204:207], v[114:117], v[174:177], v[204:207]
    s_add_u32 s55, s55, s32
    v_exp_f32 v197, v197
    v_mfma_f32_16x16x32_bf16 v[204:207], v[116:119], v[176:179], v[204:207]
    s_add_u32 s56, s28, 11
    v_exp_f32 v200, v200
    v_mfma_f32_16x16x32_bf16 v[208:211], v[150:153], v[174:177], v[208:211]
    s_mul_i32 s56, s56, s30
    v_exp_f32 v201, v201
    v_mfma_f32_16x16x32_bf16 v[208:211], v[152:155], v[176:179], v[208:211]
    s_waitcnt lgkmcnt(5)
    v_cvt_pk_bf16_f32 v185, v196, v197
    v_cvt_pk_bf16_f32 v190, v200, v201
    v_mfma_f32_16x16x32_bf16 v[232:235], a[244:247], a[140:143], v[232:235]
    ds_read_b128 a[244:247], v243 offset:12288
    ds_read_b128 v[196:199], v244 offset:64
    v_mfma_f32_16x16x32_bf16 v[212:215], v[24:27], v[184:187], v[212:215]
    s_waitcnt lgkmcnt(6)
    v_exp_f32 v202, v202
    v_mfma_f32_16x16x32_bf16 v[216:219], v[54:57], v[184:187], v[216:219]
    s_waitcnt lgkmcnt(5)
    v_exp_f32 v203, v203
    v_mfma_f32_16x16x32_bf16 v[224:227], a[248:251], v[184:187], v[224:227]
    s_waitcnt lgkmcnt(4)
    v_cvt_pk_bf16_f32 v85, v232, v233
    v_cvt_pk_bf16_f32 v88, v234, v235
    v_mfma_f32_16x16x32_bf16 v[236:239], a[144:147], a[216:219], 0
    s_waitcnt lgkmcnt(3)
    v_exp_f32 v204, v204
    v_mfma_f32_16x16x32_bf16 v[220:223], v[84:87], v[184:187], v[220:223]
    s_waitcnt lgkmcnt(2)
    v_cvt_pk_bf16_f32 v193, v202, v203
    v_mov_b32 v186, 0
    v_mfma_f32_16x16x32_bf16 v[236:239], a[148:151], a[220:223], v[236:239]
    v_exp_f32 v205, v205
    v_mfma_f32_16x16x32_bf16 v[236:239], a[152:155], a[224:227], v[236:239]
    v_exp_f32 v206, v206
    v_mfma_f32_16x16x32_bf16 v[236:239], a[156:159], a[228:231], v[236:239]
    v_exp_f32 v207, v207
    v_mfma_f32_16x16x32_bf16 v[236:239], a[160:163], a[232:235], v[236:239]
    ds_read_b128 v[200:203], v245 offset:64
    v_cvt_pk_bf16_f32 v188, v204, v205
    v_mfma_f32_16x16x32_bf16 v[236:239], a[164:167], a[236:239], v[236:239]
    s_waitcnt lgkmcnt(2)
    v_rcp_f32 v225, v224
    v_mfma_f32_16x16x32_bf16 v[228:231], a[168:171], a[216:219], 0
    s_waitcnt lgkmcnt(1)
    v_cvt_pk_bf16_f32 v191, v206, v207
    v_mul_f32 v212, v212, v225
    v_mfma_f32_16x16x32_bf16 v[196:199], v[108:111], v[174:177], v[196:199]
    ds_read_b128 v[204:207], v246 offset:64
    v_cvt_pk_bf16_f32 v236, v236, v237
    v_mfma_f32_16x16x32_bf16 v[196:199], v[110:113], v[176:179], v[196:199]
    v_cvt_pk_bf16_f32 v237, v238, v239
    v_mul_f32 v213, v213, v225
    v_mfma_f32_16x16x32_bf16 v[228:231], a[172:175], a[220:223], v[228:231]
    ds_write_b64 v249, v[236:237] offset:12288
    v_mfma_f32_16x16x32_bf16 v[228:231], a[176:179], a[224:227], v[228:231]
    v_exp_f32 v208, v208
    v_mfma_f32_16x16x32_bf16 v[228:231], a[180:183], a[228:231], v[228:231]
    v_exp_f32 v209, v209
    v_mfma_f32_16x16x32_bf16 v[228:231], a[184:187], a[232:235], v[228:231]
    v_cvt_pk_bf16_f32 v189, v208, v209
    v_mul_f32 v214, v214, v225
    v_mfma_f32_16x16x32_bf16 v[228:231], a[188:191], a[236:239], v[228:231]
    v_mul_f32 v215, v215, v225
    v_cvt_pk_bf16_f32 v212, v212, v213
    v_mfma_f32_16x16x32_bf16 v[232:235], a[192:195], a[216:219], 0
    ds_read_b128 a[216:219], v242 offset:12416
    v_cvt_pk_bf16_f32 v213, v214, v215
    v_mfma_f32_16x16x32_bf16 v[232:235], a[196:199], a[220:223], v[232:235]
    ds_read_b128 a[220:223], v243 offset:12416
    v_mul_f32 v216, v216, v225
    v_mfma_f32_16x16x32_bf16 v[232:235], a[200:203], a[224:227], v[232:235]
    ds_read_b128 a[224:227], v242 offset:12544
    v_cvt_pk_bf16_f32 v228, v228, v229
    v_mfma_f32_16x16x32_bf16 v[232:235], a[204:207], a[228:231], v[232:235]
    ds_read_b128 a[228:231], v243 offset:12544
    v_cvt_pk_bf16_f32 v229, v230, v231
    v_mfma_f32_16x16x32_bf16 v[232:235], a[208:211], a[232:235], v[232:235]
    ds_write_b64 v249, v[228:229] offset:12416
    v_mfma_f32_16x16x32_bf16 v[232:235], a[212:215], a[236:239], v[232:235]
    ds_read_b128 a[232:235], v242 offset:6144
    ds_read_b128 a[236:239], v243 offset:6144
    v_mfma_f32_16x16x32_bf16 v[236:239], a[144:147], a[240:243], 0
    ds_write_b64 v247, v[212:213] offset:36864
    v_mfma_f32_16x16x32_bf16 v[212:215], v[18:21], v[188:191], 0
    s_waitcnt lgkmcnt(9)
    v_mul_f32 v217, v217, v225
    v_mul_f32 v218, v218, v225
    v_mfma_f32_16x16x32_bf16 v[200:203], v[120:123], v[174:177], v[200:203]
    v_cvt_pk_bf16_f32 v232, v232, v233
    v_cvt_pk_bf16_f32 v233, v234, v235
    v_mfma_f32_16x16x32_bf16 v[200:203], v[122:125], v[176:179], v[200:203]
    ds_write_b64 v249, v[232:233] offset:12544
    v_mfma_f32_16x16x32_bf16 v[204:207], v[156:159], v[174:177], v[204:207]
    s_waitcnt lgkmcnt(7)
    v_mul_f32 v219, v219, v225
    v_cvt_pk_bf16_f32 v216, v216, v217
    v_mfma_f32_16x16x32_bf16 v[204:207], v[158:161], v[176:179], v[204:207]
    s_waitcnt lgkmcnt(6)
    v_cvt_pk_bf16_f32 v217, v218, v219
    v_mul_f32 v220, v220, v225
    v_mfma_f32_16x16x32_bf16 v[236:239], a[148:151], a[244:247], v[236:239]
    ds_write_b64 v247, v[216:217] offset:36992
    v_mfma_f32_16x16x32_bf16 v[216:219], v[48:51], v[188:191], 0
    s_waitcnt lgkmcnt(5)
    v_mul_f32 v221, v221, v225
    v_mul_f32 v222, v222, v225
    v_mfma_f32_16x16x32_bf16 v[236:239], a[152:155], a[216:219], v[236:239]
    s_waitcnt lgkmcnt(4)
    v_mul_f32 v223, v223, v225
    v_cvt_pk_bf16_f32 v220, v220, v221
    v_mfma_f32_16x16x32_bf16 v[236:239], a[156:159], a[220:223], v[236:239]
    s_waitcnt lgkmcnt(3)
    v_cvt_pk_bf16_f32 v221, v222, v223
    v_max3_f32 v248, v248, v224, v225
    v_mfma_f32_16x16x32_bf16 v[224:227], a[248:251], v[188:191], 0
    ds_write_b64 v247, v[220:221] offset:37120
    v_mfma_f32_16x16x32_bf16 v[220:223], v[78:81], v[188:191], 0
    v_exp_f32 v210, v210
    v_mfma_f32_16x16x32_bf16 v[236:239], a[160:163], a[224:227], v[236:239]
    v_exp_f32 v211, v211
    v_mfma_f32_16x16x32_bf16 v[236:239], a[164:167], a[228:231], v[236:239]
    v_add_u32 v209, 0xfffff900, v245
    v_cvt_pk_bf16_f32 v192, v210, v211
    v_mfma_f32_16x16x32_bf16 v[228:231], a[168:171], a[240:243], 0
    v_cndmask_b32 v209, v244, v209, vcc
    v_add_u32 v210, 0xc0, v209
    v_mfma_f32_16x16x32_bf16 v[228:231], a[172:175], a[244:247], v[228:231]
    s_mov_b32 vcc_lo, 0xff00ff00
    v_add_u32 v209, 0x340, v209
    v_cvt_pk_bf16_f32 v236, v236, v237
    v_mfma_f32_16x16x32_bf16 v[228:231], a[176:179], a[216:219], v[228:231]
    s_mov_b32 vcc_hi, 0xff00ff00
    v_cvt_pk_bf16_f32 v237, v238, v239
    v_cndmask_b32 v244, v210, v209, vcc
    v_mfma_f32_16x16x32_bf16 v[228:231], a[180:183], a[220:223], v[228:231]
    ds_write_b64 v249, v[236:237] offset:18432
    v_mfma_f32_16x16x32_bf16 v[228:231], a[184:187], a[224:227], v[228:231]
L_h8:
    s_cbranch_execz L_hback
    s_mov_b32 vcc_lo, 0xf0f0
    v_exp_f32 v200, v200
    v_mfma_f32_16x16x32_bf16 v[228:231], a[188:191], a[228:231], v[228:231]
    s_mov_b32 vcc_hi, 0x0
    v_exp_f32 v201, v201
    v_mfma_f32_16x16x32_bf16 v[232:235], a[192:195], a[240:243], 0
    ds_read_b128 a[240:243], v242 offset:6272
    v_mov_b32 v208, 0x237c0
    v_mfma_f32_16x16x32_bf16 v[232:235], a[196:199], a[244:247], v[232:235]
    ds_read_b128 a[244:247], v243 offset:6272
    v_add_u32 v245, 0x700, v244
    v_mfma_f32_16x16x32_bf16 v[232:235], a[200:203], a[216:219], v[232:235]
    ds_read_b128 a[216:219], v242 offset:6400
    v_cvt_pk_bf16_f32 v228, v228, v229
    v_mfma_f32_16x16x32_bf16 v[232:235], a[204:207], a[220:223], v[232:235]
    ds_read_b128 a[220:223], v243 offset:6400
    v_cvt_pk_bf16_f32 v229, v230, v231
    v_mfma_f32_16x16x32_bf16 v[232:235], a[208:211], a[224:227], v[232:235]
    ds_write_b64 v249, v[228:229] offset:18560
    v_mfma_f32_16x16x32_bf16 v[232:235], a[212:215], a[228:231], v[232:235]
    ds_read_b128 a[224:227], v242 offset:18432
    ds_read_b128 a[228:231], v243 offset:18432
    v_mfma_f32_16x16x32_bf16 v[236:239], a[144:147], a[232:235], 0
    v_exp_f32 v202, v202
    v_mfma_f32_16x16x32_bf16 v[236:239], a[148:151], a[236:239], v[236:239]
    v_exp_f32 v203, v203
    v_mfma_f32_16x16x32_bf16 v[228:231], a[168:171], a[232:235], 0
    s_waitcnt lgkmcnt(6)
    v_cvt_pk_bf16_f32 v232, v232, v233
    v_cvt_pk_bf16_f32 v233, v234, v235
    v_mfma_f32_16x16x32_bf16 v[236:239], a[152:155], a[240:243], v[236:239]
    s_waitcnt lgkmcnt(5)
    v_cvt_pk_bf16_f32 v194, v200, v201
    v_cvt_pk_bf16_f32 v181, v202, v203
    v_mfma_f32_16x16x32_bf16 v[236:239], a[156:159], a[244:247], v[236:239]
    s_waitcnt lgkmcnt(4)
    v_cndmask_b32 v244, v244, v208, vcc
    v_mov_b32 v189, 0
    v_mfma_f32_16x16x32_bf16 v[236:239], a[160:163], a[216:219], v[236:239]
    s_waitcnt lgkmcnt(3)
    v_exp_f32 v204, v204
    v_mfma_f32_16x16x32_bf16 v[236:239], a[164:167], a[220:223], v[236:239]
    ds_write_b64 v249, v[232:233] offset:18688
    v_mfma_f32_16x16x32_bf16 v[228:231], a[172:175], a[236:239], v[228:231]
    s_mov_b32 vcc_lo, 0x0
    v_exp_f32 v205, v205
    v_mfma_f32_16x16x32_bf16 v[228:231], a[176:179], a[240:243], v[228:231]
    ds_read_b128 v[200:203], v244 offset:64
    v_cvt_pk_bf16_f32 v195, v204, v205
    v_mfma_f32_16x16x32_bf16 v[228:231], a[180:183], a[244:247], v[228:231]
    s_mov_b32 vcc_hi, 0xf0f0000
    v_cvt_pk_bf16_f32 v236, v236, v237
    v_cvt_pk_bf16_f32 v237, v238, v239
    v_mfma_f32_16x16x32_bf16 v[212:215], v[22:25], v[192:195], v[212:215]
    ds_write_b64 v249, v[236:237] offset:24576
    v_mfma_f32_16x16x32_bf16 v[216:219], v[52:55], v[192:195], v[216:219]
    s_waitcnt lgkmcnt(4)
    v_exp_f32 v196, v196
    v_mfma_f32_16x16x32_bf16 v[220:223], v[82:85], v[192:195], v[220:223]
    ds_read_b64 v[174:175], v247 offset:55296
    v_cndmask_b32 v245, v245, v208, vcc
    v_mfma_f32_16x16x32_bf16 v[224:227], a[248:251], v[192:195], v[224:227]
    ds_read_b128 v[208:211], v244 offset:0
    v_mov_b32 v192, 0
    v_mfma_f32_16x16x32_bf16 v[228:231], a[184:187], a[216:219], v[228:231]
    s_mov_b32 vcc_lo, 0xff000f
    v_exp_f32 v197, v197
    v_mfma_f32_16x16x32_bf16 v[228:231], a[188:191], a[220:223], v[228:231]
    s_mov_b32 vcc_hi, 0xff00ff
    v_exp_f32 v198, v198
    v_mfma_f32_16x16x32_bf16 v[232:235], a[192:195], a[232:235], 0
    ds_read_b128 a[232:235], v242 offset:18560
    v_cvt_pk_bf16_f32 v180, v196, v197
    v_mfma_f32_16x16x32_bf16 v[232:235], a[196:199], a[236:239], v[232:235]
    ds_read_b128 a[236:239], v243 offset:18560
    v_mov_b32 v195, 0
    v_mfma_f32_16x16x32_bf16 v[232:235], a[200:203], a[240:243], v[232:235]
    ds_read_b128 a[240:243], v242 offset:18688
    v_cvt_pk_bf16_f32 v228, v228, v229
    v_mfma_f32_16x16x32_bf16 v[232:235], a[204:207], a[244:247], v[232:235]
    ds_read_b128 a[244:247], v243 offset:18688
    v_cvt_pk_bf16_f32 v229, v230, v231
    v_mfma_f32_16x16x32_bf16 v[232:235], a[208:211], a[216:219], v[232:235]
    ds_write_b64 v249, v[228:229] offset:24704
    v_mfma_f32_16x16x32_bf16 v[232:235], a[212:215], a[220:223], v[232:235]
    s_waitcnt lgkmcnt(8)
    v_exp_f32 v199, v199
    v_mfma_f32_16x16x32_bf16 v[200:203], v[90:93], v[168:171], v[200:203]
    ds_read_b128 a[216:219], v242 offset:24576
    v_cvt_pk_bf16_f32 v183, v198, v199
    v_mfma_f32_16x16x32_bf16 v[200:203], v[92:95], v[170:173], v[200:203]
    s_waitcnt lgkmcnt(6)
    v_exp_f32 v206, v206
    v_mfma_f32_16x16x32_bf16 v[208:211], v[96:99], v[168:171], v[208:211]
    ds_read_b128 v[196:199], v245 offset:0
    v_cvt_pk_bf16_f32 v232, v232, v233
    v_mfma_f32_16x16x32_bf16 v[208:211], v[98:101], v[170:173], v[208:211]
    ds_read_b128 a[220:223], v243 offset:24576
    v_cvt_pk_bf16_f32 v233, v234, v235
    v_mfma_f32_16x16x32_bf16 v[236:239], a[144:147], a[224:227], 0
    ds_write_b64 v249, v[232:233] offset:24832
    v_mfma_f32_16x16x32_bf16 v[236:239], a[148:151], a[228:231], v[236:239]
    s_waitcnt lgkmcnt(8)
    v_exp_f32 v207, v207
    v_mfma_f32_16x16x32_bf16 v[236:239], a[152:155], a[232:235], v[236:239]
    s_waitcnt lgkmcnt(7)
    v_exp_f32 v208, v208
    v_mfma_f32_16x16x32_bf16 v[236:239], a[156:159], a[236:239], v[236:239]
    s_waitcnt lgkmcnt(6)
    v_exp_f32 v209, v209
    v_mfma_f32_16x16x32_bf16 v[236:239], a[160:163], a[240:243], v[236:239]
    s_waitcnt lgkmcnt(5)
    v_cvt_pk_bf16_f32 v182, v206, v207
    v_cvt_pk_bf16_f32 v184, v208, v209
    v_mfma_f32_16x16x32_bf16 v[236:239], a[164:167], a[244:247], v[236:239]
    ds_read_b128 v[204:207], v245 offset:64
    ds_read_b64 v[176:177], v247 offset:55424
    v_mfma_f32_16x16x32_bf16 v[212:215], v[26:29], v[180:183], v[212:215]
    s_waitcnt lgkmcnt(5)
    v_exp_f32 v210, v210
    v_mfma_f32_16x16x32_bf16 v[216:219], v[56:59], v[180:183], v[216:219]
    s_waitcnt lgkmcnt(4)
    v_exp_f32 v211, v211
    v_mfma_f32_16x16x32_bf16 v[220:223], v[86:89], v[180:183], v[220:223]
    s_waitcnt lgkmcnt(3)
    v_cvt_pk_bf16_f32 v236, v236, v237
    v_cvt_pk_bf16_f32 v237, v238, v239
    v_mfma_f32_16x16x32_bf16 v[224:227], a[248:251], v[180:183], v[224:227]
    v_cvt_pk_bf16_f32 v187, v210, v211
    v_mov_b32 v182, 0
    v_mfma_f32_16x16x32_bf16 v[196:199], v[132:135], v[168:171], v[196:199]
    ds_read_b128 v[208:211], v244 offset:128
    ds_read_b64 v[178:179], v247 offset:55552
    v_mfma_f32_16x16x32_bf16 v[196:199], v[134:137], v[170:173], v[196:199]
    buffer_store_dwordx4 a[252:255], v250, s[20:23], s51 offen nt
    v_mfma_f32_16x16x32_bf16 v[228:231], a[168:171], a[224:227], 0
    v_rcp_f32 v225, v224
    v_mfma_f32_16x16x32_bf16 v[228:231], a[172:175], a[228:231], v[228:231]
    s_waitcnt lgkmcnt(4)
    v_mul_f32 v212, v212, v225
    v_mul_f32 v213, v213, v225
    v_mfma_f32_16x16x32_bf16 v[228:231], a[176:179], a[232:235], v[228:231]
    s_barrier
    v_mfma_f32_16x16x32_bf16 v[228:231], a[180:183], a[236:239], v[228:231]
    ds_write_b64 v249, v[236:237] offset:0
    v_mfma_f32_16x16x32_bf16 v[228:231], a[184:187], a[240:243], v[228:231]
    s_waitcnt lgkmcnt(3)
    v_exp_f32 v196, v196
    v_mfma_f32_16x16x32_bf16 v[204:207], v[126:129], v[168:171], v[204:207]
    s_waitcnt lgkmcnt(2)
    v_exp_f32 v197, v197
    v_mfma_f32_16x16x32_bf16 v[204:207], v[128:131], v[170:173], v[204:207]
    s_waitcnt lgkmcnt(1)
    v_exp_f32 v198, v198
    v_mfma_f32_16x16x32_bf16 v[208:211], v[138:141], v[168:171], v[208:211]
    v_exp_f32 v199, v199
    v_mfma_f32_16x16x32_bf16 v[208:211], v[140:143], v[170:173], v[208:211]
    ds_read_b128 a[252:255], v252 offset:12288
    v_cvt_pk_bf16_f32 v185, v196, v197
    v_mfma_f32_16x16x32_bf16 v[228:231], a[188:191], a[244:247], v[228:231]
    v_cvt_pk_bf16_f32 v188, v198, v199
    v_mul_f32 v214, v214, v225
    v_mfma_f32_16x16x32_bf16 v[232:235], a[192:195], a[224:227], 0
    ds_read_b128 a[224:227], v242 offset:24704
    v_mul_f32 v215, v215, v225
    v_mfma_f32_16x16x32_bf16 v[232:235], a[196:199], a[228:231], v[232:235]
    ds_read_b128 a[228:231], v243 offset:24704
    v_cvt_pk_bf16_f32 v212, v212, v213
    v_mfma_f32_16x16x32_bf16 v[232:235], a[200:203], a[232:235], v[232:235]
    ds_read_b128 a[232:235], v242 offset:24832
    v_cvt_pk_bf16_f32 v228, v228, v229
    v_mfma_f32_16x16x32_bf16 v[232:235], a[204:207], a[236:239], v[232:235]
    ds_read_b128 a[236:239], v243 offset:24832
    v_cvt_pk_bf16_f32 v229, v230, v231
    v_mfma_f32_16x16x32_bf16 v[232:235], a[208:211], a[240:243], v[232:235]
    ds_write_b64 v249, v[228:229] offset:128
    v_mfma_f32_16x16x32_bf16 v[232:235], a[212:215], a[244:247], v[232:235]
    ds_read_b128 a[240:243], v242 offset:30720
    v_cvt_pk_bf16_f32 v213, v214, v215
    v_mfma_f32_16x16x32_bf16 v[236:239], a[144:147], a[216:219], 0
    ds_read_b128 a[244:247], v243 offset:30720
    v_mul_f32 v216, v216, v225
    v_mfma_f32_16x16x32_bf16 v[236:239], a[148:151], a[220:223], v[236:239]
    ds_read_b128 v[196:199], v245 offset:128
    v_mul_f32 v217, v217, v225
    v_mfma_f32_16x16x32_bf16 v[228:231], a[168:171], a[216:219], 0
    s_waitcnt lgkmcnt(7)
    v_cvt_pk_bf16_f32 v232, v232, v233
    v_cvt_pk_bf16_f32 v233, v234, v235
    v_mfma_f32_16x16x32_bf16 v[236:239], a[152:155], a[224:227], v[236:239]
    s_waitcnt lgkmcnt(6)
    v_mul_f32 v218, v218, v225
    v_mul_f32 v219, v219, v225
    v_mfma_f32_16x16x32_bf16 v[236:239], a[156:159], a[228:231], v[236:239]
    s_waitcnt lgkmcnt(5)
    v_cvt_pk_bf16_f32 v216, v216, v217
    v_cvt_pk_bf16_f32 v217, v218, v219
    v_mfma_f32_16x16x32_bf16 v[236:239], a[160:163], a[232:235], v[236:239]
    s_waitcnt lgkmcnt(4)
    v_mul_f32 v220, v220, v225
    v_mul_f32 v221, v221, v225
    v_mfma_f32_16x16x32_bf16 v[236:239], a[164:167], a[236:239], v[236:239]
    ds_write_b64 v249, v[232:233] offset:256
    v_mfma_f32_16x16x32_bf16 v[228:231], a[172:175], a[220:223], v[228:231]
    buffer_store_dwordx2 v[254:255], v251, s[20:23], s51 offen offset:256 nt
    v_mfma_f32_16x16x32_bf16 v[228:231], a[176:179], a[224:227], v[228:231]
    ds_read_b64 v[254:255], v253 offset:12544
    v_mul_f32 v222, v222, v225
    v_mfma_f32_16x16x32_bf16 v[228:231], a[180:183], a[228:231], v[228:231]
    ds_write_b64 v247, v[212:213] offset:43008
    v_mfma_f32_16x16x32_bf16 v[212:215], v[0:3], v[184:187], 0
    s_mul_i32 s51, s31, 3
    v_cvt_pk_bf16_f32 v236, v236, v237
    v_cvt_pk_bf16_f32 v237, v238, v239
    v_mfma_f32_16x16x32_bf16 v[228:231], a[184:187], a[232:235], v[228:231]
    ds_write_b64 v249, v[236:237] offset:6144
    v_mfma_f32_16x16x32_bf16 v[228:231], a[188:191], a[236:239], v[228:231]
    s_waitcnt lgkmcnt(6)
    v_mul_f32 v223, v223, v225
    v_cvt_pk_bf16_f32 v220, v220, v221
    v_mfma_f32_16x16x32_bf16 v[232:235], a[192:195], a[216:219], 0
    ds_read_b128 a[216:219], v242 offset:30848
    v_cvt_pk_bf16_f32 v221, v222, v223
    v_mfma_f32_16x16x32_bf16 v[232:235], a[196:199], a[220:223], v[232:235]
    ds_read_b128 a[220:223], v243 offset:30848
    v_cvt_pk_bf16_f32 v228, v228, v229
    v_mfma_f32_16x16x32_bf16 v[232:235], a[200:203], a[224:227], v[232:235]
    ds_read_b128 a[224:227], v242 offset:30976
    v_cvt_pk_bf16_f32 v229, v230, v231
    v_mfma_f32_16x16x32_bf16 v[232:235], a[204:207], a[228:231], v[232:235]
    ds_write_b64 v249, v[228:229] offset:6272
    v_mfma_f32_16x16x32_bf16 v[232:235], a[208:211], a[232:235], v[232:235]
    ds_read_b128 a[228:231], v243 offset:30976
    v_max3_f32 v248, v248, v224, v225
    v_mfma_f32_16x16x32_bf16 v[224:227], a[248:251], v[184:187], 0
    ds_write_b64 v247, v[216:217] offset:43136
    v_mfma_f32_16x16x32_bf16 v[216:219], v[30:33], v[184:187], 0
    ds_write_b64 v247, v[220:221] offset:43264
    v_mfma_f32_16x16x32_bf16 v[220:223], v[60:63], v[184:187], 0
    s_waitcnt lgkmcnt(9)
    v_exp_f32 v200, v200
    v_mfma_f32_16x16x32_bf16 v[196:199], v[144:147], v[168:171], v[196:199]
    buffer_store_dwordx4 a[252:255], v250, s[20:23], s53 offen nt
    v_mfma_f32_16x16x32_bf16 v[196:199], v[146:149], v[170:173], v[196:199]
    s_add_u32 s57, s57, s51
    v_exp_f32 v201, v201
    v_mfma_f32_16x16x32_bf16 v[232:235], a[212:215], a[236:239], v[232:235]
    ds_read_b128 a[252:255], v252 offset:18432
    v_cvt_pk_bf16_f32 v190, v200, v201
    v_mfma_f32_16x16x32_bf16 v[236:239], a[144:147], a[240:243], 0
    buffer_store_dwordx2 v[254:255], v251, s[20:23], s53 offen offset:256 nt
    v_mfma_f32_16x16x32_bf16 v[236:239], a[148:151], a[244:247], v[236:239]
    s_waitcnt lgkmcnt(7)
    v_exp_f32 v202, v202
    v_mfma_f32_16x16x32_bf16 v[236:239], a[152:155], a[216:219], v[236:239]
    s_waitcnt lgkmcnt(6)
    v_cvt_pk_bf16_f32 v232, v232, v233
    v_cvt_pk_bf16_f32 v233, v234, v235
    v_mfma_f32_16x16x32_bf16 v[236:239], a[156:159], a[220:223], v[236:239]
    s_waitcnt lgkmcnt(5)
    v_exp_f32 v203, v203
    v_mfma_f32_16x16x32_bf16 v[236:239], a[160:163], a[224:227], v[236:239]
    s_waitcnt lgkmcnt(3)
    ds_read_b64 v[254:255], v253 offset:18688
    v_mfma_f32_16x16x32_bf16 v[236:239], a[164:167], a[228:231], v[236:239]
    ds_write_b64 v249, v[232:233] offset:6400
    v_mfma_f32_16x16x32_bf16 v[228:231], a[168:171], a[240:243], 0
    ds_read_b128 a[232:235], v242 offset:0
    v_cvt_pk_bf16_f32 v193, v202, v203
    v_mfma_f32_16x16x32_bf16 v[228:231], a[172:175], a[244:247], v[228:231]
    s_add_u32 s57, s57, s32
    v_exp_f32 v204, v204
    v_mfma_f32_16x16x32_bf16 v[228:231], a[176:179], a[216:219], v[228:231]
    s_mul_i32 s53, s31, 11
    v_exp_f32 v205, v205
    v_mfma_f32_16x16x32_bf16 v[228:231], a[180:183], a[220:223], v[228:231]
    ds_read_b128 v[200:203], v244 offset:192
    v_cvt_pk_bf16_f32 v191, v204, v205
    v_mfma_f32_16x16x32_bf16 v[228:231], a[184:187], a[224:227], v[228:231]
    s_add_u32 s52, s52, s53
    v_exp_f32 v206, v206
    v_mfma_f32_16x16x32_bf16 v[212:215], v[4:7], v[188:191], v[212:215]
    s_add_u32 s52, s52, s32
    v_exp_f32 v207, v207
    v_mfma_f32_16x16x32_bf16 v[216:219], v[34:37], v[188:191], v[216:219]
    s_waitcnt lgkmcnt(4)
    v_cvt_pk_bf16_f32 v194, v206, v207
    v_cvt_pk_bf16_f32 v236, v236, v237
    v_mfma_f32_16x16x32_bf16 v[220:223], v[64:67], v[188:191], v[220:223]
    buffer_store_dwordx4 a[252:255], v250, s[20:23], s55 offen nt
    v_mfma_f32_16x16x32_bf16 v[224:227], a[248:251], v[188:191], v[224:227]
    s_waitcnt lgkmcnt(3)
    ds_read_b128 a[252:255], v252 offset:24576
    v_mfma_f32_16x16x32_bf16 v[212:215], v[8:11], v[192:195], v[212:215]
    ds_read_b128 a[236:239], v243 offset:0
    v_cvt_pk_bf16_f32 v237, v238, v239
    v_mfma_f32_16x16x32_bf16 v[216:219], v[38:41], v[192:195], v[216:219]
    buffer_store_dwordx2 v[254:255], v251, s[20:23], s55 offen offset:256 nt
    v_mfma_f32_16x16x32_bf16 v[220:223], v[68:71], v[192:195], v[220:223]
    ds_read_b64 v[254:255], v253 offset:24832
    ds_read_b128 v[204:207], v245 offset:192
    v_mfma_f32_16x16x32_bf16 v[224:227], a[248:251], v[192:195], v[224:227]
    s_mul_i32 s55, s31, 3
    v_exp_f32 v208, v208
    v_mfma_f32_16x16x32_bf16 v[228:231], a[188:191], a[228:231], v[228:231]
    s_waitcnt lgkmcnt(4)
    v_exp_f32 v209, v209
    v_mfma_f32_16x16x32_bf16 v[200:203], v[114:117], v[168:171], v[200:203]
    s_add_u32 s54, s54, s55
    v_cvt_pk_bf16_f32 v180, v208, v209
    v_add_u32 v208, 0xffffff40, v244
    v_mfma_f32_16x16x32_bf16 v[200:203], v[116:119], v[170:173], v[200:203]
    s_add_u32 s54, s54, s32
    v_cvt_pk_bf16_f32 v228, v228, v229
    v_cvt_pk_bf16_f32 v229, v230, v231
    v_mfma_f32_16x16x32_bf16 v[232:235], a[192:195], a[240:243], 0
    ds_read_b128 a[240:243], v242 offset:128
    v_cndmask_b32 v244, v244, v208, vcc
    v_mfma_f32_16x16x32_bf16 v[232:235], a[196:199], a[244:247], v[232:235]
    ds_read_b128 a[244:247], v243 offset:128
    v_add_u32 v209, 0xffffff40, v245
    v_mfma_f32_16x16x32_bf16 v[232:235], a[200:203], a[216:219], v[232:235]
    ds_read_b128 a[216:219], v242 offset:256
    v_mov_b32 v185, 0
    v_mfma_f32_16x16x32_bf16 v[232:235], a[204:207], a[220:223], v[232:235]
    ds_read_b128 a[220:223], v243 offset:256
    s_waitcnt lgkmcnt(5)
    v_mfma_f32_16x16x32_bf16 v[232:235], a[208:211], a[224:227], v[232:235]
    s_barrier
    v_mfma_f32_16x16x32_bf16 v[232:235], a[212:215], a[228:231], v[232:235]
    s_waitcnt lgkmcnt(4)
    v_exp_f32 v200, v200
    v_mfma_f32_16x16x32_bf16 v[204:207], v[150:153], v[168:171], v[204:207]
    ds_write_b64 v249, v[236:237] offset:12288
    v_mfma_f32_16x16x32_bf16 v[204:207], v[152:155], v[170:173], v[204:207]
    ds_write_b64 v249, v[228:229] offset:12416
    v_mfma_f32_16x16x32_bf16 v[236:239], a[144:147], a[232:235], 0
    s_mov_b32 vcc_lo, 0xff00ff
    v_cvt_pk_bf16_f32 v232, v232, v233
    v_cvt_pk_bf16_f32 v233, v234, v235
    v_mfma_f32_16x16x32_bf16 v[236:239], a[148:151], a[236:239], v[236:239]
    s_waitcnt lgkmcnt(5)
    v_exp_f32 v201, v201
    v_mfma_f32_16x16x32_bf16 v[236:239], a[152:155], a[240:243], v[236:239]
    s_waitcnt lgkmcnt(4)
    v_cvt_pk_bf16_f32 v186, v200, v201
    v_mov_b32 v190, 0
    v_mfma_f32_16x16x32_bf16 v[236:239], a[156:159], a[244:247], v[236:239]
    s_waitcnt lgkmcnt(3)
    v_exp_f32 v210, v210
    v_mfma_f32_16x16x32_bf16 v[236:239], a[160:163], a[216:219], v[236:239]
    s_waitcnt lgkmcnt(2)
    v_exp_f32 v211, v211
    v_mfma_f32_16x16x32_bf16 v[236:239], a[164:167], a[220:223], v[236:239]
    ds_write_b64 v249, v[232:233] offset:12544
    v_mfma_f32_16x16x32_bf16 v[228:231], a[168:171], a[232:235], 0
    s_mov_b32 vcc_hi, 0xf000ff
    v_exp_f32 v196, v196
    v_mfma_f32_16x16x32_bf16 v[228:231], a[172:175], a[236:239], v[228:231]
    s_add_u32 s51, s28, 3
    v_exp_f32 v197, v197
    v_mfma_f32_16x16x32_bf16 v[228:231], a[176:179], a[240:243], v[228:231]
    ds_read_b128 v[200:203], v244 offset:64
    v_cvt_pk_bf16_f32 v183, v210, v211
    v_mfma_f32_16x16x32_bf16 v[228:231], a[180:183], a[244:247], v[228:231]
    s_add_u32 s53, s28, 7
    v_cvt_pk_bf16_f32 v181, v196, v197
    v_cndmask_b32 v245, v245, v209, vcc
    v_mfma_f32_16x16x32_bf16 v[228:231], a[184:187], a[216:219], v[228:231]
    ds_read_b128 v[208:211], v244 offset:0
    v_cvt_pk_bf16_f32 v236, v236, v237
    v_mfma_f32_16x16x32_bf16 v[212:215], v[12:15], v[180:183], v[212:215]
    s_mul_i32 s51, s51, s30
    v_exp_f32 v198, v198
    v_mfma_f32_16x16x32_bf16 v[216:219], v[42:45], v[180:183], v[216:219]
    s_mul_i32 s53, s53, s30
    v_exp_f32 v199, v199
    v_mfma_f32_16x16x32_bf16 v[220:223], v[72:75], v[180:183], v[220:223]
    ds_read_b128 a[224:227], v242 offset:36864
    v_cvt_pk_bf16_f32 v184, v198, v199
    v_mfma_f32_16x16x32_bf16 v[224:227], a[248:251], v[180:183], v[224:227]
    ds_read_b128 v[196:199], v245 offset:0
    v_cvt_pk_bf16_f32 v237, v238, v239
    v_mfma_f32_16x16x32_bf16 v[228:231], a[188:191], a[220:223], v[228:231]
    s_add_u32 s55, s28, 11
    v_exp_f32 v204, v204
    v_mfma_f32_16x16x32_bf16 v[232:235], a[192:195], a[232:235], 0
    s_mul_i32 s55, s55, s30
    v_exp_f32 v205, v205
    v_mfma_f32_16x16x32_bf16 v[232:235], a[196:199], a[236:239], v[232:235]
    ds_read_b128 a[228:231], v243 offset:36864
    v_cvt_pk_bf16_f32 v187, v204, v205
    v_mfma_f32_16x16x32_bf16 v[232:235], a[200:203], a[240:243], v[232:235]
    ds_read_b128 v[204:207], v245 offset:64
    v_cvt_pk_bf16_f32 v228, v228, v229
    v_mfma_f32_16x16x32_bf16 v[212:215], v[16:19], v[184:187], v[212:215]
    ds_read_b128 a[232:235], v242 offset:36992
    v_cvt_pk_bf16_f32 v229, v230, v231
    v_mfma_f32_16x16x32_bf16 v[216:219], v[46:49], v[184:187], v[216:219]
    ds_read_b128 a[236:239], v243 offset:36992
    v_mov_b32 v193, 0
    v_mfma_f32_16x16x32_bf16 v[220:223], v[76:79], v[184:187], v[220:223]
    ds_read_b128 a[240:243], v242 offset:37120
    s_waitcnt lgkmcnt(8)
    v_mfma_f32_16x16x32_bf16 v[224:227], a[248:251], v[184:187], v[224:227]
    ds_write_b64 v249, v[236:237] offset:18432
    v_mfma_f32_16x16x32_bf16 v[200:203], v[114:117], v[174:177], v[200:203]
    s_waitcnt lgkmcnt(8)
    v_mov_b32 v180, 0
    v_mov_b32 v183, 0
    v_mfma_f32_16x16x32_bf16 v[208:211], v[138:141], v[174:177], v[208:211]
    ds_write_b64 v249, v[228:229] offset:18560
    v_mfma_f32_16x16x32_bf16 v[208:211], v[140:143], v[176:179], v[208:211]
    s_waitcnt lgkmcnt(7)
    v_rcp_f32 v225, v224
    v_mfma_f32_16x16x32_bf16 v[196:199], v[144:147], v[174:177], v[196:199]
    buffer_store_dwordx4 a[252:255], v250, s[20:23], s57 offen nt
    v_mfma_f32_16x16x32_bf16 v[196:199], v[146:149], v[176:179], v[196:199]
    s_waitcnt lgkmcnt(5)
    v_mul_f32 v212, v212, v225
    v_mul_f32 v213, v213, v225
    v_mfma_f32_16x16x32_bf16 v[200:203], v[116:119], v[176:179], v[200:203]
    s_waitcnt lgkmcnt(4)
    v_exp_f32 v208, v208
    v_mfma_f32_16x16x32_bf16 v[204:207], v[150:153], v[174:177], v[204:207]
    s_waitcnt lgkmcnt(3)
    v_exp_f32 v209, v209
    v_mfma_f32_16x16x32_bf16 v[204:207], v[152:155], v[176:179], v[204:207]
    s_waitcnt lgkmcnt(2)
    v_exp_f32 v210, v210
    v_mfma_f32_16x16x32_bf16 v[232:235], a[204:207], a[244:247], v[232:235]
    ds_read_b128 a[244:247], v243 offset:37120
    v_cvt_pk_bf16_f32 v188, v208, v209
    v_mfma_f32_16x16x32_bf16 v[232:235], a[208:211], a[216:219], v[232:235]
    ds_read_b128 a[216:219], v242 offset:43008
    v_mul_f32 v214, v214, v225
    v_mfma_f32_16x16x32_bf16 v[232:235], a[212:215], a[220:223], v[232:235]
    ds_read_b128 a[220:223], v243 offset:43008
    v_mul_f32 v215, v215, v225
    v_mfma_f32_16x16x32_bf16 v[236:239], a[144:147], a[224:227], 0
    v_exp_f32 v211, v211
    v_mfma_f32_16x16x32_bf16 v[236:239], a[148:151], a[228:231], v[236:239]
    ds_read_b128 a[252:255], v252 offset:0
    v_cvt_pk_bf16_f32 v191, v210, v211
    v_mfma_f32_16x16x32_bf16 v[236:239], a[152:155], a[232:235], v[236:239]
    ds_read_b128 v[208:211], v244 offset:128
    v_cvt_pk_bf16_f32 v232, v232, v233
    v_mfma_f32_16x16x32_bf16 v[236:239], a[156:159], a[236:239], v[236:239]
    v_cvt_pk_bf16_f32 v233, v234, v235
    v_cvt_pk_bf16_f32 v212, v212, v213
    v_mfma_f32_16x16x32_bf16 v[236:239], a[160:163], a[240:243], v[236:239]
    ds_write_b64 v249, v[232:233] offset:18688
    v_mfma_f32_16x16x32_bf16 v[228:231], a[168:171], a[224:227], 0
    s_waitcnt lgkmcnt(5)
    v_exp_f32 v196, v196
    v_mfma_f32_16x16x32_bf16 v[236:239], a[164:167], a[244:247], v[236:239]
    buffer_store_dwordx2 v[254:255], v251, s[20:23], s57 offen offset:256 nt
    v_mfma_f32_16x16x32_bf16 v[228:231], a[172:175], a[228:231], v[228:231]
    ds_read_b64 v[254:255], v253 offset:256
    v_cvt_pk_bf16_f32 v213, v214, v215
    v_mfma_f32_16x16x32_bf16 v[228:231], a[176:179], a[232:235], v[228:231]
    s_mul_i32 s57, s31, 7
    v_exp_f32 v197, v197
    v_mfma_f32_16x16x32_bf16 v[228:231], a[180:183], a[236:239], v[228:231]
    s_add_u32 s56, s56, s57
    v_cvt_pk_bf16_f32 v236, v236, v237
    v_cvt_pk_bf16_f32 v237, v238, v239
    v_mfma_f32_16x16x32_bf16 v[228:231], a[184:187], a[240:243], v[228:231]
    ds_write_b64 v249, v[236:237] offset:24576
    v_mfma_f32_16x16x32_bf16 v[228:231], a[188:191], a[244:247], v[228:231]
    s_waitcnt lgkmcnt(6)
    v_exp_f32 v198, v198
    v_mfma_f32_16x16x32_bf16 v[232:235], a[192:195], a[224:227], 0
    ds_read_b128 a[224:227], v242 offset:43136
    v_cvt_pk_bf16_f32 v189, v196, v197
    v_mfma_f32_16x16x32_bf16 v[232:235], a[196:199], a[228:231], v[232:235]
    ds_read_b128 a[228:231], v243 offset:43136
    v_mul_f32 v216, v216, v225
    v_mfma_f32_16x16x32_bf16 v[232:235], a[200:203], a[232:235], v[232:235]
    ds_read_b128 a[232:235], v242 offset:43264
    v_cvt_pk_bf16_f32 v228, v228, v229
    v_mfma_f32_16x16x32_bf16 v[232:235], a[204:207], a[236:239], v[232:235]
    ds_read_b128 a[236:239], v243 offset:43264
    v_cvt_pk_bf16_f32 v229, v230, v231
    v_mfma_f32_16x16x32_bf16 v[232:235], a[208:211], a[240:243], v[232:235]
    ds_write_b64 v249, v[228:229] offset:24704
    v_mfma_f32_16x16x32_bf16 v[232:235], a[212:215], a[244:247], v[232:235]
    s_waitcnt lgkmcnt(7)
    v_exp_f32 v199, v199
    v_mfma_f32_16x16x32_bf16 v[208:211], v[120:123], v[174:177], v[208:211]
    s_add_u32 s56, s56, s32
    v_cvt_pk_bf16_f32 v192, v198, v199
    v_mul_f32 v217, v217, v225
    v_mfma_f32_16x16x32_bf16 v[208:211], v[122:125], v[176:179], v[208:211]
    ds_read_b128 v[196:199], v245 offset:128
    v_mul_f32 v218, v218, v225
    v_mfma_f32_16x16x32_bf16 v[236:239], a[144:147], a[216:219], 0
    ds_write_b64 v247, v[212:213] offset:49152
    v_mfma_f32_16x16x32_bf16 v[212:215], v[12:15], v[188:191], 0
    s_waitcnt lgkmcnt(8)
    v_mul_f32 v219, v219, v225
    v_cvt_pk_bf16_f32 v216, v216, v217
    v_mfma_f32_16x16x32_bf16 v[236:239], a[148:151], a[220:223], v[236:239]
    s_waitcnt lgkmcnt(6)
    v_cvt_pk_bf16_f32 v217, v218, v219
    v_mul_f32 v220, v220, v225
    v_mfma_f32_16x16x32_bf16 v[236:239], a[152:155], a[224:227], v[236:239]
    s_waitcnt lgkmcnt(5)
    v_mul_f32 v221, v221, v225
    v_mul_f32 v222, v222, v225
    v_mfma_f32_16x16x32_bf16 v[236:239], a[156:159], a[228:231], v[236:239]
    ds_write_b64 v247, v[216:217] offset:49280
    v_mfma_f32_16x16x32_bf16 v[216:219], v[42:45], v[188:191], 0
    s_add_u32 s57, s28, 11
    v_mul_f32 v223, v223, v225
    v_cvt_pk_bf16_f32 v220, v220, v221
    v_mfma_f32_16x16x32_bf16 v[228:231], a[168:171], a[216:219], 0
    s_waitcnt lgkmcnt(5)
    v_cvt_pk_bf16_f32 v221, v222, v223
    v_max3_f32 v248, v248, v224, v225
    v_mfma_f32_16x16x32_bf16 v[224:227], a[248:251], v[188:191], 0
    ds_write_b64 v247, v[220:221] offset:49408
    v_mfma_f32_16x16x32_bf16 v[220:223], v[72:75], v[188:191], 0
    buffer_store_dwordx4 a[252:255], v250, s[20:23], s52 offen nt
    v_mfma_f32_16x16x32_bf16 v[236:239], a[160:163], a[232:235], v[236:239]
    s_waitcnt lgkmcnt(4)
    v_cvt_pk_bf16_f32 v232, v232, v233
    v_cvt_pk_bf16_f32 v233, v234, v235
    v_mfma_f32_16x16x32_bf16 v[236:239], a[164:167], a[236:239], v[236:239]
    ds_read_b128 a[252:255], v252 offset:6144
    s_waitcnt lgkmcnt(4)
    v_mfma_f32_16x16x32_bf16 v[196:199], v[156:159], v[174:177], v[196:199]
    buffer_store_dwordx2 v[254:255], v251, s[20:23], s52 offen offset:256 nt
    v_mfma_f32_16x16x32_bf16 v[196:199], v[158:161], v[176:179], v[196:199]
    ds_read_b64 v[254:255], v253 offset:6400
    v_mov_b32 v186, 0
    v_mfma_f32_16x16x32_bf16 v[228:231], a[172:175], a[220:223], v[228:231]
    ds_write_b64 v249, v[232:233] offset:24832
    v_mfma_f32_16x16x32_bf16 v[228:231], a[176:179], a[224:227], v[228:231]
    s_mul_i32 s52, s31, 15
    v_exp_f32 v200, v200
    v_mfma_f32_16x16x32_bf16 v[228:231], a[180:183], a[228:231], v[228:231]
    s_add_u32 s51, s51, s52
    v_exp_f32 v201, v201
    v_mfma_f32_16x16x32_bf16 v[228:231], a[184:187], a[232:235], v[228:231]
    s_add_u32 s51, s51, s32
    v_exp_f32 v204, v204
    v_mfma_f32_16x16x32_bf16 v[228:231], a[188:191], a[236:239], v[228:231]
    s_mul_i32 s57, s57, s30
    v_exp_f32 v205, v205
    v_mfma_f32_16x16x32_bf16 v[232:235], a[192:195], a[216:219], 0
    s_and_b32 s52, s28, 1
    v_cvt_pk_bf16_f32 v194, v200, v201
    v_cvt_pk_bf16_f32 v195, v204, v205
    v_mfma_f32_16x16x32_bf16 v[232:235], a[196:199], a[220:223], v[232:235]
    s_add_u32 s52, s52, 15
    v_exp_f32 v202, v202
    v_mfma_f32_16x16x32_bf16 v[212:215], v[16:19], v[192:195], v[212:215]
    s_waitcnt lgkmcnt(2)
    v_exp_f32 v203, v203
    v_mfma_f32_16x16x32_bf16 v[216:219], v[46:49], v[192:195], v[216:219]
    s_mul_i32 s52, s52, s30
    v_exp_f32 v206, v206
    v_mfma_f32_16x16x32_bf16 v[220:223], v[76:79], v[192:195], v[220:223]
    s_waitcnt lgkmcnt(0)
    s_barrier
    v_mfma_f32_16x16x32_bf16 v[224:227], a[248:251], v[192:195], v[224:227]
    ds_read_b128 a[240:243], v242 offset:49152
    ds_read_b128 a[244:247], v243 offset:49152
    v_mfma_f32_16x16x32_bf16 v[232:235], a[200:203], a[224:227], v[232:235]
    ds_read_b128 a[216:219], v242 offset:49280
    ds_read_b128 a[220:223], v243 offset:49280
    v_mfma_f32_16x16x32_bf16 v[232:235], a[204:207], a[228:231], v[232:235]
    ds_read_b128 a[224:227], v242 offset:49408
    ds_read_b128 a[228:231], v243 offset:49408
    v_mfma_f32_16x16x32_bf16 v[232:235], a[208:211], a[232:235], v[232:235]
    v_exp_f32 v207, v207
    v_mfma_f32_16x16x32_bf16 v[232:235], a[212:215], a[236:239], v[232:235]
    v_exp_f32 v208, v208
    v_exp_f32 v209, v209
    v_exp_f32 v210, v210
    v_exp_f32 v211, v211
    v_exp_f32 v196, v196
    v_exp_f32 v197, v197
    v_exp_f32 v198, v198
    v_exp_f32 v199, v199
    v_cvt_pk_bf16_f32 v181, v202, v203
    v_cvt_pk_bf16_f32 v182, v206, v207
    v_cvt_pk_bf16_f32 v184, v208, v209
    v_cvt_pk_bf16_f32 v187, v210, v211
    v_mfma_f32_16x16x32_bf16 v[212:215], v[20:23], v[180:183], v[212:215]
    s_waitcnt lgkmcnt(5)
    v_cvt_pk_bf16_f32 v185, v196, v197
    v_cvt_pk_bf16_f32 v188, v198, v199
    v_mfma_f32_16x16x32_bf16 v[216:219], v[50:53], v[180:183], v[216:219]
    s_waitcnt lgkmcnt(4)
    v_mov_b32 v189, 0
    v_mov_b32 v191, 0
    v_mfma_f32_16x16x32_bf16 v[220:223], v[80:83], v[180:183], v[220:223]
    buffer_store_dwordx4 a[252:255], v250, s[20:23], s54 offen nt
    v_mfma_f32_16x16x32_bf16 v[224:227], a[248:251], v[180:183], v[224:227]
    s_waitcnt lgkmcnt(1)
    ds_read_b128 a[252:255], v252 offset:12288
    v_mfma_f32_16x16x32_bf16 v[212:215], v[24:27], v[184:187], v[212:215]
    s_waitcnt lgkmcnt(1)
    v_cvt_pk_bf16_f32 v236, v236, v237
    v_cvt_pk_bf16_f32 v228, v228, v229
    v_mfma_f32_16x16x32_bf16 v[216:219], v[54:57], v[184:187], v[216:219]
    v_cvt_pk_bf16_f32 v232, v232, v233
L_h9:
    s_cbranch_execz L_hback
    v_cvt_pk_bf16_f32 v237, v238, v239
    v_mfma_f32_16x16x32_bf16 v[220:223], v[84:87], v[184:187], v[220:223]
    buffer_store_dwordx2 v[254:255], v251, s[20:23], s54 offen offset:256 nt
    v_mfma_f32_16x16x32_bf16 v[224:227], a[248:251], v[184:187], v[224:227]
    s_mul_i32 s54, s31, 13
    v_cvt_pk_bf16_f32 v229, v230, v231
    v_cvt_pk_bf16_f32 v233, v234, v235
    v_mfma_f32_16x16x32_bf16 v[212:215], v[28:31], v[188:191], v[212:215]
    ds_read_b64 v[254:255], v253 offset:12544
    s_add_u32 s53, s53, s54
    v_mfma_f32_16x16x32_bf16 v[216:219], v[58:61], v[188:191], v[216:219]
    ds_write_b64 v249, v[236:237] offset:0
    v_mfma_f32_16x16x32_bf16 v[220:223], v[88:91], v[188:191], v[220:223]
    ds_write_b64 v249, v[228:229] offset:128
    v_mfma_f32_16x16x32_bf16 v[224:227], a[248:251], v[188:191], v[224:227]
    ds_write_b64 v249, v[232:233] offset:256
    s_waitcnt lgkmcnt(4)
    buffer_store_dwordx4 a[252:255], v250, s[20:23], s56 offen nt
    s_add_u32 s53, s53, s32
    s_lshr_b32 s54, s28, 1
    ds_read_b128 a[252:255], v252 offset:18432
    s_sub_u32 s54, s54, 1
    s_nop 0
    v_rcp_f32 v225, v224
    v_mov_b32 v226, 0x5d800000
    v_mul_f32 v212, v212, v225
    v_mul_f32 v213, v213, v225
    v_mul_f32 v214, v214, v225
    v_mul_f32 v215, v215, v225
    v_cvt_pk_bf16_f32 v212, v212, v213
    v_mul_f32 v216, v216, v225
    v_mul_f32 v217, v217, v225
    v_cvt_pk_bf16_f32 v213, v214, v215
    v_mul_f32 v218, v218, v225
    v_mul_f32 v219, v219, v225
    v_cvt_pk_bf16_f32 v216, v216, v217
    v_mul_f32 v220, v220, v225
    v_mul_f32 v221, v221, v225
    ds_write_b64 v247, v[212:213] offset:55296
    v_cvt_pk_bf16_f32 v217, v218, v219
    v_mul_f32 v222, v222, v225
    v_mul_f32 v223, v223, v225
    v_cvt_pk_bf16_f32 v220, v220, v221
    ds_write_b64 v247, v[216:217] offset:55424
    v_cvt_pk_bf16_f32 v221, v222, v223
    ds_write_b64 v247, v[220:221] offset:55552
    v_mfma_f32_16x16x32_bf16 v[236:239], a[144:147], a[240:243], 0
    s_waitcnt lgkmcnt(5)
    v_max3_f32 v248, v248, v224, v225
    v_cmp_gt_f32 vcc, v248, v226
    v_mfma_f32_16x16x32_bf16 v[236:239], a[148:151], a[244:247], v[236:239]
    s_waitcnt lgkmcnt(3)
    s_cmp_lg_u64 vcc, 0
    s_cselect_b32 s66, 1, 0
    v_mov_b32 v225, s66
    v_mfma_f32_16x16x32_bf16 v[236:239], a[152:155], a[216:219], v[236:239]
    v_mov_b32 v226, s67
    v_mfma_f32_16x16x32_bf16 v[236:239], a[156:159], a[220:223], v[236:239]
    ds_write_b32 v226, v225 offset:0
    v_mfma_f32_16x16x32_bf16 v[236:239], a[160:163], a[224:227], v[236:239]
    buffer_store_dwordx2 v[254:255], v251, s[20:23], s56 offen offset:256 nt
    v_mfma_f32_16x16x32_bf16 v[236:239], a[164:167], a[228:231], v[236:239]
    ds_read_b64 v[254:255], v253 offset:18688
    v_mov_b32 v226, 0x23000
    v_mfma_f32_16x16x32_bf16 v[228:231], a[168:171], a[240:243], 0
    s_mul_i32 s56, s31, 11
    s_add_u32 s55, s55, s56
    s_add_u32 s55, s55, s32
    v_mfma_f32_16x16x32_bf16 v[228:231], a[172:175], a[244:247], v[228:231]
    s_lshr_b32 s56, s28, 1
    v_cvt_pk_bf16_f32 v236, v236, v237
    v_cvt_pk_bf16_f32 v237, v238, v239
    v_mfma_f32_16x16x32_bf16 v[228:231], a[176:179], a[216:219], v[228:231]
    ds_write_b64 v249, v[236:237] offset:6144
    v_mfma_f32_16x16x32_bf16 v[228:231], a[180:183], a[220:223], v[228:231]
    s_mov_b32 exec_hi, 0
    buffer_store_dwordx4 a[252:255], v250, s[20:23], s51 offen nt
    s_mov_b32 exec_hi, -1
    v_mfma_f32_16x16x32_bf16 v[228:231], a[184:187], a[224:227], v[228:231]
    s_waitcnt lgkmcnt(2)
    s_barrier
    v_mfma_f32_16x16x32_bf16 v[228:231], a[188:191], a[228:231], v[228:231]
    ds_read_b128 a[232:235], v242 offset:55296
    ds_read_b128 a[236:239], v243 offset:55296
    v_mfma_f32_16x16x32_bf16 v[232:235], a[192:195], a[240:243], 0
    ds_read_b128 a[240:243], v242 offset:55424
    s_waitcnt lgkmcnt(4)
    v_mfma_f32_16x16x32_bf16 v[232:235], a[196:199], a[244:247], v[232:235]
    ds_read_b128 a[244:247], v243 offset:55424
    ds_read_b128 v[196:199], v226 offset:0
    v_mfma_f32_16x16x32_bf16 v[232:235], a[200:203], a[216:219], v[232:235]
    ds_read_b128 a[216:219], v242 offset:55552
    v_cvt_pk_bf16_f32 v228, v228, v229
    v_mfma_f32_16x16x32_bf16 v[232:235], a[204:207], a[220:223], v[232:235]
    ds_read_b128 a[220:223], v243 offset:55552
    v_cvt_pk_bf16_f32 v229, v230, v231
    v_mfma_f32_16x16x32_bf16 v[232:235], a[208:211], a[224:227], v[232:235]
    ds_write_b64 v249, v[228:229] offset:6272
    v_mfma_f32_16x16x32_bf16 v[232:235], a[212:215], a[228:231], v[232:235]
    s_mov_b32 exec_lo, 0
    buffer_store_dwordx4 a[252:255], v250, s[20:23], s53 offen nt
    s_mov_b32 exec_lo, -1
    s_waitcnt lgkmcnt(7)
    v_mfma_f32_16x16x32_bf16 v[236:239], a[144:147], a[232:235], 0
    ds_read_b128 a[252:255], v252 offset:24576
    s_waitcnt lgkmcnt(7)
    v_mfma_f32_16x16x32_bf16 v[236:239], a[148:151], a[236:239], v[236:239]
    s_lshl2_add_u32 s56, s56, 11
    s_mul_i32 s56, s56, s31
    v_cvt_pk_bf16_f32 v232, v232, v233
    v_mfma_f32_16x16x32_bf16 v[228:231], a[168:171], a[232:235], 0
    s_waitcnt lgkmcnt(6)
    v_cvt_pk_bf16_f32 v233, v234, v235
    v_mfma_f32_16x16x32_bf16 v[236:239], a[152:155], a[240:243], v[236:239]
    ds_write_b64 v249, v[232:233] offset:6400
    v_mfma_f32_16x16x32_bf16 v[228:231], a[172:175], a[236:239], v[228:231]
    s_mov_b32 exec_hi, 0
    buffer_store_dwordx2 v[254:255], v251, s[20:23], s51 offen offset:256 nt
    s_mov_b32 exec_hi, -1
    v_mfma_f32_16x16x32_bf16 v[228:231], a[176:179], a[240:243], v[228:231]
    s_waitcnt lgkmcnt(6)
    s_mul_i32 s51, s31, 15
    s_add_u32 s57, s57, s51
    v_mfma_f32_16x16x32_bf16 v[236:239], a[156:159], a[244:247], v[236:239]
    s_waitcnt lgkmcnt(4)
    s_add_u32 s57, s57, s32
    v_or3_b32 v225, v196, v197, v198
    v_mfma_f32_16x16x32_bf16 v[236:239], a[160:163], a[216:219], v[236:239]
    s_waitcnt lgkmcnt(3)
    v_or_b32 v225, v225, v199
    v_mfma_f32_16x16x32_bf16 v[236:239], a[164:167], a[220:223], v[236:239]
    s_mov_b32 exec_lo, 0
    buffer_store_dwordx2 v[254:255], v251, s[20:23], s53 offen offset:256 nt
    s_mov_b32 exec_lo, -1
    v_mfma_f32_16x16x32_bf16 v[228:231], a[180:183], a[244:247], v[228:231]
    ds_read_b64 v[254:255], v253 offset:24832
    s_waitcnt lgkmcnt(2)
    v_mfma_f32_16x16x32_bf16 v[228:231], a[184:187], a[216:219], v[228:231]
    s_lshr_b32 s53, s28, 1
    v_readfirstlane_b32 s47, v225
    s_waitcnt lgkmcnt(1)
    v_mfma_f32_16x16x32_bf16 v[228:231], a[188:191], a[220:223], v[228:231]
    s_barrier
    v_mfma_f32_16x16x32_bf16 v[232:235], a[192:195], a[232:235], 0
    buffer_store_dwordx4 a[252:255], v250, s[20:23], s55 offen nt
    v_mfma_f32_16x16x32_bf16 v[232:235], a[196:199], a[236:239], v[232:235]
    s_lshl2_add_u32 s53, s53, 3
    v_cvt_pk_bf16_f32 v236, v236, v237
    v_cvt_pk_bf16_f32 v237, v238, v239
    v_mfma_f32_16x16x32_bf16 v[232:235], a[200:203], a[240:243], v[232:235]
    ds_read_b128 a[252:255], v252 offset:0
    v_cvt_pk_bf16_f32 v228, v228, v229
    v_mfma_f32_16x16x32_bf16 v[232:235], a[204:207], a[244:247], v[232:235]
    s_waitcnt lgkmcnt(1)
    v_cvt_pk_bf16_f32 v229, v230, v231
    s_mul_i32 s53, s53, s31
    v_mfma_f32_16x16x32_bf16 v[232:235], a[208:211], a[216:219], v[232:235]
    buffer_store_dwordx2 v[254:255], v251, s[20:23], s55 offen offset:256 nt
    v_mfma_f32_16x16x32_bf16 v[232:235], a[212:215], a[220:223], v[232:235]
    ds_write_b64 v249, v[236:237] offset:12288
    ds_write_b64 v249, v[228:229] offset:12416
    ds_read_b64 v[254:255], v253 offset:256
    s_and_b32 s55, s28, 1
    s_add_u32 s55, s55, 15
    s_mul_i32 s55, s55, s30
    s_add_u32 s52, s52, s53
    s_add_u32 s55, s55, s56
    v_cvt_pk_bf16_f32 v232, v232, v233
    v_cvt_pk_bf16_f32 v233, v234, v235
    ds_write_b64 v249, v[232:233] offset:12544
    s_waitcnt lgkmcnt(4)
    s_mov_b32 exec_hi, 0
    buffer_store_dwordx4 a[252:255], v250, s[20:23], s57 offen nt
    s_mov_b32 exec_hi, -1
    s_add_u32 s52, s52, s32
    s_add_u32 s55, s55, s32
    ds_read_b128 a[252:255], v252 offset:6144
    s_waitcnt lgkmcnt(2)
    s_mov_b32 exec_hi, 0
    buffer_store_dwordx2 v[254:255], v251, s[20:23], s57 offen offset:256 nt
    s_mov_b32 exec_hi, -1
    ds_read_b64 v[254:255], v253 offset:6400
    s_waitcnt lgkmcnt(2)
    s_barrier
    ds_read_b128 a[8:11], v252 offset:12288
    ds_read_b64 a[12:13], v253 offset:12544
    s_waitcnt lgkmcnt(3)
    buffer_store_dwordx4 a[252:255], v250, s[20:23], s52 offen nt
    s_waitcnt lgkmcnt(2)
    buffer_store_dwordx2 v[254:255], v251, s[20:23], s52 offen offset:256 nt
    s_waitcnt lgkmcnt(1)
    s_waitcnt lgkmcnt(0)
    s_mov_b32 exec_hi, s54
    buffer_store_dwordx4 a[8:11], v250, s[20:23], s55 offen nt
    s_mov_b32 exec_hi, -1
    s_mov_b32 exec_hi, s54
    buffer_store_dwordx2 a[12:13], v251, s[20:23], s55 offen offset:256 nt
    s_mov_b32 exec_hi, -1
    s_nop 4
    s_cmp_lg_u32 s47, 0
    s_cbranch_scc1 L_safe
L_exit:
    s_endpgm
L_safe:
    s_waitcnt vmcnt(0) lgkmcnt(0)
    s_nop 7
    s_barrier
    v_mbcnt_lo_u32_b32 v1, -1, 0
    v_mbcnt_hi_u32_b32 v1, -1, v1
    s_lshl_b32 s51, s28, 1
    s_add_u32 s50, s31, 0xfffffe80
    s_mul_i32 s52, s36, 0x1d00
    v_lshrrev_b32 v2, 3, v1
    v_and_b32 v3, 7, v1
    v_xor_b32 v3, s51, v3
    v_lshl_add_u32 v4, v2, 7, s52
    v_mul_u32_u24 v8, 11, v2
    v_bfe_u32 v9, v8, 6, 1
    v_lshrrev_b32 v8, 5, v8
    v_xor_b32 v9, v3, v9
    v_mad_i32_i24 v8, v8, s50, v4
    v_lshl_add_u32 v168, v9, 4, v8
    v_add_u32 v8, 8, v2
    v_mul_u32_u24 v8, 11, v8
    v_bfe_u32 v9, v8, 6, 1
    v_lshrrev_b32 v8, 5, v8
    v_xor_b32 v9, v3, v9
    v_mad_i32_i24 v8, v8, s50, v4
    v_lshl_add_u32 v169, v9, 4, v8
    v_add_u32 v8, 16, v2
    v_mul_u32_u24 v8, 11, v8
    v_bfe_u32 v9, v8, 6, 1
    v_lshrrev_b32 v8, 5, v8
    v_xor_b32 v9, v3, v9
    v_mad_i32_i24 v8, v8, s50, v4
    v_lshl_add_u32 v170, v9, 4, v8
    s_movk_i32 s53, 0x480
    s_movk_i32 s54, -96
    v_lshrrev_b32 v10, 1, v1
    v_lshlrev_b32 v12, 4, v1
    v_mul_u32_u24 v8, 43, v10
    v_lshrrev_b32 v9, 8, v8
    v_lshrrev_b32 v8, 7, v8
    v_and_b32 v9, 4, v9
    v_xor_b32 v9, v8, v9
    v_mad_i32_i24 v8, v8, s54, v12
    v_mad_u32_u24 v172, v9, s53, v8
    v_add_u32 v8, 32, v10
    v_mul_u32_u24 v8, 43, v8
    v_lshrrev_b32 v9, 8, v8
    v_lshrrev_b32 v8, 7, v8
    v_and_b32 v9, 4, v9
    v_xor_b32 v9, v8, v9
    v_mad_i32_i24 v8, v8, s54, v12
    v_mad_u32_u24 v173, v9, s53, v8
    v_add_u32 v8, 64, v10
    v_mul_u32_u24 v8, 43, v8
    v_lshrrev_b32 v9, 8, v8
    v_lshrrev_b32 v8, 7, v8
    v_and_b32 v9, 4, v9
    v_xor_b32 v9, v8, v9
    v_mad_i32_i24 v8, v8, s54, v12
    v_mad_u32_u24 v174, v9, s53, v8
L_safe2:
    s_add_u32 s59, s40, s45
    s_add_u32 m0, s46, 0xc00
    s_add_u32 s60, s39, 0x180
    buffer_load_dwordx4 v168, s[4:7], s59 offen lds
    s_add_u32 m0, s29, 0
    s_add_u32 s52, s40, 0
    buffer_load_dwordx4 v172, s[8:11], s60 offen lds
    s_add_u32 m0, s46, 0xc00
    v_add_u32 v5, s52, v168
    buffer_load_dwordx4 v169, s[4:7], s59 offen offset:1024 lds
    s_add_u32 m0, s29, 0
    v_max_i32 v5, 0, v5
    buffer_load_dwordx4 v173, s[8:11], s60 offen offset:1024 lds
    s_add_u32 m0, s46, 0xc00
    s_add_u32 s53, s40, 0x400
    buffer_load_dwordx4 v170, s[4:7], s59 offen offset:2048 lds
    s_add_u32 m0, s29, 0
    v_add_u32 v6, s53, v169
    buffer_load_dwordx4 v174, s[8:11], s60 offen offset:2048 lds
    s_add_u32 m0, s46, 0
    v_max_i32 v6, 0, v6
    buffer_load_dwordx4 v5, s[4:7], 0 offen lds
    s_add_u32 m0, s46, 0x400
    s_add_u32 s54, s40, 0x800
    buffer_load_dwordx4 v6, s[4:7], 0 offen lds
    v_add_u32 v7, s54, v170
    v_max_i32 v7, 0, v7
    s_add_u32 m0, s46, 0x800
    s_add_u32 s61, s39, 0x9180
    buffer_load_dwordx4 v7, s[4:7], 0 offen lds
    s_add_u32 m0, s29, 0xc00
    s_add_u32 s62, s39, 0x12180
    buffer_load_dwordx4 v172, s[8:11], s61 offen lds
    buffer_load_dwordx4 v173, s[8:11], s61 offen offset:1024 lds
    buffer_load_dwordx4 v174, s[8:11], s61 offen offset:2048 lds
    s_add_u32 m0, s29, 0x1800
    s_add_u32 s63, s39, 0x1b180
    s_add_u32 s59, s41, s45
    s_add_u32 s60, s39, 0x24180
    s_add_u32 s61, s39, 0x2d180
    s_and_b32 s65, s48, 0xfff0
    s_lshl1_add_u32 s58, s45, s40
    v_and_b32 v13, 15, v1
    v_lshrrev_b32 v14, 4, v1
    v_lshrrev_b32 v15, 2, v13
    v_and_b32 v16, 3, v13
    v_and_b32 v17, 1, v14
    v_lshl_add_u32 v18, v14, 3, v15
    v_xor_b32 v19, 0, v17
    v_lshl_add_u32 v19, v19, 2, v18
    v_mul_u32_u24 v19, 0x60, v19
    v_lshl_add_u32 v19, v16, 3, v19
    v_add_u32 v249, s29, v19
    v_xor_b32 v19, 1, v17
    v_lshl_add_u32 v19, v19, 2, v18
    v_mul_u32_u24 v19, 0x60, v19
    v_lshl_add_u32 v19, v16, 3, v19
    v_add_u32 v250, s29, v19
    v_mov_b32 v17, v15
    v_and_b32 v18, 3, v17
    v_mul_u32_u24 v17, 0x1e00, v17
    v_lshlrev_b32 v18, 1, v18
    v_bfe_u32 v241, v16, 1, 1
    v_or_b32 v18, v18, v241
    v_xor_b32 v18, v18, v14
    v_lshl_add_u32 v17, v18, 4, v17
    v_mul_u32_u24 v18, 0x180, v16
    v_add_u32 v240, v17, v18
    v_xor_b32 v241, 64, v240
    s_add_u32 s55, s28, 3
    s_mul_i32 s56, s31, 3
    s_mul_i32 s55, s55, s30
    s_add_u32 s55, s55, s56
    s_add_u32 s55, s55, s32
    s_add_u32 s57, s28, 3
    s_mul_i32 s51, s31, 11
    s_mul_i32 s57, s57, s30
    s_add_u32 s57, s57, s51
    s_add_u32 s57, s57, s32
    s_add_u32 s52, s28, 3
    s_mul_i32 s53, s31, 7
    s_mul_i32 s52, s52, s30
    s_add_u32 s52, s52, s53
    s_add_u32 s52, s52, s32
    s_add_u32 s54, s28, 7
    s_mul_i32 s54, s54, s30
    s_add_u32 s56, s28, 7
    s_mul_i32 s56, s56, s30
    s_add_u32 s51, s28, 7
    s_mul_i32 s51, s51, s30
    s_add_u32 s53, s28, 11
    s_mul_i32 s53, s53, s30
    buffer_load_dwordx4 v172, s[8:11], s62 offen lds
    buffer_load_dwordx4 v173, s[8:11], s62 offen offset:1024 lds
    buffer_load_dwordx4 v174, s[8:11], s62 offen offset:2048 lds
    s_add_u32 m0, s46, 0x7800
    s_add_u32 s62, s39, 0x300
    buffer_load_dwordx4 v168, s[4:7], s41 offen lds
    buffer_load_dwordx4 v169, s[4:7], s41 offen offset:1024 lds
    s_waitcnt vmcnt(12)
    s_barrier
    ds_read_b128 a[216:219], v240 offset:3072
    ds_read_b128 a[220:223], v240 offset:4608
    ds_read_b128 a[240:243], v241 offset:3072
    buffer_load_dwordx4 v170, s[4:7], s41 offen offset:2048 lds
    s_add_u32 m0, s29, 0x2400
    s_waitcnt vmcnt(12)
    ds_read_b64_tr_b16 a[0:1], v249 offset:0
    ds_read_b64_tr_b16 a[2:3], v250 offset:0
    ds_read_b64_tr_b16 a[24:25], v249 offset:32
    ds_read_b64_tr_b16 a[26:27], v250 offset:32
    ds_read_b64_tr_b16 a[48:49], v249 offset:64
    ds_read_b64_tr_b16 a[50:51], v250 offset:64
    ds_read_b128 a[244:247], v241 offset:4608
    buffer_load_dwordx4 v172, s[8:11], s63 offen lds
    buffer_load_dwordx4 v173, s[8:11], s63 offen offset:1024 lds
    s_waitcnt lgkmcnt(5)
    v_mfma_f32_16x16x32_bf16 v[180:183], a[0:3], a[216:219], 0
    v_mfma_f32_16x16x32_bf16 v[192:195], a[0:3], a[220:223], 0
    s_waitcnt lgkmcnt(3)
    v_mfma_f32_16x16x32_bf16 v[184:187], a[24:27], a[216:219], 0
    s_waitcnt lgkmcnt(1)
    v_mfma_f32_16x16x32_bf16 v[188:191], a[48:51], a[216:219], 0
    buffer_load_dwordx4 v174, s[8:11], s63 offen offset:2048 lds
    s_add_u32 m0, s46, 0x8400
    v_mfma_f32_16x16x32_bf16 v[196:199], a[24:27], a[220:223], 0
    s_add_u32 s63, s39, 0x9300
    s_waitcnt vmcnt(12)
    s_barrier
    v_mfma_f32_16x16x32_bf16 v[200:203], a[48:51], a[220:223], 0
    ds_read_b128 a[224:227], v240 offset:0
    buffer_load_dwordx4 v168, s[4:7], s59 offen lds
    ds_read_b128 a[228:231], v240 offset:1536
    ds_read_b128 a[232:235], v241 offset:0
    ds_read_b128 a[236:239], v241 offset:1536
    ds_read_b128 a[216:219], v240 offset:128
    ds_read_b128 a[220:223], v240 offset:1664
    buffer_load_dwordx4 v169, s[4:7], s59 offen offset:1024 lds
    s_waitcnt lgkmcnt(5)
    v_mfma_f32_16x16x32_bf16 v[204:207], a[0:3], a[224:227], 0
    v_mfma_f32_16x16x32_bf16 v[208:211], a[24:27], a[224:227], 0
    buffer_load_dwordx4 v170, s[4:7], s59 offen offset:2048 lds
    s_add_u32 m0, s29, 0
    v_mfma_f32_16x16x32_bf16 v[212:215], a[48:51], a[224:227], 0
    s_waitcnt vmcnt(12) lgkmcnt(4)
    s_add_u32 s59, s42, s45
    ds_read_b64_tr_b16 a[4:5], v249 offset:3072
    v_mfma_f32_16x16x32_bf16 v[216:219], a[0:3], a[228:231], 0
    ds_read_b64_tr_b16 a[6:7], v250 offset:3072
    ds_read_b64_tr_b16 a[28:29], v249 offset:3104
    v_mfma_f32_16x16x32_bf16 v[220:223], a[24:27], a[228:231], 0
    ds_read_b64_tr_b16 a[30:31], v250 offset:3104
    buffer_load_dwordx4 v172, s[8:11], s60 offen lds
    v_mfma_f32_16x16x32_bf16 v[224:227], a[48:51], a[228:231], 0
    ds_read_b64_tr_b16 a[52:53], v249 offset:3136
    ds_read_b64_tr_b16 a[54:55], v250 offset:3136
    ds_read_b128 a[224:227], v240 offset:3200
    ds_read_b128 a[228:231], v240 offset:4736
    buffer_load_dwordx4 v173, s[8:11], s60 offen offset:1024 lds
    s_waitcnt lgkmcnt(6)
    v_mfma_f32_16x16x32_bf16 v[204:207], a[4:7], a[232:235], v[204:207]
    v_mfma_f32_16x16x32_bf16 v[216:219], a[4:7], a[236:239], v[216:219]
    s_waitcnt lgkmcnt(4)
    v_mfma_f32_16x16x32_bf16 v[208:211], a[28:31], a[232:235], v[208:211]
    buffer_load_dwordx4 v174, s[8:11], s60 offen offset:2048 lds
    s_add_u32 m0, s29, 0xc00
    v_mfma_f32_16x16x32_bf16 v[220:223], a[28:31], a[236:239], v[220:223]
    s_waitcnt vmcnt(12) lgkmcnt(2)
    s_add_u32 s60, s39, 0x12300
    ds_read_b64_tr_b16 a[8:9], v249 offset:6144
    v_mfma_f32_16x16x32_bf16 v[212:215], a[52:55], a[232:235], v[212:215]
    ds_read_b64_tr_b16 a[10:11], v250 offset:6144
    ds_read_b64_tr_b16 a[32:33], v249 offset:6176
    v_mfma_f32_16x16x32_bf16 v[224:227], a[52:55], a[236:239], v[224:227]
    ds_read_b64_tr_b16 a[34:35], v250 offset:6176
    ds_read_b64_tr_b16 a[56:57], v249 offset:6208
    v_mfma_f32_16x16x32_bf16 v[180:183], a[4:7], a[240:243], v[180:183]
    buffer_load_dwordx4 v172, s[8:11], s61 offen lds
    ds_read_b64_tr_b16 a[58:59], v250 offset:6208
    v_mfma_f32_16x16x32_bf16 v[184:187], a[28:31], a[240:243], v[184:187]
    s_waitcnt lgkmcnt(6)
    v_mfma_f32_16x16x32_bf16 v[188:191], a[52:55], a[240:243], v[188:191]
    v_mfma_f32_16x16x32_bf16 v[192:195], a[4:7], a[244:247], v[192:195]
    v_mfma_f32_16x16x32_bf16 v[196:199], a[28:31], a[244:247], v[196:199]
    buffer_load_dwordx4 v173, s[8:11], s61 offen offset:1024 lds
    v_mfma_f32_16x16x32_bf16 v[200:203], a[52:55], a[244:247], v[200:203]
    s_waitcnt lgkmcnt(4)
    v_mfma_f32_16x16x32_bf16 v[204:207], a[8:11], a[216:219], v[204:207]
    v_mfma_f32_16x16x32_bf16 v[216:219], a[8:11], a[220:223], v[216:219]
    s_waitcnt lgkmcnt(2)
    v_mfma_f32_16x16x32_bf16 v[208:211], a[32:35], a[216:219], v[208:211]
    buffer_load_dwordx4 v174, s[8:11], s61 offen offset:2048 lds
    s_add_u32 m0, s37, 0xd80
    v_mfma_f32_16x16x32_bf16 v[220:223], a[32:35], a[220:223], v[220:223]
    s_add_u32 s61, s39, 0x1b300
    s_waitcnt vmcnt(12) lgkmcnt(0)
    s_barrier
    v_mfma_f32_16x16x32_bf16 v[212:215], a[56:59], a[216:219], v[212:215]
    ds_read_b128 a[232:235], v240 offset:30720
    buffer_load_dwordx4 v12, s[16:19], s65 offen lds
    v_mfma_f32_16x16x32_bf16 v[224:227], a[56:59], a[220:223], v[224:227]
    s_add_u32 m0, s29, 0x1800
    ds_read_b128 a[236:239], v240 offset:32256
    v_mfma_f32_16x16x32_bf16 v[180:183], a[8:11], a[224:227], v[180:183]
    ds_read_b128 a[240:243], v241 offset:30720
    ds_read_b128 a[244:247], v241 offset:32256
    v_mfma_f32_16x16x32_bf16 v[184:187], a[32:35], a[224:227], v[184:187]
    ds_read_b128 a[216:219], v240 offset:30848
    ds_read_b128 a[220:223], v240 offset:32384
    v_mfma_f32_16x16x32_bf16 v[188:191], a[56:59], a[224:227], v[188:191]
    buffer_load_dwordx4 v172, s[8:11], s62 offen lds
    ds_read_b128 a[224:227], v241 offset:128
    v_mfma_f32_16x16x32_bf16 v[192:195], a[8:11], a[228:231], v[192:195]
    v_mfma_f32_16x16x32_bf16 v[196:199], a[32:35], a[228:231], v[196:199]
    v_mfma_f32_16x16x32_bf16 v[200:203], a[56:59], a[228:231], v[200:203]
    ds_read_b128 a[228:231], v241 offset:1664
    s_waitcnt lgkmcnt(7)
    v_mfma_f32_16x16x32_bf16 v[228:231], a[0:3], a[232:235], 0
    v_mfma_f32_16x16x32_bf16 v[232:235], a[24:27], a[232:235], 0
    buffer_load_dwordx4 v173, s[8:11], s62 offen offset:1024 lds
    s_waitcnt vmcnt(12) lgkmcnt(6)
    v_mfma_f32_16x16x32_bf16 v[236:239], a[48:51], a[232:235], 0
    ds_read_b64_tr_b16 a[12:13], v249 offset:9216
    ds_read_b64_tr_b16 a[14:15], v250 offset:9216
    v_mfma_f32_16x16x32_bf16 v[138:141], a[0:3], a[236:239], 0
    ds_read_b64_tr_b16 a[36:37], v249 offset:9248
    ds_read_b64_tr_b16 a[38:39], v250 offset:9248
    v_mfma_f32_16x16x32_bf16 v[142:145], a[24:27], a[236:239], 0
    ds_read_b64_tr_b16 a[60:61], v249 offset:9280
    buffer_load_dwordx4 v174, s[8:11], s62 offen offset:2048 lds
    v_mfma_f32_16x16x32_bf16 v[146:149], a[48:51], a[236:239], 0
    s_waitcnt lgkmcnt(9)
    s_add_u32 m0, s29, 0x2400
    s_add_u32 s62, s39, 0x24300
    v_mfma_f32_16x16x32_bf16 v[228:231], a[4:7], a[240:243], v[228:231]
    ds_read_b64_tr_b16 a[62:63], v250 offset:9280
    ds_read_b128 a[232:235], v241 offset:3200
    v_mfma_f32_16x16x32_bf16 v[232:235], a[28:31], a[240:243], v[232:235]
    ds_read_b128 a[236:239], v241 offset:4736
    s_add_u32 s50, s31, 0xfffffe80
    v_mfma_f32_16x16x32_bf16 v[236:239], a[52:55], a[240:243], v[236:239]
    ds_read_b128 a[240:243], v241 offset:30848
    v_add_u32 v8, 4, v2
    v_mfma_f32_16x16x32_bf16 v[138:141], a[4:7], a[244:247], v[138:141]
    s_and_b32 s66, s28, 1
    v_mul_u32_u24 v8, 11, v8
    v_bfe_u32 v9, v8, 6, 1
    v_mfma_f32_16x16x32_bf16 v[142:145], a[28:31], a[244:247], v[142:145]
    s_lshl_b32 s66, s66, 2
    v_lshrrev_b32 v8, 5, v8
    v_xor_b32 v9, v3, v9
    v_mfma_f32_16x16x32_bf16 v[146:149], a[52:55], a[244:247], v[146:149]
    s_waitcnt lgkmcnt(5)
    ds_read_b128 a[244:247], v241 offset:32384
    v_mfma_f32_16x16x32_bf16 v[228:231], a[8:11], a[216:219], v[228:231]
    s_lshr_b32 s67, s28, 1
    s_waitcnt vmcnt(10)
    s_barrier
    v_mfma_f32_16x16x32_bf16 v[232:235], a[32:35], a[216:219], v[232:235]
    s_waitcnt lgkmcnt(3)
    buffer_load_dwordx4 v172, s[8:11], s63 offen lds
    v_mfma_f32_16x16x32_bf16 v[236:239], a[56:59], a[216:219], v[236:239]
    ds_read_b128 a[216:219], v240 offset:33792
    v_mad_i32_i24 v8, v8, s50, v4
    v_mfma_f32_16x16x32_bf16 v[138:141], a[8:11], a[220:223], v[138:141]
    s_lshl_b32 s67, s67, 3
    v_lshl_add_u32 v171, v9, 4, v8
    v_mbcnt_lo_u32_b32 v67, -1, 0
    v_mfma_f32_16x16x32_bf16 v[142:145], a[32:35], a[220:223], v[142:145]
    s_mul_i32 s64, s35, 0xfc0
    v_mbcnt_hi_u32_b32 v67, -1, v67
    v_lshrrev_b32 v68, 1, v67
    v_mfma_f32_16x16x32_bf16 v[146:149], a[56:59], a[220:223], v[146:149]
    buffer_load_dwordx4 v173, s[8:11], s63 offen offset:1024 lds
    ds_read_b128 a[220:223], v240 offset:35328
    v_mfma_f32_16x16x32_bf16 v[204:207], a[12:15], a[224:227], v[204:207]
    s_add_u32 s64, s64, s37
    v_add_u32 v68, 0, v68
    v_mul_u32_u24 v69, 43, v68
    v_mfma_f32_16x16x32_bf16 v[208:211], a[36:39], a[224:227], v[208:211]
    s_waitcnt lgkmcnt(2)
    v_lshrrev_b32 v70, 8, v69
    v_lshrrev_b32 v69, 7, v69
    v_mfma_f32_16x16x32_bf16 v[212:215], a[60:63], a[224:227], v[212:215]
    ds_read_b128 a[224:227], v241 offset:33792
    v_mad_i32_i24 v68, v69, -3, v68
    v_mfma_f32_16x16x32_bf16 v[216:219], a[12:15], a[228:231], v[216:219]
    buffer_load_dwordx4 v174, s[8:11], s63 offen offset:2048 lds
    s_add_u32 m0, s29, 0
    v_mfma_f32_16x16x32_bf16 v[220:223], a[36:39], a[228:231], v[220:223]
    s_add_u32 s63, s39, 0x2d300
    v_and_b32 v70, 4, v70
    v_xor_b32 v69, v69, v70
    v_mfma_f32_16x16x32_bf16 v[224:227], a[60:63], a[228:231], v[224:227]
    ds_read_b128 a[228:231], v241 offset:35328
    s_waitcnt vmcnt(10) lgkmcnt(3)
    v_mfma_f32_16x16x32_bf16 v[180:183], a[12:15], a[232:235], v[180:183]
    ds_read_b64_tr_b16 a[16:17], v249 offset:0
    ds_read_b64_tr_b16 a[18:19], v250 offset:0
    v_mfma_f32_16x16x32_bf16 v[184:187], a[36:39], a[232:235], v[184:187]
    ds_read_b64_tr_b16 a[40:41], v249 offset:32
    ds_read_b64_tr_b16 a[42:43], v250 offset:32
    v_mfma_f32_16x16x32_bf16 v[188:191], a[60:63], a[232:235], v[188:191]
    ds_read_b64_tr_b16 a[64:65], v249 offset:64
    ds_read_b64_tr_b16 a[66:67], v250 offset:64
    v_mfma_f32_16x16x32_bf16 v[192:195], a[12:15], a[236:239], v[192:195]
    ds_read_b128 a[232:235], v240 offset:33920
    v_and_b32 v70, 4, v69
    v_mfma_f32_16x16x32_bf16 v[196:199], a[36:39], a[236:239], v[196:199]
    s_waitcnt lgkmcnt(9)
    v_mul_u32_u24 v252, 24, v70
    v_lshrrev_b32 v70, 3, v69
    v_mfma_f32_16x16x32_bf16 v[200:203], a[60:63], a[236:239], v[200:203]
    ds_read_b128 a[236:239], v240 offset:35456
    v_lshl_add_u32 v252, v70, 2, v252
    v_mfma_f32_16x16x32_bf16 v[228:231], a[12:15], a[240:243], v[228:231]
    s_waitcnt lgkmcnt(9)
    v_and_or_b32 v252, v69, 3, v252
    v_mad_u32_u24 v252, v252, 3, v68
    v_mfma_f32_16x16x32_bf16 v[232:235], a[36:39], a[240:243], v[232:235]
    v_and_b32 v70, 1, v67
    v_lshl_add_u32 v252, v252, 3, v70
    v_mfma_f32_16x16x32_bf16 v[236:239], a[60:63], a[240:243], v[236:239]
    ds_read_b128 a[240:243], v241 offset:33920
    v_lshlrev_b32 v252, 4, v252
    v_mfma_f32_16x16x32_bf16 v[138:141], a[12:15], a[244:247], v[138:141]
    s_waitcnt lgkmcnt(8)
    v_lshrrev_b32 v68, 1, v67
    v_add_u32 v68, 32, v68
    v_mfma_f32_16x16x32_bf16 v[142:145], a[36:39], a[244:247], v[142:145]
    s_waitcnt lgkmcnt(6)
    v_mul_u32_u24 v69, 43, v68
    s_waitcnt lgkmcnt(3)
    v_mfma_f32_16x16x32_bf16 v[146:149], a[60:63], a[244:247], v[146:149]
    buffer_load_dwordx4 v172, s[8:11], s60 offen lds
    ds_read_b128 a[244:247], v241 offset:35456
    v_mfma_f32_16x16x32_bf16 v[150:153], a[0:3], a[216:219], 0
    s_waitcnt vmcnt(8)
    ds_read_b64_tr_b16 a[20:21], v249 offset:3072
    v_mfma_f32_16x16x32_bf16 v[154:157], a[24:27], a[216:219], 0
    ds_read_b64_tr_b16 a[22:23], v250 offset:3072
    ds_read_b64_tr_b16 a[44:45], v249 offset:3104
    v_mfma_f32_16x16x32_bf16 v[158:161], a[48:51], a[216:219], 0
    ds_read_b64_tr_b16 a[46:47], v250 offset:3104
    buffer_load_dwordx4 v173, s[8:11], s60 offen offset:1024 lds
    v_mfma_f32_16x16x32_bf16 v[162:165], a[0:3], a[220:223], 0
    ds_read_b64_tr_b16 a[68:69], v249 offset:3136
    ds_read_b64_tr_b16 a[70:71], v250 offset:3136
    v_mfma_f32_16x16x32_bf16 v[24:27], a[24:27], a[220:223], 0
    ds_read_b128 a[216:219], v240 offset:256
    v_lshrrev_b32 v70, 8, v69
    v_mfma_f32_16x16x32_bf16 v[54:57], a[48:51], a[220:223], 0
    ds_read_b128 a[220:223], v240 offset:1792
    v_lshrrev_b32 v69, 7, v69
    v_mfma_f32_16x16x32_bf16 v[150:153], a[4:7], a[224:227], v[150:153]
    buffer_load_dwordx4 v174, s[8:11], s60 offen offset:2048 lds
    s_add_u32 m0, s29, 0xc00
    v_mfma_f32_16x16x32_bf16 v[154:157], a[28:31], a[224:227], v[154:157]
    s_add_u32 s60, s39, 0
    v_mad_i32_i24 v68, v69, -3, v68
    v_and_b32 v70, 4, v70
    v_mfma_f32_16x16x32_bf16 v[158:161], a[52:55], a[224:227], v[158:161]
    ds_read_b128 a[224:227], v240 offset:3328
    v_xor_b32 v69, v69, v70
    v_mfma_f32_16x16x32_bf16 v[162:165], a[4:7], a[228:231], v[162:165]
    s_waitcnt lgkmcnt(10)
    v_and_b32 v70, 4, v69
    v_mul_u32_u24 v253, 24, v70
    v_mfma_f32_16x16x32_bf16 v[24:27], a[28:31], a[228:231], v[24:27]
    s_waitcnt lgkmcnt(7)
    v_lshrrev_b32 v70, 3, v69
    v_lshl_add_u32 v253, v70, 2, v253
    v_mfma_f32_16x16x32_bf16 v[54:57], a[52:55], a[228:231], v[54:57]
    ds_read_b128 a[228:231], v240 offset:4864
    s_waitcnt lgkmcnt(4)
    v_mfma_f32_16x16x32_bf16 v[150:153], a[8:11], a[232:235], v[150:153]
    buffer_load_dwordx4 v172, s[8:11], s61 offen lds
    v_and_or_b32 v253, v69, 3, v253
    v_mfma_f32_16x16x32_bf16 v[154:157], a[32:35], a[232:235], v[154:157]
    s_waitcnt lgkmcnt(3)
    v_mad_u32_u24 v253, v253, 3, v68
    v_and_b32 v70, 1, v67
    v_mfma_f32_16x16x32_bf16 v[158:161], a[56:59], a[232:235], v[158:161]
    ds_read_b128 a[232:235], v240 offset:30976
    v_lshl_add_u32 v253, v253, 3, v70
    v_mfma_f32_16x16x32_bf16 v[162:165], a[8:11], a[236:239], v[162:165]
    s_waitcnt lgkmcnt(3)
    v_lshlrev_b32 v253, 4, v253
    v_add_u32 v253, 0xfffffc00, v253
    v_mfma_f32_16x16x32_bf16 v[24:27], a[32:35], a[236:239], v[24:27]
    buffer_load_dwordx4 v173, s[8:11], s61 offen offset:1024 lds
    s_waitcnt vmcnt(8) lgkmcnt(2)
    v_mfma_f32_16x16x32_bf16 v[54:57], a[56:59], a[236:239], v[54:57]
    ds_read_b64_tr_b16 a[72:73], v249 offset:6144
    ds_read_b64_tr_b16 a[74:75], v250 offset:6144
    v_mfma_f32_16x16x32_bf16 v[150:153], a[12:15], a[240:243], v[150:153]
    ds_read_b64_tr_b16 a[96:97], v249 offset:6176
    ds_read_b64_tr_b16 a[98:99], v250 offset:6176
    v_mfma_f32_16x16x32_bf16 v[154:157], a[36:39], a[240:243], v[154:157]
    ds_read_b64_tr_b16 a[120:121], v249 offset:6208
    buffer_load_dwordx4 v174, s[8:11], s61 offen offset:2048 lds
    v_mfma_f32_16x16x32_bf16 v[158:161], a[60:63], a[240:243], v[158:161]
    s_add_u32 m0, s29, 0x1800
    s_add_u32 s61, s39, 0x9000
    ds_read_b64_tr_b16 a[122:123], v250 offset:6208
    v_mfma_f32_16x16x32_bf16 v[162:165], a[12:15], a[244:247], v[162:165]
    ds_read_b128 a[236:239], v240 offset:32512
    ds_read_b128 a[240:243], v240 offset:34048
    v_mfma_f32_16x16x32_bf16 v[24:27], a[36:39], a[244:247], v[24:27]
    s_waitcnt lgkmcnt(8)
    v_add_u32 v17, 3, v15
    v_add_u32 v19, 3, v16
    v_mfma_f32_16x16x32_bf16 v[54:57], a[60:63], a[244:247], v[54:57]
    ds_read_b128 a[244:247], v240 offset:35584
    v_and_b32 v18, 3, v17
    v_mfma_f32_16x16x32_bf16 v[204:207], a[16:19], a[216:219], v[204:207]
    v_mul_u32_u24 v17, 0x1e00, v17
    v_lshlrev_b32 v18, 1, v18
    v_mfma_f32_16x16x32_bf16 v[208:211], a[40:43], a[216:219], v[208:211]
    v_bfe_u32 v243, v19, 1, 1
    v_or_b32 v18, v18, v243
    v_mfma_f32_16x16x32_bf16 v[212:215], a[64:67], a[216:219], v[212:215]
    ds_read_b128 a[216:219], v241 offset:256
    v_xor_b32 v18, v18, v14
    v_mfma_f32_16x16x32_bf16 v[216:219], a[16:19], a[220:223], v[216:219]
    s_waitcnt lgkmcnt(6)
    v_lshl_add_u32 v17, v18, 4, v17
    v_mul_u32_u24 v18, 0x180, v19
    v_mfma_f32_16x16x32_bf16 v[220:223], a[40:43], a[220:223], v[220:223]
    s_waitcnt lgkmcnt(5)
    s_waitcnt lgkmcnt(4)
    buffer_load_dwordx4 v172, s[8:11], s62 offen lds
    v_mfma_f32_16x16x32_bf16 v[224:227], a[64:67], a[220:223], v[224:227]
    ds_read_b128 a[220:223], v241 offset:1792
    v_add_u32 v242, v17, v18
    v_mfma_f32_16x16x32_bf16 v[180:183], a[16:19], a[224:227], v[180:183]
    s_waitcnt lgkmcnt(3)
    v_xor_b32 v243, 64, v242
    v_accvgpr_write_b32 a252, v168
    v_mfma_f32_16x16x32_bf16 v[184:187], a[40:43], a[224:227], v[184:187]
    s_waitcnt lgkmcnt(2)
    v_accvgpr_read_b32 v254, a252
    v_accvgpr_write_b32 a253, v169
    v_mfma_f32_16x16x32_bf16 v[188:191], a[64:67], a[224:227], v[188:191]
    buffer_load_dwordx4 v173, s[8:11], s62 offen offset:1024 lds
    s_waitcnt vmcnt(8)
    v_mfma_f32_16x16x32_bf16 v[192:195], a[16:19], a[228:231], v[192:195]
    ds_read_b64_tr_b16 a[76:77], v249 offset:9216
    ds_read_b64_tr_b16 a[78:79], v250 offset:9216
    v_mfma_f32_16x16x32_bf16 v[196:199], a[40:43], a[228:231], v[196:199]
    ds_read_b64_tr_b16 a[100:101], v249 offset:9248
    ds_read_b64_tr_b16 a[102:103], v250 offset:9248
    v_mfma_f32_16x16x32_bf16 v[200:203], a[64:67], a[228:231], v[200:203]
    ds_read_b64_tr_b16 a[124:125], v249 offset:9280
    buffer_load_dwordx4 v174, s[8:11], s62 offen offset:2048 lds
    v_mfma_f32_16x16x32_bf16 v[228:231], a[16:19], a[232:235], v[228:231]
    s_add_u32 m0, s29, 0x2400
    s_add_u32 s62, s39, 0x12000
    ds_read_b64_tr_b16 a[126:127], v250 offset:9280
    v_mfma_f32_16x16x32_bf16 v[232:235], a[40:43], a[232:235], v[232:235]
    ds_read_b128 a[224:227], v241 offset:3328
    ds_read_b128 a[228:231], v241 offset:4864
    v_mfma_f32_16x16x32_bf16 v[236:239], a[64:67], a[232:235], v[236:239]
    ds_read_b128 a[232:235], v241 offset:30976
    v_accvgpr_read_b32 v255, a253
    v_mfma_f32_16x16x32_bf16 v[138:141], a[16:19], a[236:239], v[138:141]
    s_waitcnt lgkmcnt(9)
    v_accvgpr_write_b32 a254, v170
    v_accvgpr_write_b32 a255, v171
    v_mfma_f32_16x16x32_bf16 v[142:145], a[40:43], a[236:239], v[142:145]
    v_mov_b32 v17, 0x3f803f80
    v_accvgpr_write_b32 a248, v17
    v_mfma_f32_16x16x32_bf16 v[146:149], a[64:67], a[236:239], v[146:149]
    ds_read_b128 a[236:239], v241 offset:32512
    v_accvgpr_write_b32 a249, v17
    v_mfma_f32_16x16x32_bf16 v[150:153], a[16:19], a[240:243], v[150:153]
    s_waitcnt lgkmcnt(8)
    v_accvgpr_write_b32 a250, v17
    v_accvgpr_write_b32 a251, v17
    v_mfma_f32_16x16x32_bf16 v[154:157], a[40:43], a[240:243], v[154:157]
    s_waitcnt lgkmcnt(6)
    v_mov_b32 v248, 0
    v_lshrrev_b32 v18, 1, v13
    v_mfma_f32_16x16x32_bf16 v[158:161], a[64:67], a[240:243], v[158:161]
    ds_read_b128 a[240:243], v241 offset:34048
    s_waitcnt lgkmcnt(5)
    v_mfma_f32_16x16x32_bf16 v[162:165], a[16:19], a[244:247], v[162:165]
    buffer_load_dwordx4 v172, s[8:11], s63 offen lds
    v_xor_b32 v18, v14, v18
    v_mfma_f32_16x16x32_bf16 v[24:27], a[40:43], a[244:247], v[24:27]
    s_waitcnt lgkmcnt(4)
    v_xor_b32 v18, s66, v18
    v_mul_u32_u24 v17, 0x180, v13
    v_mfma_f32_16x16x32_bf16 v[54:57], a[64:67], a[244:247], v[54:57]
    ds_read_b128 a[244:247], v241 offset:35584
    v_lshl_add_u32 v17, v18, 4, v17
    v_mfma_f32_16x16x32_bf16 v[204:207], a[20:23], a[216:219], v[204:207]
    s_lshl_b32 s66, s36, 1
    v_add_u32 v17, s67, v17
    s_mul_i32 s67, s36, 3
    v_mfma_f32_16x16x32_bf16 v[208:211], a[44:47], a[216:219], v[208:211]
    buffer_load_dwordx4 v173, s[8:11], s63 offen offset:1024 lds
    v_add_u32 v247, 0x7800, v17
    v_mfma_f32_16x16x32_bf16 v[212:215], a[68:71], a[216:219], v[212:215]
    ds_read_b128 a[216:219], v240 offset:0
    v_cvt_pk_bf16_f32 v102, v204, v205
    v_mfma_f32_16x16x32_bf16 v[216:219], a[20:23], a[220:223], v[216:219]
    s_sub_u32 s66, 1, s66
    v_cvt_pk_bf16_f32 v103, v206, v207
    v_cvt_pk_bf16_f32 v104, v208, v209
    v_mfma_f32_16x16x32_bf16 v[220:223], a[44:47], a[220:223], v[220:223]
    s_waitcnt lgkmcnt(3)
    v_cvt_pk_bf16_f32 v105, v210, v211
    v_cvt_pk_bf16_f32 v106, v212, v213
    v_mfma_f32_16x16x32_bf16 v[224:227], a[68:71], a[220:223], v[224:227]
    buffer_load_dwordx4 v174, s[8:11], s63 offen offset:2048 lds
    s_add_u32 m0, s46, 0x1800
    v_mfma_f32_16x16x32_bf16 v[180:183], a[20:23], a[224:227], v[180:183]
    s_add_u32 s63, s39, 0x1b000
    s_waitcnt vmcnt(9) lgkmcnt(2)
    ds_read_b64_tr_b16 a[80:81], v249 offset:0
    v_mfma_f32_16x16x32_bf16 v[184:187], a[44:47], a[224:227], v[184:187]
    ds_read_b64_tr_b16 a[82:83], v250 offset:0
    ds_read_b64_tr_b16 a[104:105], v249 offset:32
    v_mfma_f32_16x16x32_bf16 v[188:191], a[68:71], a[224:227], v[188:191]
    ds_read_b64_tr_b16 a[106:107], v250 offset:32
    buffer_load_dwordx4 v168, s[4:7], s58 offen lds
    v_mfma_f32_16x16x32_bf16 v[192:195], a[20:23], a[228:231], v[192:195]
    ds_read_b64_tr_b16 a[128:129], v249 offset:64
    ds_read_b64_tr_b16 a[130:131], v250 offset:64
    v_mfma_f32_16x16x32_bf16 v[196:199], a[44:47], a[228:231], v[196:199]
    s_waitcnt lgkmcnt(6)
    v_cvt_pk_bf16_f32 v107, v214, v215
    v_cvt_pk_bf16_f32 v108, v216, v217
    v_mfma_f32_16x16x32_bf16 v[200:203], a[68:71], a[228:231], v[200:203]
    v_cvt_pk_bf16_f32 v109, v218, v219
    v_cvt_pk_bf16_f32 v110, v220, v221
    v_mfma_f32_16x16x32_bf16 v[228:231], a[20:23], a[232:235], v[228:231]
    buffer_load_dwordx4 v171, s[4:7], s58 offen offset:512 lds
    s_lshl1_add_u32 s58, s45, s41
    v_mfma_f32_16x16x32_bf16 v[232:235], a[44:47], a[232:235], v[232:235]
    s_add_u32 m0, s46, 0x9000
    v_cvt_pk_bf16_f32 v111, v222, v223
    v_cvt_pk_bf16_f32 v112, v224, v225
    v_mfma_f32_16x16x32_bf16 v[236:239], a[68:71], a[232:235], v[236:239]
    v_cvt_pk_bf16_f32 v113, v226, v227
    v_cvt_pk_bf16_f32 v90, v180, v181
    v_mfma_f32_16x16x32_bf16 v[138:141], a[20:23], a[236:239], v[138:141]
    s_waitcnt lgkmcnt(5)
    v_cvt_pk_bf16_f32 v91, v182, v183
    v_cvt_pk_bf16_f32 v92, v184, v185
    v_mfma_f32_16x16x32_bf16 v[142:145], a[44:47], a[236:239], v[142:145]
    buffer_load_dwordx4 v168, s[4:7], s58 offen lds
    v_cvt_pk_bf16_f32 v93, v186, v187
    v_mfma_f32_16x16x32_bf16 v[146:149], a[68:71], a[236:239], v[146:149]
    s_waitcnt lgkmcnt(2)
    v_cvt_pk_bf16_f32 v94, v188, v189
    v_cvt_pk_bf16_f32 v95, v190, v191
    v_mfma_f32_16x16x32_bf16 v[150:153], a[20:23], a[240:243], v[150:153]
    v_cvt_pk_bf16_f32 v96, v192, v193
    v_cvt_pk_bf16_f32 v97, v194, v195
    v_mfma_f32_16x16x32_bf16 v[154:157], a[44:47], a[240:243], v[154:157]
    s_waitcnt vmcnt(9)
    ds_read_b64_tr_b16 a[84:85], v249 offset:3072
    v_mfma_f32_16x16x32_bf16 v[158:161], a[68:71], a[240:243], v[158:161]
    buffer_load_dwordx4 v171, s[4:7], s58 offen offset:512 lds
    s_add_u32 m0, s46, 0xf000
    v_mfma_f32_16x16x32_bf16 v[162:165], a[20:23], a[244:247], v[162:165]
    s_lshl1_add_u32 s58, s45, s42
    ds_read_b64_tr_b16 a[86:87], v250 offset:3072
    v_mfma_f32_16x16x32_bf16 v[24:27], a[44:47], a[244:247], v[24:27]
    ds_read_b64_tr_b16 a[108:109], v249 offset:3104
    ds_read_b64_tr_b16 a[110:111], v250 offset:3104
    v_mfma_f32_16x16x32_bf16 v[54:57], a[68:71], a[244:247], v[54:57]
    ds_read_b64_tr_b16 a[132:133], v249 offset:3136
    buffer_load_dwordx4 v168, s[4:7], s42 offen lds
    v_mfma_f32_16x16x32_bf16 v[84:87], a[216:219], a[72:75], 0
    ds_read_b64_tr_b16 a[134:135], v250 offset:3136
    v_cvt_pk_bf16_f32 v98, v196, v197
    v_mfma_f32_16x16x32_bf16 v[204:207], a[216:219], a[96:99], 0
    s_waitcnt lgkmcnt(6)
    v_cvt_pk_bf16_f32 v99, v198, v199
    v_cvt_pk_bf16_f32 v100, v200, v201
    v_mfma_f32_16x16x32_bf16 v[208:211], a[216:219], a[120:123], 0
    v_cvt_pk_bf16_f32 v101, v202, v203
    v_cvt_pk_bf16_f32 v114, v228, v229
    v_cvt_pk_bf16_f32 v115, v230, v231
    v_cvt_pk_bf16_f32 v116, v232, v233
    buffer_load_dwordx4 v169, s[4:7], s42 offen offset:1024 lds
    v_cvt_pk_bf16_f32 v117, v234, v235
    v_cvt_pk_bf16_f32 v118, v236, v237
    v_cvt_pk_bf16_f32 v119, v238, v239
    v_cvt_pk_bf16_f32 v120, v138, v139
    v_cvt_pk_bf16_f32 v121, v140, v141
    v_cvt_pk_bf16_f32 v122, v142, v143
    v_cvt_pk_bf16_f32 v123, v144, v145
    v_cvt_pk_bf16_f32 v124, v146, v147
    v_cvt_pk_bf16_f32 v125, v148, v149
    v_cvt_pk_bf16_f32 v126, v150, v151
    v_cvt_pk_bf16_f32 v127, v152, v153
    v_cvt_pk_bf16_f32 v128, v154, v155
    v_cvt_pk_bf16_f32 v129, v156, v157
    buffer_load_dwordx4 v170, s[4:7], s42 offen offset:2048 lds
    s_add_u32 m0, s46, 0xfc00
    v_cvt_pk_bf16_f32 v130, v158, v159
    v_cvt_pk_bf16_f32 v131, v160, v161
    v_cvt_pk_bf16_f32 v132, v162, v163
    v_cvt_pk_bf16_f32 v133, v164, v165
    v_cvt_pk_bf16_f32 v134, v24, v25
    v_cvt_pk_bf16_f32 v135, v26, v27
    v_cvt_pk_bf16_f32 v136, v54, v55
    v_cvt_pk_bf16_f32 v137, v56, v57
    ds_read_b128 a[220:223], v240 offset:1536
    ds_read_b128 a[224:227], v240 offset:3072
    buffer_load_dwordx4 v168, s[4:7], s59 offen lds
    ds_read_b128 a[228:231], v240 offset:4608
    s_waitcnt vmcnt(11)
    ds_read_b64_tr_b16 a[88:89], v249 offset:6144
    ds_read_b64_tr_b16 a[90:91], v250 offset:6144
    ds_read_b64_tr_b16 a[112:113], v249 offset:6176
    ds_read_b64_tr_b16 a[114:115], v250 offset:6176
    ds_read_b64_tr_b16 a[136:137], v249 offset:6208
    buffer_load_dwordx4 v169, s[4:7], s59 offen offset:1024 lds
    ds_read_b64_tr_b16 a[138:139], v250 offset:6208
    ds_read_b128 a[232:235], v240 offset:30720
    ds_read_b128 a[236:239], v240 offset:32256
    ds_read_b128 a[240:243], v240 offset:33792
    ds_read_b128 a[244:247], v240 offset:35328
    ds_read_b128 a[216:219], v241 offset:0
    s_waitcnt lgkmcnt(13)
    v_mfma_f32_16x16x32_bf16 v[212:215], a[220:223], a[72:75], 0
    v_add_u32 v251, 0x1e000, v17
    v_sub_u32 v17, v14, v15
    v_mfma_f32_16x16x32_bf16 v[216:219], a[220:223], a[96:99], 0
    s_waitcnt lgkmcnt(12)
    v_mul_i32_i24 v17, 0x1c0, v17
    v_lshlrev_b32 v18, 4, v16
    v_mfma_f32_16x16x32_bf16 v[220:223], a[220:223], a[120:123], 0
    ds_read_b128 a[220:223], v241 offset:1536
    buffer_load_dwordx4 v170, s[4:7], s59 offen offset:2048 lds
    v_mfma_f32_16x16x32_bf16 v[224:227], a[224:227], a[72:75], 0
    s_add_u32 m0, s46, 0x10800
    s_add_u32 s59, s43, s45
    v_sub_u32 v17, v17, v18
    v_mfma_f32_16x16x32_bf16 v[180:183], a[224:227], a[96:99], 0
    s_waitcnt lgkmcnt(12)
    v_add_u32 v17, s37, v17
    v_max_u32 v18, s33, v15
    v_mfma_f32_16x16x32_bf16 v[184:187], a[224:227], a[120:123], 0
    ds_read_b128 a[224:227], v241 offset:3072
    v_sub_u32 v18, v14, v18
    v_mfma_f32_16x16x32_bf16 v[188:191], a[228:231], a[72:75], 0
    s_waitcnt lgkmcnt(6)
    v_add_u32 v244, 0, v18
    v_cmp_gt_u32 vcc, 7, v244
    v_mfma_f32_16x16x32_bf16 v[192:195], a[228:231], a[96:99], 0
    buffer_load_dwordx4 v168, s[4:7], s58 offen lds
    v_add_u32 v244, 0xfffdc870, v17
    v_mfma_f32_16x16x32_bf16 v[196:199], a[228:231], a[120:123], 0
    ds_read_b128 a[228:231], v241 offset:4608
    v_cndmask_b32 v244, 0, v244, vcc
    v_mfma_f32_16x16x32_bf16 v[200:203], a[232:235], a[72:75], 0
    s_waitcnt lgkmcnt(4)
    v_add_u32 v244, 0x237c0, v244
    v_add_u32 v245, 4, v18
    v_mfma_f32_16x16x32_bf16 v[228:231], a[232:235], a[96:99], 0
    s_waitcnt lgkmcnt(3)
    v_cmp_gt_u32 vcc, 7, v245
    v_add_u32 v245, 0xfffdcf70, v17
    v_mfma_f32_16x16x32_bf16 v[232:235], a[232:235], a[120:123], 0
    buffer_load_dwordx4 v171, s[4:7], s58 offen offset:512 lds
    s_add_u32 m0, s29, 0
    v_mfma_f32_16x16x32_bf16 v[236:239], a[236:239], a[72:75], 0
    s_waitcnt vmcnt(12) lgkmcnt(2)
    ds_read_b64_tr_b16 a[92:93], v249 offset:9216
    v_mfma_f32_16x16x32_bf16 v[138:141], a[236:239], a[96:99], 0
    ds_read_b64_tr_b16 a[94:95], v250 offset:9216
    ds_read_b64_tr_b16 a[116:117], v249 offset:9248
    v_mfma_f32_16x16x32_bf16 v[142:145], a[236:239], a[120:123], 0
    ds_read_b64_tr_b16 a[118:119], v250 offset:9248
    ds_read_b64_tr_b16 a[140:141], v249 offset:9280
    v_mfma_f32_16x16x32_bf16 v[146:149], a[240:243], a[72:75], 0
    buffer_load_dwordx4 v172, s[8:11], s60 offen lds
    ds_read_b64_tr_b16 a[142:143], v250 offset:9280
    v_mfma_f32_16x16x32_bf16 v[150:153], a[240:243], a[96:99], 0
    ds_read_b128 a[232:235], v241 offset:30720
    ds_read_b128 a[236:239], v241 offset:32256
    v_mfma_f32_16x16x32_bf16 v[154:157], a[240:243], a[120:123], 0
    ds_read_b128 a[240:243], v241 offset:33792
    s_lshl1_add_u32 s58, s45, s43
    v_mfma_f32_16x16x32_bf16 v[158:161], a[244:247], a[72:75], 0
    s_waitcnt lgkmcnt(9)
    v_cndmask_b32 v245, 0, v245, vcc
    v_add_u32 v245, 0x237c0, v245
    v_mfma_f32_16x16x32_bf16 v[162:165], a[244:247], a[96:99], 0
    v_add_u32 v246, 8, v18
    v_cmp_gt_u32 vcc, 7, v246
    v_mfma_f32_16x16x32_bf16 v[24:27], a[244:247], a[120:123], 0
    ds_read_b128 a[244:247], v241 offset:35328
    v_add_u32 v246, 0xfffdd670, v17
    v_mfma_f32_16x16x32_bf16 v[84:87], a[216:219], a[76:79], v[84:87]
    s_waitcnt lgkmcnt(9)
    buffer_load_dwordx4 v173, s[8:11], s60 offen offset:1024 lds
    v_mfma_f32_16x16x32_bf16 v[204:207], a[216:219], a[100:103], v[204:207]
    s_waitcnt lgkmcnt(7)
    v_cndmask_b32 v246, 0, v246, vcc
    v_add_u32 v246, 0x237c0, v246
    v_mfma_f32_16x16x32_bf16 v[208:211], a[216:219], a[124:127], v[208:211]
    ds_read_b128 a[216:219], v240 offset:128
    v_min_u32 v20, 55, v1
    v_mfma_f32_16x16x32_bf16 v[212:215], a[220:223], a[76:79], v[212:215]
    s_waitcnt lgkmcnt(4)
    v_lshlrev_b32 v62, 3, v20
    v_add_u32 v62, s64, v62
    v_mfma_f32_16x16x32_bf16 v[216:219], a[220:223], a[100:103], v[216:219]
    s_and_b32 s64, s48, 15
    v_lshrrev_b32 v21, 1, v20
    v_and_b32 v20, 1, v20
    v_mfma_f32_16x16x32_bf16 v[220:223], a[220:223], a[124:127], v[220:223]
    ds_read_b128 a[220:223], v240 offset:1664
    v_lshlrev_b32 v20, 1, v20
    v_mfma_f32_16x16x32_bf16 v[224:227], a[224:227], a[76:79], v[224:227]
    s_add_u32 s64, s64, s37
    s_waitcnt vmcnt(10) lgkmcnt(3)
    s_barrier
    v_mfma_f32_16x16x32_bf16 v[180:183], a[224:227], a[100:103], v[180:183]
    buffer_load_dwordx4 v174, s[8:11], s60 offen offset:2048 lds
    s_add_u32 m0, s29, 0xc00
    v_mfma_f32_16x16x32_bf16 v[184:187], a[224:227], a[124:127], v[184:187]
    s_add_u32 s60, s39, 0x24000
    ds_read_b128 a[224:227], v240 offset:3200
    v_mfma_f32_16x16x32_bf16 v[188:191], a[228:231], a[76:79], v[188:191]
    s_waitcnt lgkmcnt(2)
    v_add_u32 v22, -12, v21
    v_cmp_lt_u32 vcc, 11, v21
    v_mfma_f32_16x16x32_bf16 v[192:195], a[228:231], a[100:103], v[192:195]
    v_mov_b32 v23, s34
    v_cndmask_b32 v22, v21, v22, vcc
    v_mfma_f32_16x16x32_bf16 v[196:199], a[228:231], a[124:127], v[196:199]
    ds_read_b128 a[228:231], v240 offset:4736
    v_cndmask_b32 v23, 0, v23, vcc
    v_mfma_f32_16x16x32_bf16 v[200:203], a[232:235], a[76:79], v[200:203]
    s_waitcnt lgkmcnt(2)
    v_add_u32 v63, 0, v20
    v_add3_u32 v64, v22, v63, -6
    v_mfma_f32_16x16x32_bf16 v[228:231], a[232:235], a[100:103], v[228:231]
    v_add_u32 v65, 3, v64
    v_and_b32 v66, 12, v22
    v_mfma_f32_16x16x32_bf16 v[232:235], a[232:235], a[124:127], v[232:235]
    buffer_load_dwordx4 v172, s[8:11], s61 offen lds
    ds_read_b128 a[232:235], v240 offset:30848
    v_mfma_f32_16x16x32_bf16 v[236:239], a[236:239], a[76:79], v[236:239]
    v_add3_u32 v66, v66, v63, -3
    v_cmp_ne_u32 vcc, 0, v23
    v_mfma_f32_16x16x32_bf16 v[138:141], a[236:239], a[100:103], v[138:141]
    v_mul_i32_i24 v64, s66, v64
    v_cndmask_b32 v65, v65, v66, vcc
    v_mfma_f32_16x16x32_bf16 v[142:145], a[236:239], a[124:127], v[142:145]
    ds_read_b128 a[236:239], v240 offset:32384
    v_cmp_gt_u32 vcc, 7, v65
    v_mfma_f32_16x16x32_bf16 v[146:149], a[240:243], a[76:79], v[146:149]
    s_waitcnt lgkmcnt(3)
    v_add_lshl_u32 v64, v64, 6, 1
    v_cndmask_b32 v50, 0, v64, vcc
    v_mfma_f32_16x16x32_bf16 v[150:153], a[240:243], a[100:103], v[150:153]
    s_waitcnt lgkmcnt(2)
    v_mov_b32 v64, 0x3fb8aa3b
    v_cndmask_b32 v52, 0, v64, vcc
    v_mfma_f32_16x16x32_bf16 v[154:157], a[240:243], a[124:127], v[154:157]
    ds_read_b128 a[240:243], v240 offset:33920
    v_mov_b32 v64, 0
    v_mfma_f32_16x16x32_bf16 v[158:161], a[244:247], a[76:79], v[158:161]
    v_mov_b32 v65, 0xf149f2ca
    v_cndmask_b32 v60, v65, v64, vcc
    v_mfma_f32_16x16x32_bf16 v[162:165], a[244:247], a[100:103], v[162:165]
    v_add_u32 v63, 1, v20
    v_add3_u32 v64, v22, v63, -6
    v_mfma_f32_16x16x32_bf16 v[24:27], a[244:247], a[124:127], v[24:27]
    ds_read_b128 a[244:247], v240 offset:35456
    v_add_u32 v65, 3, v64
    v_mfma_f32_16x16x32_bf16 v[84:87], a[216:219], a[80:83], v[84:87]
    s_waitcnt lgkmcnt(3)
    v_and_b32 v66, 12, v22
    v_add3_u32 v66, v66, v63, -3
    v_mfma_f32_16x16x32_bf16 v[204:207], a[216:219], a[104:107], v[204:207]
    v_cmp_ne_u32 vcc, 0, v23
    v_mul_i32_i24 v64, s66, v64
    v_mfma_f32_16x16x32_bf16 v[208:211], a[216:219], a[128:131], v[208:211]
    ds_read_b128 a[216:219], v241 offset:128
    s_mul_i32 s66, s28, 0xffffee00
    v_mfma_f32_16x16x32_bf16 v[212:215], a[220:223], a[80:83], v[212:215]
    s_waitcnt lgkmcnt(3)
    v_cndmask_b32 v65, v65, v66, vcc
    v_cmp_gt_u32 vcc, 7, v65
    v_mfma_f32_16x16x32_bf16 v[216:219], a[220:223], a[104:107], v[216:219]
    v_add_lshl_u32 v64, v64, 6, 1
    v_cndmask_b32 v51, 0, v64, vcc
    v_mfma_f32_16x16x32_bf16 v[220:223], a[220:223], a[128:131], v[220:223]
    ds_read_b128 a[220:223], v241 offset:1664
    v_mov_b32 v64, 0x3fb8aa3b
    v_mfma_f32_16x16x32_bf16 v[224:227], a[224:227], a[80:83], v[224:227]
    s_waitcnt lgkmcnt(3)
    v_cndmask_b32 v53, 0, v64, vcc
    v_mov_b32 v64, 0
    v_mfma_f32_16x16x32_bf16 v[180:183], a[224:227], a[104:107], v[180:183]
    v_mov_b32 v65, 0xf149f2ca
    v_cndmask_b32 v61, v65, v64, vcc
    v_mfma_f32_16x16x32_bf16 v[184:187], a[224:227], a[128:131], v[184:187]
    ds_read_b128 a[224:227], v241 offset:3200
    s_mov_b32 vcc_lo, 0xcccccccc
    v_mfma_f32_16x16x32_bf16 v[188:191], a[228:231], a[80:83], v[188:191]
    s_mov_b32 vcc_hi, 0xcccccccc
    v_add_u32 v50, s64, v50
    v_add_u32 v51, s64, v51
    v_mfma_f32_16x16x32_bf16 v[192:195], a[228:231], a[104:107], v[192:195]
    ds_read_u16 v30, v50 offset:3456
    ds_read_u16 v31, v51 offset:3456
    v_mfma_f32_16x16x32_bf16 v[196:199], a[228:231], a[128:131], v[196:199]
    ds_read_b128 a[228:231], v241 offset:4736
    ds_read_u16 v32, v50 offset:3482
    v_mfma_f32_16x16x32_bf16 v[200:203], a[232:235], a[80:83], v[200:203]
    ds_read_u16 v33, v51 offset:3482
    ds_read_u16 v34, v50 offset:3508
    v_mfma_f32_16x16x32_bf16 v[228:231], a[232:235], a[104:107], v[228:231]
    ds_read_u16 v35, v51 offset:3508
    ds_read_u16 v36, v50 offset:3534
    v_mfma_f32_16x16x32_bf16 v[232:235], a[232:235], a[128:131], v[232:235]
    ds_read_b128 a[232:235], v241 offset:30848
    ds_read_u16 v37, v51 offset:3534
    v_mfma_f32_16x16x32_bf16 v[236:239], a[236:239], a[80:83], v[236:239]
    ds_read_u16 v38, v50 offset:3560
    ds_read_u16 v39, v51 offset:3560
    v_mfma_f32_16x16x32_bf16 v[138:141], a[236:239], a[104:107], v[138:141]
    ds_read_u16 v40, v50 offset:3586
    ds_read_u16 v41, v51 offset:3586
    v_mfma_f32_16x16x32_bf16 v[142:145], a[236:239], a[128:131], v[142:145]
    ds_read_b128 a[236:239], v241 offset:32384
    ds_read_u16 v42, v50 offset:3612
    v_mfma_f32_16x16x32_bf16 v[146:149], a[240:243], a[80:83], v[146:149]
    ds_read_u16 v43, v51 offset:3612
    ds_read_u16 v44, v50 offset:3638
    v_mfma_f32_16x16x32_bf16 v[150:153], a[240:243], a[104:107], v[150:153]
    ds_read_u16 v45, v51 offset:3638
    ds_read_u16 v46, v50 offset:3664
    v_mfma_f32_16x16x32_bf16 v[154:157], a[240:243], a[128:131], v[154:157]
    s_waitcnt lgkmcnt(12)
    ds_read_b128 a[240:243], v241 offset:33920
    v_mfma_f32_16x16x32_bf16 v[158:161], a[244:247], a[80:83], v[158:161]
    ds_read_u16 v47, v51 offset:3664
    ds_read_u16 v48, v50 offset:3690
    v_mfma_f32_16x16x32_bf16 v[162:165], a[244:247], a[104:107], v[162:165]
    ds_read_u16 v49, v51 offset:3690
    v_lshlrev_b32 v30, 16, v30
    v_mfma_f32_16x16x32_bf16 v[24:27], a[244:247], a[128:131], v[24:27]
    ds_read_b128 a[244:247], v241 offset:35456
    v_fma_f32 v30, v30, v52, v60
    v_mfma_f32_16x16x32_bf16 v[84:87], a[216:219], a[84:87], v[84:87]
    s_waitcnt lgkmcnt(11)
    v_lshlrev_b32 v31, 16, v31
    v_fma_f32 v31, v31, v53, v61
    v_mfma_f32_16x16x32_bf16 v[204:207], a[216:219], a[108:111], v[204:207]
    ds_write_b64 v62, v[30:31] offset:0
    v_mfma_f32_16x16x32_bf16 v[208:211], a[216:219], a[132:135], v[208:211]
    ds_read_b128 a[216:219], v240 offset:256
    v_add_u32 v62, s49, v62
    v_mfma_f32_16x16x32_bf16 v[212:215], a[220:223], a[84:87], v[212:215]
    s_waitcnt lgkmcnt(7)
    v_lshlrev_b32 v32, 16, v32
    v_fma_f32 v32, v32, v52, v60
    v_mfma_f32_16x16x32_bf16 v[216:219], a[220:223], a[108:111], v[216:219]
    s_waitcnt lgkmcnt(6)
    v_lshlrev_b32 v33, 16, v33
    v_fma_f32 v33, v33, v53, v61
    v_mfma_f32_16x16x32_bf16 v[220:223], a[220:223], a[132:135], v[220:223]
    ds_read_b128 a[220:223], v240 offset:1792
    v_lshlrev_b32 v34, 16, v34
    v_mfma_f32_16x16x32_bf16 v[224:227], a[224:227], a[84:87], v[224:227]
    ds_write_b64 v62, v[32:33] offset:0
    v_mfma_f32_16x16x32_bf16 v[180:183], a[224:227], a[108:111], v[180:183]
    s_waitcnt lgkmcnt(4)
    v_add_u32 v62, s49, v62
    v_fma_f32 v34, v34, v52, v60
    v_mfma_f32_16x16x32_bf16 v[184:187], a[224:227], a[132:135], v[184:187]
    ds_read_b128 a[224:227], v240 offset:3328
    v_lshlrev_b32 v35, 16, v35
    v_mfma_f32_16x16x32_bf16 v[188:191], a[228:231], a[84:87], v[188:191]
    v_fma_f32 v35, v35, v53, v61
    v_lshlrev_b32 v36, 16, v36
    v_mfma_f32_16x16x32_bf16 v[192:195], a[228:231], a[108:111], v[192:195]
    ds_write_b64 v62, v[34:35] offset:0
    v_mfma_f32_16x16x32_bf16 v[196:199], a[228:231], a[132:135], v[196:199]
    ds_read_b128 a[228:231], v240 offset:4864
    v_add_u32 v62, s49, v62
    v_mfma_f32_16x16x32_bf16 v[200:203], a[232:235], a[84:87], v[200:203]
    s_waitcnt lgkmcnt(5)
    v_fma_f32 v36, v36, v52, v60
    v_lshlrev_b32 v37, 16, v37
    v_mfma_f32_16x16x32_bf16 v[228:231], a[232:235], a[108:111], v[228:231]
    s_waitcnt lgkmcnt(4)
    v_fma_f32 v37, v37, v53, v61
    v_lshlrev_b32 v38, 16, v38
    v_mfma_f32_16x16x32_bf16 v[232:235], a[232:235], a[132:135], v[232:235]
    ds_read_b128 a[232:235], v240 offset:30976
    v_fma_f32 v38, v38, v52, v60
    v_mfma_f32_16x16x32_bf16 v[236:239], a[236:239], a[84:87], v[236:239]
    ds_write_b64 v62, v[36:37] offset:0
    v_mfma_f32_16x16x32_bf16 v[138:141], a[236:239], a[108:111], v[138:141]
    s_waitcnt lgkmcnt(4)
    v_add_u32 v62, s49, v62
    v_lshlrev_b32 v39, 16, v39
    v_mfma_f32_16x16x32_bf16 v[142:145], a[236:239], a[132:135], v[142:145]
    ds_read_b128 a[236:239], v240 offset:32512
    v_fma_f32 v39, v39, v53, v61
    v_mfma_f32_16x16x32_bf16 v[146:149], a[240:243], a[84:87], v[146:149]
    ds_write_b64 v62, v[38:39] offset:0
    v_mfma_f32_16x16x32_bf16 v[150:153], a[240:243], a[108:111], v[150:153]
    s_waitcnt lgkmcnt(4)
    v_add_u32 v62, s49, v62
    v_lshlrev_b32 v40, 16, v40
    v_mfma_f32_16x16x32_bf16 v[154:157], a[240:243], a[132:135], v[154:157]
    ds_read_b128 a[240:243], v240 offset:34048
    v_fma_f32 v40, v40, v52, v60
    v_mfma_f32_16x16x32_bf16 v[158:161], a[244:247], a[84:87], v[158:161]
    v_lshlrev_b32 v41, 16, v41
    v_fma_f32 v41, v41, v53, v61
    v_mfma_f32_16x16x32_bf16 v[162:165], a[244:247], a[108:111], v[162:165]
    ds_write_b64 v62, v[40:41] offset:0
    v_mfma_f32_16x16x32_bf16 v[24:27], a[244:247], a[132:135], v[24:27]
    ds_read_b128 a[244:247], v240 offset:35584
    v_add_u32 v62, s49, v62
    v_mfma_f32_16x16x32_bf16 v[84:87], a[216:219], a[88:91], v[84:87]
    s_waitcnt lgkmcnt(6)
    v_lshlrev_b32 v42, 16, v42
    v_fma_f32 v42, v42, v52, v60
    v_mfma_f32_16x16x32_bf16 v[204:207], a[216:219], a[112:115], v[204:207]
    s_waitcnt lgkmcnt(4)
    v_lshlrev_b32 v43, 16, v43
    v_fma_f32 v43, v43, v53, v61
    v_mfma_f32_16x16x32_bf16 v[208:211], a[216:219], a[136:139], v[208:211]
    ds_read_b128 a[216:219], v241 offset:256
    v_lshlrev_b32 v44, 16, v44
    v_mfma_f32_16x16x32_bf16 v[212:215], a[220:223], a[88:91], v[212:215]
    ds_write_b64 v62, v[42:43] offset:0
    v_mfma_f32_16x16x32_bf16 v[216:219], a[220:223], a[112:115], v[216:219]
    buffer_load_dwordx4 v173, s[8:11], s61 offen offset:1024 lds
    v_add_u32 v62, s49, v62
    v_mfma_f32_16x16x32_bf16 v[220:223], a[220:223], a[136:139], v[220:223]
    ds_read_b128 a[220:223], v241 offset:1792
    v_fma_f32 v44, v44, v52, v60
    v_mfma_f32_16x16x32_bf16 v[224:227], a[224:227], a[88:91], v[224:227]
    s_waitcnt lgkmcnt(5)
    v_lshlrev_b32 v45, 16, v45
    v_fma_f32 v45, v45, v53, v61
    v_mfma_f32_16x16x32_bf16 v[180:183], a[224:227], a[112:115], v[180:183]
    ds_write_b64 v62, v[44:45] offset:0
    v_mfma_f32_16x16x32_bf16 v[184:187], a[224:227], a[136:139], v[184:187]
    ds_read_b128 a[224:227], v241 offset:3328
    v_add_u32 v62, s49, v62
    v_mfma_f32_16x16x32_bf16 v[188:191], a[228:231], a[88:91], v[188:191]
    s_waitcnt lgkmcnt(5)
    v_lshlrev_b32 v46, 16, v46
    v_fma_f32 v46, v46, v52, v60
    v_mfma_f32_16x16x32_bf16 v[192:195], a[228:231], a[112:115], v[192:195]
    s_waitcnt lgkmcnt(4)
    v_lshlrev_b32 v47, 16, v47
    v_fma_f32 v47, v47, v53, v61
    v_mfma_f32_16x16x32_bf16 v[196:199], a[228:231], a[136:139], v[196:199]
    buffer_load_dwordx4 v174, s[8:11], s61 offen offset:2048 lds
    s_add_u32 m0, s29, 0x1800
    v_mfma_f32_16x16x32_bf16 v[200:203], a[232:235], a[88:91], v[200:203]
    s_add_u32 s61, s39, 0x2d000
    ds_read_b128 a[228:231], v241 offset:4864
    v_mfma_f32_16x16x32_bf16 v[228:231], a[232:235], a[112:115], v[228:231]
    ds_write_b64 v62, v[46:47] offset:0
    v_mfma_f32_16x16x32_bf16 v[232:235], a[232:235], a[136:139], v[232:235]
    ds_read_b128 a[232:235], v241 offset:30976
    v_add_u32 v62, s49, v62
    v_mfma_f32_16x16x32_bf16 v[236:239], a[236:239], a[88:91], v[236:239]
    s_waitcnt lgkmcnt(5)
    v_lshlrev_b32 v48, 16, v48
    v_fma_f32 v48, v48, v52, v60
    v_mfma_f32_16x16x32_bf16 v[138:141], a[236:239], a[112:115], v[138:141]
    s_waitcnt lgkmcnt(3)
    v_lshlrev_b32 v49, 16, v49
    v_fma_f32 v49, v49, v53, v61
    v_mfma_f32_16x16x32_bf16 v[142:145], a[236:239], a[136:139], v[142:145]
    ds_read_b128 a[236:239], v241 offset:32512
    buffer_load_dwordx4 v172, s[8:11], s62 offen lds
    v_mfma_f32_16x16x32_bf16 v[146:149], a[240:243], a[88:91], v[146:149]
    ds_write_b64 v62, v[48:49] offset:0
    v_mfma_f32_16x16x32_bf16 v[150:153], a[240:243], a[112:115], v[150:153]
    v_add_u32 v62, s49, v62
    v_mov_b32 v64, 0xf149f2ca
    v_mfma_f32_16x16x32_bf16 v[154:157], a[240:243], a[136:139], v[154:157]
    ds_read_b128 a[240:243], v241 offset:34048
    s_waitcnt vmcnt(10) lgkmcnt(5)
    v_mfma_f32_16x16x32_bf16 v[158:161], a[244:247], a[88:91], v[158:161]
    s_barrier
    v_mfma_f32_16x16x32_bf16 v[162:165], a[244:247], a[112:115], v[162:165]
    s_waitcnt lgkmcnt(3)
    v_mov_b32 v65, 0xf149f2ca
    v_lshlrev_b32 v63, 3, v1
    v_mfma_f32_16x16x32_bf16 v[24:27], a[244:247], a[136:139], v[24:27]
    buffer_load_dwordx4 v173, s[8:11], s62 offen offset:1024 lds
    ds_read_b128 a[244:247], v241 offset:35584
    v_mfma_f32_16x16x32_bf16 v[84:87], a[216:219], a[92:95], v[84:87]
    s_waitcnt lgkmcnt(3)
    v_add_u32 v63, 0x237c0, v63
    v_mfma_f32_16x16x32_bf16 v[204:207], a[216:219], a[116:119], v[204:207]
    ds_write_b64 v63, v[64:65] offset:0
    v_mfma_f32_16x16x32_bf16 v[208:211], a[216:219], a[140:143], v[208:211]
    ds_read_b128 a[216:219], v240 offset:6144
    s_waitcnt lgkmcnt(3)
    v_mfma_f32_16x16x32_bf16 v[212:215], a[220:223], a[92:95], v[212:215]
    v_cvt_pk_bf16_f32 v0, v84, v85
    v_cvt_pk_bf16_f32 v3, v86, v87
    v_mfma_f32_16x16x32_bf16 v[216:219], a[220:223], a[116:119], v[216:219]
    v_cvt_pk_bf16_f32 v30, v204, v205
    v_cvt_pk_bf16_f32 v33, v206, v207
    v_mfma_f32_16x16x32_bf16 v[220:223], a[220:223], a[140:143], v[220:223]
    v_cvt_pk_bf16_f32 v60, v208, v209
    v_cvt_pk_bf16_f32 v63, v210, v211
    v_mfma_f32_16x16x32_bf16 v[224:227], a[224:227], a[92:95], v[224:227]
    buffer_load_dwordx4 v174, s[8:11], s62 offen offset:2048 lds
    s_add_u32 m0, s29, 0x2400
    v_mfma_f32_16x16x32_bf16 v[180:183], a[224:227], a[116:119], v[180:183]
    s_lshl_b32 s62, s28, 5
    s_add_u32 s62, s62, 0
    v_cvt_pk_bf16_f32 v6, v212, v213
    v_mfma_f32_16x16x32_bf16 v[184:187], a[224:227], a[140:143], v[184:187]
    s_waitcnt lgkmcnt(2)
    v_cvt_pk_bf16_f32 v9, v214, v215
    v_cvt_pk_bf16_f32 v36, v216, v217
    v_mfma_f32_16x16x32_bf16 v[188:191], a[228:231], a[92:95], v[188:191]
    v_cvt_pk_bf16_f32 v39, v218, v219
    v_cvt_pk_bf16_f32 v66, v220, v221
    v_mfma_f32_16x16x32_bf16 v[192:195], a[228:231], a[116:119], v[192:195]
    v_cvt_pk_bf16_f32 v69, v222, v223
    v_cvt_pk_bf16_f32 v12, v224, v225
    v_mfma_f32_16x16x32_bf16 v[196:199], a[228:231], a[140:143], v[196:199]
    v_cvt_pk_bf16_f32 v15, v226, v227
    v_cvt_pk_bf16_f32 v42, v180, v181
    v_mfma_f32_16x16x32_bf16 v[200:203], a[232:235], a[92:95], v[200:203]
    s_waitcnt lgkmcnt(0)
    v_cvt_pk_bf16_f32 v45, v182, v183
    v_cvt_pk_bf16_f32 v72, v184, v185
    v_mfma_f32_16x16x32_bf16 v[228:231], a[232:235], a[116:119], v[228:231]
    buffer_load_dwordx4 v172, s[8:11], s63 offen lds
    v_cvt_pk_bf16_f32 v75, v186, v187
    v_mfma_f32_16x16x32_bf16 v[232:235], a[232:235], a[140:143], v[232:235]
    v_cvt_pk_bf16_f32 v18, v188, v189
    v_cvt_pk_bf16_f32 v21, v190, v191
    v_mfma_f32_16x16x32_bf16 v[236:239], a[236:239], a[92:95], v[236:239]
    v_cvt_pk_bf16_f32 v48, v192, v193
    v_cvt_pk_bf16_f32 v51, v194, v195
    v_mfma_f32_16x16x32_bf16 v[138:141], a[236:239], a[116:119], v[138:141]
    v_cvt_pk_bf16_f32 v78, v196, v197
    v_cvt_pk_bf16_f32 v81, v198, v199
    v_mfma_f32_16x16x32_bf16 v[142:145], a[236:239], a[140:143], v[142:145]
    v_cvt_pk_bf16_f32 v1, v200, v201
    v_cvt_pk_bf16_f32 v4, v202, v203
    v_mfma_f32_16x16x32_bf16 v[146:149], a[240:243], a[92:95], v[146:149]
    v_cvt_pk_bf16_f32 v31, v228, v229
    v_cvt_pk_bf16_f32 v34, v230, v231
    v_mfma_f32_16x16x32_bf16 v[150:153], a[240:243], a[116:119], v[150:153]
    v_cvt_pk_bf16_f32 v61, v232, v233
    v_cvt_pk_bf16_f32 v64, v234, v235
    v_mfma_f32_16x16x32_bf16 v[154:157], a[240:243], a[140:143], v[154:157]
    buffer_load_dwordx4 v173, s[8:11], s63 offen offset:1024 lds
    v_cvt_pk_bf16_f32 v7, v236, v237
    v_mfma_f32_16x16x32_bf16 v[158:161], a[244:247], a[92:95], v[158:161]
    v_cvt_pk_bf16_f32 v10, v238, v239
    s_waitcnt vmcnt(8)
    v_mfma_f32_16x16x32_bf16 v[162:165], a[244:247], a[116:119], v[162:165]
    ds_read_b64_tr_b16 a[144:145], v249 offset:0
    ds_read_b64_tr_b16 a[146:147], v250 offset:0
    v_mfma_f32_16x16x32_bf16 v[24:27], a[244:247], a[140:143], v[24:27]
    ds_read_b64_tr_b16 a[168:169], v249 offset:32
    ds_read_b64_tr_b16 a[170:171], v250 offset:32
    v_mfma_f32_16x16x32_bf16 v[228:231], a[0:3], a[216:219], 0
    ds_read_b64_tr_b16 a[192:193], v249 offset:64
    ds_read_b64_tr_b16 a[194:195], v250 offset:64
    v_mfma_f32_16x16x32_bf16 v[232:235], a[24:27], a[216:219], 0
    v_cvt_pk_bf16_f32 v37, v138, v139
    v_cvt_pk_bf16_f32 v40, v140, v141
    v_mfma_f32_16x16x32_bf16 v[236:239], a[48:51], a[216:219], 0
    buffer_load_dwordx4 v174, s[8:11], s63 offen offset:2048 lds
    s_add_u32 m0, s29, 0
    s_lshl_b32 s63, s28, 5
    s_add_u32 s63, s63, 0x4800
    v_cvt_pk_bf16_f32 v67, v142, v143
    v_cvt_pk_bf16_f32 v70, v144, v145
    v_cvt_pk_bf16_f32 v13, v146, v147
    v_cvt_pk_bf16_f32 v16, v148, v149
    v_cvt_pk_bf16_f32 v43, v150, v151
    v_cvt_pk_bf16_f32 v46, v152, v153
    v_cvt_pk_bf16_f32 v73, v154, v155
    v_cvt_pk_bf16_f32 v76, v156, v157
    v_cvt_pk_bf16_f32 v19, v158, v159
    v_cvt_pk_bf16_f32 v22, v160, v161
    v_cvt_pk_bf16_f32 v49, v162, v163
    v_cvt_pk_bf16_f32 v52, v164, v165
    v_cvt_pk_bf16_f32 v79, v24, v25
    v_cvt_pk_bf16_f32 v82, v26, v27
    ds_read_b128 a[220:223], v241 offset:6144
    ds_read_b128 a[224:227], v240 offset:6272
    ds_read_b128 a[228:231], v241 offset:6272
    s_waitcnt lgkmcnt(3)
    buffer_load_dwordx4 v172, s[8:11], s60 offen lds
    ds_read_b128 a[232:235], v240 offset:6400
    ds_read_b128 a[236:239], v241 offset:6400
    s_waitcnt vmcnt(7)
    ds_read_b64_tr_b16 a[148:149], v249 offset:3072
    ds_read_b64_tr_b16 a[150:151], v250 offset:3072
    ds_read_b64_tr_b16 a[172:173], v249 offset:3104
    ds_read_b64_tr_b16 a[174:175], v250 offset:3104
    ds_read_b64_tr_b16 a[196:197], v249 offset:3136
    ds_read_b64_tr_b16 a[198:199], v250 offset:3136
    ds_read_b128 a[240:243], v240 offset:36864
    ds_read_b128 a[244:247], v241 offset:36864
    ds_read_b128 v[196:199], v244 offset:192
    v_mov_b32 v195, 0
    s_waitcnt lgkmcnt(13)
    v_mfma_f32_16x16x32_bf16 v[228:231], a[4:7], a[220:223], v[228:231]
    buffer_load_dwordx4 v173, s[8:11], s60 offen offset:1024 lds
    ds_read_b128 v[200:203], v245 offset:192
    v_mfma_f32_16x16x32_bf16 v[232:235], a[28:31], a[220:223], v[232:235]
    ds_read_b128 v[204:207], v246 offset:192
    ds_read_b128 v[208:211], v244 offset:256
    v_mfma_f32_16x16x32_bf16 v[236:239], a[52:55], a[220:223], v[236:239]
    s_waitcnt lgkmcnt(15)
    v_mfma_f32_16x16x32_bf16 v[228:231], a[8:11], a[224:227], v[228:231]
    s_waitcnt lgkmcnt(14)
    v_mfma_f32_16x16x32_bf16 v[228:231], a[12:15], a[228:231], v[228:231]
    s_waitcnt lgkmcnt(13)
    v_mfma_f32_16x16x32_bf16 v[228:231], a[16:19], a[232:235], v[228:231]
    s_waitcnt lgkmcnt(12)
    v_mfma_f32_16x16x32_bf16 v[228:231], a[20:23], a[236:239], v[228:231]
    s_waitcnt lgkmcnt(9)
    buffer_load_dwordx4 v174, s[8:11], s60 offen offset:2048 lds
    v_mfma_f32_16x16x32_bf16 v[232:235], a[32:35], a[224:227], v[232:235]
    s_add_u32 m0, s29, 0xc00
    s_waitcnt lgkmcnt(6)
    s_lshl_b32 s60, s28, 5
    v_mfma_f32_16x16x32_bf16 v[232:235], a[36:39], a[228:231], v[232:235]
    s_add_u32 s60, s60, 0x1800
    v_cvt_pk_bf16_f32 v138, v228, v229
    v_cvt_pk_bf16_f32 v139, v230, v231
    v_mfma_f32_16x16x32_bf16 v[232:235], a[40:43], a[232:235], v[232:235]
    s_waitcnt lgkmcnt(5)
    v_mfma_f32_16x16x32_bf16 v[232:235], a[44:47], a[236:239], v[232:235]
    s_waitcnt lgkmcnt(4)
    v_mfma_f32_16x16x32_bf16 v[236:239], a[56:59], a[224:227], v[236:239]
    s_waitcnt lgkmcnt(3)
    v_mfma_f32_16x16x32_bf16 v[236:239], a[60:63], a[228:231], v[236:239]
    s_waitcnt lgkmcnt(2)
    v_mfma_f32_16x16x32_bf16 v[236:239], a[64:67], a[232:235], v[236:239]
    s_waitcnt lgkmcnt(1)
    buffer_load_dwordx4 v172, s[8:11], s61 offen lds
    v_mfma_f32_16x16x32_bf16 v[236:239], a[68:71], a[236:239], v[236:239]
    s_waitcnt lgkmcnt(0)
    v_cvt_pk_bf16_f32 v140, v232, v233
    v_cvt_pk_bf16_f32 v141, v234, v235
    v_mfma_f32_16x16x32_bf16 v[228:231], a[216:219], a[72:75], 0
    s_waitcnt vmcnt(7)
    ds_read_b64_tr_b16 a[152:153], v249 offset:6144
    v_mfma_f32_16x16x32_bf16 v[228:231], a[220:223], a[76:79], v[228:231]
    ds_read_b64_tr_b16 a[154:155], v250 offset:6144
    ds_read_b64_tr_b16 a[176:177], v249 offset:6176
    v_mfma_f32_16x16x32_bf16 v[228:231], a[224:227], a[80:83], v[228:231]
    ds_read_b64_tr_b16 a[178:179], v250 offset:6176
    ds_read_b64_tr_b16 a[200:201], v249 offset:6208
    v_mfma_f32_16x16x32_bf16 v[228:231], a[228:231], a[84:87], v[228:231]
    ds_read_b64_tr_b16 a[202:203], v250 offset:6208
    v_cvt_pk_bf16_f32 v142, v236, v237
    v_mfma_f32_16x16x32_bf16 v[228:231], a[232:235], a[88:91], v[228:231]
    v_cvt_pk_bf16_f32 v143, v238, v239
    v_mfma_f32_16x16x32_bf16 v[228:231], a[236:239], a[92:95], v[228:231]
    buffer_load_dwordx4 v173, s[8:11], s61 offen offset:1024 lds
    v_mfma_f32_16x16x32_bf16 v[232:235], a[216:219], a[96:99], 0
    v_mfma_f32_16x16x32_bf16 v[232:235], a[220:223], a[100:103], v[232:235]
    v_mfma_f32_16x16x32_bf16 v[232:235], a[224:227], a[104:107], v[232:235]
    v_mfma_f32_16x16x32_bf16 v[232:235], a[228:231], a[108:111], v[232:235]
    v_mfma_f32_16x16x32_bf16 v[232:235], a[232:235], a[112:115], v[232:235]
    s_waitcnt lgkmcnt(4)
    v_mfma_f32_16x16x32_bf16 v[232:235], a[236:239], a[116:119], v[232:235]
    s_waitcnt lgkmcnt(3)
    v_cvt_pk_bf16_f32 v24, v228, v229
    v_cvt_pk_bf16_f32 v27, v230, v231
    v_mfma_f32_16x16x32_bf16 v[236:239], a[216:219], a[120:123], 0
    buffer_load_dwordx4 v174, s[8:11], s61 offen offset:2048 lds
    s_lshl_b32 s61, s28, 5
    v_mfma_f32_16x16x32_bf16 v[236:239], a[220:223], a[124:127], v[236:239]
    s_add_u32 s61, s61, 0x6000
    v_cvt_pk_bf16_f32 v54, v232, v233
    v_cvt_pk_bf16_f32 v57, v234, v235
    v_mfma_f32_16x16x32_bf16 v[236:239], a[224:227], a[128:131], v[236:239]
    ds_read_b128 a[216:219], v240 offset:36992
    ds_read_b128 a[220:223], v241 offset:36992
    v_mfma_f32_16x16x32_bf16 v[236:239], a[228:231], a[132:135], v[236:239]
    ds_read_b128 a[224:227], v240 offset:37120
    ds_read_b128 a[228:231], v241 offset:37120
    v_mfma_f32_16x16x32_bf16 v[236:239], a[232:235], a[136:139], v[236:239]
    ds_read_b128 a[232:235], v240 offset:61440
    s_add_u32 m0, s46, 0x16800
    v_mfma_f32_16x16x32_bf16 v[236:239], a[236:239], a[140:143], v[236:239]
    ds_read_b128 a[236:239], v241 offset:61440
    v_mfma_f32_16x16x32_bf16 v[228:231], a[0:3], a[240:243], 0
    s_waitcnt lgkmcnt(6)
    v_mfma_f32_16x16x32_bf16 v[228:231], a[4:7], a[244:247], v[228:231]
    v_mfma_f32_16x16x32_bf16 v[232:235], a[24:27], a[240:243], 0
    s_waitcnt vmcnt(6)
    ds_read_b64_tr_b16 a[156:157], v249 offset:9216
    v_mfma_f32_16x16x32_bf16 v[232:235], a[28:31], a[244:247], v[232:235]
    ds_read_b64_tr_b16 a[158:159], v250 offset:9216
    ds_read_b64_tr_b16 a[180:181], v249 offset:9248
    s_waitcnt lgkmcnt(8)
    v_mfma_f32_16x16x32_bf16 v[228:231], a[8:11], a[216:219], v[228:231]
    ds_read_b64_tr_b16 a[182:183], v250 offset:9248
    ds_read_b64_tr_b16 a[204:205], v249 offset:9280
    v_mfma_f32_16x16x32_bf16 v[232:235], a[32:35], a[216:219], v[232:235]
    s_waitcnt lgkmcnt(9)
    ds_read_b64_tr_b16 a[206:207], v250 offset:9280
    v_mfma_f32_16x16x32_bf16 v[228:231], a[12:15], a[220:223], v[228:231]
    s_waitcnt lgkmcnt(9)
    v_cvt_pk_bf16_f32 v84, v236, v237
    v_cvt_pk_bf16_f32 v87, v238, v239
    v_mfma_f32_16x16x32_bf16 v[228:231], a[16:19], a[224:227], v[228:231]
    s_waitcnt lgkmcnt(8)
    v_mfma_f32_16x16x32_bf16 v[228:231], a[20:23], a[228:231], v[228:231]
    v_mfma_f32_16x16x32_bf16 v[232:235], a[36:39], a[220:223], v[232:235]
    s_waitcnt lgkmcnt(7)
    v_mfma_f32_16x16x32_bf16 v[232:235], a[40:43], a[224:227], v[232:235]
    s_waitcnt lgkmcnt(6)
    v_mfma_f32_16x16x32_bf16 v[232:235], a[44:47], a[228:231], v[232:235]
    s_waitcnt lgkmcnt(5)
    v_mfma_f32_16x16x32_bf16 v[236:239], a[48:51], a[240:243], 0
    s_waitcnt lgkmcnt(4)
    v_cvt_pk_bf16_f32 v144, v228, v229
    v_cvt_pk_bf16_f32 v145, v230, v231
    v_mfma_f32_16x16x32_bf16 v[236:239], a[52:55], a[244:247], v[236:239]
    s_waitcnt lgkmcnt(3)
    v_mfma_f32_16x16x32_bf16 v[236:239], a[56:59], a[216:219], v[236:239]
    s_waitcnt lgkmcnt(1)
    v_cvt_pk_bf16_f32 v146, v232, v233
    v_cvt_pk_bf16_f32 v147, v234, v235
    v_mfma_f32_16x16x32_bf16 v[236:239], a[60:63], a[220:223], v[236:239]
    s_waitcnt lgkmcnt(0)
    v_mfma_f32_16x16x32_bf16 v[236:239], a[64:67], a[224:227], v[236:239]
    v_mfma_f32_16x16x32_bf16 v[236:239], a[68:71], a[228:231], v[236:239]
    v_mfma_f32_16x16x32_bf16 v[228:231], a[240:243], a[72:75], 0
    v_mfma_f32_16x16x32_bf16 v[228:231], a[244:247], a[76:79], v[228:231]
    v_mfma_f32_16x16x32_bf16 v[228:231], a[216:219], a[80:83], v[228:231]
    v_mfma_f32_16x16x32_bf16 v[228:231], a[220:223], a[84:87], v[228:231]
    v_mfma_f32_16x16x32_bf16 v[228:231], a[224:227], a[88:91], v[228:231]
    s_waitcnt vmcnt(3)
    ds_read_b64_tr_b16 a[160:161], v249 offset:0
    v_mfma_f32_16x16x32_bf16 v[228:231], a[228:231], a[92:95], v[228:231]
    ds_read_b64_tr_b16 a[162:163], v250 offset:0
    ds_read_b64_tr_b16 a[184:185], v249 offset:32
    v_mfma_f32_16x16x32_bf16 v[232:235], a[240:243], a[96:99], 0
    ds_read_b64_tr_b16 a[186:187], v250 offset:32
    ds_read_b64_tr_b16 a[208:209], v249 offset:64
    v_mfma_f32_16x16x32_bf16 v[232:235], a[244:247], a[100:103], v[232:235]
    ds_read_b64_tr_b16 a[210:211], v250 offset:64
    v_cvt_pk_bf16_f32 v148, v236, v237
    v_mfma_f32_16x16x32_bf16 v[232:235], a[216:219], a[104:107], v[232:235]
    v_cvt_pk_bf16_f32 v149, v238, v239
    v_cvt_pk_bf16_f32 v25, v228, v229
    v_mfma_f32_16x16x32_bf16 v[232:235], a[220:223], a[108:111], v[232:235]
    v_cvt_pk_bf16_f32 v28, v230, v231
    v_mfma_f32_16x16x32_bf16 v[232:235], a[224:227], a[112:115], v[232:235]
    v_mfma_f32_16x16x32_bf16 v[232:235], a[228:231], a[116:119], v[232:235]
    v_mfma_f32_16x16x32_bf16 v[236:239], a[240:243], a[120:123], 0
    ds_read_b128 a[240:243], v240 offset:61568
    v_mfma_f32_16x16x32_bf16 v[236:239], a[244:247], a[124:127], v[236:239]
    ds_read_b128 a[244:247], v241 offset:61568
    v_mfma_f32_16x16x32_bf16 v[236:239], a[216:219], a[128:131], v[236:239]
    ds_read_b128 a[216:219], v240 offset:61696
    v_mfma_f32_16x16x32_bf16 v[236:239], a[220:223], a[132:135], v[236:239]
    ds_read_b128 a[220:223], v241 offset:61696
    v_cvt_pk_bf16_f32 v55, v232, v233
    v_mfma_f32_16x16x32_bf16 v[236:239], a[224:227], a[136:139], v[236:239]
    ds_read_b128 a[224:227], v240 offset:62976
    v_cvt_pk_bf16_f32 v58, v234, v235
    v_mfma_f32_16x16x32_bf16 v[236:239], a[228:231], a[140:143], v[236:239]
    ds_read_b128 a[228:231], v241 offset:62976
    v_mfma_f32_16x16x32_bf16 v[228:231], a[0:3], a[232:235], 0
    s_waitcnt lgkmcnt(6)
    v_mfma_f32_16x16x32_bf16 v[228:231], a[4:7], a[236:239], v[228:231]
    v_mfma_f32_16x16x32_bf16 v[232:235], a[24:27], a[232:235], 0
    v_mfma_f32_16x16x32_bf16 v[232:235], a[28:31], a[236:239], v[232:235]
    s_waitcnt lgkmcnt(5)
    v_mfma_f32_16x16x32_bf16 v[228:231], a[8:11], a[240:243], v[228:231]
    s_waitcnt lgkmcnt(4)
    v_cvt_pk_bf16_f32 v85, v236, v237
    v_cvt_pk_bf16_f32 v88, v238, v239
    v_mfma_f32_16x16x32_bf16 v[228:231], a[12:15], a[244:247], v[228:231]
    s_waitcnt lgkmcnt(3)
    v_mfma_f32_16x16x32_bf16 v[228:231], a[16:19], a[216:219], v[228:231]
    s_waitcnt lgkmcnt(2)
    s_waitcnt vmcnt(0)
    ds_read_b64_tr_b16 a[164:165], v249 offset:3072
    v_mfma_f32_16x16x32_bf16 v[228:231], a[20:23], a[220:223], v[228:231]
    ds_read_b64_tr_b16 a[166:167], v250 offset:3072
    ds_read_b64_tr_b16 a[188:189], v249 offset:3104
    v_mfma_f32_16x16x32_bf16 v[232:235], a[32:35], a[240:243], v[232:235]
    ds_read_b64_tr_b16 a[190:191], v250 offset:3104
    ds_read_b64_tr_b16 a[212:213], v249 offset:3136
    v_mfma_f32_16x16x32_bf16 v[232:235], a[36:39], a[244:247], v[232:235]
    ds_read_b64_tr_b16 a[214:215], v250 offset:3136
    v_add_u32 v249, s66, v249
    v_mfma_f32_16x16x32_bf16 v[232:235], a[40:43], a[216:219], v[232:235]
    s_waitcnt lgkmcnt(6)
    v_cvt_pk_bf16_f32 v150, v228, v229
    v_cvt_pk_bf16_f32 v151, v230, v231
    v_mfma_f32_16x16x32_bf16 v[232:235], a[44:47], a[220:223], v[232:235]
    v_add_u32 v250, s66, v250
    s_lshl_b32 s66, s28, 1
    v_mfma_f32_16x16x32_bf16 v[236:239], a[48:51], a[232:235], 0
    v_mfma_f32_16x16x32_bf16 v[236:239], a[52:55], a[236:239], v[236:239]
    v_mfma_f32_16x16x32_bf16 v[236:239], a[56:59], a[240:243], v[236:239]
    v_mfma_f32_16x16x32_bf16 v[236:239], a[60:63], a[244:247], v[236:239]
    v_mfma_f32_16x16x32_bf16 v[236:239], a[64:67], a[216:219], v[236:239]
    s_waitcnt lgkmcnt(4)
    v_cvt_pk_bf16_f32 v152, v232, v233
    v_cvt_pk_bf16_f32 v153, v234, v235
    v_mfma_f32_16x16x32_bf16 v[236:239], a[68:71], a[220:223], v[236:239]
    s_waitcnt lgkmcnt(3)
    s_waitcnt lgkmcnt(0)
    s_barrier
    v_mfma_f32_16x16x32_bf16 v[228:231], a[232:235], a[72:75], 0
    s_barrier
    v_mfma_f32_16x16x32_bf16 v[228:231], a[236:239], a[76:79], v[228:231]
    buffer_load_dwordx4 v254, s[4:7], s43 offen lds
    v_accvgpr_read_b32 v254, a254
    v_mfma_f32_16x16x32_bf16 v[228:231], a[240:243], a[80:83], v[228:231]
    v_cvt_pk_bf16_f32 v154, v236, v237
    v_cvt_pk_bf16_f32 v155, v238, v239
    v_mfma_f32_16x16x32_bf16 v[228:231], a[244:247], a[84:87], v[228:231]
    v_mfma_f32_16x16x32_bf16 v[228:231], a[216:219], a[88:91], v[228:231]
    v_mfma_f32_16x16x32_bf16 v[228:231], a[220:223], a[92:95], v[228:231]
    buffer_load_dwordx4 v255, s[4:7], s43 offen offset:1024 lds
    v_accvgpr_read_b32 v255, a252
    v_mfma_f32_16x16x32_bf16 v[232:235], a[232:235], a[96:99], 0
    v_mfma_f32_16x16x32_bf16 v[232:235], a[236:239], a[100:103], v[232:235]
    v_mfma_f32_16x16x32_bf16 v[232:235], a[240:243], a[104:107], v[232:235]
    v_mfma_f32_16x16x32_bf16 v[232:235], a[244:247], a[108:111], v[232:235]
    buffer_load_dwordx4 v254, s[4:7], s43 offen offset:2048 lds
    s_add_u32 m0, s46, 0x17400
    v_mfma_f32_16x16x32_bf16 v[232:235], a[216:219], a[112:115], v[232:235]
    v_cvt_pk_bf16_f32 v2, v228, v229
    v_cvt_pk_bf16_f32 v5, v230, v231
    v_mfma_f32_16x16x32_bf16 v[232:235], a[220:223], a[116:119], v[232:235]
    v_accvgpr_read_b32 v254, a253
    v_mfma_f32_16x16x32_bf16 v[236:239], a[232:235], a[120:123], 0
    ds_read_b128 a[232:235], v240 offset:63104
    v_mfma_f32_16x16x32_bf16 v[236:239], a[236:239], a[124:127], v[236:239]
    ds_read_b128 a[236:239], v241 offset:63104
    buffer_load_dwordx4 v255, s[4:7], s59 offen lds
    v_mfma_f32_16x16x32_bf16 v[236:239], a[240:243], a[128:131], v[236:239]
    ds_read_b128 a[240:243], v240 offset:63232
    v_cvt_pk_bf16_f32 v32, v232, v233
    v_mfma_f32_16x16x32_bf16 v[236:239], a[244:247], a[132:135], v[236:239]
    ds_read_b128 a[244:247], v241 offset:63232
    v_cvt_pk_bf16_f32 v35, v234, v235
    v_mfma_f32_16x16x32_bf16 v[236:239], a[216:219], a[136:139], v[236:239]
    ds_read_b128 a[216:219], v240 offset:64512
    v_accvgpr_read_b32 v255, a254
    v_mfma_f32_16x16x32_bf16 v[236:239], a[220:223], a[140:143], v[236:239]
    ds_read_b128 a[220:223], v241 offset:64512
    buffer_load_dwordx4 v254, s[4:7], s59 offen offset:1024 lds
    v_mfma_f32_16x16x32_bf16 v[228:231], a[0:3], a[224:227], 0
    v_accvgpr_read_b32 v254, a252
    v_mfma_f32_16x16x32_bf16 v[228:231], a[4:7], a[228:231], v[228:231]
    v_mfma_f32_16x16x32_bf16 v[232:235], a[24:27], a[224:227], 0
    s_waitcnt lgkmcnt(5)
    v_mfma_f32_16x16x32_bf16 v[228:231], a[8:11], a[232:235], v[228:231]
    s_waitcnt lgkmcnt(4)
    v_cvt_pk_bf16_f32 v62, v236, v237
    v_cvt_pk_bf16_f32 v65, v238, v239
    v_mfma_f32_16x16x32_bf16 v[228:231], a[12:15], a[236:239], v[228:231]
    buffer_load_dwordx4 v255, s[4:7], s59 offen offset:2048 lds
    s_add_u32 m0, s46, 0x18000
    v_mfma_f32_16x16x32_bf16 v[232:235], a[28:31], a[228:231], v[232:235]
    s_add_u32 s59, s44, s45
    v_accvgpr_read_b32 v255, a255
    s_waitcnt lgkmcnt(3)
    v_mfma_f32_16x16x32_bf16 v[228:231], a[16:19], a[240:243], v[228:231]
    s_waitcnt lgkmcnt(2)
    v_mfma_f32_16x16x32_bf16 v[228:231], a[20:23], a[244:247], v[228:231]
    v_mfma_f32_16x16x32_bf16 v[232:235], a[32:35], a[232:235], v[232:235]
    buffer_load_dwordx4 v254, s[4:7], s58 offen lds
    v_xor_b32 v254, 16, v242
    v_mfma_f32_16x16x32_bf16 v[232:235], a[36:39], a[236:239], v[232:235]
    s_waitcnt lgkmcnt(0)
    v_add_u32 v254, 0x7500, v254
    v_cndmask_b32 v254, v242, v254, vcc
    v_mfma_f32_16x16x32_bf16 v[232:235], a[40:43], a[240:243], v[232:235]
    s_mov_b32 vcc_lo, 0x33333333
    v_cvt_pk_bf16_f32 v156, v228, v229
    v_cvt_pk_bf16_f32 v157, v230, v231
    v_mfma_f32_16x16x32_bf16 v[232:235], a[44:47], a[244:247], v[232:235]
    s_mov_b32 vcc_hi, 0x33333333
    v_mfma_f32_16x16x32_bf16 v[236:239], a[48:51], a[224:227], 0
    buffer_load_dwordx4 v255, s[4:7], s58 offen offset:512 lds
    v_xor_b32 v255, 64, v254
    v_mfma_f32_16x16x32_bf16 v[236:239], a[52:55], a[228:231], v[236:239]
    s_add_u32 m0, s46, 0
    s_lshl1_add_u32 s58, s45, s44
    v_mfma_f32_16x16x32_bf16 v[236:239], a[56:59], a[232:235], v[236:239]
    v_cvt_pk_bf16_f32 v158, v232, v233
    v_cvt_pk_bf16_f32 v159, v234, v235
    v_mfma_f32_16x16x32_bf16 v[236:239], a[60:63], a[236:239], v[236:239]
    v_mfma_f32_16x16x32_bf16 v[236:239], a[64:67], a[240:243], v[236:239]
    v_mfma_f32_16x16x32_bf16 v[236:239], a[68:71], a[244:247], v[236:239]
    v_mfma_f32_16x16x32_bf16 v[228:231], a[224:227], a[72:75], 0
    v_mfma_f32_16x16x32_bf16 v[228:231], a[228:231], a[76:79], v[228:231]
    v_mfma_f32_16x16x32_bf16 v[228:231], a[232:235], a[80:83], v[228:231]
    v_mfma_f32_16x16x32_bf16 v[228:231], a[236:239], a[84:87], v[228:231]
    v_mfma_f32_16x16x32_bf16 v[228:231], a[240:243], a[88:91], v[228:231]
    v_mfma_f32_16x16x32_bf16 v[228:231], a[244:247], a[92:95], v[228:231]
    v_mfma_f32_16x16x32_bf16 v[232:235], a[224:227], a[96:99], 0
    v_mfma_f32_16x16x32_bf16 v[232:235], a[228:231], a[100:103], v[232:235]
    v_cvt_pk_bf16_f32 v160, v236, v237
    v_cvt_pk_bf16_f32 v161, v238, v239
    v_mfma_f32_16x16x32_bf16 v[232:235], a[232:235], a[104:107], v[232:235]
    v_mfma_f32_16x16x32_bf16 v[232:235], a[236:239], a[108:111], v[232:235]
    v_mfma_f32_16x16x32_bf16 v[232:235], a[240:243], a[112:115], v[232:235]
    v_mfma_f32_16x16x32_bf16 v[232:235], a[244:247], a[116:119], v[232:235]
    v_cvt_pk_bf16_f32 v8, v228, v229
    v_cvt_pk_bf16_f32 v11, v230, v231
    v_mfma_f32_16x16x32_bf16 v[236:239], a[224:227], a[120:123], 0
    ds_read_b128 a[224:227], v240 offset:64640
    v_mfma_f32_16x16x32_bf16 v[236:239], a[228:231], a[124:127], v[236:239]
    ds_read_b128 a[228:231], v241 offset:64640
    v_mfma_f32_16x16x32_bf16 v[236:239], a[232:235], a[128:131], v[236:239]
    ds_read_b128 a[232:235], v240 offset:64768
    v_cvt_pk_bf16_f32 v38, v232, v233
    v_mfma_f32_16x16x32_bf16 v[236:239], a[236:239], a[132:135], v[236:239]
    ds_read_b128 a[236:239], v241 offset:64768
    v_cvt_pk_bf16_f32 v41, v234, v235
    v_mfma_f32_16x16x32_bf16 v[236:239], a[240:243], a[136:139], v[236:239]
    ds_read_b128 a[240:243], v242 offset:0
    v_add_u32 v240, 0xf000, v240
    v_mfma_f32_16x16x32_bf16 v[236:239], a[244:247], a[140:143], v[236:239]
    ds_read_b128 a[244:247], v243 offset:0
    v_add_u32 v241, 0xf000, v241
    v_mfma_f32_16x16x32_bf16 v[228:231], a[0:3], a[216:219], 0
    v_mfma_f32_16x16x32_bf16 v[228:231], a[4:7], a[220:223], v[228:231]
    v_mfma_f32_16x16x32_bf16 v[232:235], a[24:27], a[216:219], 0
    v_mfma_f32_16x16x32_bf16 v[232:235], a[28:31], a[220:223], v[232:235]
    s_waitcnt lgkmcnt(5)
    v_mfma_f32_16x16x32_bf16 v[228:231], a[8:11], a[224:227], v[228:231]
    s_waitcnt lgkmcnt(4)
    v_cvt_pk_bf16_f32 v68, v236, v237
    v_cvt_pk_bf16_f32 v71, v238, v239
    v_mfma_f32_16x16x32_bf16 v[228:231], a[12:15], a[228:231], v[228:231]
    s_waitcnt lgkmcnt(3)
    v_mfma_f32_16x16x32_bf16 v[228:231], a[16:19], a[232:235], v[228:231]
    s_waitcnt lgkmcnt(2)
    v_mfma_f32_16x16x32_bf16 v[228:231], a[20:23], a[236:239], v[228:231]
    v_mfma_f32_16x16x32_bf16 v[232:235], a[32:35], a[224:227], v[232:235]
    s_waitcnt lgkmcnt(1)
    v_mfma_f32_16x16x32_bf16 v[232:235], a[36:39], a[228:231], v[232:235]
    s_waitcnt lgkmcnt(0)
    v_mfma_f32_16x16x32_bf16 v[232:235], a[40:43], a[232:235], v[232:235]
    v_mfma_f32_16x16x32_bf16 v[232:235], a[44:47], a[236:239], v[232:235]
    v_mfma_f32_16x16x32_bf16 v[236:239], a[48:51], a[216:219], 0
    v_mfma_f32_16x16x32_bf16 v[236:239], a[52:55], a[220:223], v[236:239]
    v_cvt_pk_bf16_f32 v162, v228, v229
    v_cvt_pk_bf16_f32 v163, v230, v231
    v_mfma_f32_16x16x32_bf16 v[236:239], a[56:59], a[224:227], v[236:239]
    v_mfma_f32_16x16x32_bf16 v[236:239], a[60:63], a[228:231], v[236:239]
    v_mfma_f32_16x16x32_bf16 v[236:239], a[64:67], a[232:235], v[236:239]
    v_mfma_f32_16x16x32_bf16 v[236:239], a[68:71], a[236:239], v[236:239]
    v_cvt_pk_bf16_f32 v164, v232, v233
    v_cvt_pk_bf16_f32 v165, v234, v235
    v_mfma_f32_16x16x32_bf16 v[228:231], a[216:219], a[72:75], 0
    v_mfma_f32_16x16x32_bf16 v[228:231], a[220:223], a[76:79], v[228:231]
    v_mfma_f32_16x16x32_bf16 v[228:231], a[224:227], a[80:83], v[228:231]
    v_mfma_f32_16x16x32_bf16 v[228:231], a[228:231], a[84:87], v[228:231]
    v_mfma_f32_16x16x32_bf16 v[228:231], a[232:235], a[88:91], v[228:231]
    v_mfma_f32_16x16x32_bf16 v[228:231], a[236:239], a[92:95], v[228:231]
    v_cvt_pk_bf16_f32 v166, v236, v237
    v_cvt_pk_bf16_f32 v167, v238, v239
    v_mfma_f32_16x16x32_bf16 v[232:235], a[216:219], a[96:99], 0
    v_mfma_f32_16x16x32_bf16 v[232:235], a[220:223], a[100:103], v[232:235]
    v_mfma_f32_16x16x32_bf16 v[232:235], a[224:227], a[104:107], v[232:235]
    v_mfma_f32_16x16x32_bf16 v[232:235], a[228:231], a[108:111], v[232:235]
    v_mfma_f32_16x16x32_bf16 v[232:235], a[232:235], a[112:115], v[232:235]
    v_mfma_f32_16x16x32_bf16 v[232:235], a[236:239], a[116:119], v[232:235]
    v_cvt_pk_bf16_f32 v14, v228, v229
    v_cvt_pk_bf16_f32 v17, v230, v231
    v_mfma_f32_16x16x32_bf16 v[236:239], a[216:219], a[120:123], 0
    ds_read_b128 a[216:219], v242 offset:128
    v_mfma_f32_16x16x32_bf16 v[236:239], a[220:223], a[124:127], v[236:239]
    ds_read_b128 a[220:223], v243 offset:128
    v_mfma_f32_16x16x32_bf16 v[236:239], a[224:227], a[128:131], v[236:239]
    ds_read_b128 a[224:227], v242 offset:256
    v_cvt_pk_bf16_f32 v44, v232, v233
    v_mfma_f32_16x16x32_bf16 v[236:239], a[228:231], a[132:135], v[236:239]
    ds_read_b128 a[228:231], v243 offset:256
    v_cvt_pk_bf16_f32 v47, v234, v235
    v_mfma_f32_16x16x32_bf16 v[236:239], a[232:235], a[136:139], v[236:239]
    ds_read_b128 a[232:235], v242 offset:1536
    v_mfma_f32_16x16x32_bf16 v[236:239], a[236:239], a[140:143], v[236:239]
    ds_read_b128 a[236:239], v243 offset:1536
    v_mfma_f32_16x16x32_bf16 v[228:231], a[144:147], a[240:243], 0
    v_mfma_f32_16x16x32_bf16 v[228:231], a[148:151], a[244:247], v[228:231]
    v_mfma_f32_16x16x32_bf16 v[232:235], a[168:171], a[240:243], 0
    v_mfma_f32_16x16x32_bf16 v[232:235], a[172:175], a[244:247], v[232:235]
    s_waitcnt lgkmcnt(5)
    v_mfma_f32_16x16x32_bf16 v[228:231], a[152:155], a[216:219], v[228:231]
    s_waitcnt lgkmcnt(4)
    v_cvt_pk_bf16_f32 v74, v236, v237
    v_cvt_pk_bf16_f32 v77, v238, v239
    v_mfma_f32_16x16x32_bf16 v[228:231], a[156:159], a[220:223], v[228:231]
    s_waitcnt lgkmcnt(3)
    v_mfma_f32_16x16x32_bf16 v[228:231], a[160:163], a[224:227], v[228:231]
    s_waitcnt lgkmcnt(2)
    v_mfma_f32_16x16x32_bf16 v[228:231], a[164:167], a[228:231], v[228:231]
    v_mfma_f32_16x16x32_bf16 v[232:235], a[176:179], a[216:219], v[232:235]
    s_waitcnt lgkmcnt(1)
    v_mfma_f32_16x16x32_bf16 v[232:235], a[180:183], a[220:223], v[232:235]
    s_waitcnt lgkmcnt(0)
    v_mfma_f32_16x16x32_bf16 v[232:235], a[184:187], a[224:227], v[232:235]
    v_mfma_f32_16x16x32_bf16 v[232:235], a[188:191], a[228:231], v[232:235]
    v_mfma_f32_16x16x32_bf16 v[236:239], a[192:195], a[240:243], 0
    ds_read_b128 a[240:243], v242 offset:1664
    v_mul_f32 v228, s38, v228
    v_mfma_f32_16x16x32_bf16 v[236:239], a[196:199], a[244:247], v[236:239]
    v_mul_f32 v229, s38, v229
    v_mul_f32 v230, s38, v230
    v_mfma_f32_16x16x32_bf16 v[236:239], a[200:203], a[216:219], v[236:239]
    v_mul_f32 v231, s38, v231
    v_cvt_pk_bf16_f32 v168, v228, v229
    v_mfma_f32_16x16x32_bf16 v[236:239], a[204:207], a[220:223], v[236:239]
    v_cvt_pk_bf16_f32 v169, v230, v231
    v_mul_f32 v232, s3, v232
    v_mfma_f32_16x16x32_bf16 v[236:239], a[208:211], a[224:227], v[236:239]
    v_mul_f32 v233, s3, v233
    v_mul_f32 v234, s3, v234
    v_mfma_f32_16x16x32_bf16 v[236:239], a[212:215], a[228:231], v[236:239]
    v_mul_f32 v235, s3, v235
    v_cvt_pk_bf16_f32 v170, v232, v233
    v_mfma_f32_16x16x32_bf16 v[228:231], a[144:147], a[232:235], 0
    ds_read_b128 a[244:247], v243 offset:1664
    v_cvt_pk_bf16_f32 v171, v234, v235
    v_mfma_f32_16x16x32_bf16 v[228:231], a[148:151], a[236:239], v[228:231]
    ds_read_b128 a[216:219], v242 offset:1792
    ds_read_b128 a[220:223], v243 offset:1792
    v_mfma_f32_16x16x32_bf16 v[196:199], v[102:105], v[168:171], v[196:199]
    s_waitcnt lgkmcnt(3)
    v_mul_f32 v236, s38, v236
    v_mul_f32 v237, s38, v237
    v_mfma_f32_16x16x32_bf16 v[200:203], v[114:117], v[168:171], v[200:203]
    v_mul_f32 v238, s38, v238
    v_mul_f32 v239, s38, v239
    v_mfma_f32_16x16x32_bf16 v[204:207], v[150:153], v[168:171], v[204:207]
    v_cvt_pk_bf16_f32 v172, v236, v237
    v_cvt_pk_bf16_f32 v173, v238, v239
    v_mfma_f32_16x16x32_bf16 v[208:211], v[108:111], v[168:171], v[208:211]
    ds_read_b128 a[224:227], v240 offset:4608
    ds_read_b128 a[228:231], v241 offset:4608
    v_mfma_f32_16x16x32_bf16 v[196:199], v[104:107], v[170:173], v[196:199]
    v_mfma_f32_16x16x32_bf16 v[200:203], v[116:119], v[170:173], v[200:203]
    v_mfma_f32_16x16x32_bf16 v[204:207], v[152:155], v[170:173], v[204:207]
    v_mfma_f32_16x16x32_bf16 v[208:211], v[110:113], v[170:173], v[208:211]
    s_waitcnt lgkmcnt(4)
    v_mfma_f32_16x16x32_bf16 v[228:231], a[152:155], a[240:243], v[228:231]
    s_waitcnt lgkmcnt(3)
    v_mfma_f32_16x16x32_bf16 v[228:231], a[156:159], a[244:247], v[228:231]
    s_waitcnt lgkmcnt(2)
    v_max_f32 v248, v196, v197
    v_max3_f32 v248, v248, v198, v199
    v_mfma_f32_16x16x32_bf16 v[228:231], a[160:163], a[216:219], v[228:231]
    ds_read_b128 v[196:199], v245 offset:256
    v_max3_f32 v248, v248, v200, v201
    v_mfma_f32_16x16x32_bf16 v[228:231], a[164:167], a[220:223], v[228:231]
    v_max3_f32 v248, v248, v202, v203
    v_max3_f32 v248, v248, v204, v205
    v_mfma_f32_16x16x32_bf16 v[232:235], a[168:171], a[232:235], 0
    ds_read_b128 v[200:203], v246 offset:256
    v_max3_f32 v248, v248, v206, v207
    v_mfma_f32_16x16x32_bf16 v[232:235], a[172:175], a[236:239], v[232:235]
    ds_read_b128 v[204:207], v244 offset:320
    v_max3_f32 v248, v248, v208, v209
    v_mfma_f32_16x16x32_bf16 v[232:235], a[176:179], a[240:243], v[232:235]
    s_waitcnt lgkmcnt(3)
    v_mul_f32 v228, s38, v228
    v_mul_f32 v229, s38, v229
    v_mfma_f32_16x16x32_bf16 v[232:235], a[180:183], a[244:247], v[232:235]
    v_mul_f32 v230, s38, v230
    v_mul_f32 v231, s38, v231
    v_mfma_f32_16x16x32_bf16 v[232:235], a[184:187], a[216:219], v[232:235]
    v_cvt_pk_bf16_f32 v174, v228, v229
    v_cvt_pk_bf16_f32 v175, v230, v231
    v_mfma_f32_16x16x32_bf16 v[232:235], a[188:191], a[220:223], v[232:235]
    v_max3_f32 v248, v248, v210, v211
    v_mfma_f32_16x16x32_bf16 v[236:239], a[192:195], a[232:235], 0
    ds_read_b128 a[232:235], v240 offset:4736
    ds_read_b128 v[208:211], v245 offset:320
    v_mfma_f32_16x16x32_bf16 v[236:239], a[196:199], a[236:239], v[236:239]
    ds_read_b128 a[236:239], v241 offset:4736
    s_waitcnt lgkmcnt(5)
    v_mfma_f32_16x16x32_bf16 v[196:199], v[120:123], v[168:171], v[196:199]
    s_waitcnt lgkmcnt(4)
    v_mul_f32 v232, s3, v232
    v_mul_f32 v233, s3, v233
    v_mfma_f32_16x16x32_bf16 v[196:199], v[122:125], v[170:173], v[196:199]
    s_waitcnt lgkmcnt(3)
    v_mul_f32 v234, s3, v234
    v_mul_f32 v235, s3, v235
    v_mfma_f32_16x16x32_bf16 v[200:203], v[156:159], v[168:171], v[200:203]
    v_cvt_pk_bf16_f32 v176, v232, v233
    v_cvt_pk_bf16_f32 v177, v234, v235
    v_mfma_f32_16x16x32_bf16 v[200:203], v[158:161], v[170:173], v[200:203]
    v_mfma_f32_16x16x32_bf16 v[204:207], v[90:93], v[168:171], v[204:207]
    v_max3_f32 v248, v248, v196, v197
    v_max3_f32 v248, v248, v198, v199
    v_mfma_f32_16x16x32_bf16 v[204:207], v[92:95], v[170:173], v[204:207]
    ds_read_b128 v[196:199], v246 offset:320
    v_mfma_f32_16x16x32_bf16 v[236:239], a[200:203], a[240:243], v[236:239]
    ds_read_b128 a[240:243], v240 offset:4864
    v_mfma_f32_16x16x32_bf16 v[236:239], a[204:207], a[244:247], v[236:239]
    ds_read_b128 a[244:247], v241 offset:4864
    v_max3_f32 v248, v248, v200, v201
    v_mfma_f32_16x16x32_bf16 v[236:239], a[208:211], a[216:219], v[236:239]
    ds_read_b128 a[216:219], v242 offset:3072
    v_max3_f32 v248, v248, v202, v203
    v_mfma_f32_16x16x32_bf16 v[236:239], a[212:215], a[220:223], v[236:239]
    ds_read_b128 a[220:223], v243 offset:3072
    ds_read_b128 v[200:203], v244 offset:192
    v_mfma_f32_16x16x32_bf16 v[228:231], a[0:3], a[224:227], 0
    s_waitcnt lgkmcnt(7)
    v_max3_f32 v248, v248, v204, v205
    v_mfma_f32_16x16x32_bf16 v[208:211], v[126:129], v[168:171], v[208:211]
    ds_read_b128 v[204:207], v245 offset:192
    v_mfma_f32_16x16x32_bf16 v[208:211], v[128:131], v[170:173], v[208:211]
    s_waitcnt lgkmcnt(7)
    v_mul_f32 v236, s38, v236
    v_mul_f32 v237, s38, v237
    v_mfma_f32_16x16x32_bf16 v[228:231], a[4:7], a[228:231], v[228:231]
    s_waitcnt lgkmcnt(6)
    v_mul_f32 v238, s38, v238
    v_mul_f32 v239, s38, v239
    v_mfma_f32_16x16x32_bf16 v[196:199], v[162:165], v[168:171], v[196:199]
    v_cvt_pk_bf16_f32 v178, v236, v237
    v_cvt_pk_bf16_f32 v179, v238, v239
    v_mfma_f32_16x16x32_bf16 v[196:199], v[164:167], v[170:173], v[196:199]
    v_max3_f32 v248, v248, v208, v209
    v_mfma_f32_16x16x32_bf16 v[228:231], a[8:11], a[232:235], v[228:231]
    ds_read_b128 v[208:211], v246 offset:192
    v_mfma_f32_16x16x32_bf16 v[228:231], a[12:15], a[236:239], v[228:231]
    s_waitcnt lgkmcnt(6)
    v_mfma_f32_16x16x32_bf16 v[228:231], a[16:19], a[240:243], v[228:231]
    s_waitcnt lgkmcnt(2)
    v_mfma_f32_16x16x32_bf16 v[200:203], v[102:105], v[168:171], v[200:203]
    v_max3_f32 v248, v248, v196, v197
    v_mov_b32 v225, v248
    v_mfma_f32_16x16x32_bf16 v[200:203], v[104:107], v[170:173], v[200:203]
    ds_read_b128 v[196:199], v244 offset:256
    v_permlane16_swap_b32 v248, v225
    v_mfma_f32_16x16x32_bf16 v[228:231], a[20:23], a[244:247], v[228:231]
    s_waitcnt lgkmcnt(2)
    v_max_f32 v248, v248, v225
    v_mov_b32 v225, v248
    v_mfma_f32_16x16x32_bf16 v[204:207], v[114:117], v[168:171], v[204:207]
    v_mfma_f32_16x16x32_bf16 v[204:207], v[116:119], v[170:173], v[204:207]
    v_permlane32_swap_b32 v248, v225
    v_max_f32 v248, v248, v225
    v_mfma_f32_16x16x32_bf16 v[232:235], a[24:27], a[224:227], 0
    v_cvt_pk_bf16_f32 v102, v228, v229
    v_cvt_pk_bf16_f32 v103, v230, v231
    v_mfma_f32_16x16x32_bf16 v[232:235], a[28:31], a[228:231], v[232:235]
    s_waitcnt lgkmcnt(1)
    v_sub_f32 v200, v200, v248
    v_sub_f32 v201, v201, v248
    v_mfma_f32_16x16x32_bf16 v[208:211], v[150:153], v[168:171], v[208:211]
    v_exp_f32 v200, v200
    v_mfma_f32_16x16x32_bf16 v[208:211], v[152:155], v[170:173], v[208:211]
    v_exp_f32 v201, v201
    v_mfma_f32_16x16x32_bf16 v[232:235], a[32:35], a[232:235], v[232:235]
    v_sub_f32 v202, v202, v248
    v_sub_f32 v203, v203, v248
    v_mfma_f32_16x16x32_bf16 v[232:235], a[36:39], a[236:239], v[232:235]
    s_waitcnt lgkmcnt(0)
    v_exp_f32 v202, v202
    v_mfma_f32_16x16x32_bf16 v[196:199], v[108:111], v[168:171], v[196:199]
    v_exp_f32 v203, v203
    v_mfma_f32_16x16x32_bf16 v[196:199], v[110:113], v[170:173], v[196:199]
    v_cvt_pk_bf16_f32 v180, v200, v201
    v_cvt_pk_bf16_f32 v183, v202, v203
    v_mfma_f32_16x16x32_bf16 v[232:235], a[40:43], a[240:243], v[232:235]
    ds_read_b128 v[200:203], v245 offset:256
    v_sub_f32 v204, v204, v248
    v_mfma_f32_16x16x32_bf16 v[232:235], a[44:47], a[244:247], v[232:235]
    v_exp_f32 v204, v204
    v_mfma_f32_16x16x32_bf16 v[236:239], a[48:51], a[224:227], 0
    v_sub_f32 v205, v205, v248
    v_sub_f32 v206, v206, v248
    v_mfma_f32_16x16x32_bf16 v[236:239], a[52:55], a[228:231], v[236:239]
    v_exp_f32 v205, v205
    v_mfma_f32_16x16x32_bf16 v[236:239], a[56:59], a[232:235], v[236:239]
    v_exp_f32 v206, v206
    v_mfma_f32_16x16x32_bf16 v[236:239], a[60:63], a[236:239], v[236:239]
    v_cvt_pk_bf16_f32 v104, v232, v233
    v_cvt_pk_bf16_f32 v105, v234, v235
    v_mfma_f32_16x16x32_bf16 v[236:239], a[64:67], a[240:243], v[236:239]
    v_sub_f32 v207, v207, v248
    v_cvt_pk_bf16_f32 v181, v204, v205
    v_mfma_f32_16x16x32_bf16 v[236:239], a[68:71], a[244:247], v[236:239]
    v_exp_f32 v207, v207
    v_mfma_f32_16x16x32_bf16 v[228:231], a[224:227], a[72:75], 0
    v_cvt_pk_bf16_f32 v184, v206, v207
    v_sub_f32 v208, v208, v248
    v_mfma_f32_16x16x32_bf16 v[228:231], a[228:231], a[76:79], v[228:231]
    ds_read_b128 v[204:207], v246 offset:256
    v_sub_f32 v209, v209, v248
    v_mfma_f32_16x16x32_bf16 v[228:231], a[232:235], a[80:83], v[228:231]
    s_waitcnt lgkmcnt(1)
    v_cvt_pk_bf16_f32 v106, v236, v237
    v_cvt_pk_bf16_f32 v107, v238, v239
    v_mfma_f32_16x16x32_bf16 v[200:203], v[120:123], v[168:171], v[200:203]
    v_exp_f32 v208, v208
    v_mfma_f32_16x16x32_bf16 v[200:203], v[122:125], v[170:173], v[200:203]
    v_exp_f32 v209, v209
    v_mfma_f32_16x16x32_bf16 v[228:231], a[236:239], a[84:87], v[228:231]
    v_sub_f32 v210, v210, v248
    v_sub_f32 v211, v211, v248
    v_mfma_f32_16x16x32_bf16 v[228:231], a[240:243], a[88:91], v[228:231]
    v_exp_f32 v210, v210
    v_mfma_f32_16x16x32_bf16 v[228:231], a[244:247], a[92:95], v[228:231]
    v_exp_f32 v211, v211
    v_mfma_f32_16x16x32_bf16 v[232:235], a[224:227], a[96:99], 0
    v_cvt_pk_bf16_f32 v182, v208, v209
    v_cvt_pk_bf16_f32 v185, v210, v211
    v_mfma_f32_16x16x32_bf16 v[232:235], a[228:231], a[100:103], v[232:235]
    ds_read_b128 v[208:211], v244 offset:320
    v_sub_f32 v196, v196, v248
    v_mfma_f32_16x16x32_bf16 v[212:215], v[0:3], v[180:183], 0
    s_waitcnt lgkmcnt(1)
    v_cvt_pk_bf16_f32 v20, v228, v229
    v_cvt_pk_bf16_f32 v23, v230, v231
    v_mfma_f32_16x16x32_bf16 v[216:219], v[30:33], v[180:183], 0
    v_exp_f32 v196, v196
    v_mfma_f32_16x16x32_bf16 v[220:223], v[60:63], v[180:183], 0
    v_sub_f32 v197, v197, v248
    v_sub_f32 v198, v198, v248
    v_mfma_f32_16x16x32_bf16 v[224:227], a[248:251], v[180:183], 0
    v_exp_f32 v197, v197
    v_mfma_f32_16x16x32_bf16 v[204:207], v[156:159], v[168:171], v[204:207]
    v_exp_f32 v198, v198
    v_mfma_f32_16x16x32_bf16 v[204:207], v[158:161], v[170:173], v[204:207]
    v_sub_f32 v199, v199, v248
    v_cvt_pk_bf16_f32 v186, v196, v197
    v_mfma_f32_16x16x32_bf16 v[232:235], a[232:235], a[104:107], v[232:235]
    v_exp_f32 v199, v199
    v_mfma_f32_16x16x32_bf16 v[232:235], a[236:239], a[108:111], v[232:235]
    v_cvt_pk_bf16_f32 v189, v198, v199
    v_sub_f32 v200, v200, v248
    v_mfma_f32_16x16x32_bf16 v[232:235], a[240:243], a[112:115], v[232:235]
    ds_read_b128 v[196:199], v245 offset:320
    v_sub_f32 v201, v201, v248
    v_mfma_f32_16x16x32_bf16 v[232:235], a[244:247], a[116:119], v[232:235]
    s_waitcnt lgkmcnt(1)
    v_exp_f32 v200, v200
    v_mfma_f32_16x16x32_bf16 v[208:211], v[90:93], v[168:171], v[208:211]
    v_exp_f32 v201, v201
    v_mfma_f32_16x16x32_bf16 v[208:211], v[92:95], v[170:173], v[208:211]
    v_sub_f32 v202, v202, v248
    v_sub_f32 v203, v203, v248
    v_mfma_f32_16x16x32_bf16 v[236:239], a[224:227], a[120:123], 0
    v_cvt_pk_bf16_f32 v50, v232, v233
    v_cvt_pk_bf16_f32 v53, v234, v235
    v_mfma_f32_16x16x32_bf16 v[236:239], a[228:231], a[124:127], v[236:239]
    ds_read_b128 a[224:227], v242 offset:3200
    ds_read_b128 a[228:231], v243 offset:3200
    v_mfma_f32_16x16x32_bf16 v[236:239], a[232:235], a[128:131], v[236:239]
    ds_read_b128 a[232:235], v242 offset:3328
    v_cvt_pk_bf16_f32 v187, v200, v201
    v_mfma_f32_16x16x32_bf16 v[236:239], a[236:239], a[132:135], v[236:239]
    ds_read_b128 a[236:239], v243 offset:3328
    v_sub_f32 v204, v204, v248
    v_mfma_f32_16x16x32_bf16 v[212:215], v[4:7], v[184:187], v[212:215]
    s_waitcnt lgkmcnt(4)
    v_exp_f32 v202, v202
    v_mfma_f32_16x16x32_bf16 v[216:219], v[34:37], v[184:187], v[216:219]
    v_exp_f32 v203, v203
    v_mfma_f32_16x16x32_bf16 v[220:223], v[64:67], v[184:187], v[220:223]
    v_cvt_pk_bf16_f32 v190, v202, v203
    v_sub_f32 v205, v205, v248
    v_mfma_f32_16x16x32_bf16 v[224:227], a[248:251], v[184:187], v[224:227]
    ds_read_b128 v[200:203], v246 offset:320
    v_sub_f32 v206, v206, v248
    v_mfma_f32_16x16x32_bf16 v[196:199], v[126:129], v[168:171], v[196:199]
    v_exp_f32 v204, v204
    v_mfma_f32_16x16x32_bf16 v[196:199], v[128:131], v[170:173], v[196:199]
    v_exp_f32 v205, v205
    v_mfma_f32_16x16x32_bf16 v[236:239], a[240:243], a[136:139], v[236:239]
    ds_read_b128 a[240:243], v240 offset:6144
    v_sub_f32 v207, v207, v248
    v_mfma_f32_16x16x32_bf16 v[236:239], a[244:247], a[140:143], v[236:239]
    ds_read_b128 a[244:247], v241 offset:6144
    v_cvt_pk_bf16_f32 v188, v204, v205
    v_mfma_f32_16x16x32_bf16 v[228:231], a[144:147], a[216:219], 0
    s_waitcnt lgkmcnt(5)
    v_exp_f32 v206, v206
    v_mfma_f32_16x16x32_bf16 v[228:231], a[148:151], a[220:223], v[228:231]
    s_waitcnt lgkmcnt(4)
    v_exp_f32 v207, v207
    v_mfma_f32_16x16x32_bf16 v[228:231], a[152:155], a[224:227], v[228:231]
    s_waitcnt lgkmcnt(3)
    v_cvt_pk_bf16_f32 v80, v236, v237
    v_cvt_pk_bf16_f32 v83, v238, v239
    v_mfma_f32_16x16x32_bf16 v[228:231], a[156:159], a[228:231], v[228:231]
    v_cvt_pk_bf16_f32 v191, v206, v207
    v_sub_f32 v208, v208, v248
    v_mfma_f32_16x16x32_bf16 v[228:231], a[160:163], a[232:235], v[228:231]
    ds_read_b128 v[204:207], v244 offset:0
    v_sub_f32 v209, v209, v248
    v_mfma_f32_16x16x32_bf16 v[212:215], v[8:11], v[188:191], v[212:215]
    s_waitcnt lgkmcnt(3)
    v_exp_f32 v208, v208
    v_mfma_f32_16x16x32_bf16 v[216:219], v[38:41], v[188:191], v[216:219]
    v_exp_f32 v209, v209
    v_mfma_f32_16x16x32_bf16 v[220:223], v[68:71], v[188:191], v[220:223]
    v_cvt_pk_bf16_f32 v192, v208, v209
    v_sub_f32 v196, v196, v248
    v_mfma_f32_16x16x32_bf16 v[224:227], a[248:251], v[188:191], v[224:227]
    ds_read_b128 v[208:211], v245 offset:0
    v_sub_f32 v197, v197, v248
    v_mfma_f32_16x16x32_bf16 v[200:203], v[162:165], v[168:171], v[200:203]
    s_waitcnt lgkmcnt(2)
    v_exp_f32 v196, v196
    v_mfma_f32_16x16x32_bf16 v[200:203], v[164:167], v[170:173], v[200:203]
    v_exp_f32 v197, v197
    v_mfma_f32_16x16x32_bf16 v[228:231], a[164:167], a[236:239], v[228:231]
    v_cvt_pk_bf16_f32 v193, v196, v197
    v_mfma_f32_16x16x32_bf16 v[232:235], a[168:171], a[216:219], 0
    ds_read_b128 v[196:199], v246 offset:0
    s_waitcnt lgkmcnt(2)
    v_mfma_f32_16x16x32_bf16 v[204:207], v[108:111], v[174:177], v[204:207]
    v_mfma_f32_16x16x32_bf16 v[204:207], v[110:113], v[176:179], v[204:207]
    v_sub_f32 v200, v200, v248
    v_sub_f32 v201, v201, v248
    v_mfma_f32_16x16x32_bf16 v[232:235], a[172:175], a[220:223], v[232:235]
    v_mul_f32 v228, s38, v228
    v_mul_f32 v229, s38, v229
    v_mfma_f32_16x16x32_bf16 v[232:235], a[176:179], a[224:227], v[232:235]
    v_mul_f32 v230, s38, v230
    v_mul_f32 v231, s38, v231
    v_mfma_f32_16x16x32_bf16 v[232:235], a[180:183], a[228:231], v[232:235]
    s_waitcnt lgkmcnt(1)
    v_cvt_pk_bf16_f32 v168, v228, v229
    v_cvt_pk_bf16_f32 v169, v230, v231
    v_mfma_f32_16x16x32_bf16 v[208:211], v[120:123], v[174:177], v[208:211]
    v_exp_f32 v200, v200
    v_mfma_f32_16x16x32_bf16 v[208:211], v[122:125], v[176:179], v[208:211]
    v_exp_f32 v201, v201
    v_mfma_f32_16x16x32_bf16 v[232:235], a[184:187], a[232:235], v[232:235]
    v_cvt_pk_bf16_f32 v194, v200, v201
    v_max_f32 v248, v204, v205
    v_mfma_f32_16x16x32_bf16 v[232:235], a[188:191], a[236:239], v[232:235]
    ds_read_b128 v[200:203], v244 offset:64
    v_max3_f32 v248, v248, v206, v207
    v_mfma_f32_16x16x32_bf16 v[212:215], v[12:15], v[192:195], v[212:215]
    ds_read_b128 v[204:207], v245 offset:64
    v_max3_f32 v248, v248, v208, v209
    v_mfma_f32_16x16x32_bf16 v[216:219], v[42:45], v[192:195], v[216:219]
    s_waitcnt lgkmcnt(2)
    v_max3_f32 v248, v248, v210, v211
    v_mul_f32 v232, s3, v232
    v_mfma_f32_16x16x32_bf16 v[220:223], v[72:75], v[192:195], v[220:223]
    v_mul_f32 v233, s3, v233
    v_mul_f32 v234, s3, v234
    v_mfma_f32_16x16x32_bf16 v[224:227], a[248:251], v[192:195], v[224:227]
    v_mul_f32 v235, s3, v235
    v_cvt_pk_bf16_f32 v170, v232, v233
    v_mfma_f32_16x16x32_bf16 v[196:199], v[156:159], v[174:177], v[196:199]
    ds_read_b128 v[208:211], v246 offset:64
    v_cvt_pk_bf16_f32 v171, v234, v235
    v_mfma_f32_16x16x32_bf16 v[196:199], v[158:161], v[176:179], v[196:199]
    v_mfma_f32_16x16x32_bf16 v[236:239], a[192:195], a[216:219], 0
    ds_read_b128 a[216:219], v240 offset:6272
    v_mfma_f32_16x16x32_bf16 v[236:239], a[196:199], a[220:223], v[236:239]
    ds_read_b128 a[220:223], v241 offset:6272
    s_waitcnt lgkmcnt(4)
    v_mfma_f32_16x16x32_bf16 v[200:203], v[90:93], v[174:177], v[200:203]
    v_rcp_f32 v225, v224
    v_mfma_f32_16x16x32_bf16 v[200:203], v[92:95], v[176:179], v[200:203]
    s_waitcnt lgkmcnt(3)
    v_mul_f32 v212, v212, v225
    v_mul_f32 v213, v213, v225
    v_mfma_f32_16x16x32_bf16 v[204:207], v[126:129], v[174:177], v[204:207]
    v_mul_f32 v214, v214, v225
    v_mul_f32 v215, v215, v225
    v_mfma_f32_16x16x32_bf16 v[204:207], v[128:131], v[176:179], v[204:207]
    v_cvt_pk_bf16_f32 v212, v212, v213
    v_cvt_pk_bf16_f32 v213, v214, v215
    v_mfma_f32_16x16x32_bf16 v[236:239], a[200:203], a[224:227], v[236:239]
    ds_read_b128 a[224:227], v240 offset:6400
    v_mul_f32 v216, v216, v225
    v_mfma_f32_16x16x32_bf16 v[236:239], a[204:207], a[228:231], v[236:239]
    ds_read_b128 a[228:231], v241 offset:6400
    v_mul_f32 v217, v217, v225
    v_mfma_f32_16x16x32_bf16 v[236:239], a[208:211], a[232:235], v[236:239]
    ds_read_b128 a[232:235], v254 offset:4608
    v_mul_f32 v218, v218, v225
    v_mfma_f32_16x16x32_bf16 v[236:239], a[212:215], a[236:239], v[236:239]
    ds_read_b128 a[236:239], v255 offset:4608
    v_mul_f32 v219, v219, v225
    v_mfma_f32_16x16x32_bf16 v[228:231], a[0:3], a[240:243], 0
    ds_write_b64 v251, v[212:213] offset:0
    v_mfma_f32_16x16x32_bf16 v[228:231], a[4:7], a[244:247], v[228:231]
    s_waitcnt lgkmcnt(6)
    v_cvt_pk_bf16_f32 v216, v216, v217
    v_cvt_pk_bf16_f32 v217, v218, v219
    v_mfma_f32_16x16x32_bf16 v[208:211], v[162:165], v[174:177], v[208:211]
    s_waitcnt lgkmcnt(5)
    v_mul_f32 v236, s38, v236
    v_mul_f32 v237, s38, v237
    v_mfma_f32_16x16x32_bf16 v[208:211], v[164:167], v[176:179], v[208:211]
    v_mul_f32 v238, s38, v238
    v_mul_f32 v239, s38, v239
    v_mfma_f32_16x16x32_bf16 v[228:231], a[8:11], a[216:219], v[228:231]
    v_cvt_pk_bf16_f32 v172, v236, v237
    v_cvt_pk_bf16_f32 v173, v238, v239
    v_mfma_f32_16x16x32_bf16 v[228:231], a[12:15], a[220:223], v[228:231]
    ds_write_b64 v251, v[216:217] offset:128
    v_mfma_f32_16x16x32_bf16 v[232:235], a[24:27], a[240:243], 0
    s_waitcnt lgkmcnt(5)
    v_mul_f32 v220, v220, v225
    v_mul_f32 v221, v221, v225
    v_mfma_f32_16x16x32_bf16 v[228:231], a[16:19], a[224:227], v[228:231]
    s_waitcnt lgkmcnt(4)
    v_mul_f32 v222, v222, v225
    v_mul_f32 v223, v223, v225
    v_mfma_f32_16x16x32_bf16 v[228:231], a[20:23], a[228:231], v[228:231]
    s_waitcnt lgkmcnt(2)
    v_cvt_pk_bf16_f32 v220, v220, v221
    v_cvt_pk_bf16_f32 v221, v222, v223
    v_mfma_f32_16x16x32_bf16 v[232:235], a[28:31], a[244:247], v[232:235]
    ds_write_b64 v251, v[220:221] offset:256
    v_mfma_f32_16x16x32_bf16 v[232:235], a[32:35], a[216:219], v[232:235]
    v_max3_f32 v248, v248, v196, v197
    v_max3_f32 v248, v248, v198, v199
    v_mfma_f32_16x16x32_bf16 v[232:235], a[36:39], a[220:223], v[232:235]
    ds_read_b128 v[196:199], v244 offset:128
    v_max3_f32 v248, v248, v200, v201
    v_mfma_f32_16x16x32_bf16 v[232:235], a[40:43], a[224:227], v[232:235]
    v_max3_f32 v248, v248, v202, v203
    v_max3_f32 v248, v248, v204, v205
    v_mfma_f32_16x16x32_bf16 v[232:235], a[44:47], a[228:231], v[232:235]
    ds_read_b128 v[200:203], v245 offset:128
    v_max3_f32 v248, v248, v206, v207
    v_mfma_f32_16x16x32_bf16 v[236:239], a[48:51], a[240:243], 0
    ds_read_b128 v[204:207], v246 offset:128
    v_max3_f32 v248, v248, v208, v209
    v_mfma_f32_16x16x32_bf16 v[236:239], a[52:55], a[244:247], v[236:239]
    v_max3_f32 v248, v248, v210, v211
    v_mfma_f32_16x16x32_bf16 v[236:239], a[56:59], a[216:219], v[236:239]
    ds_read_b128 v[208:211], v244 offset:0
    v_mfma_f32_16x16x32_bf16 v[236:239], a[60:63], a[220:223], v[236:239]
    v_mfma_f32_16x16x32_bf16 v[236:239], a[64:67], a[224:227], v[236:239]
    v_mfma_f32_16x16x32_bf16 v[236:239], a[68:71], a[228:231], v[236:239]
    s_waitcnt lgkmcnt(3)
    v_mfma_f32_16x16x32_bf16 v[196:199], v[96:99], v[174:177], v[196:199]
    v_mfma_f32_16x16x32_bf16 v[196:199], v[98:101], v[176:179], v[196:199]
    s_nop 7
    s_waitcnt lgkmcnt(1)
    v_mfma_f32_16x16x32_bf16 v[200:203], v[132:135], v[174:177], v[200:203]
    v_max3_f32 v248, v248, v196, v197
    v_mfma_f32_16x16x32_bf16 v[200:203], v[134:137], v[176:179], v[200:203]
    ds_read_b128 v[196:199], v245 offset:0
    s_waitcnt lgkmcnt(1)
    v_mfma_f32_16x16x32_bf16 v[204:207], v[102:105], v[174:177], v[204:207]
    v_mfma_f32_16x16x32_bf16 v[204:207], v[104:107], v[176:179], v[204:207]
    v_mfma_f32_16x16x32_bf16 v[208:211], v[108:111], v[174:177], v[208:211]
    v_cvt_pk_bf16_f32 v108, v228, v229
    v_cvt_pk_bf16_f32 v109, v230, v231
    v_mfma_f32_16x16x32_bf16 v[208:211], v[110:113], v[176:179], v[208:211]
    v_cvt_pk_bf16_f32 v110, v232, v233
    v_cvt_pk_bf16_f32 v111, v234, v235
    v_mfma_f32_16x16x32_bf16 v[228:231], a[240:243], a[72:75], 0
    v_cvt_pk_bf16_f32 v112, v236, v237
    v_cvt_pk_bf16_f32 v113, v238, v239
    v_mfma_f32_16x16x32_bf16 v[228:231], a[244:247], a[76:79], v[228:231]
    v_max3_f32 v248, v248, v200, v201
    v_max3_f32 v248, v248, v204, v205
    v_mfma_f32_16x16x32_bf16 v[228:231], a[216:219], a[80:83], v[228:231]
    ds_read_b128 v[200:203], v246 offset:0
    ds_read_b128 v[204:207], v244 offset:64
    v_mfma_f32_16x16x32_bf16 v[228:231], a[220:223], a[84:87], v[228:231]
    s_waitcnt lgkmcnt(2)
    v_mov_b32 v225, v248
    v_mfma_f32_16x16x32_bf16 v[196:199], v[120:123], v[174:177], v[196:199]
    v_mfma_f32_16x16x32_bf16 v[196:199], v[122:125], v[176:179], v[196:199]
    v_permlane16_swap_b32 v248, v225
    v_max_f32 v248, v248, v225
    v_mfma_f32_16x16x32_bf16 v[228:231], a[224:227], a[88:91], v[228:231]
    v_mov_b32 v225, v248
    v_mfma_f32_16x16x32_bf16 v[228:231], a[228:231], a[92:95], v[228:231]
    v_mfma_f32_16x16x32_bf16 v[232:235], a[240:243], a[96:99], 0
    v_permlane32_swap_b32 v248, v225
    v_max_f32 v248, v248, v225
    v_mfma_f32_16x16x32_bf16 v[232:235], a[244:247], a[100:103], v[232:235]
    v_sub_f32 v208, v208, v248
    v_sub_f32 v209, v209, v248
    v_mfma_f32_16x16x32_bf16 v[232:235], a[216:219], a[104:107], v[232:235]
    s_waitcnt lgkmcnt(1)
    v_cvt_pk_bf16_f32 v26, v228, v229
    v_cvt_pk_bf16_f32 v29, v230, v231
    v_mfma_f32_16x16x32_bf16 v[200:203], v[156:159], v[174:177], v[200:203]
    s_waitcnt lgkmcnt(0)
    v_exp_f32 v208, v208
    v_mfma_f32_16x16x32_bf16 v[200:203], v[158:161], v[176:179], v[200:203]
    v_exp_f32 v209, v209
    v_mfma_f32_16x16x32_bf16 v[204:207], v[90:93], v[174:177], v[204:207]
    v_sub_f32 v210, v210, v248
    v_sub_f32 v211, v211, v248
    v_mfma_f32_16x16x32_bf16 v[204:207], v[92:95], v[176:179], v[204:207]
    v_exp_f32 v210, v210
    v_mfma_f32_16x16x32_bf16 v[232:235], a[220:223], a[108:111], v[232:235]
    v_exp_f32 v211, v211
    v_mfma_f32_16x16x32_bf16 v[232:235], a[224:227], a[112:115], v[232:235]
    v_cvt_pk_bf16_f32 v180, v208, v209
    v_cvt_pk_bf16_f32 v183, v210, v211
    v_mfma_f32_16x16x32_bf16 v[232:235], a[228:231], a[116:119], v[232:235]
    ds_read_b128 v[208:211], v245 offset:64
    v_sub_f32 v196, v196, v248
    v_mfma_f32_16x16x32_bf16 v[236:239], a[240:243], a[120:123], 0
    ds_read_b128 a[240:243], v254 offset:4736
    v_sub_f32 v197, v197, v248
    v_mfma_f32_16x16x32_bf16 v[236:239], a[244:247], a[124:127], v[236:239]
    ds_read_b128 a[244:247], v255 offset:4736
    v_sub_f32 v198, v198, v248
    v_mfma_f32_16x16x32_bf16 v[236:239], a[216:219], a[128:131], v[236:239]
    v_cvt_pk_bf16_f32 v56, v232, v233
    v_cvt_pk_bf16_f32 v59, v234, v235
    v_mfma_f32_16x16x32_bf16 v[236:239], a[220:223], a[132:135], v[236:239]
    ds_read_b128 a[216:219], v254 offset:4864
    ds_read_b128 a[220:223], v255 offset:4864
    v_mfma_f32_16x16x32_bf16 v[236:239], a[224:227], a[136:139], v[236:239]
    ds_read_b128 a[224:227], v242 offset:30720
    v_sub_f32 v199, v199, v248
    v_mfma_f32_16x16x32_bf16 v[236:239], a[228:231], a[140:143], v[236:239]
    ds_read_b128 a[228:231], v243 offset:30720
    v_sub_f32 v200, v200, v248
    v_mfma_f32_16x16x32_bf16 v[228:231], a[144:147], a[232:235], 0
    v_exp_f32 v196, v196
    v_mfma_f32_16x16x32_bf16 v[228:231], a[148:151], a[236:239], v[228:231]
    s_waitcnt lgkmcnt(6)
    v_exp_f32 v197, v197
    v_mfma_f32_16x16x32_bf16 v[208:211], v[126:129], v[174:177], v[208:211]
    s_waitcnt lgkmcnt(5)
    v_cvt_pk_bf16_f32 v86, v236, v237
    v_cvt_pk_bf16_f32 v89, v238, v239
    v_mfma_f32_16x16x32_bf16 v[208:211], v[128:131], v[176:179], v[208:211]
    v_exp_f32 v198, v198
    v_mfma_f32_16x16x32_bf16 v[228:231], a[152:155], a[240:243], v[228:231]
    s_waitcnt lgkmcnt(4)
    v_exp_f32 v199, v199
    v_mfma_f32_16x16x32_bf16 v[228:231], a[156:159], a[244:247], v[228:231]
    s_waitcnt lgkmcnt(3)
    v_cvt_pk_bf16_f32 v181, v196, v197
    v_cvt_pk_bf16_f32 v184, v198, v199
    v_mfma_f32_16x16x32_bf16 v[228:231], a[160:163], a[216:219], v[228:231]
    ds_read_b128 v[196:199], v246 offset:64
    s_waitcnt vmcnt(5) lgkmcnt(3)
    v_mfma_f32_16x16x32_bf16 v[228:231], a[164:167], a[220:223], v[228:231]
    s_barrier
    v_mfma_f32_16x16x32_bf16 v[232:235], a[168:171], a[232:235], 0
    s_waitcnt lgkmcnt(1)
    v_exp_f32 v200, v200
    v_mfma_f32_16x16x32_bf16 v[232:235], a[172:175], a[236:239], v[232:235]
    v_sub_f32 v201, v201, v248
    v_sub_f32 v202, v202, v248
    v_mfma_f32_16x16x32_bf16 v[232:235], a[176:179], a[240:243], v[232:235]
    v_mul_f32 v228, s38, v228
    v_mul_f32 v229, s38, v229
    v_mfma_f32_16x16x32_bf16 v[232:235], a[180:183], a[244:247], v[232:235]
    v_mul_f32 v230, s38, v230
    v_mul_f32 v231, s38, v231
    v_mfma_f32_16x16x32_bf16 v[232:235], a[184:187], a[216:219], v[232:235]
    v_exp_f32 v201, v201
    v_mfma_f32_16x16x32_bf16 v[232:235], a[188:191], a[220:223], v[232:235]
    s_waitcnt lgkmcnt(0)
    v_exp_f32 v202, v202
    v_mfma_f32_16x16x32_bf16 v[196:199], v[162:165], v[174:177], v[196:199]
    v_sub_f32 v203, v203, v248
    v_cvt_pk_bf16_f32 v182, v200, v201
    v_mfma_f32_16x16x32_bf16 v[196:199], v[164:167], v[176:179], v[196:199]
    v_exp_f32 v203, v203
    v_mfma_f32_16x16x32_bf16 v[212:215], v[6:9], v[180:183], 0
    v_mul_f32 v232, s3, v232
    v_mul_f32 v233, s3, v233
    v_mfma_f32_16x16x32_bf16 v[216:219], v[36:39], v[180:183], 0
    v_mul_f32 v234, s3, v234
    v_mul_f32 v235, s3, v235
    v_mfma_f32_16x16x32_bf16 v[220:223], v[66:69], v[180:183], 0
    v_cvt_pk_bf16_f32 v185, v202, v203
    v_sub_f32 v204, v204, v248
    v_mfma_f32_16x16x32_bf16 v[224:227], a[248:251], v[180:183], 0
    ds_read_b128 v[200:203], v244 offset:128
    v_sub_f32 v205, v205, v248
    v_mfma_f32_16x16x32_bf16 v[236:239], a[192:195], a[232:235], 0
    ds_read_b128 a[232:235], v242 offset:30848
    v_sub_f32 v206, v206, v248
    v_mfma_f32_16x16x32_bf16 v[236:239], a[196:199], a[236:239], v[236:239]
    ds_read_b128 a[236:239], v243 offset:30848
    v_sub_f32 v207, v207, v248
    v_mfma_f32_16x16x32_bf16 v[236:239], a[200:203], a[240:243], v[236:239]
    ds_read_b128 a[240:243], v242 offset:30976
    v_sub_f32 v208, v208, v248
    v_mfma_f32_16x16x32_bf16 v[236:239], a[204:207], a[244:247], v[236:239]
    ds_read_b128 a[244:247], v243 offset:30976
    v_sub_f32 v209, v209, v248
    v_mfma_f32_16x16x32_bf16 v[236:239], a[208:211], a[216:219], v[236:239]
    ds_read_b128 a[216:219], v240 offset:32256
    v_sub_f32 v210, v210, v248
    v_mfma_f32_16x16x32_bf16 v[236:239], a[212:215], a[220:223], v[236:239]
    ds_read_b128 a[220:223], v241 offset:32256
    v_exp_f32 v204, v204
    v_exp_f32 v205, v205
    v_exp_f32 v206, v206
    v_exp_f32 v207, v207
    s_waitcnt lgkmcnt(6)
    v_mfma_f32_16x16x32_bf16 v[200:203], v[96:99], v[174:177], v[200:203]
    v_cvt_pk_bf16_f32 v186, v204, v205
    v_mul_f32 v236, s38, v236
    v_mfma_f32_16x16x32_bf16 v[200:203], v[98:101], v[176:179], v[200:203]
    v_mul_f32 v237, s38, v237
    v_mul_f32 v238, s38, v238
    v_mul_f32 v239, s38, v239
    v_cvt_pk_bf16_f32 v189, v206, v207
    ds_read_b128 v[204:207], v245 offset:128
    v_exp_f32 v208, v208
    v_exp_f32 v209, v209
    v_exp_f32 v210, v210
    v_sub_f32 v211, v211, v248
    v_exp_f32 v211, v211
    v_cvt_pk_bf16_f32 v187, v208, v209
    v_cvt_pk_bf16_f32 v190, v210, v211
    ds_read_b128 v[208:211], v246 offset:128
    v_mfma_f32_16x16x32_bf16 v[212:215], v[10:13], v[184:187], v[212:215]
    s_waitcnt lgkmcnt(2)
    v_sub_f32 v196, v196, v248
    v_sub_f32 v197, v197, v248
    v_mfma_f32_16x16x32_bf16 v[216:219], v[40:43], v[184:187], v[216:219]
    v_exp_f32 v196, v196
    v_mfma_f32_16x16x32_bf16 v[220:223], v[70:73], v[184:187], v[220:223]
    v_exp_f32 v197, v197
    v_mfma_f32_16x16x32_bf16 v[224:227], a[248:251], v[184:187], v[224:227]
    v_sub_f32 v198, v198, v248
    v_exp_f32 v198, v198
    s_waitcnt lgkmcnt(1)
    v_mfma_f32_16x16x32_bf16 v[204:207], v[132:135], v[174:177], v[204:207]
    v_sub_f32 v199, v199, v248
    v_cvt_pk_bf16_f32 v188, v196, v197
    v_mfma_f32_16x16x32_bf16 v[204:207], v[134:137], v[176:179], v[204:207]
    v_exp_f32 v199, v199
    v_sub_f32 v200, v200, v248
    v_cvt_pk_bf16_f32 v191, v198, v199
    ds_read_b128 v[196:199], v244 offset:0
    s_waitcnt lgkmcnt(1)
    v_mfma_f32_16x16x32_bf16 v[212:215], v[14:17], v[188:191], v[212:215]
    v_exp_f32 v200, v200
    v_mfma_f32_16x16x32_bf16 v[216:219], v[44:47], v[188:191], v[216:219]
    v_sub_f32 v201, v201, v248
    v_sub_f32 v204, v204, v248
    v_mfma_f32_16x16x32_bf16 v[220:223], v[74:77], v[188:191], v[220:223]
    v_exp_f32 v201, v201
    v_mfma_f32_16x16x32_bf16 v[224:227], a[248:251], v[188:191], v[224:227]
    v_cvt_pk_bf16_f32 v192, v200, v201
    v_sub_f32 v205, v205, v248
    v_mfma_f32_16x16x32_bf16 v[208:211], v[102:105], v[174:177], v[208:211]
    v_cvt_pk_bf16_f32 v174, v228, v229
    v_cvt_pk_bf16_f32 v175, v230, v231
    v_mfma_f32_16x16x32_bf16 v[208:211], v[104:107], v[176:179], v[208:211]
    ds_write_b64 v247, v[174:175] offset:0
    v_mfma_f32_16x16x32_bf16 v[228:231], a[144:147], a[224:227], 0
    v_cvt_pk_bf16_f32 v176, v232, v233
    v_cvt_pk_bf16_f32 v177, v234, v235
    v_mfma_f32_16x16x32_bf16 v[228:231], a[148:151], a[228:231], v[228:231]
    ds_write_b64 v247, v[176:177] offset:128
    v_mfma_f32_16x16x32_bf16 v[228:231], a[152:155], a[232:235], v[228:231]
    s_waitcnt lgkmcnt(2)
    v_cvt_pk_bf16_f32 v178, v236, v237
    v_cvt_pk_bf16_f32 v179, v238, v239
    v_mfma_f32_16x16x32_bf16 v[196:199], v[90:93], v[168:171], v[196:199]
    ds_write_b64 v247, v[178:179] offset:256
    v_mfma_f32_16x16x32_bf16 v[196:199], v[92:95], v[170:173], v[196:199]
    ds_read_b128 v[200:203], v245 offset:0
    v_sub_f32 v208, v208, v248
    v_mfma_f32_16x16x32_bf16 v[228:231], a[156:159], a[236:239], v[228:231]
    v_exp_f32 v204, v204
    v_mfma_f32_16x16x32_bf16 v[228:231], a[160:163], a[240:243], v[228:231]
    v_exp_f32 v205, v205
    v_mfma_f32_16x16x32_bf16 v[228:231], a[164:167], a[244:247], v[228:231]
    v_cvt_pk_bf16_f32 v193, v204, v205
    v_sub_f32 v209, v209, v248
    v_mfma_f32_16x16x32_bf16 v[232:235], a[168:171], a[224:227], 0
    ds_read_b128 v[204:207], v246 offset:0
    v_max_f32 v248, v196, v197
    v_mfma_f32_16x16x32_bf16 v[232:235], a[172:175], a[228:231], v[232:235]
    v_exp_f32 v208, v208
    v_mfma_f32_16x16x32_bf16 v[232:235], a[176:179], a[232:235], v[232:235]
    v_mul_f32 v228, s38, v228
    v_mul_f32 v229, s38, v229
    v_mfma_f32_16x16x32_bf16 v[232:235], a[180:183], a[236:239], v[232:235]
    v_mul_f32 v230, s38, v230
    v_mul_f32 v231, s38, v231
    v_mfma_f32_16x16x32_bf16 v[232:235], a[184:187], a[240:243], v[232:235]
    v_exp_f32 v209, v209
    v_mfma_f32_16x16x32_bf16 v[232:235], a[188:191], a[244:247], v[232:235]
    s_waitcnt lgkmcnt(1)
    v_cvt_pk_bf16_f32 v194, v208, v209
    v_max3_f32 v248, v248, v198, v199
    v_mfma_f32_16x16x32_bf16 v[200:203], v[126:129], v[168:171], v[200:203]
    ds_read_b128 v[208:211], v244 offset:64
    ds_read_b128 v[196:199], v245 offset:64
    v_mfma_f32_16x16x32_bf16 v[212:215], v[18:21], v[192:195], v[212:215]
    v_accvgpr_read_b32 v254, a252
    v_mul_f32 v232, s3, v232
    v_mfma_f32_16x16x32_bf16 v[216:219], v[48:51], v[192:195], v[216:219]
    s_waitcnt lgkmcnt(2)
    v_mul_f32 v233, s3, v233
    v_mul_f32 v234, s3, v234
    v_mfma_f32_16x16x32_bf16 v[220:223], v[78:81], v[192:195], v[220:223]
    buffer_load_dwordx4 v254, s[4:7], s44 offen lds
    v_mul_f32 v235, s3, v235
    v_mfma_f32_16x16x32_bf16 v[224:227], a[248:251], v[192:195], v[224:227]
    v_accvgpr_read_b32 v255, a253
    v_accvgpr_read_b32 v254, a254
    v_mfma_f32_16x16x32_bf16 v[200:203], v[128:131], v[170:173], v[200:203]
    v_mfma_f32_16x16x32_bf16 v[204:207], v[162:165], v[168:171], v[204:207]
    v_mfma_f32_16x16x32_bf16 v[204:207], v[164:167], v[170:173], v[204:207]
    buffer_load_dwordx4 v255, s[4:7], s44 offen offset:1024 lds
    v_accvgpr_read_b32 v255, a252
    v_mfma_f32_16x16x32_bf16 v[236:239], a[192:195], a[224:227], 0
    ds_read_b128 a[224:227], v240 offset:32384
    s_waitcnt lgkmcnt(2)
    v_mfma_f32_16x16x32_bf16 v[208:211], v[96:99], v[168:171], v[208:211]
    s_waitcnt lgkmcnt(1)
    v_rcp_f32 v225, v224
    v_mfma_f32_16x16x32_bf16 v[208:211], v[98:101], v[170:173], v[208:211]
    v_mul_f32 v212, v212, v225
    v_mul_f32 v213, v213, v225
    v_mfma_f32_16x16x32_bf16 v[196:199], v[132:135], v[168:171], v[196:199]
    v_mul_f32 v214, v214, v225
    v_mul_f32 v215, v215, v225
    v_mfma_f32_16x16x32_bf16 v[196:199], v[134:137], v[170:173], v[196:199]
    v_cvt_pk_bf16_f32 v212, v212, v213
    v_cvt_pk_bf16_f32 v213, v214, v215
    v_mfma_f32_16x16x32_bf16 v[236:239], a[196:199], a[228:231], v[236:239]
    ds_read_b128 a[228:231], v241 offset:32384
    v_mul_f32 v216, v216, v225
    v_mfma_f32_16x16x32_bf16 v[236:239], a[200:203], a[232:235], v[236:239]
    ds_read_b128 a[232:235], v240 offset:32512
    v_mul_f32 v217, v217, v225
    v_mfma_f32_16x16x32_bf16 v[236:239], a[204:207], a[236:239], v[236:239]
    ds_read_b128 a[236:239], v241 offset:32512
    v_mul_f32 v218, v218, v225
    v_mfma_f32_16x16x32_bf16 v[236:239], a[208:211], a[240:243], v[236:239]
    ds_read_b128 a[240:243], v240 offset:30720
    v_mul_f32 v219, v219, v225
    v_mfma_f32_16x16x32_bf16 v[236:239], a[212:215], a[244:247], v[236:239]
    ds_read_b128 a[244:247], v241 offset:30720
    ds_write_b64 v251, v[212:213] offset:6144
    v_cvt_pk_bf16_f32 v216, v216, v217
    v_cvt_pk_bf16_f32 v217, v218, v219
    ds_write_b64 v251, v[216:217] offset:6272
    v_mul_f32 v220, v220, v225
    v_mul_f32 v221, v221, v225
    v_mul_f32 v222, v222, v225
    v_mul_f32 v236, s38, v236
    v_mul_f32 v237, s38, v237
    v_mul_f32 v238, s38, v238
    v_mul_f32 v239, s38, v239
    v_mul_f32 v223, v223, v225
    v_cvt_pk_bf16_f32 v220, v220, v221
    v_cvt_pk_bf16_f32 v221, v222, v223
    ds_write_b64 v251, v[220:221] offset:6400
    v_max3_f32 v248, v248, v200, v201
    v_max3_f32 v248, v248, v202, v203
    ds_read_b128 v[200:203], v246 offset:64
    v_max3_f32 v248, v248, v204, v205
    v_max3_f32 v248, v248, v206, v207
    ds_read_b128 v[204:207], v244 offset:128
    v_max3_f32 v248, v248, v208, v209
    v_max3_f32 v248, v248, v210, v211
    ds_read_b128 v[208:211], v245 offset:128
    v_max3_f32 v248, v248, v196, v197
    v_max3_f32 v248, v248, v198, v199
    ds_read_b128 v[196:199], v246 offset:128
    buffer_load_dwordx4 v254, s[4:7], s44 offen offset:2048 lds
    s_add_u32 m0, s46, 0xc00
    v_accvgpr_read_b32 v254, a253
    buffer_load_dwordx4 v255, s[4:7], s59 offen lds
    s_waitcnt lgkmcnt(3)
    v_mfma_f32_16x16x32_bf16 v[200:203], v[102:105], v[168:171], v[200:203]
    v_accvgpr_read_b32 v255, a254
    s_waitcnt lgkmcnt(2)
    v_mfma_f32_16x16x32_bf16 v[200:203], v[104:107], v[170:173], v[200:203]
    v_mfma_f32_16x16x32_bf16 v[204:207], v[138:141], v[168:171], v[204:207]
    s_waitcnt lgkmcnt(1)
    v_mfma_f32_16x16x32_bf16 v[204:207], v[140:143], v[170:173], v[204:207]
    buffer_load_dwordx4 v254, s[4:7], s59 offen offset:1024 lds
    v_accvgpr_read_b32 v254, a252
    v_mfma_f32_16x16x32_bf16 v[208:211], v[144:147], v[168:171], v[208:211]
    s_waitcnt lgkmcnt(0)
    v_mfma_f32_16x16x32_bf16 v[208:211], v[146:149], v[170:173], v[208:211]
    v_max3_f32 v248, v248, v200, v201
    v_max3_f32 v248, v248, v202, v203
    v_mfma_f32_16x16x32_bf16 v[196:199], v[108:111], v[168:171], v[196:199]
    ds_read_b128 v[200:203], v244 offset:0
    v_max3_f32 v248, v248, v204, v205
    v_mfma_f32_16x16x32_bf16 v[196:199], v[110:113], v[170:173], v[196:199]
    ds_read_b128 v[204:207], v245 offset:0
    buffer_load_dwordx4 v255, s[4:7], s59 offen offset:2048 lds
    v_max3_f32 v248, v248, v208, v209
    ds_read_b128 v[208:211], v246 offset:0
    s_add_u32 m0, s46, 0x1800
    v_accvgpr_read_b32 v255, a255
    s_nop 1
    v_max3_f32 v248, v248, v196, v197
    ds_read_b128 v[196:199], v244 offset:64
    v_mov_b32 v225, v248
    buffer_load_dwordx4 v254, s[4:7], s58 offen lds
    s_nop 0
    v_permlane16_swap_b32 v248, v225
    v_max_f32 v248, v248, v225
    v_mov_b32 v225, v248
    s_nop 1
    v_permlane32_swap_b32 v248, v225
    v_max_f32 v248, v248, v225
    s_waitcnt lgkmcnt(3)
    v_mfma_f32_16x16x32_bf16 v[200:203], v[90:93], v[168:171], v[200:203]
    v_mfma_f32_16x16x32_bf16 v[200:203], v[92:95], v[170:173], v[200:203]
    s_waitcnt lgkmcnt(2)
    buffer_load_dwordx4 v255, s[4:7], s58 offen offset:512 lds
    v_mfma_f32_16x16x32_bf16 v[204:207], v[126:129], v[168:171], v[204:207]
    s_add_u32 m0, s46, 0x16800
    s_waitcnt lgkmcnt(1)
    v_mfma_f32_16x16x32_bf16 v[204:207], v[128:131], v[170:173], v[204:207]
    v_mfma_f32_16x16x32_bf16 v[208:211], v[162:165], v[168:171], v[208:211]
    s_waitcnt lgkmcnt(0)
    v_sub_f32 v200, v200, v248
    v_sub_f32 v201, v201, v248
    v_mfma_f32_16x16x32_bf16 v[208:211], v[164:167], v[170:173], v[208:211]
    v_exp_f32 v200, v200
    v_mfma_f32_16x16x32_bf16 v[196:199], v[96:99], v[168:171], v[196:199]
    v_exp_f32 v201, v201
    v_mfma_f32_16x16x32_bf16 v[196:199], v[98:101], v[170:173], v[196:199]
    v_sub_f32 v202, v202, v248
    v_exp_f32 v202, v202
    v_sub_f32 v203, v203, v248
    v_exp_f32 v203, v203
    v_cvt_pk_bf16_f32 v180, v200, v201
    v_cvt_pk_bf16_f32 v183, v202, v203
    ds_read_b128 v[200:203], v245 offset:64
    v_sub_f32 v204, v204, v248
    v_exp_f32 v204, v204
    v_sub_f32 v205, v205, v248
    v_exp_f32 v205, v205
    v_sub_f32 v206, v206, v248
    v_exp_f32 v206, v206
    v_sub_f32 v207, v207, v248
    v_exp_f32 v207, v207
    v_cvt_pk_bf16_f32 v181, v204, v205
    v_cvt_pk_bf16_f32 v184, v206, v207
    ds_read_b128 v[204:207], v246 offset:64
    v_sub_f32 v208, v208, v248
    v_exp_f32 v208, v208
    v_sub_f32 v209, v209, v248
    v_exp_f32 v209, v209
    v_sub_f32 v210, v210, v248
    v_exp_f32 v210, v210
    v_sub_f32 v211, v211, v248
    v_exp_f32 v211, v211
    v_cvt_pk_bf16_f32 v182, v208, v209
    v_cvt_pk_bf16_f32 v185, v210, v211
    s_waitcnt lgkmcnt(1)
    v_mfma_f32_16x16x32_bf16 v[212:215], v[12:15], v[180:183], 0
    ds_read_b128 v[208:211], v244 offset:128
    v_sub_f32 v196, v196, v248
    v_mfma_f32_16x16x32_bf16 v[216:219], v[42:45], v[180:183], 0
    v_exp_f32 v196, v196
    v_mfma_f32_16x16x32_bf16 v[220:223], v[72:75], v[180:183], 0
    v_sub_f32 v197, v197, v248
    v_sub_f32 v198, v198, v248
    v_mfma_f32_16x16x32_bf16 v[224:227], a[248:251], v[180:183], 0
    v_exp_f32 v197, v197
    v_mfma_f32_16x16x32_bf16 v[200:203], v[132:135], v[168:171], v[200:203]
    s_waitcnt lgkmcnt(1)
    v_exp_f32 v198, v198
    v_mfma_f32_16x16x32_bf16 v[200:203], v[134:137], v[170:173], v[200:203]
    v_sub_f32 v199, v199, v248
    v_cvt_pk_bf16_f32 v186, v196, v197
    v_mfma_f32_16x16x32_bf16 v[204:207], v[102:105], v[168:171], v[204:207]
    v_exp_f32 v199, v199
    v_mfma_f32_16x16x32_bf16 v[204:207], v[104:107], v[170:173], v[204:207]
    v_cvt_pk_bf16_f32 v189, v198, v199
    ds_read_b128 v[196:199], v245 offset:128
    s_waitcnt lgkmcnt(1)
    v_mfma_f32_16x16x32_bf16 v[208:211], v[138:141], v[168:171], v[208:211]
    v_sub_f32 v200, v200, v248
    v_sub_f32 v201, v201, v248
    v_mfma_f32_16x16x32_bf16 v[208:211], v[140:143], v[170:173], v[208:211]
    v_exp_f32 v200, v200
    v_exp_f32 v201, v201
    v_sub_f32 v202, v202, v248
    v_exp_f32 v202, v202
    v_sub_f32 v203, v203, v248
    v_exp_f32 v203, v203
    v_cvt_pk_bf16_f32 v187, v200, v201
    v_cvt_pk_bf16_f32 v190, v202, v203
    ds_read_b128 v[200:203], v246 offset:128
    v_mfma_f32_16x16x32_bf16 v[212:215], v[16:19], v[184:187], v[212:215]
    v_sub_f32 v204, v204, v248
    v_sub_f32 v205, v205, v248
    v_mfma_f32_16x16x32_bf16 v[216:219], v[46:49], v[184:187], v[216:219]
    v_exp_f32 v204, v204
    v_mfma_f32_16x16x32_bf16 v[220:223], v[76:79], v[184:187], v[220:223]
    s_waitcnt lgkmcnt(1)
    v_exp_f32 v205, v205
    v_mfma_f32_16x16x32_bf16 v[224:227], a[248:251], v[184:187], v[224:227]
    v_sub_f32 v206, v206, v248
    v_sub_f32 v207, v207, v248
    v_mfma_f32_16x16x32_bf16 v[196:199], v[144:147], v[168:171], v[196:199]
    v_exp_f32 v206, v206
    v_mfma_f32_16x16x32_bf16 v[196:199], v[146:149], v[170:173], v[196:199]
    v_exp_f32 v207, v207
    v_cvt_pk_bf16_f32 v188, v204, v205
    v_cvt_pk_bf16_f32 v191, v206, v207
    ds_read_b128 v[204:207], v244 offset:0
    v_sub_f32 v208, v208, v248
    v_mfma_f32_16x16x32_bf16 v[212:215], v[20:23], v[188:191], v[212:215]
    s_waitcnt lgkmcnt(1)
    v_exp_f32 v208, v208
    v_mfma_f32_16x16x32_bf16 v[216:219], v[50:53], v[188:191], v[216:219]
    v_sub_f32 v209, v209, v248
    v_sub_f32 v196, v196, v248
    v_mfma_f32_16x16x32_bf16 v[220:223], v[80:83], v[188:191], v[220:223]
    v_exp_f32 v209, v209
    v_mfma_f32_16x16x32_bf16 v[224:227], a[248:251], v[188:191], v[224:227]
    v_cvt_pk_bf16_f32 v192, v208, v209
    v_sub_f32 v197, v197, v248
    v_mfma_f32_16x16x32_bf16 v[200:203], v[108:111], v[168:171], v[200:203]
    v_cvt_pk_bf16_f32 v168, v228, v229
    v_cvt_pk_bf16_f32 v169, v230, v231
    v_mfma_f32_16x16x32_bf16 v[200:203], v[110:113], v[170:173], v[200:203]
    v_cvt_pk_bf16_f32 v170, v232, v233
    v_cvt_pk_bf16_f32 v171, v234, v235
    v_mfma_f32_16x16x32_bf16 v[228:231], a[0:3], a[216:219], 0
    v_cvt_pk_bf16_f32 v172, v236, v237
    v_cvt_pk_bf16_f32 v173, v238, v239
    v_mfma_f32_16x16x32_bf16 v[228:231], a[4:7], a[220:223], v[228:231]
    ds_read_b128 v[208:211], v245 offset:0
    s_waitcnt lgkmcnt(1)
    v_mfma_f32_16x16x32_bf16 v[204:207], v[96:99], v[174:177], v[204:207]
    v_exp_f32 v196, v196
    v_mfma_f32_16x16x32_bf16 v[204:207], v[98:101], v[176:179], v[204:207]
    v_exp_f32 v197, v197
    v_mfma_f32_16x16x32_bf16 v[228:231], a[8:11], a[224:227], v[228:231]
    v_cvt_pk_bf16_f32 v193, v196, v197
    v_sub_f32 v200, v200, v248
    v_mfma_f32_16x16x32_bf16 v[228:231], a[12:15], a[228:231], v[228:231]
    ds_read_b128 v[196:199], v246 offset:0
    v_sub_f32 v201, v201, v248
    v_mfma_f32_16x16x32_bf16 v[228:231], a[16:19], a[232:235], v[228:231]
    v_exp_f32 v200, v200
    v_mfma_f32_16x16x32_bf16 v[228:231], a[20:23], a[236:239], v[228:231]
    v_exp_f32 v201, v201
    v_mfma_f32_16x16x32_bf16 v[232:235], a[24:27], a[216:219], 0
    v_cvt_pk_bf16_f32 v194, v200, v201
    v_max_f32 v248, v204, v205
    v_mfma_f32_16x16x32_bf16 v[232:235], a[28:31], a[220:223], v[232:235]
    ds_read_b128 v[200:203], v244 offset:64
    v_max3_f32 v248, v248, v206, v207
    v_mfma_f32_16x16x32_bf16 v[212:215], v[24:27], v[192:195], v[212:215]
    s_waitcnt lgkmcnt(2)
    v_cvt_pk_bf16_f32 v90, v228, v229
    v_cvt_pk_bf16_f32 v91, v230, v231
    v_mfma_f32_16x16x32_bf16 v[216:219], v[54:57], v[192:195], v[216:219]
    ds_read_b128 v[204:207], v245 offset:64
    v_mfma_f32_16x16x32_bf16 v[220:223], v[84:87], v[192:195], v[220:223]
    v_mfma_f32_16x16x32_bf16 v[224:227], a[248:251], v[192:195], v[224:227]
    v_mfma_f32_16x16x32_bf16 v[208:211], v[132:135], v[174:177], v[208:211]
    s_waitcnt lgkmcnt(2)
    v_mfma_f32_16x16x32_bf16 v[208:211], v[134:137], v[176:179], v[208:211]
    v_mfma_f32_16x16x32_bf16 v[196:199], v[102:105], v[174:177], v[196:199]
    v_mfma_f32_16x16x32_bf16 v[196:199], v[104:107], v[176:179], v[196:199]
    v_mfma_f32_16x16x32_bf16 v[232:235], a[32:35], a[224:227], v[232:235]
    s_waitcnt lgkmcnt(1)
    v_mfma_f32_16x16x32_bf16 v[200:203], v[138:141], v[174:177], v[200:203]
    v_rcp_f32 v225, v224
    v_mfma_f32_16x16x32_bf16 v[200:203], v[140:143], v[176:179], v[200:203]
    s_waitcnt lgkmcnt(0)
    v_mul_f32 v212, v212, v225
    v_mul_f32 v213, v213, v225
    v_mfma_f32_16x16x32_bf16 v[204:207], v[144:147], v[174:177], v[204:207]
    v_mul_f32 v214, v214, v225
    v_mul_f32 v215, v215, v225
    v_mfma_f32_16x16x32_bf16 v[204:207], v[146:149], v[176:179], v[204:207]
    v_cvt_pk_bf16_f32 v212, v212, v213
    v_cvt_pk_bf16_f32 v213, v214, v215
    v_mfma_f32_16x16x32_bf16 v[232:235], a[36:39], a[228:231], v[232:235]
    ds_write_b64 v251, v[212:213] offset:12288
    v_mfma_f32_16x16x32_bf16 v[232:235], a[40:43], a[232:235], v[232:235]
    v_mul_f32 v216, v216, v225
    v_mul_f32 v217, v217, v225
    v_mfma_f32_16x16x32_bf16 v[232:235], a[44:47], a[236:239], v[232:235]
    v_mul_f32 v218, v218, v225
    v_mul_f32 v219, v219, v225
    v_mfma_f32_16x16x32_bf16 v[236:239], a[48:51], a[216:219], 0
    v_cvt_pk_bf16_f32 v216, v216, v217
    v_cvt_pk_bf16_f32 v217, v218, v219
    v_mfma_f32_16x16x32_bf16 v[236:239], a[52:55], a[220:223], v[236:239]
    ds_write_b64 v251, v[216:217] offset:12416
    v_mfma_f32_16x16x32_bf16 v[236:239], a[56:59], a[224:227], v[236:239]
    v_cvt_pk_bf16_f32 v92, v232, v233
    v_cvt_pk_bf16_f32 v93, v234, v235
    v_mfma_f32_16x16x32_bf16 v[236:239], a[60:63], a[228:231], v[236:239]
    v_mul_f32 v220, v220, v225
    v_mul_f32 v221, v221, v225
    v_mfma_f32_16x16x32_bf16 v[236:239], a[64:67], a[232:235], v[236:239]
    v_mul_f32 v222, v222, v225
    v_mul_f32 v223, v223, v225
    v_mfma_f32_16x16x32_bf16 v[236:239], a[68:71], a[236:239], v[236:239]
    v_cvt_pk_bf16_f32 v220, v220, v221
    v_cvt_pk_bf16_f32 v221, v222, v223
    v_mfma_f32_16x16x32_bf16 v[228:231], a[216:219], a[72:75], 0
    ds_write_b64 v251, v[220:221] offset:12544
    v_mfma_f32_16x16x32_bf16 v[228:231], a[220:223], a[76:79], v[228:231]
    v_max3_f32 v248, v248, v208, v209
    v_max3_f32 v248, v248, v210, v211
    v_mfma_f32_16x16x32_bf16 v[228:231], a[224:227], a[80:83], v[228:231]
    v_cvt_pk_bf16_f32 v94, v236, v237
    v_cvt_pk_bf16_f32 v95, v238, v239
    v_mfma_f32_16x16x32_bf16 v[228:231], a[228:231], a[84:87], v[228:231]
    ds_read_b128 v[208:211], v246 offset:64
    v_max3_f32 v248, v248, v196, v197
    v_mfma_f32_16x16x32_bf16 v[228:231], a[232:235], a[88:91], v[228:231]
    v_max3_f32 v248, v248, v198, v199
    v_max3_f32 v248, v248, v200, v201
    v_mfma_f32_16x16x32_bf16 v[228:231], a[236:239], a[92:95], v[228:231]
    ds_read_b128 v[196:199], v244 offset:0
    v_max3_f32 v248, v248, v202, v203
    v_mfma_f32_16x16x32_bf16 v[232:235], a[216:219], a[96:99], 0
    ds_read_b128 v[200:203], v245 offset:0
    v_max3_f32 v248, v248, v204, v205
    v_mfma_f32_16x16x32_bf16 v[232:235], a[220:223], a[100:103], v[232:235]
    v_max3_f32 v248, v248, v206, v207
    v_mfma_f32_16x16x32_bf16 v[232:235], a[224:227], a[104:107], v[232:235]
    v_cvt_pk_bf16_f32 v6, v228, v229
    v_cvt_pk_bf16_f32 v9, v230, v231
    v_mfma_f32_16x16x32_bf16 v[232:235], a[228:231], a[108:111], v[232:235]
    ds_read_b128 v[204:207], v246 offset:0
    v_mfma_f32_16x16x32_bf16 v[232:235], a[232:235], a[112:115], v[232:235]
    v_mfma_f32_16x16x32_bf16 v[232:235], a[236:239], a[116:119], v[232:235]
    v_mfma_f32_16x16x32_bf16 v[236:239], a[216:219], a[120:123], 0
    ds_read_b128 a[216:219], v240 offset:30848
    s_waitcnt lgkmcnt(4)
    v_mfma_f32_16x16x32_bf16 v[208:211], v[108:111], v[174:177], v[208:211]
    v_mfma_f32_16x16x32_bf16 v[208:211], v[110:113], v[176:179], v[208:211]
    s_waitcnt lgkmcnt(3)
    s_waitcnt lgkmcnt(2)
    v_mfma_f32_16x16x32_bf16 v[196:199], v[96:99], v[174:177], v[196:199]
    v_cvt_pk_bf16_f32 v36, v232, v233
    v_cvt_pk_bf16_f32 v39, v234, v235
    v_mfma_f32_16x16x32_bf16 v[196:199], v[98:101], v[176:179], v[196:199]
    v_mfma_f32_16x16x32_bf16 v[200:203], v[132:135], v[174:177], v[200:203]
    v_mfma_f32_16x16x32_bf16 v[200:203], v[134:137], v[176:179], v[200:203]
    s_waitcnt lgkmcnt(1)
    v_max3_f32 v248, v248, v208, v209
    v_max3_f32 v248, v248, v210, v211
    v_mfma_f32_16x16x32_bf16 v[204:207], v[102:105], v[174:177], v[204:207]
    ds_read_b128 v[208:211], v244 offset:64
    v_mov_b32 v225, v248
    v_mfma_f32_16x16x32_bf16 v[204:207], v[104:107], v[176:179], v[204:207]
    v_mfma_f32_16x16x32_bf16 v[236:239], a[220:223], a[124:127], v[236:239]
    ds_read_b128 a[220:223], v241 offset:30848
    v_permlane16_swap_b32 v248, v225
    v_mfma_f32_16x16x32_bf16 v[236:239], a[224:227], a[128:131], v[236:239]
    ds_read_b128 a[224:227], v240 offset:30976
    v_max_f32 v248, v248, v225
    v_mfma_f32_16x16x32_bf16 v[236:239], a[228:231], a[132:135], v[236:239]
    ds_read_b128 a[228:231], v241 offset:30976
    v_mov_b32 v225, v248
    v_mfma_f32_16x16x32_bf16 v[236:239], a[232:235], a[136:139], v[236:239]
    ds_read_b128 a[232:235], v242 offset:32256
    v_permlane32_swap_b32 v248, v225
    v_mfma_f32_16x16x32_bf16 v[236:239], a[236:239], a[140:143], v[236:239]
    ds_read_b128 a[236:239], v243 offset:32256
    v_max_f32 v248, v248, v225
    v_mfma_f32_16x16x32_bf16 v[228:231], a[0:3], a[240:243], 0
    s_waitcnt lgkmcnt(6)
    v_sub_f32 v196, v196, v248
    v_sub_f32 v197, v197, v248
    v_mfma_f32_16x16x32_bf16 v[228:231], a[4:7], a[244:247], v[228:231]
    v_exp_f32 v196, v196
    v_mfma_f32_16x16x32_bf16 v[228:231], a[8:11], a[216:219], v[228:231]
    s_waitcnt lgkmcnt(5)
    v_cvt_pk_bf16_f32 v66, v236, v237
    v_cvt_pk_bf16_f32 v69, v238, v239
    v_mfma_f32_16x16x32_bf16 v[208:211], v[138:141], v[174:177], v[208:211]
    v_exp_f32 v197, v197
    v_mfma_f32_16x16x32_bf16 v[208:211], v[140:143], v[176:179], v[208:211]
    s_waitcnt lgkmcnt(4)
    v_sub_f32 v198, v198, v248
    v_sub_f32 v199, v199, v248
    v_mfma_f32_16x16x32_bf16 v[228:231], a[12:15], a[220:223], v[228:231]
    s_waitcnt lgkmcnt(3)
    v_exp_f32 v198, v198
    v_mfma_f32_16x16x32_bf16 v[228:231], a[16:19], a[224:227], v[228:231]
    s_waitcnt lgkmcnt(2)
    v_exp_f32 v199, v199
    v_mfma_f32_16x16x32_bf16 v[228:231], a[20:23], a[228:231], v[228:231]
    v_cvt_pk_bf16_f32 v180, v196, v197
    v_cvt_pk_bf16_f32 v183, v198, v199
    v_mfma_f32_16x16x32_bf16 v[232:235], a[24:27], a[240:243], 0
    ds_read_b128 v[196:199], v245 offset:64
    v_sub_f32 v200, v200, v248
    v_mfma_f32_16x16x32_bf16 v[232:235], a[28:31], a[244:247], v[232:235]
    s_waitcnt lgkmcnt(1)
    v_exp_f32 v200, v200
    v_mfma_f32_16x16x32_bf16 v[232:235], a[32:35], a[216:219], v[232:235]
    v_cvt_pk_bf16_f32 v96, v228, v229
    v_cvt_pk_bf16_f32 v97, v230, v231
    v_mfma_f32_16x16x32_bf16 v[232:235], a[36:39], a[220:223], v[232:235]
    v_sub_f32 v201, v201, v248
    v_sub_f32 v202, v202, v248
    v_mfma_f32_16x16x32_bf16 v[232:235], a[40:43], a[224:227], v[232:235]
    v_exp_f32 v201, v201
    v_mfma_f32_16x16x32_bf16 v[232:235], a[44:47], a[228:231], v[232:235]
    v_exp_f32 v202, v202
    v_mfma_f32_16x16x32_bf16 v[236:239], a[48:51], a[240:243], 0
    v_sub_f32 v203, v203, v248
    v_cvt_pk_bf16_f32 v181, v200, v201
    v_mfma_f32_16x16x32_bf16 v[236:239], a[52:55], a[244:247], v[236:239]
    v_exp_f32 v203, v203
    v_mfma_f32_16x16x32_bf16 v[236:239], a[56:59], a[216:219], v[236:239]
    v_cvt_pk_bf16_f32 v184, v202, v203
    v_cvt_pk_bf16_f32 v98, v232, v233
    v_mfma_f32_16x16x32_bf16 v[236:239], a[60:63], a[220:223], v[236:239]
    ds_read_b128 v[200:203], v246 offset:64
    v_cvt_pk_bf16_f32 v99, v234, v235
    v_mfma_f32_16x16x32_bf16 v[236:239], a[64:67], a[224:227], v[236:239]
    s_waitcnt lgkmcnt(1)
    v_sub_f32 v204, v204, v248
    v_sub_f32 v205, v205, v248
    v_mfma_f32_16x16x32_bf16 v[196:199], v[144:147], v[174:177], v[196:199]
    v_exp_f32 v204, v204
    v_mfma_f32_16x16x32_bf16 v[196:199], v[146:149], v[176:179], v[196:199]
    v_exp_f32 v205, v205
    v_mfma_f32_16x16x32_bf16 v[236:239], a[68:71], a[228:231], v[236:239]
    v_sub_f32 v206, v206, v248
    v_sub_f32 v207, v207, v248
    v_mfma_f32_16x16x32_bf16 v[228:231], a[240:243], a[72:75], 0
    v_exp_f32 v206, v206
    v_mfma_f32_16x16x32_bf16 v[228:231], a[244:247], a[76:79], v[228:231]
    v_exp_f32 v207, v207
    v_mfma_f32_16x16x32_bf16 v[228:231], a[216:219], a[80:83], v[228:231]
    v_cvt_pk_bf16_f32 v182, v204, v205
    v_cvt_pk_bf16_f32 v100, v236, v237
    v_mfma_f32_16x16x32_bf16 v[228:231], a[220:223], a[84:87], v[228:231]
    v_cvt_pk_bf16_f32 v101, v238, v239
    v_cvt_pk_bf16_f32 v185, v206, v207
    v_mfma_f32_16x16x32_bf16 v[212:215], v[18:21], v[180:183], 0
    s_waitcnt lgkmcnt(0)
    v_sub_f32 v208, v208, v248
    v_sub_f32 v209, v209, v248
    v_mfma_f32_16x16x32_bf16 v[216:219], v[48:51], v[180:183], 0
    v_exp_f32 v208, v208
    v_mfma_f32_16x16x32_bf16 v[220:223], v[78:81], v[180:183], 0
    v_exp_f32 v209, v209
    v_mfma_f32_16x16x32_bf16 v[224:227], a[248:251], v[180:183], 0
    v_sub_f32 v210, v210, v248
    v_sub_f32 v211, v211, v248
    v_mfma_f32_16x16x32_bf16 v[200:203], v[108:111], v[174:177], v[200:203]
    v_exp_f32 v210, v210
    v_mfma_f32_16x16x32_bf16 v[200:203], v[110:113], v[176:179], v[200:203]
    v_exp_f32 v211, v211
    v_mfma_f32_16x16x32_bf16 v[228:231], a[224:227], a[88:91], v[228:231]
    v_cvt_pk_bf16_f32 v186, v208, v209
    v_cvt_pk_bf16_f32 v189, v210, v211
    v_mfma_f32_16x16x32_bf16 v[228:231], a[228:231], a[92:95], v[228:231]
    v_sub_f32 v196, v196, v248
    v_sub_f32 v197, v197, v248
    v_mfma_f32_16x16x32_bf16 v[232:235], a[240:243], a[96:99], 0
    v_exp_f32 v196, v196
    v_mfma_f32_16x16x32_bf16 v[232:235], a[244:247], a[100:103], v[232:235]
    v_exp_f32 v197, v197
    v_mfma_f32_16x16x32_bf16 v[232:235], a[216:219], a[104:107], v[232:235]
    v_sub_f32 v198, v198, v248
    v_cvt_pk_bf16_f32 v0, v228, v229
    v_mfma_f32_16x16x32_bf16 v[232:235], a[220:223], a[108:111], v[232:235]
    v_cvt_pk_bf16_f32 v3, v230, v231
    v_sub_f32 v199, v199, v248
    v_mfma_f32_16x16x32_bf16 v[232:235], a[224:227], a[112:115], v[232:235]
    v_exp_f32 v198, v198
    v_mfma_f32_16x16x32_bf16 v[232:235], a[228:231], a[116:119], v[232:235]
    v_exp_f32 v199, v199
    v_mfma_f32_16x16x32_bf16 v[236:239], a[240:243], a[120:123], 0
    ds_read_b128 a[240:243], v242 offset:32384
    v_cvt_pk_bf16_f32 v187, v196, v197
    v_mfma_f32_16x16x32_bf16 v[236:239], a[244:247], a[124:127], v[236:239]
    ds_read_b128 a[244:247], v243 offset:32384
    v_cvt_pk_bf16_f32 v190, v198, v199
    v_mfma_f32_16x16x32_bf16 v[212:215], v[22:25], v[184:187], v[212:215]
    v_cvt_pk_bf16_f32 v30, v232, v233
    v_cvt_pk_bf16_f32 v33, v234, v235
    v_mfma_f32_16x16x32_bf16 v[216:219], v[52:55], v[184:187], v[216:219]
    v_sub_f32 v200, v200, v248
    v_sub_f32 v201, v201, v248
    v_mfma_f32_16x16x32_bf16 v[220:223], v[82:85], v[184:187], v[220:223]
    v_exp_f32 v200, v200
    v_mfma_f32_16x16x32_bf16 v[224:227], a[248:251], v[184:187], v[224:227]
    v_exp_f32 v201, v201
    v_mfma_f32_16x16x32_bf16 v[236:239], a[216:219], a[128:131], v[236:239]
    ds_read_b128 a[216:219], v242 offset:32512
    v_sub_f32 v202, v202, v248
    v_mfma_f32_16x16x32_bf16 v[236:239], a[220:223], a[132:135], v[236:239]
    ds_read_b128 a[220:223], v243 offset:32512
    v_sub_f32 v203, v203, v248
    v_mfma_f32_16x16x32_bf16 v[236:239], a[224:227], a[136:139], v[236:239]
    ds_read_b128 a[224:227], v242 offset:33792
    v_cvt_pk_bf16_f32 v188, v200, v201
    v_mfma_f32_16x16x32_bf16 v[236:239], a[228:231], a[140:143], v[236:239]
    ds_read_b128 a[228:231], v243 offset:33792
    v_mov_b32 v204, 0x237c0
    v_mfma_f32_16x16x32_bf16 v[228:231], a[144:147], a[232:235], 0
    s_waitcnt lgkmcnt(5)
    v_exp_f32 v202, v202
    v_mfma_f32_16x16x32_bf16 v[228:231], a[148:151], a[236:239], v[228:231]
    s_waitcnt lgkmcnt(4)
    v_exp_f32 v203, v203
    v_mfma_f32_16x16x32_bf16 v[228:231], a[152:155], a[240:243], v[228:231]
    v_cvt_pk_bf16_f32 v60, v236, v237
    v_cvt_pk_bf16_f32 v63, v238, v239
    v_mfma_f32_16x16x32_bf16 v[228:231], a[156:159], a[244:247], v[228:231]
    v_cvt_pk_bf16_f32 v191, v202, v203
    v_add_u32 v205, 0xfffff900, v245
    v_mfma_f32_16x16x32_bf16 v[232:235], a[168:171], a[232:235], 0
    v_add_u32 v246, 0x700, v245
    s_waitcnt lgkmcnt(3)
    v_mfma_f32_16x16x32_bf16 v[212:215], v[26:29], v[188:191], v[212:215]
    v_mfma_f32_16x16x32_bf16 v[216:219], v[56:59], v[188:191], v[216:219]
    v_mfma_f32_16x16x32_bf16 v[220:223], v[86:89], v[188:191], v[220:223]
    s_waitcnt lgkmcnt(2)
    v_mfma_f32_16x16x32_bf16 v[224:227], a[248:251], v[188:191], v[224:227]
    s_waitcnt lgkmcnt(1)
    v_mov_b32 v191, 0
    v_mfma_f32_16x16x32_bf16 v[228:231], a[160:163], a[216:219], v[228:231]
    s_waitcnt lgkmcnt(0)
    v_mfma_f32_16x16x32_bf16 v[228:231], a[164:167], a[220:223], v[228:231]
    v_mfma_f32_16x16x32_bf16 v[232:235], a[172:175], a[236:239], v[232:235]
    v_mfma_f32_16x16x32_bf16 v[232:235], a[176:179], a[240:243], v[232:235]
    v_mfma_f32_16x16x32_bf16 v[232:235], a[180:183], a[244:247], v[232:235]
    v_rcp_f32 v225, v224
    v_mfma_f32_16x16x32_bf16 v[232:235], a[184:187], a[216:219], v[232:235]
    v_mov_b32 v226, 0x22e00
    v_cndmask_b32 v226, v226, v247, vcc
    v_mfma_f32_16x16x32_bf16 v[232:235], a[188:191], a[220:223], v[232:235]
    s_mov_b32 vcc_lo, 0x0
    v_mul_f32 v228, s38, v228
    v_mul_f32 v229, s38, v229
    v_mfma_f32_16x16x32_bf16 v[236:239], a[192:195], a[232:235], 0
    s_mov_b32 vcc_hi, 0xf0000
    v_mul_f32 v230, s38, v230
    v_mul_f32 v231, s38, v231
    v_mfma_f32_16x16x32_bf16 v[236:239], a[196:199], a[236:239], v[236:239]
    v_cvt_pk_bf16_f32 v174, v228, v229
    v_cvt_pk_bf16_f32 v175, v230, v231
    v_mfma_f32_16x16x32_bf16 v[236:239], a[200:203], a[240:243], v[236:239]
    v_mul_f32 v232, s3, v232
    v_mul_f32 v233, s3, v233
    v_mfma_f32_16x16x32_bf16 v[236:239], a[204:207], a[244:247], v[236:239]
    v_mul_f32 v234, s3, v234
    v_mul_f32 v235, s3, v235
    v_mfma_f32_16x16x32_bf16 v[236:239], a[208:211], a[216:219], v[236:239]
    v_cvt_pk_bf16_f32 v176, v232, v233
    v_cvt_pk_bf16_f32 v177, v234, v235
    v_mfma_f32_16x16x32_bf16 v[236:239], a[212:215], a[220:223], v[236:239]
    ds_read_b128 a[232:235], v242 offset:33920
    ds_read_b128 a[236:239], v243 offset:33920
    v_mfma_f32_16x16x32_bf16 v[228:231], a[144:147], a[224:227], 0
    ds_read_b128 a[240:243], v242 offset:34048
    ds_read_b128 a[244:247], v243 offset:34048
    v_mfma_f32_16x16x32_bf16 v[228:231], a[148:151], a[228:231], v[228:231]
    v_mul_f32 v212, v212, v225
    v_mul_f32 v213, v213, v225
    v_mfma_f32_16x16x32_bf16 v[232:235], a[168:171], a[224:227], 0
    v_mul_f32 v236, s38, v236
    v_mul_f32 v237, s38, v237
    v_mfma_f32_16x16x32_bf16 v[232:235], a[172:175], a[228:231], v[232:235]
    v_mul_f32 v238, s38, v238
    v_mul_f32 v239, s38, v239
    v_cvt_pk_bf16_f32 v178, v236, v237
    v_cvt_pk_bf16_f32 v179, v238, v239
    v_mfma_f32_16x16x32_bf16 v[236:239], a[192:195], a[224:227], 0
    v_mul_f32 v214, v214, v225
    v_mul_f32 v215, v215, v225
    v_mfma_f32_16x16x32_bf16 v[236:239], a[196:199], a[228:231], v[236:239]
    v_cvt_pk_bf16_f32 v212, v212, v213
    v_cvt_pk_bf16_f32 v213, v214, v215
    ds_write_b64 v226, v[212:213] offset:0
    s_waitcnt lgkmcnt(4)
    v_mfma_f32_16x16x32_bf16 v[228:231], a[152:155], a[232:235], v[228:231]
    s_waitcnt lgkmcnt(3)
    v_mul_f32 v216, v216, v225
    v_mul_f32 v217, v217, v225
    v_mfma_f32_16x16x32_bf16 v[228:231], a[156:159], a[236:239], v[228:231]
    s_waitcnt lgkmcnt(2)
    v_mul_f32 v218, v218, v225
    v_mul_f32 v219, v219, v225
    v_mfma_f32_16x16x32_bf16 v[228:231], a[160:163], a[240:243], v[228:231]
    s_waitcnt vmcnt(10) lgkmcnt(1)
    s_barrier
    v_mfma_f32_16x16x32_bf16 v[228:231], a[164:167], a[244:247], v[228:231]
    ds_read_b128 a[216:219], v240 offset:33792
    ds_read_b128 a[220:223], v241 offset:33792
    v_mfma_f32_16x16x32_bf16 v[232:235], a[176:179], a[232:235], v[232:235]
    ds_read_b128 a[224:227], v240 offset:33920
    ds_read_b128 a[228:231], v241 offset:33920
    v_mfma_f32_16x16x32_bf16 v[232:235], a[180:183], a[236:239], v[232:235]
    v_cvt_pk_bf16_f32 v216, v216, v217
    v_cvt_pk_bf16_f32 v217, v218, v219
    v_mfma_f32_16x16x32_bf16 v[232:235], a[184:187], a[240:243], v[232:235]
    v_mul_f32 v228, s38, v228
    v_mul_f32 v229, s38, v229
    v_mfma_f32_16x16x32_bf16 v[232:235], a[188:191], a[244:247], v[232:235]
    v_mul_f32 v230, s38, v230
    v_mul_f32 v231, s38, v231
    v_mfma_f32_16x16x32_bf16 v[236:239], a[200:203], a[232:235], v[236:239]
    ds_read_b128 a[232:235], v240 offset:34048
    v_cvt_pk_bf16_f32 v228, v228, v229
    v_mfma_f32_16x16x32_bf16 v[236:239], a[204:207], a[236:239], v[236:239]
    ds_read_b128 a[236:239], v241 offset:34048
    v_cvt_pk_bf16_f32 v229, v230, v231
    v_mfma_f32_16x16x32_bf16 v[236:239], a[208:211], a[240:243], v[236:239]
    ds_write_b64 v247, v[228:229] offset:18432
    v_mfma_f32_16x16x32_bf16 v[236:239], a[212:215], a[244:247], v[236:239]
    s_waitcnt lgkmcnt(6)
    v_mul_f32 v232, s3, v232
    v_mul_f32 v233, s3, v233
    v_mfma_f32_16x16x32_bf16 v[228:231], a[0:3], a[216:219], 0
    s_waitcnt lgkmcnt(5)
    v_mul_f32 v234, s3, v234
    v_mul_f32 v235, s3, v235
    v_mfma_f32_16x16x32_bf16 v[228:231], a[4:7], a[220:223], v[228:231]
    s_waitcnt lgkmcnt(4)
    v_cvt_pk_bf16_f32 v232, v232, v233
    v_cvt_pk_bf16_f32 v233, v234, v235
    v_mfma_f32_16x16x32_bf16 v[228:231], a[8:11], a[224:227], v[228:231]
    s_waitcnt lgkmcnt(3)
    v_mul_f32 v236, s38, v236
    v_mul_f32 v237, s38, v237
    v_mfma_f32_16x16x32_bf16 v[228:231], a[12:15], a[228:231], v[228:231]
    ds_write_b64 v247, v[232:233] offset:18560
    v_mfma_f32_16x16x32_bf16 v[232:235], a[24:27], a[216:219], 0
    s_waitcnt lgkmcnt(3)
    v_mul_f32 v238, s38, v238
    v_mul_f32 v239, s38, v239
    v_mfma_f32_16x16x32_bf16 v[228:231], a[16:19], a[232:235], v[228:231]
    ds_read_b128 a[240:243], v242 offset:61440
    v_cvt_pk_bf16_f32 v236, v236, v237
    v_mfma_f32_16x16x32_bf16 v[232:235], a[28:31], a[220:223], v[232:235]
    ds_read_b128 a[244:247], v243 offset:61440
    v_cvt_pk_bf16_f32 v237, v238, v239
    v_mfma_f32_16x16x32_bf16 v[232:235], a[32:35], a[224:227], v[232:235]
    ds_write_b64 v247, v[236:237] offset:18688
    v_mfma_f32_16x16x32_bf16 v[232:235], a[36:39], a[228:231], v[232:235]
    ds_write_b64 v226, v[216:217] offset:128
    v_mfma_f32_16x16x32_bf16 v[232:235], a[40:43], a[232:235], v[232:235]
    s_waitcnt lgkmcnt(6)
    v_mul_f32 v220, v220, v225
    v_mul_f32 v221, v221, v225
    v_mfma_f32_16x16x32_bf16 v[228:231], a[20:23], a[236:239], v[228:231]
    v_mul_f32 v222, v222, v225
    v_mul_f32 v223, v223, v225
    v_mfma_f32_16x16x32_bf16 v[232:235], a[44:47], a[236:239], v[232:235]
    v_cvt_pk_bf16_f32 v220, v220, v221
    v_cvt_pk_bf16_f32 v221, v222, v223
    v_mfma_f32_16x16x32_bf16 v[236:239], a[48:51], a[216:219], 0
    ds_write_b64 v226, v[220:221] offset:256
    v_mfma_f32_16x16x32_bf16 v[236:239], a[52:55], a[220:223], v[236:239]
    v_cvt_pk_bf16_f32 v138, v228, v229
    v_cvt_pk_bf16_f32 v139, v230, v231
    v_mfma_f32_16x16x32_bf16 v[236:239], a[56:59], a[224:227], v[236:239]
    s_waitcnt lgkmcnt(4)
    v_cvt_pk_bf16_f32 v140, v232, v233
    v_cvt_pk_bf16_f32 v141, v234, v235
    v_mfma_f32_16x16x32_bf16 v[236:239], a[60:63], a[228:231], v[236:239]
    s_waitcnt lgkmcnt(3)
    v_cndmask_b32 v244, v205, v244, vcc
    v_cndmask_b32 v245, v245, v204, vcc
    v_mfma_f32_16x16x32_bf16 v[236:239], a[64:67], a[232:235], v[236:239]
    ds_read_b128 v[208:211], v245 offset:192
    s_mov_b32 vcc_lo, 0xff00fff0
    v_mfma_f32_16x16x32_bf16 v[236:239], a[68:71], a[236:239], v[236:239]
    s_mov_b32 vcc_hi, 0xf000
    v_cndmask_b32 v244, v244, v204, vcc
    s_mov_b32 vcc_lo, 0xfff00ff
    v_mfma_f32_16x16x32_bf16 v[228:231], a[216:219], a[72:75], 0
    ds_read_b128 v[200:203], v244 offset:256
    s_mov_b32 vcc_hi, 0xffffffff
    v_mfma_f32_16x16x32_bf16 v[228:231], a[220:223], a[76:79], v[228:231]
    v_cndmask_b32 v246, v246, v204, vcc
    v_cvt_pk_bf16_f32 v142, v236, v237
    v_mfma_f32_16x16x32_bf16 v[228:231], a[224:227], a[80:83], v[228:231]
    ds_read_b128 v[204:207], v244 offset:192
    v_cvt_pk_bf16_f32 v143, v238, v239
    v_mfma_f32_16x16x32_bf16 v[228:231], a[228:231], a[84:87], v[228:231]
    ds_read_b128 v[196:199], v246 offset:192
    s_mov_b32 vcc_lo, 0xff00ff00
    v_mfma_f32_16x16x32_bf16 v[228:231], a[232:235], a[88:91], v[228:231]
    s_mov_b32 vcc_hi, 0xff00ff00
    v_mfma_f32_16x16x32_bf16 v[228:231], a[236:239], a[92:95], v[228:231]
    v_mfma_f32_16x16x32_bf16 v[232:235], a[216:219], a[96:99], 0
    v_mfma_f32_16x16x32_bf16 v[232:235], a[220:223], a[100:103], v[232:235]
    s_waitcnt lgkmcnt(3)
    v_mfma_f32_16x16x32_bf16 v[208:211], v[150:153], v[168:171], v[208:211]
    v_mfma_f32_16x16x32_bf16 v[208:211], v[152:155], v[170:173], v[208:211]
    s_waitcnt lgkmcnt(2)
    v_mfma_f32_16x16x32_bf16 v[200:203], v[120:123], v[168:171], v[200:203]
    v_mfma_f32_16x16x32_bf16 v[200:203], v[122:125], v[170:173], v[200:203]
    s_waitcnt lgkmcnt(1)
    v_cvt_pk_bf16_f32 v12, v228, v229
    v_cvt_pk_bf16_f32 v15, v230, v231
    v_mfma_f32_16x16x32_bf16 v[204:207], v[114:117], v[168:171], v[204:207]
    s_waitcnt lgkmcnt(0)
    v_mfma_f32_16x16x32_bf16 v[204:207], v[116:119], v[170:173], v[204:207]
    v_mfma_f32_16x16x32_bf16 v[196:199], v[96:99], v[168:171], v[196:199]
    v_mfma_f32_16x16x32_bf16 v[196:199], v[98:101], v[170:173], v[196:199]
    v_mfma_f32_16x16x32_bf16 v[232:235], a[224:227], a[104:107], v[232:235]
    v_mfma_f32_16x16x32_bf16 v[232:235], a[228:231], a[108:111], v[232:235]
    v_mfma_f32_16x16x32_bf16 v[232:235], a[232:235], a[112:115], v[232:235]
    v_mfma_f32_16x16x32_bf16 v[232:235], a[236:239], a[116:119], v[232:235]
    v_mfma_f32_16x16x32_bf16 v[236:239], a[216:219], a[120:123], 0
    ds_read_b128 a[216:219], v242 offset:61568
    v_max_f32 v248, v204, v205
    v_mfma_f32_16x16x32_bf16 v[236:239], a[220:223], a[124:127], v[236:239]
    ds_read_b128 a[220:223], v243 offset:61568
    v_max3_f32 v248, v248, v206, v207
    v_mfma_f32_16x16x32_bf16 v[236:239], a[224:227], a[128:131], v[236:239]
    ds_read_b128 a[224:227], v242 offset:61696
    v_cvt_pk_bf16_f32 v42, v232, v233
    v_mfma_f32_16x16x32_bf16 v[236:239], a[228:231], a[132:135], v[236:239]
    ds_read_b128 a[228:231], v243 offset:61696
    v_cvt_pk_bf16_f32 v45, v234, v235
    v_mfma_f32_16x16x32_bf16 v[236:239], a[232:235], a[136:139], v[236:239]
    ds_read_b128 a[232:235], v242 offset:64512
    ds_read_b128 v[204:207], v245 offset:256
    v_mfma_f32_16x16x32_bf16 v[236:239], a[236:239], a[140:143], v[236:239]
    ds_read_b128 a[236:239], v243 offset:64512
    v_max3_f32 v248, v248, v208, v209
    v_mfma_f32_16x16x32_bf16 v[228:231], a[144:147], a[240:243], 0
    v_max3_f32 v248, v248, v210, v211
    v_max3_f32 v248, v248, v196, v197
    v_mfma_f32_16x16x32_bf16 v[228:231], a[148:151], a[244:247], v[228:231]
    ds_read_b128 v[208:211], v246 offset:256
    v_max3_f32 v248, v248, v198, v199
    v_mfma_f32_16x16x32_bf16 v[232:235], a[168:171], a[240:243], 0
    s_waitcnt lgkmcnt(7)
    v_cvt_pk_bf16_f32 v72, v236, v237
    v_cvt_pk_bf16_f32 v75, v238, v239
    v_mfma_f32_16x16x32_bf16 v[228:231], a[152:155], a[216:219], v[228:231]
    ds_read_b128 v[196:199], v244 offset:320
    v_max3_f32 v248, v248, v200, v201
    v_mfma_f32_16x16x32_bf16 v[232:235], a[172:175], a[244:247], v[232:235]
    s_waitcnt lgkmcnt(7)
    v_max3_f32 v248, v248, v202, v203
    v_mfma_f32_16x16x32_bf16 v[228:231], a[156:159], a[220:223], v[228:231]
    ds_read_b128 v[200:203], v245 offset:320
    s_waitcnt vmcnt(0) lgkmcnt(6)
    v_mfma_f32_16x16x32_bf16 v[228:231], a[160:163], a[224:227], v[228:231]
    s_barrier
    v_mfma_f32_16x16x32_bf16 v[228:231], a[164:167], a[228:231], v[228:231]
    s_waitcnt lgkmcnt(4)
    v_mfma_f32_16x16x32_bf16 v[204:207], v[156:159], v[168:171], v[204:207]
    s_waitcnt lgkmcnt(2)
    v_mfma_f32_16x16x32_bf16 v[204:207], v[158:161], v[170:173], v[204:207]
    v_mfma_f32_16x16x32_bf16 v[208:211], v[90:93], v[168:171], v[208:211]
    s_waitcnt lgkmcnt(1)
    v_mfma_f32_16x16x32_bf16 v[208:211], v[92:95], v[170:173], v[208:211]
    v_mfma_f32_16x16x32_bf16 v[196:199], v[126:129], v[168:171], v[196:199]
    s_waitcnt lgkmcnt(0)
    v_mul_f32 v228, s38, v228
    v_mul_f32 v229, s38, v229
    v_mfma_f32_16x16x32_bf16 v[196:199], v[128:131], v[170:173], v[196:199]
    v_mul_f32 v230, s38, v230
    v_mul_f32 v231, s38, v231
    v_mfma_f32_16x16x32_bf16 v[200:203], v[162:165], v[168:171], v[200:203]
    v_cvt_pk_bf16_f32 v228, v228, v229
    v_cvt_pk_bf16_f32 v229, v230, v231
    v_mfma_f32_16x16x32_bf16 v[200:203], v[164:167], v[170:173], v[200:203]
    ds_write_b64 v247, v[228:229] offset:24576
    v_mfma_f32_16x16x32_bf16 v[232:235], a[176:179], a[216:219], v[232:235]
    v_max3_f32 v248, v248, v204, v205
    v_max3_f32 v248, v248, v206, v207
    v_mfma_f32_16x16x32_bf16 v[232:235], a[180:183], a[220:223], v[232:235]
    ds_read_b128 v[204:207], v246 offset:320
    v_max3_f32 v248, v248, v208, v209
    v_mfma_f32_16x16x32_bf16 v[232:235], a[184:187], a[224:227], v[232:235]
    v_max3_f32 v248, v248, v210, v211
    v_max3_f32 v248, v248, v196, v197
    v_mfma_f32_16x16x32_bf16 v[232:235], a[188:191], a[228:231], v[232:235]
    ds_read_b128 v[208:211], v244 offset:192
    ds_read_b128 v[196:199], v245 offset:192
    v_mfma_f32_16x16x32_bf16 v[236:239], a[192:195], a[240:243], 0
    ds_read_b128 a[240:243], v242 offset:64640
    v_max3_f32 v248, v248, v200, v201
    v_mfma_f32_16x16x32_bf16 v[236:239], a[196:199], a[244:247], v[236:239]
    ds_read_b128 a[244:247], v243 offset:64640
    ds_read_b128 v[200:203], v246 offset:192
    v_mfma_f32_16x16x32_bf16 v[236:239], a[200:203], a[216:219], v[236:239]
    v_mul_f32 v232, s3, v232
    v_mul_f32 v233, s3, v233
    v_mfma_f32_16x16x32_bf16 v[236:239], a[204:207], a[220:223], v[236:239]
    v_mul_f32 v234, s3, v234
    v_mul_f32 v235, s3, v235
    v_mfma_f32_16x16x32_bf16 v[236:239], a[208:211], a[224:227], v[236:239]
    ds_read_b128 a[216:219], v242 offset:64768
    v_cvt_pk_bf16_f32 v232, v232, v233
    v_mfma_f32_16x16x32_bf16 v[236:239], a[212:215], a[228:231], v[236:239]
    ds_read_b128 a[220:223], v243 offset:64768
    v_cvt_pk_bf16_f32 v233, v234, v235
    v_mfma_f32_16x16x32_bf16 v[228:231], a[144:147], a[232:235], 0
    ds_write_b64 v247, v[232:233] offset:24704
    v_mfma_f32_16x16x32_bf16 v[228:231], a[148:151], a[236:239], v[228:231]
    ds_read_b128 a[224:227], v240 offset:35328
    ds_read_b128 a[228:231], v241 offset:35328
    v_mfma_f32_16x16x32_bf16 v[232:235], a[168:171], a[232:235], 0
    s_waitcnt lgkmcnt(8)
    v_mul_f32 v236, s38, v236
    v_mul_f32 v237, s38, v237
    v_mfma_f32_16x16x32_bf16 v[204:207], v[138:141], v[168:171], v[204:207]
    s_waitcnt lgkmcnt(7)
    v_mul_f32 v238, s38, v238
    v_mul_f32 v239, s38, v239
    v_mfma_f32_16x16x32_bf16 v[204:207], v[140:143], v[170:173], v[204:207]
    v_cvt_pk_bf16_f32 v236, v236, v237
    v_cvt_pk_bf16_f32 v237, v238, v239
    v_mfma_f32_16x16x32_bf16 v[208:211], v[114:117], v[168:171], v[208:211]
    ds_write_b64 v247, v[236:237] offset:24832
    v_mfma_f32_16x16x32_bf16 v[208:211], v[116:119], v[170:173], v[208:211]
    s_waitcnt lgkmcnt(6)
    v_add_u32 v242, 0xf000, v242
    v_add_u32 v243, 0xf000, v243
    v_mfma_f32_16x16x32_bf16 v[196:199], v[150:153], v[168:171], v[196:199]
    s_waitcnt lgkmcnt(5)
    v_max3_f32 v248, v248, v204, v205
    v_mov_b32 v225, v248
    v_mfma_f32_16x16x32_bf16 v[196:199], v[152:155], v[170:173], v[196:199]
    ds_read_b128 v[204:207], v244 offset:256
    v_permlane16_swap_b32 v248, v225
    v_mfma_f32_16x16x32_bf16 v[200:203], v[96:99], v[168:171], v[200:203]
    s_waitcnt lgkmcnt(5)
    v_max_f32 v248, v248, v225
    v_mov_b32 v225, v248
    v_mfma_f32_16x16x32_bf16 v[200:203], v[98:101], v[170:173], v[200:203]
    v_mfma_f32_16x16x32_bf16 v[228:231], a[152:155], a[240:243], v[228:231]
    s_waitcnt lgkmcnt(3)
    v_permlane32_swap_b32 v248, v225
    v_max_f32 v248, v248, v225
    v_mfma_f32_16x16x32_bf16 v[228:231], a[156:159], a[244:247], v[228:231]
    s_waitcnt lgkmcnt(2)
    v_sub_f32 v208, v208, v248
    v_sub_f32 v209, v209, v248
    v_mfma_f32_16x16x32_bf16 v[228:231], a[160:163], a[216:219], v[228:231]
    v_exp_f32 v208, v208
    v_mfma_f32_16x16x32_bf16 v[228:231], a[164:167], a[220:223], v[228:231]
    v_exp_f32 v209, v209
    v_mfma_f32_16x16x32_bf16 v[232:235], a[172:175], a[236:239], v[232:235]
    v_sub_f32 v210, v210, v248
    v_sub_f32 v211, v211, v248
    v_mfma_f32_16x16x32_bf16 v[232:235], a[176:179], a[240:243], v[232:235]
    v_exp_f32 v210, v210
    v_mfma_f32_16x16x32_bf16 v[232:235], a[180:183], a[244:247], v[232:235]
    s_waitcnt lgkmcnt(0)
    v_mul_f32 v228, s38, v228
    v_mul_f32 v229, s38, v229
    v_mfma_f32_16x16x32_bf16 v[204:207], v[120:123], v[168:171], v[204:207]
    v_mul_f32 v230, s38, v230
    v_mul_f32 v231, s38, v231
    v_mfma_f32_16x16x32_bf16 v[204:207], v[122:125], v[170:173], v[204:207]
    v_cvt_pk_bf16_f32 v228, v228, v229
    v_cvt_pk_bf16_f32 v229, v230, v231
    v_mfma_f32_16x16x32_bf16 v[232:235], a[184:187], a[216:219], v[232:235]
    ds_write_b64 v247, v[228:229] offset:36864
    v_mfma_f32_16x16x32_bf16 v[232:235], a[188:191], a[220:223], v[232:235]
    v_exp_f32 v211, v211
    v_mfma_f32_16x16x32_bf16 v[236:239], a[192:195], a[232:235], 0
    ds_read_b128 a[232:235], v240 offset:35456
    v_cvt_pk_bf16_f32 v193, v208, v209
    v_mfma_f32_16x16x32_bf16 v[236:239], a[196:199], a[236:239], v[236:239]
    ds_read_b128 a[236:239], v241 offset:35456
    v_cvt_pk_bf16_f32 v180, v210, v211
    v_mfma_f32_16x16x32_bf16 v[236:239], a[200:203], a[240:243], v[236:239]
    v_mul_f32 v232, s3, v232
    v_mul_f32 v233, s3, v233
    v_mfma_f32_16x16x32_bf16 v[236:239], a[204:207], a[244:247], v[236:239]
    v_mul_f32 v234, s3, v234
    v_mul_f32 v235, s3, v235
    v_mfma_f32_16x16x32_bf16 v[236:239], a[208:211], a[216:219], v[236:239]
    ds_read_b128 a[240:243], v240 offset:35584
    v_cvt_pk_bf16_f32 v232, v232, v233
    v_mfma_f32_16x16x32_bf16 v[236:239], a[212:215], a[220:223], v[236:239]
    ds_read_b128 a[244:247], v241 offset:35584
    v_cvt_pk_bf16_f32 v233, v234, v235
    v_mfma_f32_16x16x32_bf16 v[228:231], a[0:3], a[224:227], 0
    ds_write_b64 v247, v[232:233] offset:36992
    v_mfma_f32_16x16x32_bf16 v[228:231], a[4:7], a[228:231], v[228:231]
    ds_read_b128 a[216:219], v242 offset:4608
    ds_read_b128 a[220:223], v243 offset:4608
    v_mfma_f32_16x16x32_bf16 v[232:235], a[24:27], a[224:227], 0
    s_waitcnt lgkmcnt(6)
    v_mul_f32 v236, s38, v236
    v_mul_f32 v237, s38, v237
    v_mfma_f32_16x16x32_bf16 v[228:231], a[8:11], a[232:235], v[228:231]
    s_waitcnt lgkmcnt(5)
    v_mul_f32 v238, s38, v238
    v_mul_f32 v239, s38, v239
    v_mfma_f32_16x16x32_bf16 v[228:231], a[12:15], a[236:239], v[228:231]
    ds_read_b128 v[208:211], v245 offset:256
    v_cvt_pk_bf16_f32 v236, v236, v237
    v_mfma_f32_16x16x32_bf16 v[232:235], a[28:31], a[228:231], v[232:235]
    v_cvt_pk_bf16_f32 v237, v238, v239
    v_sub_f32 v196, v196, v248
    v_mfma_f32_16x16x32_bf16 v[232:235], a[32:35], a[232:235], v[232:235]
    ds_write_b64 v247, v[236:237] offset:37120
    v_mfma_f32_16x16x32_bf16 v[232:235], a[36:39], a[236:239], v[232:235]
    s_waitcnt lgkmcnt(6)
    v_exp_f32 v196, v196
    v_mfma_f32_16x16x32_bf16 v[228:231], a[16:19], a[240:243], v[228:231]
    s_waitcnt lgkmcnt(5)
    v_sub_f32 v197, v197, v248
    v_sub_f32 v198, v198, v248
    v_mfma_f32_16x16x32_bf16 v[228:231], a[20:23], a[244:247], v[228:231]
    v_exp_f32 v197, v197
    v_mfma_f32_16x16x32_bf16 v[232:235], a[40:43], a[240:243], v[232:235]
    v_exp_f32 v198, v198
    v_mfma_f32_16x16x32_bf16 v[232:235], a[44:47], a[244:247], v[232:235]
    s_waitcnt lgkmcnt(3)
    v_sub_f32 v199, v199, v248
    v_cvt_pk_bf16_f32 v194, v196, v197
    v_mfma_f32_16x16x32_bf16 v[236:239], a[48:51], a[224:227], 0
    s_waitcnt lgkmcnt(1)
    v_cvt_pk_bf16_f32 v114, v228, v229
    v_cvt_pk_bf16_f32 v115, v230, v231
    v_mfma_f32_16x16x32_bf16 v[208:211], v[156:159], v[168:171], v[208:211]
    v_cvt_pk_bf16_f32 v116, v232, v233
    v_cvt_pk_bf16_f32 v117, v234, v235
    v_mfma_f32_16x16x32_bf16 v[208:211], v[158:161], v[170:173], v[208:211]
    v_exp_f32 v199, v199
    v_mfma_f32_16x16x32_bf16 v[236:239], a[52:55], a[228:231], v[236:239]
    v_cvt_pk_bf16_f32 v181, v198, v199
    v_sub_f32 v200, v200, v248
    v_mfma_f32_16x16x32_bf16 v[236:239], a[56:59], a[232:235], v[236:239]
    ds_read_b128 v[196:199], v246 offset:256
    v_sub_f32 v201, v201, v248
    v_mfma_f32_16x16x32_bf16 v[236:239], a[60:63], a[236:239], v[236:239]
    v_exp_f32 v200, v200
    v_mfma_f32_16x16x32_bf16 v[236:239], a[64:67], a[240:243], v[236:239]
    v_exp_f32 v201, v201
    v_mfma_f32_16x16x32_bf16 v[236:239], a[68:71], a[244:247], v[236:239]
    v_sub_f32 v202, v202, v248
    v_sub_f32 v203, v203, v248
    v_mfma_f32_16x16x32_bf16 v[228:231], a[224:227], a[72:75], 0
    v_exp_f32 v202, v202
    v_mfma_f32_16x16x32_bf16 v[228:231], a[228:231], a[76:79], v[228:231]
    v_exp_f32 v203, v203
    v_mfma_f32_16x16x32_bf16 v[228:231], a[232:235], a[80:83], v[228:231]
    v_cvt_pk_bf16_f32 v192, v200, v201
    v_cvt_pk_bf16_f32 v118, v236, v237
    v_mfma_f32_16x16x32_bf16 v[228:231], a[236:239], a[84:87], v[228:231]
    v_cvt_pk_bf16_f32 v119, v238, v239
    v_cvt_pk_bf16_f32 v195, v202, v203
    v_mfma_f32_16x16x32_bf16 v[228:231], a[240:243], a[88:91], v[228:231]
    ds_read_b128 v[200:203], v244 offset:320
    v_sub_f32 v204, v204, v248
    v_mfma_f32_16x16x32_bf16 v[212:215], v[0:3], v[192:195], 0
    s_waitcnt lgkmcnt(1)
    v_exp_f32 v204, v204
    v_mfma_f32_16x16x32_bf16 v[216:219], v[30:33], v[192:195], 0
    v_sub_f32 v205, v205, v248
    v_sub_f32 v206, v206, v248
    v_mfma_f32_16x16x32_bf16 v[220:223], v[60:63], v[192:195], 0
    v_exp_f32 v205, v205
    v_mfma_f32_16x16x32_bf16 v[224:227], a[248:251], v[192:195], 0
    v_exp_f32 v206, v206
    v_mfma_f32_16x16x32_bf16 v[196:199], v[90:93], v[168:171], v[196:199]
    v_sub_f32 v207, v207, v248
    v_cvt_pk_bf16_f32 v183, v204, v205
    v_mfma_f32_16x16x32_bf16 v[196:199], v[92:95], v[170:173], v[196:199]
    v_exp_f32 v207, v207
    v_mfma_f32_16x16x32_bf16 v[228:231], a[244:247], a[92:95], v[228:231]
    v_cvt_pk_bf16_f32 v186, v206, v207
    v_sub_f32 v208, v208, v248
    v_mfma_f32_16x16x32_bf16 v[232:235], a[224:227], a[96:99], 0
    ds_read_b128 v[204:207], v245 offset:320
    v_sub_f32 v209, v209, v248
    v_mfma_f32_16x16x32_bf16 v[232:235], a[228:231], a[100:103], v[232:235]
    s_waitcnt lgkmcnt(1)
    v_exp_f32 v208, v208
    v_mfma_f32_16x16x32_bf16 v[200:203], v[126:129], v[168:171], v[200:203]
    v_cvt_pk_bf16_f32 v18, v228, v229
    v_cvt_pk_bf16_f32 v21, v230, v231
    v_mfma_f32_16x16x32_bf16 v[200:203], v[128:131], v[170:173], v[200:203]
    v_exp_f32 v209, v209
    v_mfma_f32_16x16x32_bf16 v[232:235], a[232:235], a[104:107], v[232:235]
    v_sub_f32 v210, v210, v248
    v_sub_f32 v211, v211, v248
    v_mfma_f32_16x16x32_bf16 v[232:235], a[236:239], a[108:111], v[232:235]
    v_exp_f32 v210, v210
    v_mfma_f32_16x16x32_bf16 v[232:235], a[240:243], a[112:115], v[232:235]
    v_exp_f32 v211, v211
    v_mfma_f32_16x16x32_bf16 v[232:235], a[244:247], a[116:119], v[232:235]
    v_cvt_pk_bf16_f32 v184, v208, v209
    v_cvt_pk_bf16_f32 v187, v210, v211
    v_mfma_f32_16x16x32_bf16 v[236:239], a[224:227], a[120:123], 0
    ds_read_b128 a[224:227], v242 offset:4736
    ds_read_b128 v[208:211], v246 offset:320
    v_mfma_f32_16x16x32_bf16 v[236:239], a[228:231], a[124:127], v[236:239]
    ds_read_b128 a[228:231], v243 offset:4736
    v_sub_f32 v196, v196, v248
    v_mfma_f32_16x16x32_bf16 v[236:239], a[232:235], a[128:131], v[236:239]
    s_waitcnt lgkmcnt(3)
    v_cvt_pk_bf16_f32 v48, v232, v233
    v_cvt_pk_bf16_f32 v51, v234, v235
    v_mfma_f32_16x16x32_bf16 v[204:207], v[162:165], v[168:171], v[204:207]
    ds_read_b128 a[232:235], v242 offset:4864
    v_sub_f32 v197, v197, v248
    v_mfma_f32_16x16x32_bf16 v[204:207], v[164:167], v[170:173], v[204:207]
    v_exp_f32 v196, v196
    v_mfma_f32_16x16x32_bf16 v[236:239], a[236:239], a[132:135], v[236:239]
    ds_read_b128 a[236:239], v243 offset:4864
    v_sub_f32 v198, v198, v248
    v_mfma_f32_16x16x32_bf16 v[236:239], a[240:243], a[136:139], v[236:239]
    ds_read_b128 a[240:243], v242 offset:1536
    v_sub_f32 v199, v199, v248
    v_mfma_f32_16x16x32_bf16 v[236:239], a[244:247], a[140:143], v[236:239]
    ds_read_b128 a[244:247], v243 offset:1536
    v_sub_f32 v200, v200, v248
    v_mfma_f32_16x16x32_bf16 v[228:231], a[144:147], a[216:219], 0
    v_exp_f32 v197, v197
    v_mfma_f32_16x16x32_bf16 v[228:231], a[148:151], a[220:223], v[228:231]
    s_waitcnt lgkmcnt(5)
    v_exp_f32 v198, v198
    v_mfma_f32_16x16x32_bf16 v[208:211], v[138:141], v[168:171], v[208:211]
    v_cvt_pk_bf16_f32 v78, v236, v237
    v_cvt_pk_bf16_f32 v81, v238, v239
    v_mfma_f32_16x16x32_bf16 v[208:211], v[140:143], v[170:173], v[208:211]
    ds_read_b64 v[168:169], v247 offset:18432
    ds_read_b64 v[170:171], v247 offset:18560
    v_mfma_f32_16x16x32_bf16 v[228:231], a[152:155], a[224:227], v[228:231]
    ds_read_b64 v[172:173], v247 offset:18688
    v_cvt_pk_bf16_f32 v182, v196, v197
    v_mfma_f32_16x16x32_bf16 v[232:235], a[168:171], a[216:219], 0
    s_waitcnt lgkmcnt(7)
    v_exp_f32 v199, v199
    v_mfma_f32_16x16x32_bf16 v[212:215], v[4:7], v[180:183], v[212:215]
    s_waitcnt lgkmcnt(6)
    v_cvt_pk_bf16_f32 v185, v198, v199
    v_sub_f32 v201, v201, v248
    v_mfma_f32_16x16x32_bf16 v[216:219], v[34:37], v[180:183], v[216:219]
    ds_read_b128 v[196:199], v244 offset:0
    v_sub_f32 v204, v204, v248
    v_mfma_f32_16x16x32_bf16 v[220:223], v[64:67], v[180:183], v[220:223]
    s_waitcnt lgkmcnt(5)
    v_exp_f32 v200, v200
    v_mfma_f32_16x16x32_bf16 v[224:227], a[248:251], v[180:183], v[224:227]
    s_waitcnt lgkmcnt(4)
    v_exp_f32 v201, v201
    v_mfma_f32_16x16x32_bf16 v[212:215], v[8:11], v[184:187], v[212:215]
    v_cvt_pk_bf16_f32 v189, v200, v201
    v_sub_f32 v205, v205, v248
    v_mfma_f32_16x16x32_bf16 v[216:219], v[38:41], v[184:187], v[216:219]
    ds_read_b128 v[200:203], v245 offset:0
    v_sub_f32 v208, v208, v248
    v_mfma_f32_16x16x32_bf16 v[220:223], v[68:71], v[184:187], v[220:223]
    v_exp_f32 v204, v204
    v_mfma_f32_16x16x32_bf16 v[224:227], a[248:251], v[184:187], v[224:227]
    s_waitcnt lgkmcnt(3)
    v_exp_f32 v205, v205
    v_mfma_f32_16x16x32_bf16 v[228:231], a[156:159], a[228:231], v[228:231]
    s_waitcnt lgkmcnt(2)
    v_cvt_pk_bf16_f32 v190, v204, v205
    v_sub_f32 v209, v209, v248
    v_mfma_f32_16x16x32_bf16 v[228:231], a[160:163], a[232:235], v[228:231]
    ds_read_b128 v[204:207], v246 offset:0
    s_waitcnt lgkmcnt(2)
    v_mfma_f32_16x16x32_bf16 v[196:199], v[120:123], v[174:177], v[196:199]
    v_exp_f32 v208, v208
    v_mfma_f32_16x16x32_bf16 v[196:199], v[122:125], v[176:179], v[196:199]
    v_exp_f32 v209, v209
    v_mfma_f32_16x16x32_bf16 v[228:231], a[164:167], a[236:239], v[228:231]
    v_cvt_pk_bf16_f32 v188, v208, v209
    v_mfma_f32_16x16x32_bf16 v[232:235], a[172:175], a[220:223], v[232:235]
    ds_read_b128 v[208:211], v244 offset:64
    s_waitcnt lgkmcnt(2)
    v_mfma_f32_16x16x32_bf16 v[212:215], v[12:15], v[188:191], v[212:215]
    v_mfma_f32_16x16x32_bf16 v[216:219], v[42:45], v[188:191], v[216:219]
    v_max_f32 v248, v196, v197
    v_max3_f32 v248, v248, v198, v199
    v_mfma_f32_16x16x32_bf16 v[220:223], v[72:75], v[188:191], v[220:223]
    v_mul_f32 v228, s38, v228
    v_mul_f32 v229, s38, v229
    v_mfma_f32_16x16x32_bf16 v[224:227], a[248:251], v[188:191], v[224:227]
    v_mul_f32 v230, s38, v230
    v_mul_f32 v231, s38, v231
    v_mfma_f32_16x16x32_bf16 v[200:203], v[156:159], v[174:177], v[200:203]
    ds_read_b128 v[196:199], v245 offset:64
    v_cvt_pk_bf16_f32 v228, v228, v229
    v_mfma_f32_16x16x32_bf16 v[200:203], v[158:161], v[176:179], v[200:203]
    s_waitcnt lgkmcnt(2)
    v_cvt_pk_bf16_f32 v229, v230, v231
    v_mfma_f32_16x16x32_bf16 v[204:207], v[90:93], v[174:177], v[204:207]
    ds_write_b64 v247, v[228:229] offset:43008
    v_mfma_f32_16x16x32_bf16 v[204:207], v[92:95], v[176:179], v[204:207]
    s_waitcnt lgkmcnt(2)
    v_rcp_f32 v225, v224
    v_mfma_f32_16x16x32_bf16 v[208:211], v[126:129], v[174:177], v[208:211]
    v_mul_f32 v212, v212, v225
    v_mul_f32 v213, v213, v225
    v_mfma_f32_16x16x32_bf16 v[208:211], v[128:131], v[176:179], v[208:211]
    v_mul_f32 v214, v214, v225
    v_mul_f32 v215, v215, v225
    v_mfma_f32_16x16x32_bf16 v[232:235], a[176:179], a[224:227], v[232:235]
    v_cvt_pk_bf16_f32 v212, v212, v213
    v_cvt_pk_bf16_f32 v213, v214, v215
    v_mfma_f32_16x16x32_bf16 v[232:235], a[180:183], a[228:231], v[232:235]
    ds_write_b64 v247, v[212:213] offset:6144
    v_mfma_f32_16x16x32_bf16 v[232:235], a[184:187], a[232:235], v[232:235]
    s_waitcnt lgkmcnt(2)
    v_mul_f32 v216, v216, v225
    v_mul_f32 v217, v217, v225
    v_mfma_f32_16x16x32_bf16 v[196:199], v[162:165], v[174:177], v[196:199]
    v_mul_f32 v218, v218, v225
    v_mul_f32 v219, v219, v225
    v_mfma_f32_16x16x32_bf16 v[196:199], v[164:167], v[176:179], v[196:199]
    v_cvt_pk_bf16_f32 v216, v216, v217
    v_cvt_pk_bf16_f32 v217, v218, v219
    v_mfma_f32_16x16x32_bf16 v[232:235], a[188:191], a[236:239], v[232:235]
    ds_write_b64 v247, v[216:217] offset:6272
    v_mfma_f32_16x16x32_bf16 v[236:239], a[192:195], a[216:219], 0
    ds_read_b128 a[216:219], v242 offset:1664
    v_mul_f32 v220, v220, v225
    v_mfma_f32_16x16x32_bf16 v[236:239], a[196:199], a[220:223], v[236:239]
    ds_read_b128 a[220:223], v243 offset:1664
    v_mul_f32 v221, v221, v225
    v_mfma_f32_16x16x32_bf16 v[236:239], a[200:203], a[224:227], v[236:239]
    v_mul_f32 v232, s3, v232
    v_mul_f32 v233, s3, v233
    v_mfma_f32_16x16x32_bf16 v[236:239], a[204:207], a[228:231], v[236:239]
    v_mul_f32 v234, s3, v234
    v_mul_f32 v235, s3, v235
    v_mfma_f32_16x16x32_bf16 v[236:239], a[208:211], a[232:235], v[236:239]
    ds_read_b128 a[224:227], v242 offset:1792
    v_cvt_pk_bf16_f32 v232, v232, v233
    v_mfma_f32_16x16x32_bf16 v[236:239], a[212:215], a[236:239], v[236:239]
    ds_read_b128 a[228:231], v243 offset:1792
    v_cvt_pk_bf16_f32 v233, v234, v235
    v_mfma_f32_16x16x32_bf16 v[228:231], a[144:147], a[240:243], 0
    ds_write_b64 v247, v[232:233] offset:43136
    v_mfma_f32_16x16x32_bf16 v[228:231], a[148:151], a[244:247], v[228:231]
    v_add_u32 v242, 0x7800, v242
    v_add_u32 v243, 0x4200, v243
    v_mfma_f32_16x16x32_bf16 v[232:235], a[168:171], a[240:243], 0
    s_waitcnt lgkmcnt(4)
    v_mul_f32 v236, s38, v236
    v_mul_f32 v237, s38, v237
    v_mfma_f32_16x16x32_bf16 v[228:231], a[152:155], a[216:219], v[228:231]
    s_waitcnt lgkmcnt(3)
    v_mul_f32 v238, s38, v238
    v_mul_f32 v239, s38, v239
    v_mfma_f32_16x16x32_bf16 v[228:231], a[156:159], a[220:223], v[228:231]
    v_cvt_pk_bf16_f32 v236, v236, v237
    v_cvt_pk_bf16_f32 v237, v238, v239
    v_mfma_f32_16x16x32_bf16 v[232:235], a[172:175], a[244:247], v[232:235]
    ds_write_b64 v247, v[236:237] offset:43264
    v_mfma_f32_16x16x32_bf16 v[232:235], a[176:179], a[216:219], v[232:235]
    s_waitcnt lgkmcnt(3)
    v_cndmask_b32 v242, v242, v243, vcc
    v_add_u32 v243, 0xfffe2000, v242
    v_mfma_f32_16x16x32_bf16 v[228:231], a[160:163], a[224:227], v[228:231]
    s_mov_b32 vcc_lo, 0xf0f0f0f0
    s_mov_b32 vcc_hi, 0xf0f0f0f0
    v_cndmask_b32 v242, v242, v243, vcc
    v_mfma_f32_16x16x32_bf16 v[232:235], a[180:183], a[220:223], v[232:235]
    ds_read_b128 a[232:235], v242 offset:0
    v_xor_b32 v243, 64, v242
    v_mfma_f32_16x16x32_bf16 v[232:235], a[184:187], a[224:227], v[232:235]
    ds_read_b128 a[236:239], v243 offset:0
    v_mul_f32 v222, v222, v225
    v_mfma_f32_16x16x32_bf16 v[236:239], a[192:195], a[240:243], 0
    ds_read_b128 a[240:243], v242 offset:128
    v_mul_f32 v223, v223, v225
    v_mfma_f32_16x16x32_bf16 v[236:239], a[196:199], a[244:247], v[236:239]
    ds_read_b128 a[244:247], v243 offset:128
    v_cvt_pk_bf16_f32 v220, v220, v221
    v_mfma_f32_16x16x32_bf16 v[236:239], a[200:203], a[216:219], v[236:239]
    ds_read_b128 a[216:219], v242 offset:256
    v_cvt_pk_bf16_f32 v221, v222, v223
    v_mfma_f32_16x16x32_bf16 v[236:239], a[204:207], a[220:223], v[236:239]
    ds_read_b128 a[220:223], v243 offset:256
    v_max3_f32 v248, v248, v200, v201
    v_mfma_f32_16x16x32_bf16 v[236:239], a[208:211], a[224:227], v[236:239]
    s_waitcnt lgkmcnt(7)
    ds_read_b128 a[224:227], v240 offset:36864
    v_mfma_f32_16x16x32_bf16 v[228:231], a[164:167], a[228:231], v[228:231]
    ds_write_b64 v247, v[220:221] offset:6400
    v_mfma_f32_16x16x32_bf16 v[232:235], a[188:191], a[228:231], v[232:235]
    s_mov_b32 vcc_lo, 0xcccccccc
    v_max3_f32 v248, v248, v202, v203
    v_max3_f32 v248, v248, v204, v205
    v_mfma_f32_16x16x32_bf16 v[236:239], a[212:215], a[228:231], v[236:239]
    ds_read_b128 a[228:231], v241 offset:36864
    ds_read_b128 v[200:203], v246 offset:64
    v_mul_f32 v228, s38, v228
    v_mul_f32 v229, s38, v229
    v_mul_f32 v230, s38, v230
    v_mul_f32 v231, s38, v231
    v_cvt_pk_bf16_f32 v228, v228, v229
    v_cvt_pk_bf16_f32 v229, v230, v231
    ds_write_b64 v247, v[228:229] offset:30720
    s_waitcnt lgkmcnt(10)
    v_mfma_f32_16x16x32_bf16 v[228:231], a[144:147], a[232:235], 0
    s_waitcnt lgkmcnt(9)
    v_mul_f32 v232, s3, v232
    v_mul_f32 v233, s3, v233
    v_mfma_f32_16x16x32_bf16 v[228:231], a[148:151], a[236:239], v[228:231]
    s_waitcnt lgkmcnt(8)
    v_mul_f32 v234, s3, v234
    v_mul_f32 v235, s3, v235
    v_mfma_f32_16x16x32_bf16 v[228:231], a[152:155], a[240:243], v[228:231]
    s_waitcnt lgkmcnt(7)
    v_cvt_pk_bf16_f32 v232, v232, v233
    v_cvt_pk_bf16_f32 v233, v234, v235
    v_mfma_f32_16x16x32_bf16 v[228:231], a[156:159], a[244:247], v[228:231]
    s_waitcnt lgkmcnt(6)
    v_mul_f32 v236, s38, v236
    v_mul_f32 v237, s38, v237
    v_mfma_f32_16x16x32_bf16 v[228:231], a[160:163], a[216:219], v[228:231]
    s_waitcnt lgkmcnt(5)
    v_mul_f32 v238, s38, v238
    v_mul_f32 v239, s38, v239
    v_mfma_f32_16x16x32_bf16 v[228:231], a[164:167], a[220:223], v[228:231]
    s_waitcnt lgkmcnt(1)
    v_cvt_pk_bf16_f32 v236, v236, v237
    v_cvt_pk_bf16_f32 v237, v238, v239
    v_mfma_f32_16x16x32_bf16 v[200:203], v[138:141], v[174:177], v[200:203]
    ds_write_b64 v247, v[232:233] offset:30848
    v_mfma_f32_16x16x32_bf16 v[200:203], v[140:143], v[176:179], v[200:203]
    ds_write_b64 v247, v[236:237] offset:30976
    v_mfma_f32_16x16x32_bf16 v[232:235], a[168:171], a[232:235], 0
    s_mov_b32 vcc_hi, 0xcccccccc
    v_mul_f32 v228, s38, v228
    v_mul_f32 v229, s38, v229
    v_mfma_f32_16x16x32_bf16 v[232:235], a[172:175], a[236:239], v[232:235]
    v_mul_f32 v230, s38, v230
    v_mul_f32 v231, s38, v231
    v_mfma_f32_16x16x32_bf16 v[232:235], a[176:179], a[240:243], v[232:235]
    v_cvt_pk_bf16_f32 v228, v228, v229
    v_cvt_pk_bf16_f32 v229, v230, v231
    v_mfma_f32_16x16x32_bf16 v[232:235], a[180:183], a[244:247], v[232:235]
    ds_write_b64 v247, v[228:229] offset:49152
    v_mfma_f32_16x16x32_bf16 v[232:235], a[184:187], a[216:219], v[232:235]
    v_max3_f32 v248, v248, v206, v207
    v_max3_f32 v248, v248, v208, v209
    v_mfma_f32_16x16x32_bf16 v[232:235], a[188:191], a[220:223], v[232:235]
    ds_read_b128 v[204:207], v244 offset:128
    v_max3_f32 v248, v248, v210, v211
    v_mfma_f32_16x16x32_bf16 v[236:239], a[192:195], a[232:235], 0
    ds_read_b128 a[232:235], v240 offset:36992
    ds_read_b128 v[208:211], v245 offset:128
    v_mfma_f32_16x16x32_bf16 v[236:239], a[196:199], a[236:239], v[236:239]
    ds_read_b128 a[236:239], v241 offset:36992
    v_max3_f32 v248, v248, v196, v197
    v_mfma_f32_16x16x32_bf16 v[236:239], a[200:203], a[240:243], v[236:239]
    v_mul_f32 v232, s3, v232
    v_mul_f32 v233, s3, v233
    v_mfma_f32_16x16x32_bf16 v[236:239], a[204:207], a[244:247], v[236:239]
    v_mul_f32 v234, s3, v234
    v_mul_f32 v235, s3, v235
    v_mfma_f32_16x16x32_bf16 v[236:239], a[208:211], a[216:219], v[236:239]
    ds_read_b128 a[240:243], v240 offset:37120
    v_cvt_pk_bf16_f32 v232, v232, v233
    v_mfma_f32_16x16x32_bf16 v[236:239], a[212:215], a[220:223], v[236:239]
    ds_read_b128 a[244:247], v241 offset:37120
    v_cvt_pk_bf16_f32 v233, v234, v235
    v_mfma_f32_16x16x32_bf16 v[228:231], a[0:3], a[224:227], 0
    ds_write_b64 v247, v[232:233] offset:49280
    v_mfma_f32_16x16x32_bf16 v[228:231], a[4:7], a[228:231], v[228:231]
    ds_read_b128 a[216:219], v242 offset:3072
    ds_read_b128 a[220:223], v243 offset:3072
    v_mfma_f32_16x16x32_bf16 v[232:235], a[24:27], a[224:227], 0
    s_waitcnt lgkmcnt(7)
    v_mul_f32 v236, s38, v236
    v_mul_f32 v237, s38, v237
    v_mfma_f32_16x16x32_bf16 v[204:207], v[132:135], v[174:177], v[204:207]
    s_waitcnt lgkmcnt(6)
    v_mul_f32 v238, s38, v238
    v_mul_f32 v239, s38, v239
    v_mfma_f32_16x16x32_bf16 v[204:207], v[134:137], v[176:179], v[204:207]
    v_cvt_pk_bf16_f32 v236, v236, v237
    v_cvt_pk_bf16_f32 v237, v238, v239
    v_mfma_f32_16x16x32_bf16 v[208:211], v[102:105], v[174:177], v[208:211]
    ds_write_b64 v247, v[236:237] offset:49408
    v_mfma_f32_16x16x32_bf16 v[208:211], v[104:107], v[176:179], v[208:211]
    s_waitcnt lgkmcnt(6)
    v_add_u32 v240, 0xffff1000, v240
    v_add_u32 v241, 0xffff1000, v241
    v_mfma_f32_16x16x32_bf16 v[228:231], a[8:11], a[232:235], v[228:231]
    s_waitcnt lgkmcnt(5)
    v_max3_f32 v248, v248, v198, v199
    v_max3_f32 v248, v248, v200, v201
    v_mfma_f32_16x16x32_bf16 v[228:231], a[12:15], a[236:239], v[228:231]
    ds_read_b128 v[196:199], v246 offset:128
    v_max3_f32 v248, v248, v202, v203
    v_mfma_f32_16x16x32_bf16 v[228:231], a[16:19], a[240:243], v[228:231]
    ds_read_b128 v[200:203], v244 offset:0
    v_max3_f32 v248, v248, v204, v205
    v_mfma_f32_16x16x32_bf16 v[232:235], a[28:31], a[228:231], v[232:235]
    ds_read_b128 v[204:207], v245 offset:0
    v_max3_f32 v248, v248, v208, v209
    v_mfma_f32_16x16x32_bf16 v[232:235], a[32:35], a[232:235], v[232:235]
    ds_read_b128 v[208:211], v246 offset:0
    s_waitcnt lgkmcnt(8)
    v_mfma_f32_16x16x32_bf16 v[228:231], a[20:23], a[244:247], v[228:231]
    s_waitcnt lgkmcnt(5)
    v_mfma_f32_16x16x32_bf16 v[232:235], a[36:39], a[236:239], v[232:235]
    v_mfma_f32_16x16x32_bf16 v[232:235], a[40:43], a[240:243], v[232:235]
    v_mfma_f32_16x16x32_bf16 v[232:235], a[44:47], a[244:247], v[232:235]
    v_mfma_f32_16x16x32_bf16 v[236:239], a[48:51], a[224:227], 0
    v_mfma_f32_16x16x32_bf16 v[236:239], a[52:55], a[228:231], v[236:239]
    s_waitcnt lgkmcnt(3)
    s_waitcnt lgkmcnt(2)
    v_mfma_f32_16x16x32_bf16 v[196:199], v[114:117], v[174:177], v[196:199]
    v_mfma_f32_16x16x32_bf16 v[196:199], v[116:119], v[176:179], v[196:199]
    s_waitcnt lgkmcnt(1)
    s_waitcnt lgkmcnt(0)
    v_mfma_f32_16x16x32_bf16 v[200:203], v[120:123], v[174:177], v[200:203]
    v_cvt_pk_bf16_f32 v120, v228, v229
    v_cvt_pk_bf16_f32 v121, v230, v231
    v_mfma_f32_16x16x32_bf16 v[200:203], v[122:125], v[176:179], v[200:203]
    v_cvt_pk_bf16_f32 v122, v232, v233
    v_cvt_pk_bf16_f32 v123, v234, v235
    v_mfma_f32_16x16x32_bf16 v[204:207], v[156:159], v[174:177], v[204:207]
    v_max3_f32 v248, v248, v196, v197
    v_mov_b32 v225, v248
    v_mfma_f32_16x16x32_bf16 v[204:207], v[158:161], v[176:179], v[204:207]
    ds_read_b128 v[196:199], v244 offset:64
    v_permlane16_swap_b32 v248, v225
    v_mfma_f32_16x16x32_bf16 v[208:211], v[90:93], v[174:177], v[208:211]
    v_max_f32 v248, v248, v225
    v_mov_b32 v225, v248
    v_mfma_f32_16x16x32_bf16 v[208:211], v[92:95], v[176:179], v[208:211]
    v_mfma_f32_16x16x32_bf16 v[236:239], a[56:59], a[232:235], v[236:239]
    v_permlane32_swap_b32 v248, v225
    v_max_f32 v248, v248, v225
    v_mfma_f32_16x16x32_bf16 v[236:239], a[60:63], a[236:239], v[236:239]
    v_sub_f32 v200, v200, v248
    v_sub_f32 v201, v201, v248
    v_mfma_f32_16x16x32_bf16 v[236:239], a[64:67], a[240:243], v[236:239]
    v_exp_f32 v200, v200
    v_mfma_f32_16x16x32_bf16 v[236:239], a[68:71], a[244:247], v[236:239]
    v_exp_f32 v201, v201
    v_mfma_f32_16x16x32_bf16 v[228:231], a[224:227], a[72:75], 0
    v_sub_f32 v202, v202, v248
    v_sub_f32 v203, v203, v248
    v_mfma_f32_16x16x32_bf16 v[228:231], a[228:231], a[76:79], v[228:231]
    v_exp_f32 v202, v202
    v_mfma_f32_16x16x32_bf16 v[228:231], a[232:235], a[80:83], v[228:231]
    s_waitcnt lgkmcnt(0)
    v_cvt_pk_bf16_f32 v124, v236, v237
    v_cvt_pk_bf16_f32 v125, v238, v239
    v_mfma_f32_16x16x32_bf16 v[196:199], v[126:129], v[174:177], v[196:199]
    v_exp_f32 v203, v203
    v_mfma_f32_16x16x32_bf16 v[196:199], v[128:131], v[176:179], v[196:199]
    v_cvt_pk_bf16_f32 v193, v200, v201
    v_cvt_pk_bf16_f32 v180, v202, v203
    v_mfma_f32_16x16x32_bf16 v[228:231], a[236:239], a[84:87], v[228:231]
    ds_read_b128 v[200:203], v245 offset:64
    v_sub_f32 v204, v204, v248
    v_mfma_f32_16x16x32_bf16 v[228:231], a[240:243], a[88:91], v[228:231]
    v_exp_f32 v204, v204
    v_mfma_f32_16x16x32_bf16 v[228:231], a[244:247], a[92:95], v[228:231]
    v_sub_f32 v205, v205, v248
    v_sub_f32 v206, v206, v248
    v_mfma_f32_16x16x32_bf16 v[232:235], a[224:227], a[96:99], 0
    v_exp_f32 v205, v205
    v_mfma_f32_16x16x32_bf16 v[232:235], a[228:231], a[100:103], v[232:235]
    v_exp_f32 v206, v206
    v_mfma_f32_16x16x32_bf16 v[232:235], a[232:235], a[104:107], v[232:235]
    v_sub_f32 v207, v207, v248
    v_cvt_pk_bf16_f32 v24, v228, v229
    v_mfma_f32_16x16x32_bf16 v[232:235], a[236:239], a[108:111], v[232:235]
    v_cvt_pk_bf16_f32 v27, v230, v231
    v_mbcnt_lo_u32_b32 v228, -1, 0
    v_mfma_f32_16x16x32_bf16 v[232:235], a[240:243], a[112:115], v[232:235]
    v_mbcnt_hi_u32_b32 v228, -1, v228
    v_lshrrev_b32 v229, 1, v228
    v_mfma_f32_16x16x32_bf16 v[232:235], a[244:247], a[116:119], v[232:235]
    v_add_u32 v229, 64, v229
    v_mul_u32_u24 v230, 43, v229
    v_mfma_f32_16x16x32_bf16 v[236:239], a[224:227], a[120:123], 0
    ds_read_b128 a[224:227], v242 offset:3200
    v_lshrrev_b32 v231, 8, v230
    v_mfma_f32_16x16x32_bf16 v[236:239], a[228:231], a[124:127], v[236:239]
    ds_read_b128 a[228:231], v243 offset:3200
    v_lshrrev_b32 v230, 7, v230
    v_mfma_f32_16x16x32_bf16 v[236:239], a[232:235], a[128:131], v[236:239]
    s_waitcnt lgkmcnt(2)
    v_cvt_pk_bf16_f32 v54, v232, v233
    v_cvt_pk_bf16_f32 v57, v234, v235
    v_mfma_f32_16x16x32_bf16 v[200:203], v[162:165], v[174:177], v[200:203]
    ds_read_b128 a[232:235], v242 offset:3328
    v_mad_i32_i24 v229, v230, -3, v229
    v_mfma_f32_16x16x32_bf16 v[200:203], v[164:167], v[176:179], v[200:203]
    v_and_b32 v231, 4, v231
    v_xor_b32 v230, v230, v231
    v_mfma_f32_16x16x32_bf16 v[236:239], a[236:239], a[132:135], v[236:239]
    ds_read_b128 a[236:239], v243 offset:3328
    v_and_b32 v231, 4, v230
    v_mfma_f32_16x16x32_bf16 v[236:239], a[240:243], a[136:139], v[236:239]
    ds_read_b128 a[240:243], v240 offset:1536
    v_mul_u32_u24 v251, 24, v231
    v_mfma_f32_16x16x32_bf16 v[236:239], a[244:247], a[140:143], v[236:239]
    ds_read_b128 a[244:247], v241 offset:1536
    v_lshrrev_b32 v231, 3, v230
    v_mfma_f32_16x16x32_bf16 v[232:235], a[144:147], a[216:219], 0
    v_lshl_add_u32 v251, v231, 2, v251
    v_and_or_b32 v251, v230, 3, v251
    v_mfma_f32_16x16x32_bf16 v[232:235], a[148:151], a[220:223], v[232:235]
    s_waitcnt lgkmcnt(5)
    v_mad_u32_u24 v251, v251, 3, v229
    v_cvt_pk_bf16_f32 v84, v236, v237
    v_mfma_f32_16x16x32_bf16 v[232:235], a[152:155], a[224:227], v[232:235]
    s_waitcnt lgkmcnt(4)
    v_cvt_pk_bf16_f32 v87, v238, v239
    v_and_b32 v231, 1, v228
    v_mfma_f32_16x16x32_bf16 v[232:235], a[156:159], a[228:231], v[232:235]
    v_lshl_add_u32 v251, v251, 3, v231
    v_lshlrev_b32 v251, 4, v251
    v_mfma_f32_16x16x32_bf16 v[236:239], a[168:171], a[216:219], 0
    s_waitcnt lgkmcnt(3)
    v_add_u32 v251, 0xfffff800, v251
    v_cvt_pk_bf16_f32 v194, v204, v205
    v_mfma_f32_16x16x32_bf16 v[232:235], a[160:163], a[232:235], v[232:235]
    v_exp_f32 v207, v207
    v_mfma_f32_16x16x32_bf16 v[236:239], a[172:175], a[220:223], v[236:239]
    s_waitcnt lgkmcnt(2)
    s_barrier
    v_mfma_f32_16x16x32_bf16 v[232:235], a[164:167], a[236:239], v[232:235]
    buffer_load_dwordx4 v252, s[12:15], s62 offen lds
    v_cvt_pk_bf16_f32 v181, v206, v207
    v_mfma_f32_16x16x32_bf16 v[236:239], a[176:179], a[224:227], v[236:239]
    ds_read_b128 v[204:207], v246 offset:64
    v_sub_f32 v208, v208, v248
    v_mfma_f32_16x16x32_bf16 v[236:239], a[180:183], a[228:231], v[236:239]
    s_waitcnt lgkmcnt(1)
    v_exp_f32 v208, v208
    v_mfma_f32_16x16x32_bf16 v[236:239], a[184:187], a[232:235], v[236:239]
    v_mul_f32 v232, s38, v232
    v_mul_f32 v233, s38, v233
    v_mfma_f32_16x16x32_bf16 v[236:239], a[188:191], a[236:239], v[236:239]
    buffer_load_dwordx4 v253, s[12:15], s62 offen offset:1024 lds
    v_mul_f32 v234, s38, v234
    v_mfma_f32_16x16x32_bf16 v[228:231], a[192:195], a[216:219], 0
    v_mul_f32 v235, s38, v235
    v_cvt_pk_bf16_f32 v232, v232, v233
    v_mfma_f32_16x16x32_bf16 v[228:231], a[196:199], a[220:223], v[228:231]
    ds_read_b128 a[216:219], v240 offset:1664
    v_cvt_pk_bf16_f32 v233, v234, v235
    v_mfma_f32_16x16x32_bf16 v[228:231], a[200:203], a[224:227], v[228:231]
    ds_write_b64 v247, v[232:233] offset:55296
    v_mfma_f32_16x16x32_bf16 v[228:231], a[204:207], a[228:231], v[228:231]
    buffer_load_dwordx4 v251, s[12:15], s62 offen offset:2048 lds
    s_add_u32 m0, s46, 0x17400
    v_mfma_f32_16x16x32_bf16 v[228:231], a[208:211], a[232:235], v[228:231]
    s_lshl_b32 s62, s28, 5
    s_add_u32 s62, s62, 0x3000
    v_mul_f32 v236, s3, v236
    v_mfma_f32_16x16x32_bf16 v[228:231], a[212:215], a[236:239], v[228:231]
    s_waitcnt lgkmcnt(2)
    v_mul_f32 v237, s3, v237
    v_mul_f32 v238, s3, v238
    v_mfma_f32_16x16x32_bf16 v[204:207], v[138:141], v[174:177], v[204:207]
    v_mul_f32 v239, s3, v239
    v_cvt_pk_bf16_f32 v236, v236, v237
    v_mfma_f32_16x16x32_bf16 v[204:207], v[140:143], v[176:179], v[204:207]
    buffer_load_dwordx4 v252, s[12:15], s63 offen lds
    v_cvt_pk_bf16_f32 v237, v238, v239
    v_mfma_f32_16x16x32_bf16 v[232:235], a[0:3], a[240:243], 0
    ds_write_b64 v247, v[236:237] offset:55424
    v_mfma_f32_16x16x32_bf16 v[232:235], a[4:7], a[244:247], v[232:235]
    s_waitcnt lgkmcnt(2)
    v_mul_f32 v228, s38, v228
    v_mul_f32 v229, s38, v229
    v_mfma_f32_16x16x32_bf16 v[232:235], a[8:11], a[216:219], v[232:235]
    v_mul_f32 v230, s38, v230
    v_mul_f32 v231, s38, v231
    v_mfma_f32_16x16x32_bf16 v[236:239], a[24:27], a[240:243], 0
    buffer_load_dwordx4 v253, s[12:15], s63 offen offset:1024 lds
    v_cvt_pk_bf16_f32 v228, v228, v229
    v_mfma_f32_16x16x32_bf16 v[236:239], a[28:31], a[244:247], v[236:239]
    ds_read_b128 a[220:223], v241 offset:1664
    v_cvt_pk_bf16_f32 v229, v230, v231
    v_mfma_f32_16x16x32_bf16 v[236:239], a[32:35], a[216:219], v[236:239]
    ds_write_b64 v247, v[228:229] offset:55552
    v_mfma_f32_16x16x32_bf16 v[228:231], a[48:51], a[240:243], 0
    ds_read_b128 a[224:227], v240 offset:1792
    buffer_load_dwordx4 v251, s[12:15], s63 offen offset:2048 lds
    v_mfma_f32_16x16x32_bf16 v[228:231], a[52:55], a[244:247], v[228:231]
    s_add_u32 m0, s46, 0x16800
    s_lshl_b32 s63, s28, 5
    s_add_u32 s63, s63, 0x7800
    v_mfma_f32_16x16x32_bf16 v[228:231], a[56:59], a[216:219], v[228:231]
    ds_read_b128 a[228:231], v241 offset:1792
    ds_read_b128 a[232:235], v240 offset:0
    ds_read_b128 a[236:239], v241 offset:0
    v_sub_f32 v209, v209, v248
    v_exp_f32 v209, v209
    v_sub_f32 v210, v210, v248
    v_exp_f32 v210, v210
    v_sub_f32 v211, v211, v248
    v_exp_f32 v211, v211
    s_waitcnt lgkmcnt(5)
    v_mfma_f32_16x16x32_bf16 v[232:235], a[12:15], a[220:223], v[232:235]
    v_cvt_pk_bf16_f32 v192, v208, v209
    v_cvt_pk_bf16_f32 v195, v210, v211
    v_mfma_f32_16x16x32_bf16 v[236:239], a[36:39], a[220:223], v[236:239]
    ds_read_b128 v[208:211], v244 offset:128
    v_sub_f32 v196, v196, v248
    v_mfma_f32_16x16x32_bf16 v[212:215], v[6:9], v[192:195], 0
    s_waitcnt lgkmcnt(4)
    v_exp_f32 v196, v196
    v_mfma_f32_16x16x32_bf16 v[216:219], v[36:39], v[192:195], 0
    v_sub_f32 v197, v197, v248
    v_sub_f32 v198, v198, v248
    v_mfma_f32_16x16x32_bf16 v[220:223], v[66:69], v[192:195], 0
    v_exp_f32 v197, v197
    v_mfma_f32_16x16x32_bf16 v[224:227], a[248:251], v[192:195], 0
    v_exp_f32 v198, v198
    v_mfma_f32_16x16x32_bf16 v[232:235], a[16:19], a[224:227], v[232:235]
    s_waitcnt lgkmcnt(3)
    v_sub_f32 v199, v199, v248
    v_cvt_pk_bf16_f32 v183, v196, v197
    v_mfma_f32_16x16x32_bf16 v[232:235], a[20:23], a[228:231], v[232:235]
    s_waitcnt lgkmcnt(2)
    v_exp_f32 v199, v199
    v_mfma_f32_16x16x32_bf16 v[236:239], a[40:43], a[224:227], v[236:239]
    s_waitcnt lgkmcnt(1)
    v_cvt_pk_bf16_f32 v186, v198, v199
    v_sub_f32 v200, v200, v248
    v_mfma_f32_16x16x32_bf16 v[236:239], a[44:47], a[228:231], v[236:239]
    ds_read_b128 v[196:199], v245 offset:128
    v_sub_f32 v201, v201, v248
    v_mfma_f32_16x16x32_bf16 v[228:231], a[60:63], a[220:223], v[228:231]
    s_waitcnt lgkmcnt(1)
    v_exp_f32 v200, v200
    v_mfma_f32_16x16x32_bf16 v[208:211], v[132:135], v[174:177], v[208:211]
    v_exp_f32 v201, v201
    v_mfma_f32_16x16x32_bf16 v[208:211], v[134:137], v[176:179], v[208:211]
    v_sub_f32 v202, v202, v248
    v_sub_f32 v203, v203, v248
    v_mfma_f32_16x16x32_bf16 v[228:231], a[64:67], a[224:227], v[228:231]
    v_exp_f32 v202, v202
    v_mfma_f32_16x16x32_bf16 v[228:231], a[68:71], a[228:231], v[228:231]
    v_exp_f32 v203, v203
    v_cvt_pk_bf16_f32 v184, v200, v201
    v_cvt_pk_bf16_f32 v187, v202, v203
    ds_read_b128 v[200:203], v246 offset:128
    v_sub_f32 v204, v204, v248
    v_exp_f32 v204, v204
    v_sub_f32 v205, v205, v248
    v_exp_f32 v205, v205
    s_waitcnt lgkmcnt(1)
    v_mfma_f32_16x16x32_bf16 v[196:199], v[102:105], v[174:177], v[196:199]
    v_sub_f32 v206, v206, v248
    v_sub_f32 v207, v207, v248
    v_mfma_f32_16x16x32_bf16 v[196:199], v[104:107], v[176:179], v[196:199]
    v_exp_f32 v206, v206
    v_exp_f32 v207, v207
    v_cvt_pk_bf16_f32 v182, v204, v205
    v_cvt_pk_bf16_f32 v185, v206, v207
    ds_read_b128 v[204:207], v244 offset:0
    v_mfma_f32_16x16x32_bf16 v[212:215], v[10:13], v[180:183], v[212:215]
    v_sub_f32 v208, v208, v248
    v_sub_f32 v209, v209, v248
    v_mfma_f32_16x16x32_bf16 v[216:219], v[40:43], v[180:183], v[216:219]
    v_exp_f32 v208, v208
    v_mfma_f32_16x16x32_bf16 v[220:223], v[70:73], v[180:183], v[220:223]
    s_waitcnt lgkmcnt(1)
    v_exp_f32 v209, v209
    v_mfma_f32_16x16x32_bf16 v[224:227], a[248:251], v[180:183], v[224:227]
    v_cvt_pk_bf16_f32 v189, v208, v209
    v_sub_f32 v196, v196, v248
    v_mfma_f32_16x16x32_bf16 v[212:215], v[14:17], v[184:187], v[212:215]
    ds_read_b128 v[208:211], v245 offset:0
    v_sub_f32 v197, v197, v248
    v_mfma_f32_16x16x32_bf16 v[216:219], v[44:47], v[184:187], v[216:219]
    v_exp_f32 v196, v196
    v_mfma_f32_16x16x32_bf16 v[220:223], v[74:77], v[184:187], v[220:223]
    v_exp_f32 v197, v197
    v_mfma_f32_16x16x32_bf16 v[224:227], a[248:251], v[184:187], v[224:227]
    v_cvt_pk_bf16_f32 v190, v196, v197
    s_waitcnt lgkmcnt(1)
    v_mfma_f32_16x16x32_bf16 v[200:203], v[114:117], v[174:177], v[200:203]
    ds_read_b128 v[196:199], v246 offset:0
    ds_read_b64 v[174:175], v247 offset:0
    v_mfma_f32_16x16x32_bf16 v[200:203], v[116:119], v[176:179], v[200:203]
    ds_read_b64 v[176:177], v247 offset:128
    ds_read_b64 v[178:179], v247 offset:256
    v_mfma_f32_16x16x32_bf16 v[204:207], v[126:129], v[168:171], v[204:207]
    v_mfma_f32_16x16x32_bf16 v[204:207], v[128:131], v[170:173], v[204:207]
    s_waitcnt vmcnt(3)
    ds_read_b64_tr_b16 a[144:145], v249 offset:0
    s_waitcnt lgkmcnt(5)
    v_mfma_f32_16x16x32_bf16 v[208:211], v[162:165], v[168:171], v[208:211]
    ds_read_b64_tr_b16 a[146:147], v250 offset:0
    ds_read_b64_tr_b16 a[168:169], v249 offset:32
    v_mfma_f32_16x16x32_bf16 v[208:211], v[164:167], v[170:173], v[208:211]
    ds_read_b64_tr_b16 a[170:171], v250 offset:32
    ds_read_b64_tr_b16 a[192:193], v249 offset:64
    ds_read_b64_tr_b16 a[194:195], v250 offset:64
    v_sub_f32 v200, v200, v248
    v_exp_f32 v200, v200
    s_waitcnt lgkmcnt(9)
    v_mfma_f32_16x16x32_bf16 v[196:199], v[138:141], v[168:171], v[196:199]
    v_sub_f32 v201, v201, v248
    v_max_f32 v248, v204, v205
    v_mfma_f32_16x16x32_bf16 v[196:199], v[140:143], v[170:173], v[196:199]
    v_exp_f32 v201, v201
    v_max3_f32 v248, v248, v206, v207
    ds_read_b128 v[204:207], v245 offset:64
    v_cvt_pk_bf16_f32 v188, v200, v201
    ds_read_b128 v[200:203], v244 offset:64
    v_max3_f32 v248, v248, v208, v209
    v_mfma_f32_16x16x32_bf16 v[212:215], v[18:21], v[188:191], v[212:215]
    s_waitcnt lgkmcnt(8)
    v_max3_f32 v248, v248, v210, v211
    v_max3_f32 v248, v248, v196, v197
    v_mfma_f32_16x16x32_bf16 v[216:219], v[48:51], v[188:191], v[216:219]
    ds_read_b128 v[208:211], v246 offset:64
    v_max3_f32 v248, v248, v198, v199
    v_mfma_f32_16x16x32_bf16 v[220:223], v[78:81], v[188:191], v[220:223]
    ds_read_b128 v[196:199], v244 offset:128
    s_waitcnt lgkmcnt(4)
    v_mfma_f32_16x16x32_bf16 v[224:227], a[248:251], v[188:191], v[224:227]
    buffer_load_dwordx4 v252, s[12:15], s60 offen lds
    s_waitcnt vmcnt(1)
    ds_read_b64_tr_b16 a[148:149], v249 offset:3072
    ds_read_b64_tr_b16 a[150:151], v250 offset:3072
    ds_read_b64_tr_b16 a[172:173], v249 offset:3104
    ds_read_b64_tr_b16 a[174:175], v250 offset:3104
    ds_read_b64_tr_b16 a[196:197], v249 offset:3136
    s_waitcnt lgkmcnt(8)
    v_mfma_f32_16x16x32_bf16 v[204:207], v[102:105], v[168:171], v[204:207]
    buffer_load_dwordx4 v253, s[12:15], s60 offen offset:1024 lds
    ds_read_b64_tr_b16 a[198:199], v250 offset:3136
    v_mfma_f32_16x16x32_bf16 v[204:207], v[104:107], v[170:173], v[204:207]
    s_waitcnt lgkmcnt(8)
    v_rcp_f32 v225, v224
    v_mfma_f32_16x16x32_bf16 v[200:203], v[132:135], v[168:171], v[200:203]
    v_mul_f32 v212, v212, v225
    v_mul_f32 v213, v213, v225
    v_mfma_f32_16x16x32_bf16 v[200:203], v[134:137], v[170:173], v[200:203]
    s_waitcnt lgkmcnt(7)
    v_mul_f32 v214, v214, v225
    v_mul_f32 v215, v215, v225
    v_mfma_f32_16x16x32_bf16 v[208:211], v[114:117], v[168:171], v[208:211]
    buffer_load_dwordx4 v251, s[12:15], s60 offen offset:2048 lds
    s_add_u32 m0, s46, 0x17400
    v_mfma_f32_16x16x32_bf16 v[208:211], v[116:119], v[170:173], v[208:211]
    s_waitcnt lgkmcnt(6)
    v_cvt_pk_bf16_f32 v212, v212, v213
    v_cvt_pk_bf16_f32 v213, v214, v215
    v_mfma_f32_16x16x32_bf16 v[196:199], v[144:147], v[168:171], v[196:199]
    ds_write_b64 v247, v[212:213] offset:12288
    v_mfma_f32_16x16x32_bf16 v[196:199], v[146:149], v[170:173], v[196:199]
    v_mul_f32 v216, v216, v225
    v_mul_f32 v217, v217, v225
    v_mul_f32 v218, v218, v225
    s_waitcnt lgkmcnt(1)
    buffer_load_dwordx4 v252, s[12:15], s61 offen lds
    v_mul_f32 v219, v219, v225
    v_cvt_pk_bf16_f32 v216, v216, v217
    v_cvt_pk_bf16_f32 v217, v218, v219
    ds_write_b64 v247, v[216:217] offset:12416
    v_mul_f32 v220, v220, v225
    v_mul_f32 v221, v221, v225
    v_mul_f32 v222, v222, v225
    v_mul_f32 v223, v223, v225
    v_cvt_pk_bf16_f32 v220, v220, v221
    buffer_load_dwordx4 v253, s[12:15], s61 offen offset:1024 lds
    v_cvt_pk_bf16_f32 v221, v222, v223
    ds_write_b64 v247, v[220:221] offset:12544
    v_max3_f32 v248, v248, v200, v201
    v_max3_f32 v248, v248, v202, v203
    ds_read_b128 v[200:203], v245 offset:128
    v_max3_f32 v248, v248, v204, v205
    v_max3_f32 v248, v248, v206, v207
    buffer_load_dwordx4 v251, s[12:15], s61 offen offset:2048 lds
    s_add_u32 m0, s46, 0x16800
    ds_read_b128 v[204:207], v246 offset:128
    v_max3_f32 v248, v248, v208, v209
    v_max3_f32 v248, v248, v210, v211
    ds_read_b128 v[208:211], v244 offset:0
    v_max3_f32 v248, v248, v196, v197
    ds_read_b128 v[196:199], v245 offset:0
    s_waitcnt lgkmcnt(3)
    v_mfma_f32_16x16x32_bf16 v[200:203], v[108:111], v[168:171], v[200:203]
    v_mfma_f32_16x16x32_bf16 v[200:203], v[110:113], v[170:173], v[200:203]
    s_nop 7
    s_waitcnt lgkmcnt(1)
    v_mfma_f32_16x16x32_bf16 v[204:207], v[120:123], v[168:171], v[204:207]
    v_max3_f32 v248, v248, v200, v201
    s_waitcnt lgkmcnt(0)
    v_mfma_f32_16x16x32_bf16 v[204:207], v[122:125], v[170:173], v[204:207]
    ds_read_b128 v[200:203], v246 offset:0
    v_mfma_f32_16x16x32_bf16 v[208:211], v[126:129], v[168:171], v[208:211]
    v_cvt_pk_bf16_f32 v126, v232, v233
    v_cvt_pk_bf16_f32 v127, v234, v235
    v_mfma_f32_16x16x32_bf16 v[208:211], v[128:131], v[170:173], v[208:211]
    v_cvt_pk_bf16_f32 v128, v236, v237
    v_cvt_pk_bf16_f32 v129, v238, v239
    v_mfma_f32_16x16x32_bf16 v[196:199], v[162:165], v[168:171], v[196:199]
    v_cvt_pk_bf16_f32 v130, v228, v229
    v_cvt_pk_bf16_f32 v131, v230, v231
    v_mfma_f32_16x16x32_bf16 v[196:199], v[164:167], v[170:173], v[196:199]
    v_max3_f32 v248, v248, v204, v205
    v_mov_b32 v225, v248
    v_mfma_f32_16x16x32_bf16 v[232:235], a[240:243], a[72:75], 0
    ds_read_b128 v[204:207], v244 offset:64
    v_permlane16_swap_b32 v248, v225
    v_mfma_f32_16x16x32_bf16 v[232:235], a[244:247], a[76:79], v[232:235]
    v_max_f32 v248, v248, v225
    v_mov_b32 v225, v248
    v_mfma_f32_16x16x32_bf16 v[232:235], a[216:219], a[80:83], v[232:235]
    v_mfma_f32_16x16x32_bf16 v[232:235], a[220:223], a[84:87], v[232:235]
    v_permlane32_swap_b32 v248, v225
    v_max_f32 v248, v248, v225
    v_mfma_f32_16x16x32_bf16 v[232:235], a[224:227], a[88:91], v[232:235]
    s_waitcnt lgkmcnt(1)
    v_sub_f32 v208, v208, v248
    v_sub_f32 v209, v209, v248
    v_mfma_f32_16x16x32_bf16 v[200:203], v[138:141], v[168:171], v[200:203]
    v_exp_f32 v208, v208
    v_mfma_f32_16x16x32_bf16 v[200:203], v[140:143], v[170:173], v[200:203]
    v_exp_f32 v209, v209
    v_mfma_f32_16x16x32_bf16 v[232:235], a[228:231], a[92:95], v[232:235]
    v_sub_f32 v210, v210, v248
    v_sub_f32 v211, v211, v248
    v_mfma_f32_16x16x32_bf16 v[236:239], a[240:243], a[96:99], 0
    v_exp_f32 v210, v210
    v_mfma_f32_16x16x32_bf16 v[236:239], a[244:247], a[100:103], v[236:239]
    s_waitcnt lgkmcnt(0)
    v_exp_f32 v211, v211
    v_mfma_f32_16x16x32_bf16 v[204:207], v[132:135], v[168:171], v[204:207]
    v_cvt_pk_bf16_f32 v7, v232, v233
    v_cvt_pk_bf16_f32 v10, v234, v235
    v_mfma_f32_16x16x32_bf16 v[204:207], v[134:137], v[170:173], v[204:207]
    v_cvt_pk_bf16_f32 v193, v208, v209
    v_cvt_pk_bf16_f32 v180, v210, v211
    v_mfma_f32_16x16x32_bf16 v[236:239], a[216:219], a[104:107], v[236:239]
    ds_read_b128 v[208:211], v245 offset:64
    v_sub_f32 v196, v196, v248
    v_mfma_f32_16x16x32_bf16 v[236:239], a[220:223], a[108:111], v[236:239]
    v_exp_f32 v196, v196
    v_mfma_f32_16x16x32_bf16 v[236:239], a[224:227], a[112:115], v[236:239]
    v_sub_f32 v197, v197, v248
    v_sub_f32 v198, v198, v248
    v_mfma_f32_16x16x32_bf16 v[236:239], a[228:231], a[116:119], v[236:239]
    v_exp_f32 v197, v197
    v_mfma_f32_16x16x32_bf16 v[228:231], a[240:243], a[120:123], 0
    ds_read_b128 a[240:243], v240 offset:128
    v_sub_f32 v199, v199, v248
    v_mfma_f32_16x16x32_bf16 v[228:231], a[244:247], a[124:127], v[228:231]
    ds_read_b128 a[244:247], v241 offset:128
    v_cvt_pk_bf16_f32 v194, v196, v197
    v_mfma_f32_16x16x32_bf16 v[228:231], a[216:219], a[128:131], v[228:231]
    v_cvt_pk_bf16_f32 v37, v236, v237
    v_cvt_pk_bf16_f32 v40, v238, v239
    v_mfma_f32_16x16x32_bf16 v[228:231], a[220:223], a[132:135], v[228:231]
    ds_read_b128 a[216:219], v240 offset:256
    ds_read_b128 a[220:223], v241 offset:256
    v_mfma_f32_16x16x32_bf16 v[228:231], a[224:227], a[136:139], v[228:231]
    ds_read_b128 a[224:227], v240 offset:3072
    v_sub_f32 v200, v200, v248
    v_mfma_f32_16x16x32_bf16 v[228:231], a[228:231], a[140:143], v[228:231]
    ds_read_b128 a[228:231], v241 offset:3072
    s_waitcnt vmcnt(3) lgkmcnt(6)
    v_mfma_f32_16x16x32_bf16 v[208:211], v[102:105], v[168:171], v[208:211]
    ds_read_b64_tr_b16 a[152:153], v249 offset:0
    ds_read_b64_tr_b16 a[154:155], v250 offset:0
    v_mfma_f32_16x16x32_bf16 v[208:211], v[104:107], v[170:173], v[208:211]
    ds_read_b64_tr_b16 a[176:177], v249 offset:32
    ds_read_b64_tr_b16 a[178:179], v250 offset:32
    v_mfma_f32_16x16x32_bf16 v[232:235], a[0:3], a[232:235], 0
    ds_read_b64_tr_b16 a[200:201], v249 offset:64
    ds_read_b64_tr_b16 a[202:203], v250 offset:64
    v_mfma_f32_16x16x32_bf16 v[232:235], a[4:7], a[236:239], v[232:235]
    s_waitcnt lgkmcnt(11)
    v_cvt_pk_bf16_f32 v67, v228, v229
    v_cvt_pk_bf16_f32 v70, v230, v231
    v_mfma_f32_16x16x32_bf16 v[232:235], a[8:11], a[240:243], v[232:235]
    s_waitcnt lgkmcnt(10)
    v_exp_f32 v198, v198
    v_mfma_f32_16x16x32_bf16 v[232:235], a[12:15], a[244:247], v[232:235]
    s_waitcnt lgkmcnt(9)
    v_exp_f32 v199, v199
    v_mfma_f32_16x16x32_bf16 v[232:235], a[16:19], a[216:219], v[232:235]
    s_waitcnt lgkmcnt(8)
    v_cvt_pk_bf16_f32 v181, v198, v199
    v_sub_f32 v201, v201, v248
    v_mfma_f32_16x16x32_bf16 v[232:235], a[20:23], a[220:223], v[232:235]
    ds_read_b128 v[196:199], v246 offset:64
    v_sub_f32 v202, v202, v248
    v_mfma_f32_16x16x32_bf16 v[236:239], a[24:27], a[232:235], 0
    s_waitcnt lgkmcnt(8)
    v_exp_f32 v200, v200
    v_mfma_f32_16x16x32_bf16 v[236:239], a[28:31], a[236:239], v[236:239]
    s_waitcnt lgkmcnt(6)
    v_exp_f32 v201, v201
    v_mfma_f32_16x16x32_bf16 v[236:239], a[32:35], a[240:243], v[236:239]
    s_waitcnt lgkmcnt(4)
    v_exp_f32 v202, v202
    v_mfma_f32_16x16x32_bf16 v[236:239], a[36:39], a[244:247], v[236:239]
    s_waitcnt lgkmcnt(1)
    buffer_load_dwordx4 v252, s[12:15], s62 offen lds
    v_mfma_f32_16x16x32_bf16 v[236:239], a[40:43], a[216:219], v[236:239]
    s_waitcnt vmcnt(1)
    ds_read_b64_tr_b16 a[156:157], v249 offset:3072
    v_mfma_f32_16x16x32_bf16 v[236:239], a[44:47], a[220:223], v[236:239]
    ds_read_b64_tr_b16 a[158:159], v250 offset:3072
    ds_read_b64_tr_b16 a[180:181], v249 offset:3104
    v_mfma_f32_16x16x32_bf16 v[228:231], a[48:51], a[232:235], 0
    ds_read_b64_tr_b16 a[182:183], v250 offset:3104
    ds_read_b64_tr_b16 a[204:205], v249 offset:3136
    v_mfma_f32_16x16x32_bf16 v[228:231], a[52:55], a[236:239], v[228:231]
    buffer_load_dwordx4 v253, s[12:15], s62 offen offset:1024 lds
    ds_read_b64_tr_b16 a[206:207], v250 offset:3136
    v_mfma_f32_16x16x32_bf16 v[228:231], a[56:59], a[240:243], v[228:231]
    s_waitcnt lgkmcnt(6)
    v_sub_f32 v203, v203, v248
    v_cvt_pk_bf16_f32 v192, v200, v201
    v_mfma_f32_16x16x32_bf16 v[196:199], v[114:117], v[168:171], v[196:199]
    v_exp_f32 v203, v203
    v_mfma_f32_16x16x32_bf16 v[196:199], v[116:119], v[170:173], v[196:199]
    v_cvt_pk_bf16_f32 v195, v202, v203
    v_sub_f32 v204, v204, v248
    v_mfma_f32_16x16x32_bf16 v[228:231], a[60:63], a[244:247], v[228:231]
    buffer_load_dwordx4 v251, s[12:15], s62 offen offset:2048 lds
    s_add_u32 m0, s46, 0x17400
    v_mfma_f32_16x16x32_bf16 v[212:215], v[12:15], v[192:195], 0
    ds_read_b128 v[200:203], v244 offset:128
    v_sub_f32 v205, v205, v248
    v_mfma_f32_16x16x32_bf16 v[216:219], v[42:45], v[192:195], 0
    s_waitcnt lgkmcnt(6)
    v_exp_f32 v204, v204
    v_mfma_f32_16x16x32_bf16 v[220:223], v[72:75], v[192:195], 0
    s_waitcnt lgkmcnt(5)
    v_exp_f32 v205, v205
    v_mfma_f32_16x16x32_bf16 v[224:227], a[248:251], v[192:195], 0
    s_waitcnt lgkmcnt(3)
    s_waitcnt lgkmcnt(1)
    buffer_load_dwordx4 v252, s[12:15], s63 offen lds
    v_mfma_f32_16x16x32_bf16 v[228:231], a[64:67], a[216:219], v[228:231]
    v_sub_f32 v206, v206, v248
    v_sub_f32 v207, v207, v248
    v_mfma_f32_16x16x32_bf16 v[228:231], a[68:71], a[220:223], v[228:231]
    v_exp_f32 v206, v206
    v_exp_f32 v207, v207
    v_cvt_pk_bf16_f32 v183, v204, v205
    v_cvt_pk_bf16_f32 v186, v206, v207
    ds_read_b128 v[204:207], v245 offset:128
    buffer_load_dwordx4 v253, s[12:15], s63 offen offset:1024 lds
    s_waitcnt lgkmcnt(1)
    v_mfma_f32_16x16x32_bf16 v[200:203], v[144:147], v[168:171], v[200:203]
    v_sub_f32 v208, v208, v248
    v_sub_f32 v209, v209, v248
    v_mfma_f32_16x16x32_bf16 v[200:203], v[146:149], v[170:173], v[200:203]
    v_exp_f32 v208, v208
    v_exp_f32 v209, v209
    v_sub_f32 v210, v210, v248
    v_exp_f32 v210, v210
    buffer_load_dwordx4 v251, s[12:15], s63 offen offset:2048 lds
    v_sub_f32 v211, v211, v248
    v_exp_f32 v211, v211
    v_cvt_pk_bf16_f32 v184, v208, v209
    v_cvt_pk_bf16_f32 v187, v210, v211
    ds_read_b128 v[208:211], v246 offset:128
    v_sub_f32 v196, v196, v248
    v_exp_f32 v196, v196
    v_sub_f32 v197, v197, v248
    s_waitcnt lgkmcnt(1)
    v_mfma_f32_16x16x32_bf16 v[204:207], v[108:111], v[168:171], v[204:207]
    v_exp_f32 v197, v197
    v_mfma_f32_16x16x32_bf16 v[204:207], v[110:113], v[170:173], v[204:207]
    v_sub_f32 v198, v198, v248
    v_exp_f32 v198, v198
    v_sub_f32 v199, v199, v248
    v_exp_f32 v199, v199
    v_cvt_pk_bf16_f32 v182, v196, v197
    v_cvt_pk_bf16_f32 v185, v198, v199
    ds_read_b128 v[196:199], v244 offset:32
    v_mfma_f32_16x16x32_bf16 v[212:215], v[16:19], v[180:183], v[212:215]
    v_sub_f32 v200, v200, v248
    v_sub_f32 v201, v201, v248
    v_mfma_f32_16x16x32_bf16 v[216:219], v[46:49], v[180:183], v[216:219]
    v_exp_f32 v200, v200
    v_mfma_f32_16x16x32_bf16 v[220:223], v[76:79], v[180:183], v[220:223]
    s_waitcnt lgkmcnt(1)
    v_exp_f32 v201, v201
    v_mfma_f32_16x16x32_bf16 v[224:227], a[248:251], v[180:183], v[224:227]
    v_cvt_pk_bf16_f32 v189, v200, v201
    v_sub_f32 v204, v204, v248
    v_mfma_f32_16x16x32_bf16 v[212:215], v[20:23], v[184:187], v[212:215]
    ds_read_b128 v[200:203], v245 offset:32
    v_sub_f32 v205, v205, v248
    v_mfma_f32_16x16x32_bf16 v[216:219], v[50:53], v[184:187], v[216:219]
    v_exp_f32 v204, v204
    v_mfma_f32_16x16x32_bf16 v[220:223], v[80:83], v[184:187], v[220:223]
    v_exp_f32 v205, v205
    v_mfma_f32_16x16x32_bf16 v[224:227], a[248:251], v[184:187], v[224:227]
    v_cvt_pk_bf16_f32 v190, v204, v205
    s_waitcnt lgkmcnt(1)
    v_mfma_f32_16x16x32_bf16 v[208:211], v[120:123], v[168:171], v[208:211]
    ds_read_b128 v[204:207], v246 offset:32
    ds_read_b64 v[168:169], v247 offset:24576
    v_mfma_f32_16x16x32_bf16 v[208:211], v[122:125], v[170:173], v[208:211]
    ds_read_b64 v[170:171], v247 offset:24704
    ds_read_b64 v[172:173], v247 offset:24832
    v_mfma_f32_16x16x32_bf16 v[196:199], v[132:135], v[174:177], v[196:199]
    v_mfma_f32_16x16x32_bf16 v[196:199], v[134:137], v[176:179], v[196:199]
    s_nop 3
    s_waitcnt lgkmcnt(4)
    v_mfma_f32_16x16x32_bf16 v[200:203], v[102:105], v[174:177], v[200:203]
    v_sub_f32 v208, v208, v248
    v_sub_f32 v209, v209, v248
    v_mfma_f32_16x16x32_bf16 v[200:203], v[104:107], v[176:179], v[200:203]
    v_exp_f32 v208, v208
    v_exp_f32 v209, v209
    v_max_f32 v248, v196, v197
    v_cvt_pk_bf16_f32 v188, v208, v209
    ds_read_b128 v[208:211], v244 offset:96
    s_waitcnt lgkmcnt(4)
    v_mfma_f32_16x16x32_bf16 v[212:215], v[24:27], v[188:191], v[212:215]
    v_max3_f32 v248, v248, v198, v199
    v_max3_f32 v248, v248, v200, v201
    v_mfma_f32_16x16x32_bf16 v[216:219], v[54:57], v[188:191], v[216:219]
    ds_read_b128 v[196:199], v245 offset:96
    v_max3_f32 v248, v248, v202, v203
    v_mfma_f32_16x16x32_bf16 v[220:223], v[84:87], v[188:191], v[220:223]
    ds_read_b128 v[200:203], v246 offset:96
    v_mfma_f32_16x16x32_bf16 v[224:227], a[248:251], v[188:191], v[224:227]
    s_waitcnt lgkmcnt(3)
    v_mfma_f32_16x16x32_bf16 v[204:207], v[114:117], v[174:177], v[204:207]
    v_mfma_f32_16x16x32_bf16 v[204:207], v[116:119], v[176:179], v[204:207]
    s_nop 4
    v_rcp_f32 v225, v224
    s_nop 0
    v_mul_f32 v212, v212, v225
    s_waitcnt lgkmcnt(2)
    v_mfma_f32_16x16x32_bf16 v[208:211], v[144:147], v[174:177], v[208:211]
    v_mul_f32 v213, v213, v225
    v_mul_f32 v214, v214, v225
    v_mfma_f32_16x16x32_bf16 v[208:211], v[146:149], v[176:179], v[208:211]
    v_mul_f32 v215, v215, v225
    s_waitcnt lgkmcnt(1)
    v_mfma_f32_16x16x32_bf16 v[196:199], v[108:111], v[174:177], v[196:199]
    v_cvt_pk_bf16_f32 v212, v212, v213
    v_cvt_pk_bf16_f32 v213, v214, v215
    v_mfma_f32_16x16x32_bf16 v[196:199], v[110:113], v[176:179], v[196:199]
    s_waitcnt lgkmcnt(0)
    v_mul_f32 v216, v216, v225
    v_mul_f32 v217, v217, v225
    v_mfma_f32_16x16x32_bf16 v[200:203], v[120:123], v[174:177], v[200:203]
    ds_write_b64 v247, v[212:213] offset:18432
    v_mfma_f32_16x16x32_bf16 v[200:203], v[122:125], v[176:179], v[200:203]
    s_waitcnt vmcnt(3)
    ds_read_b64_tr_b16 a[160:161], v249 offset:0
    ds_read_b64_tr_b16 a[162:163], v250 offset:0
    ds_read_b64_tr_b16 a[184:185], v249 offset:32
    ds_read_b64_tr_b16 a[186:187], v250 offset:32
    ds_read_b64_tr_b16 a[208:209], v249 offset:64
    ds_read_b64_tr_b16 a[210:211], v250 offset:64
    v_mul_f32 v218, v218, v225
    v_mul_f32 v219, v219, v225
    v_cvt_pk_bf16_f32 v216, v216, v217
    v_cvt_pk_bf16_f32 v217, v218, v219
    ds_write_b64 v247, v[216:217] offset:18560
    v_mul_f32 v220, v220, v225
    v_mul_f32 v221, v221, v225
    v_mul_f32 v222, v222, v225
    v_mul_f32 v223, v223, v225
    v_cvt_pk_bf16_f32 v220, v220, v221
    v_cvt_pk_bf16_f32 v221, v222, v223
    ds_write_b64 v247, v[220:221] offset:18688
    v_max3_f32 v248, v248, v204, v205
    v_max3_f32 v248, v248, v206, v207
    ds_read_b128 v[204:207], v244 offset:32
    v_max3_f32 v248, v248, v208, v209
    v_max3_f32 v248, v248, v210, v211
    ds_read_b128 v[208:211], v245 offset:32
    v_max3_f32 v248, v248, v196, v197
    v_max3_f32 v248, v248, v198, v199
    ds_read_b128 v[196:199], v246 offset:32
    v_max3_f32 v248, v248, v200, v201
    s_waitcnt vmcnt(0)
    ds_read_b64_tr_b16 a[164:165], v249 offset:3072
    ds_read_b64_tr_b16 a[166:167], v250 offset:3072
    ds_read_b64_tr_b16 a[188:189], v249 offset:3104
    ds_read_b64_tr_b16 a[190:191], v250 offset:3104
    ds_read_b64_tr_b16 a[212:213], v249 offset:3136
    ds_read_b64_tr_b16 a[214:215], v250 offset:3136
    v_max3_f32 v248, v248, v202, v203
    ds_read_b128 v[200:203], v244 offset:96
    v_mov_b32 v225, v248
    s_nop 1
    s_waitcnt lgkmcnt(9)
    v_mfma_f32_16x16x32_bf16 v[204:207], v[132:135], v[174:177], v[204:207]
    v_cvt_pk_bf16_f32 v132, v232, v233
    v_cvt_pk_bf16_f32 v133, v234, v235
    v_mfma_f32_16x16x32_bf16 v[204:207], v[134:137], v[176:179], v[204:207]
    s_waitcnt lgkmcnt(8)
    v_cvt_pk_bf16_f32 v134, v236, v237
    v_cvt_pk_bf16_f32 v135, v238, v239
    v_mfma_f32_16x16x32_bf16 v[208:211], v[102:105], v[174:177], v[208:211]
    s_waitcnt lgkmcnt(7)
    v_cvt_pk_bf16_f32 v136, v228, v229
    v_cvt_pk_bf16_f32 v137, v230, v231
    v_mfma_f32_16x16x32_bf16 v[208:211], v[104:107], v[176:179], v[208:211]
    v_permlane16_swap_b32 v248, v225
    v_max_f32 v248, v248, v225
    v_mfma_f32_16x16x32_bf16 v[196:199], v[114:117], v[174:177], v[196:199]
    v_mov_b32 v225, v248
    v_mfma_f32_16x16x32_bf16 v[196:199], v[116:119], v[176:179], v[196:199]
    s_waitcnt lgkmcnt(5)
    v_permlane32_swap_b32 v248, v225
    s_waitcnt lgkmcnt(1)
    v_mfma_f32_16x16x32_bf16 v[232:235], a[232:235], a[72:75], 0
    s_barrier
    v_mfma_f32_16x16x32_bf16 v[232:235], a[236:239], a[76:79], v[232:235]
    s_waitcnt lgkmcnt(0)
    v_max_f32 v248, v248, v225
    v_sub_f32 v204, v204, v248
    v_mfma_f32_16x16x32_bf16 v[200:203], v[144:147], v[174:177], v[200:203]
    v_exp_f32 v204, v204
    v_mfma_f32_16x16x32_bf16 v[200:203], v[146:149], v[176:179], v[200:203]
    v_sub_f32 v205, v205, v248
    v_sub_f32 v206, v206, v248
    v_mfma_f32_16x16x32_bf16 v[232:235], a[240:243], a[80:83], v[232:235]
    v_exp_f32 v205, v205
    v_mfma_f32_16x16x32_bf16 v[232:235], a[244:247], a[84:87], v[232:235]
    v_exp_f32 v206, v206
    v_mfma_f32_16x16x32_bf16 v[232:235], a[216:219], a[88:91], v[232:235]
    v_sub_f32 v207, v207, v248
    v_cvt_pk_bf16_f32 v193, v204, v205
    v_mfma_f32_16x16x32_bf16 v[232:235], a[220:223], a[92:95], v[232:235]
    v_exp_f32 v207, v207
    v_mfma_f32_16x16x32_bf16 v[236:239], a[232:235], a[96:99], 0
    v_cvt_pk_bf16_f32 v180, v206, v207
    v_sub_f32 v208, v208, v248
    v_mfma_f32_16x16x32_bf16 v[236:239], a[236:239], a[100:103], v[236:239]
    ds_read_b128 v[204:207], v245 offset:96
    v_sub_f32 v209, v209, v248
    v_mfma_f32_16x16x32_bf16 v[236:239], a[240:243], a[104:107], v[236:239]
    v_cvt_pk_bf16_f32 v1, v232, v233
    v_cvt_pk_bf16_f32 v4, v234, v235
    v_mfma_f32_16x16x32_bf16 v[236:239], a[244:247], a[108:111], v[236:239]
    v_exp_f32 v208, v208
    v_mfma_f32_16x16x32_bf16 v[236:239], a[216:219], a[112:115], v[236:239]
    v_exp_f32 v209, v209
    v_mfma_f32_16x16x32_bf16 v[236:239], a[220:223], a[116:119], v[236:239]
    v_sub_f32 v210, v210, v248
    v_sub_f32 v211, v211, v248
    v_mfma_f32_16x16x32_bf16 v[228:231], a[232:235], a[120:123], 0
    ds_read_b128 a[232:235], v240 offset:3200
    v_cvt_pk_bf16_f32 v194, v208, v209
    v_mfma_f32_16x16x32_bf16 v[228:231], a[236:239], a[124:127], v[228:231]
    ds_read_b128 a[236:239], v241 offset:3200
    v_sub_f32 v196, v196, v248
    v_mfma_f32_16x16x32_bf16 v[228:231], a[240:243], a[128:131], v[228:231]
    v_cvt_pk_bf16_f32 v31, v236, v237
    v_cvt_pk_bf16_f32 v34, v238, v239
    v_mfma_f32_16x16x32_bf16 v[228:231], a[244:247], a[132:135], v[228:231]
    ds_read_b128 a[240:243], v240 offset:3328
    ds_read_b128 a[244:247], v241 offset:3328
    v_mfma_f32_16x16x32_bf16 v[228:231], a[216:219], a[136:139], v[228:231]
    ds_read_b128 a[216:219], v240 offset:4608
    v_sub_f32 v197, v197, v248
    v_mfma_f32_16x16x32_bf16 v[228:231], a[220:223], a[140:143], v[228:231]
    ds_read_b128 a[220:223], v241 offset:4608
    v_sub_f32 v198, v198, v248
    v_mfma_f32_16x16x32_bf16 v[232:235], a[0:3], a[224:227], 0
    s_waitcnt lgkmcnt(6)
    v_exp_f32 v210, v210
    v_mfma_f32_16x16x32_bf16 v[204:207], v[108:111], v[174:177], v[204:207]
    v_exp_f32 v211, v211
    v_mfma_f32_16x16x32_bf16 v[204:207], v[110:113], v[176:179], v[204:207]
    v_cvt_pk_bf16_f32 v61, v228, v229
    v_cvt_pk_bf16_f32 v64, v230, v231
    v_mfma_f32_16x16x32_bf16 v[232:235], a[4:7], a[228:231], v[232:235]
    s_waitcnt lgkmcnt(5)
    v_cvt_pk_bf16_f32 v181, v210, v211
    v_sub_f32 v199, v199, v248
    v_mfma_f32_16x16x32_bf16 v[232:235], a[8:11], a[232:235], v[232:235]
    ds_read_b128 v[208:211], v246 offset:96
    v_sub_f32 v200, v200, v248
    v_mfma_f32_16x16x32_bf16 v[236:239], a[24:27], a[224:227], 0
    s_waitcnt lgkmcnt(5)
    v_exp_f32 v196, v196
    v_mfma_f32_16x16x32_bf16 v[232:235], a[12:15], a[236:239], v[232:235]
    s_waitcnt lgkmcnt(4)
    v_exp_f32 v197, v197
    v_mfma_f32_16x16x32_bf16 v[232:235], a[16:19], a[240:243], v[232:235]
    s_waitcnt lgkmcnt(3)
    v_exp_f32 v198, v198
    v_mfma_f32_16x16x32_bf16 v[232:235], a[20:23], a[244:247], v[232:235]
    v_exp_f32 v199, v199
    v_mfma_f32_16x16x32_bf16 v[236:239], a[28:31], a[228:231], v[236:239]
    s_waitcnt lgkmcnt(2)
    v_cvt_pk_bf16_f32 v192, v196, v197
    v_cvt_pk_bf16_f32 v195, v198, v199
    v_mfma_f32_16x16x32_bf16 v[236:239], a[32:35], a[232:235], v[236:239]
    ds_read_b128 v[196:199], v244 offset:192
    v_sub_f32 v201, v201, v248
    v_mfma_f32_16x16x32_bf16 v[212:215], v[18:21], v[192:195], 0
    s_waitcnt lgkmcnt(2)
    v_cvt_pk_bf16_f32 v144, v232, v233
    v_cvt_pk_bf16_f32 v145, v234, v235
    v_mfma_f32_16x16x32_bf16 v[216:219], v[48:51], v[192:195], 0
    v_exp_f32 v200, v200
    v_mfma_f32_16x16x32_bf16 v[220:223], v[78:81], v[192:195], 0
    s_waitcnt lgkmcnt(1)
    v_exp_f32 v201, v201
    v_mfma_f32_16x16x32_bf16 v[224:227], a[248:251], v[192:195], 0
    v_sub_f32 v202, v202, v248
    v_sub_f32 v203, v203, v248
    v_mfma_f32_16x16x32_bf16 v[208:211], v[120:123], v[174:177], v[208:211]
    ds_read_b64 v[174:175], v247 offset:30720
    v_cvt_pk_bf16_f32 v183, v200, v201
    v_mfma_f32_16x16x32_bf16 v[208:211], v[122:125], v[176:179], v[208:211]
    ds_read_b64 v[176:177], v247 offset:30848
    ds_read_b64 v[178:179], v247 offset:30976
    v_mfma_f32_16x16x32_bf16 v[236:239], a[36:39], a[236:239], v[236:239]
    v_exp_f32 v202, v202
    v_mfma_f32_16x16x32_bf16 v[236:239], a[40:43], a[240:243], v[236:239]
    s_waitcnt lgkmcnt(3)
    v_exp_f32 v203, v203
    v_mfma_f32_16x16x32_bf16 v[196:199], v[150:153], v[168:171], v[196:199]
    v_cvt_pk_bf16_f32 v186, v202, v203
    v_sub_f32 v204, v204, v248
    v_mfma_f32_16x16x32_bf16 v[196:199], v[152:155], v[170:173], v[196:199]
    ds_read_b128 v[200:203], v245 offset:192
    v_sub_f32 v205, v205, v248
    v_mfma_f32_16x16x32_bf16 v[236:239], a[44:47], a[244:247], v[236:239]
    v_exp_f32 v204, v204
    v_mfma_f32_16x16x32_bf16 v[228:231], a[48:51], a[224:227], 0
    v_exp_f32 v205, v205
    v_mfma_f32_16x16x32_bf16 v[228:231], a[52:55], a[228:231], v[228:231]
    v_sub_f32 v206, v206, v248
    v_sub_f32 v207, v207, v248
    v_mfma_f32_16x16x32_bf16 v[228:231], a[56:59], a[232:235], v[228:231]
    v_exp_f32 v206, v206
    v_mfma_f32_16x16x32_bf16 v[228:231], a[60:63], a[236:239], v[228:231]
    s_waitcnt lgkmcnt(3)
    v_cvt_pk_bf16_f32 v146, v236, v237
    v_cvt_pk_bf16_f32 v147, v238, v239
    v_mfma_f32_16x16x32_bf16 v[228:231], a[64:67], a[240:243], v[228:231]
    s_waitcnt lgkmcnt(1)
    v_exp_f32 v207, v207
    v_mfma_f32_16x16x32_bf16 v[228:231], a[68:71], a[244:247], v[228:231]
    v_cvt_pk_bf16_f32 v184, v204, v205
    v_cvt_pk_bf16_f32 v187, v206, v207
    v_mfma_f32_16x16x32_bf16 v[232:235], a[224:227], a[72:75], 0
    ds_read_b128 v[204:207], v246 offset:192
    v_sub_f32 v208, v208, v248
    v_mfma_f32_16x16x32_bf16 v[232:235], a[228:231], a[76:79], v[232:235]
    s_waitcnt lgkmcnt(1)
    v_exp_f32 v208, v208
    v_mfma_f32_16x16x32_bf16 v[200:203], v[96:99], v[168:171], v[200:203]
    v_cvt_pk_bf16_f32 v148, v228, v229
    v_cvt_pk_bf16_f32 v149, v230, v231
    v_mfma_f32_16x16x32_bf16 v[200:203], v[98:101], v[170:173], v[200:203]
    v_sub_f32 v209, v209, v248
    v_sub_f32 v210, v210, v248
    v_mfma_f32_16x16x32_bf16 v[232:235], a[232:235], a[80:83], v[232:235]
    v_exp_f32 v209, v209
    v_mfma_f32_16x16x32_bf16 v[232:235], a[236:239], a[84:87], v[232:235]
    v_exp_f32 v210, v210
    v_mfma_f32_16x16x32_bf16 v[232:235], a[240:243], a[88:91], v[232:235]
    v_sub_f32 v211, v211, v248
    v_cvt_pk_bf16_f32 v182, v208, v209
    v_mfma_f32_16x16x32_bf16 v[232:235], a[244:247], a[92:95], v[232:235]
    v_exp_f32 v211, v211
    v_mfma_f32_16x16x32_bf16 v[212:215], v[22:25], v[180:183], v[212:215]
    v_cvt_pk_bf16_f32 v185, v210, v211
    v_max_f32 v248, v196, v197
    v_mfma_f32_16x16x32_bf16 v[216:219], v[52:55], v[180:183], v[216:219]
    ds_read_b128 v[208:211], v244 offset:256
    v_max3_f32 v248, v248, v198, v199
    v_mfma_f32_16x16x32_bf16 v[220:223], v[82:85], v[180:183], v[220:223]
    s_waitcnt lgkmcnt(1)
    v_cvt_pk_bf16_f32 v13, v232, v233
    v_cvt_pk_bf16_f32 v16, v234, v235
    v_mfma_f32_16x16x32_bf16 v[224:227], a[248:251], v[180:183], v[224:227]
    ds_read_b128 v[196:199], v245 offset:256
    v_max3_f32 v248, v248, v200, v201
    v_mfma_f32_16x16x32_bf16 v[212:215], v[26:29], v[184:187], v[212:215]
    v_max3_f32 v248, v248, v202, v203
    v_mfma_f32_16x16x32_bf16 v[216:219], v[56:59], v[184:187], v[216:219]
    ds_read_b128 v[200:203], v246 offset:256
    v_mfma_f32_16x16x32_bf16 v[220:223], v[86:89], v[184:187], v[220:223]
    v_mfma_f32_16x16x32_bf16 v[224:227], a[248:251], v[184:187], v[224:227]
    v_mov_b32 v187, 0
    v_mfma_f32_16x16x32_bf16 v[204:207], v[132:135], v[168:171], v[204:207]
    v_mfma_f32_16x16x32_bf16 v[204:207], v[134:137], v[170:173], v[204:207]
    v_mfma_f32_16x16x32_bf16 v[236:239], a[224:227], a[96:99], 0
    s_waitcnt lgkmcnt(2)
    v_mfma_f32_16x16x32_bf16 v[208:211], v[156:159], v[168:171], v[208:211]
    v_mfma_f32_16x16x32_bf16 v[208:211], v[158:161], v[170:173], v[208:211]
    s_waitcnt lgkmcnt(1)
    v_rcp_f32 v225, v224
    v_mfma_f32_16x16x32_bf16 v[196:199], v[90:93], v[168:171], v[196:199]
    v_mov_b32 v226, 0x22e00
    v_cndmask_b32 v226, v226, v247, vcc
    v_mfma_f32_16x16x32_bf16 v[196:199], v[92:95], v[170:173], v[196:199]
    s_mov_b32 vcc_lo, 0xff00fff0
    v_mul_f32 v212, v212, v225
    v_mul_f32 v213, v213, v225
    v_mfma_f32_16x16x32_bf16 v[236:239], a[228:231], a[100:103], v[236:239]
    s_mov_b32 vcc_hi, 0xf000
    v_mul_f32 v214, v214, v225
    v_mul_f32 v215, v215, v225
    v_mfma_f32_16x16x32_bf16 v[236:239], a[232:235], a[104:107], v[236:239]
    s_waitcnt lgkmcnt(0)
    v_cvt_pk_bf16_f32 v212, v212, v213
    v_cvt_pk_bf16_f32 v213, v214, v215
    v_mfma_f32_16x16x32_bf16 v[200:203], v[126:129], v[168:171], v[200:203]
    ds_write_b64 v226, v[212:213] offset:0
    v_mfma_f32_16x16x32_bf16 v[200:203], v[128:131], v[170:173], v[200:203]
    v_mul_f32 v216, v216, v225
    v_mul_f32 v217, v217, v225
    v_mfma_f32_16x16x32_bf16 v[236:239], a[236:239], a[108:111], v[236:239]
    v_mul_f32 v218, v218, v225
    v_mul_f32 v219, v219, v225
    v_mfma_f32_16x16x32_bf16 v[236:239], a[240:243], a[112:115], v[236:239]
    v_cvt_pk_bf16_f32 v216, v216, v217
    v_cvt_pk_bf16_f32 v217, v218, v219
    v_mfma_f32_16x16x32_bf16 v[236:239], a[244:247], a[116:119], v[236:239]
    ds_write_b64 v226, v[216:217] offset:128
    v_mfma_f32_16x16x32_bf16 v[228:231], a[224:227], a[120:123], 0
    ds_read_b128 a[224:227], v240 offset:4736
    v_mul_f32 v220, v220, v225
    v_mfma_f32_16x16x32_bf16 v[228:231], a[228:231], a[124:127], v[228:231]
    ds_read_b128 a[228:231], v241 offset:4736
    v_mul_f32 v221, v221, v225
    v_mfma_f32_16x16x32_bf16 v[228:231], a[232:235], a[128:131], v[228:231]
    v_cvt_pk_bf16_f32 v43, v236, v237
    v_cvt_pk_bf16_f32 v46, v238, v239
    v_mfma_f32_16x16x32_bf16 v[228:231], a[236:239], a[132:135], v[228:231]
    ds_read_b128 a[232:235], v240 offset:4864
    ds_read_b128 a[236:239], v241 offset:4864
    v_mfma_f32_16x16x32_bf16 v[228:231], a[240:243], a[136:139], v[228:231]
    v_mul_f32 v222, v222, v225
    v_mul_f32 v223, v223, v225
    v_mfma_f32_16x16x32_bf16 v[228:231], a[244:247], a[140:143], v[228:231]
    v_cvt_pk_bf16_f32 v220, v220, v221
    v_cvt_pk_bf16_f32 v221, v222, v223
    v_mfma_f32_16x16x32_bf16 v[232:235], a[0:3], a[216:219], 0
    ds_write_b64 v226, v[220:221] offset:256
    v_mfma_f32_16x16x32_bf16 v[232:235], a[4:7], a[220:223], v[232:235]
    v_max3_f32 v248, v248, v204, v205
    v_max3_f32 v248, v248, v206, v207
    v_mfma_f32_16x16x32_bf16 v[236:239], a[24:27], a[216:219], 0
    s_waitcnt lgkmcnt(4)
    v_cvt_pk_bf16_f32 v73, v228, v229
    v_cvt_pk_bf16_f32 v76, v230, v231
    v_mfma_f32_16x16x32_bf16 v[232:235], a[8:11], a[224:227], v[232:235]
    ds_read_b128 v[204:207], v244 offset:320
    v_max3_f32 v248, v248, v208, v209
    v_mfma_f32_16x16x32_bf16 v[236:239], a[28:31], a[220:223], v[236:239]
    s_waitcnt lgkmcnt(4)
    v_max3_f32 v248, v248, v210, v211
    v_max3_f32 v248, v248, v196, v197
    v_mfma_f32_16x16x32_bf16 v[232:235], a[12:15], a[228:231], v[232:235]
    ds_read_b128 v[208:211], v245 offset:320
    v_max3_f32 v248, v248, v198, v199
    v_mfma_f32_16x16x32_bf16 v[236:239], a[32:35], a[224:227], v[236:239]
    ds_read_b128 v[196:199], v246 offset:320
    v_max3_f32 v248, v248, v200, v201
    v_mfma_f32_16x16x32_bf16 v[236:239], a[36:39], a[228:231], v[236:239]
    s_waitcnt lgkmcnt(5)
    v_max3_f32 v248, v248, v202, v203
    v_mfma_f32_16x16x32_bf16 v[232:235], a[16:19], a[232:235], v[232:235]
    ds_read_b128 v[200:203], v244 offset:192
    s_waitcnt lgkmcnt(5)
    v_mfma_f32_16x16x32_bf16 v[232:235], a[20:23], a[236:239], v[232:235]
    v_mfma_f32_16x16x32_bf16 v[236:239], a[40:43], a[232:235], v[236:239]
    v_mfma_f32_16x16x32_bf16 v[236:239], a[44:47], a[236:239], v[236:239]
    v_mfma_f32_16x16x32_bf16 v[228:231], a[48:51], a[216:219], 0
    s_waitcnt lgkmcnt(3)
    v_mfma_f32_16x16x32_bf16 v[204:207], v[162:165], v[168:171], v[204:207]
    v_mfma_f32_16x16x32_bf16 v[204:207], v[164:167], v[170:173], v[204:207]
    s_waitcnt lgkmcnt(2)
    s_waitcnt lgkmcnt(1)
    v_mfma_f32_16x16x32_bf16 v[208:211], v[138:141], v[168:171], v[208:211]
    v_mfma_f32_16x16x32_bf16 v[208:211], v[140:143], v[170:173], v[208:211]
    v_mfma_f32_16x16x32_bf16 v[196:199], v[144:147], v[168:171], v[196:199]
    s_waitcnt lgkmcnt(0)
    v_mfma_f32_16x16x32_bf16 v[196:199], v[146:149], v[170:173], v[196:199]
    v_mfma_f32_16x16x32_bf16 v[200:203], v[150:153], v[168:171], v[200:203]
    v_cvt_pk_bf16_f32 v150, v232, v233
    v_cvt_pk_bf16_f32 v151, v234, v235
    v_mfma_f32_16x16x32_bf16 v[200:203], v[152:155], v[170:173], v[200:203]
    v_cvt_pk_bf16_f32 v152, v236, v237
    v_cvt_pk_bf16_f32 v153, v238, v239
    v_mfma_f32_16x16x32_bf16 v[228:231], a[52:55], a[220:223], v[228:231]
    v_max3_f32 v248, v248, v204, v205
    v_max3_f32 v248, v248, v208, v209
    v_mfma_f32_16x16x32_bf16 v[228:231], a[56:59], a[224:227], v[228:231]
    ds_read_b128 v[204:207], v245 offset:192
    ds_read_b128 v[208:211], v246 offset:192
    v_mfma_f32_16x16x32_bf16 v[228:231], a[60:63], a[228:231], v[228:231]
    v_max3_f32 v248, v248, v196, v197
    v_mov_b32 v225, v248
    v_mfma_f32_16x16x32_bf16 v[228:231], a[64:67], a[232:235], v[228:231]
    ds_read_b128 v[196:199], v244 offset:256
    v_permlane16_swap_b32 v248, v225
    v_mfma_f32_16x16x32_bf16 v[228:231], a[68:71], a[236:239], v[228:231]
    v_max_f32 v248, v248, v225
    v_mov_b32 v225, v248
    v_mfma_f32_16x16x32_bf16 v[232:235], a[216:219], a[72:75], 0
    v_mfma_f32_16x16x32_bf16 v[232:235], a[220:223], a[76:79], v[232:235]
    v_permlane32_swap_b32 v248, v225
    v_max_f32 v248, v248, v225
    v_mfma_f32_16x16x32_bf16 v[232:235], a[224:227], a[80:83], v[232:235]
    v_sub_f32 v200, v200, v248
    v_cvt_pk_bf16_f32 v154, v228, v229
    v_mfma_f32_16x16x32_bf16 v[232:235], a[228:231], a[84:87], v[232:235]
    v_cvt_pk_bf16_f32 v155, v230, v231
    v_sub_f32 v201, v201, v248
    v_mfma_f32_16x16x32_bf16 v[232:235], a[232:235], a[88:91], v[232:235]
    s_waitcnt lgkmcnt(2)
    v_exp_f32 v200, v200
    v_mfma_f32_16x16x32_bf16 v[204:207], v[96:99], v[168:171], v[204:207]
    s_waitcnt lgkmcnt(1)
    v_exp_f32 v201, v201
    v_mfma_f32_16x16x32_bf16 v[204:207], v[98:101], v[170:173], v[204:207]
    v_sub_f32 v202, v202, v248
    v_sub_f32 v203, v203, v248
    v_mfma_f32_16x16x32_bf16 v[208:211], v[132:135], v[168:171], v[208:211]
    s_waitcnt lgkmcnt(0)
    v_exp_f32 v202, v202
    v_mfma_f32_16x16x32_bf16 v[208:211], v[134:137], v[170:173], v[208:211]
    v_exp_f32 v203, v203
    v_mfma_f32_16x16x32_bf16 v[196:199], v[156:159], v[168:171], v[196:199]
    v_cvt_pk_bf16_f32 v190, v200, v201
    v_cvt_pk_bf16_f32 v193, v202, v203
    v_mfma_f32_16x16x32_bf16 v[196:199], v[158:161], v[170:173], v[196:199]
    ds_read_b128 v[200:203], v245 offset:256
    v_sub_f32 v204, v204, v248
    v_mfma_f32_16x16x32_bf16 v[232:235], a[236:239], a[92:95], v[232:235]
    v_exp_f32 v204, v204
    v_mfma_f32_16x16x32_bf16 v[236:239], a[216:219], a[96:99], 0
    v_sub_f32 v205, v205, v248
    v_sub_f32 v206, v206, v248
    v_mfma_f32_16x16x32_bf16 v[236:239], a[220:223], a[100:103], v[236:239]
    v_exp_f32 v205, v205
    v_mfma_f32_16x16x32_bf16 v[236:239], a[224:227], a[104:107], v[236:239]
    v_exp_f32 v206, v206
    v_mfma_f32_16x16x32_bf16 v[236:239], a[228:231], a[108:111], v[236:239]
    v_cvt_pk_bf16_f32 v19, v232, v233
    v_cvt_pk_bf16_f32 v22, v234, v235
    v_mfma_f32_16x16x32_bf16 v[236:239], a[232:235], a[112:115], v[236:239]
    v_mbcnt_lo_u32_b32 v232, -1, 0
    v_mbcnt_hi_u32_b32 v232, -1, v232
    v_mfma_f32_16x16x32_bf16 v[236:239], a[236:239], a[116:119], v[236:239]
    v_and_b32 v233, 15, v232
    v_lshrrev_b32 v232, 4, v232
    v_mfma_f32_16x16x32_bf16 v[228:231], a[216:219], a[120:123], 0
    v_lshrrev_b32 v234, 1, v233
    v_mul_u32_u24 v235, 0x180, v233
    v_mfma_f32_16x16x32_bf16 v[228:231], a[220:223], a[124:127], v[228:231]
    s_waitcnt lgkmcnt(0)
    v_xor_b32 v243, v232, v234
    v_cvt_pk_bf16_f32 v49, v236, v237
    v_mfma_f32_16x16x32_bf16 v[200:203], v[90:93], v[168:171], v[200:203]
    v_cvt_pk_bf16_f32 v52, v238, v239
    v_lshl_add_u32 v242, v243, 4, v235
    v_mfma_f32_16x16x32_bf16 v[200:203], v[92:95], v[170:173], v[200:203]
    v_xor_b32 v243, 64, v242
    v_add_u32 v242, 0x1e000, v242
    v_mfma_f32_16x16x32_bf16 v[228:231], a[224:227], a[128:131], v[228:231]
    ds_read_b128 a[240:243], v242 offset:0
    v_add_u32 v243, 0x1e000, v243
    v_mfma_f32_16x16x32_bf16 v[228:231], a[228:231], a[132:135], v[228:231]
    ds_read_b128 a[244:247], v243 offset:0
    ds_read_b128 a[216:219], v242 offset:128
    v_mfma_f32_16x16x32_bf16 v[228:231], a[232:235], a[136:139], v[228:231]
    ds_read_b128 a[220:223], v243 offset:128
    ds_read_b128 a[224:227], v242 offset:256
    v_mfma_f32_16x16x32_bf16 v[228:231], a[236:239], a[140:143], v[228:231]
    ds_read_b128 a[228:231], v243 offset:256
    ds_read_b128 a[232:235], v242 offset:12288
    ds_read_b128 a[236:239], v243 offset:12288
    v_lshrrev_b32 v249, 1, v232
    v_or_b32 v249, s66, v249
    v_mov_b32 v253, v249
    v_xor_b32 v249, v249, v234
    v_lshl_add_u32 v249, v249, 4, v235
    v_cvt_pk_bf16_f32 v79, v228, v229
    v_cvt_pk_bf16_f32 v82, v230, v231
    v_and_b32 v235, 1, v232
    v_lshl_add_u32 v249, v235, 3, v249
    v_add_u32 v249, 0x16800, v249
    v_xor_b32 v250, s67, v232
    v_mul_u32_u24 v250, 0x300, v250
    s_mul_i32 s67, s28, 0x600
    s_add_u32 s67, s67, 0x16800
    v_mul_u32_u24 v232, 0x180, v232
    v_add_u32 v232, s67, v232
    v_lshlrev_b32 v235, 3, v235
    v_xor_b32 v252, v233, v235
    v_xor_b32 v252, v252, v253
    v_lshl_add_u32 v252, v252, 4, v232
    v_xor_b32 v253, v253, v234
    v_lshl_add_u32 v253, v253, 4, v232
    v_and_b32 v234, 1, v233
    v_lshl_add_u32 v253, v234, 3, v253
    v_lshl_add_u32 v251, v233, 3, v250
    v_xor_b32 v233, v233, v235
    v_lshl_add_u32 v250, v233, 4, v250
    v_sub_f32 v207, v207, v248
    v_exp_f32 v207, v207
    v_cvt_pk_bf16_f32 v188, v204, v205
    v_cvt_pk_bf16_f32 v191, v206, v207
    ds_read_b128 v[204:207], v246 offset:256
    v_sub_f32 v208, v208, v248
    v_exp_f32 v208, v208
    v_sub_f32 v209, v209, v248
    v_exp_f32 v209, v209
    v_sub_f32 v210, v210, v248
    v_exp_f32 v210, v210
    v_sub_f32 v211, v211, v248
    v_exp_f32 v211, v211
    v_cvt_pk_bf16_f32 v189, v208, v209
    v_cvt_pk_bf16_f32 v192, v210, v211
    ds_read_b128 v[208:211], v244 offset:320
    v_mfma_f32_16x16x32_bf16 v[212:215], v[0:3], v[188:191], 0
    s_waitcnt lgkmcnt(2)
    v_sub_f32 v196, v196, v248
    v_sub_f32 v197, v197, v248
    v_mfma_f32_16x16x32_bf16 v[216:219], v[30:33], v[188:191], 0
    v_exp_f32 v196, v196
    v_mfma_f32_16x16x32_bf16 v[220:223], v[60:63], v[188:191], 0
    v_exp_f32 v197, v197
    v_mfma_f32_16x16x32_bf16 v[224:227], a[248:251], v[188:191], 0
    v_sub_f32 v198, v198, v248
    s_waitcnt lgkmcnt(1)
    v_mfma_f32_16x16x32_bf16 v[204:207], v[126:129], v[168:171], v[204:207]
    v_exp_f32 v198, v198
    v_mfma_f32_16x16x32_bf16 v[204:207], v[128:131], v[170:173], v[204:207]
    v_sub_f32 v199, v199, v248
    v_exp_f32 v199, v199
    v_cvt_pk_bf16_f32 v180, v196, v197
    v_cvt_pk_bf16_f32 v183, v198, v199
    ds_read_b128 v[196:199], v245 offset:320
    v_sub_f32 v200, v200, v248
    s_waitcnt lgkmcnt(1)
    v_mfma_f32_16x16x32_bf16 v[208:211], v[162:165], v[168:171], v[208:211]
    v_exp_f32 v200, v200
    v_mfma_f32_16x16x32_bf16 v[208:211], v[164:167], v[170:173], v[208:211]
    v_sub_f32 v201, v201, v248
    v_exp_f32 v201, v201
    v_sub_f32 v202, v202, v248
    v_exp_f32 v202, v202
    v_sub_f32 v203, v203, v248
    v_exp_f32 v203, v203
    v_cvt_pk_bf16_f32 v194, v200, v201
    v_cvt_pk_bf16_f32 v181, v202, v203
    ds_read_b128 v[200:203], v246 offset:320
    v_sub_f32 v204, v204, v248
    v_exp_f32 v204, v204
    v_sub_f32 v205, v205, v248
    v_exp_f32 v205, v205
    v_sub_f32 v206, v206, v248
    v_exp_f32 v206, v206
    s_waitcnt lgkmcnt(1)
    v_mfma_f32_16x16x32_bf16 v[196:199], v[138:141], v[168:171], v[196:199]
    v_sub_f32 v207, v207, v248
    v_cvt_pk_bf16_f32 v195, v204, v205
    v_mfma_f32_16x16x32_bf16 v[196:199], v[140:143], v[170:173], v[196:199]
    v_exp_f32 v207, v207
    v_mfma_f32_16x16x32_bf16 v[212:215], v[4:7], v[192:195], v[212:215]
    v_cvt_pk_bf16_f32 v182, v206, v207
    v_sub_f32 v208, v208, v248
    v_mfma_f32_16x16x32_bf16 v[216:219], v[34:37], v[192:195], v[216:219]
    ds_read_b128 v[204:207], v244 offset:0
    v_sub_f32 v209, v209, v248
    v_mfma_f32_16x16x32_bf16 v[220:223], v[64:67], v[192:195], v[220:223]
    v_exp_f32 v208, v208
    v_mfma_f32_16x16x32_bf16 v[224:227], a[248:251], v[192:195], v[224:227]
    s_waitcnt lgkmcnt(1)
    v_exp_f32 v209, v209
    v_mfma_f32_16x16x32_bf16 v[212:215], v[8:11], v[180:183], v[212:215]
    v_cvt_pk_bf16_f32 v186, v208, v209
    v_sub_f32 v196, v196, v248
    v_mfma_f32_16x16x32_bf16 v[216:219], v[38:41], v[180:183], v[216:219]
    ds_read_b128 v[208:211], v245 offset:0
    v_sub_f32 v197, v197, v248
    v_mfma_f32_16x16x32_bf16 v[220:223], v[68:71], v[180:183], v[220:223]
    v_exp_f32 v196, v196
    v_mfma_f32_16x16x32_bf16 v[224:227], a[248:251], v[180:183], v[224:227]
    v_exp_f32 v197, v197
    v_mfma_f32_16x16x32_bf16 v[200:203], v[144:147], v[168:171], v[200:203]
    ds_read_b64 v[168:169], v247 offset:36864
    v_cvt_pk_bf16_f32 v184, v196, v197
    v_mfma_f32_16x16x32_bf16 v[200:203], v[146:149], v[170:173], v[200:203]
    ds_read_b128 v[196:199], v246 offset:0
    s_waitcnt lgkmcnt(3)
    v_mfma_f32_16x16x32_bf16 v[204:207], v[156:159], v[174:177], v[204:207]
    ds_read_b64 v[170:171], v247 offset:36992
    ds_read_b64 v[172:173], v247 offset:37120
    v_mfma_f32_16x16x32_bf16 v[204:207], v[158:161], v[176:179], v[204:207]
    s_nop 1
    v_sub_f32 v200, v200, v248
    v_exp_f32 v200, v200
    v_sub_f32 v201, v201, v248
    v_exp_f32 v201, v201
    s_waitcnt lgkmcnt(4)
    v_mfma_f32_16x16x32_bf16 v[208:211], v[90:93], v[174:177], v[208:211]
    v_cvt_pk_bf16_f32 v185, v200, v201
    v_max_f32 v248, v204, v205
    v_mfma_f32_16x16x32_bf16 v[208:211], v[92:95], v[176:179], v[208:211]
    ds_read_b128 v[200:203], v244 offset:64
    v_max3_f32 v248, v248, v206, v207
    v_mfma_f32_16x16x32_bf16 v[212:215], v[12:15], v[184:187], v[212:215]
    ds_read_b128 v[204:207], v245 offset:64
    v_mfma_f32_16x16x32_bf16 v[216:219], v[42:45], v[184:187], v[216:219]
    v_mfma_f32_16x16x32_bf16 v[220:223], v[72:75], v[184:187], v[220:223]
    s_waitcnt lgkmcnt(4)
    v_mfma_f32_16x16x32_bf16 v[224:227], a[248:251], v[184:187], v[224:227]
    v_max3_f32 v248, v248, v208, v209
    v_max3_f32 v248, v248, v210, v211
    v_mfma_f32_16x16x32_bf16 v[196:199], v[126:129], v[174:177], v[196:199]
    ds_read_b128 v[208:211], v246 offset:64
    v_mfma_f32_16x16x32_bf16 v[196:199], v[128:131], v[176:179], v[196:199]
    s_nop 2
    v_rcp_f32 v225, v224
    s_nop 0
    v_mul_f32 v212, v212, v225
    v_mul_f32 v213, v213, v225
    v_mul_f32 v214, v214, v225
    s_waitcnt lgkmcnt(2)
    v_mfma_f32_16x16x32_bf16 v[200:203], v[162:165], v[174:177], v[200:203]
    v_mul_f32 v215, v215, v225
    v_cvt_pk_bf16_f32 v212, v212, v213
    v_mfma_f32_16x16x32_bf16 v[200:203], v[164:167], v[176:179], v[200:203]
    s_waitcnt lgkmcnt(1)
    v_cvt_pk_bf16_f32 v213, v214, v215
    v_mul_f32 v216, v216, v225
    v_mfma_f32_16x16x32_bf16 v[204:207], v[138:141], v[174:177], v[204:207]
    ds_write_b64 v247, v[212:213] offset:24576
    v_mfma_f32_16x16x32_bf16 v[204:207], v[140:143], v[176:179], v[204:207]
    v_mul_f32 v217, v217, v225
    v_mul_f32 v218, v218, v225
    v_mfma_f32_16x16x32_bf16 v[236:239], a[144:147], a[240:243], 0
    v_mul_f32 v219, v219, v225
    v_cvt_pk_bf16_f32 v216, v216, v217
    v_mfma_f32_16x16x32_bf16 v[236:239], a[148:151], a[244:247], v[236:239]
    s_waitcnt lgkmcnt(1)
    v_cvt_pk_bf16_f32 v217, v218, v219
    v_mul_f32 v220, v220, v225
    v_mfma_f32_16x16x32_bf16 v[208:211], v[144:147], v[174:177], v[208:211]
    ds_write_b64 v247, v[216:217] offset:24704
    v_mfma_f32_16x16x32_bf16 v[208:211], v[146:149], v[176:179], v[208:211]
    v_mul_f32 v221, v221, v225
    v_mul_f32 v222, v222, v225
    v_mfma_f32_16x16x32_bf16 v[236:239], a[152:155], a[216:219], v[236:239]
    v_mul_f32 v223, v223, v225
    v_cvt_pk_bf16_f32 v220, v220, v221
    v_mfma_f32_16x16x32_bf16 v[236:239], a[156:159], a[220:223], v[236:239]
    v_cvt_pk_bf16_f32 v221, v222, v223
    v_max3_f32 v248, v248, v196, v197
    v_mfma_f32_16x16x32_bf16 v[236:239], a[160:163], a[224:227], v[236:239]
    ds_write_b64 v247, v[220:221] offset:24832
    v_mfma_f32_16x16x32_bf16 v[236:239], a[164:167], a[228:231], v[236:239]
    v_max3_f32 v248, v248, v198, v199
    v_max3_f32 v248, v248, v200, v201
    v_mfma_f32_16x16x32_bf16 v[228:231], a[168:171], a[240:243], 0
    ds_read_b128 v[196:199], v244 offset:128
    v_max3_f32 v248, v248, v202, v203
    v_mfma_f32_16x16x32_bf16 v[228:231], a[172:175], a[244:247], v[228:231]
    ds_read_b128 v[200:203], v245 offset:128
    v_max3_f32 v248, v248, v204, v205
    v_mfma_f32_16x16x32_bf16 v[228:231], a[176:179], a[216:219], v[228:231]
    v_cvt_pk_bf16_f32 v236, v236, v237
    v_cvt_pk_bf16_f32 v237, v238, v239
    v_mfma_f32_16x16x32_bf16 v[228:231], a[180:183], a[220:223], v[228:231]
    ds_write_b64 v249, v[236:237] offset:0
    v_mfma_f32_16x16x32_bf16 v[228:231], a[184:187], a[224:227], v[228:231]
    v_max3_f32 v248, v248, v206, v207
    v_max3_f32 v248, v248, v208, v209
    v_mfma_f32_16x16x32_bf16 v[228:231], a[188:191], a[228:231], v[228:231]
    ds_read_b128 v[204:207], v246 offset:128
    v_max3_f32 v248, v248, v210, v211
    v_mfma_f32_16x16x32_bf16 v[232:235], a[192:195], a[240:243], 0
    ds_read_b128 a[240:243], v242 offset:12416
    ds_read_b128 v[208:211], v244 offset:0
    v_mfma_f32_16x16x32_bf16 v[232:235], a[196:199], a[244:247], v[232:235]
    ds_read_b128 a[244:247], v243 offset:12416
    v_mfma_f32_16x16x32_bf16 v[232:235], a[200:203], a[216:219], v[232:235]
    ds_read_b128 a[216:219], v242 offset:12544
    v_cvt_pk_bf16_f32 v228, v228, v229
    v_mfma_f32_16x16x32_bf16 v[232:235], a[204:207], a[220:223], v[232:235]
    ds_read_b128 a[220:223], v243 offset:12544
    v_cvt_pk_bf16_f32 v229, v230, v231
    v_mfma_f32_16x16x32_bf16 v[232:235], a[208:211], a[224:227], v[232:235]
    ds_write_b64 v249, v[228:229] offset:128
    v_mfma_f32_16x16x32_bf16 v[232:235], a[212:215], a[228:231], v[232:235]
    ds_read_b128 a[224:227], v240 offset:6144
    ds_read_b128 a[228:231], v241 offset:6144
    v_mfma_f32_16x16x32_bf16 v[236:239], a[144:147], a[232:235], 0
    s_waitcnt lgkmcnt(10)
    v_mfma_f32_16x16x32_bf16 v[196:199], v[102:105], v[174:177], v[196:199]
    s_waitcnt lgkmcnt(8)
    v_mfma_f32_16x16x32_bf16 v[196:199], v[104:107], v[176:179], v[196:199]
    v_mfma_f32_16x16x32_bf16 v[200:203], v[114:117], v[174:177], v[200:203]
    s_waitcnt lgkmcnt(6)
    v_cvt_pk_bf16_f32 v232, v232, v233
    v_cvt_pk_bf16_f32 v233, v234, v235
    v_mfma_f32_16x16x32_bf16 v[200:203], v[116:119], v[176:179], v[200:203]
    ds_write_b64 v249, v[232:233] offset:256
    v_mfma_f32_16x16x32_bf16 v[204:207], v[150:153], v[174:177], v[204:207]
    s_waitcnt lgkmcnt(6)
    v_max3_f32 v248, v248, v196, v197
    v_mfma_f32_16x16x32_bf16 v[204:207], v[152:155], v[176:179], v[204:207]
    ds_read_b128 v[196:199], v245 offset:0
    v_mfma_f32_16x16x32_bf16 v[208:211], v[156:159], v[174:177], v[208:211]
    s_waitcnt lgkmcnt(5)
    v_max3_f32 v248, v248, v200, v201
    v_mfma_f32_16x16x32_bf16 v[208:211], v[158:161], v[176:179], v[208:211]
    ds_read_b128 v[200:203], v246 offset:0
    v_mfma_f32_16x16x32_bf16 v[236:239], a[148:151], a[236:239], v[236:239]
    s_waitcnt lgkmcnt(4)
    v_max3_f32 v248, v248, v204, v205
    v_mov_b32 v225, v248
    v_mfma_f32_16x16x32_bf16 v[236:239], a[152:155], a[240:243], v[236:239]
    ds_read_b128 v[204:207], v244 offset:64
    v_permlane16_swap_b32 v248, v225
    v_mfma_f32_16x16x32_bf16 v[236:239], a[156:159], a[244:247], v[236:239]
    s_waitcnt lgkmcnt(4)
    v_max_f32 v248, v248, v225
    v_mov_b32 v225, v248
    v_mfma_f32_16x16x32_bf16 v[236:239], a[160:163], a[216:219], v[236:239]
    v_mfma_f32_16x16x32_bf16 v[236:239], a[164:167], a[220:223], v[236:239]
    v_permlane32_swap_b32 v248, v225
    v_max_f32 v248, v248, v225
    v_mfma_f32_16x16x32_bf16 v[228:231], a[168:171], a[232:235], 0
    v_sub_f32 v208, v208, v248
    v_sub_f32 v209, v209, v248
    v_mfma_f32_16x16x32_bf16 v[228:231], a[172:175], a[236:239], v[228:231]
    s_waitcnt lgkmcnt(2)
    v_exp_f32 v208, v208
    v_mfma_f32_16x16x32_bf16 v[196:199], v[90:93], v[174:177], v[196:199]
    v_cvt_pk_bf16_f32 v236, v236, v237
    v_cvt_pk_bf16_f32 v237, v238, v239
    v_mfma_f32_16x16x32_bf16 v[196:199], v[92:95], v[176:179], v[196:199]
    ds_write_b64 v249, v[236:237] offset:6144
    v_mfma_f32_16x16x32_bf16 v[228:231], a[176:179], a[240:243], v[228:231]
    s_waitcnt lgkmcnt(1)
    v_exp_f32 v209, v209
    v_mfma_f32_16x16x32_bf16 v[200:203], v[126:129], v[174:177], v[200:203]
    v_sub_f32 v210, v210, v248
    v_sub_f32 v211, v211, v248
    v_mfma_f32_16x16x32_bf16 v[200:203], v[128:131], v[176:179], v[200:203]
    v_exp_f32 v210, v210
    v_mfma_f32_16x16x32_bf16 v[204:207], v[162:165], v[174:177], v[204:207]
    v_exp_f32 v211, v211
    v_mfma_f32_16x16x32_bf16 v[204:207], v[164:167], v[176:179], v[204:207]
    v_cvt_pk_bf16_f32 v190, v208, v209
    v_cvt_pk_bf16_f32 v193, v210, v211
    v_mfma_f32_16x16x32_bf16 v[228:231], a[180:183], a[244:247], v[228:231]
    ds_read_b128 v[208:211], v245 offset:64
    v_sub_f32 v196, v196, v248
    v_mfma_f32_16x16x32_bf16 v[228:231], a[184:187], a[216:219], v[228:231]
    v_exp_f32 v196, v196
    v_mfma_f32_16x16x32_bf16 v[228:231], a[188:191], a[220:223], v[228:231]
    v_sub_f32 v197, v197, v248
    v_sub_f32 v198, v198, v248
    v_mfma_f32_16x16x32_bf16 v[232:235], a[192:195], a[232:235], 0
    ds_read_b128 a[232:235], v240 offset:6272
    v_sub_f32 v199, v199, v248
    v_mfma_f32_16x16x32_bf16 v[232:235], a[196:199], a[236:239], v[232:235]
    ds_read_b128 a[236:239], v241 offset:6272
    v_sub_f32 v200, v200, v248
    v_mfma_f32_16x16x32_bf16 v[232:235], a[200:203], a[240:243], v[232:235]
    ds_read_b128 a[240:243], v240 offset:6400
    v_cvt_pk_bf16_f32 v228, v228, v229
    v_mfma_f32_16x16x32_bf16 v[232:235], a[204:207], a[244:247], v[232:235]
    ds_read_b128 a[244:247], v241 offset:6400
    v_cvt_pk_bf16_f32 v229, v230, v231
    v_mfma_f32_16x16x32_bf16 v[232:235], a[208:211], a[216:219], v[232:235]
    ds_write_b64 v249, v[228:229] offset:6272
    v_mfma_f32_16x16x32_bf16 v[232:235], a[212:215], a[220:223], v[232:235]
    ds_read_b128 a[216:219], v242 offset:6144
    ds_read_b128 a[220:223], v243 offset:6144
    v_mfma_f32_16x16x32_bf16 v[236:239], a[0:3], a[224:227], 0
    s_waitcnt lgkmcnt(7)
    v_exp_f32 v197, v197
    v_mfma_f32_16x16x32_bf16 v[208:211], v[138:141], v[174:177], v[208:211]
    v_exp_f32 v198, v198
    v_mfma_f32_16x16x32_bf16 v[208:211], v[140:143], v[176:179], v[208:211]
    v_cvt_pk_bf16_f32 v232, v232, v233
    v_cvt_pk_bf16_f32 v233, v234, v235
    v_mfma_f32_16x16x32_bf16 v[236:239], a[4:7], a[228:231], v[236:239]
    ds_write_b64 v249, v[232:233] offset:6400
    v_mfma_f32_16x16x32_bf16 v[228:231], a[24:27], a[224:227], 0
    s_waitcnt lgkmcnt(7)
    v_exp_f32 v199, v199
    v_mfma_f32_16x16x32_bf16 v[236:239], a[8:11], a[232:235], v[236:239]
    s_waitcnt lgkmcnt(6)
    v_cvt_pk_bf16_f32 v188, v196, v197
    v_cvt_pk_bf16_f32 v191, v198, v199
    v_mfma_f32_16x16x32_bf16 v[236:239], a[12:15], a[236:239], v[236:239]
    ds_read_b128 v[196:199], v246 offset:64
    v_sub_f32 v201, v201, v248
    v_mfma_f32_16x16x32_bf16 v[228:231], a[28:31], a[228:231], v[228:231]
    s_waitcnt lgkmcnt(6)
    v_exp_f32 v200, v200
    v_mfma_f32_16x16x32_bf16 v[236:239], a[16:19], a[240:243], v[236:239]
    s_waitcnt lgkmcnt(5)
    v_exp_f32 v201, v201
    v_mfma_f32_16x16x32_bf16 v[236:239], a[20:23], a[244:247], v[236:239]
    s_waitcnt lgkmcnt(3)
    v_sub_f32 v202, v202, v248
    v_sub_f32 v203, v203, v248
    v_mfma_f32_16x16x32_bf16 v[228:231], a[32:35], a[232:235], v[228:231]
    s_waitcnt lgkmcnt(2)
    v_exp_f32 v202, v202
    v_mfma_f32_16x16x32_bf16 v[228:231], a[36:39], a[236:239], v[228:231]
    s_waitcnt lgkmcnt(1)
    v_cvt_pk_bf16_f32 v156, v236, v237
    v_cvt_pk_bf16_f32 v157, v238, v239
    v_mfma_f32_16x16x32_bf16 v[228:231], a[40:43], a[240:243], v[228:231]
    s_barrier
    v_mfma_f32_16x16x32_bf16 v[228:231], a[44:47], a[244:247], v[228:231]
    ds_read_b128 a[252:255], v252 offset:0
    ds_read_b64 v[254:255], v253 offset:256
    v_mfma_f32_16x16x32_bf16 v[232:235], a[48:51], a[224:227], 0
    s_waitcnt lgkmcnt(2)
    v_exp_f32 v203, v203
    v_mfma_f32_16x16x32_bf16 v[196:199], v[144:147], v[174:177], v[196:199]
    v_cvt_pk_bf16_f32 v189, v200, v201
    v_cvt_pk_bf16_f32 v192, v202, v203
    v_mfma_f32_16x16x32_bf16 v[196:199], v[146:149], v[176:179], v[196:199]
    v_cvt_pk_bf16_f32 v158, v228, v229
    v_cvt_pk_bf16_f32 v159, v230, v231
    v_mfma_f32_16x16x32_bf16 v[212:215], v[6:9], v[188:191], 0
    ds_read_b128 v[200:203], v244 offset:128
    v_sub_f32 v204, v204, v248
    v_mfma_f32_16x16x32_bf16 v[216:219], v[36:39], v[188:191], 0
    v_exp_f32 v204, v204
    v_mfma_f32_16x16x32_bf16 v[220:223], v[66:69], v[188:191], 0
    v_sub_f32 v205, v205, v248
    v_sub_f32 v206, v206, v248
    v_mfma_f32_16x16x32_bf16 v[224:227], a[248:251], v[188:191], 0
    v_exp_f32 v205, v205
    v_mfma_f32_16x16x32_bf16 v[232:235], a[52:55], a[228:231], v[232:235]
    s_waitcnt lgkmcnt(2)
    v_exp_f32 v206, v206
    v_mfma_f32_16x16x32_bf16 v[232:235], a[56:59], a[232:235], v[232:235]
    buffer_store_dwordx4 a[252:255], v250, s[20:23], s55 offen nt
    v_mfma_f32_16x16x32_bf16 v[232:235], a[60:63], a[236:239], v[232:235]
    s_waitcnt lgkmcnt(1)
    ds_read_b128 a[252:255], v252 offset:6144
    v_mfma_f32_16x16x32_bf16 v[232:235], a[64:67], a[240:243], v[232:235]
    v_sub_f32 v207, v207, v248
    v_cvt_pk_bf16_f32 v180, v204, v205
    v_mfma_f32_16x16x32_bf16 v[232:235], a[68:71], a[244:247], v[232:235]
    buffer_store_dwordx2 v[254:255], v251, s[20:23], s55 offen offset:256 nt
    v_mfma_f32_16x16x32_bf16 v[236:239], a[224:227], a[72:75], 0
    ds_read_b64 v[254:255], v253 offset:6400
    s_mul_i32 s55, s31, 7
    v_mfma_f32_16x16x32_bf16 v[236:239], a[228:231], a[76:79], v[236:239]
    s_add_u32 s54, s54, s55
    s_add_u32 s54, s54, s32
    s_add_u32 s55, s28, 11
    v_mfma_f32_16x16x32_bf16 v[236:239], a[232:235], a[80:83], v[236:239]
    s_mul_i32 s55, s55, s30
    v_cvt_pk_bf16_f32 v160, v232, v233
    v_cvt_pk_bf16_f32 v161, v234, v235
    v_mfma_f32_16x16x32_bf16 v[236:239], a[236:239], a[84:87], v[236:239]
    s_waitcnt lgkmcnt(2)
    v_exp_f32 v207, v207
    v_mfma_f32_16x16x32_bf16 v[200:203], v[102:105], v[174:177], v[200:203]
    v_cvt_pk_bf16_f32 v183, v206, v207
    v_sub_f32 v208, v208, v248
    v_mfma_f32_16x16x32_bf16 v[200:203], v[104:107], v[176:179], v[200:203]
    ds_read_b128 v[204:207], v245 offset:128
    s_waitcnt lgkmcnt(2)
    v_mfma_f32_16x16x32_bf16 v[236:239], a[240:243], a[88:91], v[236:239]
    buffer_store_dwordx4 a[252:255], v250, s[20:23], s57 offen nt
    v_mfma_f32_16x16x32_bf16 v[236:239], a[244:247], a[92:95], v[236:239]
    v_exp_f32 v208, v208
    v_mfma_f32_16x16x32_bf16 v[228:231], a[224:227], a[96:99], 0
    s_waitcnt lgkmcnt(1)
    v_sub_f32 v209, v209, v248
    v_sub_f32 v210, v210, v248
    v_mfma_f32_16x16x32_bf16 v[228:231], a[228:231], a[100:103], v[228:231]
    buffer_store_dwordx2 v[254:255], v251, s[20:23], s57 offen offset:256 nt
    v_mfma_f32_16x16x32_bf16 v[228:231], a[232:235], a[104:107], v[228:231]
    s_mul_i32 s57, s31, 3
    v_cvt_pk_bf16_f32 v25, v236, v237
    v_cvt_pk_bf16_f32 v28, v238, v239
    v_mfma_f32_16x16x32_bf16 v[228:231], a[236:239], a[108:111], v[228:231]
    s_add_u32 s56, s56, s57
    s_add_u32 s56, s56, s32
    s_add_u32 s57, s28, 3
    v_mfma_f32_16x16x32_bf16 v[228:231], a[240:243], a[112:115], v[228:231]
    s_mul_i32 s57, s57, s30
    v_exp_f32 v209, v209
    v_mfma_f32_16x16x32_bf16 v[228:231], a[244:247], a[116:119], v[228:231]
    s_waitcnt lgkmcnt(0)
    v_exp_f32 v210, v210
    v_mfma_f32_16x16x32_bf16 v[204:207], v[114:117], v[174:177], v[204:207]
    v_sub_f32 v211, v211, v248
    v_cvt_pk_bf16_f32 v194, v208, v209
    v_mfma_f32_16x16x32_bf16 v[204:207], v[116:119], v[176:179], v[204:207]
    v_exp_f32 v211, v211
    v_mfma_f32_16x16x32_bf16 v[232:235], a[224:227], a[120:123], 0
    v_cvt_pk_bf16_f32 v55, v228, v229
    v_cvt_pk_bf16_f32 v58, v230, v231
    v_mfma_f32_16x16x32_bf16 v[232:235], a[228:231], a[124:127], v[232:235]
    ds_read_b128 a[224:227], v242 offset:6272
    ds_read_b128 a[228:231], v243 offset:6272
    v_mfma_f32_16x16x32_bf16 v[232:235], a[232:235], a[128:131], v[232:235]
    ds_read_b128 a[232:235], v242 offset:6400
    v_add_u32 v242, 0xfffe9800, v242
    v_mfma_f32_16x16x32_bf16 v[232:235], a[236:239], a[132:135], v[232:235]
    ds_read_b128 a[236:239], v243 offset:6400
    v_add_u32 v243, 0xfffe9800, v243
    v_mfma_f32_16x16x32_bf16 v[232:235], a[240:243], a[136:139], v[232:235]
    ds_read_b128 a[240:243], v242 offset:12288
    v_cvt_pk_bf16_f32 v181, v210, v211
    v_mfma_f32_16x16x32_bf16 v[232:235], a[244:247], a[140:143], v[232:235]
    ds_read_b128 a[244:247], v243 offset:12288
    ds_read_b128 v[208:211], v246 offset:128
    v_mfma_f32_16x16x32_bf16 v[236:239], a[144:147], a[216:219], 0
    v_sub_f32 v196, v196, v248
    v_sub_f32 v197, v197, v248
    v_mfma_f32_16x16x32_bf16 v[236:239], a[148:151], a[220:223], v[236:239]
    v_exp_f32 v196, v196
    v_mfma_f32_16x16x32_bf16 v[228:231], a[168:171], a[216:219], 0
    v_cvt_pk_bf16_f32 v85, v232, v233
    v_cvt_pk_bf16_f32 v88, v234, v235
    v_mfma_f32_16x16x32_bf16 v[228:231], a[172:175], a[220:223], v[228:231]
    s_waitcnt lgkmcnt(6)
    v_exp_f32 v197, v197
    v_mfma_f32_16x16x32_bf16 v[236:239], a[152:155], a[224:227], v[236:239]
    s_waitcnt lgkmcnt(5)
    v_sub_f32 v198, v198, v248
    v_sub_f32 v199, v199, v248
    v_mfma_f32_16x16x32_bf16 v[236:239], a[156:159], a[228:231], v[236:239]
    s_waitcnt lgkmcnt(4)
    v_exp_f32 v198, v198
    v_mfma_f32_16x16x32_bf16 v[236:239], a[160:163], a[232:235], v[236:239]
    s_waitcnt lgkmcnt(3)
    v_exp_f32 v199, v199
    v_mfma_f32_16x16x32_bf16 v[236:239], a[164:167], a[236:239], v[236:239]
    v_cvt_pk_bf16_f32 v195, v196, v197
    v_cvt_pk_bf16_f32 v182, v198, v199
    v_mfma_f32_16x16x32_bf16 v[228:231], a[176:179], a[224:227], v[228:231]
    ds_read_b128 v[196:199], v244 offset:0
    v_sub_f32 v200, v200, v248
    v_mfma_f32_16x16x32_bf16 v[212:215], v[10:13], v[192:195], v[212:215]
    s_waitcnt lgkmcnt(1)
    v_exp_f32 v200, v200
    v_mfma_f32_16x16x32_bf16 v[216:219], v[40:43], v[192:195], v[216:219]
    v_cvt_pk_bf16_f32 v236, v236, v237
    v_cvt_pk_bf16_f32 v237, v238, v239
    v_mfma_f32_16x16x32_bf16 v[220:223], v[70:73], v[192:195], v[220:223]
    ds_write_b64 v249, v[236:237] offset:12288
    v_mfma_f32_16x16x32_bf16 v[224:227], a[248:251], v[192:195], v[224:227]
    v_sub_f32 v201, v201, v248
    v_sub_f32 v204, v204, v248
    v_mfma_f32_16x16x32_bf16 v[212:215], v[14:17], v[180:183], v[212:215]
    v_exp_f32 v201, v201
    v_mfma_f32_16x16x32_bf16 v[216:219], v[44:47], v[180:183], v[216:219]
    v_cvt_pk_bf16_f32 v186, v200, v201
    v_sub_f32 v205, v205, v248
    v_mfma_f32_16x16x32_bf16 v[220:223], v[74:77], v[180:183], v[220:223]
    ds_read_b128 v[200:203], v245 offset:0
    v_mfma_f32_16x16x32_bf16 v[224:227], a[248:251], v[180:183], v[224:227]
    s_waitcnt lgkmcnt(2)
    v_exp_f32 v204, v204
    v_mfma_f32_16x16x32_bf16 v[208:211], v[150:153], v[174:177], v[208:211]
    ds_read_b64 v[174:175], v247 offset:43008
    v_mfma_f32_16x16x32_bf16 v[208:211], v[152:155], v[176:179], v[208:211]
    ds_read_b64 v[176:177], v247 offset:43136
    ds_read_b64 v[178:179], v247 offset:43264
    v_mfma_f32_16x16x32_bf16 v[196:199], v[162:165], v[168:171], v[196:199]
    v_exp_f32 v205, v205
    v_mfma_f32_16x16x32_bf16 v[196:199], v[164:167], v[170:173], v[196:199]
    v_cvt_pk_bf16_f32 v184, v204, v205
    v_mfma_f32_16x16x32_bf16 v[228:231], a[180:183], a[228:231], v[228:231]
    ds_read_b128 v[204:207], v246 offset:0
    v_sub_f32 v208, v208, v248
    v_mfma_f32_16x16x32_bf16 v[228:231], a[184:187], a[232:235], v[228:231]
    v_exp_f32 v208, v208
    v_mfma_f32_16x16x32_bf16 v[228:231], a[188:191], a[236:239], v[228:231]
    s_waitcnt lgkmcnt(4)
    v_sub_f32 v209, v209, v248
    v_max_f32 v248, v196, v197
    v_mfma_f32_16x16x32_bf16 v[200:203], v[138:141], v[168:171], v[200:203]
    v_exp_f32 v209, v209
    v_mfma_f32_16x16x32_bf16 v[200:203], v[140:143], v[170:173], v[200:203]
    v_cvt_pk_bf16_f32 v185, v208, v209
    v_max3_f32 v248, v248, v198, v199
    v_mfma_f32_16x16x32_bf16 v[232:235], a[192:195], a[216:219], 0
    ds_read_b128 a[216:219], v242 offset:12416
    v_cvt_pk_bf16_f32 v228, v228, v229
    v_mfma_f32_16x16x32_bf16 v[212:215], v[18:21], v[184:187], v[212:215]
    ds_read_b128 v[208:211], v244 offset:64
    v_cvt_pk_bf16_f32 v229, v230, v231
    v_mfma_f32_16x16x32_bf16 v[216:219], v[48:51], v[184:187], v[216:219]
    ds_write_b64 v249, v[228:229] offset:12416
    v_mfma_f32_16x16x32_bf16 v[220:223], v[78:81], v[184:187], v[220:223]
    ds_read_b128 v[196:199], v245 offset:64
    v_max3_f32 v248, v248, v200, v201
    v_mfma_f32_16x16x32_bf16 v[224:227], a[248:251], v[184:187], v[224:227]
    s_waitcnt lgkmcnt(4)
    v_max3_f32 v248, v248, v202, v203
    v_mfma_f32_16x16x32_bf16 v[204:207], v[144:147], v[168:171], v[204:207]
    ds_read_b128 v[200:203], v246 offset:64
    v_mfma_f32_16x16x32_bf16 v[204:207], v[146:149], v[170:173], v[204:207]
    v_mfma_f32_16x16x32_bf16 v[232:235], a[196:199], a[220:223], v[232:235]
    ds_read_b128 a[220:223], v243 offset:12416
    v_mfma_f32_16x16x32_bf16 v[232:235], a[200:203], a[224:227], v[232:235]
    ds_read_b128 a[224:227], v242 offset:12544
    v_mfma_f32_16x16x32_bf16 v[232:235], a[204:207], a[228:231], v[232:235]
    ds_read_b128 a[228:231], v243 offset:12544
    s_waitcnt lgkmcnt(6)
    v_mfma_f32_16x16x32_bf16 v[208:211], v[102:105], v[168:171], v[208:211]
    v_rcp_f32 v225, v224
    v_mfma_f32_16x16x32_bf16 v[208:211], v[104:107], v[170:173], v[208:211]
    v_mul_f32 v212, v212, v225
    v_mul_f32 v213, v213, v225
    v_mfma_f32_16x16x32_bf16 v[232:235], a[208:211], a[232:235], v[232:235]
    ds_read_b128 a[232:235], v242 offset:6144
    v_mul_f32 v214, v214, v225
    v_mfma_f32_16x16x32_bf16 v[232:235], a[212:215], a[236:239], v[232:235]
    ds_read_b128 a[236:239], v243 offset:6144
    v_mul_f32 v215, v215, v225
    v_mfma_f32_16x16x32_bf16 v[236:239], a[144:147], a[240:243], 0
    s_waitcnt lgkmcnt(5)
    v_cvt_pk_bf16_f32 v212, v212, v213
    v_cvt_pk_bf16_f32 v213, v214, v215
    v_mfma_f32_16x16x32_bf16 v[196:199], v[114:117], v[168:171], v[196:199]
    ds_write_b64 v247, v[212:213] offset:30720
    v_mfma_f32_16x16x32_bf16 v[196:199], v[116:119], v[170:173], v[196:199]
    v_cvt_pk_bf16_f32 v232, v232, v233
    v_cvt_pk_bf16_f32 v233, v234, v235
    v_mfma_f32_16x16x32_bf16 v[200:203], v[150:153], v[168:171], v[200:203]
    ds_write_b64 v249, v[232:233] offset:12544
    v_mfma_f32_16x16x32_bf16 v[200:203], v[152:155], v[170:173], v[200:203]
    s_waitcnt lgkmcnt(4)
    v_mul_f32 v216, v216, v225
    v_mul_f32 v217, v217, v225
    v_mfma_f32_16x16x32_bf16 v[236:239], a[148:151], a[244:247], v[236:239]
    v_mul_f32 v218, v218, v225
    v_mul_f32 v219, v219, v225
    v_mfma_f32_16x16x32_bf16 v[236:239], a[152:155], a[216:219], v[236:239]
    v_cvt_pk_bf16_f32 v216, v216, v217
    v_cvt_pk_bf16_f32 v217, v218, v219
    v_mfma_f32_16x16x32_bf16 v[236:239], a[156:159], a[220:223], v[236:239]
    ds_write_b64 v247, v[216:217] offset:30848
    v_mfma_f32_16x16x32_bf16 v[236:239], a[160:163], a[224:227], v[236:239]
    s_waitcnt lgkmcnt(3)
    v_mul_f32 v220, v220, v225
    v_mul_f32 v221, v221, v225
    v_mfma_f32_16x16x32_bf16 v[236:239], a[164:167], a[228:231], v[236:239]
    v_mul_f32 v222, v222, v225
    v_mul_f32 v223, v223, v225
    v_mfma_f32_16x16x32_bf16 v[228:231], a[168:171], a[240:243], 0
    v_cvt_pk_bf16_f32 v220, v220, v221
    v_cvt_pk_bf16_f32 v221, v222, v223
    v_mfma_f32_16x16x32_bf16 v[228:231], a[172:175], a[244:247], v[228:231]
    ds_write_b64 v247, v[220:221] offset:30976
    v_mfma_f32_16x16x32_bf16 v[228:231], a[176:179], a[216:219], v[228:231]
    v_cvt_pk_bf16_f32 v236, v236, v237
    v_cvt_pk_bf16_f32 v237, v238, v239
    v_mfma_f32_16x16x32_bf16 v[228:231], a[180:183], a[220:223], v[228:231]
    ds_write_b64 v249, v[236:237] offset:18432
    v_mfma_f32_16x16x32_bf16 v[228:231], a[184:187], a[224:227], v[228:231]
    v_max3_f32 v248, v248, v204, v205
    v_max3_f32 v248, v248, v206, v207
    v_mfma_f32_16x16x32_bf16 v[228:231], a[188:191], a[228:231], v[228:231]
    ds_read_b128 v[204:207], v244 offset:128
    v_max3_f32 v248, v248, v208, v209
    v_mfma_f32_16x16x32_bf16 v[232:235], a[192:195], a[240:243], 0
    ds_read_b128 a[240:243], v242 offset:6272
    v_max3_f32 v248, v248, v210, v211
    v_mfma_f32_16x16x32_bf16 v[232:235], a[196:199], a[244:247], v[232:235]
    ds_read_b128 a[244:247], v243 offset:6272
    ds_read_b128 v[208:211], v245 offset:128
    v_mfma_f32_16x16x32_bf16 v[232:235], a[200:203], a[216:219], v[232:235]
    ds_read_b128 a[216:219], v242 offset:6400
    v_cvt_pk_bf16_f32 v228, v228, v229
    v_mfma_f32_16x16x32_bf16 v[232:235], a[204:207], a[220:223], v[232:235]
    ds_read_b128 a[220:223], v243 offset:6400
    v_cvt_pk_bf16_f32 v229, v230, v231
    v_mfma_f32_16x16x32_bf16 v[232:235], a[208:211], a[224:227], v[232:235]
    ds_write_b64 v249, v[228:229] offset:18560
    v_mfma_f32_16x16x32_bf16 v[232:235], a[212:215], a[228:231], v[232:235]
    ds_read_b128 a[224:227], v242 offset:18432
    ds_read_b128 a[228:231], v243 offset:18432
    v_mfma_f32_16x16x32_bf16 v[236:239], a[144:147], a[232:235], 0
    v_max3_f32 v248, v248, v196, v197
    v_max3_f32 v248, v248, v198, v199
    v_mfma_f32_16x16x32_bf16 v[236:239], a[148:151], a[236:239], v[236:239]
    ds_read_b128 v[196:199], v246 offset:128
    v_max3_f32 v248, v248, v200, v201
    v_mfma_f32_16x16x32_bf16 v[228:231], a[168:171], a[232:235], 0
    s_waitcnt lgkmcnt(8)
    v_cvt_pk_bf16_f32 v232, v232, v233
    v_cvt_pk_bf16_f32 v233, v234, v235
    v_mfma_f32_16x16x32_bf16 v[204:207], v[108:111], v[168:171], v[204:207]
    ds_write_b64 v249, v[232:233] offset:18688
    v_mfma_f32_16x16x32_bf16 v[204:207], v[110:113], v[170:173], v[204:207]
    s_waitcnt lgkmcnt(7)
    v_max3_f32 v248, v248, v202, v203
    v_mfma_f32_16x16x32_bf16 v[208:211], v[120:123], v[168:171], v[208:211]
    ds_read_b128 v[200:203], v244 offset:0
    v_mfma_f32_16x16x32_bf16 v[208:211], v[122:125], v[170:173], v[208:211]
    s_waitcnt lgkmcnt(7)
    v_mfma_f32_16x16x32_bf16 v[236:239], a[152:155], a[240:243], v[236:239]
    s_waitcnt lgkmcnt(6)
    v_max3_f32 v248, v248, v204, v205
    v_mfma_f32_16x16x32_bf16 v[236:239], a[156:159], a[244:247], v[236:239]
    ds_read_b128 v[204:207], v245 offset:0
    v_mfma_f32_16x16x32_bf16 v[236:239], a[160:163], a[216:219], v[236:239]
    s_waitcnt lgkmcnt(5)
    v_max3_f32 v248, v248, v208, v209
    v_mfma_f32_16x16x32_bf16 v[236:239], a[164:167], a[220:223], v[236:239]
    ds_read_b128 v[208:211], v246 offset:0
    s_waitcnt lgkmcnt(4)
    v_mfma_f32_16x16x32_bf16 v[196:199], v[156:159], v[168:171], v[196:199]
    v_mfma_f32_16x16x32_bf16 v[196:199], v[158:161], v[170:173], v[196:199]
    v_mfma_f32_16x16x32_bf16 v[228:231], a[172:175], a[236:239], v[228:231]
    v_mfma_f32_16x16x32_bf16 v[228:231], a[176:179], a[240:243], v[228:231]
    s_waitcnt lgkmcnt(2)
    v_mfma_f32_16x16x32_bf16 v[200:203], v[162:165], v[168:171], v[200:203]
    v_cvt_pk_bf16_f32 v236, v236, v237
    v_cvt_pk_bf16_f32 v237, v238, v239
    v_mfma_f32_16x16x32_bf16 v[200:203], v[164:167], v[170:173], v[200:203]
    ds_write_b64 v249, v[236:237] offset:24576
    v_mfma_f32_16x16x32_bf16 v[228:231], a[180:183], a[244:247], v[228:231]
    s_waitcnt lgkmcnt(2)
    v_max3_f32 v248, v248, v196, v197
    v_mov_b32 v225, v248
    v_mfma_f32_16x16x32_bf16 v[204:207], v[138:141], v[168:171], v[204:207]
    ds_read_b128 v[196:199], v244 offset:64
    v_permlane16_swap_b32 v248, v225
    v_mfma_f32_16x16x32_bf16 v[204:207], v[140:143], v[170:173], v[204:207]
    s_waitcnt lgkmcnt(2)
    v_max_f32 v248, v248, v225
    v_mov_b32 v225, v248
    v_mfma_f32_16x16x32_bf16 v[208:211], v[144:147], v[168:171], v[208:211]
    v_mfma_f32_16x16x32_bf16 v[208:211], v[146:149], v[170:173], v[208:211]
    v_permlane32_swap_b32 v248, v225
    v_max_f32 v248, v248, v225
    v_mfma_f32_16x16x32_bf16 v[228:231], a[184:187], a[216:219], v[228:231]
    v_sub_f32 v200, v200, v248
    v_sub_f32 v201, v201, v248
    v_mfma_f32_16x16x32_bf16 v[228:231], a[188:191], a[220:223], v[228:231]
    v_exp_f32 v200, v200
    v_mfma_f32_16x16x32_bf16 v[232:235], a[192:195], a[232:235], 0
    ds_read_b128 a[232:235], v242 offset:18560
    v_sub_f32 v202, v202, v248
    v_mfma_f32_16x16x32_bf16 v[232:235], a[196:199], a[236:239], v[232:235]
    ds_read_b128 a[236:239], v243 offset:18560
    v_sub_f32 v203, v203, v248
    v_mfma_f32_16x16x32_bf16 v[232:235], a[200:203], a[240:243], v[232:235]
    ds_read_b128 a[240:243], v242 offset:18688
    v_cvt_pk_bf16_f32 v228, v228, v229
    v_mfma_f32_16x16x32_bf16 v[232:235], a[204:207], a[244:247], v[232:235]
    ds_read_b128 a[244:247], v243 offset:18688
    v_cvt_pk_bf16_f32 v229, v230, v231
    v_mfma_f32_16x16x32_bf16 v[232:235], a[208:211], a[216:219], v[232:235]
    ds_write_b64 v249, v[228:229] offset:24704
    v_mfma_f32_16x16x32_bf16 v[232:235], a[212:215], a[220:223], v[232:235]
    ds_read_b128 a[216:219], v242 offset:24576
    ds_read_b128 a[220:223], v243 offset:24576
    v_mfma_f32_16x16x32_bf16 v[236:239], a[144:147], a[224:227], 0
    s_waitcnt lgkmcnt(7)
    v_exp_f32 v201, v201
    v_mfma_f32_16x16x32_bf16 v[196:199], v[102:105], v[168:171], v[196:199]
    v_exp_f32 v202, v202
    v_mfma_f32_16x16x32_bf16 v[196:199], v[104:107], v[170:173], v[196:199]
    v_cvt_pk_bf16_f32 v232, v232, v233
    v_cvt_pk_bf16_f32 v233, v234, v235
    v_mfma_f32_16x16x32_bf16 v[236:239], a[148:151], a[228:231], v[236:239]
    ds_write_b64 v249, v[232:233] offset:24832
    v_mfma_f32_16x16x32_bf16 v[228:231], a[168:171], a[224:227], 0
    s_waitcnt lgkmcnt(7)
    v_exp_f32 v203, v203
    v_mfma_f32_16x16x32_bf16 v[236:239], a[152:155], a[232:235], v[236:239]
    s_waitcnt lgkmcnt(6)
    v_cvt_pk_bf16_f32 v190, v200, v201
    v_cvt_pk_bf16_f32 v193, v202, v203
    v_mfma_f32_16x16x32_bf16 v[236:239], a[156:159], a[236:239], v[236:239]
    ds_read_b128 v[200:203], v245 offset:64
    v_sub_f32 v204, v204, v248
    v_mfma_f32_16x16x32_bf16 v[228:231], a[172:175], a[228:231], v[228:231]
    s_waitcnt lgkmcnt(6)
    v_exp_f32 v204, v204
    v_mfma_f32_16x16x32_bf16 v[236:239], a[160:163], a[240:243], v[236:239]
    s_waitcnt lgkmcnt(5)
    v_sub_f32 v205, v205, v248
    v_sub_f32 v206, v206, v248
    v_mfma_f32_16x16x32_bf16 v[236:239], a[164:167], a[244:247], v[236:239]
    s_waitcnt lgkmcnt(3)
    v_exp_f32 v205, v205
    v_mfma_f32_16x16x32_bf16 v[228:231], a[176:179], a[232:235], v[228:231]
    s_waitcnt lgkmcnt(2)
    v_exp_f32 v206, v206
    v_mfma_f32_16x16x32_bf16 v[228:231], a[180:183], a[236:239], v[228:231]
    s_waitcnt lgkmcnt(1)
    s_barrier
    v_mfma_f32_16x16x32_bf16 v[228:231], a[184:187], a[240:243], v[228:231]
    ds_read_b128 a[252:255], v252 offset:12288
    v_cvt_pk_bf16_f32 v236, v236, v237
    v_mfma_f32_16x16x32_bf16 v[228:231], a[188:191], a[244:247], v[228:231]
    ds_read_b64 v[254:255], v253 offset:12544
    v_cvt_pk_bf16_f32 v237, v238, v239
    v_mfma_f32_16x16x32_bf16 v[232:235], a[192:195], a[224:227], 0
    ds_write_b64 v249, v[236:237] offset:0
    v_mfma_f32_16x16x32_bf16 v[232:235], a[196:199], a[228:231], v[232:235]
    ds_read_b128 a[224:227], v242 offset:24704
    ds_read_b128 a[228:231], v243 offset:24704
    v_mfma_f32_16x16x32_bf16 v[232:235], a[200:203], a[232:235], v[232:235]
    ds_read_b128 a[232:235], v242 offset:24832
    v_cvt_pk_bf16_f32 v228, v228, v229
    v_mfma_f32_16x16x32_bf16 v[232:235], a[204:207], a[236:239], v[232:235]
    ds_read_b128 a[236:239], v243 offset:24832
    v_cvt_pk_bf16_f32 v229, v230, v231
    v_mfma_f32_16x16x32_bf16 v[232:235], a[208:211], a[240:243], v[232:235]
    ds_write_b64 v249, v[228:229] offset:128
    v_mfma_f32_16x16x32_bf16 v[232:235], a[212:215], a[244:247], v[232:235]
    s_waitcnt lgkmcnt(8)
    ds_read_b128 a[240:243], v242 offset:30720
    v_mfma_f32_16x16x32_bf16 v[200:203], v[114:117], v[168:171], v[200:203]
    ds_read_b128 a[244:247], v243 offset:30720
    s_waitcnt lgkmcnt(8)
    v_mfma_f32_16x16x32_bf16 v[200:203], v[116:119], v[170:173], v[200:203]
    buffer_store_dwordx4 a[252:255], v250, s[20:23], s52 offen nt
    v_sub_f32 v207, v207, v248
    v_cvt_pk_bf16_f32 v232, v232, v233
    v_cvt_pk_bf16_f32 v233, v234, v235
    ds_write_b64 v249, v[232:233] offset:256
    ds_read_b128 a[252:255], v252 offset:18432
    buffer_store_dwordx2 v[254:255], v251, s[20:23], s52 offen offset:256 nt
    ds_read_b64 v[254:255], v253 offset:18688
    s_mul_i32 s52, s31, 11
    s_add_u32 s51, s51, s52
    s_add_u32 s51, s51, s32
    s_add_u32 s52, s28, 7
    s_mul_i32 s52, s52, s30
    v_exp_f32 v207, v207
    v_cvt_pk_bf16_f32 v188, v204, v205
    v_cvt_pk_bf16_f32 v191, v206, v207
    ds_read_b128 v[204:207], v246 offset:64
    v_sub_f32 v208, v208, v248
    v_exp_f32 v208, v208
    v_sub_f32 v209, v209, v248
    v_exp_f32 v209, v209
    v_sub_f32 v210, v210, v248
    v_exp_f32 v210, v210
    v_sub_f32 v211, v211, v248
    v_exp_f32 v211, v211
    v_cvt_pk_bf16_f32 v189, v208, v209
    v_cvt_pk_bf16_f32 v192, v210, v211
    ds_read_b128 v[208:211], v244 offset:128
    v_mfma_f32_16x16x32_bf16 v[212:215], v[12:15], v[188:191], 0
    s_waitcnt lgkmcnt(3)
    s_waitcnt lgkmcnt(2)
    v_sub_f32 v196, v196, v248
    v_mfma_f32_16x16x32_bf16 v[216:219], v[42:45], v[188:191], 0
    buffer_store_dwordx4 a[252:255], v250, s[20:23], s54 offen nt
    v_mfma_f32_16x16x32_bf16 v[220:223], v[72:75], v[188:191], 0
    v_exp_f32 v196, v196
    v_mfma_f32_16x16x32_bf16 v[224:227], a[248:251], v[188:191], 0
    s_waitcnt lgkmcnt(1)
    ds_read_b128 a[252:255], v252 offset:24576
    v_mfma_f32_16x16x32_bf16 v[204:207], v[150:153], v[168:171], v[204:207]
    buffer_store_dwordx2 v[254:255], v251, s[20:23], s54 offen offset:256 nt
    v_mfma_f32_16x16x32_bf16 v[204:207], v[152:155], v[170:173], v[204:207]
    ds_read_b64 v[254:255], v253 offset:24832
    s_mul_i32 s54, s31, 3
    s_add_u32 s53, s53, s54
    s_add_u32 s53, s53, s32
    s_add_u32 s54, s28, 11
    s_waitcnt lgkmcnt(2)
    v_mfma_f32_16x16x32_bf16 v[208:211], v[108:111], v[168:171], v[208:211]
    s_mul_i32 s54, s54, s30
    v_sub_f32 v197, v197, v248
    v_sub_f32 v198, v198, v248
    v_mfma_f32_16x16x32_bf16 v[208:211], v[110:113], v[170:173], v[208:211]
    v_exp_f32 v197, v197
    v_exp_f32 v198, v198
    v_sub_f32 v199, v199, v248
    v_exp_f32 v199, v199
    v_cvt_pk_bf16_f32 v180, v196, v197
    v_cvt_pk_bf16_f32 v183, v198, v199
    ds_read_b128 v[196:199], v245 offset:128
    s_waitcnt lgkmcnt(2)
    buffer_store_dwordx4 a[252:255], v250, s[20:23], s56 offen nt
    v_sub_f32 v200, v200, v248
    s_waitcnt lgkmcnt(1)
    v_exp_f32 v200, v200
    v_sub_f32 v201, v201, v248
    v_exp_f32 v201, v201
    v_sub_f32 v202, v202, v248
    v_exp_f32 v202, v202
    buffer_store_dwordx2 v[254:255], v251, s[20:23], s56 offen offset:256 nt
    s_mul_i32 s56, s31, 7
    s_add_u32 s55, s55, s56
    s_add_u32 s55, s55, s32
    s_add_u32 s56, s28, 11
    s_mul_i32 s56, s56, s30
    v_sub_f32 v203, v203, v248
    v_exp_f32 v203, v203
    v_cvt_pk_bf16_f32 v194, v200, v201
    s_waitcnt lgkmcnt(0)
    v_mfma_f32_16x16x32_bf16 v[196:199], v[120:123], v[168:171], v[196:199]
    v_cvt_pk_bf16_f32 v181, v202, v203
    v_sub_f32 v204, v204, v248
    v_mfma_f32_16x16x32_bf16 v[196:199], v[122:125], v[170:173], v[196:199]
    ds_read_b128 v[200:203], v246 offset:128
    v_exp_f32 v204, v204
    v_sub_f32 v205, v205, v248
    v_exp_f32 v205, v205
    v_sub_f32 v206, v206, v248
    v_exp_f32 v206, v206
    v_sub_f32 v207, v207, v248
    v_exp_f32 v207, v207
    v_cvt_pk_bf16_f32 v195, v204, v205
    v_cvt_pk_bf16_f32 v182, v206, v207
    ds_read_b128 v[204:207], v244 offset:0
    v_mfma_f32_16x16x32_bf16 v[212:215], v[16:19], v[192:195], v[212:215]
    v_sub_f32 v208, v208, v248
    v_sub_f32 v209, v209, v248
    v_mfma_f32_16x16x32_bf16 v[216:219], v[46:49], v[192:195], v[216:219]
    v_exp_f32 v208, v208
    v_mfma_f32_16x16x32_bf16 v[220:223], v[76:79], v[192:195], v[220:223]
    v_exp_f32 v209, v209
    v_mfma_f32_16x16x32_bf16 v[224:227], a[248:251], v[192:195], v[224:227]
    v_cvt_pk_bf16_f32 v186, v208, v209
    v_sub_f32 v196, v196, v248
    v_mfma_f32_16x16x32_bf16 v[212:215], v[20:23], v[180:183], v[212:215]
    ds_read_b128 v[208:211], v245 offset:0
    v_sub_f32 v197, v197, v248
    v_mfma_f32_16x16x32_bf16 v[216:219], v[50:53], v[180:183], v[216:219]
    s_waitcnt lgkmcnt(2)
    v_exp_f32 v196, v196
    v_mfma_f32_16x16x32_bf16 v[220:223], v[80:83], v[180:183], v[220:223]
    v_exp_f32 v197, v197
    v_mfma_f32_16x16x32_bf16 v[224:227], a[248:251], v[180:183], v[224:227]
    v_cvt_pk_bf16_f32 v184, v196, v197
    s_waitcnt lgkmcnt(1)
    v_mfma_f32_16x16x32_bf16 v[200:203], v[156:159], v[168:171], v[200:203]
    ds_read_b128 v[196:199], v246 offset:0
    ds_read_b64 v[168:169], v247 offset:49152
    v_mfma_f32_16x16x32_bf16 v[200:203], v[158:161], v[170:173], v[200:203]
    ds_read_b64 v[170:171], v247 offset:49280
    ds_read_b64 v[172:173], v247 offset:49408
    v_mfma_f32_16x16x32_bf16 v[204:207], v[102:105], v[174:177], v[204:207]
    v_mfma_f32_16x16x32_bf16 v[204:207], v[104:107], v[176:179], v[204:207]
    s_nop 3
    s_waitcnt lgkmcnt(4)
    v_mfma_f32_16x16x32_bf16 v[208:211], v[114:117], v[174:177], v[208:211]
    v_sub_f32 v200, v200, v248
    v_sub_f32 v201, v201, v248
    v_mfma_f32_16x16x32_bf16 v[208:211], v[116:119], v[176:179], v[208:211]
    v_exp_f32 v200, v200
    v_exp_f32 v201, v201
    v_max_f32 v248, v204, v205
    v_cvt_pk_bf16_f32 v185, v200, v201
    ds_read_b128 v[200:203], v244 offset:64
    s_waitcnt lgkmcnt(4)
    v_mfma_f32_16x16x32_bf16 v[212:215], v[24:27], v[184:187], v[212:215]
    v_max3_f32 v248, v248, v206, v207
    v_max3_f32 v248, v248, v208, v209
    v_mfma_f32_16x16x32_bf16 v[216:219], v[54:57], v[184:187], v[216:219]
    ds_read_b128 v[204:207], v245 offset:64
    v_max3_f32 v248, v248, v210, v211
    v_mfma_f32_16x16x32_bf16 v[220:223], v[84:87], v[184:187], v[220:223]
    ds_read_b128 v[208:211], v246 offset:64
    v_mfma_f32_16x16x32_bf16 v[224:227], a[248:251], v[184:187], v[224:227]
    s_waitcnt lgkmcnt(3)
    v_mov_b32 v186, 0
    v_mfma_f32_16x16x32_bf16 v[196:199], v[150:153], v[174:177], v[196:199]
    v_mfma_f32_16x16x32_bf16 v[196:199], v[152:155], v[176:179], v[196:199]
    s_nop 3
    v_rcp_f32 v225, v224
    s_nop 0
    v_mul_f32 v212, v212, v225
    v_mul_f32 v213, v213, v225
    s_waitcnt lgkmcnt(2)
    v_mfma_f32_16x16x32_bf16 v[200:203], v[108:111], v[174:177], v[200:203]
    v_mul_f32 v214, v214, v225
    v_mul_f32 v215, v215, v225
    v_mfma_f32_16x16x32_bf16 v[200:203], v[110:113], v[176:179], v[200:203]
    v_cvt_pk_bf16_f32 v212, v212, v213
    s_waitcnt lgkmcnt(1)
    v_mfma_f32_16x16x32_bf16 v[204:207], v[120:123], v[174:177], v[204:207]
    v_cvt_pk_bf16_f32 v213, v214, v215
    v_mul_f32 v216, v216, v225
    v_mfma_f32_16x16x32_bf16 v[204:207], v[122:125], v[176:179], v[204:207]
    s_waitcnt lgkmcnt(0)
    v_mul_f32 v217, v217, v225
    v_mul_f32 v218, v218, v225
    v_mfma_f32_16x16x32_bf16 v[208:211], v[156:159], v[174:177], v[208:211]
    ds_write_b64 v247, v[212:213] offset:36864
    v_mfma_f32_16x16x32_bf16 v[208:211], v[158:161], v[176:179], v[208:211]
    v_mul_f32 v219, v219, v225
    v_cvt_pk_bf16_f32 v216, v216, v217
    v_cvt_pk_bf16_f32 v217, v218, v219
    ds_write_b64 v247, v[216:217] offset:36992
    v_mul_f32 v220, v220, v225
    v_mul_f32 v221, v221, v225
    v_mul_f32 v222, v222, v225
    v_mul_f32 v223, v223, v225
    v_cvt_pk_bf16_f32 v220, v220, v221
    v_cvt_pk_bf16_f32 v221, v222, v223
    ds_write_b64 v247, v[220:221] offset:37120
    v_max3_f32 v248, v248, v196, v197
    v_max3_f32 v248, v248, v198, v199
    ds_read_b128 v[196:199], v244 offset:0
    v_max3_f32 v248, v248, v200, v201
    v_max3_f32 v248, v248, v202, v203
    ds_read_b128 v[200:203], v245 offset:0
    v_max3_f32 v248, v248, v204, v205
    v_max3_f32 v248, v248, v206, v207
    ds_read_b128 v[204:207], v246 offset:0
    v_max3_f32 v248, v248, v208, v209
    v_max3_f32 v248, v248, v210, v211
    ds_read_b128 v[208:211], v244 offset:64
    v_mov_b32 v225, v248
    s_nop 1
    v_permlane16_swap_b32 v248, v225
    v_max_f32 v248, v248, v225
    v_mov_b32 v225, v248
    s_nop 1
    v_permlane32_swap_b32 v248, v225
    v_max_f32 v248, v248, v225
    s_waitcnt lgkmcnt(3)
    v_mfma_f32_16x16x32_bf16 v[196:199], v[102:105], v[174:177], v[196:199]
    v_mfma_f32_16x16x32_bf16 v[196:199], v[104:107], v[176:179], v[196:199]
    s_waitcnt lgkmcnt(2)
    v_mfma_f32_16x16x32_bf16 v[200:203], v[114:117], v[174:177], v[200:203]
    s_waitcnt lgkmcnt(1)
    v_mfma_f32_16x16x32_bf16 v[200:203], v[116:119], v[176:179], v[200:203]
    v_mfma_f32_16x16x32_bf16 v[204:207], v[150:153], v[174:177], v[204:207]
    s_waitcnt lgkmcnt(0)
    v_mfma_f32_16x16x32_bf16 v[204:207], v[152:155], v[176:179], v[204:207]
    v_mfma_f32_16x16x32_bf16 v[208:211], v[108:111], v[174:177], v[208:211]
    v_sub_f32 v196, v196, v248
    v_sub_f32 v197, v197, v248
    v_mfma_f32_16x16x32_bf16 v[208:211], v[110:113], v[176:179], v[208:211]
    v_exp_f32 v196, v196
    v_exp_f32 v197, v197
    v_sub_f32 v198, v198, v248
    v_exp_f32 v198, v198
    v_sub_f32 v199, v199, v248
    v_exp_f32 v199, v199
    v_cvt_pk_bf16_f32 v190, v196, v197
    v_cvt_pk_bf16_f32 v193, v198, v199
    ds_read_b128 v[196:199], v245 offset:64
    v_sub_f32 v200, v200, v248
    v_exp_f32 v200, v200
    v_sub_f32 v201, v201, v248
    v_exp_f32 v201, v201
    v_sub_f32 v202, v202, v248
    v_exp_f32 v202, v202
    v_sub_f32 v203, v203, v248
    v_exp_f32 v203, v203
    v_cvt_pk_bf16_f32 v188, v200, v201
    v_cvt_pk_bf16_f32 v191, v202, v203
    ds_read_b128 v[200:203], v246 offset:64
    v_sub_f32 v204, v204, v248
    v_exp_f32 v204, v204
    v_sub_f32 v205, v205, v248
    v_exp_f32 v205, v205
    v_sub_f32 v206, v206, v248
    v_exp_f32 v206, v206
    v_sub_f32 v207, v207, v248
    v_exp_f32 v207, v207
    v_cvt_pk_bf16_f32 v189, v204, v205
    v_cvt_pk_bf16_f32 v192, v206, v207
    s_waitcnt lgkmcnt(1)
    v_mfma_f32_16x16x32_bf16 v[212:215], v[18:21], v[188:191], 0
    v_sub_f32 v208, v208, v248
    v_sub_f32 v209, v209, v248
    v_mfma_f32_16x16x32_bf16 v[216:219], v[48:51], v[188:191], 0
    v_exp_f32 v208, v208
    v_mfma_f32_16x16x32_bf16 v[220:223], v[78:81], v[188:191], 0
    v_exp_f32 v209, v209
    v_mfma_f32_16x16x32_bf16 v[224:227], a[248:251], v[188:191], 0
    v_sub_f32 v210, v210, v248
    v_sub_f32 v211, v211, v248
    v_mfma_f32_16x16x32_bf16 v[196:199], v[120:123], v[174:177], v[196:199]
    s_waitcnt lgkmcnt(0)
    v_exp_f32 v210, v210
    v_mfma_f32_16x16x32_bf16 v[196:199], v[122:125], v[176:179], v[196:199]
    v_exp_f32 v211, v211
    v_mfma_f32_16x16x32_bf16 v[200:203], v[156:159], v[174:177], v[200:203]
    ds_read_b64 v[174:175], v247 offset:55296
    v_cvt_pk_bf16_f32 v180, v208, v209
    v_mfma_f32_16x16x32_bf16 v[200:203], v[158:161], v[176:179], v[200:203]
    ds_read_b64 v[176:177], v247 offset:55424
    ds_read_b64 v[178:179], v247 offset:55552
    v_cvt_pk_bf16_f32 v183, v210, v211
    v_sub_f32 v196, v196, v248
    v_exp_f32 v196, v196
    v_sub_f32 v197, v197, v248
    v_exp_f32 v197, v197
    v_sub_f32 v198, v198, v248
    v_exp_f32 v198, v198
    v_sub_f32 v199, v199, v248
    v_exp_f32 v199, v199
    v_cvt_pk_bf16_f32 v194, v196, v197
    v_cvt_pk_bf16_f32 v181, v198, v199
    v_sub_f32 v200, v200, v248
    v_exp_f32 v200, v200
    v_sub_f32 v201, v201, v248
    v_exp_f32 v201, v201
    v_sub_f32 v202, v202, v248
    v_exp_f32 v202, v202
    v_sub_f32 v203, v203, v248
    v_exp_f32 v203, v203
    v_cvt_pk_bf16_f32 v195, v200, v201
    v_cvt_pk_bf16_f32 v182, v202, v203
    v_mov_b32 v204, 0x237c0
    v_mfma_f32_16x16x32_bf16 v[212:215], v[22:25], v[192:195], v[212:215]
    s_waitcnt lgkmcnt(2)
    v_add_u32 v205, 0xfffff900, v245
    v_cndmask_b32 v205, v244, v205, vcc
    v_mfma_f32_16x16x32_bf16 v[216:219], v[52:55], v[192:195], v[216:219]
    s_mov_b32 vcc_lo, 0xff00ff00
    v_add_u32 v206, 0xc0, v205
    v_add_u32 v205, 0x340, v205
    v_mfma_f32_16x16x32_bf16 v[220:223], v[82:85], v[192:195], v[220:223]
    s_mov_b32 vcc_hi, 0xff00ff00
    v_cndmask_b32 v244, v206, v205, vcc
    v_add_u32 v245, 0x700, v244
    v_mfma_f32_16x16x32_bf16 v[224:227], a[248:251], v[192:195], v[224:227]
    s_mov_b32 vcc_lo, 0xf0f0
    s_mov_b32 vcc_hi, 0x0
    v_cndmask_b32 v244, v244, v204, vcc
    v_mfma_f32_16x16x32_bf16 v[212:215], v[26:29], v[180:183], v[212:215]
    ds_read_b128 v[196:199], v244 offset:64
    s_mov_b32 vcc_lo, 0x0
    v_mfma_f32_16x16x32_bf16 v[216:219], v[56:59], v[180:183], v[216:219]
    s_mov_b32 vcc_hi, 0xf0f0000
    v_cndmask_b32 v245, v245, v204, vcc
    v_mov_b32 v189, 0
    v_mfma_f32_16x16x32_bf16 v[220:223], v[86:89], v[180:183], v[220:223]
    ds_read_b128 v[204:207], v244 offset:0
    ds_read_b128 v[208:211], v245 offset:0
    v_mfma_f32_16x16x32_bf16 v[224:227], a[248:251], v[180:183], v[224:227]
    ds_read_b128 v[200:203], v245 offset:64
    v_mov_b32 v192, 0
    v_mov_b32 v195, 0
    v_mov_b32 v182, 0
    s_mov_b32 vcc_lo, 0xff000f
    s_mov_b32 vcc_hi, 0xff00ff
    s_nop 1
    v_rcp_f32 v225, v224
    s_nop 0
    v_mul_f32 v212, v212, v225
    v_mul_f32 v213, v213, v225
    v_mul_f32 v214, v214, v225
    v_mul_f32 v215, v215, v225
    v_cvt_pk_bf16_f32 v212, v212, v213
    v_cvt_pk_bf16_f32 v213, v214, v215
    ds_write_b64 v247, v[212:213] offset:43008
    s_waitcnt lgkmcnt(4)
    v_mfma_f32_16x16x32_bf16 v[196:199], v[90:93], v[168:171], v[196:199]
    v_mul_f32 v216, v216, v225
    v_mul_f32 v217, v217, v225
    v_mfma_f32_16x16x32_bf16 v[196:199], v[92:95], v[170:173], v[196:199]
    s_waitcnt lgkmcnt(3)
    v_mul_f32 v218, v218, v225
    v_mul_f32 v219, v219, v225
    v_mfma_f32_16x16x32_bf16 v[204:207], v[96:99], v[168:171], v[204:207]
    s_waitcnt lgkmcnt(2)
    v_cvt_pk_bf16_f32 v216, v216, v217
    v_cvt_pk_bf16_f32 v217, v218, v219
    v_mfma_f32_16x16x32_bf16 v[204:207], v[98:101], v[170:173], v[204:207]
    ds_write_b64 v247, v[216:217] offset:43136
    v_mfma_f32_16x16x32_bf16 v[208:211], v[132:135], v[168:171], v[208:211]
    s_waitcnt lgkmcnt(2)
    v_mul_f32 v220, v220, v225
    v_mul_f32 v221, v221, v225
    v_mfma_f32_16x16x32_bf16 v[208:211], v[134:137], v[170:173], v[208:211]
    v_mul_f32 v222, v222, v225
    v_mul_f32 v223, v223, v225
    v_mfma_f32_16x16x32_bf16 v[200:203], v[126:129], v[168:171], v[200:203]
    v_cvt_pk_bf16_f32 v220, v220, v221
    v_cvt_pk_bf16_f32 v221, v222, v223
    v_mfma_f32_16x16x32_bf16 v[200:203], v[128:131], v[170:173], v[200:203]
    ds_write_b64 v247, v[220:221] offset:43264
    v_mfma_f32_16x16x32_bf16 v[236:239], a[144:147], a[216:219], 0
    v_max_f32 v248, v204, v205
    v_max3_f32 v248, v248, v206, v207
    v_mfma_f32_16x16x32_bf16 v[236:239], a[148:151], a[220:223], v[236:239]
    ds_read_b128 v[204:207], v244 offset:128
    v_max3_f32 v248, v248, v208, v209
    v_mfma_f32_16x16x32_bf16 v[236:239], a[152:155], a[224:227], v[236:239]
    v_max3_f32 v248, v248, v210, v211
    v_max3_f32 v248, v248, v196, v197
    v_mfma_f32_16x16x32_bf16 v[236:239], a[156:159], a[228:231], v[236:239]
    ds_read_b128 v[208:211], v245 offset:128
    v_max3_f32 v248, v248, v198, v199
    v_mfma_f32_16x16x32_bf16 v[236:239], a[160:163], a[232:235], v[236:239]
    ds_read_b128 v[196:199], v244 offset:192
    v_max3_f32 v248, v248, v200, v201
    v_mfma_f32_16x16x32_bf16 v[236:239], a[164:167], a[236:239], v[236:239]
    v_max3_f32 v248, v248, v202, v203
    v_mfma_f32_16x16x32_bf16 v[228:231], a[168:171], a[216:219], 0
    ds_read_b128 v[200:203], v245 offset:192
    v_mfma_f32_16x16x32_bf16 v[228:231], a[172:175], a[220:223], v[228:231]
    v_mfma_f32_16x16x32_bf16 v[228:231], a[176:179], a[224:227], v[228:231]
    v_mfma_f32_16x16x32_bf16 v[228:231], a[180:183], a[228:231], v[228:231]
    v_mfma_f32_16x16x32_bf16 v[228:231], a[184:187], a[232:235], v[228:231]
    s_waitcnt lgkmcnt(3)
    v_cvt_pk_bf16_f32 v236, v236, v237
    v_cvt_pk_bf16_f32 v237, v238, v239
    v_mfma_f32_16x16x32_bf16 v[204:207], v[138:141], v[168:171], v[204:207]
    ds_write_b64 v249, v[236:237] offset:6144
    v_mfma_f32_16x16x32_bf16 v[204:207], v[140:143], v[170:173], v[204:207]
    s_waitcnt lgkmcnt(2)
    v_mfma_f32_16x16x32_bf16 v[208:211], v[144:147], v[168:171], v[208:211]
    v_mfma_f32_16x16x32_bf16 v[208:211], v[146:149], v[170:173], v[208:211]
    s_waitcnt lgkmcnt(1)
    v_mfma_f32_16x16x32_bf16 v[196:199], v[114:117], v[168:171], v[196:199]
    v_mfma_f32_16x16x32_bf16 v[196:199], v[116:119], v[170:173], v[196:199]
    v_mfma_f32_16x16x32_bf16 v[200:203], v[150:153], v[168:171], v[200:203]
    v_mfma_f32_16x16x32_bf16 v[200:203], v[152:155], v[170:173], v[200:203]
    v_max3_f32 v248, v248, v204, v205
    v_max3_f32 v248, v248, v206, v207
    v_mfma_f32_16x16x32_bf16 v[228:231], a[188:191], a[236:239], v[228:231]
    ds_read_b128 v[204:207], v244 offset:0
    v_max3_f32 v248, v248, v208, v209
    v_mfma_f32_16x16x32_bf16 v[232:235], a[192:195], a[216:219], 0
    ds_read_b128 a[216:219], v242 offset:30848
    v_max3_f32 v248, v248, v210, v211
    v_mfma_f32_16x16x32_bf16 v[232:235], a[196:199], a[220:223], v[232:235]
    ds_read_b128 a[220:223], v243 offset:30848
    ds_read_b128 v[208:211], v245 offset:0
    v_mfma_f32_16x16x32_bf16 v[232:235], a[200:203], a[224:227], v[232:235]
    ds_read_b128 a[224:227], v242 offset:30976
    v_cvt_pk_bf16_f32 v228, v228, v229
    v_mfma_f32_16x16x32_bf16 v[232:235], a[204:207], a[228:231], v[232:235]
    ds_read_b128 a[228:231], v243 offset:30976
    v_cvt_pk_bf16_f32 v229, v230, v231
    v_mfma_f32_16x16x32_bf16 v[232:235], a[208:211], a[232:235], v[232:235]
    ds_write_b64 v249, v[228:229] offset:6272
    v_mfma_f32_16x16x32_bf16 v[232:235], a[212:215], a[236:239], v[232:235]
    ds_read_b128 a[232:235], v242 offset:0
    ds_read_b128 a[236:239], v243 offset:0
    v_mfma_f32_16x16x32_bf16 v[236:239], a[144:147], a[240:243], 0
    v_max3_f32 v248, v248, v196, v197
    v_max3_f32 v248, v248, v200, v201
    v_mfma_f32_16x16x32_bf16 v[236:239], a[148:151], a[244:247], v[236:239]
    ds_read_b128 v[196:199], v244 offset:64
    ds_read_b128 v[200:203], v245 offset:64
    v_mfma_f32_16x16x32_bf16 v[228:231], a[168:171], a[240:243], 0
    s_waitcnt lgkmcnt(9)
    v_cvt_pk_bf16_f32 v232, v232, v233
    v_cvt_pk_bf16_f32 v233, v234, v235
    v_mfma_f32_16x16x32_bf16 v[204:207], v[96:99], v[168:171], v[204:207]
    ds_write_b64 v249, v[232:233] offset:6400
    v_mfma_f32_16x16x32_bf16 v[204:207], v[98:101], v[170:173], v[204:207]
    s_waitcnt lgkmcnt(8)
    v_mov_b32 v225, v248
    v_mfma_f32_16x16x32_bf16 v[208:211], v[132:135], v[168:171], v[208:211]
    v_mfma_f32_16x16x32_bf16 v[208:211], v[134:137], v[170:173], v[208:211]
    s_waitcnt lgkmcnt(7)
    v_permlane16_swap_b32 v248, v225
    v_max_f32 v248, v248, v225
    v_mfma_f32_16x16x32_bf16 v[236:239], a[152:155], a[216:219], v[236:239]
    s_waitcnt lgkmcnt(6)
    v_mov_b32 v225, v248
    v_mfma_f32_16x16x32_bf16 v[236:239], a[156:159], a[220:223], v[236:239]
    v_mfma_f32_16x16x32_bf16 v[236:239], a[160:163], a[224:227], v[236:239]
    s_waitcnt lgkmcnt(4)
    v_permlane32_swap_b32 v248, v225
    v_max_f32 v248, v248, v225
    v_mfma_f32_16x16x32_bf16 v[236:239], a[164:167], a[228:231], v[236:239]
    s_waitcnt lgkmcnt(2)
    v_sub_f32 v204, v204, v248
    v_sub_f32 v205, v205, v248
    v_mfma_f32_16x16x32_bf16 v[196:199], v[90:93], v[168:171], v[196:199]
    s_waitcnt lgkmcnt(1)
    v_exp_f32 v204, v204
    v_mfma_f32_16x16x32_bf16 v[196:199], v[92:95], v[170:173], v[196:199]
    s_waitcnt lgkmcnt(0)
    v_cvt_pk_bf16_f32 v236, v236, v237
    v_cvt_pk_bf16_f32 v237, v238, v239
    v_mfma_f32_16x16x32_bf16 v[200:203], v[126:129], v[168:171], v[200:203]
    s_barrier
    v_mfma_f32_16x16x32_bf16 v[200:203], v[128:131], v[170:173], v[200:203]
    ds_write_b64 v249, v[236:237] offset:12288
    v_mfma_f32_16x16x32_bf16 v[228:231], a[172:175], a[244:247], v[228:231]
    ds_read_b128 a[252:255], v252 offset:0
    ds_read_b64 v[254:255], v253 offset:256
    v_mfma_f32_16x16x32_bf16 v[228:231], a[176:179], a[216:219], v[228:231]
    v_exp_f32 v205, v205
    v_mfma_f32_16x16x32_bf16 v[228:231], a[180:183], a[220:223], v[228:231]
    v_sub_f32 v206, v206, v248
    v_sub_f32 v207, v207, v248
    v_mfma_f32_16x16x32_bf16 v[228:231], a[184:187], a[224:227], v[228:231]
    v_exp_f32 v206, v206
    v_mfma_f32_16x16x32_bf16 v[228:231], a[188:191], a[228:231], v[228:231]
    v_exp_f32 v207, v207
    v_mfma_f32_16x16x32_bf16 v[232:235], a[192:195], a[240:243], 0
    ds_read_b128 a[240:243], v242 offset:128
    v_cvt_pk_bf16_f32 v184, v204, v205
    v_mfma_f32_16x16x32_bf16 v[232:235], a[196:199], a[244:247], v[232:235]
    ds_read_b128 a[244:247], v243 offset:128
    v_cvt_pk_bf16_f32 v187, v206, v207
    v_mfma_f32_16x16x32_bf16 v[232:235], a[200:203], a[216:219], v[232:235]
    ds_read_b128 a[216:219], v242 offset:256
    v_cvt_pk_bf16_f32 v228, v228, v229
    v_mfma_f32_16x16x32_bf16 v[232:235], a[204:207], a[220:223], v[232:235]
    ds_read_b128 a[220:223], v243 offset:256
    v_cvt_pk_bf16_f32 v229, v230, v231
    v_mfma_f32_16x16x32_bf16 v[232:235], a[208:211], a[224:227], v[232:235]
    ds_write_b64 v249, v[228:229] offset:12416
    v_mfma_f32_16x16x32_bf16 v[232:235], a[212:215], a[228:231], v[232:235]
    ds_read_b128 a[224:227], v242 offset:36864
    ds_read_b128 a[228:231], v243 offset:36864
    v_mfma_f32_16x16x32_bf16 v[236:239], a[144:147], a[232:235], 0
    ds_read_b128 v[204:207], v244 offset:128
    s_waitcnt lgkmcnt(8)
    v_mfma_f32_16x16x32_bf16 v[236:239], a[148:151], a[236:239], v[236:239]
    buffer_store_dwordx4 a[252:255], v250, s[20:23], s51 offen nt
    v_mfma_f32_16x16x32_bf16 v[228:231], a[168:171], a[232:235], 0
    s_waitcnt lgkmcnt(7)
    v_cvt_pk_bf16_f32 v232, v232, v233
    v_cvt_pk_bf16_f32 v233, v234, v235
    v_mfma_f32_16x16x32_bf16 v[236:239], a[152:155], a[240:243], v[236:239]
    ds_write_b64 v249, v[232:233] offset:12544
    v_mfma_f32_16x16x32_bf16 v[228:231], a[172:175], a[236:239], v[228:231]
    buffer_store_dwordx2 v[254:255], v251, s[20:23], s51 offen offset:256 nt
    v_mfma_f32_16x16x32_bf16 v[228:231], a[176:179], a[240:243], v[228:231]
    ds_read_b128 a[252:255], v252 offset:6144
    ds_read_b64 v[254:255], v253 offset:6400
    v_mfma_f32_16x16x32_bf16 v[232:235], a[192:195], a[232:235], 0
    ds_read_b128 a[232:235], v242 offset:36992
    s_mul_i32 s51, s31, 15
    v_mfma_f32_16x16x32_bf16 v[232:235], a[196:199], a[236:239], v[232:235]
    ds_read_b128 a[236:239], v243 offset:36992
    s_add_u32 s57, s57, s51
    v_mfma_f32_16x16x32_bf16 v[232:235], a[200:203], a[240:243], v[232:235]
    s_waitcnt lgkmcnt(5)
    ds_read_b128 a[240:243], v242 offset:37120
    v_mfma_f32_16x16x32_bf16 v[204:207], v[138:141], v[168:171], v[204:207]
    s_add_u32 s57, s57, s32
    s_and_b32 s51, s28, 1
    s_add_u32 s51, s51, 15
    v_mfma_f32_16x16x32_bf16 v[204:207], v[140:143], v[170:173], v[204:207]
    s_mul_i32 s51, s51, s30
    v_sub_f32 v208, v208, v248
    v_sub_f32 v209, v209, v248
    v_mfma_f32_16x16x32_bf16 v[236:239], a[156:159], a[244:247], v[236:239]
    v_exp_f32 v208, v208
    v_mfma_f32_16x16x32_bf16 v[236:239], a[160:163], a[216:219], v[236:239]
    v_exp_f32 v209, v209
    v_mfma_f32_16x16x32_bf16 v[236:239], a[164:167], a[220:223], v[236:239]
    s_waitcnt lgkmcnt(4)
    v_sub_f32 v210, v210, v248
    s_waitcnt lgkmcnt(3)
    v_mfma_f32_16x16x32_bf16 v[228:231], a[180:183], a[244:247], v[228:231]
    buffer_store_dwordx4 a[252:255], v250, s[20:23], s53 offen nt
    v_mfma_f32_16x16x32_bf16 v[228:231], a[184:187], a[216:219], v[228:231]
    s_waitcnt lgkmcnt(2)
    v_exp_f32 v210, v210
    v_mfma_f32_16x16x32_bf16 v[228:231], a[188:191], a[220:223], v[228:231]
    s_waitcnt lgkmcnt(1)
    v_cvt_pk_bf16_f32 v236, v236, v237
    v_cvt_pk_bf16_f32 v237, v238, v239
    v_mfma_f32_16x16x32_bf16 v[232:235], a[204:207], a[244:247], v[232:235]
    ds_write_b64 v249, v[236:237] offset:18432
    v_mfma_f32_16x16x32_bf16 v[232:235], a[208:211], a[216:219], v[232:235]
    ds_read_b128 a[244:247], v243 offset:37120
    ds_read_b128 a[216:219], v242 offset:43008
    v_mfma_f32_16x16x32_bf16 v[232:235], a[212:215], a[220:223], v[232:235]
    v_cvt_pk_bf16_f32 v228, v228, v229
    v_cvt_pk_bf16_f32 v229, v230, v231
    ds_write_b64 v249, v[228:229] offset:18560
    ds_read_b128 a[220:223], v243 offset:43008
    buffer_store_dwordx2 v[254:255], v251, s[20:23], s53 offen offset:256 nt
    s_mul_i32 s53, s31, 13
    s_add_u32 s52, s52, s53
    s_add_u32 s52, s52, s32
    v_cvt_pk_bf16_f32 v232, v232, v233
    v_cvt_pk_bf16_f32 v233, v234, v235
    ds_write_b64 v249, v[232:233] offset:18688
    s_lshr_b32 s53, s28, 1
    s_sub_u32 s53, s53, 1
    v_sub_f32 v211, v211, v248
    v_exp_f32 v211, v211
    v_cvt_pk_bf16_f32 v185, v208, v209
    v_cvt_pk_bf16_f32 v188, v210, v211
    ds_read_b128 v[208:211], v245 offset:128
    v_mfma_f32_16x16x32_bf16 v[212:215], v[0:3], v[184:187], 0
    s_waitcnt lgkmcnt(5)
    v_sub_f32 v196, v196, v248
    v_sub_f32 v197, v197, v248
    v_mfma_f32_16x16x32_bf16 v[216:219], v[30:33], v[184:187], 0
    s_waitcnt lgkmcnt(4)
    v_exp_f32 v196, v196
    v_mfma_f32_16x16x32_bf16 v[220:223], v[60:63], v[184:187], 0
    v_exp_f32 v197, v197
    v_mfma_f32_16x16x32_bf16 v[224:227], a[248:251], v[184:187], 0
    v_sub_f32 v198, v198, v248
    v_exp_f32 v198, v198
    v_sub_f32 v199, v199, v248
    v_exp_f32 v199, v199
    v_cvt_pk_bf16_f32 v190, v196, v197
    v_cvt_pk_bf16_f32 v193, v198, v199
    ds_read_b128 v[196:199], v244 offset:192
    v_sub_f32 v200, v200, v248
    v_exp_f32 v200, v200
    v_sub_f32 v201, v201, v248
    v_exp_f32 v201, v201
    s_waitcnt lgkmcnt(1)
    v_mfma_f32_16x16x32_bf16 v[208:211], v[144:147], v[168:171], v[208:211]
    v_sub_f32 v202, v202, v248
    v_sub_f32 v203, v203, v248
    v_mfma_f32_16x16x32_bf16 v[208:211], v[146:149], v[170:173], v[208:211]
    v_exp_f32 v202, v202
    v_exp_f32 v203, v203
    v_cvt_pk_bf16_f32 v191, v200, v201
    v_cvt_pk_bf16_f32 v194, v202, v203
    ds_read_b128 v[200:203], v245 offset:192
    v_mfma_f32_16x16x32_bf16 v[212:215], v[4:7], v[188:191], v[212:215]
    v_sub_f32 v204, v204, v248
    v_sub_f32 v205, v205, v248
    v_mfma_f32_16x16x32_bf16 v[216:219], v[34:37], v[188:191], v[216:219]
    v_exp_f32 v204, v204
    v_mfma_f32_16x16x32_bf16 v[220:223], v[64:67], v[188:191], v[220:223]
    s_waitcnt lgkmcnt(1)
    v_exp_f32 v205, v205
    v_mfma_f32_16x16x32_bf16 v[224:227], a[248:251], v[188:191], v[224:227]
    v_sub_f32 v206, v206, v248
    v_sub_f32 v207, v207, v248
    v_mfma_f32_16x16x32_bf16 v[212:215], v[8:11], v[192:195], v[212:215]
    v_exp_f32 v206, v206
    v_mfma_f32_16x16x32_bf16 v[216:219], v[38:41], v[192:195], v[216:219]
    v_exp_f32 v207, v207
    v_mfma_f32_16x16x32_bf16 v[220:223], v[68:71], v[192:195], v[220:223]
    v_cvt_pk_bf16_f32 v180, v204, v205
    v_cvt_pk_bf16_f32 v183, v206, v207
    v_mfma_f32_16x16x32_bf16 v[224:227], a[248:251], v[192:195], v[224:227]
    v_sub_f32 v208, v208, v248
    v_sub_f32 v209, v209, v248
    v_mfma_f32_16x16x32_bf16 v[196:199], v[114:117], v[168:171], v[196:199]
    s_waitcnt lgkmcnt(0)
    v_exp_f32 v208, v208
    v_mfma_f32_16x16x32_bf16 v[196:199], v[116:119], v[170:173], v[196:199]
    v_exp_f32 v209, v209
    v_mfma_f32_16x16x32_bf16 v[200:203], v[150:153], v[168:171], v[200:203]
    v_sub_f32 v210, v210, v248
    v_sub_f32 v211, v211, v248
    v_mfma_f32_16x16x32_bf16 v[200:203], v[152:155], v[170:173], v[200:203]
    v_exp_f32 v210, v210
    v_exp_f32 v211, v211
    v_cvt_pk_bf16_f32 v181, v208, v209
    v_cvt_pk_bf16_f32 v184, v210, v211
    v_sub_f32 v196, v196, v248
    v_mfma_f32_16x16x32_bf16 v[212:215], v[12:15], v[180:183], v[212:215]
    v_exp_f32 v196, v196
    v_mfma_f32_16x16x32_bf16 v[216:219], v[42:45], v[180:183], v[216:219]
    v_sub_f32 v197, v197, v248
    v_sub_f32 v200, v200, v248
    v_mfma_f32_16x16x32_bf16 v[220:223], v[72:75], v[180:183], v[220:223]
    v_exp_f32 v197, v197
    v_mfma_f32_16x16x32_bf16 v[224:227], a[248:251], v[180:183], v[224:227]
    v_cvt_pk_bf16_f32 v186, v196, v197
    v_exp_f32 v200, v200
    v_sub_f32 v201, v201, v248
    v_exp_f32 v201, v201
    v_mov_b32 v185, 0
    v_cvt_pk_bf16_f32 v187, v200, v201
    v_add_u32 v204, 0xffffff40, v244
    v_cndmask_b32 v244, v244, v204, vcc
    v_mfma_f32_16x16x32_bf16 v[212:215], v[16:19], v[184:187], v[212:215]
    ds_read_b128 v[196:199], v244 offset:64
    v_add_u32 v205, 0xffffff40, v245
    v_mfma_f32_16x16x32_bf16 v[216:219], v[46:49], v[184:187], v[216:219]
    s_mov_b32 vcc_lo, 0xff00ff
    s_mov_b32 vcc_hi, 0xf000ff
    v_cndmask_b32 v245, v245, v205, vcc
    v_mfma_f32_16x16x32_bf16 v[220:223], v[76:79], v[184:187], v[220:223]
    ds_read_b128 v[204:207], v244 offset:0
    ds_read_b128 v[208:211], v245 offset:0
    v_mfma_f32_16x16x32_bf16 v[224:227], a[248:251], v[184:187], v[224:227]
    ds_read_b128 v[200:203], v245 offset:64
    v_mov_b32 v190, 0
    v_mov_b32 v193, 0
    v_mov_b32 v180, 0
    v_mov_b32 v183, 0
    v_mov_b32 v186, 0
    s_nop 1
    v_rcp_f32 v225, v224
    s_nop 0
    v_mul_f32 v212, v212, v225
    v_mul_f32 v213, v213, v225
    v_mul_f32 v214, v214, v225
    v_mul_f32 v215, v215, v225
    v_cvt_pk_bf16_f32 v212, v212, v213
    v_cvt_pk_bf16_f32 v213, v214, v215
    ds_write_b64 v247, v[212:213] offset:49152
    s_waitcnt lgkmcnt(4)
    v_mfma_f32_16x16x32_bf16 v[196:199], v[114:117], v[174:177], v[196:199]
    v_mul_f32 v216, v216, v225
    v_mul_f32 v217, v217, v225
    v_mfma_f32_16x16x32_bf16 v[196:199], v[116:119], v[176:179], v[196:199]
    s_waitcnt lgkmcnt(3)
    v_mul_f32 v218, v218, v225
    v_mul_f32 v219, v219, v225
    v_mfma_f32_16x16x32_bf16 v[204:207], v[138:141], v[174:177], v[204:207]
    s_waitcnt lgkmcnt(2)
    v_cvt_pk_bf16_f32 v216, v216, v217
    v_cvt_pk_bf16_f32 v217, v218, v219
    v_mfma_f32_16x16x32_bf16 v[204:207], v[140:143], v[176:179], v[204:207]
    ds_write_b64 v247, v[216:217] offset:49280
    v_mfma_f32_16x16x32_bf16 v[208:211], v[144:147], v[174:177], v[208:211]
    s_waitcnt lgkmcnt(2)
    v_mul_f32 v220, v220, v225
    v_mul_f32 v221, v221, v225
    v_mfma_f32_16x16x32_bf16 v[208:211], v[146:149], v[176:179], v[208:211]
    v_mul_f32 v222, v222, v225
    v_mul_f32 v223, v223, v225
    v_mfma_f32_16x16x32_bf16 v[200:203], v[150:153], v[174:177], v[200:203]
    v_cvt_pk_bf16_f32 v220, v220, v221
    v_cvt_pk_bf16_f32 v221, v222, v223
    v_mfma_f32_16x16x32_bf16 v[200:203], v[152:155], v[176:179], v[200:203]
    ds_write_b64 v247, v[220:221] offset:49408
    v_mfma_f32_16x16x32_bf16 v[236:239], a[144:147], a[224:227], 0
    v_max_f32 v248, v204, v205
    v_max3_f32 v248, v248, v206, v207
    v_mfma_f32_16x16x32_bf16 v[236:239], a[148:151], a[228:231], v[236:239]
    ds_read_b128 v[204:207], v244 offset:128
    v_max3_f32 v248, v248, v208, v209
    v_mfma_f32_16x16x32_bf16 v[236:239], a[152:155], a[232:235], v[236:239]
    v_max3_f32 v248, v248, v210, v211
    v_max3_f32 v248, v248, v196, v197
    v_mfma_f32_16x16x32_bf16 v[236:239], a[156:159], a[236:239], v[236:239]
    ds_read_b128 v[208:211], v245 offset:128
    v_max3_f32 v248, v248, v198, v199
    v_mfma_f32_16x16x32_bf16 v[236:239], a[160:163], a[240:243], v[236:239]
    ds_read_b128 v[196:199], v244 offset:0
    v_max3_f32 v248, v248, v200, v201
    v_mfma_f32_16x16x32_bf16 v[236:239], a[164:167], a[244:247], v[236:239]
    v_max3_f32 v248, v248, v202, v203
    v_mfma_f32_16x16x32_bf16 v[228:231], a[168:171], a[224:227], 0
    ds_read_b128 v[200:203], v245 offset:0
    v_mfma_f32_16x16x32_bf16 v[228:231], a[172:175], a[228:231], v[228:231]
    v_mfma_f32_16x16x32_bf16 v[228:231], a[176:179], a[232:235], v[228:231]
    v_mfma_f32_16x16x32_bf16 v[228:231], a[180:183], a[236:239], v[228:231]
    v_mfma_f32_16x16x32_bf16 v[228:231], a[184:187], a[240:243], v[228:231]
    s_waitcnt lgkmcnt(3)
    v_cvt_pk_bf16_f32 v236, v236, v237
    v_cvt_pk_bf16_f32 v237, v238, v239
    v_mfma_f32_16x16x32_bf16 v[204:207], v[120:123], v[174:177], v[204:207]
    ds_write_b64 v249, v[236:237] offset:24576
    v_mfma_f32_16x16x32_bf16 v[204:207], v[122:125], v[176:179], v[204:207]
    s_waitcnt lgkmcnt(2)
    v_mfma_f32_16x16x32_bf16 v[208:211], v[156:159], v[174:177], v[208:211]
    v_mfma_f32_16x16x32_bf16 v[208:211], v[158:161], v[176:179], v[208:211]
    s_waitcnt lgkmcnt(1)
    v_mfma_f32_16x16x32_bf16 v[196:199], v[138:141], v[174:177], v[196:199]
    v_mfma_f32_16x16x32_bf16 v[196:199], v[140:143], v[176:179], v[196:199]
    v_mfma_f32_16x16x32_bf16 v[200:203], v[144:147], v[174:177], v[200:203]
    v_mfma_f32_16x16x32_bf16 v[200:203], v[146:149], v[176:179], v[200:203]
    v_max3_f32 v248, v248, v204, v205
    v_max3_f32 v248, v248, v206, v207
    v_mfma_f32_16x16x32_bf16 v[228:231], a[188:191], a[244:247], v[228:231]
    ds_read_b128 v[204:207], v244 offset:64
    v_max3_f32 v248, v248, v208, v209
    v_mfma_f32_16x16x32_bf16 v[232:235], a[192:195], a[224:227], 0
    ds_read_b128 a[224:227], v242 offset:43136
    v_max3_f32 v248, v248, v210, v211
    v_mfma_f32_16x16x32_bf16 v[232:235], a[196:199], a[228:231], v[232:235]
    ds_read_b128 a[228:231], v243 offset:43136
    ds_read_b128 v[208:211], v245 offset:64
    v_mfma_f32_16x16x32_bf16 v[232:235], a[200:203], a[232:235], v[232:235]
    ds_read_b128 a[232:235], v242 offset:43264
    v_cvt_pk_bf16_f32 v228, v228, v229
    v_mfma_f32_16x16x32_bf16 v[232:235], a[204:207], a[236:239], v[232:235]
    ds_read_b128 a[236:239], v243 offset:43264
    v_cvt_pk_bf16_f32 v229, v230, v231
    v_mfma_f32_16x16x32_bf16 v[232:235], a[208:211], a[240:243], v[232:235]
    ds_write_b64 v249, v[228:229] offset:24704
    v_mfma_f32_16x16x32_bf16 v[232:235], a[212:215], a[244:247], v[232:235]
    v_mov_b32 v225, v248
    v_mfma_f32_16x16x32_bf16 v[236:239], a[144:147], a[216:219], 0
    v_mfma_f32_16x16x32_bf16 v[236:239], a[148:151], a[220:223], v[236:239]
    s_waitcnt lgkmcnt(6)
    v_permlane16_swap_b32 v248, v225
    v_max_f32 v248, v248, v225
    v_mfma_f32_16x16x32_bf16 v[204:207], v[114:117], v[174:177], v[204:207]
    s_waitcnt lgkmcnt(5)
    v_cvt_pk_bf16_f32 v232, v232, v233
    v_cvt_pk_bf16_f32 v233, v234, v235
    v_mfma_f32_16x16x32_bf16 v[204:207], v[116:119], v[176:179], v[204:207]
    ds_write_b64 v249, v[232:233] offset:24832
    v_mfma_f32_16x16x32_bf16 v[236:239], a[152:155], a[224:227], v[236:239]
    s_waitcnt lgkmcnt(4)
    v_mov_b32 v225, v248
    v_mfma_f32_16x16x32_bf16 v[208:211], v[150:153], v[174:177], v[208:211]
    v_mfma_f32_16x16x32_bf16 v[208:211], v[152:155], v[176:179], v[208:211]
    s_waitcnt lgkmcnt(3)
    v_permlane32_swap_b32 v248, v225
    v_max_f32 v248, v248, v225
    v_mfma_f32_16x16x32_bf16 v[236:239], a[156:159], a[228:231], v[236:239]
    s_waitcnt lgkmcnt(2)
    v_sub_f32 v196, v196, v248
    v_sub_f32 v197, v197, v248
    v_mfma_f32_16x16x32_bf16 v[236:239], a[160:163], a[232:235], v[236:239]
    v_exp_f32 v196, v196
    v_mfma_f32_16x16x32_bf16 v[236:239], a[164:167], a[236:239], v[236:239]
    v_exp_f32 v197, v197
    v_mfma_f32_16x16x32_bf16 v[228:231], a[168:171], a[216:219], 0
    v_sub_f32 v198, v198, v248
    v_sub_f32 v199, v199, v248
    v_mfma_f32_16x16x32_bf16 v[228:231], a[172:175], a[220:223], v[228:231]
    s_waitcnt lgkmcnt(0)
    s_barrier
    v_mfma_f32_16x16x32_bf16 v[228:231], a[176:179], a[224:227], v[228:231]
    ds_read_b128 a[240:243], v242 offset:49152
    v_cvt_pk_bf16_f32 v236, v236, v237
    v_mfma_f32_16x16x32_bf16 v[228:231], a[180:183], a[228:231], v[228:231]
    ds_read_b128 a[244:247], v243 offset:49152
    v_cvt_pk_bf16_f32 v237, v238, v239
    v_mfma_f32_16x16x32_bf16 v[228:231], a[184:187], a[232:235], v[228:231]
    ds_write_b64 v249, v[236:237] offset:0
    v_mfma_f32_16x16x32_bf16 v[228:231], a[188:191], a[236:239], v[228:231]
    ds_read_b128 a[252:255], v252 offset:12288
    ds_read_b64 v[254:255], v253 offset:12544
    v_mfma_f32_16x16x32_bf16 v[232:235], a[192:195], a[216:219], 0
    ds_read_b128 a[216:219], v242 offset:49280
    v_cvt_pk_bf16_f32 v188, v196, v197
    v_mfma_f32_16x16x32_bf16 v[232:235], a[196:199], a[220:223], v[232:235]
    ds_read_b128 a[220:223], v243 offset:49280
    v_sub_f32 v200, v200, v248
    v_mfma_f32_16x16x32_bf16 v[232:235], a[200:203], a[224:227], v[232:235]
    ds_read_b128 a[224:227], v242 offset:49408
    v_cvt_pk_bf16_f32 v228, v228, v229
    v_mfma_f32_16x16x32_bf16 v[232:235], a[204:207], a[228:231], v[232:235]
    ds_read_b128 a[228:231], v243 offset:49408
    v_cvt_pk_bf16_f32 v229, v230, v231
    v_mfma_f32_16x16x32_bf16 v[232:235], a[208:211], a[232:235], v[232:235]
    ds_write_b64 v249, v[228:229] offset:128
    v_mfma_f32_16x16x32_bf16 v[232:235], a[212:215], a[236:239], v[232:235]
    v_exp_f32 v198, v198
    v_exp_f32 v199, v199
    v_exp_f32 v200, v200
    v_cvt_pk_bf16_f32 v191, v198, v199
    ds_read_b128 v[196:199], v244 offset:128
    s_waitcnt lgkmcnt(6)
    buffer_store_dwordx4 a[252:255], v250, s[20:23], s55 offen nt
    v_sub_f32 v201, v201, v248
    v_cvt_pk_bf16_f32 v232, v232, v233
    v_cvt_pk_bf16_f32 v233, v234, v235
    ds_write_b64 v249, v[232:233] offset:256
    ds_read_b128 a[252:255], v252 offset:18432
    buffer_store_dwordx2 v[254:255], v251, s[20:23], s55 offen offset:256 nt
    ds_read_b64 v[254:255], v253 offset:18688
    s_mul_i32 s55, s31, 11
    s_add_u32 s54, s54, s55
    s_add_u32 s54, s54, s32
    s_lshr_b32 s55, s28, 1
    s_lshl2_add_u32 s55, s55, 11
    s_mul_i32 s55, s55, s31
    v_exp_f32 v201, v201
    v_sub_f32 v202, v202, v248
    s_waitcnt lgkmcnt(3)
    v_mfma_f32_16x16x32_bf16 v[196:199], v[120:123], v[174:177], v[196:199]
    v_exp_f32 v202, v202
    v_mfma_f32_16x16x32_bf16 v[196:199], v[122:125], v[176:179], v[196:199]
    v_sub_f32 v203, v203, v248
    v_exp_f32 v203, v203
    v_cvt_pk_bf16_f32 v189, v200, v201
    v_cvt_pk_bf16_f32 v192, v202, v203
    ds_read_b128 v[200:203], v245 offset:128
    v_mfma_f32_16x16x32_bf16 v[212:215], v[12:15], v[188:191], 0
    s_waitcnt lgkmcnt(3)
    s_waitcnt lgkmcnt(2)
    s_barrier
    v_mfma_f32_16x16x32_bf16 v[216:219], v[42:45], v[188:191], 0
    s_mov_b32 exec_hi, 0
    buffer_store_dwordx4 a[252:255], v250, s[20:23], s57 offen nt
    s_mov_b32 exec_hi, -1
    v_mfma_f32_16x16x32_bf16 v[220:223], v[72:75], v[188:191], 0
    s_waitcnt lgkmcnt(1)
    v_sub_f32 v204, v204, v248
    v_sub_f32 v205, v205, v248
    v_mfma_f32_16x16x32_bf16 v[224:227], a[248:251], v[188:191], 0
    v_exp_f32 v204, v204
    v_exp_f32 v205, v205
    s_mov_b32 exec_hi, 0
    buffer_store_dwordx2 v[254:255], v251, s[20:23], s57 offen offset:256 nt
    s_mov_b32 exec_hi, -1
    s_waitcnt lgkmcnt(0)
    v_mfma_f32_16x16x32_bf16 v[200:203], v[156:159], v[174:177], v[200:203]
    s_mul_i32 s57, s31, 15
    s_add_u32 s56, s56, s57
    s_add_u32 s56, s56, s32
    v_mfma_f32_16x16x32_bf16 v[200:203], v[158:161], v[176:179], v[200:203]
    v_sub_f32 v206, v206, v248
    v_exp_f32 v206, v206
    v_sub_f32 v207, v207, v248
    s_mov_b32 exec_lo, 0
    buffer_store_dwordx4 a[252:255], v250, s[20:23], s52 offen nt
    s_mov_b32 exec_lo, -1
    v_exp_f32 v207, v207
    v_cvt_pk_bf16_f32 v194, v204, v205
    ds_read_b128 a[252:255], v252 offset:24576
    v_cvt_pk_bf16_f32 v181, v206, v207
    v_sub_f32 v208, v208, v248
    v_exp_f32 v208, v208
    s_mov_b32 exec_lo, 0
    buffer_store_dwordx2 v[254:255], v251, s[20:23], s52 offen offset:256 nt
    s_mov_b32 exec_lo, -1
    ds_read_b64 v[254:255], v253 offset:24832
    s_lshr_b32 s52, s28, 1
    s_lshl2_add_u32 s52, s52, 3
    s_mul_i32 s52, s52, s31
    s_add_u32 s51, s51, s52
    s_add_u32 s51, s51, s32
    v_sub_f32 v209, v209, v248
    v_exp_f32 v209, v209
    v_sub_f32 v210, v210, v248
    v_exp_f32 v210, v210
    v_sub_f32 v211, v211, v248
    v_exp_f32 v211, v211
    v_cvt_pk_bf16_f32 v195, v208, v209
    v_cvt_pk_bf16_f32 v182, v210, v211
    v_sub_f32 v196, v196, v248
    v_mfma_f32_16x16x32_bf16 v[212:215], v[16:19], v[192:195], v[212:215]
    v_exp_f32 v196, v196
    v_mfma_f32_16x16x32_bf16 v[216:219], v[46:49], v[192:195], v[216:219]
    s_waitcnt lgkmcnt(1)
    v_sub_f32 v197, v197, v248
    v_sub_f32 v198, v198, v248
    v_mfma_f32_16x16x32_bf16 v[220:223], v[76:79], v[192:195], v[220:223]
    buffer_store_dwordx4 a[252:255], v250, s[20:23], s54 offen nt
    v_mfma_f32_16x16x32_bf16 v[224:227], a[248:251], v[192:195], v[224:227]
    s_waitcnt lgkmcnt(0)
    ds_read_b128 a[252:255], v252 offset:0
    v_mfma_f32_16x16x32_bf16 v[212:215], v[20:23], v[180:183], v[212:215]
    v_exp_f32 v197, v197
    v_mfma_f32_16x16x32_bf16 v[216:219], v[50:53], v[180:183], v[216:219]
    buffer_store_dwordx2 v[254:255], v251, s[20:23], s54 offen offset:256 nt
    v_mfma_f32_16x16x32_bf16 v[220:223], v[80:83], v[180:183], v[220:223]
    ds_read_b64 v[254:255], v253 offset:256
    s_and_b32 s54, s28, 1
    v_mfma_f32_16x16x32_bf16 v[224:227], a[248:251], v[180:183], v[224:227]
    s_add_u32 s54, s54, 15
    s_mul_i32 s54, s54, s30
    s_add_u32 s54, s54, s55
    s_add_u32 s54, s54, s32
    v_exp_f32 v198, v198
    v_sub_f32 v199, v199, v248
    v_exp_f32 v199, v199
    v_cvt_pk_bf16_f32 v184, v196, v197
    v_cvt_pk_bf16_f32 v187, v198, v199
    v_sub_f32 v200, v200, v248
    v_exp_f32 v200, v200
    v_sub_f32 v201, v201, v248
    v_exp_f32 v201, v201
    s_waitcnt lgkmcnt(1)
    s_mov_b32 exec_hi, 0
    buffer_store_dwordx4 a[252:255], v250, s[20:23], s56 offen nt
    s_mov_b32 exec_hi, -1
    v_sub_f32 v202, v202, v248
    v_exp_f32 v202, v202
    v_sub_f32 v203, v203, v248
    v_exp_f32 v203, v203
    s_waitcnt lgkmcnt(0)
    v_cvt_pk_bf16_f32 v185, v200, v201
    v_cvt_pk_bf16_f32 v188, v202, v203
    s_mov_b32 exec_hi, 0
    buffer_store_dwordx2 v[254:255], v251, s[20:23], s56 offen offset:256 nt
    s_mov_b32 exec_hi, -1
    v_mfma_f32_16x16x32_bf16 v[212:215], v[24:27], v[184:187], v[212:215]
    v_mov_b32 v189, 0
    v_mov_b32 v191, 0
    v_mfma_f32_16x16x32_bf16 v[216:219], v[54:57], v[184:187], v[216:219]
    v_mfma_f32_16x16x32_bf16 v[220:223], v[84:87], v[184:187], v[220:223]
    v_mfma_f32_16x16x32_bf16 v[224:227], a[248:251], v[184:187], v[224:227]
    v_mfma_f32_16x16x32_bf16 v[212:215], v[28:31], v[188:191], v[212:215]
    v_mfma_f32_16x16x32_bf16 v[216:219], v[58:61], v[188:191], v[216:219]
    v_mfma_f32_16x16x32_bf16 v[220:223], v[88:91], v[188:191], v[220:223]
    v_mfma_f32_16x16x32_bf16 v[224:227], a[248:251], v[188:191], v[224:227]
    s_nop 7
    v_rcp_f32 v225, v224
    s_nop 0
    v_mul_f32 v212, v212, v225
    v_mul_f32 v213, v213, v225
    v_mul_f32 v214, v214, v225
    v_mul_f32 v215, v215, v225
    v_cvt_pk_bf16_f32 v212, v212, v213
    v_cvt_pk_bf16_f32 v213, v214, v215
    ds_write_b64 v247, v[212:213] offset:55296
    v_mul_f32 v216, v216, v225
    v_mul_f32 v217, v217, v225
    v_mul_f32 v218, v218, v225
    v_mul_f32 v219, v219, v225
    v_cvt_pk_bf16_f32 v216, v216, v217
    v_cvt_pk_bf16_f32 v217, v218, v219
    ds_write_b64 v247, v[216:217] offset:55424
    v_mul_f32 v220, v220, v225
    v_mul_f32 v221, v221, v225
    v_mul_f32 v222, v222, v225
    v_mul_f32 v223, v223, v225
    v_cvt_pk_bf16_f32 v220, v220, v221
    v_cvt_pk_bf16_f32 v221, v222, v223
    ds_write_b64 v247, v[220:221] offset:55552
    v_mfma_f32_16x16x32_bf16 v[236:239], a[144:147], a[240:243], 0
    v_mfma_f32_16x16x32_bf16 v[236:239], a[148:151], a[244:247], v[236:239]
    v_mfma_f32_16x16x32_bf16 v[236:239], a[152:155], a[216:219], v[236:239]
    v_mfma_f32_16x16x32_bf16 v[236:239], a[156:159], a[220:223], v[236:239]
    v_mfma_f32_16x16x32_bf16 v[236:239], a[160:163], a[224:227], v[236:239]
    v_mfma_f32_16x16x32_bf16 v[236:239], a[164:167], a[228:231], v[236:239]
    v_mfma_f32_16x16x32_bf16 v[228:231], a[168:171], a[240:243], 0
    v_mfma_f32_16x16x32_bf16 v[228:231], a[172:175], a[244:247], v[228:231]
    v_mfma_f32_16x16x32_bf16 v[228:231], a[176:179], a[216:219], v[228:231]
    v_mfma_f32_16x16x32_bf16 v[228:231], a[180:183], a[220:223], v[228:231]
    v_mfma_f32_16x16x32_bf16 v[228:231], a[184:187], a[224:227], v[228:231]
    v_mfma_f32_16x16x32_bf16 v[228:231], a[188:191], a[228:231], v[228:231]
    v_mfma_f32_16x16x32_bf16 v[232:235], a[192:195], a[240:243], 0
    v_mfma_f32_16x16x32_bf16 v[232:235], a[196:199], a[244:247], v[232:235]
    v_cvt_pk_bf16_f32 v236, v236, v237
    v_cvt_pk_bf16_f32 v237, v238, v239
    v_mfma_f32_16x16x32_bf16 v[232:235], a[200:203], a[216:219], v[232:235]
    ds_write_b64 v249, v[236:237] offset:6144
    v_mfma_f32_16x16x32_bf16 v[232:235], a[204:207], a[220:223], v[232:235]
    v_mfma_f32_16x16x32_bf16 v[232:235], a[208:211], a[224:227], v[232:235]
    v_cvt_pk_bf16_f32 v228, v228, v229
    v_cvt_pk_bf16_f32 v229, v230, v231
    v_mfma_f32_16x16x32_bf16 v[232:235], a[212:215], a[228:231], v[232:235]
    ds_write_b64 v249, v[228:229] offset:6272
    s_nop 6
    v_cvt_pk_bf16_f32 v232, v232, v233
    v_cvt_pk_bf16_f32 v233, v234, v235
    ds_write_b64 v249, v[232:233] offset:6400
    s_waitcnt lgkmcnt(0)
    s_barrier
    ds_read_b128 a[232:235], v242 offset:55296
    ds_read_b128 a[236:239], v243 offset:55296
    ds_read_b128 a[240:243], v242 offset:55424
    ds_read_b128 a[244:247], v243 offset:55424
    ds_read_b128 a[216:219], v242 offset:55552
    ds_read_b128 a[220:223], v243 offset:55552
    ds_read_b128 a[252:255], v252 offset:6144
    ds_read_b64 v[254:255], v253 offset:6400
    s_waitcnt lgkmcnt(7)
    v_mfma_f32_16x16x32_bf16 v[236:239], a[144:147], a[232:235], 0
    v_mfma_f32_16x16x32_bf16 v[228:231], a[168:171], a[232:235], 0
    s_waitcnt lgkmcnt(6)
    v_mfma_f32_16x16x32_bf16 v[236:239], a[148:151], a[236:239], v[236:239]
    s_waitcnt lgkmcnt(5)
    v_mfma_f32_16x16x32_bf16 v[236:239], a[152:155], a[240:243], v[236:239]
    s_waitcnt lgkmcnt(4)
    v_mfma_f32_16x16x32_bf16 v[236:239], a[156:159], a[244:247], v[236:239]
    s_waitcnt lgkmcnt(3)
    v_mfma_f32_16x16x32_bf16 v[236:239], a[160:163], a[216:219], v[236:239]
    s_waitcnt lgkmcnt(2)
    v_mfma_f32_16x16x32_bf16 v[236:239], a[164:167], a[220:223], v[236:239]
    s_waitcnt lgkmcnt(0)
    v_mfma_f32_16x16x32_bf16 v[228:231], a[172:175], a[236:239], v[228:231]
    buffer_store_dwordx4 a[252:255], v250, s[20:23], s51 offen nt
    v_mfma_f32_16x16x32_bf16 v[228:231], a[176:179], a[240:243], v[228:231]
    v_mfma_f32_16x16x32_bf16 v[228:231], a[180:183], a[244:247], v[228:231]
    v_mfma_f32_16x16x32_bf16 v[228:231], a[184:187], a[216:219], v[228:231]
    buffer_store_dwordx2 v[254:255], v251, s[20:23], s51 offen offset:256 nt
    v_mfma_f32_16x16x32_bf16 v[228:231], a[188:191], a[220:223], v[228:231]
    v_cvt_pk_bf16_f32 v236, v236, v237
    v_cvt_pk_bf16_f32 v237, v238, v239
    v_mfma_f32_16x16x32_bf16 v[232:235], a[192:195], a[232:235], 0
    ds_write_b64 v249, v[236:237] offset:12288
    v_mfma_f32_16x16x32_bf16 v[232:235], a[196:199], a[236:239], v[232:235]
    v_mfma_f32_16x16x32_bf16 v[232:235], a[200:203], a[240:243], v[232:235]
    v_mfma_f32_16x16x32_bf16 v[232:235], a[204:207], a[244:247], v[232:235]
    v_mfma_f32_16x16x32_bf16 v[232:235], a[208:211], a[216:219], v[232:235]
    v_cvt_pk_bf16_f32 v228, v228, v229
    v_cvt_pk_bf16_f32 v229, v230, v231
    v_mfma_f32_16x16x32_bf16 v[232:235], a[212:215], a[220:223], v[232:235]
    ds_write_b64 v249, v[228:229] offset:12416
    s_nop 6
    v_cvt_pk_bf16_f32 v232, v232, v233
    v_cvt_pk_bf16_f32 v233, v234, v235
    ds_write_b64 v249, v[232:233] offset:12544
    s_waitcnt lgkmcnt(0)
    s_barrier
    ds_read_b128 a[8:11], v252 offset:12288
    ds_read_b64 a[12:13], v253 offset:12544
    s_waitcnt lgkmcnt(1)
    s_mov_b32 exec_hi, s53
    buffer_store_dwordx4 a[8:11], v250, s[20:23], s54 offen nt
    s_mov_b32 exec_hi, -1
    s_waitcnt lgkmcnt(0)
    s_mov_b32 exec_hi, s53
    buffer_store_dwordx2 a[12:13], v251, s[20:23], s54 offen offset:256 nt
    s_mov_b32 exec_hi, -1
    s_endpgm
.section .rodata,"a"
.p2align 6
.amdhsa_kernel standalone__neighborhood_dinat__vision_kernel
  .amdhsa_next_free_vgpr 512
  .amdhsa_next_free_sgpr 102
  .amdhsa_accum_offset 256
  .amdhsa_group_segment_fixed_size 0
  .amdhsa_kernarg_size 56
  .amdhsa_user_sgpr_count 2
  .amdhsa_user_sgpr_kernarg_segment_ptr 1
  .amdhsa_system_sgpr_workgroup_id_x 1
.end_amdhsa_kernel
```

```asm
; @launch grid=(256,1,1) block=(256,1,1) lds=163840
.amdgcn_target "amdgcn-amd-amdhsa--gfx950"
.text
.globl standalone__neighborhood_dinat__vision_kernel
.p2align 12
.p2align 8
.type standalone__neighborhood_dinat__vision_kernel,@function
standalone__neighborhood_dinat__vision_kernel:
    s_cmpk_ge_u32 s2, 0x100
    s_cbranch_scc1 L_exit
    s_load_dwordx2 s[4:5], s[0:1], 0
    s_load_dwordx2 s[8:9], s[0:1], 8
    s_load_dwordx2 s[12:13], s[0:1], 16
    s_load_dwordx2 s[16:17], s[0:1], 24
    s_load_dwordx2 s[20:21], s[0:1], 32
    s_getpc_b64 s[68:69]
    v_lshrrev_b32 v4, 6, v0
    s_bfe_u32 s65, s2, 0x30003
    v_readfirstlane_b32 s28, v4
    s_lshl_b32 s66, s65, 13
    v_lshl_add_u32 v0, v0, 5, s66
    global_load_dword v11, v0, s[68:69]
    s_lshr_b32 s66, s2, 6
    s_and_b32 s67, s2, 1
    s_lshl2_add_u32 s64, s67, s66
    s_mov_b32 s30, 0x2a000
    s_mul_i32 s66, s64, 14
    s_bitcmp1_b32 s64, 0
    s_cselect_b32 s67, 16, -3
    s_cselect_b32 s35, -1, 1
    s_add_u32 s66, s66, s67
    s_mul_i32 s32, s66, s30
    s_mul_i32 s40, s30, 0x6f
    s_mul_i32 s30, s30, s35
    s_mul_i32 s66, s65, 28
    s_cmp_eq_u32 s65, 7
    s_cselect_b32 s36, 1, 0
    s_cselect_b32 s67, 18, -6
    s_cselect_b32 s31, -3, 3
    s_add_u32 s66, s66, s67
    s_bfe_u32 s67, s2, 0x10001
    s_add_u32 s66, s66, s67
    s_bfe_u32 s67, s2, 0x10002
    s_mulk_i32 s67, 0xe0
    s_add_u32 s66, s66, s67
    s_mulk_i32 s66, 0x180
    s_lshl_b32 s67, s36, 11
    s_sub_u32 s66, s66, s67
    s_lshl_b32 s45, s31, 11
    s_lshl_b32 s31, s31, 8
    s_mul_i32 s67, s30, s28
    s_add_u32 s67, s67, s32
    s_add_u32 s32, s32, s66
    s_cmp_le_u32 s67, s40
    s_cselect_b32 s40, s67, 0x70000000
    s_add_u32 s40, s40, s66
    s_add_u32 s67, s67, s66
    s_lshl2_add_u32 s41, s30, s67
    s_mul_i32 s46, s28, 0x1e00
    s_mul_i32 s29, s28, 0x3000
    s_add_u32 s29, s29, 0x16800
    s_mul_i32 s39, s28, 0x60
    s_mov_b32 s6, 0x1260000
    s_mov_b32 s7, 0x20000
    s_mov_b32 s10, 0x36000
    s_mov_b32 s11, 0x20000
    v_mbcnt_lo_u32_b32 v1, -1, 0
    v_mbcnt_hi_u32_b32 v1, -1, v1
    s_lshl_b32 s51, s28, 1
    s_add_u32 s50, s31, 0xfffffe80
    s_mul_i32 s52, s36, 0x1d00
    v_lshrrev_b32 v2, 3, v1
    v_and_b32 v3, 7, v1
    v_xor_b32 v3, s51, v3
    v_lshl_add_u32 v4, v2, 7, s52
    v_mul_u32_u24 v8, 11, v2
    v_bfe_u32 v9, v8, 6, 1
    v_lshrrev_b32 v8, 5, v8
    v_xor_b32 v9, v3, v9
    v_mad_i32_i24 v8, v8, s50, v4
    v_lshl_add_u32 v168, v9, 4, v8
    v_add_u32 v8, 8, v2
    v_mul_u32_u24 v8, 11, v8
    v_bfe_u32 v9, v8, 6, 1
    v_lshrrev_b32 v8, 5, v8
    v_xor_b32 v9, v3, v9
    v_mad_i32_i24 v8, v8, s50, v4
    v_lshl_add_u32 v169, v9, 4, v8
    v_add_u32 v8, 16, v2
    v_mul_u32_u24 v8, 11, v8
    v_bfe_u32 v9, v8, 6, 1
    v_lshrrev_b32 v8, 5, v8
    v_xor_b32 v9, v3, v9
    v_mad_i32_i24 v8, v8, s50, v4
    v_lshl_add_u32 v170, v9, 4, v8
    s_movk_i32 s53, 0x480
    s_movk_i32 s54, -96
    v_lshrrev_b32 v10, 1, v1
    v_lshlrev_b32 v12, 4, v1
    v_mul_u32_u24 v8, 43, v10
    v_lshrrev_b32 v9, 8, v8
    v_lshrrev_b32 v8, 7, v8
    v_and_b32 v9, 4, v9
    v_xor_b32 v9, v8, v9
    v_mad_i32_i24 v8, v8, s54, v12
    v_mad_u32_u24 v172, v9, s53, v8
    v_add_u32 v8, 32, v10
    v_mul_u32_u24 v8, 43, v8
    v_lshrrev_b32 v9, 8, v8
    v_lshrrev_b32 v8, 7, v8
    v_and_b32 v9, 4, v9
    v_xor_b32 v9, v8, v9
    v_mad_i32_i24 v8, v8, s54, v12
    v_mad_u32_u24 v173, v9, s53, v8
    v_add_u32 v8, 64, v10
    v_mul_u32_u24 v8, 43, v8
    v_lshrrev_b32 v9, 8, v8
    v_lshrrev_b32 v8, 7, v8
    v_and_b32 v9, 4, v9
    v_xor_b32 v9, v8, v9
    v_mad_i32_i24 v8, v8, s54, v12
    v_mad_u32_u24 v174, v9, s53, v8
    s_waitcnt lgkmcnt(0)
    s_add_u32 m0, s46, 0xc00
    s_add_u32 s59, s40, s45
    buffer_load_dwordx4 v168, s[4:7], s59 offen lds
    s_add_u32 m0, s29, 0
    s_add_u32 s60, s39, 0x180
    buffer_load_dwordx4 v172, s[8:11], s60 offen lds
    s_add_u32 m0, s46, 0xc00
    s_add_u32 s52, s40, 0
    buffer_load_dwordx4 v169, s[4:7], s59 offen offset:1024 lds
    s_add_u32 m0, s29, 0
    v_add_u32 v5, s52, v168
    buffer_load_dwordx4 v173, s[8:11], s60 offen offset:1024 lds
    s_add_u32 m0, s46, 0xc00
    v_max_i32 v5, 0, v5
    buffer_load_dwordx4 v170, s[4:7], s59 offen offset:2048 lds
    s_add_u32 m0, s29, 0
    s_add_u32 s53, s40, 0x400
    buffer_load_dwordx4 v174, s[8:11], s60 offen offset:2048 lds
    s_add_u32 m0, s46, 0
    v_add_u32 v6, s53, v169
    buffer_load_dwordx4 v5, s[4:7], 0 offen lds
    s_add_u32 m0, s46, 0x400
    v_max_i32 v6, 0, v6
    buffer_load_dwordx4 v6, s[4:7], 0 offen lds
    s_add_u32 s54, s40, 0x800
    s_add_u32 m0, s46, 0x800
    v_add_u32 v7, s54, v170
    v_max_i32 v7, 0, v7
    buffer_load_dwordx4 v7, s[4:7], 0 offen lds
    s_add_u32 m0, s29, 0xc00
    s_add_u32 s61, s39, 0x9180
    buffer_load_dwordx4 v172, s[8:11], s61 offen lds
    buffer_load_dwordx4 v173, s[8:11], s61 offen offset:1024 lds
    buffer_load_dwordx4 v174, s[8:11], s61 offen offset:2048 lds
    s_add_u32 m0, s29, 0x1800
    s_mov_b32 s33, 0
    s_add_u32 s66, s64, 1
    s_and_b32 s66, s66, 6
    s_cselect_b32 s33, 0, 3
    s_add_u32 s66, s65, 1
    s_and_b32 s66, s66, 6
    s_cselect_b32 s34, 0, 1
    s_cmp_lt_i32 s30, 0
    s_cselect_b32 s35, 1, 0
    s_cselect_b32 s49, -1, 1
    s_mul_i32 s49, s49, 0x1c0
    s_cselect_b32 s48, 0, 0x4e
    s_mul_i32 s66, s28, 0x152
    s_add_u32 s48, s48, s66
    s_lshl2_add_u32 s42, s30, s41
    s_lshl2_add_u32 s43, s30, s42
    s_lshl2_add_u32 s44, s30, s43
    s_mul_i32 s66, s36, 0x1400
    s_add_u32 s32, s32, s66
    s_mul_i32 s37, s28, 0x1180
    s_add_u32 s37, s37, 0x239c0
    s_mov_b32 s38, 0x3e553b95
    s_mov_b32 s3, 0x3dd53b95
    s_mov_b32 s14, 0x12000
    s_mov_b32 s15, 0x20000
    s_mov_b32 s18, 0x548
    s_mov_b32 s19, 0x20000
    s_mov_b32 s22, 0x1260000
    s_mov_b32 s23, 0x20000
    s_mov_b32 s26, 0x1000000
    s_mov_b32 s27, 0x20000
    s_add_u32 s62, s39, 0x12180
    s_add_u32 s63, s39, 0x1b180
    v_and_b32 v13, 15, v1
    v_lshrrev_b32 v14, 4, v1
    v_lshrrev_b32 v15, 2, v13
    v_and_b32 v17, 1, v14
    v_lshl_add_u32 v18, v14, 3, v15
    v_xor_b32 v19, 0, v17
    v_lshl_add_u32 v19, v19, 2, v18
    v_and_b32 v16, 3, v13
    v_mul_u32_u24 v19, 0x60, v19
    v_lshl_add_u32 v19, v16, 3, v19
    v_add_u32 v249, s29, v19
    v_xor_b32 v19, 1, v17
    v_lshl_add_u32 v19, v19, 2, v18
    v_mov_b32 v17, v15
    v_and_b32 v18, 3, v17
    v_lshlrev_b32 v18, 1, v18
    v_bfe_u32 v241, v16, 1, 1
    v_or_b32 v18, v18, v241
    v_mul_u32_u24 v17, 0x1e00, v17
    v_xor_b32 v18, v18, v14
    v_lshl_add_u32 v17, v18, 4, v17
    v_mul_u32_u24 v19, 0x60, v19
    v_mul_u32_u24 v18, 0x180, v16
    v_lshl_add_u32 v19, v16, 3, v19
    v_add_u32 v240, v17, v18
    v_add_u32 v250, s29, v19
    v_xor_b32 v241, 64, v240
    s_add_u32 s59, s41, s45
    s_add_u32 s60, s39, 0x24180
    s_add_u32 s61, s39, 0x2d180
    s_and_b32 s65, s48, 0xfff0
    s_lshr_b32 s55, s2, 3
    s_lshl2_add_u32 s55, s55, s28
    s_mul_i32 s55, s55, 0x240
    s_lshl1_add_u32 s58, s45, s40
    s_add_u32 s56, s28, 3
    s_mul_i32 s57, s31, 3
    s_mul_i32 s56, s56, s30
    s_add_u32 s56, s56, s57
    s_add_u32 s56, s56, s32
    s_add_u32 s51, s28, 3
    s_mul_i32 s52, s31, 11
    s_mul_i32 s51, s51, s30
    s_add_u32 s51, s51, s52
    s_add_u32 s51, s51, s32
    s_add_u32 s53, s28, 3
    s_mul_i32 s54, s31, 7
    s_mul_i32 s53, s53, s30
    s_add_u32 s53, s53, s54
    s_add_u32 s53, s53, s32
    s_add_u32 s57, s28, 7
    s_mul_i32 s57, s57, s30
    s_add_u32 s52, s28, 7
    s_mul_i32 s52, s52, s30
    s_add_u32 s54, s28, 11
    s_mul_i32 s54, s54, s30
    buffer_load_dwordx4 v172, s[8:11], s62 offen lds
    s_mov_b64 exec, 0
    s_cmp_eq_u32 s28, 0
    s_cbranch_scc1 L_h1
    s_cmp_eq_u32 s28, 1
    s_cbranch_scc1 L_h2
    s_cmp_eq_u32 s28, 2
    s_cbranch_scc1 L_h3
    s_branch L_h4
    L_hback:
    s_mov_b64 exec, -1
    buffer_load_dwordx4 v173, s[8:11], s62 offen offset:1024 lds
    buffer_load_dwordx4 v174, s[8:11], s62 offen offset:2048 lds
    s_add_u32 m0, s46, 0x7800
    s_add_u32 s62, s39, 0x300
    buffer_load_dwordx4 v168, s[4:7], s41 offen lds
    buffer_load_dwordx4 v169, s[4:7], s41 offen offset:1024 lds
    s_waitcnt vmcnt(12)
    s_barrier
    ds_read_b128 a[216:219], v240 offset:3072
    ds_read_b128 a[220:223], v240 offset:4608
    ds_read_b128 a[240:243], v241 offset:3072
    buffer_load_dwordx4 v170, s[4:7], s41 offen offset:2048 lds
    s_add_u32 m0, s29, 0x2400
    s_waitcnt vmcnt(12)
    ds_read_b64_tr_b16 a[0:1], v249 offset:0
    ds_read_b64_tr_b16 a[2:3], v250 offset:0
    ds_read_b64_tr_b16 a[24:25], v249 offset:32
    ds_read_b64_tr_b16 a[26:27], v250 offset:32
    ds_read_b64_tr_b16 a[48:49], v249 offset:64
    ds_read_b64_tr_b16 a[50:51], v250 offset:64
    ds_read_b128 a[244:247], v241 offset:4608
    buffer_load_dwordx4 v172, s[8:11], s63 offen lds
    buffer_load_dwordx4 v173, s[8:11], s63 offen offset:1024 lds
    s_waitcnt lgkmcnt(5)
    v_mfma_f32_16x16x32_bf16 v[180:183], a[0:3], a[216:219], 0
    v_mfma_f32_16x16x32_bf16 v[192:195], a[0:3], a[220:223], 0
    s_waitcnt lgkmcnt(3)
    v_mfma_f32_16x16x32_bf16 v[184:187], a[24:27], a[216:219], 0
    s_waitcnt lgkmcnt(1)
    v_mfma_f32_16x16x32_bf16 v[188:191], a[48:51], a[216:219], 0
    buffer_load_dwordx4 v174, s[8:11], s63 offen offset:2048 lds
    s_waitcnt vmcnt(12)
    v_mfma_f32_16x16x32_bf16 v[196:199], a[24:27], a[220:223], 0
    s_barrier
    v_mfma_f32_16x16x32_bf16 v[200:203], a[48:51], a[220:223], 0
    s_add_u32 m0, s46, 0x8400
    ds_read_b128 a[224:227], v240 offset:0
    ds_read_b128 a[228:231], v240 offset:1536
    buffer_load_dwordx4 v168, s[4:7], s59 offen lds
    ds_read_b128 a[232:235], v241 offset:0
    ds_read_b128 a[236:239], v241 offset:1536
    ds_read_b128 a[216:219], v240 offset:128
    ds_read_b128 a[220:223], v240 offset:1664
    s_add_u32 s63, s39, 0x9300
    buffer_load_dwordx4 v169, s[4:7], s59 offen offset:1024 lds
    s_waitcnt lgkmcnt(5)
    v_mfma_f32_16x16x32_bf16 v[204:207], a[0:3], a[224:227], 0
    v_mfma_f32_16x16x32_bf16 v[208:211], a[24:27], a[224:227], 0
    s_waitcnt vmcnt(11) lgkmcnt(4)
    ds_read_b64_tr_b16 a[4:5], v249 offset:3072
    v_mfma_f32_16x16x32_bf16 v[212:215], a[48:51], a[224:227], 0
    ds_read_b64_tr_b16 a[6:7], v250 offset:3072
    ds_read_b64_tr_b16 a[28:29], v249 offset:3104
    v_mfma_f32_16x16x32_bf16 v[216:219], a[0:3], a[228:231], 0
    ds_read_b64_tr_b16 a[30:31], v250 offset:3104
    buffer_load_dwordx4 v170, s[4:7], s59 offen offset:2048 lds
    v_mfma_f32_16x16x32_bf16 v[220:223], a[24:27], a[228:231], 0
    ds_read_b64_tr_b16 a[52:53], v249 offset:3136
    ds_read_b64_tr_b16 a[54:55], v250 offset:3136
    v_mfma_f32_16x16x32_bf16 v[224:227], a[48:51], a[228:231], 0
    ds_read_b128 a[224:227], v240 offset:3200
    ds_read_b128 a[228:231], v240 offset:4736
    s_add_u32 m0, s29, 0
    s_add_u32 s59, s42, s45
    buffer_load_dwordx4 v172, s[8:11], s60 offen lds
    s_waitcnt lgkmcnt(6)
    v_mfma_f32_16x16x32_bf16 v[204:207], a[4:7], a[232:235], v[204:207]
    v_mfma_f32_16x16x32_bf16 v[216:219], a[4:7], a[236:239], v[216:219]
    s_waitcnt lgkmcnt(4)
    buffer_load_dwordx4 v173, s[8:11], s60 offen offset:1024 lds
    v_mfma_f32_16x16x32_bf16 v[208:211], a[28:31], a[232:235], v[208:211]
    v_mfma_f32_16x16x32_bf16 v[220:223], a[28:31], a[236:239], v[220:223]
    s_waitcnt lgkmcnt(2)
    s_waitcnt vmcnt(11)
    ds_read_b64_tr_b16 a[8:9], v249 offset:6144
    v_mfma_f32_16x16x32_bf16 v[212:215], a[52:55], a[232:235], v[212:215]
    ds_read_b64_tr_b16 a[10:11], v250 offset:6144
    ds_read_b64_tr_b16 a[32:33], v249 offset:6176
    v_mfma_f32_16x16x32_bf16 v[224:227], a[52:55], a[236:239], v[224:227]
    ds_read_b64_tr_b16 a[34:35], v250 offset:6176
    ds_read_b64_tr_b16 a[56:57], v249 offset:6208
    v_mfma_f32_16x16x32_bf16 v[180:183], a[4:7], a[240:243], v[180:183]
    ds_read_b64_tr_b16 a[58:59], v250 offset:6208
    buffer_load_dwordx4 v174, s[8:11], s60 offen offset:2048 lds
    v_mfma_f32_16x16x32_bf16 v[184:187], a[28:31], a[240:243], v[184:187]
    s_add_u32 m0, s29, 0xc00
    s_add_u32 s60, s39, 0x12300
    v_mfma_f32_16x16x32_bf16 v[188:191], a[52:55], a[240:243], v[188:191]
    s_waitcnt lgkmcnt(6)
    v_mfma_f32_16x16x32_bf16 v[192:195], a[4:7], a[244:247], v[192:195]
    v_mfma_f32_16x16x32_bf16 v[196:199], a[28:31], a[244:247], v[196:199]
    buffer_load_dwordx4 v172, s[8:11], s61 offen lds
    v_mfma_f32_16x16x32_bf16 v[200:203], a[52:55], a[244:247], v[200:203]
    s_waitcnt lgkmcnt(4)
    v_mfma_f32_16x16x32_bf16 v[204:207], a[8:11], a[216:219], v[204:207]
    v_mfma_f32_16x16x32_bf16 v[216:219], a[8:11], a[220:223], v[216:219]
    s_waitcnt lgkmcnt(2)
    v_mfma_f32_16x16x32_bf16 v[208:211], a[32:35], a[216:219], v[208:211]
    s_waitcnt lgkmcnt(0)
    buffer_load_dwordx4 v173, s[8:11], s61 offen offset:1024 lds
    v_mfma_f32_16x16x32_bf16 v[212:215], a[56:59], a[216:219], v[212:215]
    v_mfma_f32_16x16x32_bf16 v[220:223], a[32:35], a[220:223], v[220:223]
    s_waitcnt vmcnt(11)
    s_barrier
    v_mfma_f32_16x16x32_bf16 v[224:227], a[56:59], a[220:223], v[224:227]
    ds_read_b128 a[232:235], v240 offset:30720
    ds_read_b128 a[236:239], v240 offset:32256
    v_mfma_f32_16x16x32_bf16 v[180:183], a[8:11], a[224:227], v[180:183]
    ds_read_b128 a[240:243], v241 offset:30720
    v_add_u32 v8, 4, v2
    v_mfma_f32_16x16x32_bf16 v[184:187], a[32:35], a[224:227], v[184:187]
    ds_read_b128 a[244:247], v241 offset:32256
    v_mul_u32_u24 v8, 11, v8
    v_mfma_f32_16x16x32_bf16 v[188:191], a[56:59], a[224:227], v[188:191]
    ds_read_b128 a[216:219], v240 offset:30848
    v_bfe_u32 v9, v8, 6, 1
    v_mfma_f32_16x16x32_bf16 v[192:195], a[8:11], a[228:231], v[192:195]
    ds_read_b128 a[220:223], v240 offset:32384
    v_lshrrev_b32 v8, 5, v8
    v_mfma_f32_16x16x32_bf16 v[196:199], a[32:35], a[228:231], v[196:199]
    ds_read_b128 a[224:227], v241 offset:128
    v_xor_b32 v9, v3, v9
    v_mfma_f32_16x16x32_bf16 v[200:203], a[56:59], a[228:231], v[200:203]
    ds_read_b128 a[228:231], v241 offset:1664
    buffer_load_dwordx4 v174, s[8:11], s61 offen offset:2048 lds
    s_add_u32 m0, s37, 0xd80
    s_add_u32 s61, s39, 0x1b300
    s_add_u32 s50, s31, 0xfffffe80
    v_mad_i32_i24 v8, v8, s50, v4
    s_waitcnt lgkmcnt(7)
    v_mfma_f32_16x16x32_bf16 v[228:231], a[0:3], a[232:235], 0
    s_and_b32 s66, s28, 1
    v_lshl_add_u32 v171, v9, 4, v8
    s_waitcnt lgkmcnt(6)
    v_mfma_f32_16x16x32_bf16 v[232:235], a[24:27], a[232:235], 0
    s_lshl_b32 s66, s66, 2
    v_add_u32 v17, 3, v15
    v_add_u32 v19, 3, v16
    v_mfma_f32_16x16x32_bf16 v[236:239], a[48:51], a[232:235], 0
    s_waitcnt lgkmcnt(5)
    v_and_b32 v18, 3, v17
    v_lshlrev_b32 v18, 1, v18
    v_mfma_f32_16x16x32_bf16 v[138:141], a[0:3], a[236:239], 0
    ds_read_b128 a[232:235], v241 offset:3200
    v_bfe_u32 v243, v19, 1, 1
    v_mfma_f32_16x16x32_bf16 v[142:145], a[24:27], a[236:239], 0
    s_waitcnt vmcnt(9)
    ds_read_b64_tr_b16 a[12:13], v249 offset:9216
    v_mfma_f32_16x16x32_bf16 v[146:149], a[48:51], a[236:239], 0
    s_waitcnt lgkmcnt(6)
    ds_read_b64_tr_b16 a[14:15], v250 offset:9216
    v_mfma_f32_16x16x32_bf16 v[228:231], a[4:7], a[240:243], v[228:231]
    ds_read_b64_tr_b16 a[36:37], v249 offset:9248
    ds_read_b64_tr_b16 a[38:39], v250 offset:9248
    v_mfma_f32_16x16x32_bf16 v[232:235], a[28:31], a[240:243], v[232:235]
    ds_read_b64_tr_b16 a[60:61], v249 offset:9280
    ds_read_b64_tr_b16 a[62:63], v250 offset:9280
    v_mfma_f32_16x16x32_bf16 v[236:239], a[52:55], a[240:243], v[236:239]
    s_waitcnt lgkmcnt(10)
    v_or_b32 v18, v18, v243
    v_mul_u32_u24 v17, 0x1e00, v17
    v_mfma_f32_16x16x32_bf16 v[138:141], a[4:7], a[244:247], v[138:141]
    s_waitcnt lgkmcnt(9)
    v_xor_b32 v18, v18, v14
    v_lshl_add_u32 v17, v18, 4, v17
    v_mfma_f32_16x16x32_bf16 v[142:145], a[28:31], a[244:247], v[142:145]
    ds_read_b128 a[236:239], v241 offset:4736
    v_mul_u32_u24 v18, 0x180, v19
    v_mfma_f32_16x16x32_bf16 v[146:149], a[52:55], a[244:247], v[146:149]
    ds_read_b128 a[240:243], v241 offset:30848
    v_add_u32 v242, v17, v18
    v_mfma_f32_16x16x32_bf16 v[228:231], a[8:11], a[216:219], v[228:231]
    ds_read_b128 a[244:247], v241 offset:32384
    v_mov_b32 v17, 0x3f803f80
    v_mfma_f32_16x16x32_bf16 v[232:235], a[32:35], a[216:219], v[232:235]
    buffer_load_dwordx4 v12, s[16:19], s65 offen lds
    v_lshrrev_b32 v18, 1, v13
    v_mfma_f32_16x16x32_bf16 v[236:239], a[56:59], a[216:219], v[236:239]
    s_waitcnt lgkmcnt(7)
    v_accvgpr_write_b32 a248, v17
    v_accvgpr_write_b32 a249, v17
    v_mfma_f32_16x16x32_bf16 v[138:141], a[8:11], a[220:223], v[138:141]
    s_waitcnt lgkmcnt(5)
    v_accvgpr_write_b32 a250, v17
    v_accvgpr_write_b32 a251, v17
    v_mfma_f32_16x16x32_bf16 v[142:145], a[32:35], a[220:223], v[142:145]
    s_waitcnt lgkmcnt(3)
    v_xor_b32 v18, v14, v18
    v_xor_b32 v18, s66, v18
    v_mfma_f32_16x16x32_bf16 v[146:149], a[56:59], a[220:223], v[146:149]
    buffer_load_dword v11, v12, s[12:15], s55 offen
    v_mul_u32_u24 v17, 0x180, v13
    v_mfma_f32_16x16x32_bf16 v[204:207], a[12:15], a[224:227], v[204:207]
    s_add_u32 m0, s29, 0x1800
    v_lshl_add_u32 v17, v18, 4, v17
    v_lshlrev_b32 v18, 4, v16
    v_mfma_f32_16x16x32_bf16 v[208:211], a[36:39], a[224:227], v[208:211]
    s_lshr_b32 s67, s28, 1
    v_min_u32 v20, 55, v1
    v_lshrrev_b32 v21, 1, v20
    v_mfma_f32_16x16x32_bf16 v[212:215], a[60:63], a[224:227], v[212:215]
    s_lshl_b32 s67, s67, 3
    v_add_u32 v17, s67, v17
    v_add_u32 v247, 0x7800, v17
    v_mfma_f32_16x16x32_bf16 v[216:219], a[12:15], a[228:231], v[216:219]
    buffer_load_dwordx4 v172, s[8:11], s62 offen lds
    v_add_u32 v251, 0x1e000, v17
    v_mfma_f32_16x16x32_bf16 v[220:223], a[36:39], a[228:231], v[220:223]
    s_waitcnt vmcnt(9)
    s_barrier
    v_mfma_f32_16x16x32_bf16 v[224:227], a[60:63], a[228:231], v[224:227]
    s_waitcnt lgkmcnt(1)
    ds_read_b128 a[216:219], v240 offset:33792
    v_mfma_f32_16x16x32_bf16 v[180:183], a[12:15], a[232:235], v[180:183]
    ds_read_b128 a[220:223], v240 offset:35328
    v_sub_u32 v17, v14, v15
    v_mfma_f32_16x16x32_bf16 v[184:187], a[36:39], a[232:235], v[184:187]
    s_waitcnt lgkmcnt(2)
    v_mul_i32_i24 v17, 0x1c0, v17
    v_sub_u32 v17, v17, v18
    v_mfma_f32_16x16x32_bf16 v[188:191], a[60:63], a[232:235], v[188:191]
    ds_read_b128 a[224:227], v241 offset:33792
    v_max_u32 v18, s33, v15
    v_mfma_f32_16x16x32_bf16 v[192:195], a[12:15], a[236:239], v[192:195]
    ds_read_b128 a[228:231], v241 offset:35328
    v_sub_u32 v18, v14, v18
    v_mfma_f32_16x16x32_bf16 v[196:199], a[36:39], a[236:239], v[196:199]
    buffer_load_dwordx4 v173, s[8:11], s62 offen offset:1024 lds
    v_add_u32 v244, 0, v18
    v_mfma_f32_16x16x32_bf16 v[200:203], a[60:63], a[236:239], v[200:203]
    ds_read_b128 a[232:235], v240 offset:33920
    v_cmp_gt_u32 vcc, 7, v244
    v_mfma_f32_16x16x32_bf16 v[228:231], a[12:15], a[240:243], v[228:231]
    ds_read_b128 a[236:239], v240 offset:35456
    v_add_u32 v17, s37, v17
    v_mfma_f32_16x16x32_bf16 v[232:235], a[36:39], a[240:243], v[232:235]
    s_lshl_b32 s66, s36, 1
    v_add_u32 v244, 0xfffdc870, v17
    v_cndmask_b32 v244, 0, v244, vcc
    v_mfma_f32_16x16x32_bf16 v[236:239], a[60:63], a[240:243], v[236:239]
    s_waitcnt lgkmcnt(5)
    v_add_u32 v245, 4, v18
    v_cmp_gt_u32 vcc, 7, v245
    v_mfma_f32_16x16x32_bf16 v[138:141], a[12:15], a[244:247], v[138:141]
    buffer_load_dwordx4 v174, s[8:11], s62 offen offset:2048 lds
    v_add_u32 v245, 0xfffdcf70, v17
    v_mfma_f32_16x16x32_bf16 v[142:145], a[36:39], a[244:247], v[142:145]
    ds_read_b128 a[240:243], v241 offset:33920
    v_cndmask_b32 v245, 0, v245, vcc
    v_mfma_f32_16x16x32_bf16 v[146:149], a[60:63], a[244:247], v[146:149]
    s_waitcnt lgkmcnt(5)
    v_add_u32 v246, 8, v18
    v_cmp_gt_u32 vcc, 7, v246
    v_mfma_f32_16x16x32_bf16 v[150:153], a[0:3], a[216:219], 0
    ds_read_b128 a[244:247], v241 offset:35456
    v_add_u32 v246, 0xfffdd670, v17
    v_mfma_f32_16x16x32_bf16 v[154:157], a[24:27], a[216:219], 0
    s_add_u32 m0, s29, 0x2400
    v_cndmask_b32 v246, 0, v246, vcc
    v_cmp_lt_u32 vcc, 11, v21
    v_mfma_f32_16x16x32_bf16 v[158:161], a[48:51], a[216:219], 0
    s_waitcnt lgkmcnt(5)
    v_lshlrev_b32 v62, 3, v20
    v_add_u32 v22, -12, v21
    v_mfma_f32_16x16x32_bf16 v[162:165], a[0:3], a[220:223], 0
    ds_read_b128 a[216:219], v240 offset:256
    v_mov_b32 v23, s34
    v_mfma_f32_16x16x32_bf16 v[24:27], a[24:27], a[220:223], 0
    buffer_load_dwordx4 v172, s[8:11], s63 offen lds
    s_waitcnt lgkmcnt(5)
    v_mfma_f32_16x16x32_bf16 v[54:57], a[48:51], a[220:223], 0
    ds_read_b128 a[220:223], v240 offset:1792
    v_and_b32 v20, 1, v20
    v_mfma_f32_16x16x32_bf16 v[150:153], a[4:7], a[224:227], v[150:153]
    s_add_u32 s62, s39, 0x24300
    s_waitcnt lgkmcnt(5)
    v_cndmask_b32 v22, v21, v22, vcc
    v_mfma_f32_16x16x32_bf16 v[154:157], a[28:31], a[224:227], v[154:157]
    s_sub_u32 s66, 1, s66
    v_cndmask_b32 v23, 0, v23, vcc
    v_lshlrev_b32 v20, 1, v20
    v_mfma_f32_16x16x32_bf16 v[158:161], a[52:55], a[224:227], v[158:161]
    ds_read_b128 a[224:227], v240 offset:3328
    v_cmp_ne_u32 vcc, 0, v23
    v_mfma_f32_16x16x32_bf16 v[162:165], a[4:7], a[228:231], v[162:165]
    s_waitcnt lgkmcnt(5)
    v_add_u32 v63, 0, v20
    v_add3_u32 v64, v22, v63, -6
L_h1:
    s_cbranch_execz L_h5
    v_mfma_f32_16x16x32_bf16 v[24:27], a[28:31], a[228:231], v[24:27]
    s_waitcnt vmcnt(9)
    ds_read_b64_tr_b16 a[16:17], v249 offset:0
    v_mfma_f32_16x16x32_bf16 v[54:57], a[52:55], a[228:231], v[54:57]
    ds_read_b64_tr_b16 a[18:19], v250 offset:0
    ds_read_b64_tr_b16 a[40:41], v249 offset:32
    v_mfma_f32_16x16x32_bf16 v[150:153], a[8:11], a[232:235], v[150:153]
    ds_read_b64_tr_b16 a[42:43], v250 offset:32
    ds_read_b64_tr_b16 a[64:65], v249 offset:64
    v_mfma_f32_16x16x32_bf16 v[154:157], a[32:35], a[232:235], v[154:157]
    ds_read_b64_tr_b16 a[66:67], v250 offset:64
    s_waitcnt lgkmcnt(9)
    v_mfma_f32_16x16x32_bf16 v[158:161], a[56:59], a[232:235], v[158:161]
    ds_read_b128 a[228:231], v240 offset:4864
    v_and_b32 v66, 12, v22
    v_mfma_f32_16x16x32_bf16 v[162:165], a[8:11], a[236:239], v[162:165]
    buffer_load_dwordx4 v173, s[8:11], s63 offen offset:1024 lds
    v_add_u32 v65, 3, v64
    v_mfma_f32_16x16x32_bf16 v[24:27], a[32:35], a[236:239], v[24:27]
    ds_read_b128 a[232:235], v240 offset:30976
    v_add3_u32 v66, v66, v63, -3
    v_mfma_f32_16x16x32_bf16 v[54:57], a[56:59], a[236:239], v[54:57]
    ds_read_b128 a[236:239], v240 offset:32512
    v_cndmask_b32 v65, v65, v66, vcc
    v_mfma_f32_16x16x32_bf16 v[150:153], a[12:15], a[240:243], v[150:153]
    s_mul_i32 s64, s35, 0xfc0
    v_cmp_gt_u32 vcc, 7, v65
    v_mul_i32_i24 v64, s66, v64
    v_mfma_f32_16x16x32_bf16 v[154:157], a[36:39], a[240:243], v[154:157]
    buffer_load_dwordx4 v174, s[8:11], s63 offen offset:2048 lds
    v_add_lshl_u32 v64, v64, 6, 1
    v_mfma_f32_16x16x32_bf16 v[158:161], a[60:63], a[240:243], v[158:161]
    s_waitcnt lgkmcnt(7)
    v_cndmask_b32 v50, 0, v64, vcc
    v_mov_b32 v64, 0x3fb8aa3b
    v_mfma_f32_16x16x32_bf16 v[162:165], a[12:15], a[244:247], v[162:165]
    s_waitcnt lgkmcnt(5)
    v_cndmask_b32 v52, 0, v64, vcc
    v_mov_b32 v64, 0
    v_mfma_f32_16x16x32_bf16 v[24:27], a[36:39], a[244:247], v[24:27]
    s_waitcnt lgkmcnt(3)
    v_mov_b32 v65, 0xf149f2ca
    v_cndmask_b32 v60, v65, v64, vcc
    v_mfma_f32_16x16x32_bf16 v[54:57], a[60:63], a[244:247], v[54:57]
    ds_read_b128 a[240:243], v240 offset:34048
    v_cmp_ne_u32 vcc, 0, v23
    v_mfma_f32_16x16x32_bf16 v[204:207], a[16:19], a[216:219], v[204:207]
    ds_read_b128 a[244:247], v240 offset:35584
    v_add_u32 v63, 1, v20
    v_mfma_f32_16x16x32_bf16 v[208:211], a[40:43], a[216:219], v[208:211]
    s_add_u32 m0, s29, 0
    v_add3_u32 v64, v22, v63, -6
    v_and_b32 v66, 12, v22
    v_mfma_f32_16x16x32_bf16 v[212:215], a[64:67], a[216:219], v[212:215]
    ds_read_b128 a[216:219], v241 offset:256
    v_add_u32 v65, 3, v64
    v_mfma_f32_16x16x32_bf16 v[216:219], a[16:19], a[220:223], v[216:219]
    buffer_load_dwordx4 v172, s[8:11], s60 offen lds
    s_waitcnt lgkmcnt(5)
    v_mfma_f32_16x16x32_bf16 v[220:223], a[40:43], a[220:223], v[220:223]
    s_add_u32 s63, s39, 0x2d300
    v_add3_u32 v66, v66, v63, -3
    v_cndmask_b32 v65, v65, v66, vcc
    v_mfma_f32_16x16x32_bf16 v[224:227], a[64:67], a[220:223], v[224:227]
    ds_read_b128 a[220:223], v241 offset:1792
    v_cmp_gt_u32 vcc, 7, v65
    v_mfma_f32_16x16x32_bf16 v[180:183], a[16:19], a[224:227], v[180:183]
    s_waitcnt lgkmcnt(5)
    v_mul_i32_i24 v64, s66, v64
    v_add_lshl_u32 v64, v64, 6, 1
    v_mfma_f32_16x16x32_bf16 v[184:187], a[40:43], a[224:227], v[184:187]
    s_waitcnt lgkmcnt(4)
    v_cndmask_b32 v51, 0, v64, vcc
    v_mov_b32 v64, 0x3fb8aa3b
    v_mfma_f32_16x16x32_bf16 v[188:191], a[64:67], a[224:227], v[188:191]
    ds_read_b128 a[224:227], v241 offset:3328
    v_cndmask_b32 v53, 0, v64, vcc
    v_mfma_f32_16x16x32_bf16 v[192:195], a[16:19], a[228:231], v[192:195]
    buffer_load_dwordx4 v173, s[8:11], s60 offen offset:1024 lds
    v_mov_b32 v64, 0
    v_mfma_f32_16x16x32_bf16 v[196:199], a[40:43], a[228:231], v[196:199]
    s_waitcnt vmcnt(10)
    ds_read_b64_tr_b16 a[20:21], v249 offset:3072
    v_mfma_f32_16x16x32_bf16 v[200:203], a[64:67], a[228:231], v[200:203]
    ds_read_b64_tr_b16 a[22:23], v250 offset:3072
    ds_read_b64_tr_b16 a[44:45], v249 offset:3104
    v_mfma_f32_16x16x32_bf16 v[228:231], a[16:19], a[232:235], v[228:231]
    ds_read_b64_tr_b16 a[46:47], v250 offset:3104
    ds_read_b64_tr_b16 a[68:69], v249 offset:3136
    v_mfma_f32_16x16x32_bf16 v[232:235], a[40:43], a[232:235], v[232:235]
    ds_read_b64_tr_b16 a[70:71], v250 offset:3136
    s_waitcnt lgkmcnt(9)
    v_mfma_f32_16x16x32_bf16 v[236:239], a[64:67], a[232:235], v[236:239]
    ds_read_b128 a[228:231], v241 offset:4864
    v_mov_b32 v65, 0xf149f2ca
    v_mfma_f32_16x16x32_bf16 v[138:141], a[16:19], a[236:239], v[138:141]
    ds_read_b128 a[232:235], v241 offset:30976
    v_cndmask_b32 v61, v65, v64, vcc
    v_mfma_f32_16x16x32_bf16 v[142:145], a[40:43], a[236:239], v[142:145]
    buffer_load_dwordx4 v174, s[8:11], s60 offen offset:2048 lds
    v_lshlrev_b32 v63, 3, v1
    v_mfma_f32_16x16x32_bf16 v[146:149], a[64:67], a[236:239], v[146:149]
    ds_read_b128 a[236:239], v241 offset:32512
    v_mov_b32 v64, 0xf149f2ca
    v_mfma_f32_16x16x32_bf16 v[150:153], a[16:19], a[240:243], v[150:153]
    s_add_u32 m0, s29, 0xc00
    v_mov_b32 v65, 0xf149f2ca
    v_add_u32 v63, 0x237c0, v63
    v_mfma_f32_16x16x32_bf16 v[154:157], a[40:43], a[240:243], v[154:157]
    s_add_u32 s64, s64, s37
    v_add_u32 v62, s64, v62
    v_mbcnt_lo_u32_b32 v67, -1, 0
    v_mfma_f32_16x16x32_bf16 v[158:161], a[64:67], a[240:243], v[158:161]
    s_waitcnt lgkmcnt(7)
    v_mbcnt_hi_u32_b32 v67, -1, v67
    v_lshrrev_b32 v68, 1, v67
    v_mfma_f32_16x16x32_bf16 v[162:165], a[16:19], a[244:247], v[162:165]
    s_waitcnt lgkmcnt(5)
    v_add_u32 v68, 0, v68
    v_mul_u32_u24 v69, 43, v68
    v_mfma_f32_16x16x32_bf16 v[24:27], a[40:43], a[244:247], v[24:27]
    s_waitcnt lgkmcnt(3)
    v_lshrrev_b32 v70, 8, v69
    v_lshrrev_b32 v69, 7, v69
    v_mfma_f32_16x16x32_bf16 v[54:57], a[64:67], a[244:247], v[54:57]
    ds_read_b128 a[240:243], v241 offset:34048
    v_mad_i32_i24 v68, v69, -3, v68
    v_mfma_f32_16x16x32_bf16 v[204:207], a[20:23], a[216:219], v[204:207]
    ds_read_b128 a[244:247], v241 offset:35584
    v_and_b32 v70, 4, v70
    v_mfma_f32_16x16x32_bf16 v[208:211], a[44:47], a[216:219], v[208:211]
    buffer_load_dwordx4 v172, s[8:11], s61 offen lds
    v_xor_b32 v69, v69, v70
    v_mfma_f32_16x16x32_bf16 v[212:215], a[68:71], a[216:219], v[212:215]
    ds_read_b128 a[216:219], v240 offset:0
    v_and_b32 v70, 4, v69
    v_mfma_f32_16x16x32_bf16 v[216:219], a[20:23], a[220:223], v[216:219]
    s_and_b32 s64, s48, 15
    s_waitcnt lgkmcnt(5)
    v_cvt_pk_bf16_f32 v102, v204, v205
    v_mfma_f32_16x16x32_bf16 v[220:223], a[44:47], a[220:223], v[220:223]
    s_add_u32 s64, s64, s37
    v_cvt_pk_bf16_f32 v103, v206, v207
    v_cvt_pk_bf16_f32 v104, v208, v209
    v_mfma_f32_16x16x32_bf16 v[224:227], a[68:71], a[220:223], v[224:227]
    s_waitcnt lgkmcnt(4)
    v_cvt_pk_bf16_f32 v105, v210, v211
    v_cvt_pk_bf16_f32 v106, v212, v213
    v_mfma_f32_16x16x32_bf16 v[180:183], a[20:23], a[224:227], v[180:183]
    ds_read_b128 a[220:223], v240 offset:1536
    v_cvt_pk_bf16_f32 v107, v214, v215
    v_mfma_f32_16x16x32_bf16 v[184:187], a[44:47], a[224:227], v[184:187]
    s_waitcnt lgkmcnt(4)
    v_cvt_pk_bf16_f32 v108, v216, v217
    v_cvt_pk_bf16_f32 v109, v218, v219
    v_mfma_f32_16x16x32_bf16 v[188:191], a[68:71], a[224:227], v[188:191]
    ds_read_b128 a[224:227], v240 offset:3072
    v_cvt_pk_bf16_f32 v110, v220, v221
    v_mfma_f32_16x16x32_bf16 v[192:195], a[20:23], a[228:231], v[192:195]
    buffer_load_dwordx4 v173, s[8:11], s61 offen offset:1024 lds
    v_cvt_pk_bf16_f32 v111, v222, v223
    v_mfma_f32_16x16x32_bf16 v[196:199], a[44:47], a[228:231], v[196:199]
    s_waitcnt vmcnt(8)
    ds_read_b64_tr_b16 a[72:73], v249 offset:6144
    v_mfma_f32_16x16x32_bf16 v[200:203], a[68:71], a[228:231], v[200:203]
    ds_read_b64_tr_b16 a[74:75], v250 offset:6144
    ds_read_b64_tr_b16 a[96:97], v249 offset:6176
    v_mfma_f32_16x16x32_bf16 v[228:231], a[20:23], a[232:235], v[228:231]
    ds_read_b64_tr_b16 a[98:99], v250 offset:6176
    ds_read_b64_tr_b16 a[120:121], v249 offset:6208
    v_mfma_f32_16x16x32_bf16 v[232:235], a[44:47], a[232:235], v[232:235]
    ds_read_b64_tr_b16 a[122:123], v250 offset:6208
    s_waitcnt lgkmcnt(9)
    v_mfma_f32_16x16x32_bf16 v[236:239], a[68:71], a[232:235], v[236:239]
    ds_read_b128 a[228:231], v240 offset:4608
    v_cvt_pk_bf16_f32 v112, v224, v225
    v_mfma_f32_16x16x32_bf16 v[138:141], a[20:23], a[236:239], v[138:141]
    ds_read_b128 a[232:235], v240 offset:30720
    v_cvt_pk_bf16_f32 v113, v226, v227
    v_mfma_f32_16x16x32_bf16 v[142:145], a[44:47], a[236:239], v[142:145]
    buffer_load_dwordx4 v174, s[8:11], s61 offen offset:2048 lds
    v_cvt_pk_bf16_f32 v90, v180, v181
    v_mfma_f32_16x16x32_bf16 v[146:149], a[68:71], a[236:239], v[146:149]
    ds_read_b128 a[236:239], v240 offset:32256
    v_cvt_pk_bf16_f32 v91, v182, v183
    v_mfma_f32_16x16x32_bf16 v[150:153], a[20:23], a[240:243], v[150:153]
    s_add_u32 m0, s29, 0x1800
    v_cvt_pk_bf16_f32 v92, v184, v185
    v_cvt_pk_bf16_f32 v93, v186, v187
    v_mfma_f32_16x16x32_bf16 v[154:157], a[44:47], a[240:243], v[154:157]
    s_add_u32 s60, s39, 0
    v_cvt_pk_bf16_f32 v94, v188, v189
    v_cvt_pk_bf16_f32 v95, v190, v191
    v_mfma_f32_16x16x32_bf16 v[158:161], a[68:71], a[240:243], v[158:161]
    s_waitcnt lgkmcnt(7)
    v_cvt_pk_bf16_f32 v96, v192, v193
    v_cvt_pk_bf16_f32 v97, v194, v195
    v_mfma_f32_16x16x32_bf16 v[162:165], a[20:23], a[244:247], v[162:165]
    s_waitcnt lgkmcnt(5)
    v_cvt_pk_bf16_f32 v98, v196, v197
    v_cvt_pk_bf16_f32 v99, v198, v199
    v_mfma_f32_16x16x32_bf16 v[24:27], a[44:47], a[244:247], v[24:27]
    s_waitcnt lgkmcnt(3)
    v_cvt_pk_bf16_f32 v100, v200, v201
    v_cvt_pk_bf16_f32 v101, v202, v203
    v_mfma_f32_16x16x32_bf16 v[54:57], a[68:71], a[244:247], v[54:57]
    ds_read_b128 a[240:243], v240 offset:33792
    v_cvt_pk_bf16_f32 v114, v228, v229
    v_mfma_f32_16x16x32_bf16 v[84:87], a[216:219], a[72:75], 0
    ds_read_b128 a[244:247], v240 offset:35328
    v_cvt_pk_bf16_f32 v115, v230, v231
    v_mfma_f32_16x16x32_bf16 v[204:207], a[216:219], a[96:99], 0
    buffer_load_dwordx4 v172, s[8:11], s62 offen lds
    v_cvt_pk_bf16_f32 v116, v232, v233
    v_mfma_f32_16x16x32_bf16 v[208:211], a[216:219], a[120:123], 0
    ds_read_b128 a[216:219], v241 offset:0
    v_cvt_pk_bf16_f32 v117, v234, v235
    v_mfma_f32_16x16x32_bf16 v[212:215], a[220:223], a[72:75], 0
    s_add_u32 s61, s39, 0x9000
    s_waitcnt lgkmcnt(5)
    v_cvt_pk_bf16_f32 v118, v236, v237
    v_mfma_f32_16x16x32_bf16 v[216:219], a[220:223], a[96:99], 0
    s_mov_b32 vcc_lo, 0xcccccccc
    v_cvt_pk_bf16_f32 v119, v238, v239
    v_cvt_pk_bf16_f32 v120, v138, v139
    v_mfma_f32_16x16x32_bf16 v[220:223], a[220:223], a[120:123], 0
    s_waitcnt lgkmcnt(4)
    v_cvt_pk_bf16_f32 v121, v140, v141
    v_cvt_pk_bf16_f32 v122, v142, v143
    v_mfma_f32_16x16x32_bf16 v[224:227], a[224:227], a[72:75], 0
    ds_read_b128 a[220:223], v241 offset:1536
    v_cvt_pk_bf16_f32 v123, v144, v145
    v_mfma_f32_16x16x32_bf16 v[180:183], a[224:227], a[96:99], 0
    s_waitcnt lgkmcnt(4)
    v_cvt_pk_bf16_f32 v124, v146, v147
    v_cvt_pk_bf16_f32 v125, v148, v149
    v_mfma_f32_16x16x32_bf16 v[184:187], a[224:227], a[120:123], 0
    buffer_load_dwordx4 v173, s[8:11], s62 offen offset:1024 lds
    v_cvt_pk_bf16_f32 v126, v150, v151
    v_mfma_f32_16x16x32_bf16 v[188:191], a[228:231], a[72:75], 0
    s_mov_b32 vcc_hi, 0xcccccccc
    v_cvt_pk_bf16_f32 v127, v152, v153
    v_cvt_pk_bf16_f32 v128, v154, v155
    v_mfma_f32_16x16x32_bf16 v[192:195], a[228:231], a[96:99], 0
    s_waitcnt vmcnt(8)
    ds_read_b64_tr_b16 a[76:77], v249 offset:9216
    v_mfma_f32_16x16x32_bf16 v[196:199], a[228:231], a[120:123], 0
    ds_read_b64_tr_b16 a[78:79], v250 offset:9216
    ds_read_b64_tr_b16 a[100:101], v249 offset:9248
    v_mfma_f32_16x16x32_bf16 v[200:203], a[232:235], a[72:75], 0
    ds_read_b64_tr_b16 a[102:103], v250 offset:9248
    ds_read_b64_tr_b16 a[124:125], v249 offset:9280
    v_mfma_f32_16x16x32_bf16 v[228:231], a[232:235], a[96:99], 0
    ds_read_b64_tr_b16 a[126:127], v250 offset:9280
    s_waitcnt lgkmcnt(8)
    v_mfma_f32_16x16x32_bf16 v[232:235], a[232:235], a[120:123], 0
    ds_read_b128 a[224:227], v241 offset:3072
    v_cvt_pk_bf16_f32 v129, v156, v157
    v_mfma_f32_16x16x32_bf16 v[236:239], a[236:239], a[72:75], 0
    s_mul_i32 s66, s28, 0xffffee00
    v_cvt_pk_bf16_f32 v130, v158, v159
    v_cvt_pk_bf16_f32 v131, v160, v161
    v_mfma_f32_16x16x32_bf16 v[138:141], a[236:239], a[96:99], 0
    s_mul_i32 s67, s36, 3
    v_cvt_pk_bf16_f32 v132, v162, v163
    v_cvt_pk_bf16_f32 v133, v164, v165
    v_mfma_f32_16x16x32_bf16 v[142:145], a[236:239], a[120:123], 0
    buffer_load_dwordx4 v174, s[8:11], s62 offen offset:2048 lds
    v_cvt_pk_bf16_f32 v134, v24, v25
    v_mfma_f32_16x16x32_bf16 v[146:149], a[240:243], a[72:75], 0
    ds_read_b128 a[228:231], v241 offset:4608
    v_cvt_pk_bf16_f32 v135, v26, v27
    v_mfma_f32_16x16x32_bf16 v[150:153], a[240:243], a[96:99], 0
    s_add_u32 m0, s29, 0x2400
    v_add_u32 v50, s64, v50
    v_add_u32 v51, s64, v51
    v_mfma_f32_16x16x32_bf16 v[154:157], a[240:243], a[120:123], 0
    s_waitcnt lgkmcnt(6)
    v_mul_u32_u24 v252, 24, v70
    v_lshrrev_b32 v70, 3, v69
    v_mfma_f32_16x16x32_bf16 v[158:161], a[244:247], a[72:75], 0
    s_waitcnt lgkmcnt(4)
    v_lshl_add_u32 v252, v70, 2, v252
    v_and_or_b32 v252, v69, 3, v252
    v_mfma_f32_16x16x32_bf16 v[162:165], a[244:247], a[96:99], 0
    s_waitcnt lgkmcnt(2)
    ds_read_b128 a[232:235], v241 offset:30720
    v_mfma_f32_16x16x32_bf16 v[24:27], a[244:247], a[120:123], 0
    buffer_load_dwordx4 v172, s[8:11], s63 offen lds
    v_mad_u32_u24 v252, v252, 3, v68
    v_mfma_f32_16x16x32_bf16 v[84:87], a[216:219], a[76:79], v[84:87]
    ds_read_b128 a[236:239], v241 offset:32256
    v_lshrrev_b32 v68, 1, v67
    v_mfma_f32_16x16x32_bf16 v[204:207], a[216:219], a[100:103], v[204:207]
    ds_read_b128 a[240:243], v241 offset:33792
    v_and_b32 v70, 1, v67
    v_mfma_f32_16x16x32_bf16 v[208:211], a[216:219], a[124:127], v[208:211]
    s_waitcnt lgkmcnt(4)
    v_add_u32 v68, 32, v68
    v_lshl_add_u32 v252, v252, 3, v70
    v_mfma_f32_16x16x32_bf16 v[212:215], a[220:223], a[76:79], v[212:215]
    buffer_load_dwordx4 v173, s[8:11], s63 offen offset:1024 lds
    v_mul_u32_u24 v69, 43, v68
    v_mfma_f32_16x16x32_bf16 v[216:219], a[220:223], a[100:103], v[216:219]
    ds_read_b128 a[244:247], v241 offset:35328
    v_lshrrev_b32 v70, 8, v69
    v_mfma_f32_16x16x32_bf16 v[220:223], a[220:223], a[124:127], v[220:223]
    s_waitcnt lgkmcnt(4)
    v_lshrrev_b32 v69, 7, v69
    v_mad_i32_i24 v68, v69, -3, v68
    v_mfma_f32_16x16x32_bf16 v[224:227], a[224:227], a[76:79], v[224:227]
    ds_read_b128 a[216:219], v240 offset:128
    v_and_b32 v70, 4, v70
    v_mfma_f32_16x16x32_bf16 v[180:183], a[224:227], a[100:103], v[180:183]
    buffer_load_dwordx4 v174, s[8:11], s63 offen offset:2048 lds
    v_xor_b32 v69, v69, v70
    v_mfma_f32_16x16x32_bf16 v[184:187], a[224:227], a[124:127], v[184:187]
    s_waitcnt lgkmcnt(4)
    v_and_b32 v70, 4, v69
    v_mul_u32_u24 v253, 24, v70
    v_mfma_f32_16x16x32_bf16 v[188:191], a[228:231], a[76:79], v[188:191]
    s_add_u32 m0, s46, 0x1800
    v_lshrrev_b32 v70, 3, v69
    v_lshl_add_u32 v253, v70, 2, v253
    v_mfma_f32_16x16x32_bf16 v[192:195], a[228:231], a[100:103], v[192:195]
    s_waitcnt vmcnt(9)
    ds_read_b64_tr_b16 a[80:81], v249 offset:0
    v_mfma_f32_16x16x32_bf16 v[196:199], a[228:231], a[124:127], v[196:199]
    s_waitcnt lgkmcnt(4)
    ds_read_b64_tr_b16 a[82:83], v250 offset:0
    v_mfma_f32_16x16x32_bf16 v[200:203], a[232:235], a[76:79], v[200:203]
    ds_read_b64_tr_b16 a[104:105], v249 offset:32
    ds_read_b64_tr_b16 a[106:107], v250 offset:32
    v_mfma_f32_16x16x32_bf16 v[228:231], a[232:235], a[100:103], v[228:231]
    buffer_load_dwordx4 v168, s[4:7], s58 offen lds
    ds_read_b64_tr_b16 a[128:129], v249 offset:64
    v_mfma_f32_16x16x32_bf16 v[232:235], a[232:235], a[124:127], v[232:235]
    ds_read_b64_tr_b16 a[130:131], v250 offset:64
    s_waitcnt lgkmcnt(8)
    v_mfma_f32_16x16x32_bf16 v[236:239], a[236:239], a[76:79], v[236:239]
    ds_read_b128 a[220:223], v240 offset:1664
    v_and_b32 v70, 1, v67
    v_mfma_f32_16x16x32_bf16 v[138:141], a[236:239], a[100:103], v[138:141]
    ds_read_b128 a[224:227], v240 offset:3200
    buffer_load_dwordx4 v171, s[4:7], s58 offen offset:512 lds
    v_mfma_f32_16x16x32_bf16 v[142:145], a[236:239], a[124:127], v[142:145]
    s_waitcnt lgkmcnt(9)
    v_cvt_pk_bf16_f32 v136, v54, v55
    v_cvt_pk_bf16_f32 v137, v56, v57
    v_mfma_f32_16x16x32_bf16 v[146:149], a[240:243], a[76:79], v[146:149]
    ds_read_b128 a[228:231], v240 offset:4736
    v_and_or_b32 v253, v69, 3, v253
    v_mfma_f32_16x16x32_bf16 v[150:153], a[240:243], a[100:103], v[150:153]
    s_add_u32 m0, s46, 0x9000
    v_mad_u32_u24 v253, v253, 3, v68
    v_lshl_add_u32 v253, v253, 3, v70
    v_mfma_f32_16x16x32_bf16 v[154:157], a[240:243], a[124:127], v[154:157]
    s_waitcnt lgkmcnt(7)
    s_lshl1_add_u32 s58, s45, s41
    buffer_load_dwordx4 v168, s[4:7], s58 offen lds
    v_mfma_f32_16x16x32_bf16 v[158:161], a[244:247], a[76:79], v[158:161]
    s_waitcnt lgkmcnt(5)
    v_xor_b32 v243, 64, v242
    v_add_u32 v244, 0x237c0, v244
    v_mfma_f32_16x16x32_bf16 v[162:165], a[244:247], a[100:103], v[162:165]
    s_waitcnt lgkmcnt(3)
    ds_read_b128 a[232:235], v240 offset:30848
    v_mfma_f32_16x16x32_bf16 v[24:27], a[244:247], a[124:127], v[24:27]
    s_waitcnt lgkmcnt(3)
    v_add_u32 v245, 0x237c0, v245
    v_add_u32 v246, 0x237c0, v246
    v_mfma_f32_16x16x32_bf16 v[84:87], a[216:219], a[80:83], v[84:87]
    buffer_load_dwordx4 v171, s[4:7], s58 offen offset:512 lds
    v_accvgpr_write_b32 a252, v168
    v_mfma_f32_16x16x32_bf16 v[204:207], a[216:219], a[104:107], v[204:207]
    ds_read_b128 a[236:239], v240 offset:32384
    v_accvgpr_write_b32 a253, v169
    v_mfma_f32_16x16x32_bf16 v[208:211], a[216:219], a[128:131], v[208:211]
    s_waitcnt lgkmcnt(3)
    v_accvgpr_write_b32 a254, v170
    v_accvgpr_write_b32 a255, v171
    v_mfma_f32_16x16x32_bf16 v[212:215], a[220:223], a[80:83], v[212:215]
    ds_read_b128 a[240:243], v240 offset:33920
    v_accvgpr_read_b32 v254, a252
    v_mfma_f32_16x16x32_bf16 v[216:219], a[220:223], a[104:107], v[216:219]
    s_add_u32 m0, s46, 0xf000
    v_accvgpr_read_b32 v255, a253
    v_mov_b32 v248, 0
    v_mfma_f32_16x16x32_bf16 v[220:223], a[220:223], a[128:131], v[220:223]
    s_waitcnt lgkmcnt(3)
    buffer_load_dwordx4 v168, s[4:7], s42 offen lds
    v_mfma_f32_16x16x32_bf16 v[224:227], a[224:227], a[80:83], v[224:227]
    ds_read_b128 a[244:247], v240 offset:35456
    v_lshlrev_b32 v252, 4, v252
    v_mfma_f32_16x16x32_bf16 v[180:183], a[224:227], a[104:107], v[180:183]
    ds_read_b128 a[216:219], v241 offset:128
    v_lshlrev_b32 v253, 4, v253
    v_mfma_f32_16x16x32_bf16 v[184:187], a[224:227], a[128:131], v[184:187]
    s_waitcnt lgkmcnt(4)
    v_add_u32 v253, 0xfffffc00, v253
    s_lshl1_add_u32 s58, s45, s42
    v_mfma_f32_16x16x32_bf16 v[188:191], a[228:231], a[80:83], v[188:191]
    buffer_load_dwordx4 v169, s[4:7], s42 offen offset:1024 lds
    ds_read_b128 a[220:223], v241 offset:1664
    v_mfma_f32_16x16x32_bf16 v[192:195], a[228:231], a[104:107], v[192:195]
    s_waitcnt vmcnt(12)
    ds_read_b64_tr_b16 a[84:85], v249 offset:3072
    v_mfma_f32_16x16x32_bf16 v[196:199], a[228:231], a[128:131], v[196:199]
    s_waitcnt lgkmcnt(5)
    ds_read_b64_tr_b16 a[86:87], v250 offset:3072
    v_mfma_f32_16x16x32_bf16 v[200:203], a[232:235], a[80:83], v[200:203]
    ds_read_b64_tr_b16 a[108:109], v249 offset:3104
    ds_read_b64_tr_b16 a[110:111], v250 offset:3104
    v_mfma_f32_16x16x32_bf16 v[228:231], a[232:235], a[104:107], v[228:231]
    ds_read_b64_tr_b16 a[132:133], v249 offset:3136
    ds_read_b64_tr_b16 a[134:135], v250 offset:3136
    v_mfma_f32_16x16x32_bf16 v[232:235], a[232:235], a[128:131], v[232:235]
    s_waitcnt lgkmcnt(9)
    buffer_load_dwordx4 v170, s[4:7], s42 offen offset:2048 lds
    v_mfma_f32_16x16x32_bf16 v[236:239], a[236:239], a[80:83], v[236:239]
    ds_read_b128 a[224:227], v241 offset:3200
    s_add_u32 m0, s46, 0xfc00
    v_mfma_f32_16x16x32_bf16 v[138:141], a[236:239], a[104:107], v[138:141]
    ds_read_b128 a[228:231], v241 offset:4736
    ds_read_b128 a[232:235], v241 offset:30848
    v_mfma_f32_16x16x32_bf16 v[142:145], a[236:239], a[128:131], v[142:145]
    s_waitcnt lgkmcnt(11)
    ds_read_b128 a[236:239], v241 offset:32384
    v_mfma_f32_16x16x32_bf16 v[146:149], a[240:243], a[80:83], v[146:149]
    buffer_load_dwordx4 v168, s[4:7], s59 offen lds
    ds_read_u16 v30, v50 offset:3456
    v_mfma_f32_16x16x32_bf16 v[150:153], a[240:243], a[104:107], v[150:153]
    ds_read_u16 v31, v51 offset:3456
    ds_read_u16 v32, v50 offset:3482
    v_mfma_f32_16x16x32_bf16 v[154:157], a[240:243], a[128:131], v[154:157]
    s_waitcnt lgkmcnt(11)
    ds_read_b128 a[240:243], v241 offset:33920
    v_mfma_f32_16x16x32_bf16 v[158:161], a[244:247], a[80:83], v[158:161]
    s_waitcnt lgkmcnt(10)
    buffer_load_dwordx4 v169, s[4:7], s59 offen offset:1024 lds
    v_mfma_f32_16x16x32_bf16 v[162:165], a[244:247], a[104:107], v[162:165]
    s_waitcnt lgkmcnt(8)
    ds_read_u16 v33, v51 offset:3482
    v_mfma_f32_16x16x32_bf16 v[24:27], a[244:247], a[128:131], v[24:27]
    ds_read_b128 a[244:247], v241 offset:35456
    ds_read_u16 v34, v50 offset:3508
    v_mfma_f32_16x16x32_bf16 v[84:87], a[216:219], a[84:87], v[84:87]
    ds_read_u16 v35, v51 offset:3508
    ds_read_u16 v37, v51 offset:3534
    v_mfma_f32_16x16x32_bf16 v[204:207], a[216:219], a[108:111], v[204:207]
    ds_read_u16 v39, v51 offset:3560
    ds_read_u16 v41, v51 offset:3586
    v_mfma_f32_16x16x32_bf16 v[208:211], a[216:219], a[132:135], v[208:211]
    s_waitcnt lgkmcnt(14)
    ds_read_b128 a[216:219], v240 offset:256
    v_mfma_f32_16x16x32_bf16 v[212:215], a[220:223], a[84:87], v[212:215]
    ds_read_u16 v43, v51 offset:3612
    ds_read_u16 v45, v51 offset:3638
    v_mfma_f32_16x16x32_bf16 v[216:219], a[220:223], a[108:111], v[216:219]
    ds_read_u16 v47, v51 offset:3664
    ds_read_u16 v49, v51 offset:3690
    v_mfma_f32_16x16x32_bf16 v[220:223], a[220:223], a[132:135], v[220:223]
    ds_read_b128 a[220:223], v240 offset:1792
    buffer_load_dwordx4 v170, s[4:7], s59 offen offset:2048 lds
    v_mfma_f32_16x16x32_bf16 v[224:227], a[224:227], a[84:87], v[224:227]
    s_add_u32 m0, s46, 0x10800
    ds_read_u16 v36, v50 offset:3534
    v_mfma_f32_16x16x32_bf16 v[180:183], a[224:227], a[108:111], v[180:183]
    s_waitcnt lgkmcnt(15)
    v_lshlrev_b32 v30, 16, v30
    v_lshlrev_b32 v31, 16, v31
    v_mfma_f32_16x16x32_bf16 v[184:187], a[224:227], a[132:135], v[184:187]
    s_waitcnt lgkmcnt(14)
    v_fma_f32 v30, v30, v52, v60
    v_fma_f32 v31, v31, v53, v61
    v_mfma_f32_16x16x32_bf16 v[188:191], a[228:231], a[84:87], v[188:191]
    ds_read_b128 a[224:227], v240 offset:3328
    v_lshlrev_b32 v32, 16, v32
    v_mfma_f32_16x16x32_bf16 v[192:195], a[228:231], a[108:111], v[192:195]
    s_waitcnt vmcnt(13) lgkmcnt(14)
    ds_read_b64_tr_b16 a[88:89], v249 offset:6144
    v_mfma_f32_16x16x32_bf16 v[196:199], a[228:231], a[132:135], v[196:199]
    ds_read_b64_tr_b16 a[90:91], v250 offset:6144
    ds_read_b64_tr_b16 a[112:113], v249 offset:6176
    v_mfma_f32_16x16x32_bf16 v[200:203], a[232:235], a[84:87], v[200:203]
    ds_read_b64_tr_b16 a[114:115], v250 offset:6176
    ds_read_b64_tr_b16 a[136:137], v249 offset:6208
    v_mfma_f32_16x16x32_bf16 v[228:231], a[232:235], a[108:111], v[228:231]
    ds_read_b64_tr_b16 a[138:139], v250 offset:6208
    v_lshlrev_b32 v33, 16, v33
    v_mfma_f32_16x16x32_bf16 v[232:235], a[232:235], a[132:135], v[232:235]
    s_waitcnt lgkmcnt(14)
    v_fma_f32 v32, v32, v52, v60
    v_fma_f32 v33, v33, v53, v61
    v_mfma_f32_16x16x32_bf16 v[236:239], a[236:239], a[84:87], v[236:239]
    ds_read_b128 a[228:231], v240 offset:4864
    v_lshlrev_b32 v34, 16, v34
    v_mfma_f32_16x16x32_bf16 v[138:141], a[236:239], a[108:111], v[138:141]
    ds_read_b128 a[232:235], v240 offset:30976
    v_lshlrev_b32 v35, 16, v35
    v_mfma_f32_16x16x32_bf16 v[142:145], a[236:239], a[132:135], v[142:145]
    ds_read_b128 a[236:239], v240 offset:32512
    v_fma_f32 v34, v34, v52, v60
    v_mfma_f32_16x16x32_bf16 v[146:149], a[240:243], a[84:87], v[146:149]
    buffer_load_dwordx4 v168, s[4:7], s58 offen lds
    v_fma_f32 v35, v35, v53, v61
    v_mfma_f32_16x16x32_bf16 v[150:153], a[240:243], a[108:111], v[150:153]
    ds_read_u16 v38, v50 offset:3560
    v_lshlrev_b32 v37, 16, v37
    v_mfma_f32_16x16x32_bf16 v[154:157], a[240:243], a[132:135], v[154:157]
    s_waitcnt lgkmcnt(8)
    v_lshlrev_b32 v39, 16, v39
    v_lshlrev_b32 v41, 16, v41
    v_mfma_f32_16x16x32_bf16 v[158:161], a[244:247], a[84:87], v[158:161]
    s_waitcnt lgkmcnt(6)
    v_lshlrev_b32 v43, 16, v43
    v_lshlrev_b32 v45, 16, v45
    v_mfma_f32_16x16x32_bf16 v[162:165], a[244:247], a[108:111], v[162:165]
    s_waitcnt lgkmcnt(4)
    v_lshlrev_b32 v47, 16, v47
    v_lshlrev_b32 v49, 16, v49
    v_mfma_f32_16x16x32_bf16 v[24:27], a[244:247], a[132:135], v[24:27]
    ds_read_b128 a[240:243], v240 offset:34048
    v_fma_f32 v37, v37, v53, v61
    v_mfma_f32_16x16x32_bf16 v[84:87], a[216:219], a[88:91], v[84:87]
    ds_read_b128 a[244:247], v240 offset:35584
    v_fma_f32 v39, v39, v53, v61
    v_mfma_f32_16x16x32_bf16 v[204:207], a[216:219], a[112:115], v[204:207]
    ds_read_u16 v40, v50 offset:3586
    v_fma_f32 v41, v41, v53, v61
    v_mfma_f32_16x16x32_bf16 v[208:211], a[216:219], a[136:139], v[208:211]
    ds_read_b128 a[216:219], v241 offset:256
    v_fma_f32 v43, v43, v53, v61
    v_mfma_f32_16x16x32_bf16 v[212:215], a[220:223], a[88:91], v[212:215]
    ds_read_u16 v42, v50 offset:3612
    v_fma_f32 v45, v45, v53, v61
    v_mfma_f32_16x16x32_bf16 v[216:219], a[220:223], a[112:115], v[216:219]
    ds_read_u16 v44, v50 offset:3638
    s_waitcnt lgkmcnt(9)
    v_mfma_f32_16x16x32_bf16 v[220:223], a[220:223], a[136:139], v[220:223]
    ds_read_b128 a[220:223], v241 offset:1792
    v_fma_f32 v47, v47, v53, v61
    v_mfma_f32_16x16x32_bf16 v[224:227], a[224:227], a[88:91], v[224:227]
    s_waitcnt lgkmcnt(9)
    v_fma_f32 v49, v49, v53, v61
    v_lshlrev_b32 v36, 16, v36
    v_mfma_f32_16x16x32_bf16 v[180:183], a[224:227], a[112:115], v[180:183]
    s_waitcnt lgkmcnt(8)
    v_fma_f32 v36, v36, v52, v60
    s_add_u32 s62, s39, 0x12000
    v_mfma_f32_16x16x32_bf16 v[184:187], a[224:227], a[136:139], v[184:187]
    ds_read_b128 a[224:227], v241 offset:3328
    ds_read_u16 v46, v50 offset:3664
    v_mfma_f32_16x16x32_bf16 v[188:191], a[228:231], a[88:91], v[188:191]
    ds_read_u16 v48, v50 offset:3690
    buffer_load_dwordx4 v171, s[4:7], s58 offen offset:512 lds
    v_mfma_f32_16x16x32_bf16 v[192:195], a[228:231], a[112:115], v[192:195]
    s_waitcnt vmcnt(12) lgkmcnt(10)
    ds_read_b64_tr_b16 a[92:93], v249 offset:9216
    v_mfma_f32_16x16x32_bf16 v[196:199], a[228:231], a[136:139], v[196:199]
    ds_read_b64_tr_b16 a[94:95], v250 offset:9216
    ds_read_b64_tr_b16 a[116:117], v249 offset:9248
    v_mfma_f32_16x16x32_bf16 v[200:203], a[232:235], a[88:91], v[200:203]
    ds_read_b64_tr_b16 a[118:119], v250 offset:9248
    ds_read_b64_tr_b16 a[140:141], v249 offset:9280
    v_mfma_f32_16x16x32_bf16 v[228:231], a[232:235], a[112:115], v[228:231]
    ds_read_b64_tr_b16 a[142:143], v250 offset:9280
    s_waitcnt lgkmcnt(13)
    v_mfma_f32_16x16x32_bf16 v[232:235], a[232:235], a[136:139], v[232:235]
    ds_read_b128 a[228:231], v241 offset:4864
    v_lshlrev_b32 v38, 16, v38
    v_mfma_f32_16x16x32_bf16 v[236:239], a[236:239], a[88:91], v[236:239]
    ds_read_b128 a[232:235], v241 offset:30976
    v_fma_f32 v38, v38, v52, v60
    v_mfma_f32_16x16x32_bf16 v[138:141], a[236:239], a[112:115], v[138:141]
    ds_write_b64 v62, v[30:31] offset:0
    v_mfma_f32_16x16x32_bf16 v[142:145], a[236:239], a[136:139], v[142:145]
    ds_read_b128 a[236:239], v241 offset:32512
    v_add_u32 v62, s49, v62
    v_mfma_f32_16x16x32_bf16 v[146:149], a[240:243], a[88:91], v[146:149]
L_h2:
    s_cbranch_execz L_h6
    ds_write_b64 v62, v[32:33] offset:0
    v_mfma_f32_16x16x32_bf16 v[150:153], a[240:243], a[112:115], v[150:153]
    s_add_u32 m0, s29, 0
    v_add_u32 v62, s49, v62
    v_lshlrev_b32 v40, 16, v40
    v_mfma_f32_16x16x32_bf16 v[154:157], a[240:243], a[136:139], v[154:157]
    s_waitcnt lgkmcnt(9)
    v_fma_f32 v40, v40, v52, v60
    v_lshlrev_b32 v42, 16, v42
    v_mfma_f32_16x16x32_bf16 v[158:161], a[244:247], a[88:91], v[158:161]
    s_waitcnt lgkmcnt(7)
    v_fma_f32 v42, v42, v52, v60
    v_lshlrev_b32 v44, 16, v44
    v_mfma_f32_16x16x32_bf16 v[162:165], a[244:247], a[112:115], v[162:165]
    s_waitcnt lgkmcnt(5)
    v_fma_f32 v44, v44, v52, v60
    v_lshlrev_b32 v46, 16, v46
    v_mfma_f32_16x16x32_bf16 v[24:27], a[244:247], a[136:139], v[24:27]
    ds_read_b128 a[240:243], v241 offset:34048
    v_fma_f32 v46, v46, v52, v60
    v_mfma_f32_16x16x32_bf16 v[84:87], a[216:219], a[92:95], v[84:87]
    ds_read_b128 a[244:247], v241 offset:35584
    v_lshlrev_b32 v48, 16, v48
    v_mfma_f32_16x16x32_bf16 v[204:207], a[216:219], a[116:119], v[204:207]
    ds_write_b64 v62, v[34:35] offset:0
    v_mfma_f32_16x16x32_bf16 v[208:211], a[216:219], a[140:143], v[208:211]
    ds_write_b64 v63, v[64:65] offset:0
    v_mfma_f32_16x16x32_bf16 v[212:215], a[220:223], a[92:95], v[212:215]
    s_waitcnt lgkmcnt(8)
    v_add_u32 v62, s49, v62
    v_cvt_pk_bf16_f32 v0, v84, v85
    v_mfma_f32_16x16x32_bf16 v[216:219], a[220:223], a[116:119], v[216:219]
    s_waitcnt lgkmcnt(7)
    v_cvt_pk_bf16_f32 v3, v86, v87
    v_fma_f32 v48, v48, v52, v60
    v_mfma_f32_16x16x32_bf16 v[220:223], a[220:223], a[140:143], v[220:223]
    buffer_load_dwordx4 v172, s[8:11], s60 offen lds
    v_cvt_pk_bf16_f32 v30, v204, v205
    v_mfma_f32_16x16x32_bf16 v[224:227], a[224:227], a[92:95], v[224:227]
    s_waitcnt lgkmcnt(5)
    v_cvt_pk_bf16_f32 v33, v206, v207
    v_cvt_pk_bf16_f32 v60, v208, v209
    v_mfma_f32_16x16x32_bf16 v[180:183], a[224:227], a[116:119], v[180:183]
    ds_write_b64 v62, v[36:37] offset:0
    v_mfma_f32_16x16x32_bf16 v[184:187], a[224:227], a[140:143], v[184:187]
    s_add_u32 s63, s39, 0x1b000
    v_add_u32 v62, s49, v62
    v_cvt_pk_bf16_f32 v63, v210, v211
    v_mfma_f32_16x16x32_bf16 v[188:191], a[228:231], a[92:95], v[188:191]
    ds_write_b64 v62, v[38:39] offset:0
    v_mfma_f32_16x16x32_bf16 v[192:195], a[228:231], a[116:119], v[192:195]
    s_waitcnt vmcnt(9)
    s_barrier
    v_mfma_f32_16x16x32_bf16 v[196:199], a[228:231], a[140:143], v[196:199]
    ds_read_b128 a[216:219], v240 offset:6144
    v_add_u32 v62, s49, v62
    v_mfma_f32_16x16x32_bf16 v[200:203], a[232:235], a[92:95], v[200:203]
    s_waitcnt lgkmcnt(4)
    v_cvt_pk_bf16_f32 v72, v184, v185
    v_cvt_pk_bf16_f32 v6, v212, v213
    v_mfma_f32_16x16x32_bf16 v[228:231], a[232:235], a[116:119], v[228:231]
    ds_read_b128 a[220:223], v241 offset:6144
    v_cvt_pk_bf16_f32 v78, v196, v197
    v_mfma_f32_16x16x32_bf16 v[232:235], a[232:235], a[140:143], v[232:235]
    ds_read_b128 a[224:227], v240 offset:6272
    v_cvt_pk_bf16_f32 v81, v198, v199
    v_mfma_f32_16x16x32_bf16 v[236:239], a[236:239], a[92:95], v[236:239]
    ds_read_b128 a[228:231], v241 offset:6272
    v_cvt_pk_bf16_f32 v1, v200, v201
    v_mfma_f32_16x16x32_bf16 v[138:141], a[236:239], a[116:119], v[138:141]
    s_add_u32 s59, s43, s45
    v_cvt_pk_bf16_f32 v31, v228, v229
    v_cvt_pk_bf16_f32 v34, v230, v231
    v_mfma_f32_16x16x32_bf16 v[142:145], a[236:239], a[140:143], v[142:145]
    ds_read_b128 a[232:235], v240 offset:6400
    v_cvt_pk_bf16_f32 v61, v232, v233
    v_mfma_f32_16x16x32_bf16 v[146:149], a[240:243], a[92:95], v[146:149]
    ds_read_b128 a[236:239], v241 offset:6400
    v_cvt_pk_bf16_f32 v64, v234, v235
    v_mfma_f32_16x16x32_bf16 v[150:153], a[240:243], a[116:119], v[150:153]
    s_lshl1_add_u32 s58, s45, s43
    v_cvt_pk_bf16_f32 v7, v236, v237
    v_cvt_pk_bf16_f32 v10, v238, v239
    v_mfma_f32_16x16x32_bf16 v[154:157], a[240:243], a[140:143], v[154:157]
    s_waitcnt lgkmcnt(5)
    v_cvt_pk_bf16_f32 v37, v138, v139
    v_cvt_pk_bf16_f32 v67, v142, v143
    v_mfma_f32_16x16x32_bf16 v[158:161], a[244:247], a[92:95], v[158:161]
    buffer_load_dwordx4 v173, s[8:11], s60 offen offset:1024 lds
    v_cvt_pk_bf16_f32 v70, v144, v145
    v_mfma_f32_16x16x32_bf16 v[162:165], a[244:247], a[116:119], v[162:165]
    ds_write_b64 v62, v[40:41] offset:0
    v_mfma_f32_16x16x32_bf16 v[24:27], a[244:247], a[140:143], v[24:27]
    ds_read_b128 a[240:243], v240 offset:36864
    v_cvt_pk_bf16_f32 v40, v140, v141
    v_mfma_f32_16x16x32_bf16 v[228:231], a[0:3], a[216:219], 0
    s_waitcnt lgkmcnt(6)
    v_add_u32 v62, s49, v62
    v_cvt_pk_bf16_f32 v13, v146, v147
    v_mfma_f32_16x16x32_bf16 v[228:231], a[4:7], a[220:223], v[228:231]
    ds_read_b128 a[244:247], v241 offset:36864
    v_cvt_pk_bf16_f32 v79, v24, v25
    v_mfma_f32_16x16x32_bf16 v[232:235], a[24:27], a[216:219], 0
    s_waitcnt lgkmcnt(6)
    v_cvt_pk_bf16_f32 v82, v26, v27
    v_cvt_pk_bf16_f32 v16, v148, v149
    v_mfma_f32_16x16x32_bf16 v[228:231], a[8:11], a[224:227], v[228:231]
    ds_write_b64 v62, v[42:43] offset:0
    v_mfma_f32_16x16x32_bf16 v[232:235], a[28:31], a[220:223], v[232:235]
    s_waitcnt lgkmcnt(6)
    v_add_u32 v62, s49, v62
    v_cvt_pk_bf16_f32 v43, v150, v151
    v_mfma_f32_16x16x32_bf16 v[228:231], a[12:15], a[228:231], v[228:231]
    buffer_load_dwordx4 v174, s[8:11], s60 offen offset:2048 lds
    v_cvt_pk_bf16_f32 v73, v154, v155
    v_mfma_f32_16x16x32_bf16 v[232:235], a[32:35], a[224:227], v[232:235]
    s_waitcnt lgkmcnt(5)
    v_cvt_pk_bf16_f32 v76, v156, v157
    v_cvt_pk_bf16_f32 v19, v158, v159
    v_mfma_f32_16x16x32_bf16 v[228:231], a[16:19], a[232:235], v[228:231]
    s_waitcnt lgkmcnt(4)
    v_cvt_pk_bf16_f32 v22, v160, v161
    v_cvt_pk_bf16_f32 v52, v164, v165
    v_mfma_f32_16x16x32_bf16 v[228:231], a[20:23], a[236:239], v[228:231]
    s_add_u32 m0, s29, 0xc00
    v_cvt_pk_bf16_f32 v4, v202, v203
    v_cvt_pk_bf16_f32 v42, v180, v181
    v_mfma_f32_16x16x32_bf16 v[232:235], a[36:39], a[228:231], v[232:235]
    ds_write_b64 v62, v[44:45] offset:0
    v_mfma_f32_16x16x32_bf16 v[232:235], a[40:43], a[232:235], v[232:235]
    s_add_u32 s60, s39, 0x24000
    v_add_u32 v62, s49, v62
    v_cvt_pk_bf16_f32 v138, v228, v229
    v_mfma_f32_16x16x32_bf16 v[232:235], a[44:47], a[236:239], v[232:235]
    s_add_u32 s55, s28, 7
    v_cvt_pk_bf16_f32 v139, v230, v231
    v_cvt_pk_bf16_f32 v45, v182, v183
    v_mfma_f32_16x16x32_bf16 v[236:239], a[48:51], a[216:219], 0
    buffer_load_dwordx4 v172, s[8:11], s61 offen lds
    v_cvt_pk_bf16_f32 v9, v214, v215
    v_mfma_f32_16x16x32_bf16 v[236:239], a[52:55], a[220:223], v[236:239]
    ds_write_b64 v62, v[46:47] offset:0
    v_mfma_f32_16x16x32_bf16 v[236:239], a[56:59], a[224:227], v[236:239]
    s_mul_i32 s55, s55, s30
    v_cvt_pk_bf16_f32 v140, v232, v233
    v_cvt_pk_bf16_f32 v141, v234, v235
    v_mfma_f32_16x16x32_bf16 v[236:239], a[60:63], a[228:231], v[236:239]
    s_waitcnt lgkmcnt(2)
    v_cvt_pk_bf16_f32 v46, v152, v153
    v_add_u32 v62, s49, v62
    v_mfma_f32_16x16x32_bf16 v[236:239], a[64:67], a[232:235], v[236:239]
    ds_write_b64 v62, v[48:49] offset:0
    v_mfma_f32_16x16x32_bf16 v[236:239], a[68:71], a[236:239], v[236:239]
    v_add_u32 v62, s49, v62
    v_cvt_pk_bf16_f32 v49, v162, v163
    v_mfma_f32_16x16x32_bf16 v[228:231], a[216:219], a[72:75], 0
    ds_read_b128 v[196:199], v244 offset:192
    v_cvt_pk_bf16_f32 v36, v216, v217
    v_mfma_f32_16x16x32_bf16 v[228:231], a[220:223], a[76:79], v[228:231]
    ds_read_b128 v[200:203], v245 offset:192
    v_cvt_pk_bf16_f32 v39, v218, v219
    v_mfma_f32_16x16x32_bf16 v[228:231], a[224:227], a[80:83], v[228:231]
    v_cvt_pk_bf16_f32 v142, v236, v237
    v_cvt_pk_bf16_f32 v143, v238, v239
    v_mfma_f32_16x16x32_bf16 v[228:231], a[228:231], a[84:87], v[228:231]
    ds_read_b128 v[204:207], v246 offset:192
    v_cvt_pk_bf16_f32 v66, v220, v221
    v_mfma_f32_16x16x32_bf16 v[228:231], a[232:235], a[88:91], v[228:231]
    ds_read_b128 v[208:211], v244 offset:256
    v_cvt_pk_bf16_f32 v69, v222, v223
    v_mfma_f32_16x16x32_bf16 v[228:231], a[236:239], a[92:95], v[228:231]
    v_cvt_pk_bf16_f32 v12, v224, v225
    v_cvt_pk_bf16_f32 v15, v226, v227
    v_mfma_f32_16x16x32_bf16 v[232:235], a[216:219], a[96:99], 0
    v_cvt_pk_bf16_f32 v75, v186, v187
    v_cvt_pk_bf16_f32 v18, v188, v189
    v_mfma_f32_16x16x32_bf16 v[232:235], a[220:223], a[100:103], v[232:235]
    v_cvt_pk_bf16_f32 v21, v190, v191
    v_cvt_pk_bf16_f32 v48, v192, v193
    v_mfma_f32_16x16x32_bf16 v[232:235], a[224:227], a[104:107], v[232:235]
    buffer_load_dwordx4 v173, s[8:11], s61 offen offset:1024 lds
    v_cvt_pk_bf16_f32 v24, v228, v229
    v_mfma_f32_16x16x32_bf16 v[232:235], a[228:231], a[108:111], v[232:235]
    v_cvt_pk_bf16_f32 v27, v230, v231
    v_cvt_pk_bf16_f32 v51, v194, v195
    v_mfma_f32_16x16x32_bf16 v[232:235], a[232:235], a[112:115], v[232:235]
    s_waitcnt lgkmcnt(3)
    v_mov_b32 v195, 0
    v_mfma_f32_16x16x32_bf16 v[232:235], a[236:239], a[116:119], v[232:235]
    s_waitcnt lgkmcnt(2)
    v_mfma_f32_16x16x32_bf16 v[236:239], a[216:219], a[120:123], 0
    ds_read_b128 a[216:219], v240 offset:36992
    v_mfma_f32_16x16x32_bf16 v[236:239], a[220:223], a[124:127], v[236:239]
    ds_read_b128 a[220:223], v241 offset:36992
    v_mfma_f32_16x16x32_bf16 v[236:239], a[224:227], a[128:131], v[236:239]
    ds_read_b128 a[224:227], v240 offset:37120
    v_mfma_f32_16x16x32_bf16 v[236:239], a[228:231], a[132:135], v[236:239]
    ds_read_b128 a[228:231], v241 offset:37120
    v_cvt_pk_bf16_f32 v54, v232, v233
    v_mfma_f32_16x16x32_bf16 v[236:239], a[232:235], a[136:139], v[236:239]
    buffer_load_dwordx4 v174, s[8:11], s61 offen offset:2048 lds
    v_cvt_pk_bf16_f32 v57, v234, v235
    v_mfma_f32_16x16x32_bf16 v[236:239], a[236:239], a[140:143], v[236:239]
    s_add_u32 m0, s29, 0x1800
    s_add_u32 s61, s39, 0x2d000
    v_mfma_f32_16x16x32_bf16 v[228:231], a[0:3], a[240:243], 0
    s_waitcnt lgkmcnt(4)
    v_mfma_f32_16x16x32_bf16 v[228:231], a[4:7], a[244:247], v[228:231]
    v_mfma_f32_16x16x32_bf16 v[232:235], a[24:27], a[240:243], 0
    v_mfma_f32_16x16x32_bf16 v[232:235], a[28:31], a[244:247], v[232:235]
    s_waitcnt lgkmcnt(3)
    v_cvt_pk_bf16_f32 v84, v236, v237
    v_cvt_pk_bf16_f32 v87, v238, v239
    v_mfma_f32_16x16x32_bf16 v[228:231], a[8:11], a[216:219], v[228:231]
    s_waitcnt lgkmcnt(2)
    v_mfma_f32_16x16x32_bf16 v[228:231], a[12:15], a[220:223], v[228:231]
    s_waitcnt lgkmcnt(1)
    buffer_load_dwordx4 v172, s[8:11], s62 offen lds
    v_mfma_f32_16x16x32_bf16 v[228:231], a[16:19], a[224:227], v[228:231]
    s_waitcnt lgkmcnt(0)
    v_mfma_f32_16x16x32_bf16 v[228:231], a[20:23], a[228:231], v[228:231]
    v_mfma_f32_16x16x32_bf16 v[232:235], a[32:35], a[216:219], v[232:235]
    v_mfma_f32_16x16x32_bf16 v[232:235], a[36:39], a[220:223], v[232:235]
    v_mfma_f32_16x16x32_bf16 v[232:235], a[40:43], a[224:227], v[232:235]
    v_mfma_f32_16x16x32_bf16 v[232:235], a[44:47], a[228:231], v[232:235]
    v_mfma_f32_16x16x32_bf16 v[236:239], a[48:51], a[240:243], 0
    buffer_load_dwordx4 v173, s[8:11], s62 offen offset:1024 lds
    v_mfma_f32_16x16x32_bf16 v[236:239], a[52:55], a[244:247], v[236:239]
    v_mfma_f32_16x16x32_bf16 v[236:239], a[56:59], a[216:219], v[236:239]
    v_cvt_pk_bf16_f32 v144, v228, v229
    v_cvt_pk_bf16_f32 v145, v230, v231
    v_mfma_f32_16x16x32_bf16 v[236:239], a[60:63], a[220:223], v[236:239]
    v_mfma_f32_16x16x32_bf16 v[236:239], a[64:67], a[224:227], v[236:239]
    v_cvt_pk_bf16_f32 v146, v232, v233
    v_cvt_pk_bf16_f32 v147, v234, v235
    v_mfma_f32_16x16x32_bf16 v[236:239], a[68:71], a[228:231], v[236:239]
    v_mfma_f32_16x16x32_bf16 v[228:231], a[240:243], a[72:75], 0
    v_mfma_f32_16x16x32_bf16 v[228:231], a[244:247], a[76:79], v[228:231]
    buffer_load_dwordx4 v174, s[8:11], s62 offen offset:2048 lds
    s_add_u32 m0, s29, 0x2400
    v_mfma_f32_16x16x32_bf16 v[228:231], a[216:219], a[80:83], v[228:231]
    s_lshl_b32 s62, s28, 5
    s_add_u32 s62, s62, 0
    v_mfma_f32_16x16x32_bf16 v[228:231], a[220:223], a[84:87], v[228:231]
    v_cvt_pk_bf16_f32 v148, v236, v237
    v_cvt_pk_bf16_f32 v149, v238, v239
    v_mfma_f32_16x16x32_bf16 v[228:231], a[224:227], a[88:91], v[228:231]
    s_waitcnt vmcnt(12)
    s_barrier
    v_mfma_f32_16x16x32_bf16 v[228:231], a[228:231], a[92:95], v[228:231]
    ds_read_b128 a[232:235], v240 offset:61440
    ds_read_b128 a[236:239], v241 offset:61440
    v_mfma_f32_16x16x32_bf16 v[232:235], a[240:243], a[96:99], 0
    buffer_load_dwordx4 v172, s[8:11], s63 offen lds
    v_mfma_f32_16x16x32_bf16 v[232:235], a[244:247], a[100:103], v[232:235]
    v_mfma_f32_16x16x32_bf16 v[232:235], a[216:219], a[104:107], v[232:235]
    v_mfma_f32_16x16x32_bf16 v[232:235], a[220:223], a[108:111], v[232:235]
    v_mfma_f32_16x16x32_bf16 v[232:235], a[224:227], a[112:115], v[232:235]
    v_cvt_pk_bf16_f32 v25, v228, v229
    v_cvt_pk_bf16_f32 v28, v230, v231
    v_mfma_f32_16x16x32_bf16 v[232:235], a[228:231], a[116:119], v[232:235]
    v_mfma_f32_16x16x32_bf16 v[236:239], a[240:243], a[120:123], 0
    ds_read_b128 a[240:243], v240 offset:61568
    v_mfma_f32_16x16x32_bf16 v[236:239], a[244:247], a[124:127], v[236:239]
    ds_read_b128 a[244:247], v241 offset:61568
    buffer_load_dwordx4 v173, s[8:11], s63 offen offset:1024 lds
    v_mfma_f32_16x16x32_bf16 v[236:239], a[216:219], a[128:131], v[236:239]
    ds_read_b128 a[216:219], v240 offset:61696
    s_waitcnt lgkmcnt(4)
    v_mfma_f32_16x16x32_bf16 v[236:239], a[220:223], a[132:135], v[236:239]
    ds_read_b128 a[220:223], v241 offset:61696
    v_cvt_pk_bf16_f32 v55, v232, v233
    v_mfma_f32_16x16x32_bf16 v[236:239], a[224:227], a[136:139], v[236:239]
    ds_read_b128 a[224:227], v240 offset:62976
    v_cvt_pk_bf16_f32 v58, v234, v235
    v_mfma_f32_16x16x32_bf16 v[236:239], a[228:231], a[140:143], v[236:239]
    ds_read_b128 a[228:231], v241 offset:62976
    v_mfma_f32_16x16x32_bf16 v[228:231], a[0:3], a[232:235], 0
    s_waitcnt lgkmcnt(6)
    v_mfma_f32_16x16x32_bf16 v[228:231], a[4:7], a[236:239], v[228:231]
    s_waitcnt vmcnt(8)
    ds_read_b64_tr_b16 a[144:145], v249 offset:0
    v_mfma_f32_16x16x32_bf16 v[232:235], a[24:27], a[232:235], 0
    s_waitcnt lgkmcnt(6)
    ds_read_b64_tr_b16 a[146:147], v250 offset:0
    v_mfma_f32_16x16x32_bf16 v[228:231], a[8:11], a[240:243], v[228:231]
    s_waitcnt lgkmcnt(6)
    ds_read_b64_tr_b16 a[168:169], v249 offset:32
    v_mfma_f32_16x16x32_bf16 v[228:231], a[12:15], a[244:247], v[228:231]
    ds_read_b64_tr_b16 a[170:171], v250 offset:32
    ds_read_b64_tr_b16 a[192:193], v249 offset:64
    v_mfma_f32_16x16x32_bf16 v[232:235], a[28:31], a[236:239], v[232:235]
    ds_read_b64_tr_b16 a[194:195], v250 offset:64
    s_waitcnt lgkmcnt(9)
    v_mfma_f32_16x16x32_bf16 v[228:231], a[16:19], a[216:219], v[228:231]
    s_waitcnt lgkmcnt(8)
    buffer_load_dwordx4 v174, s[8:11], s63 offen offset:2048 lds
    v_mfma_f32_16x16x32_bf16 v[228:231], a[20:23], a[220:223], v[228:231]
    s_add_u32 m0, s29, 0
    v_cvt_pk_bf16_f32 v85, v236, v237
    v_cvt_pk_bf16_f32 v88, v238, v239
    v_mfma_f32_16x16x32_bf16 v[232:235], a[32:35], a[240:243], v[232:235]
    s_lshl_b32 s63, s28, 5
    s_add_u32 s63, s63, 0x4800
    v_mfma_f32_16x16x32_bf16 v[232:235], a[36:39], a[244:247], v[232:235]
    s_waitcnt lgkmcnt(6)
    v_cvt_pk_bf16_f32 v150, v228, v229
    v_cvt_pk_bf16_f32 v151, v230, v231
    v_mfma_f32_16x16x32_bf16 v[232:235], a[40:43], a[216:219], v[232:235]
    v_mfma_f32_16x16x32_bf16 v[232:235], a[44:47], a[220:223], v[232:235]
    s_waitcnt lgkmcnt(5)
    v_mfma_f32_16x16x32_bf16 v[236:239], a[48:51], a[232:235], 0
    s_waitcnt lgkmcnt(4)
    v_mfma_f32_16x16x32_bf16 v[236:239], a[52:55], a[236:239], v[236:239]
    s_waitcnt lgkmcnt(3)
    s_waitcnt lgkmcnt(0)
    buffer_load_dwordx4 v172, s[8:11], s60 offen lds
    v_mfma_f32_16x16x32_bf16 v[236:239], a[56:59], a[240:243], v[236:239]
    v_cvt_pk_bf16_f32 v152, v232, v233
    v_cvt_pk_bf16_f32 v153, v234, v235
    v_mfma_f32_16x16x32_bf16 v[236:239], a[60:63], a[244:247], v[236:239]
    v_mfma_f32_16x16x32_bf16 v[236:239], a[64:67], a[216:219], v[236:239]
    v_mfma_f32_16x16x32_bf16 v[236:239], a[68:71], a[220:223], v[236:239]
    v_mfma_f32_16x16x32_bf16 v[228:231], a[232:235], a[72:75], 0
    v_mfma_f32_16x16x32_bf16 v[228:231], a[236:239], a[76:79], v[228:231]
    v_mfma_f32_16x16x32_bf16 v[228:231], a[240:243], a[80:83], v[228:231]
    buffer_load_dwordx4 v173, s[8:11], s60 offen offset:1024 lds
    v_mfma_f32_16x16x32_bf16 v[228:231], a[244:247], a[84:87], v[228:231]
    v_mfma_f32_16x16x32_bf16 v[228:231], a[216:219], a[88:91], v[228:231]
    s_waitcnt vmcnt(8)
    ds_read_b64_tr_b16 a[148:149], v249 offset:3072
    v_mfma_f32_16x16x32_bf16 v[228:231], a[220:223], a[92:95], v[228:231]
    ds_read_b64_tr_b16 a[150:151], v250 offset:3072
    ds_read_b64_tr_b16 a[172:173], v249 offset:3104
    v_mfma_f32_16x16x32_bf16 v[232:235], a[232:235], a[96:99], 0
    ds_read_b64_tr_b16 a[174:175], v250 offset:3104
    ds_read_b64_tr_b16 a[196:197], v249 offset:3136
    v_mfma_f32_16x16x32_bf16 v[232:235], a[236:239], a[100:103], v[232:235]
    ds_read_b64_tr_b16 a[198:199], v250 offset:3136
    v_cvt_pk_bf16_f32 v154, v236, v237
    v_mfma_f32_16x16x32_bf16 v[232:235], a[240:243], a[104:107], v[232:235]
    v_cvt_pk_bf16_f32 v155, v238, v239
    v_cvt_pk_bf16_f32 v2, v228, v229
    v_mfma_f32_16x16x32_bf16 v[232:235], a[244:247], a[108:111], v[232:235]
    buffer_load_dwordx4 v174, s[8:11], s60 offen offset:2048 lds
    v_cvt_pk_bf16_f32 v5, v230, v231
    v_mfma_f32_16x16x32_bf16 v[232:235], a[216:219], a[112:115], v[232:235]
    s_add_u32 m0, s29, 0xc00
    s_lshl_b32 s60, s28, 5
    s_add_u32 s60, s60, 0x1800
    v_mfma_f32_16x16x32_bf16 v[232:235], a[220:223], a[116:119], v[232:235]
    v_mfma_f32_16x16x32_bf16 v[236:239], a[232:235], a[120:123], 0
    ds_read_b128 a[232:235], v240 offset:63104
    v_mfma_f32_16x16x32_bf16 v[236:239], a[236:239], a[124:127], v[236:239]
    ds_read_b128 a[236:239], v241 offset:63104
    v_mfma_f32_16x16x32_bf16 v[236:239], a[240:243], a[128:131], v[236:239]
    ds_read_b128 a[240:243], v240 offset:63232
    v_mfma_f32_16x16x32_bf16 v[236:239], a[244:247], a[132:135], v[236:239]
    ds_read_b128 a[244:247], v241 offset:63232
    s_waitcnt lgkmcnt(4)
    v_mfma_f32_16x16x32_bf16 v[236:239], a[216:219], a[136:139], v[236:239]
    buffer_load_dwordx4 v172, s[8:11], s61 offen lds
    v_cvt_pk_bf16_f32 v32, v232, v233
    v_mfma_f32_16x16x32_bf16 v[236:239], a[220:223], a[140:143], v[236:239]
    ds_read_b128 a[216:219], v240 offset:64512
    v_cvt_pk_bf16_f32 v35, v234, v235
    v_mfma_f32_16x16x32_bf16 v[228:231], a[0:3], a[224:227], 0
    ds_read_b128 a[220:223], v241 offset:64512
    v_mfma_f32_16x16x32_bf16 v[228:231], a[4:7], a[228:231], v[228:231]
    v_mfma_f32_16x16x32_bf16 v[232:235], a[24:27], a[224:227], 0
    v_mfma_f32_16x16x32_bf16 v[232:235], a[28:31], a[228:231], v[232:235]
    s_waitcnt vmcnt(7) lgkmcnt(5)
    v_cvt_pk_bf16_f32 v62, v236, v237
    v_cvt_pk_bf16_f32 v65, v238, v239
    v_mfma_f32_16x16x32_bf16 v[228:231], a[8:11], a[232:235], v[228:231]
    s_waitcnt lgkmcnt(4)
    ds_read_b64_tr_b16 a[152:153], v249 offset:6144
    v_mfma_f32_16x16x32_bf16 v[228:231], a[12:15], a[236:239], v[228:231]
    s_waitcnt lgkmcnt(4)
    buffer_load_dwordx4 v173, s[8:11], s61 offen offset:1024 lds
    v_mfma_f32_16x16x32_bf16 v[228:231], a[16:19], a[240:243], v[228:231]
    s_waitcnt lgkmcnt(3)
    ds_read_b64_tr_b16 a[154:155], v250 offset:6144
    v_mfma_f32_16x16x32_bf16 v[228:231], a[20:23], a[244:247], v[228:231]
    ds_read_b64_tr_b16 a[176:177], v249 offset:6176
    ds_read_b64_tr_b16 a[178:179], v250 offset:6176
    v_mfma_f32_16x16x32_bf16 v[232:235], a[32:35], a[232:235], v[232:235]
    ds_read_b64_tr_b16 a[200:201], v249 offset:6208
    ds_read_b64_tr_b16 a[202:203], v250 offset:6208
    v_mfma_f32_16x16x32_bf16 v[232:235], a[36:39], a[236:239], v[232:235]
    s_waitcnt lgkmcnt(6)
    v_mfma_f32_16x16x32_bf16 v[232:235], a[40:43], a[240:243], v[232:235]
    v_cvt_pk_bf16_f32 v156, v228, v229
    v_cvt_pk_bf16_f32 v157, v230, v231
    v_mfma_f32_16x16x32_bf16 v[232:235], a[44:47], a[244:247], v[232:235]
    v_mfma_f32_16x16x32_bf16 v[236:239], a[48:51], a[224:227], 0
    buffer_load_dwordx4 v174, s[8:11], s61 offen offset:2048 lds
    s_add_u32 m0, s46, 0x16800
    v_mfma_f32_16x16x32_bf16 v[236:239], a[52:55], a[228:231], v[236:239]
    s_lshl_b32 s61, s28, 5
    s_add_u32 s61, s61, 0x6000
    v_mfma_f32_16x16x32_bf16 v[236:239], a[56:59], a[232:235], v[236:239]
    s_waitcnt lgkmcnt(5)
    v_cvt_pk_bf16_f32 v158, v232, v233
    v_cvt_pk_bf16_f32 v159, v234, v235
    v_mfma_f32_16x16x32_bf16 v[236:239], a[60:63], a[236:239], v[236:239]
    v_mfma_f32_16x16x32_bf16 v[236:239], a[64:67], a[240:243], v[236:239]
    s_waitcnt lgkmcnt(3)
    v_mfma_f32_16x16x32_bf16 v[236:239], a[68:71], a[244:247], v[236:239]
    s_waitcnt lgkmcnt(2)
    v_mfma_f32_16x16x32_bf16 v[228:231], a[224:227], a[72:75], 0
    s_waitcnt lgkmcnt(0)
    v_mfma_f32_16x16x32_bf16 v[228:231], a[228:231], a[76:79], v[228:231]
    v_mfma_f32_16x16x32_bf16 v[228:231], a[232:235], a[80:83], v[228:231]
    v_mfma_f32_16x16x32_bf16 v[228:231], a[236:239], a[84:87], v[228:231]
    v_mfma_f32_16x16x32_bf16 v[228:231], a[240:243], a[88:91], v[228:231]
    v_mfma_f32_16x16x32_bf16 v[228:231], a[244:247], a[92:95], v[228:231]
    v_cvt_pk_bf16_f32 v160, v236, v237
    v_cvt_pk_bf16_f32 v161, v238, v239
    v_mfma_f32_16x16x32_bf16 v[232:235], a[224:227], a[96:99], 0
    v_mfma_f32_16x16x32_bf16 v[232:235], a[228:231], a[100:103], v[232:235]
    v_mfma_f32_16x16x32_bf16 v[232:235], a[232:235], a[104:107], v[232:235]
    v_mfma_f32_16x16x32_bf16 v[232:235], a[236:239], a[108:111], v[232:235]
    v_mfma_f32_16x16x32_bf16 v[232:235], a[240:243], a[112:115], v[232:235]
    v_mfma_f32_16x16x32_bf16 v[232:235], a[244:247], a[116:119], v[232:235]
    v_cvt_pk_bf16_f32 v8, v228, v229
    v_cvt_pk_bf16_f32 v11, v230, v231
    v_mfma_f32_16x16x32_bf16 v[236:239], a[224:227], a[120:123], 0
    ds_read_b128 a[224:227], v240 offset:64640
    v_mfma_f32_16x16x32_bf16 v[236:239], a[228:231], a[124:127], v[236:239]
    ds_read_b128 a[228:231], v241 offset:64640
    v_mfma_f32_16x16x32_bf16 v[236:239], a[232:235], a[128:131], v[236:239]
    ds_read_b128 a[232:235], v240 offset:64768
    v_cvt_pk_bf16_f32 v38, v232, v233
    v_mfma_f32_16x16x32_bf16 v[236:239], a[236:239], a[132:135], v[236:239]
    ds_read_b128 a[236:239], v241 offset:64768
    v_cvt_pk_bf16_f32 v41, v234, v235
    v_mfma_f32_16x16x32_bf16 v[236:239], a[240:243], a[136:139], v[236:239]
    ds_read_b128 a[240:243], v242 offset:0
    v_add_u32 v240, 0xf000, v240
    v_mfma_f32_16x16x32_bf16 v[236:239], a[244:247], a[140:143], v[236:239]
    ds_read_b128 a[244:247], v243 offset:0
    v_add_u32 v241, 0xf000, v241
    v_mfma_f32_16x16x32_bf16 v[228:231], a[0:3], a[216:219], 0
    v_mfma_f32_16x16x32_bf16 v[228:231], a[4:7], a[220:223], v[228:231]
    v_mfma_f32_16x16x32_bf16 v[232:235], a[24:27], a[216:219], 0
    v_mfma_f32_16x16x32_bf16 v[232:235], a[28:31], a[220:223], v[232:235]
    s_waitcnt vmcnt(6) lgkmcnt(5)
    ds_read_b64_tr_b16 a[156:157], v249 offset:9216
    v_mfma_f32_16x16x32_bf16 v[228:231], a[8:11], a[224:227], v[228:231]
    s_waitcnt lgkmcnt(5)
    v_cvt_pk_bf16_f32 v68, v236, v237
    v_cvt_pk_bf16_f32 v71, v238, v239
    v_mfma_f32_16x16x32_bf16 v[228:231], a[12:15], a[228:231], v[228:231]
    s_waitcnt lgkmcnt(4)
    ds_read_b64_tr_b16 a[158:159], v250 offset:9216
    v_mfma_f32_16x16x32_bf16 v[228:231], a[16:19], a[232:235], v[228:231]
    s_waitcnt lgkmcnt(4)
    ds_read_b64_tr_b16 a[180:181], v249 offset:9248
    v_mfma_f32_16x16x32_bf16 v[228:231], a[20:23], a[236:239], v[228:231]
    ds_read_b64_tr_b16 a[182:183], v250 offset:9248
    ds_read_b64_tr_b16 a[204:205], v249 offset:9280
    v_mfma_f32_16x16x32_bf16 v[232:235], a[32:35], a[224:227], v[232:235]
    ds_read_b64_tr_b16 a[206:207], v250 offset:9280
    v_mfma_f32_16x16x32_bf16 v[232:235], a[36:39], a[228:231], v[232:235]
    s_waitcnt lgkmcnt(6)
    v_mfma_f32_16x16x32_bf16 v[232:235], a[40:43], a[232:235], v[232:235]
    v_mfma_f32_16x16x32_bf16 v[232:235], a[44:47], a[236:239], v[232:235]
    v_cvt_pk_bf16_f32 v162, v228, v229
    v_cvt_pk_bf16_f32 v163, v230, v231
    v_mfma_f32_16x16x32_bf16 v[236:239], a[48:51], a[216:219], 0
    v_mfma_f32_16x16x32_bf16 v[236:239], a[52:55], a[220:223], v[236:239]
    s_waitcnt lgkmcnt(5)
    v_mfma_f32_16x16x32_bf16 v[236:239], a[56:59], a[224:227], v[236:239]
    v_mfma_f32_16x16x32_bf16 v[236:239], a[60:63], a[228:231], v[236:239]
    s_waitcnt lgkmcnt(4)
    v_cvt_pk_bf16_f32 v164, v232, v233
    v_cvt_pk_bf16_f32 v165, v234, v235
    v_mfma_f32_16x16x32_bf16 v[236:239], a[64:67], a[232:235], v[236:239]
    s_waitcnt lgkmcnt(3)
    v_mfma_f32_16x16x32_bf16 v[236:239], a[68:71], a[236:239], v[236:239]
    s_waitcnt lgkmcnt(1)
    v_mfma_f32_16x16x32_bf16 v[228:231], a[216:219], a[72:75], 0
    s_waitcnt lgkmcnt(0)
    v_mfma_f32_16x16x32_bf16 v[228:231], a[220:223], a[76:79], v[228:231]
    v_mfma_f32_16x16x32_bf16 v[228:231], a[224:227], a[80:83], v[228:231]
    v_mfma_f32_16x16x32_bf16 v[228:231], a[228:231], a[84:87], v[228:231]
    v_mfma_f32_16x16x32_bf16 v[228:231], a[232:235], a[88:91], v[228:231]
    v_mfma_f32_16x16x32_bf16 v[228:231], a[236:239], a[92:95], v[228:231]
    v_cvt_pk_bf16_f32 v166, v236, v237
    v_cvt_pk_bf16_f32 v167, v238, v239
    v_mfma_f32_16x16x32_bf16 v[232:235], a[216:219], a[96:99], 0
    v_mfma_f32_16x16x32_bf16 v[232:235], a[220:223], a[100:103], v[232:235]
    v_mfma_f32_16x16x32_bf16 v[232:235], a[224:227], a[104:107], v[232:235]
    v_mfma_f32_16x16x32_bf16 v[232:235], a[228:231], a[108:111], v[232:235]
    v_mfma_f32_16x16x32_bf16 v[232:235], a[232:235], a[112:115], v[232:235]
    s_waitcnt vmcnt(3)
    ds_read_b64_tr_b16 a[160:161], v249 offset:0
    v_mfma_f32_16x16x32_bf16 v[232:235], a[236:239], a[116:119], v[232:235]
    ds_read_b64_tr_b16 a[162:163], v250 offset:0
    s_waitcnt vmcnt(0)
    v_mfma_f32_16x16x32_bf16 v[236:239], a[216:219], a[120:123], 0
    ds_read_b128 a[216:219], v242 offset:128
    ds_read_b64_tr_b16 a[164:165], v249 offset:3072
    v_mfma_f32_16x16x32_bf16 v[236:239], a[220:223], a[124:127], v[236:239]
    ds_read_b128 a[220:223], v243 offset:128
    ds_read_b64_tr_b16 a[166:167], v250 offset:3072
    v_mfma_f32_16x16x32_bf16 v[236:239], a[224:227], a[128:131], v[236:239]
    ds_read_b128 a[224:227], v242 offset:256
    v_cvt_pk_bf16_f32 v14, v228, v229
    v_mfma_f32_16x16x32_bf16 v[236:239], a[228:231], a[132:135], v[236:239]
    ds_read_b128 a[228:231], v243 offset:256
    v_cvt_pk_bf16_f32 v17, v230, v231
    v_mfma_f32_16x16x32_bf16 v[236:239], a[232:235], a[136:139], v[236:239]
    ds_read_b64_tr_b16 a[184:185], v249 offset:32
    ds_read_b64_tr_b16 a[186:187], v250 offset:32
    v_mfma_f32_16x16x32_bf16 v[236:239], a[236:239], a[140:143], v[236:239]
    ds_read_b64_tr_b16 a[188:189], v249 offset:3104
    ds_read_b64_tr_b16 a[190:191], v250 offset:3104
    v_mfma_f32_16x16x32_bf16 v[228:231], a[144:147], a[240:243], 0
    v_cvt_pk_bf16_f32 v44, v232, v233
    v_cvt_pk_bf16_f32 v47, v234, v235
    v_mfma_f32_16x16x32_bf16 v[228:231], a[148:151], a[244:247], v[228:231]
    ds_read_b64_tr_b16 a[208:209], v249 offset:64
    s_waitcnt lgkmcnt(10)
    v_mfma_f32_16x16x32_bf16 v[228:231], a[152:155], a[216:219], v[228:231]
    ds_read_b64_tr_b16 a[210:211], v250 offset:64
    v_cvt_pk_bf16_f32 v74, v236, v237
    v_mfma_f32_16x16x32_bf16 v[232:235], a[168:171], a[240:243], 0
    s_waitcnt lgkmcnt(9)
    ds_read_b64_tr_b16 a[212:213], v249 offset:3136
    v_mfma_f32_16x16x32_bf16 v[228:231], a[156:159], a[220:223], v[228:231]
    ds_read_b64_tr_b16 a[214:215], v250 offset:3136
    s_waitcnt lgkmcnt(9)
    v_mfma_f32_16x16x32_bf16 v[228:231], a[160:163], a[224:227], v[228:231]
    ds_read_b128 a[232:235], v242 offset:1536
    s_waitcnt lgkmcnt(9)
    v_mfma_f32_16x16x32_bf16 v[228:231], a[164:167], a[228:231], v[228:231]
    ds_read_b128 a[236:239], v243 offset:1536
    v_cvt_pk_bf16_f32 v77, v238, v239
    v_mfma_f32_16x16x32_bf16 v[232:235], a[172:175], a[244:247], v[232:235]
    s_waitcnt lgkmcnt(9)
    v_add_u32 v249, s66, v249
    v_add_u32 v250, s66, v250
    v_mfma_f32_16x16x32_bf16 v[232:235], a[176:179], a[216:219], v[232:235]
    s_lshl_b32 s66, s28, 1
    v_mul_f32 v228, s38, v228
    v_mul_f32 v229, s38, v229
    v_mfma_f32_16x16x32_bf16 v[232:235], a[180:183], a[220:223], v[232:235]
    s_waitcnt lgkmcnt(8)
    v_mul_f32 v230, s38, v230
    v_mul_f32 v231, s38, v231
    v_mfma_f32_16x16x32_bf16 v[232:235], a[184:187], a[224:227], v[232:235]
    s_waitcnt lgkmcnt(6)
    v_cvt_pk_bf16_f32 v168, v228, v229
    v_cvt_pk_bf16_f32 v169, v230, v231
    v_mfma_f32_16x16x32_bf16 v[232:235], a[188:191], a[228:231], v[232:235]
    s_waitcnt lgkmcnt(5)
    v_mfma_f32_16x16x32_bf16 v[236:239], a[192:195], a[240:243], 0
    ds_read_b128 a[240:243], v242 offset:1664
    v_mfma_f32_16x16x32_bf16 v[236:239], a[196:199], a[244:247], v[236:239]
    ds_read_b128 a[244:247], v243 offset:1664
L_h3:
    s_cbranch_execz L_h7
    v_mfma_f32_16x16x32_bf16 v[236:239], a[200:203], a[216:219], v[236:239]
    s_waitcnt lgkmcnt(3)
    ds_read_b128 a[216:219], v242 offset:1792
    v_mfma_f32_16x16x32_bf16 v[236:239], a[204:207], a[220:223], v[236:239]
    s_barrier
    v_mfma_f32_16x16x32_bf16 v[236:239], a[208:211], a[224:227], v[236:239]
    s_barrier
    v_mfma_f32_16x16x32_bf16 v[236:239], a[212:215], a[228:231], v[236:239]
    s_waitcnt lgkmcnt(3)
    v_mul_f32 v232, s3, v232
    v_mul_f32 v233, s3, v233
    v_mfma_f32_16x16x32_bf16 v[228:231], a[144:147], a[232:235], 0
    v_mul_f32 v234, s3, v234
    v_mul_f32 v235, s3, v235
    v_mfma_f32_16x16x32_bf16 v[228:231], a[148:151], a[236:239], v[228:231]
    s_waitcnt lgkmcnt(2)
    v_cvt_pk_bf16_f32 v170, v232, v233
    v_cvt_pk_bf16_f32 v171, v234, v235
    v_mfma_f32_16x16x32_bf16 v[228:231], a[152:155], a[240:243], v[228:231]
    ds_read_b128 a[220:223], v243 offset:1792
    v_mul_f32 v236, s38, v236
    v_mfma_f32_16x16x32_bf16 v[196:199], v[102:105], v[168:171], v[196:199]
    s_waitcnt lgkmcnt(1)
    v_mul_f32 v237, s38, v237
    v_mul_f32 v238, s38, v238
    v_mfma_f32_16x16x32_bf16 v[200:203], v[114:117], v[168:171], v[200:203]
    v_mul_f32 v239, s38, v239
    v_cvt_pk_bf16_f32 v172, v236, v237
    v_mfma_f32_16x16x32_bf16 v[204:207], v[150:153], v[168:171], v[204:207]
    ds_read_b128 a[224:227], v240 offset:4608
    v_cvt_pk_bf16_f32 v173, v238, v239
    v_mfma_f32_16x16x32_bf16 v[208:211], v[108:111], v[168:171], v[208:211]
    ds_read_b128 a[228:231], v241 offset:4608
    buffer_load_dwordx4 v254, s[4:7], s43 offen lds
    v_mfma_f32_16x16x32_bf16 v[196:199], v[104:107], v[170:173], v[196:199]
    v_accvgpr_read_b32 v254, a254
    v_mfma_f32_16x16x32_bf16 v[200:203], v[116:119], v[170:173], v[200:203]
    v_mfma_f32_16x16x32_bf16 v[204:207], v[152:155], v[170:173], v[204:207]
    v_mfma_f32_16x16x32_bf16 v[208:211], v[110:113], v[170:173], v[208:211]
    buffer_load_dwordx4 v255, s[4:7], s43 offen offset:1024 lds
    v_accvgpr_read_b32 v255, a252
    v_mfma_f32_16x16x32_bf16 v[228:231], a[156:159], a[244:247], v[228:231]
    v_mfma_f32_16x16x32_bf16 v[228:231], a[160:163], a[216:219], v[228:231]
    s_waitcnt lgkmcnt(2)
    v_exp_f32 v196, v196
    v_mfma_f32_16x16x32_bf16 v[228:231], a[164:167], a[220:223], v[228:231]
    v_exp_f32 v197, v197
    v_mfma_f32_16x16x32_bf16 v[232:235], a[168:171], a[232:235], 0
    v_exp_f32 v198, v198
    v_mfma_f32_16x16x32_bf16 v[232:235], a[172:175], a[236:239], v[232:235]
    s_waitcnt lgkmcnt(1)
    v_exp_f32 v199, v199
    v_mfma_f32_16x16x32_bf16 v[232:235], a[176:179], a[240:243], v[232:235]
    s_waitcnt lgkmcnt(0)
    v_cvt_pk_bf16_f32 v180, v196, v197
    v_cvt_pk_bf16_f32 v183, v198, v199
    v_mfma_f32_16x16x32_bf16 v[232:235], a[180:183], a[244:247], v[232:235]
    ds_read_b128 v[196:199], v245 offset:256
    v_mul_f32 v228, s38, v228
    v_mfma_f32_16x16x32_bf16 v[232:235], a[184:187], a[216:219], v[232:235]
    v_mul_f32 v229, s38, v229
    v_mul_f32 v230, s38, v230
    v_mfma_f32_16x16x32_bf16 v[232:235], a[188:191], a[220:223], v[232:235]
    v_mul_f32 v231, s38, v231
    v_cvt_pk_bf16_f32 v174, v228, v229
    v_mfma_f32_16x16x32_bf16 v[236:239], a[192:195], a[232:235], 0
    ds_read_b128 a[232:235], v240 offset:4736
    v_cvt_pk_bf16_f32 v175, v230, v231
    v_mfma_f32_16x16x32_bf16 v[236:239], a[196:199], a[236:239], v[236:239]
    ds_read_b128 a[236:239], v241 offset:4736
    buffer_load_dwordx4 v254, s[4:7], s43 offen offset:2048 lds
    v_mfma_f32_16x16x32_bf16 v[236:239], a[200:203], a[240:243], v[236:239]
    ds_read_b128 a[240:243], v240 offset:4864
    v_mul_f32 v232, s3, v232
    v_mfma_f32_16x16x32_bf16 v[236:239], a[204:207], a[244:247], v[236:239]
    ds_read_b128 a[244:247], v241 offset:4864
    v_mul_f32 v233, s3, v233
    v_mfma_f32_16x16x32_bf16 v[236:239], a[208:211], a[216:219], v[236:239]
    s_add_u32 m0, s46, 0x17400
    v_mul_f32 v234, s3, v234
    v_mul_f32 v235, s3, v235
    v_mfma_f32_16x16x32_bf16 v[236:239], a[212:215], a[220:223], v[236:239]
    s_waitcnt lgkmcnt(4)
    v_cvt_pk_bf16_f32 v176, v232, v233
    v_cvt_pk_bf16_f32 v177, v234, v235
    v_mfma_f32_16x16x32_bf16 v[196:199], v[120:123], v[168:171], v[196:199]
    v_exp_f32 v200, v200
    v_mfma_f32_16x16x32_bf16 v[196:199], v[122:125], v[170:173], v[196:199]
    v_exp_f32 v201, v201
    v_mfma_f32_16x16x32_bf16 v[228:231], a[0:3], a[224:227], 0
    v_exp_f32 v202, v202
    v_mfma_f32_16x16x32_bf16 v[228:231], a[4:7], a[228:231], v[228:231]
    s_waitcnt lgkmcnt(3)
    v_exp_f32 v203, v203
    v_mfma_f32_16x16x32_bf16 v[228:231], a[8:11], a[232:235], v[228:231]
    s_waitcnt lgkmcnt(2)
    v_cvt_pk_bf16_f32 v181, v200, v201
    v_cvt_pk_bf16_f32 v184, v202, v203
    v_mfma_f32_16x16x32_bf16 v[228:231], a[12:15], a[236:239], v[228:231]
    s_waitcnt lgkmcnt(1)
    v_mul_f32 v236, s38, v236
    v_mul_f32 v237, s38, v237
    v_mfma_f32_16x16x32_bf16 v[228:231], a[16:19], a[240:243], v[228:231]
    s_waitcnt lgkmcnt(0)
    v_mul_f32 v238, s38, v238
    v_mul_f32 v239, s38, v239
    v_mfma_f32_16x16x32_bf16 v[228:231], a[20:23], a[244:247], v[228:231]
    ds_read_b128 v[200:203], v246 offset:256
    v_cvt_pk_bf16_f32 v178, v236, v237
    v_mfma_f32_16x16x32_bf16 v[232:235], a[24:27], a[224:227], 0
    ds_read_b128 a[216:219], v242 offset:3072
    v_cvt_pk_bf16_f32 v179, v238, v239
    v_mfma_f32_16x16x32_bf16 v[232:235], a[28:31], a[228:231], v[232:235]
    v_exp_f32 v204, v204
    v_mfma_f32_16x16x32_bf16 v[232:235], a[32:35], a[232:235], v[232:235]
    v_exp_f32 v205, v205
    v_mfma_f32_16x16x32_bf16 v[232:235], a[36:39], a[236:239], v[232:235]
    v_cvt_pk_bf16_f32 v182, v204, v205
    v_cvt_pk_bf16_f32 v102, v228, v229
    v_mfma_f32_16x16x32_bf16 v[232:235], a[40:43], a[240:243], v[232:235]
    v_exp_f32 v206, v206
    v_mfma_f32_16x16x32_bf16 v[212:215], v[0:3], v[180:183], 0
    v_exp_f32 v207, v207
    v_mfma_f32_16x16x32_bf16 v[216:219], v[30:33], v[180:183], 0
    v_cvt_pk_bf16_f32 v185, v206, v207
    v_cvt_pk_bf16_f32 v103, v230, v231
    v_mfma_f32_16x16x32_bf16 v[220:223], v[60:63], v[180:183], 0
    ds_read_b128 v[204:207], v244 offset:320
    v_accvgpr_read_b32 v254, a253
    v_mfma_f32_16x16x32_bf16 v[224:227], a[248:251], v[180:183], 0
    v_exp_f32 v208, v208
    v_mfma_f32_16x16x32_bf16 v[232:235], a[44:47], a[244:247], v[232:235]
    s_waitcnt lgkmcnt(2)
    v_exp_f32 v209, v209
    v_mfma_f32_16x16x32_bf16 v[200:203], v[156:159], v[168:171], v[200:203]
    s_waitcnt lgkmcnt(1)
    v_exp_f32 v210, v210
    v_mfma_f32_16x16x32_bf16 v[200:203], v[158:161], v[170:173], v[200:203]
    v_exp_f32 v211, v211
    v_mfma_f32_16x16x32_bf16 v[236:239], a[48:51], a[224:227], 0
    v_cvt_pk_bf16_f32 v186, v208, v209
    v_cvt_pk_bf16_f32 v189, v210, v211
    v_mfma_f32_16x16x32_bf16 v[236:239], a[52:55], a[228:231], v[236:239]
    ds_read_b128 v[208:211], v245 offset:320
    v_cvt_pk_bf16_f32 v104, v232, v233
    v_mfma_f32_16x16x32_bf16 v[236:239], a[56:59], a[232:235], v[236:239]
    v_exp_f32 v196, v196
    v_mfma_f32_16x16x32_bf16 v[236:239], a[60:63], a[236:239], v[236:239]
    v_exp_f32 v197, v197
    v_mfma_f32_16x16x32_bf16 v[236:239], a[64:67], a[240:243], v[236:239]
    s_waitcnt lgkmcnt(1)
    v_cvt_pk_bf16_f32 v187, v196, v197
    v_cvt_pk_bf16_f32 v105, v234, v235
    v_mfma_f32_16x16x32_bf16 v[204:207], v[90:93], v[168:171], v[204:207]
    v_exp_f32 v198, v198
    v_mfma_f32_16x16x32_bf16 v[212:215], v[4:7], v[184:187], v[212:215]
    v_exp_f32 v199, v199
    v_mfma_f32_16x16x32_bf16 v[216:219], v[34:37], v[184:187], v[216:219]
    ds_read_b128 a[220:223], v243 offset:3072
    v_cvt_pk_bf16_f32 v190, v198, v199
    v_mfma_f32_16x16x32_bf16 v[220:223], v[64:67], v[184:187], v[220:223]
    ds_read_b128 v[196:199], v246 offset:320
    buffer_load_dwordx4 v255, s[4:7], s59 offen lds
    v_mfma_f32_16x16x32_bf16 v[224:227], a[248:251], v[184:187], v[224:227]
    v_exp_f32 v200, v200
    v_mfma_f32_16x16x32_bf16 v[204:207], v[92:95], v[170:173], v[204:207]
    v_exp_f32 v201, v201
    v_mfma_f32_16x16x32_bf16 v[236:239], a[68:71], a[244:247], v[236:239]
    s_waitcnt lgkmcnt(2)
    v_exp_f32 v202, v202
    v_mfma_f32_16x16x32_bf16 v[208:211], v[126:129], v[168:171], v[208:211]
    v_exp_f32 v203, v203
    v_mfma_f32_16x16x32_bf16 v[208:211], v[128:131], v[170:173], v[208:211]
    v_cvt_pk_bf16_f32 v188, v200, v201
    v_cvt_pk_bf16_f32 v191, v202, v203
    v_mfma_f32_16x16x32_bf16 v[228:231], a[224:227], a[72:75], 0
    ds_read_b128 v[200:203], v244 offset:0
    v_cvt_pk_bf16_f32 v106, v236, v237
    v_mfma_f32_16x16x32_bf16 v[212:215], v[8:11], v[188:191], v[212:215]
    v_exp_f32 v204, v204
    v_mfma_f32_16x16x32_bf16 v[216:219], v[38:41], v[188:191], v[216:219]
    v_exp_f32 v205, v205
    v_mfma_f32_16x16x32_bf16 v[220:223], v[68:71], v[188:191], v[220:223]
    s_waitcnt lgkmcnt(2)
    v_cvt_pk_bf16_f32 v192, v204, v205
    v_cvt_pk_bf16_f32 v107, v238, v239
    v_mfma_f32_16x16x32_bf16 v[224:227], a[248:251], v[188:191], v[224:227]
    s_waitcnt lgkmcnt(1)
    ds_read_b128 v[204:207], v245 offset:0
    v_mfma_f32_16x16x32_bf16 v[196:199], v[162:165], v[168:171], v[196:199]
    v_exp_f32 v208, v208
    v_mfma_f32_16x16x32_bf16 v[196:199], v[164:167], v[170:173], v[196:199]
    v_exp_f32 v209, v209
    v_mfma_f32_16x16x32_bf16 v[228:231], a[228:231], a[76:79], v[228:231]
    buffer_load_dwordx4 v254, s[4:7], s59 offen offset:1024 lds
    v_cvt_pk_bf16_f32 v193, v208, v209
    v_mfma_f32_16x16x32_bf16 v[228:231], a[232:235], a[80:83], v[228:231]
    ds_read_b128 v[208:211], v246 offset:0
    s_waitcnt lgkmcnt(2)
    v_mfma_f32_16x16x32_bf16 v[200:203], v[108:111], v[174:177], v[200:203]
    v_exp_f32 v196, v196
    v_mfma_f32_16x16x32_bf16 v[200:203], v[110:113], v[176:179], v[200:203]
    v_exp_f32 v197, v197
    v_mfma_f32_16x16x32_bf16 v[228:231], a[236:239], a[84:87], v[228:231]
    v_cvt_pk_bf16_f32 v194, v196, v197
    v_accvgpr_read_b32 v255, a254
    v_mfma_f32_16x16x32_bf16 v[228:231], a[240:243], a[88:91], v[228:231]
    ds_read_b128 v[196:199], v244 offset:64
    v_accvgpr_read_b32 v254, a252
    v_mfma_f32_16x16x32_bf16 v[212:215], v[12:15], v[192:195], v[212:215]
    s_waitcnt lgkmcnt(2)
    v_exp_f32 v200, v200
    v_mfma_f32_16x16x32_bf16 v[216:219], v[42:45], v[192:195], v[216:219]
    v_exp_f32 v201, v201
    v_mfma_f32_16x16x32_bf16 v[220:223], v[72:75], v[192:195], v[220:223]
    v_exp_f32 v202, v202
    v_mfma_f32_16x16x32_bf16 v[224:227], a[248:251], v[192:195], v[224:227]
    v_exp_f32 v203, v203
    v_mfma_f32_16x16x32_bf16 v[204:207], v[120:123], v[174:177], v[204:207]
    v_cvt_pk_bf16_f32 v180, v200, v201
    v_cvt_pk_bf16_f32 v183, v202, v203
    v_mfma_f32_16x16x32_bf16 v[204:207], v[122:125], v[176:179], v[204:207]
    ds_read_b128 v[200:203], v245 offset:64
    buffer_load_dwordx4 v255, s[4:7], s59 offen offset:2048 lds
    v_mfma_f32_16x16x32_bf16 v[228:231], a[244:247], a[92:95], v[228:231]
    s_add_u32 m0, s46, 0x18000
    v_rcp_f32 v225, v224
    v_mfma_f32_16x16x32_bf16 v[232:235], a[224:227], a[96:99], 0
    s_waitcnt lgkmcnt(2)
    v_mul_f32 v212, v212, v225
    v_mul_f32 v213, v213, v225
    v_mfma_f32_16x16x32_bf16 v[208:211], v[156:159], v[174:177], v[208:211]
    s_add_u32 s59, s44, s45
    v_cvt_pk_bf16_f32 v20, v228, v229
    v_cvt_pk_bf16_f32 v23, v230, v231
    v_mfma_f32_16x16x32_bf16 v[208:211], v[158:161], v[176:179], v[208:211]
    s_waitcnt lgkmcnt(1)
    v_exp_f32 v204, v204
    v_mfma_f32_16x16x32_bf16 v[196:199], v[90:93], v[174:177], v[196:199]
    v_exp_f32 v205, v205
    v_mfma_f32_16x16x32_bf16 v[196:199], v[92:95], v[176:179], v[196:199]
    v_exp_f32 v206, v206
    v_mfma_f32_16x16x32_bf16 v[232:235], a[228:231], a[100:103], v[232:235]
    v_exp_f32 v207, v207
    v_mfma_f32_16x16x32_bf16 v[232:235], a[232:235], a[104:107], v[232:235]
    v_cvt_pk_bf16_f32 v181, v204, v205
    v_cvt_pk_bf16_f32 v184, v206, v207
    v_mfma_f32_16x16x32_bf16 v[232:235], a[236:239], a[108:111], v[232:235]
    ds_read_b128 v[204:207], v246 offset:64
    v_mul_f32 v214, v214, v225
    v_mfma_f32_16x16x32_bf16 v[232:235], a[240:243], a[112:115], v[232:235]
    s_waitcnt lgkmcnt(1)
    v_exp_f32 v208, v208
    v_mfma_f32_16x16x32_bf16 v[200:203], v[126:129], v[174:177], v[200:203]
    v_exp_f32 v209, v209
    v_mfma_f32_16x16x32_bf16 v[200:203], v[128:131], v[176:179], v[200:203]
    v_exp_f32 v210, v210
    v_mfma_f32_16x16x32_bf16 v[232:235], a[244:247], a[116:119], v[232:235]
    v_exp_f32 v211, v211
    v_mfma_f32_16x16x32_bf16 v[236:239], a[224:227], a[120:123], 0
    ds_read_b128 a[224:227], v242 offset:3200
    v_cvt_pk_bf16_f32 v182, v208, v209
    v_mfma_f32_16x16x32_bf16 v[236:239], a[228:231], a[124:127], v[236:239]
    ds_read_b128 a[228:231], v243 offset:3200
    v_mul_f32 v215, v215, v225
    v_mfma_f32_16x16x32_bf16 v[236:239], a[232:235], a[128:131], v[236:239]
    ds_read_b128 a[232:235], v242 offset:3328
    v_cvt_pk_bf16_f32 v50, v232, v233
    v_mfma_f32_16x16x32_bf16 v[236:239], a[236:239], a[132:135], v[236:239]
    ds_read_b128 a[236:239], v243 offset:3328
    v_cvt_pk_bf16_f32 v53, v234, v235
    v_mfma_f32_16x16x32_bf16 v[236:239], a[240:243], a[136:139], v[236:239]
    ds_read_b128 a[240:243], v240 offset:6144
    v_cvt_pk_bf16_f32 v212, v212, v213
    v_mfma_f32_16x16x32_bf16 v[236:239], a[244:247], a[140:143], v[236:239]
    ds_read_b128 a[244:247], v241 offset:6144
    v_cvt_pk_bf16_f32 v185, v210, v211
    v_mfma_f32_16x16x32_bf16 v[228:231], a[144:147], a[216:219], 0
    ds_read_b128 v[208:211], v244 offset:128
    v_cvt_pk_bf16_f32 v213, v214, v215
    v_mfma_f32_16x16x32_bf16 v[228:231], a[148:151], a[220:223], v[228:231]
    ds_write_b64 v251, v[212:213] offset:0
    v_mfma_f32_16x16x32_bf16 v[212:215], v[6:9], v[180:183], 0
    s_waitcnt lgkmcnt(7)
    v_cvt_pk_bf16_f32 v80, v236, v237
    v_cvt_pk_bf16_f32 v83, v238, v239
    v_mfma_f32_16x16x32_bf16 v[204:207], v[162:165], v[174:177], v[204:207]
    v_mul_f32 v216, v216, v225
    v_mul_f32 v217, v217, v225
    v_mfma_f32_16x16x32_bf16 v[204:207], v[164:167], v[176:179], v[204:207]
    v_mul_f32 v218, v218, v225
    v_mul_f32 v219, v219, v225
    v_mfma_f32_16x16x32_bf16 v[228:231], a[152:155], a[224:227], v[228:231]
    s_waitcnt lgkmcnt(6)
    v_cvt_pk_bf16_f32 v216, v216, v217
    v_cvt_pk_bf16_f32 v217, v218, v219
    v_mfma_f32_16x16x32_bf16 v[228:231], a[156:159], a[228:231], v[228:231]
    s_waitcnt lgkmcnt(5)
    v_mul_f32 v220, v220, v225
    v_mul_f32 v221, v221, v225
    v_mfma_f32_16x16x32_bf16 v[228:231], a[160:163], a[232:235], v[228:231]
    s_waitcnt lgkmcnt(4)
    v_mul_f32 v222, v222, v225
    v_mul_f32 v223, v223, v225
    v_mfma_f32_16x16x32_bf16 v[228:231], a[164:167], a[236:239], v[228:231]
    ds_write_b64 v251, v[216:217] offset:128
    v_mfma_f32_16x16x32_bf16 v[216:219], v[36:39], v[180:183], 0
    s_waitcnt lgkmcnt(2)
    v_cvt_pk_bf16_f32 v220, v220, v221
    v_cvt_pk_bf16_f32 v221, v222, v223
    v_mfma_f32_16x16x32_bf16 v[208:211], v[96:99], v[174:177], v[208:211]
    ds_write_b64 v251, v[220:221] offset:256
    v_mfma_f32_16x16x32_bf16 v[220:223], v[66:69], v[180:183], 0
    v_mul_f32 v228, s38, v228
    v_mul_f32 v229, s38, v229
    v_mfma_f32_16x16x32_bf16 v[208:211], v[98:101], v[176:179], v[208:211]
    v_mul_f32 v230, s38, v230
    v_mul_f32 v231, s38, v231
    v_mfma_f32_16x16x32_bf16 v[232:235], a[168:171], a[216:219], 0
    v_cvt_pk_bf16_f32 v168, v228, v229
    v_cvt_pk_bf16_f32 v169, v230, v231
    v_mfma_f32_16x16x32_bf16 v[232:235], a[172:175], a[220:223], v[232:235]
    buffer_load_dwordx4 v254, s[4:7], s58 offen lds
    v_max3_f32 v248, v248, v224, v225
    v_mfma_f32_16x16x32_bf16 v[224:227], a[248:251], v[180:183], 0
    v_exp_f32 v196, v196
    v_mfma_f32_16x16x32_bf16 v[232:235], a[176:179], a[224:227], v[232:235]
    v_exp_f32 v197, v197
    v_mfma_f32_16x16x32_bf16 v[232:235], a[180:183], a[228:231], v[232:235]
    v_exp_f32 v198, v198
    v_mfma_f32_16x16x32_bf16 v[232:235], a[184:187], a[232:235], v[232:235]
    v_exp_f32 v199, v199
    v_mfma_f32_16x16x32_bf16 v[232:235], a[188:191], a[236:239], v[232:235]
    v_cvt_pk_bf16_f32 v186, v196, v197
    v_cvt_pk_bf16_f32 v189, v198, v199
    v_mfma_f32_16x16x32_bf16 v[236:239], a[192:195], a[216:219], 0
    ds_read_b128 a[216:219], v240 offset:6272
    v_xor_b32 v254, 16, v242
    v_mfma_f32_16x16x32_bf16 v[236:239], a[196:199], a[220:223], v[236:239]
    ds_read_b128 a[220:223], v241 offset:6272
    v_add_u32 v254, 0x7500, v254
    v_mfma_f32_16x16x32_bf16 v[236:239], a[200:203], a[224:227], v[236:239]
    ds_read_b128 a[224:227], v240 offset:6400
    v_mul_f32 v232, s3, v232
    v_mfma_f32_16x16x32_bf16 v[236:239], a[204:207], a[228:231], v[236:239]
    ds_read_b128 a[228:231], v241 offset:6400
    v_mul_f32 v233, s3, v233
    v_mfma_f32_16x16x32_bf16 v[236:239], a[208:211], a[232:235], v[236:239]
    v_mul_f32 v234, s3, v234
    v_mul_f32 v235, s3, v235
    v_mfma_f32_16x16x32_bf16 v[236:239], a[212:215], a[236:239], v[236:239]
    v_cvt_pk_bf16_f32 v170, v232, v233
    v_cvt_pk_bf16_f32 v171, v234, v235
    v_mfma_f32_16x16x32_bf16 v[228:231], a[0:3], a[240:243], 0
    ds_read_b128 v[196:199], v245 offset:128
    v_cndmask_b32 v254, v242, v254, vcc
    v_mfma_f32_16x16x32_bf16 v[228:231], a[4:7], a[244:247], v[228:231]
    s_mov_b32 vcc_lo, 0x33333333
    v_exp_f32 v200, v200
    v_mfma_f32_16x16x32_bf16 v[232:235], a[24:27], a[240:243], 0
    s_mov_b32 vcc_hi, 0x33333333
    s_waitcnt lgkmcnt(4)
    v_mul_f32 v236, s38, v236
    v_mfma_f32_16x16x32_bf16 v[228:231], a[8:11], a[216:219], v[228:231]
    v_mul_f32 v237, s38, v237
    s_waitcnt lgkmcnt(3)
    v_mfma_f32_16x16x32_bf16 v[228:231], a[12:15], a[220:223], v[228:231]
    v_mul_f32 v238, s38, v238
    s_waitcnt lgkmcnt(2)
    v_mfma_f32_16x16x32_bf16 v[228:231], a[16:19], a[224:227], v[228:231]
    v_mul_f32 v239, s38, v239
    s_waitcnt lgkmcnt(1)
    v_mfma_f32_16x16x32_bf16 v[228:231], a[20:23], a[228:231], v[228:231]
    v_cvt_pk_bf16_f32 v172, v236, v237
    v_cvt_pk_bf16_f32 v173, v238, v239
    v_mfma_f32_16x16x32_bf16 v[232:235], a[28:31], a[244:247], v[232:235]
    v_exp_f32 v201, v201
    v_mfma_f32_16x16x32_bf16 v[232:235], a[32:35], a[216:219], v[232:235]
    ds_read_b128 a[232:235], v254 offset:4608
    v_cvt_pk_bf16_f32 v187, v200, v201
    v_mfma_f32_16x16x32_bf16 v[232:235], a[36:39], a[220:223], v[232:235]
    v_exp_f32 v202, v202
    v_mfma_f32_16x16x32_bf16 v[212:215], v[10:13], v[184:187], v[212:215]
    s_waitcnt lgkmcnt(1)
    v_exp_f32 v203, v203
    v_mfma_f32_16x16x32_bf16 v[216:219], v[40:43], v[184:187], v[216:219]
    v_cvt_pk_bf16_f32 v190, v202, v203
    v_cvt_pk_bf16_f32 v108, v228, v229
    v_mfma_f32_16x16x32_bf16 v[220:223], v[70:73], v[184:187], v[220:223]
    ds_read_b128 v[200:203], v246 offset:128
    v_cvt_pk_bf16_f32 v109, v230, v231
    v_mfma_f32_16x16x32_bf16 v[224:227], a[248:251], v[184:187], v[224:227]
    v_exp_f32 v204, v204
    v_mfma_f32_16x16x32_bf16 v[196:199], v[132:135], v[174:177], v[196:199]
    v_exp_f32 v205, v205
    v_mfma_f32_16x16x32_bf16 v[196:199], v[134:137], v[176:179], v[196:199]
    v_exp_f32 v206, v206
    v_mfma_f32_16x16x32_bf16 v[232:235], a[40:43], a[224:227], v[232:235]
    v_exp_f32 v207, v207
    v_mfma_f32_16x16x32_bf16 v[232:235], a[44:47], a[228:231], v[232:235]
    v_cvt_pk_bf16_f32 v188, v204, v205
    v_cvt_pk_bf16_f32 v191, v206, v207
    v_mfma_f32_16x16x32_bf16 v[236:239], a[48:51], a[240:243], 0
    ds_read_b128 v[204:207], v244 offset:0
    v_accvgpr_read_b32 v255, a255
    v_mfma_f32_16x16x32_bf16 v[212:215], v[14:17], v[188:191], v[212:215]
    s_waitcnt lgkmcnt(2)
    v_exp_f32 v208, v208
    v_mfma_f32_16x16x32_bf16 v[216:219], v[44:47], v[188:191], v[216:219]
    v_exp_f32 v209, v209
    v_mfma_f32_16x16x32_bf16 v[220:223], v[74:77], v[188:191], v[220:223]
    v_cvt_pk_bf16_f32 v192, v208, v209
    v_cvt_pk_bf16_f32 v110, v232, v233
    v_mfma_f32_16x16x32_bf16 v[224:227], a[248:251], v[188:191], v[224:227]
    ds_read_b128 v[208:211], v245 offset:0
    v_cvt_pk_bf16_f32 v111, v234, v235
    v_mfma_f32_16x16x32_bf16 v[236:239], a[52:55], a[244:247], v[236:239]
    s_waitcnt lgkmcnt(2)
    v_exp_f32 v196, v196
    v_mfma_f32_16x16x32_bf16 v[200:203], v[102:105], v[174:177], v[200:203]
    v_exp_f32 v197, v197
    v_mfma_f32_16x16x32_bf16 v[200:203], v[104:107], v[176:179], v[200:203]
    buffer_load_dwordx4 v255, s[4:7], s58 offen offset:512 lds
    v_cvt_pk_bf16_f32 v193, v196, v197
    v_mfma_f32_16x16x32_bf16 v[236:239], a[56:59], a[216:219], v[236:239]
    ds_read_b128 v[196:199], v246 offset:0
    v_xor_b32 v255, 64, v254
    v_mfma_f32_16x16x32_bf16 v[236:239], a[60:63], a[220:223], v[236:239]
    s_waitcnt lgkmcnt(2)
    ds_read_b128 a[236:239], v255 offset:4608
    v_mfma_f32_16x16x32_bf16 v[204:207], v[90:93], v[168:171], v[204:207]
    s_add_u32 m0, s46, 0
    v_exp_f32 v200, v200
    v_mfma_f32_16x16x32_bf16 v[204:207], v[92:95], v[170:173], v[204:207]
    s_lshl1_add_u32 s58, s45, s44
    v_exp_f32 v201, v201
    v_mfma_f32_16x16x32_bf16 v[236:239], a[64:67], a[224:227], v[236:239]
    v_cvt_pk_bf16_f32 v194, v200, v201
    v_mfma_f32_16x16x32_bf16 v[236:239], a[68:71], a[228:231], v[236:239]
    ds_read_b128 v[200:203], v244 offset:64
    v_mfma_f32_16x16x32_bf16 v[212:215], v[18:21], v[192:195], v[212:215]
    s_waitcnt lgkmcnt(3)
    v_exp_f32 v204, v204
    v_mfma_f32_16x16x32_bf16 v[216:219], v[48:51], v[192:195], v[216:219]
    v_exp_f32 v205, v205
    v_mfma_f32_16x16x32_bf16 v[220:223], v[78:81], v[192:195], v[220:223]
    v_exp_f32 v206, v206
    v_mfma_f32_16x16x32_bf16 v[224:227], a[248:251], v[192:195], v[224:227]
    v_exp_f32 v207, v207
    v_mfma_f32_16x16x32_bf16 v[208:211], v[126:129], v[168:171], v[208:211]
    s_waitcnt lgkmcnt(2)
    v_cvt_pk_bf16_f32 v180, v204, v205
    v_cvt_pk_bf16_f32 v183, v206, v207
    v_mfma_f32_16x16x32_bf16 v[208:211], v[128:131], v[170:173], v[208:211]
    ds_read_b128 v[204:207], v245 offset:64
    v_cvt_pk_bf16_f32 v112, v236, v237
    v_mfma_f32_16x16x32_bf16 v[196:199], v[162:165], v[168:171], v[196:199]
    s_waitcnt lgkmcnt(2)
    v_rcp_f32 v225, v224
    v_mfma_f32_16x16x32_bf16 v[196:199], v[164:167], v[170:173], v[196:199]
    v_cvt_pk_bf16_f32 v113, v238, v239
    v_mul_f32 v212, v212, v225
    v_mfma_f32_16x16x32_bf16 v[228:231], a[240:243], a[72:75], 0
    v_exp_f32 v208, v208
    v_mfma_f32_16x16x32_bf16 v[228:231], a[244:247], a[76:79], v[228:231]
    s_waitcnt lgkmcnt(1)
    v_exp_f32 v209, v209
    v_mfma_f32_16x16x32_bf16 v[200:203], v[96:99], v[168:171], v[200:203]
    v_exp_f32 v210, v210
    v_mfma_f32_16x16x32_bf16 v[200:203], v[98:101], v[170:173], v[200:203]
    v_exp_f32 v211, v211
    v_mfma_f32_16x16x32_bf16 v[228:231], a[216:219], a[80:83], v[228:231]
    v_cvt_pk_bf16_f32 v181, v208, v209
    v_cvt_pk_bf16_f32 v184, v210, v211
    v_mfma_f32_16x16x32_bf16 v[228:231], a[220:223], a[84:87], v[228:231]
    ds_read_b128 v[208:211], v246 offset:64
    v_mul_f32 v213, v213, v225
    v_mfma_f32_16x16x32_bf16 v[228:231], a[224:227], a[88:91], v[228:231]
    v_exp_f32 v196, v196
    v_mfma_f32_16x16x32_bf16 v[228:231], a[228:231], a[92:95], v[228:231]
    s_waitcnt lgkmcnt(1)
    v_exp_f32 v197, v197
    v_mfma_f32_16x16x32_bf16 v[204:207], v[132:135], v[168:171], v[204:207]
    v_cvt_pk_bf16_f32 v182, v196, v197
    v_mul_f32 v214, v214, v225
    v_mfma_f32_16x16x32_bf16 v[204:207], v[134:137], v[170:173], v[204:207]
    v_mul_f32 v215, v215, v225
    v_cvt_pk_bf16_f32 v212, v212, v213
    v_mfma_f32_16x16x32_bf16 v[232:235], a[240:243], a[96:99], 0
    v_cvt_pk_bf16_f32 v26, v228, v229
    v_cvt_pk_bf16_f32 v29, v230, v231
    v_mfma_f32_16x16x32_bf16 v[232:235], a[244:247], a[100:103], v[232:235]
    v_cvt_pk_bf16_f32 v213, v214, v215
    v_mul_f32 v216, v216, v225
    v_mfma_f32_16x16x32_bf16 v[232:235], a[216:219], a[104:107], v[232:235]
    ds_write_b64 v251, v[212:213] offset:6144
    v_mfma_f32_16x16x32_bf16 v[212:215], v[12:15], v[180:183], 0
    v_exp_f32 v198, v198
    v_mfma_f32_16x16x32_bf16 v[232:235], a[220:223], a[108:111], v[232:235]
    v_exp_f32 v199, v199
    v_mfma_f32_16x16x32_bf16 v[232:235], a[224:227], a[112:115], v[232:235]
    s_waitcnt lgkmcnt(1)
    v_mul_f32 v217, v217, v225
    v_mul_f32 v218, v218, v225
    v_mfma_f32_16x16x32_bf16 v[208:211], v[102:105], v[168:171], v[208:211]
    v_mul_f32 v219, v219, v225
    v_cvt_pk_bf16_f32 v216, v216, v217
    v_mfma_f32_16x16x32_bf16 v[208:211], v[104:107], v[170:173], v[208:211]
    v_cvt_pk_bf16_f32 v185, v198, v199
    v_cvt_pk_bf16_f32 v217, v218, v219
    v_mfma_f32_16x16x32_bf16 v[232:235], a[228:231], a[116:119], v[232:235]
    ds_read_b128 v[196:199], v244 offset:128
    v_mul_f32 v220, v220, v225
    v_mfma_f32_16x16x32_bf16 v[236:239], a[240:243], a[120:123], 0
    ds_read_b128 a[240:243], v254 offset:4736
    v_mul_f32 v221, v221, v225
    v_mfma_f32_16x16x32_bf16 v[236:239], a[244:247], a[124:127], v[236:239]
    ds_read_b128 a[244:247], v255 offset:4736
    v_mul_f32 v222, v222, v225
    v_mfma_f32_16x16x32_bf16 v[236:239], a[216:219], a[128:131], v[236:239]
    ds_read_b128 a[216:219], v254 offset:4864
    v_cvt_pk_bf16_f32 v56, v232, v233
    v_mfma_f32_16x16x32_bf16 v[236:239], a[220:223], a[132:135], v[236:239]
    ds_read_b128 a[220:223], v255 offset:4864
    v_cvt_pk_bf16_f32 v59, v234, v235
    v_mfma_f32_16x16x32_bf16 v[236:239], a[224:227], a[136:139], v[236:239]
    ds_read_b128 a[224:227], v242 offset:30720
    v_mul_f32 v223, v223, v225
    v_mfma_f32_16x16x32_bf16 v[236:239], a[228:231], a[140:143], v[236:239]
    ds_read_b128 a[228:231], v243 offset:30720
    v_cvt_pk_bf16_f32 v220, v220, v221
    v_mfma_f32_16x16x32_bf16 v[228:231], a[144:147], a[232:235], 0
    ds_write_b64 v251, v[216:217] offset:6272
    v_mfma_f32_16x16x32_bf16 v[216:219], v[42:45], v[180:183], 0
    v_cvt_pk_bf16_f32 v221, v222, v223
    v_max3_f32 v248, v248, v224, v225
    v_mfma_f32_16x16x32_bf16 v[224:227], a[248:251], v[180:183], 0
    v_cvt_pk_bf16_f32 v86, v236, v237
    v_cvt_pk_bf16_f32 v89, v238, v239
    v_mfma_f32_16x16x32_bf16 v[228:231], a[148:151], a[236:239], v[228:231]
    s_waitcnt lgkmcnt(6)
    v_exp_f32 v200, v200
    v_mfma_f32_16x16x32_bf16 v[196:199], v[138:141], v[168:171], v[196:199]
    ds_write_b64 v251, v[220:221] offset:6400
    v_mfma_f32_16x16x32_bf16 v[220:223], v[72:75], v[180:183], 0
    s_waitcnt lgkmcnt(5)
    v_exp_f32 v201, v201
    v_mfma_f32_16x16x32_bf16 v[196:199], v[140:143], v[170:173], v[196:199]
    s_waitcnt lgkmcnt(4)
    v_exp_f32 v202, v202
    v_mfma_f32_16x16x32_bf16 v[228:231], a[152:155], a[240:243], v[228:231]
    s_waitcnt vmcnt(5)
    v_exp_f32 v203, v203
    v_mfma_f32_16x16x32_bf16 v[228:231], a[156:159], a[244:247], v[228:231]
    s_barrier
    v_mfma_f32_16x16x32_bf16 v[228:231], a[160:163], a[216:219], v[228:231]
    s_waitcnt lgkmcnt(1)
    v_cvt_pk_bf16_f32 v186, v200, v201
    v_cvt_pk_bf16_f32 v189, v202, v203
    v_mfma_f32_16x16x32_bf16 v[228:231], a[164:167], a[220:223], v[228:231]
    ds_read_b128 v[200:203], v245 offset:128
    v_accvgpr_read_b32 v254, a252
    v_mfma_f32_16x16x32_bf16 v[232:235], a[168:171], a[232:235], 0
    v_exp_f32 v204, v204
    v_mfma_f32_16x16x32_bf16 v[232:235], a[172:175], a[236:239], v[232:235]
    v_exp_f32 v205, v205
    v_mfma_f32_16x16x32_bf16 v[232:235], a[176:179], a[240:243], v[232:235]
    v_exp_f32 v206, v206
    v_mfma_f32_16x16x32_bf16 v[232:235], a[180:183], a[244:247], v[232:235]
    v_mul_f32 v228, s38, v228
    v_mul_f32 v229, s38, v229
    v_mfma_f32_16x16x32_bf16 v[232:235], a[184:187], a[216:219], v[232:235]
    v_mul_f32 v230, s38, v230
    v_mul_f32 v231, s38, v231
    v_mfma_f32_16x16x32_bf16 v[232:235], a[188:191], a[220:223], v[232:235]
    v_cvt_pk_bf16_f32 v174, v228, v229
    v_cvt_pk_bf16_f32 v175, v230, v231
    v_mfma_f32_16x16x32_bf16 v[236:239], a[192:195], a[232:235], 0
    ds_read_b128 a[232:235], v242 offset:30848
    v_cvt_pk_bf16_f32 v187, v204, v205
    v_mfma_f32_16x16x32_bf16 v[236:239], a[196:199], a[236:239], v[236:239]
    ds_read_b128 a[236:239], v243 offset:30848
    v_accvgpr_read_b32 v255, a253
    v_mfma_f32_16x16x32_bf16 v[212:215], v[16:19], v[184:187], v[212:215]
    v_mul_f32 v232, s3, v232
    v_mul_f32 v233, s3, v233
    v_mfma_f32_16x16x32_bf16 v[216:219], v[46:49], v[184:187], v[216:219]
    s_waitcnt lgkmcnt(2)
    v_mul_f32 v234, s3, v234
    v_mul_f32 v235, s3, v235
    v_mfma_f32_16x16x32_bf16 v[220:223], v[76:79], v[184:187], v[220:223]
    v_cvt_pk_bf16_f32 v176, v232, v233
    v_cvt_pk_bf16_f32 v177, v234, v235
    v_mfma_f32_16x16x32_bf16 v[224:227], a[248:251], v[184:187], v[224:227]
    v_exp_f32 v207, v207
    v_mfma_f32_16x16x32_bf16 v[200:203], v[144:147], v[168:171], v[200:203]
    buffer_load_dwordx4 v254, s[4:7], s44 offen lds
    v_cvt_pk_bf16_f32 v190, v206, v207
    v_mfma_f32_16x16x32_bf16 v[200:203], v[146:149], v[170:173], v[200:203]
    ds_read_b128 v[204:207], v246 offset:128
    v_accvgpr_read_b32 v254, a254
    v_mfma_f32_16x16x32_bf16 v[236:239], a[200:203], a[240:243], v[236:239]
    ds_read_b128 a[240:243], v242 offset:30976
    v_mfma_f32_16x16x32_bf16 v[236:239], a[204:207], a[244:247], v[236:239]
    ds_read_b128 a[244:247], v243 offset:30976
    v_mfma_f32_16x16x32_bf16 v[236:239], a[208:211], a[216:219], v[236:239]
    ds_read_b128 a[216:219], v240 offset:32256
    buffer_load_dwordx4 v255, s[4:7], s44 offen offset:1024 lds
    v_mfma_f32_16x16x32_bf16 v[236:239], a[212:215], a[220:223], v[236:239]
    ds_read_b128 a[220:223], v241 offset:32256
    v_accvgpr_read_b32 v255, a252
    v_mfma_f32_16x16x32_bf16 v[228:231], a[144:147], a[224:227], 0
    s_waitcnt lgkmcnt(5)
    v_exp_f32 v208, v208
    v_mfma_f32_16x16x32_bf16 v[228:231], a[148:151], a[228:231], v[228:231]
L_h4:
    s_cbranch_execz L_h8
    v_exp_f32 v209, v209
    v_mfma_f32_16x16x32_bf16 v[228:231], a[152:155], a[232:235], v[228:231]
    v_mul_f32 v236, s38, v236
    v_mul_f32 v237, s38, v237
    v_mfma_f32_16x16x32_bf16 v[228:231], a[156:159], a[236:239], v[228:231]
    v_mul_f32 v238, s38, v238
    v_mul_f32 v239, s38, v239
    v_mfma_f32_16x16x32_bf16 v[232:235], a[168:171], a[224:227], 0
    s_waitcnt lgkmcnt(3)
    v_cvt_pk_bf16_f32 v178, v236, v237
    v_cvt_pk_bf16_f32 v179, v238, v239
    v_mfma_f32_16x16x32_bf16 v[204:207], v[108:111], v[168:171], v[204:207]
    v_exp_f32 v210, v210
    v_mfma_f32_16x16x32_bf16 v[204:207], v[110:113], v[170:173], v[204:207]
    v_exp_f32 v211, v211
    v_mfma_f32_16x16x32_bf16 v[228:231], a[160:163], a[240:243], v[228:231]
    s_waitcnt lgkmcnt(2)
    v_cvt_pk_bf16_f32 v188, v208, v209
    v_cvt_pk_bf16_f32 v191, v210, v211
    v_mfma_f32_16x16x32_bf16 v[228:231], a[164:167], a[244:247], v[228:231]
    ds_read_b128 v[208:211], v244 offset:0
    buffer_load_dwordx4 v254, s[4:7], s44 offen offset:2048 lds
    v_mfma_f32_16x16x32_bf16 v[212:215], v[20:23], v[188:191], v[212:215]
    s_add_u32 m0, s46, 0xc00
    v_exp_f32 v196, v196
    v_mfma_f32_16x16x32_bf16 v[216:219], v[50:53], v[188:191], v[216:219]
    s_waitcnt lgkmcnt(1)
    v_exp_f32 v197, v197
    v_mfma_f32_16x16x32_bf16 v[220:223], v[80:83], v[188:191], v[220:223]
    v_cvt_pk_bf16_f32 v192, v196, v197
    v_mul_f32 v228, s38, v228
    v_mfma_f32_16x16x32_bf16 v[224:227], a[248:251], v[188:191], v[224:227]
    ds_read_b128 v[196:199], v245 offset:0
    v_mul_f32 v229, s38, v229
    v_mfma_f32_16x16x32_bf16 v[232:235], a[172:175], a[228:231], v[232:235]
    v_mul_f32 v230, s38, v230
    v_mul_f32 v231, s38, v231
    v_mfma_f32_16x16x32_bf16 v[232:235], a[176:179], a[232:235], v[232:235]
    v_cvt_pk_bf16_f32 v168, v228, v229
    v_cvt_pk_bf16_f32 v169, v230, v231
    v_mfma_f32_16x16x32_bf16 v[232:235], a[180:183], a[236:239], v[232:235]
    v_exp_f32 v200, v200
    v_mfma_f32_16x16x32_bf16 v[232:235], a[184:187], a[240:243], v[232:235]
    v_exp_f32 v201, v201
    v_mfma_f32_16x16x32_bf16 v[232:235], a[188:191], a[244:247], v[232:235]
    buffer_load_dwordx4 v255, s[4:7], s59 offen lds
    v_cvt_pk_bf16_f32 v193, v200, v201
    v_mfma_f32_16x16x32_bf16 v[236:239], a[192:195], a[224:227], 0
    ds_read_b128 a[224:227], v240 offset:32384
    v_accvgpr_read_b32 v254, a253
    v_mfma_f32_16x16x32_bf16 v[236:239], a[196:199], a[228:231], v[236:239]
    ds_read_b128 a[228:231], v241 offset:32384
    v_accvgpr_read_b32 v255, a254
    v_mfma_f32_16x16x32_bf16 v[236:239], a[200:203], a[232:235], v[236:239]
    ds_read_b128 v[200:203], v246 offset:0
    v_mul_f32 v232, s3, v232
    v_mfma_f32_16x16x32_bf16 v[236:239], a[204:207], a[236:239], v[236:239]
    s_waitcnt lgkmcnt(4)
    v_exp_f32 v204, v204
    v_mfma_f32_16x16x32_bf16 v[208:211], v[96:99], v[174:177], v[208:211]
    ds_read_b128 a[232:235], v240 offset:32512
    v_mul_f32 v233, s3, v233
    v_mfma_f32_16x16x32_bf16 v[208:211], v[98:101], v[176:179], v[208:211]
    ds_read_b128 a[236:239], v241 offset:32512
    v_mul_f32 v234, s3, v234
    v_mfma_f32_16x16x32_bf16 v[236:239], a[208:211], a[240:243], v[236:239]
    s_waitcnt lgkmcnt(5)
    v_exp_f32 v205, v205
    v_mfma_f32_16x16x32_bf16 v[196:199], v[132:135], v[174:177], v[196:199]
    v_cvt_pk_bf16_f32 v194, v204, v205
    v_mul_f32 v235, s3, v235
    v_mfma_f32_16x16x32_bf16 v[196:199], v[134:137], v[176:179], v[196:199]
    ds_read_b128 v[204:207], v244 offset:64
    v_cvt_pk_bf16_f32 v170, v232, v233
    v_mfma_f32_16x16x32_bf16 v[212:215], v[24:27], v[192:195], v[212:215]
    v_exp_f32 v208, v208
    v_mfma_f32_16x16x32_bf16 v[216:219], v[54:57], v[192:195], v[216:219]
    s_waitcnt lgkmcnt(5)
    v_exp_f32 v209, v209
    v_mfma_f32_16x16x32_bf16 v[220:223], v[84:87], v[192:195], v[220:223]
    s_waitcnt lgkmcnt(4)
    v_exp_f32 v210, v210
    v_mfma_f32_16x16x32_bf16 v[224:227], a[248:251], v[192:195], v[224:227]
    s_waitcnt lgkmcnt(3)
    v_exp_f32 v211, v211
    v_mfma_f32_16x16x32_bf16 v[200:203], v[102:105], v[174:177], v[200:203]
    v_cvt_pk_bf16_f32 v180, v208, v209
    v_cvt_pk_bf16_f32 v183, v210, v211
    v_mfma_f32_16x16x32_bf16 v[200:203], v[104:107], v[176:179], v[200:203]
    ds_read_b128 v[208:211], v245 offset:64
    v_cvt_pk_bf16_f32 v171, v234, v235
    v_mfma_f32_16x16x32_bf16 v[236:239], a[212:215], a[244:247], v[236:239]
    s_waitcnt lgkmcnt(2)
    v_exp_f32 v196, v196
    v_mfma_f32_16x16x32_bf16 v[228:231], a[0:3], a[216:219], 0
    v_exp_f32 v197, v197
    v_mfma_f32_16x16x32_bf16 v[228:231], a[4:7], a[220:223], v[228:231]
    v_exp_f32 v198, v198
    v_mfma_f32_16x16x32_bf16 v[228:231], a[8:11], a[224:227], v[228:231]
    s_waitcnt lgkmcnt(1)
    v_mul_f32 v236, s38, v236
    v_mul_f32 v237, s38, v237
    v_mfma_f32_16x16x32_bf16 v[204:207], v[138:141], v[174:177], v[204:207]
    v_mul_f32 v238, s38, v238
    v_mul_f32 v239, s38, v239
    v_mfma_f32_16x16x32_bf16 v[204:207], v[140:143], v[176:179], v[204:207]
    v_cvt_pk_bf16_f32 v172, v236, v237
    v_cvt_pk_bf16_f32 v173, v238, v239
    v_mfma_f32_16x16x32_bf16 v[228:231], a[12:15], a[228:231], v[228:231]
    v_exp_f32 v199, v199
    v_mfma_f32_16x16x32_bf16 v[228:231], a[16:19], a[232:235], v[228:231]
    v_cvt_pk_bf16_f32 v181, v196, v197
    v_cvt_pk_bf16_f32 v184, v198, v199
    v_mfma_f32_16x16x32_bf16 v[228:231], a[20:23], a[236:239], v[228:231]
    ds_read_b128 v[196:199], v246 offset:64
    v_add_u32 v246, 0x700, v245
    v_mfma_f32_16x16x32_bf16 v[232:235], a[24:27], a[216:219], 0
    s_waitcnt lgkmcnt(1)
    v_rcp_f32 v225, v224
    v_mfma_f32_16x16x32_bf16 v[208:211], v[144:147], v[174:177], v[208:211]
    v_exp_f32 v200, v200
    v_mfma_f32_16x16x32_bf16 v[208:211], v[146:149], v[176:179], v[208:211]
    v_cvt_pk_bf16_f32 v90, v228, v229
    v_cvt_pk_bf16_f32 v91, v230, v231
    v_mfma_f32_16x16x32_bf16 v[232:235], a[28:31], a[220:223], v[232:235]
    v_exp_f32 v201, v201
    v_mfma_f32_16x16x32_bf16 v[232:235], a[32:35], a[224:227], v[232:235]
    v_mul_f32 v212, v212, v225
    v_mul_f32 v213, v213, v225
    v_mfma_f32_16x16x32_bf16 v[232:235], a[36:39], a[228:231], v[232:235]
    v_cvt_pk_bf16_f32 v182, v200, v201
    v_mul_f32 v214, v214, v225
    v_mfma_f32_16x16x32_bf16 v[232:235], a[40:43], a[232:235], v[232:235]
    v_mul_f32 v215, v215, v225
    v_cvt_pk_bf16_f32 v212, v212, v213
    v_mfma_f32_16x16x32_bf16 v[232:235], a[44:47], a[236:239], v[232:235]
    v_cvt_pk_bf16_f32 v213, v214, v215
    v_mul_f32 v216, v216, v225
    v_mfma_f32_16x16x32_bf16 v[236:239], a[48:51], a[216:219], 0
    ds_write_b64 v251, v[212:213] offset:12288
    v_mfma_f32_16x16x32_bf16 v[212:215], v[18:21], v[180:183], 0
    s_waitcnt lgkmcnt(1)
    v_mul_f32 v217, v217, v225
    v_mul_f32 v218, v218, v225
    v_mfma_f32_16x16x32_bf16 v[196:199], v[108:111], v[174:177], v[196:199]
    v_cvt_pk_bf16_f32 v92, v232, v233
    v_cvt_pk_bf16_f32 v93, v234, v235
    v_mfma_f32_16x16x32_bf16 v[196:199], v[110:113], v[176:179], v[196:199]
    v_mul_f32 v219, v219, v225
    v_cvt_pk_bf16_f32 v216, v216, v217
    v_mfma_f32_16x16x32_bf16 v[236:239], a[52:55], a[220:223], v[236:239]
    v_cvt_pk_bf16_f32 v217, v218, v219
    v_mul_f32 v220, v220, v225
    v_mfma_f32_16x16x32_bf16 v[236:239], a[56:59], a[224:227], v[236:239]
    ds_write_b64 v251, v[216:217] offset:12416
    v_mfma_f32_16x16x32_bf16 v[216:219], v[48:51], v[180:183], 0
    v_mul_f32 v221, v221, v225
    v_mul_f32 v222, v222, v225
    v_mfma_f32_16x16x32_bf16 v[236:239], a[60:63], a[228:231], v[236:239]
    v_mul_f32 v223, v223, v225
    v_cvt_pk_bf16_f32 v220, v220, v221
    v_mfma_f32_16x16x32_bf16 v[236:239], a[64:67], a[232:235], v[236:239]
    ds_read_b128 a[240:243], v240 offset:30720
    v_cvt_pk_bf16_f32 v221, v222, v223
    v_mfma_f32_16x16x32_bf16 v[236:239], a[68:71], a[236:239], v[236:239]
    ds_write_b64 v251, v[220:221] offset:12544
    v_mfma_f32_16x16x32_bf16 v[220:223], v[78:81], v[180:183], 0
    ds_read_b128 a[244:247], v241 offset:30720
    v_max3_f32 v248, v248, v224, v225
    v_mfma_f32_16x16x32_bf16 v[224:227], a[248:251], v[180:183], 0
    v_exp_f32 v202, v202
    v_mfma_f32_16x16x32_bf16 v[228:231], a[216:219], a[72:75], 0
    v_exp_f32 v203, v203
    v_mfma_f32_16x16x32_bf16 v[228:231], a[220:223], a[76:79], v[228:231]
    v_cvt_pk_bf16_f32 v94, v236, v237
    v_cvt_pk_bf16_f32 v95, v238, v239
    v_mfma_f32_16x16x32_bf16 v[228:231], a[224:227], a[80:83], v[228:231]
    v_exp_f32 v204, v204
    v_mfma_f32_16x16x32_bf16 v[228:231], a[228:231], a[84:87], v[228:231]
    v_exp_f32 v205, v205
    v_mfma_f32_16x16x32_bf16 v[228:231], a[232:235], a[88:91], v[228:231]
    v_exp_f32 v208, v208
    v_mfma_f32_16x16x32_bf16 v[228:231], a[236:239], a[92:95], v[228:231]
    v_exp_f32 v209, v209
    v_mfma_f32_16x16x32_bf16 v[232:235], a[216:219], a[96:99], 0
    s_waitcnt lgkmcnt(2)
    v_cvt_pk_bf16_f32 v185, v202, v203
    v_cvt_pk_bf16_f32 v186, v204, v205
    v_mfma_f32_16x16x32_bf16 v[232:235], a[220:223], a[100:103], v[232:235]
    v_cvt_pk_bf16_f32 v187, v208, v209
    v_mov_b32 v200, 0x237c0
    v_mfma_f32_16x16x32_bf16 v[232:235], a[224:227], a[104:107], v[232:235]
    s_waitcnt lgkmcnt(0)
    v_cvt_pk_bf16_f32 v6, v228, v229
    v_cvt_pk_bf16_f32 v9, v230, v231
    v_mfma_f32_16x16x32_bf16 v[212:215], v[22:25], v[184:187], v[212:215]
    v_exp_f32 v206, v206
    v_mfma_f32_16x16x32_bf16 v[216:219], v[52:55], v[184:187], v[216:219]
    v_exp_f32 v207, v207
    v_mfma_f32_16x16x32_bf16 v[220:223], v[82:85], v[184:187], v[220:223]
    v_exp_f32 v210, v210
    v_mfma_f32_16x16x32_bf16 v[224:227], a[248:251], v[184:187], v[224:227]
    v_exp_f32 v211, v211
    v_mfma_f32_16x16x32_bf16 v[232:235], a[228:231], a[108:111], v[232:235]
    v_exp_f32 v196, v196
    v_mfma_f32_16x16x32_bf16 v[232:235], a[232:235], a[112:115], v[232:235]
    v_exp_f32 v197, v197
    v_mfma_f32_16x16x32_bf16 v[232:235], a[236:239], a[116:119], v[232:235]
    v_exp_f32 v198, v198
    v_mfma_f32_16x16x32_bf16 v[236:239], a[216:219], a[120:123], 0
    ds_read_b128 a[216:219], v240 offset:30848
    v_cvt_pk_bf16_f32 v189, v206, v207
    v_mfma_f32_16x16x32_bf16 v[236:239], a[220:223], a[124:127], v[236:239]
    ds_read_b128 a[220:223], v241 offset:30848
    v_cvt_pk_bf16_f32 v190, v210, v211
    v_mfma_f32_16x16x32_bf16 v[236:239], a[224:227], a[128:131], v[236:239]
    ds_read_b128 a[224:227], v240 offset:30976
    v_cvt_pk_bf16_f32 v36, v232, v233
    v_mfma_f32_16x16x32_bf16 v[236:239], a[228:231], a[132:135], v[236:239]
    ds_read_b128 a[228:231], v241 offset:30976
    v_cvt_pk_bf16_f32 v39, v234, v235
    v_mfma_f32_16x16x32_bf16 v[236:239], a[232:235], a[136:139], v[236:239]
    v_exp_f32 v199, v199
    v_mfma_f32_16x16x32_bf16 v[236:239], a[236:239], a[140:143], v[236:239]
    v_cvt_pk_bf16_f32 v188, v196, v197
    v_cvt_pk_bf16_f32 v191, v198, v199
    v_mfma_f32_16x16x32_bf16 v[228:231], a[0:3], a[240:243], 0
    ds_read_b128 a[232:235], v242 offset:32256
    v_add_u32 v201, 0xfffff900, v245
    v_mfma_f32_16x16x32_bf16 v[212:215], v[26:29], v[188:191], v[212:215]
    ds_read_b128 a[236:239], v243 offset:32256
    buffer_load_dwordx4 v254, s[4:7], s59 offen offset:1024 lds
    v_mfma_f32_16x16x32_bf16 v[216:219], v[56:59], v[188:191], v[216:219]
    v_cvt_pk_bf16_f32 v66, v236, v237
    v_cvt_pk_bf16_f32 v69, v238, v239
    v_mfma_f32_16x16x32_bf16 v[220:223], v[86:89], v[188:191], v[220:223]
    ds_write_b64 v247, v[174:175] offset:0
    v_mfma_f32_16x16x32_bf16 v[224:227], a[248:251], v[188:191], v[224:227]
    ds_write_b64 v247, v[176:177] offset:128
    v_mfma_f32_16x16x32_bf16 v[228:231], a[4:7], a[244:247], v[228:231]
    s_waitcnt lgkmcnt(7)
    v_accvgpr_read_b32 v254, a252
    v_mov_b32 v191, 0
    v_mfma_f32_16x16x32_bf16 v[228:231], a[8:11], a[216:219], v[228:231]
    s_waitcnt lgkmcnt(6)
    buffer_load_dwordx4 v255, s[4:7], s59 offen offset:2048 lds
    v_mfma_f32_16x16x32_bf16 v[228:231], a[12:15], a[220:223], v[228:231]
    s_waitcnt lgkmcnt(5)
    v_mov_b32 v226, 0x22e00
    v_cndmask_b32 v226, v226, v247, vcc
    v_mfma_f32_16x16x32_bf16 v[228:231], a[16:19], a[224:227], v[228:231]
    s_waitcnt lgkmcnt(4)
    v_rcp_f32 v225, v224
    v_mfma_f32_16x16x32_bf16 v[228:231], a[20:23], a[228:231], v[228:231]
    s_mov_b32 vcc_lo, 0x0
    v_mul_f32 v212, v212, v225
    v_mul_f32 v213, v213, v225
    v_mfma_f32_16x16x32_bf16 v[232:235], a[24:27], a[240:243], 0
    s_mov_b32 vcc_hi, 0xf0000
    v_cndmask_b32 v245, v245, v200, vcc
    v_cndmask_b32 v244, v201, v244, vcc
    v_mfma_f32_16x16x32_bf16 v[232:235], a[28:31], a[244:247], v[232:235]
    s_mov_b32 vcc_lo, 0xff00fff0
    v_cvt_pk_bf16_f32 v96, v228, v229
    v_cvt_pk_bf16_f32 v97, v230, v231
    v_mfma_f32_16x16x32_bf16 v[232:235], a[32:35], a[216:219], v[232:235]
    ds_read_b128 v[204:207], v245 offset:192
    v_mul_f32 v214, v214, v225
    v_mfma_f32_16x16x32_bf16 v[232:235], a[36:39], a[220:223], v[232:235]
    s_mov_b32 vcc_hi, 0xf000
    v_cndmask_b32 v244, v244, v200, vcc
    v_mul_f32 v215, v215, v225
    v_mfma_f32_16x16x32_bf16 v[232:235], a[40:43], a[224:227], v[232:235]
    ds_read_b128 v[196:199], v244 offset:256
    v_cvt_pk_bf16_f32 v212, v212, v213
    v_mfma_f32_16x16x32_bf16 v[232:235], a[44:47], a[228:231], v[232:235]
    s_mov_b32 vcc_lo, 0xfff00ff
    v_mul_f32 v216, v216, v225
    v_mul_f32 v217, v217, v225
    v_mfma_f32_16x16x32_bf16 v[236:239], a[48:51], a[240:243], 0
    s_mov_b32 vcc_hi, 0xffffffff
    v_cndmask_b32 v246, v246, v200, vcc
    v_cvt_pk_bf16_f32 v213, v214, v215
    v_mfma_f32_16x16x32_bf16 v[236:239], a[52:55], a[244:247], v[236:239]
    s_add_u32 m0, s46, 0x1800
    v_cvt_pk_bf16_f32 v98, v232, v233
    v_cvt_pk_bf16_f32 v99, v234, v235
    v_mfma_f32_16x16x32_bf16 v[236:239], a[56:59], a[216:219], v[236:239]
    ds_read_b128 v[200:203], v244 offset:192
    v_mul_f32 v218, v218, v225
    v_mfma_f32_16x16x32_bf16 v[236:239], a[60:63], a[220:223], v[236:239]
    ds_read_b128 v[208:211], v246 offset:192
    v_mul_f32 v219, v219, v225
    v_mfma_f32_16x16x32_bf16 v[236:239], a[64:67], a[224:227], v[236:239]
    ds_write_b64 v247, v[178:179] offset:256
    v_mfma_f32_16x16x32_bf16 v[236:239], a[68:71], a[228:231], v[236:239]
    s_mov_b32 vcc_lo, 0xff00ff00
    v_cvt_pk_bf16_f32 v216, v216, v217
    v_mul_f32 v220, v220, v225
    v_mfma_f32_16x16x32_bf16 v[228:231], a[240:243], a[72:75], 0
    s_mov_b32 vcc_hi, 0xff00ff00
    v_mul_f32 v221, v221, v225
    v_cvt_pk_bf16_f32 v217, v218, v219
    v_mfma_f32_16x16x32_bf16 v[228:231], a[244:247], a[76:79], v[228:231]
    s_waitcnt lgkmcnt(4)
    v_cvt_pk_bf16_f32 v100, v236, v237
    v_cvt_pk_bf16_f32 v101, v238, v239
    v_mfma_f32_16x16x32_bf16 v[204:207], v[150:153], v[168:171], v[204:207]
    ds_write_b64 v226, v[212:213] offset:0
    v_mfma_f32_16x16x32_bf16 v[204:207], v[152:155], v[170:173], v[204:207]
    s_waitcnt lgkmcnt(4)
    v_mul_f32 v222, v222, v225
    v_mul_f32 v223, v223, v225
    v_mfma_f32_16x16x32_bf16 v[196:199], v[120:123], v[168:171], v[196:199]
    v_cvt_pk_bf16_f32 v220, v220, v221
    v_cvt_pk_bf16_f32 v221, v222, v223
    v_mfma_f32_16x16x32_bf16 v[196:199], v[122:125], v[170:173], v[196:199]
    ds_write_b64 v226, v[216:217] offset:128
    v_mfma_f32_16x16x32_bf16 v[228:231], a[216:219], a[80:83], v[228:231]
    s_waitcnt lgkmcnt(3)
    v_exp_f32 v204, v204
    v_mfma_f32_16x16x32_bf16 v[200:203], v[114:117], v[168:171], v[200:203]
    v_exp_f32 v205, v205
    v_mfma_f32_16x16x32_bf16 v[200:203], v[116:119], v[170:173], v[200:203]
    v_exp_f32 v206, v206
    v_mfma_f32_16x16x32_bf16 v[208:211], v[96:99], v[168:171], v[208:211]
    v_exp_f32 v207, v207
    v_mfma_f32_16x16x32_bf16 v[208:211], v[98:101], v[170:173], v[208:211]
    v_cvt_pk_bf16_f32 v194, v204, v205
    v_cvt_pk_bf16_f32 v181, v206, v207
    v_mfma_f32_16x16x32_bf16 v[228:231], a[220:223], a[84:87], v[228:231]
    ds_read_b128 v[204:207], v246 offset:256
    v_max3_f32 v248, v248, v224, v225
    v_mfma_f32_16x16x32_bf16 v[228:231], a[224:227], a[88:91], v[228:231]
    v_exp_f32 v200, v200
    v_mfma_f32_16x16x32_bf16 v[228:231], a[228:231], a[92:95], v[228:231]
    v_exp_f32 v201, v201
    v_mfma_f32_16x16x32_bf16 v[232:235], a[240:243], a[96:99], 0
    v_exp_f32 v202, v202
    v_mfma_f32_16x16x32_bf16 v[232:235], a[244:247], a[100:103], v[232:235]
    v_exp_f32 v203, v203
    v_mfma_f32_16x16x32_bf16 v[232:235], a[216:219], a[104:107], v[232:235]
    v_cvt_pk_bf16_f32 v193, v200, v201
    v_cvt_pk_bf16_f32 v180, v202, v203
    v_mfma_f32_16x16x32_bf16 v[232:235], a[220:223], a[108:111], v[232:235]
    v_cvt_pk_bf16_f32 v0, v228, v229
    v_cvt_pk_bf16_f32 v3, v230, v231
    v_mfma_f32_16x16x32_bf16 v[232:235], a[224:227], a[112:115], v[232:235]
    ds_read_b128 v[200:203], v245 offset:256
    v_accvgpr_read_b32 v255, a255
    v_mfma_f32_16x16x32_bf16 v[232:235], a[228:231], a[116:119], v[232:235]
    ds_write_b64 v226, v[220:221] offset:256
    v_mfma_f32_16x16x32_bf16 v[236:239], a[240:243], a[120:123], 0
    ds_read_b128 a[240:243], v242 offset:32384
    buffer_load_dwordx4 v254, s[4:7], s58 offen lds
    v_mfma_f32_16x16x32_bf16 v[236:239], a[244:247], a[124:127], v[236:239]
    ds_read_b128 a[244:247], v243 offset:32384
    v_mfma_f32_16x16x32_bf16 v[236:239], a[216:219], a[128:131], v[236:239]
    ds_read_b128 a[216:219], v242 offset:32512
    v_cvt_pk_bf16_f32 v30, v232, v233
    v_mfma_f32_16x16x32_bf16 v[236:239], a[220:223], a[132:135], v[236:239]
    ds_read_b128 a[220:223], v243 offset:32512
    v_cvt_pk_bf16_f32 v33, v234, v235
    v_mfma_f32_16x16x32_bf16 v[236:239], a[224:227], a[136:139], v[236:239]
    ds_read_b128 a[224:227], v242 offset:33792
    s_waitcnt lgkmcnt(7)
    v_mfma_f32_16x16x32_bf16 v[204:207], v[90:93], v[168:171], v[204:207]
    v_exp_f32 v208, v208
    v_mfma_f32_16x16x32_bf16 v[204:207], v[92:95], v[170:173], v[204:207]
    v_exp_f32 v209, v209
    v_mfma_f32_16x16x32_bf16 v[236:239], a[228:231], a[140:143], v[236:239]
    ds_read_b128 a[228:231], v243 offset:33792
    v_cvt_pk_bf16_f32 v192, v208, v209
    v_mfma_f32_16x16x32_bf16 v[228:231], a[144:147], a[232:235], 0
    s_waitcnt lgkmcnt(7)
    v_exp_f32 v210, v210
    v_mfma_f32_16x16x32_bf16 v[200:203], v[156:159], v[168:171], v[200:203]
    v_exp_f32 v211, v211
    v_mfma_f32_16x16x32_bf16 v[200:203], v[158:161], v[170:173], v[200:203]
    s_waitcnt lgkmcnt(5)
    v_cvt_pk_bf16_f32 v60, v236, v237
    v_cvt_pk_bf16_f32 v63, v238, v239
    v_mfma_f32_16x16x32_bf16 v[228:231], a[148:151], a[236:239], v[228:231]
    buffer_load_dwordx4 v255, s[4:7], s58 offen offset:512 lds
    v_cvt_pk_bf16_f32 v195, v210, v211
    v_mfma_f32_16x16x32_bf16 v[228:231], a[152:155], a[240:243], v[228:231]
    s_waitcnt lgkmcnt(4)
    v_exp_f32 v196, v196
    v_mfma_f32_16x16x32_bf16 v[212:215], v[0:3], v[192:195], 0
    ds_read_b128 v[208:211], v244 offset:320
    s_add_u32 m0, s46, 0x16800
    v_mfma_f32_16x16x32_bf16 v[216:219], v[30:33], v[192:195], 0
    s_waitcnt lgkmcnt(2)
    v_exp_f32 v197, v197
    v_mfma_f32_16x16x32_bf16 v[220:223], v[60:63], v[192:195], 0
    v_exp_f32 v198, v198
    v_mfma_f32_16x16x32_bf16 v[224:227], a[248:251], v[192:195], 0
    v_exp_f32 v199, v199
    v_mfma_f32_16x16x32_bf16 v[228:231], a[156:159], a[244:247], v[228:231]
    s_waitcnt lgkmcnt(1)
    v_cvt_pk_bf16_f32 v183, v196, v197
    v_cvt_pk_bf16_f32 v186, v198, v199
    v_mfma_f32_16x16x32_bf16 v[228:231], a[160:163], a[216:219], v[228:231]
    ds_read_b128 v[196:199], v245 offset:320
    v_mfma_f32_16x16x32_bf16 v[228:231], a[164:167], a[220:223], v[228:231]
    v_exp_f32 v200, v200
    v_mfma_f32_16x16x32_bf16 v[232:235], a[168:171], a[232:235], 0
    v_exp_f32 v201, v201
    v_mfma_f32_16x16x32_bf16 v[232:235], a[172:175], a[236:239], v[232:235]
    v_exp_f32 v202, v202
    v_mfma_f32_16x16x32_bf16 v[232:235], a[176:179], a[240:243], v[232:235]
    v_exp_f32 v203, v203
    v_mfma_f32_16x16x32_bf16 v[232:235], a[180:183], a[244:247], v[232:235]
    s_waitcnt lgkmcnt(1)
    v_mul_f32 v228, s38, v228
    v_mul_f32 v229, s38, v229
    v_mfma_f32_16x16x32_bf16 v[208:211], v[126:129], v[168:171], v[208:211]
    v_mul_f32 v230, s38, v230
    v_mul_f32 v231, s38, v231
    v_mfma_f32_16x16x32_bf16 v[208:211], v[128:131], v[170:173], v[208:211]
    v_cvt_pk_bf16_f32 v174, v228, v229
    v_cvt_pk_bf16_f32 v175, v230, v231
    v_mfma_f32_16x16x32_bf16 v[232:235], a[184:187], a[216:219], v[232:235]
    v_cvt_pk_bf16_f32 v184, v200, v201
    v_cvt_pk_bf16_f32 v187, v202, v203
    v_mfma_f32_16x16x32_bf16 v[232:235], a[188:191], a[220:223], v[232:235]
    v_exp_f32 v204, v204
    v_mfma_f32_16x16x32_bf16 v[236:239], a[192:195], a[232:235], 0
    ds_read_b128 a[232:235], v242 offset:33920
    ds_read_b128 v[200:203], v246 offset:320
    v_mfma_f32_16x16x32_bf16 v[236:239], a[196:199], a[236:239], v[236:239]
    ds_read_b128 a[236:239], v243 offset:33920
    v_mfma_f32_16x16x32_bf16 v[236:239], a[200:203], a[240:243], v[236:239]
    ds_read_b128 a[240:243], v242 offset:34048
    v_mul_f32 v232, s3, v232
    v_mfma_f32_16x16x32_bf16 v[236:239], a[204:207], a[244:247], v[236:239]
    s_waitcnt lgkmcnt(4)
    v_mul_f32 v233, s3, v233
    v_mul_f32 v234, s3, v234
    v_mfma_f32_16x16x32_bf16 v[196:199], v[162:165], v[168:171], v[196:199]
    v_mul_f32 v235, s3, v235
    v_cvt_pk_bf16_f32 v176, v232, v233
    v_mfma_f32_16x16x32_bf16 v[196:199], v[164:167], v[170:173], v[196:199]
    ds_read_b128 a[244:247], v243 offset:34048
    v_cvt_pk_bf16_f32 v177, v234, v235
    v_mfma_f32_16x16x32_bf16 v[236:239], a[208:211], a[216:219], v[236:239]
    v_exp_f32 v205, v205
    v_mfma_f32_16x16x32_bf16 v[236:239], a[212:215], a[220:223], v[236:239]
    v_exp_f32 v206, v206
    v_mfma_f32_16x16x32_bf16 v[228:231], a[144:147], a[224:227], 0
    v_exp_f32 v207, v207
    v_mfma_f32_16x16x32_bf16 v[228:231], a[148:151], a[228:231], v[228:231]
    s_waitcnt lgkmcnt(4)
    v_cvt_pk_bf16_f32 v182, v204, v205
    v_cvt_pk_bf16_f32 v185, v206, v207
    v_mfma_f32_16x16x32_bf16 v[228:231], a[152:155], a[232:235], v[228:231]
    s_waitcnt lgkmcnt(2)
    v_mul_f32 v236, s38, v236
    v_mul_f32 v237, s38, v237
    v_mfma_f32_16x16x32_bf16 v[212:215], v[4:7], v[180:183], v[212:215]
    v_mul_f32 v238, s38, v238
    v_mul_f32 v239, s38, v239
    v_mfma_f32_16x16x32_bf16 v[216:219], v[34:37], v[180:183], v[216:219]
    v_cvt_pk_bf16_f32 v178, v236, v237
    v_cvt_pk_bf16_f32 v179, v238, v239
    v_mfma_f32_16x16x32_bf16 v[220:223], v[64:67], v[180:183], v[220:223]
    ds_read_b128 v[204:207], v244 offset:0
    s_waitcnt vmcnt(10) lgkmcnt(1)
    v_mfma_f32_16x16x32_bf16 v[224:227], a[248:251], v[180:183], v[224:227]
    s_barrier
    v_mfma_f32_16x16x32_bf16 v[212:215], v[8:11], v[184:187], v[212:215]
    ds_read_b128 a[216:219], v240 offset:33792
    ds_read_b128 a[220:223], v241 offset:33792
    v_mfma_f32_16x16x32_bf16 v[216:219], v[38:41], v[184:187], v[216:219]
    v_exp_f32 v208, v208
    v_mfma_f32_16x16x32_bf16 v[220:223], v[68:71], v[184:187], v[220:223]
    v_exp_f32 v209, v209
    v_mfma_f32_16x16x32_bf16 v[224:227], a[248:251], v[184:187], v[224:227]
    v_exp_f32 v196, v196
    v_mfma_f32_16x16x32_bf16 v[228:231], a[156:159], a[236:239], v[228:231]
    v_exp_f32 v197, v197
    v_mfma_f32_16x16x32_bf16 v[228:231], a[160:163], a[240:243], v[228:231]
    v_cvt_pk_bf16_f32 v189, v208, v209
    v_cvt_pk_bf16_f32 v190, v196, v197
    v_mfma_f32_16x16x32_bf16 v[228:231], a[164:167], a[244:247], v[228:231]
    ds_read_b128 v[208:211], v245 offset:0
    ds_read_b128 v[196:199], v246 offset:0
    v_mfma_f32_16x16x32_bf16 v[232:235], a[168:171], a[224:227], 0
    s_waitcnt lgkmcnt(4)
    v_mfma_f32_16x16x32_bf16 v[204:207], v[120:123], v[174:177], v[204:207]
    v_mfma_f32_16x16x32_bf16 v[204:207], v[122:125], v[176:179], v[204:207]
    s_waitcnt lgkmcnt(3)
    v_mfma_f32_16x16x32_bf16 v[232:235], a[172:175], a[228:231], v[232:235]
    s_waitcnt lgkmcnt(2)
    v_mul_f32 v228, s38, v228
    v_mul_f32 v229, s38, v229
    v_mfma_f32_16x16x32_bf16 v[232:235], a[176:179], a[232:235], v[232:235]
    v_mul_f32 v230, s38, v230
    v_mul_f32 v231, s38, v231
    v_mfma_f32_16x16x32_bf16 v[232:235], a[180:183], a[236:239], v[232:235]
    v_cvt_pk_bf16_f32 v228, v228, v229
    v_cvt_pk_bf16_f32 v229, v230, v231
    v_mfma_f32_16x16x32_bf16 v[232:235], a[184:187], a[240:243], v[232:235]
    ds_write_b64 v247, v[228:229] offset:18432
    v_mfma_f32_16x16x32_bf16 v[232:235], a[188:191], a[244:247], v[232:235]
    v_exp_f32 v204, v204
    v_mfma_f32_16x16x32_bf16 v[236:239], a[192:195], a[224:227], 0
    ds_read_b128 a[224:227], v240 offset:33920
    v_mfma_f32_16x16x32_bf16 v[236:239], a[196:199], a[228:231], v[236:239]
    ds_read_b128 a[228:231], v241 offset:33920
    v_mfma_f32_16x16x32_bf16 v[236:239], a[200:203], a[232:235], v[236:239]
    ds_read_b128 a[232:235], v240 offset:34048
    v_mfma_f32_16x16x32_bf16 v[236:239], a[204:207], a[236:239], v[236:239]
    ds_read_b128 a[236:239], v241 offset:34048
    v_mul_f32 v232, s3, v232
    v_mfma_f32_16x16x32_bf16 v[236:239], a[208:211], a[240:243], v[236:239]
    s_waitcnt lgkmcnt(6)
    v_mul_f32 v233, s3, v233
    v_mul_f32 v234, s3, v234
    v_mfma_f32_16x16x32_bf16 v[208:211], v[156:159], v[174:177], v[208:211]
    s_waitcnt lgkmcnt(5)
    v_mul_f32 v235, s3, v235
    v_cvt_pk_bf16_f32 v232, v232, v233
    v_mfma_f32_16x16x32_bf16 v[208:211], v[158:161], v[176:179], v[208:211]
    ds_read_b128 a[240:243], v242 offset:61440
    v_cvt_pk_bf16_f32 v233, v234, v235
    v_mfma_f32_16x16x32_bf16 v[196:199], v[90:93], v[174:177], v[196:199]
    ds_write_b64 v247, v[232:233] offset:18560
    v_mfma_f32_16x16x32_bf16 v[196:199], v[92:95], v[176:179], v[196:199]
    v_exp_f32 v205, v205
    v_mfma_f32_16x16x32_bf16 v[236:239], a[212:215], a[244:247], v[236:239]
    v_exp_f32 v206, v206
    v_mfma_f32_16x16x32_bf16 v[228:231], a[0:3], a[216:219], 0
    s_waitcnt lgkmcnt(5)
    v_exp_f32 v207, v207
    v_mfma_f32_16x16x32_bf16 v[228:231], a[4:7], a[220:223], v[228:231]
    s_waitcnt lgkmcnt(4)
    v_cvt_pk_bf16_f32 v193, v204, v205
    v_cvt_pk_bf16_f32 v180, v206, v207
    v_mfma_f32_16x16x32_bf16 v[228:231], a[8:11], a[224:227], v[228:231]
    s_waitcnt lgkmcnt(3)
    v_mul_f32 v236, s38, v236
    v_mul_f32 v237, s38, v237
    v_mfma_f32_16x16x32_bf16 v[228:231], a[12:15], a[228:231], v[228:231]
    s_waitcnt lgkmcnt(2)
    v_mul_f32 v238, s38, v238
    v_mul_f32 v239, s38, v239
    v_mfma_f32_16x16x32_bf16 v[228:231], a[16:19], a[232:235], v[228:231]
    ds_read_b128 v[204:207], v245 offset:64
    v_cvt_pk_bf16_f32 v236, v236, v237
    v_mfma_f32_16x16x32_bf16 v[228:231], a[20:23], a[236:239], v[228:231]
    ds_read_b128 a[244:247], v243 offset:61440
    v_cvt_pk_bf16_f32 v237, v238, v239
    v_mfma_f32_16x16x32_bf16 v[232:235], a[24:27], a[216:219], 0
    ds_write_b64 v247, v[236:237] offset:18688
    v_mfma_f32_16x16x32_bf16 v[232:235], a[28:31], a[220:223], v[232:235]
    s_waitcnt lgkmcnt(3)
    v_exp_f32 v208, v208
    v_mfma_f32_16x16x32_bf16 v[232:235], a[32:35], a[224:227], v[232:235]
    v_cvt_pk_bf16_f32 v138, v228, v229
    v_cvt_pk_bf16_f32 v139, v230, v231
    v_mfma_f32_16x16x32_bf16 v[232:235], a[36:39], a[228:231], v[232:235]
    v_exp_f32 v209, v209
    v_mfma_f32_16x16x32_bf16 v[232:235], a[40:43], a[232:235], v[232:235]
    v_exp_f32 v210, v210
    v_mfma_f32_16x16x32_bf16 v[232:235], a[44:47], a[236:239], v[232:235]
    v_exp_f32 v211, v211
    v_mfma_f32_16x16x32_bf16 v[236:239], a[48:51], a[216:219], 0
    v_cvt_pk_bf16_f32 v194, v208, v209
    v_cvt_pk_bf16_f32 v181, v210, v211
    v_mfma_f32_16x16x32_bf16 v[236:239], a[52:55], a[220:223], v[236:239]
    ds_read_b128 v[208:211], v246 offset:64
    v_mfma_f32_16x16x32_bf16 v[236:239], a[56:59], a[224:227], v[236:239]
    s_waitcnt lgkmcnt(3)
    v_cvt_pk_bf16_f32 v140, v232, v233
    v_cvt_pk_bf16_f32 v141, v234, v235
    v_mfma_f32_16x16x32_bf16 v[204:207], v[162:165], v[174:177], v[204:207]
    s_waitcnt lgkmcnt(2)
    v_exp_f32 v196, v196
    v_mfma_f32_16x16x32_bf16 v[200:203], v[138:141], v[168:171], v[200:203]
    v_exp_f32 v197, v197
    v_mfma_f32_16x16x32_bf16 v[204:207], v[164:167], v[176:179], v[204:207]
    v_exp_f32 v198, v198
    v_mfma_f32_16x16x32_bf16 v[236:239], a[60:63], a[228:231], v[236:239]
    v_exp_f32 v199, v199
    v_mfma_f32_16x16x32_bf16 v[236:239], a[64:67], a[232:235], v[236:239]
    v_cvt_pk_bf16_f32 v192, v196, v197
    v_cvt_pk_bf16_f32 v195, v198, v199
    v_mfma_f32_16x16x32_bf16 v[236:239], a[68:71], a[236:239], v[236:239]
    ds_read_b128 v[196:199], v244 offset:128
    ds_read_b64 v[168:169], v247 offset:18432
    v_mfma_f32_16x16x32_bf16 v[228:231], a[216:219], a[72:75], 0
    v_exp_f32 v204, v204
    v_mfma_f32_16x16x32_bf16 v[228:231], a[220:223], a[76:79], v[228:231]
    v_exp_f32 v205, v205
    v_mfma_f32_16x16x32_bf16 v[228:231], a[224:227], a[80:83], v[228:231]
    s_waitcnt lgkmcnt(2)
    v_cvt_pk_bf16_f32 v142, v236, v237
    v_cvt_pk_bf16_f32 v143, v238, v239
    v_mfma_f32_16x16x32_bf16 v[208:211], v[138:141], v[174:177], v[208:211]
    v_exp_f32 v206, v206
    v_mfma_f32_16x16x32_bf16 v[200:203], v[140:143], v[170:173], v[200:203]
    v_exp_f32 v207, v207
    v_mfma_f32_16x16x32_bf16 v[208:211], v[140:143], v[176:179], v[208:211]
    v_cvt_pk_bf16_f32 v184, v204, v205
    v_cvt_pk_bf16_f32 v187, v206, v207
    v_mfma_f32_16x16x32_bf16 v[228:231], a[228:231], a[84:87], v[228:231]
    ds_read_b128 v[204:207], v246 offset:128
    ds_read_b64 v[170:171], v247 offset:18560
    v_mfma_f32_16x16x32_bf16 v[228:231], a[232:235], a[88:91], v[228:231]
L_h5:
    s_cbranch_execz L_h9
    v_exp_f32 v200, v200
    v_mfma_f32_16x16x32_bf16 v[228:231], a[236:239], a[92:95], v[228:231]
    s_waitcnt lgkmcnt(3)
    v_exp_f32 v201, v201
    v_mfma_f32_16x16x32_bf16 v[196:199], v[132:135], v[174:177], v[196:199]
    ds_read_b64 v[172:173], v247 offset:18688
    v_cvt_pk_bf16_f32 v188, v200, v201
    v_mfma_f32_16x16x32_bf16 v[196:199], v[134:137], v[176:179], v[196:199]
    ds_read_b128 v[200:203], v244 offset:64
    v_mfma_f32_16x16x32_bf16 v[224:227], a[248:251], v[188:191], v[224:227]
    s_waitcnt lgkmcnt(4)
    v_cvt_pk_bf16_f32 v12, v228, v229
    v_cvt_pk_bf16_f32 v15, v230, v231
    v_mfma_f32_16x16x32_bf16 v[232:235], a[216:219], a[96:99], 0
    v_exp_f32 v208, v208
    v_mfma_f32_16x16x32_bf16 v[212:215], v[12:15], v[188:191], v[212:215]
    v_exp_f32 v209, v209
    v_mfma_f32_16x16x32_bf16 v[232:235], a[220:223], a[100:103], v[232:235]
    v_rcp_f32 v225, v224
    v_mfma_f32_16x16x32_bf16 v[232:235], a[224:227], a[104:107], v[232:235]
    v_max3_f32 v248, v248, v224, v225
    v_cvt_pk_bf16_f32 v182, v208, v209
    v_mfma_f32_16x16x32_bf16 v[232:235], a[228:231], a[108:111], v[232:235]
    s_waitcnt lgkmcnt(2)
    v_mul_f32 v212, v212, v225
    v_mul_f32 v213, v213, v225
    v_mfma_f32_16x16x32_bf16 v[232:235], a[232:235], a[112:115], v[232:235]
    v_mul_f32 v214, v214, v225
    v_mul_f32 v215, v215, v225
    v_mfma_f32_16x16x32_bf16 v[232:235], a[236:239], a[116:119], v[232:235]
    v_cvt_pk_bf16_f32 v212, v212, v213
    s_waitcnt lgkmcnt(0)
    v_mfma_f32_16x16x32_bf16 v[200:203], v[126:129], v[174:177], v[200:203]
    v_exp_f32 v210, v210
    v_mfma_f32_16x16x32_bf16 v[200:203], v[128:131], v[176:179], v[200:203]
    v_exp_f32 v211, v211
    v_mfma_f32_16x16x32_bf16 v[236:239], a[216:219], a[120:123], 0
    ds_read_b128 a[216:219], v242 offset:61568
    v_cvt_pk_bf16_f32 v42, v232, v233
    v_mfma_f32_16x16x32_bf16 v[236:239], a[220:223], a[124:127], v[236:239]
    ds_read_b128 a[220:223], v243 offset:61568
    v_cvt_pk_bf16_f32 v45, v234, v235
    v_mfma_f32_16x16x32_bf16 v[236:239], a[224:227], a[128:131], v[236:239]
    ds_read_b128 a[224:227], v242 offset:61696
    v_cvt_pk_bf16_f32 v213, v214, v215
    v_mfma_f32_16x16x32_bf16 v[216:219], v[42:45], v[188:191], v[216:219]
    ds_write_b64 v247, v[212:213] offset:6144
    v_mfma_f32_16x16x32_bf16 v[212:215], v[6:9], v[192:195], 0
    v_exp_f32 v200, v200
    v_mfma_f32_16x16x32_bf16 v[236:239], a[228:231], a[132:135], v[236:239]
    ds_read_b128 a[228:231], v243 offset:61696
    v_cvt_pk_bf16_f32 v185, v210, v211
    v_mfma_f32_16x16x32_bf16 v[236:239], a[232:235], a[136:139], v[236:239]
    ds_read_b128 a[232:235], v242 offset:64512
    v_mul_f32 v216, v216, v225
    v_mfma_f32_16x16x32_bf16 v[236:239], a[236:239], a[140:143], v[236:239]
    ds_read_b128 a[236:239], v243 offset:64512
    v_mul_f32 v217, v217, v225
    v_mfma_f32_16x16x32_bf16 v[228:231], a[144:147], a[240:243], 0
    v_mul_f32 v218, v218, v225
    v_mul_f32 v219, v219, v225
    v_mfma_f32_16x16x32_bf16 v[228:231], a[148:151], a[244:247], v[228:231]
    s_waitcnt lgkmcnt(6)
    v_cvt_pk_bf16_f32 v216, v216, v217
    v_cvt_pk_bf16_f32 v72, v236, v237
    v_mfma_f32_16x16x32_bf16 v[228:231], a[152:155], a[216:219], v[228:231]
    s_waitcnt lgkmcnt(5)
    v_cvt_pk_bf16_f32 v75, v238, v239
    v_cvt_pk_bf16_f32 v217, v218, v219
    v_mfma_f32_16x16x32_bf16 v[228:231], a[156:159], a[220:223], v[228:231]
    s_waitcnt lgkmcnt(4)
    v_exp_f32 v201, v201
    v_mfma_f32_16x16x32_bf16 v[220:223], v[72:75], v[188:191], v[220:223]
    ds_write_b64 v247, v[216:217] offset:6272
    v_mfma_f32_16x16x32_bf16 v[216:219], v[36:39], v[192:195], 0
    v_exp_f32 v202, v202
    v_mfma_f32_16x16x32_bf16 v[228:231], a[160:163], a[224:227], v[228:231]
    s_waitcnt lgkmcnt(3)
    v_exp_f32 v203, v203
    v_mfma_f32_16x16x32_bf16 v[228:231], a[164:167], a[228:231], v[228:231]
    v_cvt_pk_bf16_f32 v183, v200, v201
    v_mul_f32 v220, v220, v225
    v_mfma_f32_16x16x32_bf16 v[232:235], a[168:171], a[240:243], 0
    s_waitcnt lgkmcnt(2)
    v_mul_f32 v221, v221, v225
    v_mul_f32 v222, v222, v225
    v_mfma_f32_16x16x32_bf16 v[212:215], v[10:13], v[180:183], v[212:215]
    s_waitcnt lgkmcnt(1)
    v_mul_f32 v228, s38, v228
    v_mul_f32 v229, s38, v229
    v_mfma_f32_16x16x32_bf16 v[216:219], v[40:43], v[180:183], v[216:219]
    v_mul_f32 v230, s38, v230
    v_mul_f32 v231, s38, v231
    v_mfma_f32_16x16x32_bf16 v[232:235], a[172:175], a[244:247], v[232:235]
    v_cvt_pk_bf16_f32 v228, v228, v229
    v_cvt_pk_bf16_f32 v229, v230, v231
    v_mfma_f32_16x16x32_bf16 v[232:235], a[176:179], a[216:219], v[232:235]
    ds_write_b64 v247, v[228:229] offset:24576
    v_mfma_f32_16x16x32_bf16 v[232:235], a[180:183], a[220:223], v[232:235]
    v_mul_f32 v223, v223, v225
    v_cvt_pk_bf16_f32 v220, v220, v221
    v_mfma_f32_16x16x32_bf16 v[224:227], a[248:251], v[192:195], 0
    v_cvt_pk_bf16_f32 v221, v222, v223
    v_cvt_pk_bf16_f32 v186, v202, v203
    v_mfma_f32_16x16x32_bf16 v[224:227], a[248:251], v[180:183], v[224:227]
    ds_write_b64 v247, v[220:221] offset:6400
    v_mfma_f32_16x16x32_bf16 v[220:223], v[66:69], v[192:195], 0
    ds_read_b128 v[200:203], v245 offset:128
    ds_read_b128 v[208:211], v244 offset:0
    v_mfma_f32_16x16x32_bf16 v[220:223], v[70:73], v[180:183], v[220:223]
    v_exp_f32 v196, v196
    v_mfma_f32_16x16x32_bf16 v[212:215], v[14:17], v[184:187], v[212:215]
    v_exp_f32 v197, v197
    v_mfma_f32_16x16x32_bf16 v[216:219], v[44:47], v[184:187], v[216:219]
    v_cvt_pk_bf16_f32 v189, v196, v197
    v_mfma_f32_16x16x32_bf16 v[220:223], v[74:77], v[184:187], v[220:223]
    ds_read_b128 v[196:199], v245 offset:0
    v_mfma_f32_16x16x32_bf16 v[224:227], a[248:251], v[184:187], v[224:227]
    v_mfma_f32_16x16x32_bf16 v[232:235], a[184:187], a[224:227], v[232:235]
    v_mfma_f32_16x16x32_bf16 v[232:235], a[188:191], a[228:231], v[232:235]
    v_mfma_f32_16x16x32_bf16 v[236:239], a[192:195], a[240:243], 0
    ds_read_b128 a[240:243], v242 offset:64640
    v_mfma_f32_16x16x32_bf16 v[236:239], a[196:199], a[244:247], v[236:239]
    ds_read_b128 a[244:247], v243 offset:64640
    v_mfma_f32_16x16x32_bf16 v[236:239], a[200:203], a[216:219], v[236:239]
    ds_read_b128 a[216:219], v242 offset:64768
    v_add_u32 v242, 0xf000, v242
    v_mfma_f32_16x16x32_bf16 v[236:239], a[204:207], a[220:223], v[236:239]
    ds_read_b128 a[220:223], v243 offset:64768
    v_mul_f32 v232, s3, v232
    v_mfma_f32_16x16x32_bf16 v[236:239], a[208:211], a[224:227], v[236:239]
    s_waitcnt lgkmcnt(5)
    v_mul_f32 v233, s3, v233
    v_mul_f32 v234, s3, v234
    v_mfma_f32_16x16x32_bf16 v[200:203], v[102:105], v[174:177], v[200:203]
    v_mul_f32 v235, s3, v235
    v_cvt_pk_bf16_f32 v232, v232, v233
    v_mfma_f32_16x16x32_bf16 v[200:203], v[104:107], v[176:179], v[200:203]
    ds_read_b128 a[224:227], v240 offset:35328
    v_cvt_pk_bf16_f32 v233, v234, v235
    v_mfma_f32_16x16x32_bf16 v[208:211], v[126:129], v[168:171], v[208:211]
    ds_write_b64 v247, v[232:233] offset:24704
    v_mfma_f32_16x16x32_bf16 v[208:211], v[128:131], v[170:173], v[208:211]
    s_waitcnt lgkmcnt(6)
    v_add_u32 v243, 0xf000, v243
    v_mfma_f32_16x16x32_bf16 v[196:199], v[162:165], v[168:171], v[196:199]
    v_exp_f32 v200, v200
    v_mfma_f32_16x16x32_bf16 v[196:199], v[164:167], v[170:173], v[196:199]
    s_waitcnt lgkmcnt(5)
    v_exp_f32 v201, v201
    v_mfma_f32_16x16x32_bf16 v[236:239], a[212:215], a[228:231], v[236:239]
    ds_read_b128 a[228:231], v241 offset:35328
    v_cvt_pk_bf16_f32 v190, v200, v201
    v_mfma_f32_16x16x32_bf16 v[228:231], a[144:147], a[232:235], 0
    ds_read_b128 v[200:203], v246 offset:0
    v_mfma_f32_16x16x32_bf16 v[228:231], a[148:151], a[236:239], v[228:231]
    s_waitcnt lgkmcnt(4)
    v_exp_f32 v208, v208
    v_mfma_f32_16x16x32_bf16 v[228:231], a[152:155], a[240:243], v[228:231]
    v_mul_f32 v236, s38, v236
    v_mul_f32 v237, s38, v237
    v_mfma_f32_16x16x32_bf16 v[228:231], a[156:159], a[244:247], v[228:231]
    v_mul_f32 v238, s38, v238
    v_mul_f32 v239, s38, v239
    v_mfma_f32_16x16x32_bf16 v[228:231], a[160:163], a[216:219], v[228:231]
    s_waitcnt lgkmcnt(3)
    v_cvt_pk_bf16_f32 v236, v236, v237
    v_cvt_pk_bf16_f32 v237, v238, v239
    v_mfma_f32_16x16x32_bf16 v[228:231], a[164:167], a[220:223], v[228:231]
    ds_write_b64 v247, v[236:237] offset:24832
    v_mfma_f32_16x16x32_bf16 v[232:235], a[168:171], a[232:235], 0
    v_exp_f32 v209, v209
    v_mfma_f32_16x16x32_bf16 v[232:235], a[172:175], a[236:239], v[232:235]
    v_exp_f32 v210, v210
    v_mfma_f32_16x16x32_bf16 v[232:235], a[176:179], a[240:243], v[232:235]
    v_exp_f32 v211, v211
    v_mfma_f32_16x16x32_bf16 v[232:235], a[180:183], a[244:247], v[232:235]
    s_waitcnt lgkmcnt(2)
    v_mul_f32 v228, s38, v228
    v_mul_f32 v229, s38, v229
    v_mfma_f32_16x16x32_bf16 v[232:235], a[184:187], a[216:219], v[232:235]
    s_waitcnt lgkmcnt(1)
    v_mul_f32 v230, s38, v230
    v_mul_f32 v231, s38, v231
    v_mfma_f32_16x16x32_bf16 v[200:203], v[138:141], v[168:171], v[200:203]
    v_cvt_pk_bf16_f32 v228, v228, v229
    v_cvt_pk_bf16_f32 v229, v230, v231
    v_mfma_f32_16x16x32_bf16 v[200:203], v[140:143], v[170:173], v[200:203]
    ds_write_b64 v247, v[228:229] offset:36864
    v_mfma_f32_16x16x32_bf16 v[232:235], a[188:191], a[220:223], v[232:235]
    v_cvt_pk_bf16_f32 v193, v208, v209
    v_cvt_pk_bf16_f32 v180, v210, v211
    v_mfma_f32_16x16x32_bf16 v[236:239], a[192:195], a[232:235], 0
    ds_read_b128 a[232:235], v240 offset:35456
    ds_read_b128 v[208:211], v245 offset:64
    v_mfma_f32_16x16x32_bf16 v[236:239], a[196:199], a[236:239], v[236:239]
    ds_read_b128 a[236:239], v241 offset:35456
    v_mfma_f32_16x16x32_bf16 v[236:239], a[200:203], a[240:243], v[236:239]
    v_mul_f32 v232, s3, v232
    v_mul_f32 v233, s3, v233
    v_mfma_f32_16x16x32_bf16 v[236:239], a[204:207], a[244:247], v[236:239]
    v_mul_f32 v234, s3, v234
    v_mul_f32 v235, s3, v235
    v_mfma_f32_16x16x32_bf16 v[236:239], a[208:211], a[216:219], v[236:239]
    ds_read_b128 a[240:243], v240 offset:35584
    v_cvt_pk_bf16_f32 v232, v232, v233
    v_mfma_f32_16x16x32_bf16 v[236:239], a[212:215], a[220:223], v[236:239]
    ds_read_b128 a[244:247], v241 offset:35584
    v_cvt_pk_bf16_f32 v233, v234, v235
    v_mfma_f32_16x16x32_bf16 v[228:231], a[0:3], a[224:227], 0
    ds_write_b64 v247, v[232:233] offset:36992
    v_mfma_f32_16x16x32_bf16 v[228:231], a[4:7], a[228:231], v[228:231]
    v_exp_f32 v196, v196
    v_mfma_f32_16x16x32_bf16 v[232:235], a[24:27], a[224:227], 0
    s_waitcnt lgkmcnt(5)
    v_mul_f32 v236, s38, v236
    v_mul_f32 v237, s38, v237
    v_mfma_f32_16x16x32_bf16 v[228:231], a[8:11], a[232:235], v[228:231]
    v_mul_f32 v238, s38, v238
    v_mul_f32 v239, s38, v239
    v_mfma_f32_16x16x32_bf16 v[232:235], a[28:31], a[228:231], v[232:235]
    s_waitcnt lgkmcnt(3)
    v_cvt_pk_bf16_f32 v236, v236, v237
    v_cvt_pk_bf16_f32 v237, v238, v239
    v_mfma_f32_16x16x32_bf16 v[208:211], v[102:105], v[168:171], v[208:211]
    ds_write_b64 v247, v[236:237] offset:37120
    v_mfma_f32_16x16x32_bf16 v[208:211], v[104:107], v[170:173], v[208:211]
    s_waitcnt vmcnt(0)
    v_exp_f32 v197, v197
    v_mfma_f32_16x16x32_bf16 v[228:231], a[12:15], a[236:239], v[228:231]
    s_waitcnt lgkmcnt(3)
    v_exp_f32 v198, v198
    v_mfma_f32_16x16x32_bf16 v[228:231], a[16:19], a[240:243], v[228:231]
    s_waitcnt lgkmcnt(2)
    v_exp_f32 v199, v199
    v_mfma_f32_16x16x32_bf16 v[228:231], a[20:23], a[244:247], v[228:231]
    s_barrier
    v_mfma_f32_16x16x32_bf16 v[232:235], a[32:35], a[232:235], v[232:235]
    ds_read_b128 a[216:219], v242 offset:4608
    v_cvt_pk_bf16_f32 v194, v196, v197
    v_mfma_f32_16x16x32_bf16 v[232:235], a[36:39], a[236:239], v[232:235]
    ds_read_b128 a[220:223], v243 offset:4608
    v_cvt_pk_bf16_f32 v181, v198, v199
    v_mfma_f32_16x16x32_bf16 v[232:235], a[40:43], a[240:243], v[232:235]
    v_cvt_pk_bf16_f32 v114, v228, v229
    v_cvt_pk_bf16_f32 v115, v230, v231
    v_mfma_f32_16x16x32_bf16 v[232:235], a[44:47], a[244:247], v[232:235]
    ds_read_b128 v[196:199], v246 offset:64
    v_mfma_f32_16x16x32_bf16 v[236:239], a[48:51], a[224:227], 0
    v_exp_f32 v200, v200
    v_mfma_f32_16x16x32_bf16 v[236:239], a[52:55], a[228:231], v[236:239]
    v_exp_f32 v201, v201
    v_mfma_f32_16x16x32_bf16 v[236:239], a[56:59], a[232:235], v[236:239]
    v_exp_f32 v202, v202
    v_mfma_f32_16x16x32_bf16 v[236:239], a[60:63], a[236:239], v[236:239]
    v_cvt_pk_bf16_f32 v116, v232, v233
    v_cvt_pk_bf16_f32 v117, v234, v235
    v_mfma_f32_16x16x32_bf16 v[236:239], a[64:67], a[240:243], v[236:239]
    v_exp_f32 v203, v203
    v_mfma_f32_16x16x32_bf16 v[204:207], v[114:117], v[174:177], v[204:207]
    v_cvt_pk_bf16_f32 v192, v200, v201
    v_cvt_pk_bf16_f32 v195, v202, v203
    v_mfma_f32_16x16x32_bf16 v[236:239], a[68:71], a[244:247], v[236:239]
    ds_read_b128 v[200:203], v244 offset:128
    ds_read_b64 v[174:175], v247 offset:0
    v_mfma_f32_16x16x32_bf16 v[228:231], a[224:227], a[72:75], 0
    s_waitcnt lgkmcnt(3)
    v_exp_f32 v208, v208
    v_mfma_f32_16x16x32_bf16 v[228:231], a[228:231], a[76:79], v[228:231]
    v_exp_f32 v209, v209
    v_mfma_f32_16x16x32_bf16 v[228:231], a[232:235], a[80:83], v[228:231]
    s_waitcnt lgkmcnt(2)
    v_cvt_pk_bf16_f32 v118, v236, v237
    v_cvt_pk_bf16_f32 v119, v238, v239
    v_mfma_f32_16x16x32_bf16 v[196:199], v[114:117], v[168:171], v[196:199]
    v_exp_f32 v210, v210
    v_mfma_f32_16x16x32_bf16 v[204:207], v[116:119], v[176:179], v[204:207]
    v_exp_f32 v211, v211
    v_mfma_f32_16x16x32_bf16 v[196:199], v[116:119], v[170:173], v[196:199]
    v_cvt_pk_bf16_f32 v184, v208, v209
    v_cvt_pk_bf16_f32 v187, v210, v211
    v_mfma_f32_16x16x32_bf16 v[228:231], a[236:239], a[84:87], v[228:231]
    ds_read_b128 v[208:211], v246 offset:128
    ds_read_b64 v[176:177], v247 offset:128
    v_mfma_f32_16x16x32_bf16 v[228:231], a[240:243], a[88:91], v[228:231]
    v_exp_f32 v204, v204
    v_mfma_f32_16x16x32_bf16 v[228:231], a[244:247], a[92:95], v[228:231]
    s_waitcnt lgkmcnt(3)
    v_exp_f32 v205, v205
    v_mfma_f32_16x16x32_bf16 v[200:203], v[144:147], v[168:171], v[200:203]
    ds_read_b64 v[178:179], v247 offset:256
    v_cvt_pk_bf16_f32 v188, v204, v205
    v_mfma_f32_16x16x32_bf16 v[200:203], v[146:149], v[170:173], v[200:203]
    ds_read_b128 v[204:207], v244 offset:64
    v_mfma_f32_16x16x32_bf16 v[224:227], a[248:251], v[188:191], v[224:227]
    s_waitcnt lgkmcnt(4)
    v_cvt_pk_bf16_f32 v18, v228, v229
    v_cvt_pk_bf16_f32 v21, v230, v231
    v_mfma_f32_16x16x32_bf16 v[232:235], a[224:227], a[96:99], 0
    v_exp_f32 v196, v196
    v_mfma_f32_16x16x32_bf16 v[212:215], v[18:21], v[188:191], v[212:215]
    v_exp_f32 v197, v197
    v_mfma_f32_16x16x32_bf16 v[232:235], a[228:231], a[100:103], v[232:235]
    v_rcp_f32 v225, v224
    v_mfma_f32_16x16x32_bf16 v[232:235], a[232:235], a[104:107], v[232:235]
    v_max3_f32 v248, v248, v224, v225
    v_cvt_pk_bf16_f32 v182, v196, v197
    v_mfma_f32_16x16x32_bf16 v[232:235], a[236:239], a[108:111], v[232:235]
    s_waitcnt lgkmcnt(2)
    v_mul_f32 v212, v212, v225
    v_mul_f32 v213, v213, v225
    v_mfma_f32_16x16x32_bf16 v[232:235], a[240:243], a[112:115], v[232:235]
    v_mul_f32 v214, v214, v225
    v_mul_f32 v215, v215, v225
    v_mfma_f32_16x16x32_bf16 v[232:235], a[244:247], a[116:119], v[232:235]
    v_cvt_pk_bf16_f32 v212, v212, v213
    s_waitcnt lgkmcnt(0)
    v_mfma_f32_16x16x32_bf16 v[204:207], v[132:135], v[168:171], v[204:207]
    v_exp_f32 v198, v198
    v_mfma_f32_16x16x32_bf16 v[204:207], v[134:137], v[170:173], v[204:207]
    v_exp_f32 v199, v199
    v_mfma_f32_16x16x32_bf16 v[236:239], a[224:227], a[120:123], 0
    ds_read_b128 a[224:227], v242 offset:4736
    v_cvt_pk_bf16_f32 v48, v232, v233
    v_mfma_f32_16x16x32_bf16 v[236:239], a[228:231], a[124:127], v[236:239]
    ds_read_b128 a[228:231], v243 offset:4736
    v_cvt_pk_bf16_f32 v51, v234, v235
    v_mfma_f32_16x16x32_bf16 v[236:239], a[232:235], a[128:131], v[236:239]
    ds_read_b128 a[232:235], v242 offset:4864
    v_cvt_pk_bf16_f32 v213, v214, v215
    v_mfma_f32_16x16x32_bf16 v[216:219], v[48:51], v[188:191], v[216:219]
    ds_write_b64 v247, v[212:213] offset:12288
    v_mfma_f32_16x16x32_bf16 v[212:215], v[12:15], v[192:195], 0
    v_exp_f32 v204, v204
    v_mfma_f32_16x16x32_bf16 v[236:239], a[236:239], a[132:135], v[236:239]
    ds_read_b128 a[236:239], v243 offset:4864
    v_cvt_pk_bf16_f32 v185, v198, v199
    v_mfma_f32_16x16x32_bf16 v[236:239], a[240:243], a[136:139], v[236:239]
    ds_read_b128 a[240:243], v242 offset:1536
    v_mul_f32 v216, v216, v225
    v_mfma_f32_16x16x32_bf16 v[236:239], a[244:247], a[140:143], v[236:239]
    ds_read_b128 a[244:247], v243 offset:1536
    v_mul_f32 v217, v217, v225
    v_mfma_f32_16x16x32_bf16 v[228:231], a[144:147], a[216:219], 0
    v_mul_f32 v218, v218, v225
    v_mul_f32 v219, v219, v225
    v_mfma_f32_16x16x32_bf16 v[228:231], a[148:151], a[220:223], v[228:231]
    s_waitcnt lgkmcnt(6)
    v_cvt_pk_bf16_f32 v216, v216, v217
    v_cvt_pk_bf16_f32 v78, v236, v237
    v_mfma_f32_16x16x32_bf16 v[228:231], a[152:155], a[224:227], v[228:231]
    s_waitcnt lgkmcnt(5)
    v_cvt_pk_bf16_f32 v81, v238, v239
    v_cvt_pk_bf16_f32 v217, v218, v219
    v_mfma_f32_16x16x32_bf16 v[228:231], a[156:159], a[228:231], v[228:231]
    s_waitcnt lgkmcnt(4)
    v_exp_f32 v205, v205
    v_mfma_f32_16x16x32_bf16 v[220:223], v[78:81], v[188:191], v[220:223]
    ds_write_b64 v247, v[216:217] offset:12416
    v_mfma_f32_16x16x32_bf16 v[216:219], v[42:45], v[192:195], 0
    v_exp_f32 v206, v206
    v_mfma_f32_16x16x32_bf16 v[228:231], a[160:163], a[232:235], v[228:231]
    s_waitcnt lgkmcnt(3)
    v_exp_f32 v207, v207
    v_mfma_f32_16x16x32_bf16 v[228:231], a[164:167], a[236:239], v[228:231]
    v_cvt_pk_bf16_f32 v183, v204, v205
    v_mul_f32 v220, v220, v225
    v_mfma_f32_16x16x32_bf16 v[232:235], a[168:171], a[216:219], 0
    s_waitcnt lgkmcnt(2)
    v_mul_f32 v221, v221, v225
    v_mul_f32 v222, v222, v225
    v_mfma_f32_16x16x32_bf16 v[212:215], v[16:19], v[180:183], v[212:215]
    s_waitcnt lgkmcnt(1)
    v_mul_f32 v228, s38, v228
    v_mul_f32 v229, s38, v229
    v_mfma_f32_16x16x32_bf16 v[216:219], v[46:49], v[180:183], v[216:219]
    v_mul_f32 v230, s38, v230
    v_mul_f32 v231, s38, v231
    v_mfma_f32_16x16x32_bf16 v[232:235], a[172:175], a[220:223], v[232:235]
    v_cvt_pk_bf16_f32 v228, v228, v229
    v_cvt_pk_bf16_f32 v229, v230, v231
    v_mfma_f32_16x16x32_bf16 v[232:235], a[176:179], a[224:227], v[232:235]
    ds_write_b64 v247, v[228:229] offset:43008
    v_mfma_f32_16x16x32_bf16 v[232:235], a[180:183], a[228:231], v[232:235]
    v_mul_f32 v223, v223, v225
    v_cvt_pk_bf16_f32 v220, v220, v221
    v_mfma_f32_16x16x32_bf16 v[224:227], a[248:251], v[192:195], 0
    v_cvt_pk_bf16_f32 v221, v222, v223
    v_cvt_pk_bf16_f32 v186, v206, v207
    v_mfma_f32_16x16x32_bf16 v[224:227], a[248:251], v[180:183], v[224:227]
    ds_write_b64 v247, v[220:221] offset:12544
    v_mfma_f32_16x16x32_bf16 v[220:223], v[72:75], v[192:195], 0
    ds_read_b128 v[204:207], v245 offset:128
    ds_read_b128 v[196:199], v244 offset:32
    v_mfma_f32_16x16x32_bf16 v[220:223], v[76:79], v[180:183], v[220:223]
    v_exp_f32 v200, v200
    v_mfma_f32_16x16x32_bf16 v[212:215], v[20:23], v[184:187], v[212:215]
    v_exp_f32 v201, v201
    v_mfma_f32_16x16x32_bf16 v[216:219], v[50:53], v[184:187], v[216:219]
    v_cvt_pk_bf16_f32 v189, v200, v201
    v_mfma_f32_16x16x32_bf16 v[220:223], v[80:83], v[184:187], v[220:223]
    ds_read_b128 v[200:203], v245 offset:32
    v_mfma_f32_16x16x32_bf16 v[224:227], a[248:251], v[184:187], v[224:227]
    v_mfma_f32_16x16x32_bf16 v[232:235], a[184:187], a[232:235], v[232:235]
    v_mfma_f32_16x16x32_bf16 v[232:235], a[188:191], a[236:239], v[232:235]
    v_mfma_f32_16x16x32_bf16 v[236:239], a[192:195], a[216:219], 0
    ds_read_b128 a[216:219], v242 offset:1664
    v_mfma_f32_16x16x32_bf16 v[236:239], a[196:199], a[220:223], v[236:239]
    ds_read_b128 a[220:223], v243 offset:1664
    v_mfma_f32_16x16x32_bf16 v[236:239], a[200:203], a[224:227], v[236:239]
    ds_read_b128 a[224:227], v242 offset:1792
    v_add_u32 v242, 0x7800, v242
    v_mfma_f32_16x16x32_bf16 v[236:239], a[204:207], a[228:231], v[236:239]
    s_waitcnt lgkmcnt(4)
    v_mul_f32 v232, s3, v232
    v_mul_f32 v233, s3, v233
    v_mfma_f32_16x16x32_bf16 v[204:207], v[108:111], v[168:171], v[204:207]
    v_mul_f32 v234, s3, v234
    v_mul_f32 v235, s3, v235
    v_mfma_f32_16x16x32_bf16 v[204:207], v[110:113], v[170:173], v[204:207]
    ds_read_b128 a[228:231], v243 offset:1792
    v_cvt_pk_bf16_f32 v232, v232, v233
    v_mfma_f32_16x16x32_bf16 v[196:199], v[132:135], v[174:177], v[196:199]
    s_waitcnt lgkmcnt(4)
    v_cvt_pk_bf16_f32 v233, v234, v235
    v_add_u32 v243, 0x4200, v243
    v_mfma_f32_16x16x32_bf16 v[196:199], v[134:137], v[176:179], v[196:199]
    ds_write_b64 v247, v[232:233] offset:43136
    v_mfma_f32_16x16x32_bf16 v[200:203], v[102:105], v[174:177], v[200:203]
    v_cndmask_b32 v242, v242, v243, vcc
    s_mov_b32 vcc_lo, 0xf0f0f0f0
    v_mfma_f32_16x16x32_bf16 v[200:203], v[104:107], v[176:179], v[200:203]
    s_mov_b32 vcc_hi, 0xf0f0f0f0
    v_add_u32 v243, 0xfffe2000, v242
    v_cndmask_b32 v242, v242, v243, vcc
    v_mfma_f32_16x16x32_bf16 v[236:239], a[208:211], a[232:235], v[236:239]
    ds_read_b128 a[232:235], v242 offset:0
    v_xor_b32 v243, 64, v242
    v_mfma_f32_16x16x32_bf16 v[236:239], a[212:215], a[236:239], v[236:239]
    ds_read_b128 a[236:239], v243 offset:0
    s_mov_b32 vcc_lo, 0xcccccccc
    v_mfma_f32_16x16x32_bf16 v[228:231], a[144:147], a[240:243], 0
    s_mov_b32 vcc_hi, 0xcccccccc
    v_exp_f32 v204, v204
    v_mfma_f32_16x16x32_bf16 v[228:231], a[148:151], a[244:247], v[228:231]
    s_waitcnt lgkmcnt(6)
    v_exp_f32 v205, v205
    v_mfma_f32_16x16x32_bf16 v[228:231], a[152:155], a[216:219], v[228:231]
    s_waitcnt lgkmcnt(5)
    v_mul_f32 v236, s38, v236
    v_mul_f32 v237, s38, v237
    v_mfma_f32_16x16x32_bf16 v[228:231], a[156:159], a[220:223], v[228:231]
    s_waitcnt lgkmcnt(4)
    v_mul_f32 v238, s38, v238
    v_mul_f32 v239, s38, v239
    v_mfma_f32_16x16x32_bf16 v[228:231], a[160:163], a[224:227], v[228:231]
    s_waitcnt lgkmcnt(3)
    v_cvt_pk_bf16_f32 v236, v236, v237
    v_cvt_pk_bf16_f32 v237, v238, v239
    v_mfma_f32_16x16x32_bf16 v[228:231], a[164:167], a[228:231], v[228:231]
    ds_write_b64 v247, v[236:237] offset:43264
    v_mfma_f32_16x16x32_bf16 v[232:235], a[168:171], a[240:243], 0
    v_exp_f32 v196, v196
    v_mfma_f32_16x16x32_bf16 v[232:235], a[172:175], a[244:247], v[232:235]
    v_exp_f32 v197, v197
    v_mfma_f32_16x16x32_bf16 v[232:235], a[176:179], a[216:219], v[232:235]
    s_waitcnt lgkmcnt(2)
    v_cvt_pk_bf16_f32 v190, v204, v205
    v_mul_f32 v228, s38, v228
    v_mfma_f32_16x16x32_bf16 v[232:235], a[180:183], a[220:223], v[232:235]
    s_waitcnt lgkmcnt(1)
    v_mul_f32 v229, s38, v229
    v_mul_f32 v230, s38, v230
    v_mfma_f32_16x16x32_bf16 v[232:235], a[184:187], a[224:227], v[232:235]
    v_mul_f32 v231, s38, v231
    v_cvt_pk_bf16_f32 v228, v228, v229
    v_mfma_f32_16x16x32_bf16 v[232:235], a[188:191], a[228:231], v[232:235]
    ds_read_b128 v[204:207], v246 offset:32
    v_cvt_pk_bf16_f32 v229, v230, v231
    v_mfma_f32_16x16x32_bf16 v[236:239], a[192:195], a[240:243], 0
    ds_read_b128 a[240:243], v242 offset:128
    v_cvt_pk_bf16_f32 v193, v196, v197
    v_mfma_f32_16x16x32_bf16 v[236:239], a[196:199], a[244:247], v[236:239]
    ds_read_b128 a[244:247], v243 offset:128
    v_mfma_f32_16x16x32_bf16 v[236:239], a[200:203], a[216:219], v[236:239]
    ds_read_b128 a[216:219], v242 offset:256
    v_mul_f32 v232, s3, v232
    v_mfma_f32_16x16x32_bf16 v[236:239], a[204:207], a[220:223], v[236:239]
    ds_read_b128 a[220:223], v243 offset:256
    v_mul_f32 v233, s3, v233
    v_mfma_f32_16x16x32_bf16 v[236:239], a[208:211], a[224:227], v[236:239]
    ds_write_b64 v247, v[228:229] offset:30720
    v_mfma_f32_16x16x32_bf16 v[236:239], a[212:215], a[228:231], v[236:239]
    v_mul_f32 v234, s3, v234
    v_mul_f32 v235, s3, v235
    v_mfma_f32_16x16x32_bf16 v[228:231], a[144:147], a[232:235], 0
    ds_read_b128 a[224:227], v240 offset:36864
    v_cvt_pk_bf16_f32 v232, v232, v233
    v_mfma_f32_16x16x32_bf16 v[228:231], a[148:151], a[236:239], v[228:231]
    s_waitcnt lgkmcnt(6)
    v_cvt_pk_bf16_f32 v233, v234, v235
    v_mul_f32 v236, s38, v236
    v_mfma_f32_16x16x32_bf16 v[204:207], v[114:117], v[174:177], v[204:207]
    s_waitcnt lgkmcnt(5)
    ds_read_b128 a[228:231], v241 offset:36864
    v_mfma_f32_16x16x32_bf16 v[204:207], v[116:119], v[176:179], v[204:207]
    ds_write_b64 v247, v[232:233] offset:30848
    v_mfma_f32_16x16x32_bf16 v[228:231], a[152:155], a[240:243], v[228:231]
    s_waitcnt lgkmcnt(6)
    v_mul_f32 v237, s38, v237
    v_mul_f32 v238, s38, v238
    v_mfma_f32_16x16x32_bf16 v[228:231], a[156:159], a[244:247], v[228:231]
    s_waitcnt lgkmcnt(5)
    v_mul_f32 v239, s38, v239
    v_cvt_pk_bf16_f32 v236, v236, v237
    v_mfma_f32_16x16x32_bf16 v[228:231], a[160:163], a[216:219], v[228:231]
    s_waitcnt lgkmcnt(4)
    v_cvt_pk_bf16_f32 v237, v238, v239
    v_mfma_f32_16x16x32_bf16 v[228:231], a[164:167], a[220:223], v[228:231]
    ds_write_b64 v247, v[236:237] offset:30976
    v_mfma_f32_16x16x32_bf16 v[232:235], a[168:171], a[232:235], 0
    v_exp_f32 v198, v198
    v_mfma_f32_16x16x32_bf16 v[232:235], a[172:175], a[236:239], v[232:235]
    s_waitcnt lgkmcnt(3)
    v_exp_f32 v199, v199
    v_mfma_f32_16x16x32_bf16 v[232:235], a[176:179], a[240:243], v[232:235]
    v_exp_f32 v200, v200
    v_mfma_f32_16x16x32_bf16 v[232:235], a[180:183], a[244:247], v[232:235]
    v_mul_f32 v228, s38, v228
    v_mul_f32 v229, s38, v229
    v_mfma_f32_16x16x32_bf16 v[232:235], a[184:187], a[216:219], v[232:235]
    s_waitcnt lgkmcnt(2)
    v_mul_f32 v230, s38, v230
    v_mul_f32 v231, s38, v231
    v_mfma_f32_16x16x32_bf16 v[232:235], a[188:191], a[220:223], v[232:235]
    v_cvt_pk_bf16_f32 v228, v228, v229
    v_cvt_pk_bf16_f32 v229, v230, v231
    v_mfma_f32_16x16x32_bf16 v[236:239], a[192:195], a[232:235], 0
    ds_read_b128 a[232:235], v240 offset:36992
    v_cvt_pk_bf16_f32 v180, v198, v199
    v_mfma_f32_16x16x32_bf16 v[236:239], a[196:199], a[236:239], v[236:239]
    ds_read_b128 a[236:239], v241 offset:36992
    ds_read_b128 v[196:199], v245 offset:96
    v_mfma_f32_16x16x32_bf16 v[236:239], a[200:203], a[240:243], v[236:239]
    ds_read_b128 a[240:243], v240 offset:37120
    v_mul_f32 v232, s3, v232
    v_mfma_f32_16x16x32_bf16 v[236:239], a[204:207], a[244:247], v[236:239]
    ds_read_b128 a[244:247], v241 offset:37120
    v_mul_f32 v233, s3, v233
    v_mfma_f32_16x16x32_bf16 v[236:239], a[208:211], a[216:219], v[236:239]
    ds_write_b64 v247, v[228:229] offset:49152
    v_mfma_f32_16x16x32_bf16 v[236:239], a[212:215], a[220:223], v[236:239]
    v_mul_f32 v234, s3, v234
    v_mul_f32 v235, s3, v235
    v_mfma_f32_16x16x32_bf16 v[228:231], a[0:3], a[224:227], 0
    ds_read_b128 a[216:219], v242 offset:3072
    v_cvt_pk_bf16_f32 v232, v232, v233
    v_mfma_f32_16x16x32_bf16 v[228:231], a[4:7], a[228:231], v[228:231]
    ds_read_b128 a[220:223], v243 offset:3072
    v_cvt_pk_bf16_f32 v233, v234, v235
    s_waitcnt lgkmcnt(7)
    v_mfma_f32_16x16x32_bf16 v[228:231], a[8:11], a[232:235], v[228:231]
    ds_write_b64 v247, v[232:233] offset:49280
    v_mfma_f32_16x16x32_bf16 v[232:235], a[24:27], a[224:227], 0
    s_waitcnt lgkmcnt(7)
    v_mul_f32 v236, s38, v236
    v_mul_f32 v237, s38, v237
    v_mfma_f32_16x16x32_bf16 v[228:231], a[12:15], a[236:239], v[228:231]
    v_mul_f32 v238, s38, v238
    s_waitcnt lgkmcnt(5)
    v_mfma_f32_16x16x32_bf16 v[196:199], v[108:111], v[174:177], v[196:199]
    v_mul_f32 v239, s38, v239
    v_cvt_pk_bf16_f32 v236, v236, v237
    v_mfma_f32_16x16x32_bf16 v[196:199], v[110:113], v[176:179], v[196:199]
    v_cvt_pk_bf16_f32 v237, v238, v239
    v_add_u32 v240, 0xffff1000, v240
    v_mfma_f32_16x16x32_bf16 v[228:231], a[16:19], a[240:243], v[228:231]
    s_waitcnt lgkmcnt(4)
    v_exp_f32 v201, v201
    v_mfma_f32_16x16x32_bf16 v[228:231], a[20:23], a[244:247], v[228:231]
    ds_write_b64 v247, v[236:237] offset:49408
    v_mfma_f32_16x16x32_bf16 v[232:235], a[28:31], a[228:231], v[232:235]
    s_waitcnt lgkmcnt(3)
    v_add_u32 v241, 0xffff1000, v241
    v_cvt_pk_bf16_f32 v194, v200, v201
    v_mfma_f32_16x16x32_bf16 v[232:235], a[32:35], a[232:235], v[232:235]
    s_waitcnt lgkmcnt(2)
    v_exp_f32 v202, v202
    v_mfma_f32_16x16x32_bf16 v[232:235], a[36:39], a[236:239], v[232:235]
    v_cvt_pk_bf16_f32 v120, v228, v229
    v_cvt_pk_bf16_f32 v121, v230, v231
    v_mfma_f32_16x16x32_bf16 v[232:235], a[40:43], a[240:243], v[232:235]
    v_exp_f32 v203, v203
    v_mfma_f32_16x16x32_bf16 v[232:235], a[44:47], a[244:247], v[232:235]
    v_exp_f32 v204, v204
    v_mfma_f32_16x16x32_bf16 v[236:239], a[48:51], a[224:227], 0
    v_exp_f32 v205, v205
    v_mfma_f32_16x16x32_bf16 v[236:239], a[52:55], a[228:231], v[236:239]
    v_cvt_pk_bf16_f32 v181, v202, v203
    v_cvt_pk_bf16_f32 v192, v204, v205
    v_mfma_f32_16x16x32_bf16 v[236:239], a[56:59], a[232:235], v[236:239]
    ds_read_b128 v[200:203], v246 offset:96
    v_cvt_pk_bf16_f32 v122, v232, v233
    v_mfma_f32_16x16x32_bf16 v[236:239], a[60:63], a[236:239], v[236:239]
    v_cvt_pk_bf16_f32 v123, v234, v235
    v_mfma_f32_16x16x32_bf16 v[236:239], a[64:67], a[240:243], v[236:239]
    v_exp_f32 v206, v206
    v_mfma_f32_16x16x32_bf16 v[208:211], v[120:123], v[168:171], v[208:211]
    v_exp_f32 v207, v207
    v_mfma_f32_16x16x32_bf16 v[236:239], a[68:71], a[244:247], v[236:239]
    ds_read_b64 v[168:169], v247 offset:24576
    v_cvt_pk_bf16_f32 v195, v206, v207
    v_mfma_f32_16x16x32_bf16 v[228:231], a[224:227], a[72:75], 0
    ds_read_b128 v[204:207], v244 offset:192
    v_mfma_f32_16x16x32_bf16 v[228:231], a[228:231], a[76:79], v[228:231]
L_h6:
    s_cbranch_execz L_hback
    v_exp_f32 v196, v196
    v_mfma_f32_16x16x32_bf16 v[228:231], a[232:235], a[80:83], v[228:231]
    v_exp_f32 v197, v197
    v_mfma_f32_16x16x32_bf16 v[228:231], a[236:239], a[84:87], v[228:231]
    v_cvt_pk_bf16_f32 v124, v236, v237
    v_cvt_pk_bf16_f32 v125, v238, v239
    v_mfma_f32_16x16x32_bf16 v[228:231], a[240:243], a[88:91], v[228:231]
    v_exp_f32 v198, v198
    v_mfma_f32_16x16x32_bf16 v[208:211], v[122:125], v[170:173], v[208:211]
    ds_read_b64 v[170:171], v247 offset:24704
    v_cvt_pk_bf16_f32 v184, v196, v197
    v_mfma_f32_16x16x32_bf16 v[228:231], a[244:247], a[92:95], v[228:231]
    ds_read_b64 v[172:173], v247 offset:24832
    v_mfma_f32_16x16x32_bf16 v[232:235], a[224:227], a[96:99], 0
    s_waitcnt lgkmcnt(4)
    v_exp_f32 v199, v199
    v_mfma_f32_16x16x32_bf16 v[200:203], v[120:123], v[174:177], v[200:203]
    v_exp_f32 v208, v208
    v_mfma_f32_16x16x32_bf16 v[200:203], v[122:125], v[176:179], v[200:203]
    s_waitcnt lgkmcnt(3)
    v_cvt_pk_bf16_f32 v24, v228, v229
    v_mbcnt_lo_u32_b32 v228, -1, 0
    v_mfma_f32_16x16x32_bf16 v[232:235], a[228:231], a[100:103], v[232:235]
    s_waitcnt lgkmcnt(2)
    v_mbcnt_hi_u32_b32 v228, -1, v228
    v_lshrrev_b32 v229, 1, v228
    v_mfma_f32_16x16x32_bf16 v[232:235], a[232:235], a[104:107], v[232:235]
    v_cvt_pk_bf16_f32 v27, v230, v231
    v_add_u32 v229, 64, v229
    v_mfma_f32_16x16x32_bf16 v[232:235], a[236:239], a[108:111], v[232:235]
    v_mul_u32_u24 v230, 43, v229
    v_lshrrev_b32 v231, 8, v230
    v_mfma_f32_16x16x32_bf16 v[232:235], a[240:243], a[112:115], v[232:235]
    v_lshrrev_b32 v230, 7, v230
    v_mad_i32_i24 v229, v230, -3, v229
    v_mfma_f32_16x16x32_bf16 v[232:235], a[244:247], a[116:119], v[232:235]
    v_and_b32 v231, 4, v231
    v_xor_b32 v230, v230, v231
    v_mfma_f32_16x16x32_bf16 v[236:239], a[224:227], a[120:123], 0
    ds_read_b128 a[224:227], v242 offset:3200
    v_and_b32 v231, 4, v230
    v_mfma_f32_16x16x32_bf16 v[236:239], a[228:231], a[124:127], v[236:239]
    ds_read_b128 a[228:231], v243 offset:3200
    v_mul_u32_u24 v251, 24, v231
    v_mfma_f32_16x16x32_bf16 v[236:239], a[232:235], a[128:131], v[236:239]
    ds_read_b128 a[232:235], v242 offset:3328
    v_cvt_pk_bf16_f32 v54, v232, v233
    v_mfma_f32_16x16x32_bf16 v[236:239], a[236:239], a[132:135], v[236:239]
    ds_read_b128 a[236:239], v243 offset:3328
    v_cvt_pk_bf16_f32 v57, v234, v235
    v_mfma_f32_16x16x32_bf16 v[236:239], a[240:243], a[136:139], v[236:239]
    ds_read_b128 a[240:243], v240 offset:1536
    v_lshrrev_b32 v231, 3, v230
    v_mfma_f32_16x16x32_bf16 v[236:239], a[244:247], a[140:143], v[236:239]
    ds_read_b128 a[244:247], v241 offset:1536
    v_lshl_add_u32 v251, v231, 2, v251
    v_mfma_f32_16x16x32_bf16 v[232:235], a[144:147], a[216:219], 0
    s_waitcnt lgkmcnt(6)
    v_and_or_b32 v251, v230, 3, v251
    v_mad_u32_u24 v251, v251, 3, v229
    v_mfma_f32_16x16x32_bf16 v[204:207], v[150:153], v[168:171], v[204:207]
    v_and_b32 v231, 1, v228
    v_lshl_add_u32 v251, v251, 3, v231
    v_mfma_f32_16x16x32_bf16 v[204:207], v[152:155], v[170:173], v[204:207]
    v_cvt_pk_bf16_f32 v84, v236, v237
    v_cvt_pk_bf16_f32 v87, v238, v239
    v_mfma_f32_16x16x32_bf16 v[232:235], a[148:151], a[220:223], v[232:235]
    s_waitcnt lgkmcnt(5)
    v_exp_f32 v209, v209
    v_mfma_f32_16x16x32_bf16 v[232:235], a[152:155], a[224:227], v[232:235]
    s_waitcnt lgkmcnt(4)
    v_cvt_pk_bf16_f32 v188, v208, v209
    v_lshlrev_b32 v251, 4, v251
    v_mfma_f32_16x16x32_bf16 v[232:235], a[156:159], a[228:231], v[232:235]
    ds_read_b128 v[208:211], v244 offset:96
    s_waitcnt lgkmcnt(3)
    v_mfma_f32_16x16x32_bf16 v[212:215], v[24:27], v[188:191], v[212:215]
    s_barrier
    v_mfma_f32_16x16x32_bf16 v[216:219], v[54:57], v[188:191], v[216:219]
    buffer_load_dwordx4 v252, s[12:15], s62 offen lds
    v_add_u32 v251, 0xfffff800, v251
    v_mfma_f32_16x16x32_bf16 v[220:223], v[84:87], v[188:191], v[220:223]
    s_waitcnt lgkmcnt(1)
    v_exp_f32 v200, v200
    v_mfma_f32_16x16x32_bf16 v[224:227], a[248:251], v[188:191], v[224:227]
    v_exp_f32 v201, v201
    v_mfma_f32_16x16x32_bf16 v[232:235], a[160:163], a[232:235], v[232:235]
    v_cvt_pk_bf16_f32 v187, v198, v199
    v_cvt_pk_bf16_f32 v182, v200, v201
    v_mfma_f32_16x16x32_bf16 v[232:235], a[164:167], a[236:239], v[232:235]
    buffer_load_dwordx4 v253, s[12:15], s62 offen offset:1024 lds
    ds_read_b128 v[196:199], v246 offset:192
    v_mfma_f32_16x16x32_bf16 v[236:239], a[168:171], a[216:219], 0
    s_waitcnt lgkmcnt(1)
    v_rcp_f32 v225, v224
    v_mfma_f32_16x16x32_bf16 v[208:211], v[144:147], v[174:177], v[208:211]
    v_mul_f32 v212, v212, v225
    v_mul_f32 v213, v213, v225
    v_mfma_f32_16x16x32_bf16 v[208:211], v[146:149], v[176:179], v[208:211]
    v_mul_f32 v232, s38, v232
    v_mul_f32 v233, s38, v233
    v_mfma_f32_16x16x32_bf16 v[236:239], a[172:175], a[220:223], v[236:239]
    buffer_load_dwordx4 v251, s[12:15], s62 offen offset:2048 lds
    s_add_u32 m0, s46, 0x17400
    v_mfma_f32_16x16x32_bf16 v[236:239], a[176:179], a[224:227], v[236:239]
    s_lshl_b32 s62, s28, 5
    v_mul_f32 v234, s38, v234
    v_mul_f32 v235, s38, v235
    v_mfma_f32_16x16x32_bf16 v[236:239], a[180:183], a[228:231], v[236:239]
    s_add_u32 s62, s62, 0x3000
    v_cvt_pk_bf16_f32 v232, v232, v233
    v_cvt_pk_bf16_f32 v233, v234, v235
    v_mfma_f32_16x16x32_bf16 v[236:239], a[184:187], a[232:235], v[236:239]
    ds_write_b64 v247, v[232:233] offset:55296
    v_mfma_f32_16x16x32_bf16 v[236:239], a[188:191], a[236:239], v[236:239]
    buffer_load_dwordx4 v252, s[12:15], s63 offen lds
    v_mul_f32 v214, v214, v225
    v_mfma_f32_16x16x32_bf16 v[228:231], a[192:195], a[216:219], 0
    ds_read_b128 a[216:219], v240 offset:1664
    v_mul_f32 v215, v215, v225
    v_mfma_f32_16x16x32_bf16 v[228:231], a[196:199], a[220:223], v[228:231]
    ds_read_b128 a[220:223], v241 offset:1664
    v_cvt_pk_bf16_f32 v212, v212, v213
    v_mfma_f32_16x16x32_bf16 v[228:231], a[200:203], a[224:227], v[228:231]
    ds_read_b128 a[224:227], v240 offset:1792
    v_mul_f32 v236, s3, v236
    v_mfma_f32_16x16x32_bf16 v[228:231], a[204:207], a[228:231], v[228:231]
    buffer_load_dwordx4 v253, s[12:15], s63 offen offset:1024 lds
    v_mul_f32 v237, s3, v237
    v_mfma_f32_16x16x32_bf16 v[228:231], a[208:211], a[232:235], v[228:231]
    s_waitcnt lgkmcnt(4)
    v_mul_f32 v238, s3, v238
    v_mul_f32 v239, s3, v239
    v_mfma_f32_16x16x32_bf16 v[228:231], a[212:215], a[236:239], v[228:231]
    ds_read_b128 a[228:231], v241 offset:1792
    v_cvt_pk_bf16_f32 v236, v236, v237
    v_mfma_f32_16x16x32_bf16 v[232:235], a[0:3], a[240:243], 0
    ds_read_b128 a[232:235], v240 offset:0
    v_cvt_pk_bf16_f32 v237, v238, v239
    v_mfma_f32_16x16x32_bf16 v[232:235], a[4:7], a[244:247], v[232:235]
    buffer_load_dwordx4 v251, s[12:15], s63 offen offset:2048 lds
    ds_write_b64 v247, v[236:237] offset:55424
    v_mfma_f32_16x16x32_bf16 v[236:239], a[24:27], a[240:243], 0
    s_waitcnt lgkmcnt(5)
    v_mul_f32 v228, s38, v228
    v_mul_f32 v229, s38, v229
    v_mfma_f32_16x16x32_bf16 v[232:235], a[8:11], a[216:219], v[232:235]
    s_waitcnt lgkmcnt(4)
    v_mul_f32 v230, s38, v230
    v_mul_f32 v231, s38, v231
    v_mfma_f32_16x16x32_bf16 v[232:235], a[12:15], a[220:223], v[232:235]
    s_waitcnt lgkmcnt(3)
    v_cvt_pk_bf16_f32 v228, v228, v229
    v_cvt_pk_bf16_f32 v229, v230, v231
    v_mfma_f32_16x16x32_bf16 v[232:235], a[16:19], a[224:227], v[232:235]
    ds_write_b64 v247, v[228:229] offset:55552
    v_mfma_f32_16x16x32_bf16 v[236:239], a[28:31], a[244:247], v[236:239]
    ds_read_b128 a[236:239], v241 offset:0
    s_waitcnt lgkmcnt(4)
    v_mfma_f32_16x16x32_bf16 v[232:235], a[20:23], a[228:231], v[232:235]
    s_add_u32 m0, s46, 0x16800
    v_cvt_pk_bf16_f32 v213, v214, v215
    v_mul_f32 v216, v216, v225
    v_mfma_f32_16x16x32_bf16 v[236:239], a[32:35], a[216:219], v[236:239]
    ds_write_b64 v247, v[212:213] offset:18432
    v_mfma_f32_16x16x32_bf16 v[212:215], v[18:21], v[192:195], 0
    s_lshl_b32 s63, s28, 5
    v_mul_f32 v217, v217, v225
    v_cvt_pk_bf16_f32 v126, v232, v233
    v_mfma_f32_16x16x32_bf16 v[236:239], a[36:39], a[220:223], v[236:239]
    s_add_u32 s63, s63, 0x7800
    v_cvt_pk_bf16_f32 v127, v234, v235
    v_mul_f32 v218, v218, v225
    v_mfma_f32_16x16x32_bf16 v[236:239], a[40:43], a[224:227], v[236:239]
    s_waitcnt lgkmcnt(3)
    v_mul_f32 v219, v219, v225
    v_cvt_pk_bf16_f32 v216, v216, v217
    v_mfma_f32_16x16x32_bf16 v[236:239], a[44:47], a[228:231], v[236:239]
    v_cvt_pk_bf16_f32 v217, v218, v219
    v_mul_f32 v220, v220, v225
    v_mfma_f32_16x16x32_bf16 v[228:231], a[48:51], a[240:243], 0
    ds_write_b64 v247, v[216:217] offset:18560
    v_mfma_f32_16x16x32_bf16 v[216:219], v[48:51], v[192:195], 0
    v_mul_f32 v221, v221, v225
    v_mul_f32 v222, v222, v225
    v_mfma_f32_16x16x32_bf16 v[228:231], a[52:55], a[244:247], v[228:231]
    s_waitcnt lgkmcnt(2)
    v_cvt_pk_bf16_f32 v128, v236, v237
    v_cvt_pk_bf16_f32 v129, v238, v239
    v_mfma_f32_16x16x32_bf16 v[228:231], a[56:59], a[216:219], v[228:231]
    v_mul_f32 v223, v223, v225
    v_cvt_pk_bf16_f32 v220, v220, v221
    v_mfma_f32_16x16x32_bf16 v[228:231], a[60:63], a[220:223], v[228:231]
    v_cvt_pk_bf16_f32 v221, v222, v223
    v_max3_f32 v248, v248, v224, v225
    v_mfma_f32_16x16x32_bf16 v[224:227], a[248:251], v[192:195], 0
    ds_write_b64 v247, v[220:221] offset:18688
    v_mfma_f32_16x16x32_bf16 v[220:223], v[78:81], v[192:195], 0
    v_exp_f32 v208, v208
    v_mfma_f32_16x16x32_bf16 v[228:231], a[64:67], a[224:227], v[228:231]
    v_exp_f32 v209, v209
    v_mfma_f32_16x16x32_bf16 v[228:231], a[68:71], a[228:231], v[228:231]
    v_exp_f32 v210, v210
    v_mfma_f32_16x16x32_bf16 v[232:235], a[240:243], a[72:75], 0
    v_exp_f32 v211, v211
    v_mfma_f32_16x16x32_bf16 v[232:235], a[244:247], a[76:79], v[232:235]
    v_cvt_pk_bf16_f32 v183, v208, v209
    v_cvt_pk_bf16_f32 v186, v210, v211
    v_mfma_f32_16x16x32_bf16 v[232:235], a[216:219], a[80:83], v[232:235]
    ds_read_b128 v[208:211], v245 offset:192
    v_cvt_pk_bf16_f32 v130, v228, v229
    v_mfma_f32_16x16x32_bf16 v[212:215], v[22:25], v[180:183], v[212:215]
    ds_read_b64 v[174:175], v247 offset:30720
    v_cvt_pk_bf16_f32 v131, v230, v231
    v_mfma_f32_16x16x32_bf16 v[216:219], v[52:55], v[180:183], v[216:219]
    v_exp_f32 v202, v202
    v_mfma_f32_16x16x32_bf16 v[220:223], v[82:85], v[180:183], v[220:223]
    v_exp_f32 v203, v203
    v_mfma_f32_16x16x32_bf16 v[224:227], a[248:251], v[180:183], v[224:227]
    ds_read_b64 v[176:177], v247 offset:30848
    v_cvt_pk_bf16_f32 v185, v202, v203
    v_mfma_f32_16x16x32_bf16 v[232:235], a[220:223], a[84:87], v[232:235]
    ds_read_b128 v[200:203], v244 offset:256
    ds_read_b64 v[178:179], v247 offset:30976
    v_mfma_f32_16x16x32_bf16 v[212:215], v[26:29], v[184:187], v[212:215]
    v_exp_f32 v204, v204
    v_mfma_f32_16x16x32_bf16 v[216:219], v[56:59], v[184:187], v[216:219]
    v_exp_f32 v205, v205
    v_mfma_f32_16x16x32_bf16 v[220:223], v[86:89], v[184:187], v[220:223]
    v_exp_f32 v206, v206
    v_mfma_f32_16x16x32_bf16 v[224:227], a[248:251], v[184:187], v[224:227]
    v_exp_f32 v207, v207
    v_mfma_f32_16x16x32_bf16 v[232:235], a[224:227], a[88:91], v[232:235]
    s_waitcnt lgkmcnt(4)
    v_cvt_pk_bf16_f32 v190, v204, v205
    v_cvt_pk_bf16_f32 v193, v206, v207
    v_mfma_f32_16x16x32_bf16 v[208:211], v[96:99], v[168:171], v[208:211]
    ds_read_b128 v[204:207], v245 offset:256
    v_mov_b32 v187, 0
    v_mfma_f32_16x16x32_bf16 v[208:211], v[98:101], v[170:173], v[208:211]
    s_waitcnt lgkmcnt(4)
    v_rcp_f32 v225, v224
    v_mfma_f32_16x16x32_bf16 v[232:235], a[228:231], a[92:95], v[232:235]
    v_mul_f32 v212, v212, v225
    s_waitcnt vmcnt(3)
    v_mfma_f32_16x16x32_bf16 v[236:239], a[240:243], a[96:99], 0
    ds_read_b64_tr_b16 a[144:145], v249 offset:0
    ds_read_b64_tr_b16 a[146:147], v250 offset:0
    v_mfma_f32_16x16x32_bf16 v[236:239], a[244:247], a[100:103], v[236:239]
    ds_read_b64_tr_b16 a[168:169], v249 offset:32
    ds_read_b64_tr_b16 a[170:171], v250 offset:32
    v_mfma_f32_16x16x32_bf16 v[236:239], a[216:219], a[104:107], v[236:239]
    s_waitcnt lgkmcnt(5)
    v_cvt_pk_bf16_f32 v7, v232, v233
    v_cvt_pk_bf16_f32 v10, v234, v235
    v_mfma_f32_16x16x32_bf16 v[200:203], v[156:159], v[168:171], v[200:203]
    ds_read_b64_tr_b16 a[192:193], v249 offset:64
    ds_read_b64_tr_b16 a[194:195], v250 offset:64
    v_mfma_f32_16x16x32_bf16 v[200:203], v[158:161], v[170:173], v[200:203]
    v_exp_f32 v208, v208
    v_mfma_f32_16x16x32_bf16 v[236:239], a[220:223], a[108:111], v[236:239]
    v_exp_f32 v209, v209
    v_mfma_f32_16x16x32_bf16 v[236:239], a[224:227], a[112:115], v[236:239]
    s_waitcnt lgkmcnt(6)
    v_exp_f32 v210, v210
    v_mfma_f32_16x16x32_bf16 v[204:207], v[90:93], v[168:171], v[204:207]
    v_exp_f32 v211, v211
    v_mfma_f32_16x16x32_bf16 v[204:207], v[92:95], v[170:173], v[204:207]
    v_cvt_pk_bf16_f32 v188, v208, v209
    v_cvt_pk_bf16_f32 v191, v210, v211
    v_mfma_f32_16x16x32_bf16 v[236:239], a[228:231], a[116:119], v[236:239]
    ds_read_b128 v[208:211], v246 offset:256
    v_mul_f32 v213, v213, v225
    v_mfma_f32_16x16x32_bf16 v[228:231], a[240:243], a[120:123], 0
    ds_read_b128 a[240:243], v240 offset:128
    v_mov_b32 v226, 0x22e00
    v_mfma_f32_16x16x32_bf16 v[228:231], a[244:247], a[124:127], v[228:231]
    ds_read_b128 a[244:247], v241 offset:128
    s_waitcnt lgkmcnt(3)
    v_mfma_f32_16x16x32_bf16 v[228:231], a[216:219], a[128:131], v[228:231]
    ds_read_b128 a[216:219], v240 offset:256
    v_cvt_pk_bf16_f32 v37, v236, v237
    v_mfma_f32_16x16x32_bf16 v[228:231], a[220:223], a[132:135], v[228:231]
    ds_read_b128 a[220:223], v241 offset:256
    v_cvt_pk_bf16_f32 v40, v238, v239
    v_mfma_f32_16x16x32_bf16 v[228:231], a[224:227], a[136:139], v[228:231]
    buffer_load_dwordx4 v252, s[12:15], s60 offen lds
    s_waitcnt vmcnt(1)
    v_mfma_f32_16x16x32_bf16 v[228:231], a[228:231], a[140:143], v[228:231]
    ds_read_b64_tr_b16 a[148:149], v249 offset:3072
    ds_read_b64_tr_b16 a[150:151], v250 offset:3072
    v_mfma_f32_16x16x32_bf16 v[232:235], a[0:3], a[232:235], 0
    ds_read_b64_tr_b16 a[172:173], v249 offset:3104
    ds_read_b64_tr_b16 a[174:175], v250 offset:3104
    v_mfma_f32_16x16x32_bf16 v[232:235], a[4:7], a[236:239], v[232:235]
    ds_read_b64_tr_b16 a[196:197], v249 offset:3136
    ds_read_b64_tr_b16 a[198:199], v250 offset:3136
    v_mfma_f32_16x16x32_bf16 v[236:239], a[24:27], a[232:235], 0
    s_waitcnt lgkmcnt(9)
    buffer_load_dwordx4 v253, s[12:15], s60 offen offset:1024 lds
    v_mfma_f32_16x16x32_bf16 v[208:211], v[126:129], v[168:171], v[208:211]
    v_cvt_pk_bf16_f32 v67, v228, v229
    v_cvt_pk_bf16_f32 v70, v230, v231
    v_mfma_f32_16x16x32_bf16 v[208:211], v[128:131], v[170:173], v[208:211]
    ds_read_b128 a[224:227], v240 offset:3072
    v_mul_f32 v214, v214, v225
    v_mfma_f32_16x16x32_bf16 v[232:235], a[8:11], a[240:243], v[232:235]
    s_waitcnt lgkmcnt(9)
    v_mul_f32 v215, v215, v225
    v_cvt_pk_bf16_f32 v212, v212, v213
    v_mfma_f32_16x16x32_bf16 v[232:235], a[12:15], a[244:247], v[232:235]
    s_waitcnt lgkmcnt(8)
    buffer_load_dwordx4 v251, s[12:15], s60 offen offset:2048 lds
    v_mfma_f32_16x16x32_bf16 v[232:235], a[16:19], a[216:219], v[232:235]
    s_waitcnt lgkmcnt(7)
    s_add_u32 m0, s46, 0x17400
    v_cndmask_b32 v226, v226, v247, vcc
    v_mfma_f32_16x16x32_bf16 v[232:235], a[20:23], a[220:223], v[232:235]
    ds_read_b128 a[228:231], v241 offset:3072
    v_cvt_pk_bf16_f32 v213, v214, v215
    v_mfma_f32_16x16x32_bf16 v[236:239], a[28:31], a[236:239], v[236:239]
    ds_write_b64 v226, v[212:213] offset:0
    v_mfma_f32_16x16x32_bf16 v[236:239], a[32:35], a[240:243], v[236:239]
    s_waitcnt lgkmcnt(3)
    buffer_load_dwordx4 v252, s[12:15], s61 offen lds
    v_mfma_f32_16x16x32_bf16 v[236:239], a[36:39], a[244:247], v[236:239]
    s_mov_b32 vcc_lo, 0xff00fff0
    v_cvt_pk_bf16_f32 v132, v232, v233
    v_cvt_pk_bf16_f32 v133, v234, v235
    v_mfma_f32_16x16x32_bf16 v[236:239], a[40:43], a[216:219], v[236:239]
    s_mov_b32 vcc_hi, 0xf000
    v_mul_f32 v216, v216, v225
    v_mul_f32 v217, v217, v225
    v_mfma_f32_16x16x32_bf16 v[236:239], a[44:47], a[220:223], v[236:239]
    v_mul_f32 v218, v218, v225
    v_mul_f32 v219, v219, v225
    v_mfma_f32_16x16x32_bf16 v[228:231], a[48:51], a[232:235], 0
    buffer_load_dwordx4 v253, s[12:15], s61 offen offset:1024 lds
    v_cvt_pk_bf16_f32 v216, v216, v217
    v_mfma_f32_16x16x32_bf16 v[228:231], a[52:55], a[236:239], v[228:231]
    s_waitcnt lgkmcnt(2)
    v_cvt_pk_bf16_f32 v217, v218, v219
    v_cvt_pk_bf16_f32 v134, v236, v237
    v_mfma_f32_16x16x32_bf16 v[228:231], a[56:59], a[240:243], v[228:231]
    v_cvt_pk_bf16_f32 v135, v238, v239
    v_mul_f32 v220, v220, v225
    v_mfma_f32_16x16x32_bf16 v[228:231], a[60:63], a[244:247], v[228:231]
    ds_write_b64 v226, v[216:217] offset:128
    v_mfma_f32_16x16x32_bf16 v[196:199], v[132:135], v[168:171], v[196:199]
    buffer_load_dwordx4 v251, s[12:15], s61 offen offset:2048 lds
    v_mul_f32 v221, v221, v225
    v_mfma_f32_16x16x32_bf16 v[228:231], a[64:67], a[216:219], v[228:231]
    s_add_u32 m0, s46, 0x16800
    v_mul_f32 v222, v222, v225
    v_mul_f32 v223, v223, v225
    v_mfma_f32_16x16x32_bf16 v[228:231], a[68:71], a[220:223], v[228:231]
    s_waitcnt lgkmcnt(1)
    v_cvt_pk_bf16_f32 v220, v220, v221
    v_cvt_pk_bf16_f32 v221, v222, v223
    v_mfma_f32_16x16x32_bf16 v[232:235], a[232:235], a[72:75], 0
    ds_write_b64 v226, v[220:221] offset:256
    v_mfma_f32_16x16x32_bf16 v[232:235], a[236:239], a[76:79], v[232:235]
    v_exp_f32 v200, v200
    v_mfma_f32_16x16x32_bf16 v[232:235], a[240:243], a[80:83], v[232:235]
    v_cvt_pk_bf16_f32 v136, v228, v229
    v_cvt_pk_bf16_f32 v137, v230, v231
    v_mfma_f32_16x16x32_bf16 v[232:235], a[244:247], a[84:87], v[232:235]
    v_exp_f32 v201, v201
    v_mfma_f32_16x16x32_bf16 v[196:199], v[134:137], v[170:173], v[196:199]
    v_max3_f32 v248, v248, v224, v225
    v_cvt_pk_bf16_f32 v180, v200, v201
    v_mfma_f32_16x16x32_bf16 v[232:235], a[216:219], a[88:91], v[232:235]
    v_exp_f32 v202, v202
    v_mfma_f32_16x16x32_bf16 v[232:235], a[220:223], a[92:95], v[232:235]
    v_exp_f32 v203, v203
    v_mfma_f32_16x16x32_bf16 v[236:239], a[232:235], a[96:99], 0
    v_exp_f32 v204, v204
    v_mfma_f32_16x16x32_bf16 v[236:239], a[236:239], a[100:103], v[236:239]
    v_exp_f32 v196, v196
    v_mfma_f32_16x16x32_bf16 v[236:239], a[240:243], a[104:107], v[236:239]
    v_exp_f32 v197, v197
    v_mfma_f32_16x16x32_bf16 v[236:239], a[244:247], a[108:111], v[236:239]
    v_cvt_pk_bf16_f32 v1, v232, v233
    v_cvt_pk_bf16_f32 v4, v234, v235
    v_mfma_f32_16x16x32_bf16 v[236:239], a[216:219], a[112:115], v[236:239]
    v_cvt_pk_bf16_f32 v189, v196, v197
    v_cvt_pk_bf16_f32 v183, v202, v203
    v_mfma_f32_16x16x32_bf16 v[236:239], a[220:223], a[116:119], v[236:239]
    v_exp_f32 v198, v198
    v_mfma_f32_16x16x32_bf16 v[212:215], v[0:3], v[188:191], 0
    v_exp_f32 v199, v199
    v_mfma_f32_16x16x32_bf16 v[224:227], a[248:251], v[188:191], 0
    ds_read_b128 v[200:203], v245 offset:320
    v_cvt_pk_bf16_f32 v192, v198, v199
    v_mfma_f32_16x16x32_bf16 v[228:231], a[232:235], a[120:123], 0
    ds_read_b128 a[232:235], v240 offset:3200
    v_cvt_pk_bf16_f32 v31, v236, v237
    v_mfma_f32_16x16x32_bf16 v[228:231], a[236:239], a[124:127], v[228:231]
    ds_read_b128 a[236:239], v241 offset:3200
    v_cvt_pk_bf16_f32 v34, v238, v239
    v_mfma_f32_16x16x32_bf16 v[216:219], v[30:33], v[188:191], 0
    ds_read_b128 v[196:199], v244 offset:320
    v_mfma_f32_16x16x32_bf16 v[228:231], a[240:243], a[128:131], v[228:231]
    ds_read_b128 a[240:243], v240 offset:3328
    v_mfma_f32_16x16x32_bf16 v[228:231], a[244:247], a[132:135], v[228:231]
    ds_read_b128 a[244:247], v241 offset:3328
    v_mfma_f32_16x16x32_bf16 v[228:231], a[216:219], a[136:139], v[228:231]
    ds_read_b128 a[216:219], v240 offset:4608
    v_mfma_f32_16x16x32_bf16 v[228:231], a[220:223], a[140:143], v[228:231]
    ds_read_b128 a[220:223], v241 offset:4608
    v_mfma_f32_16x16x32_bf16 v[232:235], a[0:3], a[224:227], 0
    v_exp_f32 v205, v205
    v_mfma_f32_16x16x32_bf16 v[232:235], a[4:7], a[228:231], v[232:235]
    v_exp_f32 v208, v208
    v_mfma_f32_16x16x32_bf16 v[236:239], a[24:27], a[224:227], 0
    s_waitcnt lgkmcnt(6)
    v_exp_f32 v209, v209
    v_mfma_f32_16x16x32_bf16 v[200:203], v[138:141], v[168:171], v[200:203]
    v_cvt_pk_bf16_f32 v61, v228, v229
    v_cvt_pk_bf16_f32 v64, v230, v231
    v_mfma_f32_16x16x32_bf16 v[200:203], v[140:143], v[170:173], v[200:203]
    s_waitcnt lgkmcnt(5)
    v_cvt_pk_bf16_f32 v194, v204, v205
    v_cvt_pk_bf16_f32 v195, v208, v209
    v_mfma_f32_16x16x32_bf16 v[220:223], v[60:63], v[188:191], 0
    s_waitcnt lgkmcnt(4)
    v_exp_f32 v206, v206
    v_mfma_f32_16x16x32_bf16 v[212:215], v[4:7], v[192:195], v[212:215]
    s_waitcnt lgkmcnt(3)
    v_exp_f32 v207, v207
    v_mfma_f32_16x16x32_bf16 v[216:219], v[34:37], v[192:195], v[216:219]
    s_waitcnt lgkmcnt(2)
    v_exp_f32 v210, v210
    v_mfma_f32_16x16x32_bf16 v[220:223], v[64:67], v[192:195], v[220:223]
    s_waitcnt lgkmcnt(1)
    v_exp_f32 v211, v211
    v_mfma_f32_16x16x32_bf16 v[224:227], a[248:251], v[192:195], v[224:227]
    s_waitcnt lgkmcnt(0)
    v_cvt_pk_bf16_f32 v181, v206, v207
    v_cvt_pk_bf16_f32 v182, v210, v211
    v_mfma_f32_16x16x32_bf16 v[196:199], v[162:165], v[168:171], v[196:199]
    ds_read_b128 v[204:207], v246 offset:320
    ds_read_b128 v[208:211], v244 offset:0
    v_mfma_f32_16x16x32_bf16 v[212:215], v[8:11], v[180:183], v[212:215]
    v_exp_f32 v200, v200
    v_mfma_f32_16x16x32_bf16 v[216:219], v[38:41], v[180:183], v[216:219]
    v_exp_f32 v201, v201
    v_mfma_f32_16x16x32_bf16 v[220:223], v[68:71], v[180:183], v[220:223]
    s_waitcnt vmcnt(3)
    ds_read_b64_tr_b16 a[152:153], v249 offset:0
    v_mfma_f32_16x16x32_bf16 v[224:227], a[248:251], v[180:183], v[224:227]
    ds_read_b64_tr_b16 a[154:155], v250 offset:0
    ds_read_b64_tr_b16 a[176:177], v249 offset:32
    v_mfma_f32_16x16x32_bf16 v[196:199], v[164:167], v[170:173], v[196:199]
    ds_read_b64_tr_b16 a[178:179], v250 offset:32
    ds_read_b64_tr_b16 a[200:201], v249 offset:64
    v_mfma_f32_16x16x32_bf16 v[232:235], a[8:11], a[232:235], v[232:235]
    ds_read_b64_tr_b16 a[202:203], v250 offset:64
    v_cvt_pk_bf16_f32 v184, v200, v201
    v_mfma_f32_16x16x32_bf16 v[232:235], a[12:15], a[236:239], v[232:235]
    ds_read_b128 v[200:203], v246 offset:0
    v_mfma_f32_16x16x32_bf16 v[232:235], a[16:19], a[240:243], v[232:235]
    v_exp_f32 v196, v196
    v_mfma_f32_16x16x32_bf16 v[232:235], a[20:23], a[244:247], v[232:235]
    s_waitcnt lgkmcnt(8)
    v_exp_f32 v197, v197
    v_mfma_f32_16x16x32_bf16 v[236:239], a[28:31], a[228:231], v[236:239]
    s_waitcnt lgkmcnt(7)
    v_cvt_pk_bf16_f32 v186, v196, v197
    v_mfma_f32_16x16x32_bf16 v[208:211], v[156:159], v[174:177], v[208:211]
    ds_read_b128 v[196:199], v245 offset:0
    v_mfma_f32_16x16x32_bf16 v[208:211], v[158:161], v[176:179], v[208:211]
    v_cvt_pk_bf16_f32 v144, v232, v233
    v_cvt_pk_bf16_f32 v145, v234, v235
    v_mfma_f32_16x16x32_bf16 v[236:239], a[32:35], a[232:235], v[236:239]
    s_waitcnt lgkmcnt(6)
    v_mfma_f32_16x16x32_bf16 v[236:239], a[36:39], a[236:239], v[236:239]
    s_waitcnt lgkmcnt(5)
    s_waitcnt lgkmcnt(2)
    buffer_load_dwordx4 v252, s[12:15], s62 offen lds
    v_mfma_f32_16x16x32_bf16 v[236:239], a[40:43], a[240:243], v[236:239]
    s_waitcnt vmcnt(1)
    ds_read_b64_tr_b16 a[156:157], v249 offset:3072
    v_mfma_f32_16x16x32_bf16 v[236:239], a[44:47], a[244:247], v[236:239]
    ds_read_b64_tr_b16 a[158:159], v250 offset:3072
    ds_read_b64_tr_b16 a[180:181], v249 offset:3104
    v_mfma_f32_16x16x32_bf16 v[228:231], a[48:51], a[224:227], 0
    ds_read_b64_tr_b16 a[182:183], v250 offset:3104
    ds_read_b64_tr_b16 a[204:205], v249 offset:3136
    v_mfma_f32_16x16x32_bf16 v[228:231], a[52:55], a[228:231], v[228:231]
    ds_read_b64_tr_b16 a[206:207], v250 offset:3136
    buffer_load_dwordx4 v253, s[12:15], s62 offen offset:1024 lds
    v_mfma_f32_16x16x32_bf16 v[228:231], a[56:59], a[232:235], v[228:231]
    s_waitcnt lgkmcnt(7)
    v_cvt_pk_bf16_f32 v146, v236, v237
    v_cvt_pk_bf16_f32 v147, v238, v239
    v_mfma_f32_16x16x32_bf16 v[200:203], v[126:129], v[174:177], v[200:203]
    s_waitcnt lgkmcnt(6)
    v_exp_f32 v208, v208
    v_mfma_f32_16x16x32_bf16 v[204:207], v[144:147], v[168:171], v[204:207]
    v_exp_f32 v209, v209
    v_mfma_f32_16x16x32_bf16 v[196:199], v[90:93], v[174:177], v[196:199]
    buffer_load_dwordx4 v251, s[12:15], s62 offen offset:2048 lds
    s_add_u32 m0, s46, 0x17400
    v_mfma_f32_16x16x32_bf16 v[196:199], v[92:95], v[176:179], v[196:199]
    v_exp_f32 v210, v210
    v_mfma_f32_16x16x32_bf16 v[200:203], v[128:131], v[176:179], v[200:203]
    s_waitcnt lgkmcnt(5)
    v_exp_f32 v211, v211
    v_mfma_f32_16x16x32_bf16 v[228:231], a[60:63], a[236:239], v[228:231]
    s_waitcnt lgkmcnt(4)
    v_cvt_pk_bf16_f32 v190, v208, v209
    v_cvt_pk_bf16_f32 v193, v210, v211
    v_mfma_f32_16x16x32_bf16 v[228:231], a[64:67], a[240:243], v[228:231]
    s_waitcnt lgkmcnt(0)
    buffer_load_dwordx4 v252, s[12:15], s63 offen lds
    v_mfma_f32_16x16x32_bf16 v[228:231], a[68:71], a[244:247], v[228:231]
    ds_read_b128 v[208:211], v245 offset:64
    ds_read_b64 v[168:169], v247 offset:36864
    v_mfma_f32_16x16x32_bf16 v[232:235], a[224:227], a[72:75], 0
    v_exp_f32 v196, v196
    v_mfma_f32_16x16x32_bf16 v[232:235], a[228:231], a[76:79], v[232:235]
    v_exp_f32 v197, v197
    v_mfma_f32_16x16x32_bf16 v[232:235], a[232:235], a[80:83], v[232:235]
    buffer_load_dwordx4 v253, s[12:15], s63 offen offset:1024 lds
    v_cvt_pk_bf16_f32 v148, v228, v229
    v_mfma_f32_16x16x32_bf16 v[232:235], a[236:239], a[84:87], v[232:235]
    v_cvt_pk_bf16_f32 v149, v230, v231
    v_cvt_pk_bf16_f32 v188, v196, v197
    v_mfma_f32_16x16x32_bf16 v[232:235], a[240:243], a[88:91], v[232:235]
    v_exp_f32 v198, v198
    v_mfma_f32_16x16x32_bf16 v[204:207], v[146:149], v[170:173], v[204:207]
    v_exp_f32 v199, v199
    v_mfma_f32_16x16x32_bf16 v[232:235], a[244:247], a[92:95], v[232:235]
    buffer_load_dwordx4 v251, s[12:15], s63 offen offset:2048 lds
    v_cvt_pk_bf16_f32 v191, v198, v199
    v_mfma_f32_16x16x32_bf16 v[236:239], a[224:227], a[96:99], 0
    ds_read_b128 v[196:199], v246 offset:64
    ds_read_b64 v[170:171], v247 offset:36992
    v_mfma_f32_16x16x32_bf16 v[236:239], a[228:231], a[100:103], v[236:239]
    s_waitcnt lgkmcnt(3)
    v_exp_f32 v204, v204
    v_mfma_f32_16x16x32_bf16 v[208:211], v[138:141], v[174:177], v[208:211]
    s_waitcnt lgkmcnt(2)
    v_cvt_pk_bf16_f32 v13, v232, v233
    v_cvt_pk_bf16_f32 v16, v234, v235
    v_mfma_f32_16x16x32_bf16 v[208:211], v[140:143], v[176:179], v[208:211]
    v_exp_f32 v205, v205
    v_mfma_f32_16x16x32_bf16 v[236:239], a[232:235], a[104:107], v[236:239]
    ds_read_b64 v[172:173], v247 offset:37120
    v_cvt_pk_bf16_f32 v185, v204, v205
    v_mfma_f32_16x16x32_bf16 v[236:239], a[236:239], a[108:111], v[236:239]
    ds_read_b128 v[204:207], v244 offset:64
    v_mfma_f32_16x16x32_bf16 v[212:215], v[12:15], v[184:187], v[212:215]
    v_exp_f32 v200, v200
    v_mfma_f32_16x16x32_bf16 v[224:227], a[248:251], v[184:187], v[224:227]
    v_exp_f32 v201, v201
    v_mfma_f32_16x16x32_bf16 v[236:239], a[240:243], a[112:115], v[236:239]
    v_exp_f32 v202, v202
    v_mfma_f32_16x16x32_bf16 v[236:239], a[244:247], a[116:119], v[236:239]
    v_exp_f32 v203, v203
    v_mfma_f32_16x16x32_bf16 v[228:231], a[224:227], a[120:123], 0
    ds_read_b128 a[224:227], v240 offset:4736
    v_cvt_pk_bf16_f32 v189, v200, v201
    v_mfma_f32_16x16x32_bf16 v[228:231], a[228:231], a[124:127], v[228:231]
    ds_read_b128 a[228:231], v241 offset:4736
    v_cvt_pk_bf16_f32 v192, v202, v203
    v_mfma_f32_16x16x32_bf16 v[228:231], a[232:235], a[128:131], v[228:231]
    ds_read_b128 a[232:235], v240 offset:4864
    v_cvt_pk_bf16_f32 v43, v236, v237
    v_mfma_f32_16x16x32_bf16 v[228:231], a[236:239], a[132:135], v[228:231]
    ds_read_b128 a[236:239], v241 offset:4864
    v_cvt_pk_bf16_f32 v46, v238, v239
    v_mfma_f32_16x16x32_bf16 v[216:219], v[42:45], v[184:187], v[216:219]
    s_waitcnt lgkmcnt(6)
    v_rcp_f32 v225, v224
    v_mfma_f32_16x16x32_bf16 v[196:199], v[144:147], v[174:177], v[196:199]
    s_waitcnt lgkmcnt(4)
    v_mul_f32 v212, v212, v225
    v_mul_f32 v213, v213, v225
    v_mfma_f32_16x16x32_bf16 v[204:207], v[162:165], v[174:177], v[204:207]
    v_mul_f32 v214, v214, v225
    v_mul_f32 v215, v215, v225
    v_mfma_f32_16x16x32_bf16 v[204:207], v[164:167], v[176:179], v[204:207]
    ds_read_b128 v[200:203], v244 offset:128
    v_cvt_pk_bf16_f32 v212, v212, v213
    v_mfma_f32_16x16x32_bf16 v[196:199], v[146:149], v[176:179], v[196:199]
    v_cvt_pk_bf16_f32 v213, v214, v215
    v_mul_f32 v216, v216, v225
    v_mfma_f32_16x16x32_bf16 v[228:231], a[240:243], a[136:139], v[228:231]
    ds_write_b64 v247, v[212:213] offset:24576
    v_mfma_f32_16x16x32_bf16 v[212:215], v[6:9], v[188:191], 0
L_h7:
    s_cbranch_execz L_hback
    s_waitcnt lgkmcnt(5)
    v_mul_f32 v217, v217, v225
    v_mul_f32 v218, v218, v225
    v_mfma_f32_16x16x32_bf16 v[228:231], a[244:247], a[140:143], v[228:231]
    s_waitcnt lgkmcnt(4)
    v_mul_f32 v219, v219, v225
    v_cvt_pk_bf16_f32 v216, v216, v217
    v_mfma_f32_16x16x32_bf16 v[232:235], a[0:3], a[216:219], 0
    s_waitcnt lgkmcnt(3)
    v_cvt_pk_bf16_f32 v217, v218, v219
    v_max3_f32 v248, v248, v224, v225
    v_mfma_f32_16x16x32_bf16 v[232:235], a[4:7], a[220:223], v[232:235]
    s_waitcnt lgkmcnt(2)
    v_cvt_pk_bf16_f32 v73, v228, v229
    v_cvt_pk_bf16_f32 v76, v230, v231
    v_mfma_f32_16x16x32_bf16 v[232:235], a[8:11], a[224:227], v[232:235]
    ds_write_b64 v247, v[216:217] offset:24704
    v_mfma_f32_16x16x32_bf16 v[220:223], v[72:75], v[184:187], v[220:223]
    v_exp_f32 v204, v204
    v_mfma_f32_16x16x32_bf16 v[216:219], v[36:39], v[188:191], 0
    s_waitcnt lgkmcnt(2)
    v_exp_f32 v205, v205
    v_mfma_f32_16x16x32_bf16 v[200:203], v[102:105], v[174:177], v[200:203]
    v_exp_f32 v206, v206
    v_mfma_f32_16x16x32_bf16 v[200:203], v[104:107], v[176:179], v[200:203]
    v_exp_f32 v207, v207
    v_mfma_f32_16x16x32_bf16 v[232:235], a[12:15], a[228:231], v[232:235]
    v_mul_f32 v220, v220, v225
    v_mul_f32 v221, v221, v225
    v_mfma_f32_16x16x32_bf16 v[232:235], a[16:19], a[232:235], v[232:235]
    v_mul_f32 v222, v222, v225
    v_mul_f32 v223, v223, v225
    v_mfma_f32_16x16x32_bf16 v[224:227], a[248:251], v[188:191], 0
    v_cvt_pk_bf16_f32 v220, v220, v221
    v_cvt_pk_bf16_f32 v221, v222, v223
    v_mfma_f32_16x16x32_bf16 v[232:235], a[20:23], a[236:239], v[232:235]
    ds_write_b64 v247, v[220:221] offset:24832
    v_mfma_f32_16x16x32_bf16 v[220:223], v[66:69], v[188:191], 0
    v_cvt_pk_bf16_f32 v180, v204, v205
    v_cvt_pk_bf16_f32 v183, v206, v207
    v_mfma_f32_16x16x32_bf16 v[236:239], a[24:27], a[216:219], 0
    ds_read_b128 v[204:207], v245 offset:128
    v_mfma_f32_16x16x32_bf16 v[236:239], a[28:31], a[220:223], v[236:239]
    v_exp_f32 v208, v208
    v_mfma_f32_16x16x32_bf16 v[236:239], a[32:35], a[224:227], v[236:239]
    v_cvt_pk_bf16_f32 v150, v232, v233
    v_cvt_pk_bf16_f32 v151, v234, v235
    v_mfma_f32_16x16x32_bf16 v[236:239], a[36:39], a[228:231], v[236:239]
    v_exp_f32 v209, v209
    v_mfma_f32_16x16x32_bf16 v[236:239], a[40:43], a[232:235], v[236:239]
    v_exp_f32 v196, v196
    v_mfma_f32_16x16x32_bf16 v[236:239], a[44:47], a[236:239], v[236:239]
    v_exp_f32 v197, v197
    v_mfma_f32_16x16x32_bf16 v[228:231], a[48:51], a[216:219], 0
    v_cvt_pk_bf16_f32 v194, v208, v209
    v_cvt_pk_bf16_f32 v195, v196, v197
    v_mfma_f32_16x16x32_bf16 v[228:231], a[52:55], a[220:223], v[228:231]
    v_exp_f32 v210, v210
    v_mfma_f32_16x16x32_bf16 v[212:215], v[10:13], v[192:195], v[212:215]
    v_exp_f32 v211, v211
    v_mfma_f32_16x16x32_bf16 v[216:219], v[40:43], v[192:195], v[216:219]
    v_cvt_pk_bf16_f32 v152, v236, v237
    v_cvt_pk_bf16_f32 v153, v238, v239
    v_mfma_f32_16x16x32_bf16 v[220:223], v[70:73], v[192:195], v[220:223]
    s_waitcnt lgkmcnt(0)
    v_exp_f32 v198, v198
    v_mfma_f32_16x16x32_bf16 v[224:227], a[248:251], v[192:195], v[224:227]
    v_exp_f32 v199, v199
    v_mfma_f32_16x16x32_bf16 v[204:207], v[114:117], v[174:177], v[204:207]
    v_cvt_pk_bf16_f32 v181, v210, v211
    v_cvt_pk_bf16_f32 v182, v198, v199
    v_mfma_f32_16x16x32_bf16 v[204:207], v[116:119], v[176:179], v[204:207]
    ds_read_b128 v[208:211], v246 offset:128
    ds_read_b128 v[196:199], v244 offset:0
    v_mfma_f32_16x16x32_bf16 v[212:215], v[14:17], v[180:183], v[212:215]
    s_waitcnt vmcnt(3)
    ds_read_b64_tr_b16 a[160:161], v249 offset:0
    v_mfma_f32_16x16x32_bf16 v[216:219], v[44:47], v[180:183], v[216:219]
    ds_read_b64_tr_b16 a[162:163], v250 offset:0
    ds_read_b64_tr_b16 a[184:185], v249 offset:32
    v_mfma_f32_16x16x32_bf16 v[220:223], v[74:77], v[180:183], v[220:223]
    s_waitcnt vmcnt(0)
    ds_read_b64_tr_b16 a[164:165], v249 offset:3072
    v_mfma_f32_16x16x32_bf16 v[224:227], a[248:251], v[180:183], v[224:227]
    ds_read_b64_tr_b16 a[166:167], v250 offset:3072
    ds_read_b64_tr_b16 a[186:187], v250 offset:32
    v_mfma_f32_16x16x32_bf16 v[228:231], a[56:59], a[224:227], v[228:231]
    ds_read_b64_tr_b16 a[188:189], v249 offset:3104
    ds_read_b64_tr_b16 a[190:191], v250 offset:3104
    v_mfma_f32_16x16x32_bf16 v[228:231], a[60:63], a[228:231], v[228:231]
    ds_read_b64_tr_b16 a[208:209], v249 offset:64
    ds_read_b64_tr_b16 a[210:211], v250 offset:64
    v_mfma_f32_16x16x32_bf16 v[228:231], a[64:67], a[232:235], v[228:231]
    ds_read_b64_tr_b16 a[212:213], v249 offset:3136
    ds_read_b64_tr_b16 a[214:215], v250 offset:3136
    v_mfma_f32_16x16x32_bf16 v[228:231], a[68:71], a[236:239], v[228:231]
    s_waitcnt lgkmcnt(13)
    v_exp_f32 v200, v200
    v_mfma_f32_16x16x32_bf16 v[208:211], v[150:153], v[174:177], v[208:211]
    s_waitcnt lgkmcnt(12)
    v_exp_f32 v201, v201
    v_mfma_f32_16x16x32_bf16 v[196:199], v[162:165], v[168:171], v[196:199]
    ds_read_b64 v[174:175], v247 offset:43008
    v_cvt_pk_bf16_f32 v186, v200, v201
    v_mfma_f32_16x16x32_bf16 v[196:199], v[164:167], v[170:173], v[196:199]
    s_waitcnt lgkmcnt(10)
    v_cvt_pk_bf16_f32 v154, v228, v229
    v_cvt_pk_bf16_f32 v155, v230, v231
    v_mfma_f32_16x16x32_bf16 v[232:235], a[216:219], a[72:75], 0
    ds_read_b128 v[200:203], v245 offset:0
    v_mfma_f32_16x16x32_bf16 v[208:211], v[152:155], v[176:179], v[208:211]
    s_waitcnt lgkmcnt(8)
    v_exp_f32 v204, v204
    v_mfma_f32_16x16x32_bf16 v[232:235], a[220:223], a[76:79], v[232:235]
    s_waitcnt lgkmcnt(7)
    v_exp_f32 v205, v205
    v_mfma_f32_16x16x32_bf16 v[232:235], a[224:227], a[80:83], v[232:235]
    ds_read_b64 v[176:177], v247 offset:43136
    v_cvt_pk_bf16_f32 v184, v204, v205
    v_mfma_f32_16x16x32_bf16 v[232:235], a[228:231], a[84:87], v[232:235]
    s_waitcnt lgkmcnt(3)
    s_barrier
    v_mfma_f32_16x16x32_bf16 v[232:235], a[232:235], a[88:91], v[232:235]
    v_exp_f32 v208, v208
    v_mfma_f32_16x16x32_bf16 v[232:235], a[236:239], a[92:95], v[232:235]
    s_waitcnt lgkmcnt(2)
    v_exp_f32 v209, v209
    v_mfma_f32_16x16x32_bf16 v[236:239], a[216:219], a[96:99], 0
    ds_read_b128 v[204:207], v246 offset:0
    v_cvt_pk_bf16_f32 v185, v208, v209
    v_mfma_f32_16x16x32_bf16 v[236:239], a[220:223], a[100:103], v[236:239]
    ds_read_b128 v[208:211], v244 offset:64
    ds_read_b64 v[178:179], v247 offset:43264
    v_mfma_f32_16x16x32_bf16 v[224:227], a[248:251], v[184:187], v[224:227]
    s_waitcnt lgkmcnt(4)
    v_cvt_pk_bf16_f32 v19, v232, v233
    v_mbcnt_lo_u32_b32 v232, -1, 0
    v_mfma_f32_16x16x32_bf16 v[200:203], v[138:141], v[168:171], v[200:203]
    v_mbcnt_hi_u32_b32 v232, -1, v232
    v_cvt_pk_bf16_f32 v22, v234, v235
    v_mfma_f32_16x16x32_bf16 v[212:215], v[18:21], v[184:187], v[212:215]
    s_waitcnt lgkmcnt(3)
    v_and_b32 v233, 15, v232
    v_lshrrev_b32 v232, 4, v232
    v_mfma_f32_16x16x32_bf16 v[200:203], v[140:143], v[170:173], v[200:203]
    v_lshrrev_b32 v234, 1, v233
    v_mul_u32_u24 v235, 0x180, v233
    v_mfma_f32_16x16x32_bf16 v[236:239], a[224:227], a[104:107], v[236:239]
    v_xor_b32 v243, v232, v234
    v_lshl_add_u32 v242, v243, 4, v235
    v_mfma_f32_16x16x32_bf16 v[236:239], a[228:231], a[108:111], v[236:239]
    v_xor_b32 v243, 64, v242
    v_add_u32 v242, 0x1e000, v242
    v_mfma_f32_16x16x32_bf16 v[236:239], a[232:235], a[112:115], v[236:239]
    ds_read_b128 a[240:243], v242 offset:0
    v_add_u32 v243, 0x1e000, v243
    v_mfma_f32_16x16x32_bf16 v[236:239], a[236:239], a[116:119], v[236:239]
    ds_read_b128 a[244:247], v243 offset:0
    v_lshrrev_b32 v249, 1, v232
    v_mfma_f32_16x16x32_bf16 v[228:231], a[216:219], a[120:123], 0
    ds_read_b128 a[216:219], v242 offset:128
    v_or_b32 v249, s66, v249
    v_mfma_f32_16x16x32_bf16 v[228:231], a[220:223], a[124:127], v[228:231]
    ds_read_b128 a[220:223], v243 offset:128
    v_mov_b32 v253, v249
    v_mfma_f32_16x16x32_bf16 v[228:231], a[224:227], a[128:131], v[228:231]
    ds_read_b128 a[224:227], v242 offset:256
    v_cvt_pk_bf16_f32 v49, v236, v237
    v_mfma_f32_16x16x32_bf16 v[228:231], a[228:231], a[132:135], v[228:231]
    ds_read_b128 a[228:231], v243 offset:256
    v_cvt_pk_bf16_f32 v52, v238, v239
    v_mfma_f32_16x16x32_bf16 v[216:219], v[48:51], v[184:187], v[216:219]
    s_waitcnt lgkmcnt(7)
    v_xor_b32 v249, v249, v234
    v_lshl_add_u32 v249, v249, 4, v235
    v_mfma_f32_16x16x32_bf16 v[204:207], v[144:147], v[168:171], v[204:207]
    s_waitcnt lgkmcnt(6)
    v_and_b32 v235, 1, v232
    v_lshl_add_u32 v249, v235, 3, v249
    v_mfma_f32_16x16x32_bf16 v[204:207], v[146:149], v[170:173], v[204:207]
    v_lshlrev_b32 v235, 3, v235
    s_waitcnt lgkmcnt(5)
    v_mfma_f32_16x16x32_bf16 v[208:211], v[102:105], v[168:171], v[208:211]
    v_xor_b32 v250, s67, v232
    v_xor_b32 v252, v233, v235
    v_mfma_f32_16x16x32_bf16 v[208:211], v[104:107], v[170:173], v[208:211]
    s_mul_i32 s67, s28, 0x600
    v_xor_b32 v252, v252, v253
    v_mul_u32_u24 v250, 0x300, v250
    v_mfma_f32_16x16x32_bf16 v[228:231], a[232:235], a[136:139], v[228:231]
    ds_read_b128 a[232:235], v242 offset:12288
    s_add_u32 s67, s67, 0x16800
    v_mfma_f32_16x16x32_bf16 v[228:231], a[236:239], a[140:143], v[228:231]
    ds_read_b128 a[236:239], v243 offset:12288
    v_mul_u32_u24 v232, 0x180, v232
    v_mfma_f32_16x16x32_bf16 v[236:239], a[144:147], a[240:243], 0
    s_waitcnt lgkmcnt(6)
    v_xor_b32 v253, v253, v234
    v_add_u32 v249, 0x16800, v249
    v_mfma_f32_16x16x32_bf16 v[236:239], a[148:151], a[244:247], v[236:239]
    s_waitcnt lgkmcnt(5)
    v_cvt_pk_bf16_f32 v79, v228, v229
    v_cvt_pk_bf16_f32 v82, v230, v231
    v_mfma_f32_16x16x32_bf16 v[236:239], a[152:155], a[216:219], v[236:239]
    s_waitcnt lgkmcnt(4)
    v_add_u32 v232, s67, v232
    v_and_b32 v234, 1, v233
    v_mfma_f32_16x16x32_bf16 v[220:223], v[78:81], v[184:187], v[220:223]
    s_lshl2_add_u32 s67, s28, 0x23000
    v_lshl_add_u32 v251, v233, 3, v250
    v_lshl_add_u32 v253, v253, 4, v232
    v_mfma_f32_16x16x32_bf16 v[236:239], a[156:159], a[220:223], v[236:239]
    s_waitcnt lgkmcnt(3)
    v_xor_b32 v233, v233, v235
    v_lshl_add_u32 v252, v252, 4, v232
    v_mfma_f32_16x16x32_bf16 v[236:239], a[160:163], a[224:227], v[236:239]
    s_waitcnt lgkmcnt(2)
    v_lshl_add_u32 v253, v234, 3, v253
    v_lshl_add_u32 v250, v233, 4, v250
    v_mfma_f32_16x16x32_bf16 v[236:239], a[164:167], a[228:231], v[236:239]
    v_exp_f32 v196, v196
    v_mfma_f32_16x16x32_bf16 v[228:231], a[168:171], a[240:243], 0
    v_exp_f32 v197, v197
    v_mfma_f32_16x16x32_bf16 v[228:231], a[172:175], a[244:247], v[228:231]
    s_waitcnt lgkmcnt(1)
    v_exp_f32 v198, v198
    v_mfma_f32_16x16x32_bf16 v[228:231], a[176:179], a[216:219], v[228:231]
    s_waitcnt lgkmcnt(0)
    v_cvt_pk_bf16_f32 v236, v236, v237
    v_cvt_pk_bf16_f32 v237, v238, v239
    v_mfma_f32_16x16x32_bf16 v[228:231], a[180:183], a[220:223], v[228:231]
    ds_write_b64 v249, v[236:237] offset:0
    v_mfma_f32_16x16x32_bf16 v[228:231], a[184:187], a[224:227], v[228:231]
    v_exp_f32 v199, v199
    v_mfma_f32_16x16x32_bf16 v[228:231], a[188:191], a[228:231], v[228:231]
    v_cvt_pk_bf16_f32 v190, v196, v197
    v_cvt_pk_bf16_f32 v193, v198, v199
    v_mfma_f32_16x16x32_bf16 v[232:235], a[192:195], a[240:243], 0
    ds_read_b128 a[240:243], v242 offset:12416
    ds_read_b128 v[196:199], v245 offset:64
    v_mfma_f32_16x16x32_bf16 v[232:235], a[196:199], a[244:247], v[232:235]
    ds_read_b128 a[244:247], v243 offset:12416
    v_mfma_f32_16x16x32_bf16 v[232:235], a[200:203], a[216:219], v[232:235]
    ds_read_b128 a[216:219], v242 offset:12544
    v_cvt_pk_bf16_f32 v228, v228, v229
    v_mfma_f32_16x16x32_bf16 v[232:235], a[204:207], a[220:223], v[232:235]
    ds_read_b128 a[220:223], v243 offset:12544
    v_cvt_pk_bf16_f32 v229, v230, v231
    v_mfma_f32_16x16x32_bf16 v[232:235], a[208:211], a[224:227], v[232:235]
    ds_write_b64 v249, v[228:229] offset:128
    v_mfma_f32_16x16x32_bf16 v[232:235], a[212:215], a[228:231], v[232:235]
    ds_read_b128 a[224:227], v240 offset:6144
    ds_read_b128 a[228:231], v241 offset:6144
    v_mfma_f32_16x16x32_bf16 v[236:239], a[144:147], a[232:235], 0
    v_rcp_f32 v225, v224
    v_mfma_f32_16x16x32_bf16 v[236:239], a[148:151], a[236:239], v[236:239]
    v_exp_f32 v200, v200
    v_mfma_f32_16x16x32_bf16 v[228:231], a[168:171], a[232:235], 0
    s_waitcnt lgkmcnt(7)
    v_cvt_pk_bf16_f32 v232, v232, v233
    v_cvt_pk_bf16_f32 v233, v234, v235
    v_mfma_f32_16x16x32_bf16 v[236:239], a[152:155], a[240:243], v[236:239]
    ds_write_b64 v249, v[232:233] offset:256
    v_mfma_f32_16x16x32_bf16 v[228:231], a[172:175], a[236:239], v[228:231]
    s_waitcnt lgkmcnt(6)
    v_exp_f32 v201, v201
    v_mfma_f32_16x16x32_bf16 v[196:199], v[114:117], v[168:171], v[196:199]
    v_exp_f32 v202, v202
    v_mfma_f32_16x16x32_bf16 v[196:199], v[116:119], v[170:173], v[196:199]
    s_waitcnt lgkmcnt(5)
    v_exp_f32 v203, v203
    v_mfma_f32_16x16x32_bf16 v[236:239], a[156:159], a[244:247], v[236:239]
    s_waitcnt lgkmcnt(4)
    v_exp_f32 v204, v204
    v_mfma_f32_16x16x32_bf16 v[236:239], a[160:163], a[216:219], v[236:239]
    v_exp_f32 v205, v205
    v_mfma_f32_16x16x32_bf16 v[236:239], a[164:167], a[220:223], v[236:239]
    s_waitcnt lgkmcnt(2)
    v_mul_f32 v212, v212, v225
    v_mul_f32 v213, v213, v225
    v_mfma_f32_16x16x32_bf16 v[228:231], a[176:179], a[240:243], v[228:231]
    s_waitcnt lgkmcnt(1)
    v_cvt_pk_bf16_f32 v188, v200, v201
    v_cvt_pk_bf16_f32 v191, v202, v203
    v_mfma_f32_16x16x32_bf16 v[228:231], a[180:183], a[244:247], v[228:231]
    v_cvt_pk_bf16_f32 v236, v236, v237
    v_cvt_pk_bf16_f32 v237, v238, v239
    v_mfma_f32_16x16x32_bf16 v[228:231], a[184:187], a[216:219], v[228:231]
    ds_write_b64 v249, v[236:237] offset:6144
    v_mfma_f32_16x16x32_bf16 v[228:231], a[188:191], a[220:223], v[228:231]
    v_cvt_pk_bf16_f32 v189, v204, v205
    v_mul_f32 v214, v214, v225
    v_mfma_f32_16x16x32_bf16 v[232:235], a[192:195], a[232:235], 0
    ds_read_b128 a[232:235], v240 offset:6272
    v_mul_f32 v215, v215, v225
    v_mfma_f32_16x16x32_bf16 v[232:235], a[196:199], a[236:239], v[232:235]
    ds_read_b128 a[236:239], v241 offset:6272
    v_cvt_pk_bf16_f32 v212, v212, v213
    v_mfma_f32_16x16x32_bf16 v[232:235], a[200:203], a[240:243], v[232:235]
    ds_read_b128 a[240:243], v240 offset:6400
    v_cvt_pk_bf16_f32 v228, v228, v229
    v_mfma_f32_16x16x32_bf16 v[232:235], a[204:207], a[244:247], v[232:235]
    ds_read_b128 a[244:247], v241 offset:6400
    v_cvt_pk_bf16_f32 v229, v230, v231
    v_mfma_f32_16x16x32_bf16 v[232:235], a[208:211], a[216:219], v[232:235]
    ds_write_b64 v249, v[228:229] offset:6272
    v_mfma_f32_16x16x32_bf16 v[232:235], a[212:215], a[220:223], v[232:235]
    ds_read_b128 a[216:219], v242 offset:6144
    v_cvt_pk_bf16_f32 v213, v214, v215
    v_mfma_f32_16x16x32_bf16 v[236:239], a[0:3], a[224:227], 0
    ds_read_b128 a[220:223], v243 offset:6144
    v_mul_f32 v216, v216, v225
    v_mfma_f32_16x16x32_bf16 v[236:239], a[4:7], a[228:231], v[236:239]
    ds_read_b128 v[200:203], v246 offset:64
    v_mul_f32 v217, v217, v225
    v_mfma_f32_16x16x32_bf16 v[228:231], a[24:27], a[224:227], 0
    s_waitcnt lgkmcnt(7)
    v_cvt_pk_bf16_f32 v232, v232, v233
    v_cvt_pk_bf16_f32 v233, v234, v235
    v_mfma_f32_16x16x32_bf16 v[236:239], a[8:11], a[232:235], v[236:239]
    s_waitcnt lgkmcnt(6)
    v_mul_f32 v218, v218, v225
    v_mul_f32 v219, v219, v225
    v_mfma_f32_16x16x32_bf16 v[236:239], a[12:15], a[236:239], v[236:239]
    s_waitcnt lgkmcnt(5)
    v_cvt_pk_bf16_f32 v216, v216, v217
    v_cvt_pk_bf16_f32 v217, v218, v219
    v_mfma_f32_16x16x32_bf16 v[236:239], a[16:19], a[240:243], v[236:239]
    s_waitcnt lgkmcnt(4)
    v_mul_f32 v220, v220, v225
    v_mul_f32 v221, v221, v225
    v_mfma_f32_16x16x32_bf16 v[236:239], a[20:23], a[244:247], v[236:239]
    ds_write_b64 v249, v[232:233] offset:6400
    v_mfma_f32_16x16x32_bf16 v[228:231], a[28:31], a[228:231], v[228:231]
    ds_write_b64 v247, v[212:213] offset:30720
    v_mfma_f32_16x16x32_bf16 v[212:215], v[12:15], v[188:191], 0
    ds_write_b64 v247, v[216:217] offset:30848
    v_mfma_f32_16x16x32_bf16 v[216:219], v[42:45], v[188:191], 0
    s_waitcnt lgkmcnt(4)
    v_mul_f32 v222, v222, v225
    v_cvt_pk_bf16_f32 v156, v236, v237
    v_mfma_f32_16x16x32_bf16 v[228:231], a[32:35], a[232:235], v[228:231]
    s_waitcnt lgkmcnt(3)
    v_cvt_pk_bf16_f32 v157, v238, v239
    v_mul_f32 v223, v223, v225
    v_mfma_f32_16x16x32_bf16 v[200:203], v[150:153], v[168:171], v[200:203]
    v_cvt_pk_bf16_f32 v220, v220, v221
    v_cvt_pk_bf16_f32 v221, v222, v223
    v_mfma_f32_16x16x32_bf16 v[200:203], v[152:155], v[170:173], v[200:203]
    ds_write_b64 v247, v[220:221] offset:30976
    v_mfma_f32_16x16x32_bf16 v[220:223], v[72:75], v[188:191], 0
    v_exp_f32 v206, v206
    v_mfma_f32_16x16x32_bf16 v[228:231], a[36:39], a[236:239], v[228:231]
    v_exp_f32 v207, v207
    v_mfma_f32_16x16x32_bf16 v[228:231], a[40:43], a[240:243], v[228:231]
    v_max3_f32 v248, v248, v224, v225
    v_cvt_pk_bf16_f32 v192, v206, v207
    v_mfma_f32_16x16x32_bf16 v[224:227], a[248:251], v[188:191], 0
    ds_read_b128 v[204:207], v244 offset:128
    v_mfma_f32_16x16x32_bf16 v[228:231], a[44:47], a[244:247], v[228:231]
    v_exp_f32 v208, v208
    v_mfma_f32_16x16x32_bf16 v[232:235], a[48:51], a[224:227], 0
    v_exp_f32 v209, v209
    v_mfma_f32_16x16x32_bf16 v[232:235], a[52:55], a[228:231], v[232:235]
    s_waitcnt lgkmcnt(4)
    v_exp_f32 v210, v210
    v_mfma_f32_16x16x32_bf16 v[232:235], a[56:59], a[232:235], v[232:235]
    s_barrier
    v_mfma_f32_16x16x32_bf16 v[232:235], a[60:63], a[236:239], v[232:235]
    v_cvt_pk_bf16_f32 v158, v228, v229
    v_cvt_pk_bf16_f32 v159, v230, v231
    v_mfma_f32_16x16x32_bf16 v[232:235], a[64:67], a[240:243], v[232:235]
    v_exp_f32 v211, v211
    v_mfma_f32_16x16x32_bf16 v[232:235], a[68:71], a[244:247], v[232:235]
    v_cvt_pk_bf16_f32 v180, v208, v209
    v_cvt_pk_bf16_f32 v183, v210, v211
    v_mfma_f32_16x16x32_bf16 v[236:239], a[224:227], a[72:75], 0
    ds_read_b128 v[208:211], v245 offset:128
    ds_read_b128 a[252:255], v252 offset:0
    v_mfma_f32_16x16x32_bf16 v[236:239], a[228:231], a[76:79], v[236:239]
    s_waitcnt lgkmcnt(2)
    v_exp_f32 v196, v196
    v_mfma_f32_16x16x32_bf16 v[204:207], v[108:111], v[168:171], v[204:207]
    v_cvt_pk_bf16_f32 v160, v232, v233
    v_cvt_pk_bf16_f32 v161, v234, v235
    v_mfma_f32_16x16x32_bf16 v[204:207], v[110:113], v[170:173], v[204:207]
    v_exp_f32 v197, v197
    v_mfma_f32_16x16x32_bf16 v[236:239], a[232:235], a[80:83], v[236:239]
    v_exp_f32 v198, v198
    v_mfma_f32_16x16x32_bf16 v[236:239], a[236:239], a[84:87], v[236:239]
    v_exp_f32 v199, v199
    v_mfma_f32_16x16x32_bf16 v[236:239], a[240:243], a[88:91], v[236:239]
    v_cvt_pk_bf16_f32 v194, v196, v197
    v_cvt_pk_bf16_f32 v181, v198, v199
    v_mfma_f32_16x16x32_bf16 v[236:239], a[244:247], a[92:95], v[236:239]
    ds_read_b128 v[196:199], v246 offset:128
    ds_read_b64 v[254:255], v253 offset:256
    v_mfma_f32_16x16x32_bf16 v[228:231], a[224:227], a[96:99], 0
    v_exp_f32 v200, v200
    v_mfma_f32_16x16x32_bf16 v[228:231], a[228:231], a[100:103], v[228:231]
    s_waitcnt lgkmcnt(3)
    v_exp_f32 v201, v201
    v_mfma_f32_16x16x32_bf16 v[208:211], v[120:123], v[168:171], v[208:211]
    s_waitcnt lgkmcnt(2)
    v_cvt_pk_bf16_f32 v25, v236, v237
    v_cvt_pk_bf16_f32 v28, v238, v239
    v_mfma_f32_16x16x32_bf16 v[208:211], v[122:125], v[170:173], v[208:211]
    v_exp_f32 v202, v202
    v_mfma_f32_16x16x32_bf16 v[228:231], a[232:235], a[104:107], v[228:231]
    v_exp_f32 v203, v203
    v_mfma_f32_16x16x32_bf16 v[228:231], a[236:239], a[108:111], v[228:231]
    v_cvt_pk_bf16_f32 v195, v200, v201
    v_cvt_pk_bf16_f32 v182, v202, v203
    v_mfma_f32_16x16x32_bf16 v[228:231], a[240:243], a[112:115], v[228:231]
    ds_read_b128 v[200:203], v244 offset:0
    v_mfma_f32_16x16x32_bf16 v[212:215], v[16:19], v[192:195], v[212:215]
    v_exp_f32 v204, v204
    v_mfma_f32_16x16x32_bf16 v[216:219], v[46:49], v[192:195], v[216:219]
    v_exp_f32 v205, v205
    v_mfma_f32_16x16x32_bf16 v[220:223], v[76:79], v[192:195], v[220:223]
    s_waitcnt lgkmcnt(1)
    v_exp_f32 v208, v208
    v_mfma_f32_16x16x32_bf16 v[224:227], a[248:251], v[192:195], v[224:227]
    v_exp_f32 v209, v209
    v_mfma_f32_16x16x32_bf16 v[212:215], v[20:23], v[180:183], v[212:215]
    v_cvt_pk_bf16_f32 v186, v204, v205
    v_cvt_pk_bf16_f32 v184, v208, v209
    v_mfma_f32_16x16x32_bf16 v[216:219], v[50:53], v[180:183], v[216:219]
    ds_read_b128 v[204:207], v245 offset:0
    ds_read_b128 v[208:211], v246 offset:0
    v_mfma_f32_16x16x32_bf16 v[220:223], v[80:83], v[180:183], v[220:223]
    buffer_store_dwordx4 a[252:255], v250, s[20:23], s56 offen nt
    v_mfma_f32_16x16x32_bf16 v[224:227], a[248:251], v[180:183], v[224:227]
    v_mfma_f32_16x16x32_bf16 v[196:199], v[156:159], v[168:171], v[196:199]
    ds_read_b64 v[168:169], v247 offset:49152
    ds_read_b128 a[252:255], v252 offset:6144
    v_mfma_f32_16x16x32_bf16 v[196:199], v[158:161], v[170:173], v[196:199]
    ds_read_b64 v[170:171], v247 offset:49280
    ds_read_b64 v[172:173], v247 offset:49408
    v_mfma_f32_16x16x32_bf16 v[228:231], a[244:247], a[116:119], v[228:231]
    buffer_store_dwordx2 v[254:255], v251, s[20:23], s56 offen offset:256 nt
    v_mfma_f32_16x16x32_bf16 v[232:235], a[224:227], a[120:123], 0
    ds_read_b128 a[224:227], v242 offset:6272
    s_waitcnt lgkmcnt(7)
    v_mfma_f32_16x16x32_bf16 v[200:203], v[102:105], v[174:177], v[200:203]
    s_mul_i32 s56, s31, 7
    v_exp_f32 v196, v196
    v_mfma_f32_16x16x32_bf16 v[200:203], v[104:107], v[176:179], v[200:203]
    s_add_u32 s55, s55, s56
    v_cvt_pk_bf16_f32 v55, v228, v229
    v_cvt_pk_bf16_f32 v58, v230, v231
    v_mfma_f32_16x16x32_bf16 v[232:235], a[228:231], a[124:127], v[232:235]
    ds_read_b128 a[228:231], v243 offset:6272
    ds_read_b64 v[254:255], v253 offset:6400
    v_mfma_f32_16x16x32_bf16 v[232:235], a[232:235], a[128:131], v[232:235]
    ds_read_b128 a[232:235], v242 offset:6400
    v_add_u32 v242, 0xfffe9800, v242
    v_mfma_f32_16x16x32_bf16 v[232:235], a[236:239], a[132:135], v[232:235]
    ds_read_b128 a[236:239], v243 offset:6400
    v_add_u32 v243, 0xfffe9800, v243
    v_mfma_f32_16x16x32_bf16 v[232:235], a[240:243], a[136:139], v[232:235]
    ds_read_b128 a[240:243], v242 offset:12288
    s_waitcnt lgkmcnt(10)
    v_mfma_f32_16x16x32_bf16 v[204:207], v[114:117], v[174:177], v[204:207]
    s_add_u32 s55, s55, s32
    v_exp_f32 v197, v197
    v_mfma_f32_16x16x32_bf16 v[204:207], v[116:119], v[176:179], v[204:207]
    s_add_u32 s56, s28, 11
    v_exp_f32 v200, v200
    v_mfma_f32_16x16x32_bf16 v[208:211], v[150:153], v[174:177], v[208:211]
    s_mul_i32 s56, s56, s30
    v_exp_f32 v201, v201
    v_mfma_f32_16x16x32_bf16 v[208:211], v[152:155], v[176:179], v[208:211]
    s_waitcnt lgkmcnt(5)
    v_cvt_pk_bf16_f32 v185, v196, v197
    v_cvt_pk_bf16_f32 v190, v200, v201
    v_mfma_f32_16x16x32_bf16 v[232:235], a[244:247], a[140:143], v[232:235]
    ds_read_b128 a[244:247], v243 offset:12288
    ds_read_b128 v[196:199], v244 offset:64
    v_mfma_f32_16x16x32_bf16 v[212:215], v[24:27], v[184:187], v[212:215]
    s_waitcnt lgkmcnt(6)
    v_exp_f32 v202, v202
    v_mfma_f32_16x16x32_bf16 v[216:219], v[54:57], v[184:187], v[216:219]
    s_waitcnt lgkmcnt(5)
    v_exp_f32 v203, v203
    v_mfma_f32_16x16x32_bf16 v[224:227], a[248:251], v[184:187], v[224:227]
    s_waitcnt lgkmcnt(4)
    v_cvt_pk_bf16_f32 v85, v232, v233
    v_cvt_pk_bf16_f32 v88, v234, v235
    v_mfma_f32_16x16x32_bf16 v[236:239], a[144:147], a[216:219], 0
    s_waitcnt lgkmcnt(3)
    v_exp_f32 v204, v204
    v_mfma_f32_16x16x32_bf16 v[220:223], v[84:87], v[184:187], v[220:223]
    s_waitcnt lgkmcnt(2)
    v_cvt_pk_bf16_f32 v193, v202, v203
    v_mov_b32 v186, 0
    v_mfma_f32_16x16x32_bf16 v[236:239], a[148:151], a[220:223], v[236:239]
    v_exp_f32 v205, v205
    v_mfma_f32_16x16x32_bf16 v[236:239], a[152:155], a[224:227], v[236:239]
    v_exp_f32 v206, v206
    v_mfma_f32_16x16x32_bf16 v[236:239], a[156:159], a[228:231], v[236:239]
    v_exp_f32 v207, v207
    v_mfma_f32_16x16x32_bf16 v[236:239], a[160:163], a[232:235], v[236:239]
    ds_read_b128 v[200:203], v245 offset:64
    v_cvt_pk_bf16_f32 v188, v204, v205
    v_mfma_f32_16x16x32_bf16 v[236:239], a[164:167], a[236:239], v[236:239]
    s_waitcnt lgkmcnt(2)
    v_rcp_f32 v225, v224
    v_mfma_f32_16x16x32_bf16 v[228:231], a[168:171], a[216:219], 0
    s_waitcnt lgkmcnt(1)
    v_cvt_pk_bf16_f32 v191, v206, v207
    v_mul_f32 v212, v212, v225
    v_mfma_f32_16x16x32_bf16 v[196:199], v[108:111], v[174:177], v[196:199]
    ds_read_b128 v[204:207], v246 offset:64
    v_cvt_pk_bf16_f32 v236, v236, v237
    v_mfma_f32_16x16x32_bf16 v[196:199], v[110:113], v[176:179], v[196:199]
    v_cvt_pk_bf16_f32 v237, v238, v239
    v_mul_f32 v213, v213, v225
    v_mfma_f32_16x16x32_bf16 v[228:231], a[172:175], a[220:223], v[228:231]
    ds_write_b64 v249, v[236:237] offset:12288
    v_mfma_f32_16x16x32_bf16 v[228:231], a[176:179], a[224:227], v[228:231]
    v_exp_f32 v208, v208
    v_mfma_f32_16x16x32_bf16 v[228:231], a[180:183], a[228:231], v[228:231]
    v_exp_f32 v209, v209
    v_mfma_f32_16x16x32_bf16 v[228:231], a[184:187], a[232:235], v[228:231]
    v_cvt_pk_bf16_f32 v189, v208, v209
    v_mul_f32 v214, v214, v225
    v_mfma_f32_16x16x32_bf16 v[228:231], a[188:191], a[236:239], v[228:231]
    v_mul_f32 v215, v215, v225
    v_cvt_pk_bf16_f32 v212, v212, v213
    v_mfma_f32_16x16x32_bf16 v[232:235], a[192:195], a[216:219], 0
    ds_read_b128 a[216:219], v242 offset:12416
    v_cvt_pk_bf16_f32 v213, v214, v215
    v_mfma_f32_16x16x32_bf16 v[232:235], a[196:199], a[220:223], v[232:235]
    ds_read_b128 a[220:223], v243 offset:12416
    v_mul_f32 v216, v216, v225
    v_mfma_f32_16x16x32_bf16 v[232:235], a[200:203], a[224:227], v[232:235]
    ds_read_b128 a[224:227], v242 offset:12544
    v_cvt_pk_bf16_f32 v228, v228, v229
    v_mfma_f32_16x16x32_bf16 v[232:235], a[204:207], a[228:231], v[232:235]
    ds_read_b128 a[228:231], v243 offset:12544
    v_cvt_pk_bf16_f32 v229, v230, v231
    v_mfma_f32_16x16x32_bf16 v[232:235], a[208:211], a[232:235], v[232:235]
    ds_write_b64 v249, v[228:229] offset:12416
    v_mfma_f32_16x16x32_bf16 v[232:235], a[212:215], a[236:239], v[232:235]
    ds_read_b128 a[232:235], v242 offset:6144
    ds_read_b128 a[236:239], v243 offset:6144
    v_mfma_f32_16x16x32_bf16 v[236:239], a[144:147], a[240:243], 0
    ds_write_b64 v247, v[212:213] offset:36864
    v_mfma_f32_16x16x32_bf16 v[212:215], v[18:21], v[188:191], 0
    s_waitcnt lgkmcnt(9)
    v_mul_f32 v217, v217, v225
    v_mul_f32 v218, v218, v225
    v_mfma_f32_16x16x32_bf16 v[200:203], v[120:123], v[174:177], v[200:203]
    v_cvt_pk_bf16_f32 v232, v232, v233
    v_cvt_pk_bf16_f32 v233, v234, v235
    v_mfma_f32_16x16x32_bf16 v[200:203], v[122:125], v[176:179], v[200:203]
    ds_write_b64 v249, v[232:233] offset:12544
    v_mfma_f32_16x16x32_bf16 v[204:207], v[156:159], v[174:177], v[204:207]
    s_waitcnt lgkmcnt(7)
    v_mul_f32 v219, v219, v225
    v_cvt_pk_bf16_f32 v216, v216, v217
    v_mfma_f32_16x16x32_bf16 v[204:207], v[158:161], v[176:179], v[204:207]
    s_waitcnt lgkmcnt(6)
    v_cvt_pk_bf16_f32 v217, v218, v219
    v_mul_f32 v220, v220, v225
    v_mfma_f32_16x16x32_bf16 v[236:239], a[148:151], a[244:247], v[236:239]
    ds_write_b64 v247, v[216:217] offset:36992
    v_mfma_f32_16x16x32_bf16 v[216:219], v[48:51], v[188:191], 0
    s_waitcnt lgkmcnt(5)
    v_mul_f32 v221, v221, v225
    v_mul_f32 v222, v222, v225
    v_mfma_f32_16x16x32_bf16 v[236:239], a[152:155], a[216:219], v[236:239]
    s_waitcnt lgkmcnt(4)
    v_mul_f32 v223, v223, v225
    v_cvt_pk_bf16_f32 v220, v220, v221
    v_mfma_f32_16x16x32_bf16 v[236:239], a[156:159], a[220:223], v[236:239]
    s_waitcnt lgkmcnt(3)
    v_cvt_pk_bf16_f32 v221, v222, v223
    v_max3_f32 v248, v248, v224, v225
    v_mfma_f32_16x16x32_bf16 v[224:227], a[248:251], v[188:191], 0
    ds_write_b64 v247, v[220:221] offset:37120
    v_mfma_f32_16x16x32_bf16 v[220:223], v[78:81], v[188:191], 0
    v_exp_f32 v210, v210
    v_mfma_f32_16x16x32_bf16 v[236:239], a[160:163], a[224:227], v[236:239]
    v_exp_f32 v211, v211
    v_mfma_f32_16x16x32_bf16 v[236:239], a[164:167], a[228:231], v[236:239]
    v_add_u32 v209, 0xfffff900, v245
    v_cvt_pk_bf16_f32 v192, v210, v211
    v_mfma_f32_16x16x32_bf16 v[228:231], a[168:171], a[240:243], 0
    v_cndmask_b32 v209, v244, v209, vcc
    v_add_u32 v210, 0xc0, v209
    v_mfma_f32_16x16x32_bf16 v[228:231], a[172:175], a[244:247], v[228:231]
    s_mov_b32 vcc_lo, 0xff00ff00
    v_add_u32 v209, 0x340, v209
    v_cvt_pk_bf16_f32 v236, v236, v237
    v_mfma_f32_16x16x32_bf16 v[228:231], a[176:179], a[216:219], v[228:231]
    s_mov_b32 vcc_hi, 0xff00ff00
    v_cvt_pk_bf16_f32 v237, v238, v239
    v_cndmask_b32 v244, v210, v209, vcc
    v_mfma_f32_16x16x32_bf16 v[228:231], a[180:183], a[220:223], v[228:231]
    ds_write_b64 v249, v[236:237] offset:18432
L_h8:
    s_cbranch_execz L_hback
    v_mfma_f32_16x16x32_bf16 v[228:231], a[184:187], a[224:227], v[228:231]
    s_mov_b32 vcc_lo, 0xf0f0
    v_exp_f32 v200, v200
    v_mfma_f32_16x16x32_bf16 v[228:231], a[188:191], a[228:231], v[228:231]
    s_mov_b32 vcc_hi, 0x0
    v_exp_f32 v201, v201
    v_mfma_f32_16x16x32_bf16 v[232:235], a[192:195], a[240:243], 0
    ds_read_b128 a[240:243], v242 offset:6272
    v_mov_b32 v208, 0x237c0
    v_mfma_f32_16x16x32_bf16 v[232:235], a[196:199], a[244:247], v[232:235]
    ds_read_b128 a[244:247], v243 offset:6272
    v_add_u32 v245, 0x700, v244
    v_mfma_f32_16x16x32_bf16 v[232:235], a[200:203], a[216:219], v[232:235]
    ds_read_b128 a[216:219], v242 offset:6400
    v_cvt_pk_bf16_f32 v228, v228, v229
    v_mfma_f32_16x16x32_bf16 v[232:235], a[204:207], a[220:223], v[232:235]
    ds_read_b128 a[220:223], v243 offset:6400
    v_cvt_pk_bf16_f32 v229, v230, v231
    v_mfma_f32_16x16x32_bf16 v[232:235], a[208:211], a[224:227], v[232:235]
    ds_write_b64 v249, v[228:229] offset:18560
    v_mfma_f32_16x16x32_bf16 v[232:235], a[212:215], a[228:231], v[232:235]
    ds_read_b128 a[224:227], v242 offset:18432
    ds_read_b128 a[228:231], v243 offset:18432
    v_mfma_f32_16x16x32_bf16 v[236:239], a[144:147], a[232:235], 0
    v_exp_f32 v202, v202
    v_mfma_f32_16x16x32_bf16 v[236:239], a[148:151], a[236:239], v[236:239]
    v_exp_f32 v203, v203
    v_mfma_f32_16x16x32_bf16 v[228:231], a[168:171], a[232:235], 0
    s_waitcnt lgkmcnt(6)
    v_cvt_pk_bf16_f32 v232, v232, v233
    v_cvt_pk_bf16_f32 v233, v234, v235
    v_mfma_f32_16x16x32_bf16 v[236:239], a[152:155], a[240:243], v[236:239]
    s_waitcnt lgkmcnt(5)
    v_cvt_pk_bf16_f32 v194, v200, v201
    v_cvt_pk_bf16_f32 v181, v202, v203
    v_mfma_f32_16x16x32_bf16 v[236:239], a[156:159], a[244:247], v[236:239]
    s_waitcnt lgkmcnt(4)
    v_cndmask_b32 v244, v244, v208, vcc
    v_mov_b32 v189, 0
    v_mfma_f32_16x16x32_bf16 v[236:239], a[160:163], a[216:219], v[236:239]
    s_waitcnt lgkmcnt(3)
    v_exp_f32 v204, v204
    v_mfma_f32_16x16x32_bf16 v[236:239], a[164:167], a[220:223], v[236:239]
    ds_write_b64 v249, v[232:233] offset:18688
    v_mfma_f32_16x16x32_bf16 v[228:231], a[172:175], a[236:239], v[228:231]
    s_mov_b32 vcc_lo, 0x0
    v_exp_f32 v205, v205
    v_mfma_f32_16x16x32_bf16 v[228:231], a[176:179], a[240:243], v[228:231]
    ds_read_b128 v[200:203], v244 offset:64
    v_cvt_pk_bf16_f32 v195, v204, v205
    v_mfma_f32_16x16x32_bf16 v[228:231], a[180:183], a[244:247], v[228:231]
    s_mov_b32 vcc_hi, 0xf0f0000
    v_cvt_pk_bf16_f32 v236, v236, v237
    v_cvt_pk_bf16_f32 v237, v238, v239
    v_mfma_f32_16x16x32_bf16 v[212:215], v[22:25], v[192:195], v[212:215]
    ds_write_b64 v249, v[236:237] offset:24576
    v_mfma_f32_16x16x32_bf16 v[216:219], v[52:55], v[192:195], v[216:219]
    s_waitcnt lgkmcnt(4)
    v_exp_f32 v196, v196
    v_mfma_f32_16x16x32_bf16 v[220:223], v[82:85], v[192:195], v[220:223]
    ds_read_b64 v[174:175], v247 offset:55296
    v_cndmask_b32 v245, v245, v208, vcc
    v_mfma_f32_16x16x32_bf16 v[224:227], a[248:251], v[192:195], v[224:227]
    ds_read_b128 v[208:211], v244 offset:0
    v_mov_b32 v192, 0
    v_mfma_f32_16x16x32_bf16 v[228:231], a[184:187], a[216:219], v[228:231]
    s_mov_b32 vcc_lo, 0xff000f
    v_exp_f32 v197, v197
    v_mfma_f32_16x16x32_bf16 v[228:231], a[188:191], a[220:223], v[228:231]
    s_mov_b32 vcc_hi, 0xff00ff
    v_exp_f32 v198, v198
    v_mfma_f32_16x16x32_bf16 v[232:235], a[192:195], a[232:235], 0
    ds_read_b128 a[232:235], v242 offset:18560
    v_cvt_pk_bf16_f32 v180, v196, v197
    v_mfma_f32_16x16x32_bf16 v[232:235], a[196:199], a[236:239], v[232:235]
    ds_read_b128 a[236:239], v243 offset:18560
    v_mov_b32 v195, 0
    v_mfma_f32_16x16x32_bf16 v[232:235], a[200:203], a[240:243], v[232:235]
    ds_read_b128 a[240:243], v242 offset:18688
    v_cvt_pk_bf16_f32 v228, v228, v229
    v_mfma_f32_16x16x32_bf16 v[232:235], a[204:207], a[244:247], v[232:235]
    ds_read_b128 a[244:247], v243 offset:18688
    v_cvt_pk_bf16_f32 v229, v230, v231
    v_mfma_f32_16x16x32_bf16 v[232:235], a[208:211], a[216:219], v[232:235]
    ds_write_b64 v249, v[228:229] offset:24704
    v_mfma_f32_16x16x32_bf16 v[232:235], a[212:215], a[220:223], v[232:235]
    s_waitcnt lgkmcnt(8)
    v_exp_f32 v199, v199
    v_mfma_f32_16x16x32_bf16 v[200:203], v[90:93], v[168:171], v[200:203]
    ds_read_b128 a[216:219], v242 offset:24576
    v_cvt_pk_bf16_f32 v183, v198, v199
    v_mfma_f32_16x16x32_bf16 v[200:203], v[92:95], v[170:173], v[200:203]
    s_waitcnt lgkmcnt(6)
    v_exp_f32 v206, v206
    v_mfma_f32_16x16x32_bf16 v[208:211], v[96:99], v[168:171], v[208:211]
    ds_read_b128 v[196:199], v245 offset:0
    v_cvt_pk_bf16_f32 v232, v232, v233
    v_mfma_f32_16x16x32_bf16 v[208:211], v[98:101], v[170:173], v[208:211]
    ds_read_b128 a[220:223], v243 offset:24576
    v_cvt_pk_bf16_f32 v233, v234, v235
    v_mfma_f32_16x16x32_bf16 v[236:239], a[144:147], a[224:227], 0
    ds_write_b64 v249, v[232:233] offset:24832
    v_mfma_f32_16x16x32_bf16 v[236:239], a[148:151], a[228:231], v[236:239]
    s_waitcnt lgkmcnt(8)
    v_exp_f32 v207, v207
    v_mfma_f32_16x16x32_bf16 v[236:239], a[152:155], a[232:235], v[236:239]
    s_waitcnt lgkmcnt(7)
    v_exp_f32 v208, v208
    v_mfma_f32_16x16x32_bf16 v[236:239], a[156:159], a[236:239], v[236:239]
    s_waitcnt lgkmcnt(6)
    v_exp_f32 v209, v209
    v_mfma_f32_16x16x32_bf16 v[236:239], a[160:163], a[240:243], v[236:239]
    s_waitcnt lgkmcnt(5)
    v_cvt_pk_bf16_f32 v182, v206, v207
    v_cvt_pk_bf16_f32 v184, v208, v209
    v_mfma_f32_16x16x32_bf16 v[236:239], a[164:167], a[244:247], v[236:239]
    ds_read_b128 v[204:207], v245 offset:64
    ds_read_b64 v[176:177], v247 offset:55424
    v_mfma_f32_16x16x32_bf16 v[212:215], v[26:29], v[180:183], v[212:215]
    s_waitcnt lgkmcnt(5)
    v_exp_f32 v210, v210
    v_mfma_f32_16x16x32_bf16 v[216:219], v[56:59], v[180:183], v[216:219]
    s_waitcnt lgkmcnt(4)
    v_exp_f32 v211, v211
    v_mfma_f32_16x16x32_bf16 v[220:223], v[86:89], v[180:183], v[220:223]
    s_waitcnt lgkmcnt(3)
    v_cvt_pk_bf16_f32 v236, v236, v237
    v_cvt_pk_bf16_f32 v237, v238, v239
    v_mfma_f32_16x16x32_bf16 v[224:227], a[248:251], v[180:183], v[224:227]
    v_cvt_pk_bf16_f32 v187, v210, v211
    v_mov_b32 v182, 0
    v_mfma_f32_16x16x32_bf16 v[196:199], v[132:135], v[168:171], v[196:199]
    ds_read_b128 v[208:211], v244 offset:128
    ds_read_b64 v[178:179], v247 offset:55552
    v_mfma_f32_16x16x32_bf16 v[196:199], v[134:137], v[170:173], v[196:199]
    buffer_store_dwordx4 a[252:255], v250, s[20:23], s51 offen nt
    v_mfma_f32_16x16x32_bf16 v[228:231], a[168:171], a[224:227], 0
    v_rcp_f32 v225, v224
    v_mfma_f32_16x16x32_bf16 v[228:231], a[172:175], a[228:231], v[228:231]
    s_waitcnt lgkmcnt(4)
    v_mul_f32 v212, v212, v225
    v_mul_f32 v213, v213, v225
    v_mfma_f32_16x16x32_bf16 v[228:231], a[176:179], a[232:235], v[228:231]
    s_barrier
    v_mfma_f32_16x16x32_bf16 v[228:231], a[180:183], a[236:239], v[228:231]
    ds_write_b64 v249, v[236:237] offset:0
    v_mfma_f32_16x16x32_bf16 v[228:231], a[184:187], a[240:243], v[228:231]
    s_waitcnt lgkmcnt(3)
    v_exp_f32 v196, v196
    v_mfma_f32_16x16x32_bf16 v[204:207], v[126:129], v[168:171], v[204:207]
    s_waitcnt lgkmcnt(2)
    v_exp_f32 v197, v197
    v_mfma_f32_16x16x32_bf16 v[204:207], v[128:131], v[170:173], v[204:207]
    s_waitcnt lgkmcnt(1)
    v_exp_f32 v198, v198
    v_mfma_f32_16x16x32_bf16 v[208:211], v[138:141], v[168:171], v[208:211]
    v_exp_f32 v199, v199
    v_mfma_f32_16x16x32_bf16 v[208:211], v[140:143], v[170:173], v[208:211]
    ds_read_b128 a[252:255], v252 offset:12288
    v_cvt_pk_bf16_f32 v185, v196, v197
    v_mfma_f32_16x16x32_bf16 v[228:231], a[188:191], a[244:247], v[228:231]
    v_cvt_pk_bf16_f32 v188, v198, v199
    v_mul_f32 v214, v214, v225
    v_mfma_f32_16x16x32_bf16 v[232:235], a[192:195], a[224:227], 0
    ds_read_b128 a[224:227], v242 offset:24704
    v_mul_f32 v215, v215, v225
    v_mfma_f32_16x16x32_bf16 v[232:235], a[196:199], a[228:231], v[232:235]
    ds_read_b128 a[228:231], v243 offset:24704
    v_cvt_pk_bf16_f32 v212, v212, v213
    v_mfma_f32_16x16x32_bf16 v[232:235], a[200:203], a[232:235], v[232:235]
    ds_read_b128 a[232:235], v242 offset:24832
    v_cvt_pk_bf16_f32 v228, v228, v229
    v_mfma_f32_16x16x32_bf16 v[232:235], a[204:207], a[236:239], v[232:235]
    ds_read_b128 a[236:239], v243 offset:24832
    v_cvt_pk_bf16_f32 v229, v230, v231
    v_mfma_f32_16x16x32_bf16 v[232:235], a[208:211], a[240:243], v[232:235]
    ds_write_b64 v249, v[228:229] offset:128
    v_mfma_f32_16x16x32_bf16 v[232:235], a[212:215], a[244:247], v[232:235]
    ds_read_b128 a[240:243], v242 offset:30720
    v_cvt_pk_bf16_f32 v213, v214, v215
    v_mfma_f32_16x16x32_bf16 v[236:239], a[144:147], a[216:219], 0
    ds_read_b128 a[244:247], v243 offset:30720
    v_mul_f32 v216, v216, v225
    v_mfma_f32_16x16x32_bf16 v[236:239], a[148:151], a[220:223], v[236:239]
    ds_read_b128 v[196:199], v245 offset:128
    v_mul_f32 v217, v217, v225
    v_mfma_f32_16x16x32_bf16 v[228:231], a[168:171], a[216:219], 0
    s_waitcnt lgkmcnt(7)
    v_cvt_pk_bf16_f32 v232, v232, v233
    v_cvt_pk_bf16_f32 v233, v234, v235
    v_mfma_f32_16x16x32_bf16 v[236:239], a[152:155], a[224:227], v[236:239]
    s_waitcnt lgkmcnt(6)
    v_mul_f32 v218, v218, v225
    v_mul_f32 v219, v219, v225
    v_mfma_f32_16x16x32_bf16 v[236:239], a[156:159], a[228:231], v[236:239]
    s_waitcnt lgkmcnt(5)
    v_cvt_pk_bf16_f32 v216, v216, v217
    v_cvt_pk_bf16_f32 v217, v218, v219
    v_mfma_f32_16x16x32_bf16 v[236:239], a[160:163], a[232:235], v[236:239]
    s_waitcnt lgkmcnt(4)
    v_mul_f32 v220, v220, v225
    v_mul_f32 v221, v221, v225
    v_mfma_f32_16x16x32_bf16 v[236:239], a[164:167], a[236:239], v[236:239]
    ds_write_b64 v249, v[232:233] offset:256
    v_mfma_f32_16x16x32_bf16 v[228:231], a[172:175], a[220:223], v[228:231]
    buffer_store_dwordx2 v[254:255], v251, s[20:23], s51 offen offset:256 nt
    v_mfma_f32_16x16x32_bf16 v[228:231], a[176:179], a[224:227], v[228:231]
    ds_read_b64 v[254:255], v253 offset:12544
    v_mul_f32 v222, v222, v225
    v_mfma_f32_16x16x32_bf16 v[228:231], a[180:183], a[228:231], v[228:231]
    ds_write_b64 v247, v[212:213] offset:43008
    v_mfma_f32_16x16x32_bf16 v[212:215], v[0:3], v[184:187], 0
    s_mul_i32 s51, s31, 3
    v_cvt_pk_bf16_f32 v236, v236, v237
    v_cvt_pk_bf16_f32 v237, v238, v239
    v_mfma_f32_16x16x32_bf16 v[228:231], a[184:187], a[232:235], v[228:231]
    ds_write_b64 v249, v[236:237] offset:6144
    v_mfma_f32_16x16x32_bf16 v[228:231], a[188:191], a[236:239], v[228:231]
    s_waitcnt lgkmcnt(6)
    v_mul_f32 v223, v223, v225
    v_cvt_pk_bf16_f32 v220, v220, v221
    v_mfma_f32_16x16x32_bf16 v[232:235], a[192:195], a[216:219], 0
    ds_read_b128 a[216:219], v242 offset:30848
    v_cvt_pk_bf16_f32 v221, v222, v223
    v_mfma_f32_16x16x32_bf16 v[232:235], a[196:199], a[220:223], v[232:235]
    ds_read_b128 a[220:223], v243 offset:30848
    v_cvt_pk_bf16_f32 v228, v228, v229
    v_mfma_f32_16x16x32_bf16 v[232:235], a[200:203], a[224:227], v[232:235]
    ds_read_b128 a[224:227], v242 offset:30976
    v_cvt_pk_bf16_f32 v229, v230, v231
    v_mfma_f32_16x16x32_bf16 v[232:235], a[204:207], a[228:231], v[232:235]
    ds_write_b64 v249, v[228:229] offset:6272
    v_mfma_f32_16x16x32_bf16 v[232:235], a[208:211], a[232:235], v[232:235]
    ds_read_b128 a[228:231], v243 offset:30976
    v_max3_f32 v248, v248, v224, v225
    v_mfma_f32_16x16x32_bf16 v[224:227], a[248:251], v[184:187], 0
    ds_write_b64 v247, v[216:217] offset:43136
    v_mfma_f32_16x16x32_bf16 v[216:219], v[30:33], v[184:187], 0
    ds_write_b64 v247, v[220:221] offset:43264
    v_mfma_f32_16x16x32_bf16 v[220:223], v[60:63], v[184:187], 0
    s_waitcnt lgkmcnt(9)
    v_exp_f32 v200, v200
    v_mfma_f32_16x16x32_bf16 v[196:199], v[144:147], v[168:171], v[196:199]
    buffer_store_dwordx4 a[252:255], v250, s[20:23], s53 offen nt
    v_mfma_f32_16x16x32_bf16 v[196:199], v[146:149], v[170:173], v[196:199]
    s_add_u32 s57, s57, s51
    v_exp_f32 v201, v201
    v_mfma_f32_16x16x32_bf16 v[232:235], a[212:215], a[236:239], v[232:235]
    ds_read_b128 a[252:255], v252 offset:18432
    v_cvt_pk_bf16_f32 v190, v200, v201
    v_mfma_f32_16x16x32_bf16 v[236:239], a[144:147], a[240:243], 0
    buffer_store_dwordx2 v[254:255], v251, s[20:23], s53 offen offset:256 nt
    v_mfma_f32_16x16x32_bf16 v[236:239], a[148:151], a[244:247], v[236:239]
    s_waitcnt lgkmcnt(7)
    v_exp_f32 v202, v202
    v_mfma_f32_16x16x32_bf16 v[236:239], a[152:155], a[216:219], v[236:239]
    s_waitcnt lgkmcnt(6)
    v_cvt_pk_bf16_f32 v232, v232, v233
    v_cvt_pk_bf16_f32 v233, v234, v235
    v_mfma_f32_16x16x32_bf16 v[236:239], a[156:159], a[220:223], v[236:239]
    s_waitcnt lgkmcnt(5)
    v_exp_f32 v203, v203
    v_mfma_f32_16x16x32_bf16 v[236:239], a[160:163], a[224:227], v[236:239]
    s_waitcnt lgkmcnt(3)
    ds_read_b64 v[254:255], v253 offset:18688
    v_mfma_f32_16x16x32_bf16 v[236:239], a[164:167], a[228:231], v[236:239]
    ds_write_b64 v249, v[232:233] offset:6400
    v_mfma_f32_16x16x32_bf16 v[228:231], a[168:171], a[240:243], 0
    ds_read_b128 a[232:235], v242 offset:0
    v_cvt_pk_bf16_f32 v193, v202, v203
    v_mfma_f32_16x16x32_bf16 v[228:231], a[172:175], a[244:247], v[228:231]
    s_add_u32 s57, s57, s32
    v_exp_f32 v204, v204
    v_mfma_f32_16x16x32_bf16 v[228:231], a[176:179], a[216:219], v[228:231]
    s_mul_i32 s53, s31, 11
    v_exp_f32 v205, v205
    v_mfma_f32_16x16x32_bf16 v[228:231], a[180:183], a[220:223], v[228:231]
    ds_read_b128 v[200:203], v244 offset:192
    v_cvt_pk_bf16_f32 v191, v204, v205
    v_mfma_f32_16x16x32_bf16 v[228:231], a[184:187], a[224:227], v[228:231]
    s_add_u32 s52, s52, s53
    v_exp_f32 v206, v206
    v_mfma_f32_16x16x32_bf16 v[212:215], v[4:7], v[188:191], v[212:215]
    s_add_u32 s52, s52, s32
    v_exp_f32 v207, v207
    v_mfma_f32_16x16x32_bf16 v[216:219], v[34:37], v[188:191], v[216:219]
    s_waitcnt lgkmcnt(4)
    v_cvt_pk_bf16_f32 v194, v206, v207
    v_cvt_pk_bf16_f32 v236, v236, v237
    v_mfma_f32_16x16x32_bf16 v[220:223], v[64:67], v[188:191], v[220:223]
    buffer_store_dwordx4 a[252:255], v250, s[20:23], s55 offen nt
    v_mfma_f32_16x16x32_bf16 v[224:227], a[248:251], v[188:191], v[224:227]
    s_waitcnt lgkmcnt(3)
    ds_read_b128 a[252:255], v252 offset:24576
    v_mfma_f32_16x16x32_bf16 v[212:215], v[8:11], v[192:195], v[212:215]
    ds_read_b128 a[236:239], v243 offset:0
    v_cvt_pk_bf16_f32 v237, v238, v239
    v_mfma_f32_16x16x32_bf16 v[216:219], v[38:41], v[192:195], v[216:219]
    buffer_store_dwordx2 v[254:255], v251, s[20:23], s55 offen offset:256 nt
    v_mfma_f32_16x16x32_bf16 v[220:223], v[68:71], v[192:195], v[220:223]
    ds_read_b64 v[254:255], v253 offset:24832
    ds_read_b128 v[204:207], v245 offset:192
    v_mfma_f32_16x16x32_bf16 v[224:227], a[248:251], v[192:195], v[224:227]
    s_mul_i32 s55, s31, 3
    v_exp_f32 v208, v208
    v_mfma_f32_16x16x32_bf16 v[228:231], a[188:191], a[228:231], v[228:231]
    s_waitcnt lgkmcnt(4)
    v_exp_f32 v209, v209
    v_mfma_f32_16x16x32_bf16 v[200:203], v[114:117], v[168:171], v[200:203]
    s_add_u32 s54, s54, s55
    v_cvt_pk_bf16_f32 v180, v208, v209
    v_add_u32 v208, 0xffffff40, v244
    v_mfma_f32_16x16x32_bf16 v[200:203], v[116:119], v[170:173], v[200:203]
    s_add_u32 s54, s54, s32
    v_cvt_pk_bf16_f32 v228, v228, v229
    v_cvt_pk_bf16_f32 v229, v230, v231
    v_mfma_f32_16x16x32_bf16 v[232:235], a[192:195], a[240:243], 0
    ds_read_b128 a[240:243], v242 offset:128
    v_cndmask_b32 v244, v244, v208, vcc
    v_mfma_f32_16x16x32_bf16 v[232:235], a[196:199], a[244:247], v[232:235]
    ds_read_b128 a[244:247], v243 offset:128
    v_add_u32 v209, 0xffffff40, v245
    v_mfma_f32_16x16x32_bf16 v[232:235], a[200:203], a[216:219], v[232:235]
    ds_read_b128 a[216:219], v242 offset:256
    v_mov_b32 v185, 0
    v_mfma_f32_16x16x32_bf16 v[232:235], a[204:207], a[220:223], v[232:235]
    ds_read_b128 a[220:223], v243 offset:256
    s_waitcnt lgkmcnt(5)
    v_mfma_f32_16x16x32_bf16 v[232:235], a[208:211], a[224:227], v[232:235]
    s_barrier
    v_mfma_f32_16x16x32_bf16 v[232:235], a[212:215], a[228:231], v[232:235]
    s_waitcnt lgkmcnt(4)
    v_exp_f32 v200, v200
    v_mfma_f32_16x16x32_bf16 v[204:207], v[150:153], v[168:171], v[204:207]
    ds_write_b64 v249, v[236:237] offset:12288
    v_mfma_f32_16x16x32_bf16 v[204:207], v[152:155], v[170:173], v[204:207]
    ds_write_b64 v249, v[228:229] offset:12416
    v_mfma_f32_16x16x32_bf16 v[236:239], a[144:147], a[232:235], 0
    s_mov_b32 vcc_lo, 0xff00ff
    v_cvt_pk_bf16_f32 v232, v232, v233
    v_cvt_pk_bf16_f32 v233, v234, v235
    v_mfma_f32_16x16x32_bf16 v[236:239], a[148:151], a[236:239], v[236:239]
    s_waitcnt lgkmcnt(5)
    v_exp_f32 v201, v201
    v_mfma_f32_16x16x32_bf16 v[236:239], a[152:155], a[240:243], v[236:239]
    s_waitcnt lgkmcnt(4)
    v_cvt_pk_bf16_f32 v186, v200, v201
    v_mov_b32 v190, 0
    v_mfma_f32_16x16x32_bf16 v[236:239], a[156:159], a[244:247], v[236:239]
    s_waitcnt lgkmcnt(3)
    v_exp_f32 v210, v210
    v_mfma_f32_16x16x32_bf16 v[236:239], a[160:163], a[216:219], v[236:239]
    s_waitcnt lgkmcnt(2)
    v_exp_f32 v211, v211
    v_mfma_f32_16x16x32_bf16 v[236:239], a[164:167], a[220:223], v[236:239]
    ds_write_b64 v249, v[232:233] offset:12544
    v_mfma_f32_16x16x32_bf16 v[228:231], a[168:171], a[232:235], 0
    s_mov_b32 vcc_hi, 0xf000ff
    v_exp_f32 v196, v196
    v_mfma_f32_16x16x32_bf16 v[228:231], a[172:175], a[236:239], v[228:231]
    s_add_u32 s51, s28, 3
    v_exp_f32 v197, v197
    v_mfma_f32_16x16x32_bf16 v[228:231], a[176:179], a[240:243], v[228:231]
    ds_read_b128 v[200:203], v244 offset:64
    v_cvt_pk_bf16_f32 v183, v210, v211
    v_mfma_f32_16x16x32_bf16 v[228:231], a[180:183], a[244:247], v[228:231]
    s_add_u32 s53, s28, 7
    v_cvt_pk_bf16_f32 v181, v196, v197
    v_cndmask_b32 v245, v245, v209, vcc
    v_mfma_f32_16x16x32_bf16 v[228:231], a[184:187], a[216:219], v[228:231]
    ds_read_b128 v[208:211], v244 offset:0
    v_cvt_pk_bf16_f32 v236, v236, v237
    v_mfma_f32_16x16x32_bf16 v[212:215], v[12:15], v[180:183], v[212:215]
    s_mul_i32 s51, s51, s30
    v_exp_f32 v198, v198
    v_mfma_f32_16x16x32_bf16 v[216:219], v[42:45], v[180:183], v[216:219]
    s_mul_i32 s53, s53, s30
    v_exp_f32 v199, v199
    v_mfma_f32_16x16x32_bf16 v[220:223], v[72:75], v[180:183], v[220:223]
    ds_read_b128 a[224:227], v242 offset:36864
    v_cvt_pk_bf16_f32 v184, v198, v199
    v_mfma_f32_16x16x32_bf16 v[224:227], a[248:251], v[180:183], v[224:227]
    ds_read_b128 v[196:199], v245 offset:0
    v_cvt_pk_bf16_f32 v237, v238, v239
    v_mfma_f32_16x16x32_bf16 v[228:231], a[188:191], a[220:223], v[228:231]
    s_add_u32 s55, s28, 11
    v_exp_f32 v204, v204
    v_mfma_f32_16x16x32_bf16 v[232:235], a[192:195], a[232:235], 0
    s_mul_i32 s55, s55, s30
    v_exp_f32 v205, v205
    v_mfma_f32_16x16x32_bf16 v[232:235], a[196:199], a[236:239], v[232:235]
    ds_read_b128 a[228:231], v243 offset:36864
    v_cvt_pk_bf16_f32 v187, v204, v205
    v_mfma_f32_16x16x32_bf16 v[232:235], a[200:203], a[240:243], v[232:235]
    ds_read_b128 v[204:207], v245 offset:64
    v_cvt_pk_bf16_f32 v228, v228, v229
    v_mfma_f32_16x16x32_bf16 v[212:215], v[16:19], v[184:187], v[212:215]
    ds_read_b128 a[232:235], v242 offset:36992
    v_cvt_pk_bf16_f32 v229, v230, v231
    v_mfma_f32_16x16x32_bf16 v[216:219], v[46:49], v[184:187], v[216:219]
    ds_read_b128 a[236:239], v243 offset:36992
    v_mov_b32 v193, 0
    v_mfma_f32_16x16x32_bf16 v[220:223], v[76:79], v[184:187], v[220:223]
    ds_read_b128 a[240:243], v242 offset:37120
    s_waitcnt lgkmcnt(8)
    v_mfma_f32_16x16x32_bf16 v[224:227], a[248:251], v[184:187], v[224:227]
    ds_write_b64 v249, v[236:237] offset:18432
    v_mfma_f32_16x16x32_bf16 v[200:203], v[114:117], v[174:177], v[200:203]
    s_waitcnt lgkmcnt(8)
    v_mov_b32 v180, 0
    v_mov_b32 v183, 0
    v_mfma_f32_16x16x32_bf16 v[208:211], v[138:141], v[174:177], v[208:211]
    ds_write_b64 v249, v[228:229] offset:18560
    v_mfma_f32_16x16x32_bf16 v[208:211], v[140:143], v[176:179], v[208:211]
    s_waitcnt lgkmcnt(7)
    v_rcp_f32 v225, v224
    v_mfma_f32_16x16x32_bf16 v[196:199], v[144:147], v[174:177], v[196:199]
    buffer_store_dwordx4 a[252:255], v250, s[20:23], s57 offen nt
    v_mfma_f32_16x16x32_bf16 v[196:199], v[146:149], v[176:179], v[196:199]
    s_waitcnt lgkmcnt(5)
    v_mul_f32 v212, v212, v225
    v_mul_f32 v213, v213, v225
    v_mfma_f32_16x16x32_bf16 v[200:203], v[116:119], v[176:179], v[200:203]
    s_waitcnt lgkmcnt(4)
    v_exp_f32 v208, v208
    v_mfma_f32_16x16x32_bf16 v[204:207], v[150:153], v[174:177], v[204:207]
    s_waitcnt lgkmcnt(3)
    v_exp_f32 v209, v209
    v_mfma_f32_16x16x32_bf16 v[204:207], v[152:155], v[176:179], v[204:207]
    s_waitcnt lgkmcnt(2)
    v_exp_f32 v210, v210
    v_mfma_f32_16x16x32_bf16 v[232:235], a[204:207], a[244:247], v[232:235]
    ds_read_b128 a[244:247], v243 offset:37120
    v_cvt_pk_bf16_f32 v188, v208, v209
    v_mfma_f32_16x16x32_bf16 v[232:235], a[208:211], a[216:219], v[232:235]
    ds_read_b128 a[216:219], v242 offset:43008
    v_mul_f32 v214, v214, v225
    v_mfma_f32_16x16x32_bf16 v[232:235], a[212:215], a[220:223], v[232:235]
    ds_read_b128 a[220:223], v243 offset:43008
    v_mul_f32 v215, v215, v225
    v_mfma_f32_16x16x32_bf16 v[236:239], a[144:147], a[224:227], 0
    v_exp_f32 v211, v211
    v_mfma_f32_16x16x32_bf16 v[236:239], a[148:151], a[228:231], v[236:239]
    ds_read_b128 a[252:255], v252 offset:0
    v_cvt_pk_bf16_f32 v191, v210, v211
    v_mfma_f32_16x16x32_bf16 v[236:239], a[152:155], a[232:235], v[236:239]
    ds_read_b128 v[208:211], v244 offset:128
    v_cvt_pk_bf16_f32 v232, v232, v233
    v_mfma_f32_16x16x32_bf16 v[236:239], a[156:159], a[236:239], v[236:239]
    v_cvt_pk_bf16_f32 v233, v234, v235
    v_cvt_pk_bf16_f32 v212, v212, v213
    v_mfma_f32_16x16x32_bf16 v[236:239], a[160:163], a[240:243], v[236:239]
    ds_write_b64 v249, v[232:233] offset:18688
    v_mfma_f32_16x16x32_bf16 v[228:231], a[168:171], a[224:227], 0
    s_waitcnt lgkmcnt(5)
    v_exp_f32 v196, v196
    v_mfma_f32_16x16x32_bf16 v[236:239], a[164:167], a[244:247], v[236:239]
    buffer_store_dwordx2 v[254:255], v251, s[20:23], s57 offen offset:256 nt
    v_mfma_f32_16x16x32_bf16 v[228:231], a[172:175], a[228:231], v[228:231]
    ds_read_b64 v[254:255], v253 offset:256
    v_cvt_pk_bf16_f32 v213, v214, v215
    v_mfma_f32_16x16x32_bf16 v[228:231], a[176:179], a[232:235], v[228:231]
    s_mul_i32 s57, s31, 7
    v_exp_f32 v197, v197
    v_mfma_f32_16x16x32_bf16 v[228:231], a[180:183], a[236:239], v[228:231]
    s_add_u32 s56, s56, s57
    v_cvt_pk_bf16_f32 v236, v236, v237
    v_cvt_pk_bf16_f32 v237, v238, v239
    v_mfma_f32_16x16x32_bf16 v[228:231], a[184:187], a[240:243], v[228:231]
    ds_write_b64 v249, v[236:237] offset:24576
    v_mfma_f32_16x16x32_bf16 v[228:231], a[188:191], a[244:247], v[228:231]
    s_waitcnt lgkmcnt(6)
    v_exp_f32 v198, v198
    v_mfma_f32_16x16x32_bf16 v[232:235], a[192:195], a[224:227], 0
    ds_read_b128 a[224:227], v242 offset:43136
    v_cvt_pk_bf16_f32 v189, v196, v197
    v_mfma_f32_16x16x32_bf16 v[232:235], a[196:199], a[228:231], v[232:235]
    ds_read_b128 a[228:231], v243 offset:43136
    v_mul_f32 v216, v216, v225
    v_mfma_f32_16x16x32_bf16 v[232:235], a[200:203], a[232:235], v[232:235]
    ds_read_b128 a[232:235], v242 offset:43264
    v_cvt_pk_bf16_f32 v228, v228, v229
    v_mfma_f32_16x16x32_bf16 v[232:235], a[204:207], a[236:239], v[232:235]
    ds_read_b128 a[236:239], v243 offset:43264
    v_cvt_pk_bf16_f32 v229, v230, v231
    v_mfma_f32_16x16x32_bf16 v[232:235], a[208:211], a[240:243], v[232:235]
    ds_write_b64 v249, v[228:229] offset:24704
    v_mfma_f32_16x16x32_bf16 v[232:235], a[212:215], a[244:247], v[232:235]
    s_waitcnt lgkmcnt(7)
    v_exp_f32 v199, v199
    v_mfma_f32_16x16x32_bf16 v[208:211], v[120:123], v[174:177], v[208:211]
    s_add_u32 s56, s56, s32
    v_cvt_pk_bf16_f32 v192, v198, v199
    v_mul_f32 v217, v217, v225
    v_mfma_f32_16x16x32_bf16 v[208:211], v[122:125], v[176:179], v[208:211]
    ds_read_b128 v[196:199], v245 offset:128
    v_mul_f32 v218, v218, v225
    v_mfma_f32_16x16x32_bf16 v[236:239], a[144:147], a[216:219], 0
    ds_write_b64 v247, v[212:213] offset:49152
    v_mfma_f32_16x16x32_bf16 v[212:215], v[12:15], v[188:191], 0
    s_waitcnt lgkmcnt(8)
    v_mul_f32 v219, v219, v225
    v_cvt_pk_bf16_f32 v216, v216, v217
    v_mfma_f32_16x16x32_bf16 v[236:239], a[148:151], a[220:223], v[236:239]
    s_waitcnt lgkmcnt(6)
    v_cvt_pk_bf16_f32 v217, v218, v219
    v_mul_f32 v220, v220, v225
    v_mfma_f32_16x16x32_bf16 v[236:239], a[152:155], a[224:227], v[236:239]
    s_waitcnt lgkmcnt(5)
    v_mul_f32 v221, v221, v225
    v_mul_f32 v222, v222, v225
    v_mfma_f32_16x16x32_bf16 v[236:239], a[156:159], a[228:231], v[236:239]
    ds_write_b64 v247, v[216:217] offset:49280
    v_mfma_f32_16x16x32_bf16 v[216:219], v[42:45], v[188:191], 0
    s_add_u32 s57, s28, 11
    v_mul_f32 v223, v223, v225
    v_cvt_pk_bf16_f32 v220, v220, v221
    v_mfma_f32_16x16x32_bf16 v[228:231], a[168:171], a[216:219], 0
    s_waitcnt lgkmcnt(5)
    v_cvt_pk_bf16_f32 v221, v222, v223
    v_max3_f32 v248, v248, v224, v225
    v_mfma_f32_16x16x32_bf16 v[224:227], a[248:251], v[188:191], 0
    ds_write_b64 v247, v[220:221] offset:49408
    v_mfma_f32_16x16x32_bf16 v[220:223], v[72:75], v[188:191], 0
    buffer_store_dwordx4 a[252:255], v250, s[20:23], s52 offen nt
    v_mfma_f32_16x16x32_bf16 v[236:239], a[160:163], a[232:235], v[236:239]
    s_waitcnt lgkmcnt(4)
    v_cvt_pk_bf16_f32 v232, v232, v233
    v_cvt_pk_bf16_f32 v233, v234, v235
    v_mfma_f32_16x16x32_bf16 v[236:239], a[164:167], a[236:239], v[236:239]
    ds_read_b128 a[252:255], v252 offset:6144
    s_waitcnt lgkmcnt(4)
    v_mfma_f32_16x16x32_bf16 v[196:199], v[156:159], v[174:177], v[196:199]
    buffer_store_dwordx2 v[254:255], v251, s[20:23], s52 offen offset:256 nt
    v_mfma_f32_16x16x32_bf16 v[196:199], v[158:161], v[176:179], v[196:199]
    ds_read_b64 v[254:255], v253 offset:6400
    v_mov_b32 v186, 0
    v_mfma_f32_16x16x32_bf16 v[228:231], a[172:175], a[220:223], v[228:231]
    ds_write_b64 v249, v[232:233] offset:24832
    v_mfma_f32_16x16x32_bf16 v[228:231], a[176:179], a[224:227], v[228:231]
    s_mul_i32 s52, s31, 15
    v_exp_f32 v200, v200
    v_mfma_f32_16x16x32_bf16 v[228:231], a[180:183], a[228:231], v[228:231]
    s_add_u32 s51, s51, s52
    v_exp_f32 v201, v201
    v_mfma_f32_16x16x32_bf16 v[228:231], a[184:187], a[232:235], v[228:231]
    s_add_u32 s51, s51, s32
    v_exp_f32 v204, v204
    v_mfma_f32_16x16x32_bf16 v[228:231], a[188:191], a[236:239], v[228:231]
    s_mul_i32 s57, s57, s30
    v_exp_f32 v205, v205
    v_mfma_f32_16x16x32_bf16 v[232:235], a[192:195], a[216:219], 0
    s_and_b32 s52, s28, 1
    v_cvt_pk_bf16_f32 v194, v200, v201
    v_cvt_pk_bf16_f32 v195, v204, v205
    v_mfma_f32_16x16x32_bf16 v[232:235], a[196:199], a[220:223], v[232:235]
    s_add_u32 s52, s52, 15
    v_exp_f32 v202, v202
    v_mfma_f32_16x16x32_bf16 v[212:215], v[16:19], v[192:195], v[212:215]
    s_waitcnt lgkmcnt(2)
    v_exp_f32 v203, v203
    v_mfma_f32_16x16x32_bf16 v[216:219], v[46:49], v[192:195], v[216:219]
    s_mul_i32 s52, s52, s30
    v_exp_f32 v206, v206
    v_mfma_f32_16x16x32_bf16 v[220:223], v[76:79], v[192:195], v[220:223]
    s_waitcnt lgkmcnt(0)
    s_barrier
    v_mfma_f32_16x16x32_bf16 v[224:227], a[248:251], v[192:195], v[224:227]
    ds_read_b128 a[240:243], v242 offset:49152
    ds_read_b128 a[244:247], v243 offset:49152
    v_mfma_f32_16x16x32_bf16 v[232:235], a[200:203], a[224:227], v[232:235]
    ds_read_b128 a[216:219], v242 offset:49280
    ds_read_b128 a[220:223], v243 offset:49280
    v_mfma_f32_16x16x32_bf16 v[232:235], a[204:207], a[228:231], v[232:235]
    ds_read_b128 a[224:227], v242 offset:49408
    ds_read_b128 a[228:231], v243 offset:49408
    v_mfma_f32_16x16x32_bf16 v[232:235], a[208:211], a[232:235], v[232:235]
    v_exp_f32 v207, v207
    v_mfma_f32_16x16x32_bf16 v[232:235], a[212:215], a[236:239], v[232:235]
    v_exp_f32 v208, v208
    v_exp_f32 v209, v209
    v_exp_f32 v210, v210
    v_exp_f32 v211, v211
    v_exp_f32 v196, v196
    v_exp_f32 v197, v197
    v_exp_f32 v198, v198
    v_exp_f32 v199, v199
    v_cvt_pk_bf16_f32 v181, v202, v203
    v_cvt_pk_bf16_f32 v182, v206, v207
    v_cvt_pk_bf16_f32 v184, v208, v209
    v_cvt_pk_bf16_f32 v187, v210, v211
    v_mfma_f32_16x16x32_bf16 v[212:215], v[20:23], v[180:183], v[212:215]
    s_waitcnt lgkmcnt(5)
    v_cvt_pk_bf16_f32 v185, v196, v197
    v_cvt_pk_bf16_f32 v188, v198, v199
    v_mfma_f32_16x16x32_bf16 v[216:219], v[50:53], v[180:183], v[216:219]
    s_waitcnt lgkmcnt(4)
    v_mov_b32 v189, 0
    v_mov_b32 v191, 0
    v_mfma_f32_16x16x32_bf16 v[220:223], v[80:83], v[180:183], v[220:223]
    buffer_store_dwordx4 a[252:255], v250, s[20:23], s54 offen nt
    v_mfma_f32_16x16x32_bf16 v[224:227], a[248:251], v[180:183], v[224:227]
    s_waitcnt lgkmcnt(1)
    ds_read_b128 a[252:255], v252 offset:12288
    v_mfma_f32_16x16x32_bf16 v[212:215], v[24:27], v[184:187], v[212:215]
    s_waitcnt lgkmcnt(1)
    v_cvt_pk_bf16_f32 v236, v236, v237
    v_cvt_pk_bf16_f32 v228, v228, v229
    v_mfma_f32_16x16x32_bf16 v[216:219], v[54:57], v[184:187], v[216:219]
    v_cvt_pk_bf16_f32 v232, v232, v233
L_h9:
    s_cbranch_execz L_hback
    v_cvt_pk_bf16_f32 v237, v238, v239
    v_mfma_f32_16x16x32_bf16 v[220:223], v[84:87], v[184:187], v[220:223]
    buffer_store_dwordx2 v[254:255], v251, s[20:23], s54 offen offset:256 nt
    v_mfma_f32_16x16x32_bf16 v[224:227], a[248:251], v[184:187], v[224:227]
    s_mul_i32 s54, s31, 13
    v_cvt_pk_bf16_f32 v229, v230, v231
    v_cvt_pk_bf16_f32 v233, v234, v235
    v_mfma_f32_16x16x32_bf16 v[212:215], v[28:31], v[188:191], v[212:215]
    ds_read_b64 v[254:255], v253 offset:12544
    s_add_u32 s53, s53, s54
    v_mfma_f32_16x16x32_bf16 v[216:219], v[58:61], v[188:191], v[216:219]
    ds_write_b64 v249, v[236:237] offset:0
    v_mfma_f32_16x16x32_bf16 v[220:223], v[88:91], v[188:191], v[220:223]
    ds_write_b64 v249, v[228:229] offset:128
    v_mfma_f32_16x16x32_bf16 v[224:227], a[248:251], v[188:191], v[224:227]
    ds_write_b64 v249, v[232:233] offset:256
    s_waitcnt lgkmcnt(4)
    buffer_store_dwordx4 a[252:255], v250, s[20:23], s56 offen nt
    s_add_u32 s53, s53, s32
    s_lshr_b32 s54, s28, 1
    ds_read_b128 a[252:255], v252 offset:18432
    s_sub_u32 s54, s54, 1
    s_nop 0
    v_rcp_f32 v225, v224
    v_mov_b32 v226, 0x5d800000
    v_mul_f32 v212, v212, v225
    v_mul_f32 v213, v213, v225
    v_mul_f32 v214, v214, v225
    v_mul_f32 v215, v215, v225
    v_cvt_pk_bf16_f32 v212, v212, v213
    v_mul_f32 v216, v216, v225
    v_mul_f32 v217, v217, v225
    v_cvt_pk_bf16_f32 v213, v214, v215
    v_mul_f32 v218, v218, v225
    v_mul_f32 v219, v219, v225
    v_cvt_pk_bf16_f32 v216, v216, v217
    v_mul_f32 v220, v220, v225
    v_mul_f32 v221, v221, v225
    ds_write_b64 v247, v[212:213] offset:55296
    v_cvt_pk_bf16_f32 v217, v218, v219
    v_mul_f32 v222, v222, v225
    v_mul_f32 v223, v223, v225
    v_cvt_pk_bf16_f32 v220, v220, v221
    ds_write_b64 v247, v[216:217] offset:55424
    v_cvt_pk_bf16_f32 v221, v222, v223
    ds_write_b64 v247, v[220:221] offset:55552
    v_mfma_f32_16x16x32_bf16 v[236:239], a[144:147], a[240:243], 0
    s_waitcnt lgkmcnt(5)
    v_max3_f32 v248, v248, v224, v225
    v_cmp_gt_f32 vcc, v248, v226
    v_mfma_f32_16x16x32_bf16 v[236:239], a[148:151], a[244:247], v[236:239]
    s_waitcnt lgkmcnt(3)
    s_cmp_lg_u64 vcc, 0
    s_cselect_b32 s66, 1, 0
    v_mov_b32 v225, s66
    v_mfma_f32_16x16x32_bf16 v[236:239], a[152:155], a[216:219], v[236:239]
    v_mov_b32 v226, s67
    v_mfma_f32_16x16x32_bf16 v[236:239], a[156:159], a[220:223], v[236:239]
    ds_write_b32 v226, v225 offset:0
    v_mfma_f32_16x16x32_bf16 v[236:239], a[160:163], a[224:227], v[236:239]
    buffer_store_dwordx2 v[254:255], v251, s[20:23], s56 offen offset:256 nt
    v_mfma_f32_16x16x32_bf16 v[236:239], a[164:167], a[228:231], v[236:239]
    ds_read_b64 v[254:255], v253 offset:18688
    v_mov_b32 v226, 0x23000
    v_mfma_f32_16x16x32_bf16 v[228:231], a[168:171], a[240:243], 0
    s_mul_i32 s56, s31, 11
    s_add_u32 s55, s55, s56
    s_add_u32 s55, s55, s32
    v_mfma_f32_16x16x32_bf16 v[228:231], a[172:175], a[244:247], v[228:231]
    s_lshr_b32 s56, s28, 1
    v_cvt_pk_bf16_f32 v236, v236, v237
    v_cvt_pk_bf16_f32 v237, v238, v239
    v_mfma_f32_16x16x32_bf16 v[228:231], a[176:179], a[216:219], v[228:231]
    ds_write_b64 v249, v[236:237] offset:6144
    v_mfma_f32_16x16x32_bf16 v[228:231], a[180:183], a[220:223], v[228:231]
    s_mov_b32 exec_hi, 0
    buffer_store_dwordx4 a[252:255], v250, s[20:23], s51 offen nt
    s_mov_b32 exec_hi, -1
    v_mfma_f32_16x16x32_bf16 v[228:231], a[184:187], a[224:227], v[228:231]
    s_waitcnt lgkmcnt(2)
    s_barrier
    v_mfma_f32_16x16x32_bf16 v[228:231], a[188:191], a[228:231], v[228:231]
    ds_read_b128 a[232:235], v242 offset:55296
    ds_read_b128 a[236:239], v243 offset:55296
    v_mfma_f32_16x16x32_bf16 v[232:235], a[192:195], a[240:243], 0
    ds_read_b128 a[240:243], v242 offset:55424
    s_waitcnt lgkmcnt(4)
    v_mfma_f32_16x16x32_bf16 v[232:235], a[196:199], a[244:247], v[232:235]
    ds_read_b128 a[244:247], v243 offset:55424
    ds_read_b128 v[196:199], v226 offset:0
    v_mfma_f32_16x16x32_bf16 v[232:235], a[200:203], a[216:219], v[232:235]
    ds_read_b128 a[216:219], v242 offset:55552
    v_cvt_pk_bf16_f32 v228, v228, v229
    v_mfma_f32_16x16x32_bf16 v[232:235], a[204:207], a[220:223], v[232:235]
    ds_read_b128 a[220:223], v243 offset:55552
    v_cvt_pk_bf16_f32 v229, v230, v231
    v_mfma_f32_16x16x32_bf16 v[232:235], a[208:211], a[224:227], v[232:235]
    ds_write_b64 v249, v[228:229] offset:6272
    v_mfma_f32_16x16x32_bf16 v[232:235], a[212:215], a[228:231], v[232:235]
    s_mov_b32 exec_lo, 0
    buffer_store_dwordx4 a[252:255], v250, s[20:23], s53 offen nt
    s_mov_b32 exec_lo, -1
    s_waitcnt lgkmcnt(7)
    v_mfma_f32_16x16x32_bf16 v[236:239], a[144:147], a[232:235], 0
    ds_read_b128 a[252:255], v252 offset:24576
    s_waitcnt lgkmcnt(7)
    v_mfma_f32_16x16x32_bf16 v[236:239], a[148:151], a[236:239], v[236:239]
    s_lshl2_add_u32 s56, s56, 11
    s_mul_i32 s56, s56, s31
    v_cvt_pk_bf16_f32 v232, v232, v233
    v_mfma_f32_16x16x32_bf16 v[228:231], a[168:171], a[232:235], 0
    s_waitcnt lgkmcnt(6)
    v_cvt_pk_bf16_f32 v233, v234, v235
    v_mfma_f32_16x16x32_bf16 v[236:239], a[152:155], a[240:243], v[236:239]
    ds_write_b64 v249, v[232:233] offset:6400
    v_mfma_f32_16x16x32_bf16 v[228:231], a[172:175], a[236:239], v[228:231]
    s_mov_b32 exec_hi, 0
    buffer_store_dwordx2 v[254:255], v251, s[20:23], s51 offen offset:256 nt
    s_mov_b32 exec_hi, -1
    v_mfma_f32_16x16x32_bf16 v[228:231], a[176:179], a[240:243], v[228:231]
    s_waitcnt lgkmcnt(6)
    s_mul_i32 s51, s31, 15
    s_add_u32 s57, s57, s51
    v_mfma_f32_16x16x32_bf16 v[236:239], a[156:159], a[244:247], v[236:239]
    s_waitcnt lgkmcnt(4)
    s_add_u32 s57, s57, s32
    v_or3_b32 v225, v196, v197, v198
    v_mfma_f32_16x16x32_bf16 v[236:239], a[160:163], a[216:219], v[236:239]
    s_waitcnt lgkmcnt(3)
    v_or_b32 v225, v225, v199
    v_mfma_f32_16x16x32_bf16 v[236:239], a[164:167], a[220:223], v[236:239]
    s_mov_b32 exec_lo, 0
    buffer_store_dwordx2 v[254:255], v251, s[20:23], s53 offen offset:256 nt
    s_mov_b32 exec_lo, -1
    v_mfma_f32_16x16x32_bf16 v[228:231], a[180:183], a[244:247], v[228:231]
    ds_read_b64 v[254:255], v253 offset:24832
    s_waitcnt lgkmcnt(2)
    v_mfma_f32_16x16x32_bf16 v[228:231], a[184:187], a[216:219], v[228:231]
    s_lshr_b32 s53, s28, 1
    v_readfirstlane_b32 s47, v225
    s_waitcnt lgkmcnt(1)
    v_mfma_f32_16x16x32_bf16 v[228:231], a[188:191], a[220:223], v[228:231]
    s_barrier
    v_mfma_f32_16x16x32_bf16 v[232:235], a[192:195], a[232:235], 0
    buffer_store_dwordx4 a[252:255], v250, s[20:23], s55 offen nt
    v_mfma_f32_16x16x32_bf16 v[232:235], a[196:199], a[236:239], v[232:235]
    s_lshl2_add_u32 s53, s53, 3
    v_cvt_pk_bf16_f32 v236, v236, v237
    v_cvt_pk_bf16_f32 v237, v238, v239
    v_mfma_f32_16x16x32_bf16 v[232:235], a[200:203], a[240:243], v[232:235]
    ds_read_b128 a[252:255], v252 offset:0
    v_cvt_pk_bf16_f32 v228, v228, v229
    v_mfma_f32_16x16x32_bf16 v[232:235], a[204:207], a[244:247], v[232:235]
    s_waitcnt lgkmcnt(1)
    v_cvt_pk_bf16_f32 v229, v230, v231
    s_mul_i32 s53, s53, s31
    v_mfma_f32_16x16x32_bf16 v[232:235], a[208:211], a[216:219], v[232:235]
    buffer_store_dwordx2 v[254:255], v251, s[20:23], s55 offen offset:256 nt
    v_mfma_f32_16x16x32_bf16 v[232:235], a[212:215], a[220:223], v[232:235]
    ds_write_b64 v249, v[236:237] offset:12288
    ds_write_b64 v249, v[228:229] offset:12416
    ds_read_b64 v[254:255], v253 offset:256
    s_and_b32 s55, s28, 1
    s_add_u32 s55, s55, 15
    s_mul_i32 s55, s55, s30
    s_add_u32 s52, s52, s53
    s_add_u32 s55, s55, s56
    v_cvt_pk_bf16_f32 v232, v232, v233
    v_cvt_pk_bf16_f32 v233, v234, v235
    ds_write_b64 v249, v[232:233] offset:12544
    s_waitcnt lgkmcnt(4)
    s_mov_b32 exec_hi, 0
    buffer_store_dwordx4 a[252:255], v250, s[20:23], s57 offen nt
    s_mov_b32 exec_hi, -1
    s_add_u32 s52, s52, s32
    s_add_u32 s55, s55, s32
    ds_read_b128 a[252:255], v252 offset:6144
    s_waitcnt lgkmcnt(2)
    s_mov_b32 exec_hi, 0
    buffer_store_dwordx2 v[254:255], v251, s[20:23], s57 offen offset:256 nt
    s_mov_b32 exec_hi, -1
    ds_read_b64 v[254:255], v253 offset:6400
    s_waitcnt lgkmcnt(2)
    s_barrier
    ds_read_b128 a[8:11], v252 offset:12288
    ds_read_b64 a[12:13], v253 offset:12544
    s_waitcnt lgkmcnt(3)
    buffer_store_dwordx4 a[252:255], v250, s[20:23], s52 offen nt
    s_waitcnt lgkmcnt(2)
    buffer_store_dwordx2 v[254:255], v251, s[20:23], s52 offen offset:256 nt
    s_waitcnt lgkmcnt(1)
    s_waitcnt lgkmcnt(0)
    s_mov_b32 exec_hi, s54
    buffer_store_dwordx4 a[8:11], v250, s[20:23], s55 offen nt
    s_mov_b32 exec_hi, -1
    s_mov_b32 exec_hi, s54
    buffer_store_dwordx2 a[12:13], v251, s[20:23], s55 offen offset:256 nt
    s_mov_b32 exec_hi, -1
    s_nop 4
    s_cmp_lg_u32 s47, 0
    s_cbranch_scc1 L_safe
L_exit:
    s_endpgm
L_safe:
    s_waitcnt vmcnt(0) lgkmcnt(0)
    s_nop 7
    s_barrier
    v_mbcnt_lo_u32_b32 v1, -1, 0
    v_mbcnt_hi_u32_b32 v1, -1, v1
    s_lshl_b32 s51, s28, 1
    s_add_u32 s50, s31, 0xfffffe80
    s_mul_i32 s52, s36, 0x1d00
    v_lshrrev_b32 v2, 3, v1
    v_and_b32 v3, 7, v1
    v_xor_b32 v3, s51, v3
    v_lshl_add_u32 v4, v2, 7, s52
    v_mul_u32_u24 v8, 11, v2
    v_bfe_u32 v9, v8, 6, 1
    v_lshrrev_b32 v8, 5, v8
    v_xor_b32 v9, v3, v9
    v_mad_i32_i24 v8, v8, s50, v4
    v_lshl_add_u32 v168, v9, 4, v8
    v_add_u32 v8, 8, v2
    v_mul_u32_u24 v8, 11, v8
    v_bfe_u32 v9, v8, 6, 1
    v_lshrrev_b32 v8, 5, v8
    v_xor_b32 v9, v3, v9
    v_mad_i32_i24 v8, v8, s50, v4
    v_lshl_add_u32 v169, v9, 4, v8
    v_add_u32 v8, 16, v2
    v_mul_u32_u24 v8, 11, v8
    v_bfe_u32 v9, v8, 6, 1
    v_lshrrev_b32 v8, 5, v8
    v_xor_b32 v9, v3, v9
    v_mad_i32_i24 v8, v8, s50, v4
    v_lshl_add_u32 v170, v9, 4, v8
    s_movk_i32 s53, 0x480
    s_movk_i32 s54, -96
    v_lshrrev_b32 v10, 1, v1
    v_lshlrev_b32 v12, 4, v1
    v_mul_u32_u24 v8, 43, v10
    v_lshrrev_b32 v9, 8, v8
    v_lshrrev_b32 v8, 7, v8
    v_and_b32 v9, 4, v9
    v_xor_b32 v9, v8, v9
    v_mad_i32_i24 v8, v8, s54, v12
    v_mad_u32_u24 v172, v9, s53, v8
    v_add_u32 v8, 32, v10
    v_mul_u32_u24 v8, 43, v8
    v_lshrrev_b32 v9, 8, v8
    v_lshrrev_b32 v8, 7, v8
    v_and_b32 v9, 4, v9
    v_xor_b32 v9, v8, v9
    v_mad_i32_i24 v8, v8, s54, v12
    v_mad_u32_u24 v173, v9, s53, v8
    v_add_u32 v8, 64, v10
    v_mul_u32_u24 v8, 43, v8
    v_lshrrev_b32 v9, 8, v8
    v_lshrrev_b32 v8, 7, v8
    v_and_b32 v9, 4, v9
    v_xor_b32 v9, v8, v9
    v_mad_i32_i24 v8, v8, s54, v12
    v_mad_u32_u24 v174, v9, s53, v8
L_safe2:
    s_add_u32 s59, s40, s45
    s_add_u32 m0, s46, 0xc00
    s_add_u32 s60, s39, 0x180
    buffer_load_dwordx4 v168, s[4:7], s59 offen lds
    s_add_u32 m0, s29, 0
    s_add_u32 s52, s40, 0
    buffer_load_dwordx4 v172, s[8:11], s60 offen lds
    s_add_u32 m0, s46, 0xc00
    v_add_u32 v5, s52, v168
    buffer_load_dwordx4 v169, s[4:7], s59 offen offset:1024 lds
    s_add_u32 m0, s29, 0
    v_max_i32 v5, 0, v5
    buffer_load_dwordx4 v173, s[8:11], s60 offen offset:1024 lds
    s_add_u32 m0, s46, 0xc00
    s_add_u32 s53, s40, 0x400
    buffer_load_dwordx4 v170, s[4:7], s59 offen offset:2048 lds
    s_add_u32 m0, s29, 0
    v_add_u32 v6, s53, v169
    buffer_load_dwordx4 v174, s[8:11], s60 offen offset:2048 lds
    s_add_u32 m0, s46, 0
    v_max_i32 v6, 0, v6
    buffer_load_dwordx4 v5, s[4:7], 0 offen lds
    s_add_u32 m0, s46, 0x400
    s_add_u32 s54, s40, 0x800
    buffer_load_dwordx4 v6, s[4:7], 0 offen lds
    v_add_u32 v7, s54, v170
    v_max_i32 v7, 0, v7
    s_add_u32 m0, s46, 0x800
    s_add_u32 s61, s39, 0x9180
    buffer_load_dwordx4 v7, s[4:7], 0 offen lds
    s_add_u32 m0, s29, 0xc00
    s_add_u32 s62, s39, 0x12180
    buffer_load_dwordx4 v172, s[8:11], s61 offen lds
    buffer_load_dwordx4 v173, s[8:11], s61 offen offset:1024 lds
    buffer_load_dwordx4 v174, s[8:11], s61 offen offset:2048 lds
    s_add_u32 m0, s29, 0x1800
    s_add_u32 s63, s39, 0x1b180
    s_add_u32 s59, s41, s45
    s_add_u32 s60, s39, 0x24180
    s_add_u32 s61, s39, 0x2d180
    s_and_b32 s65, s48, 0xfff0
    s_lshl1_add_u32 s58, s45, s40
    v_and_b32 v13, 15, v1
    v_lshrrev_b32 v14, 4, v1
    v_lshrrev_b32 v15, 2, v13
    v_and_b32 v16, 3, v13
    v_and_b32 v17, 1, v14
    v_lshl_add_u32 v18, v14, 3, v15
    v_xor_b32 v19, 0, v17
    v_lshl_add_u32 v19, v19, 2, v18
    v_mul_u32_u24 v19, 0x60, v19
    v_lshl_add_u32 v19, v16, 3, v19
    v_add_u32 v249, s29, v19
    v_xor_b32 v19, 1, v17
    v_lshl_add_u32 v19, v19, 2, v18
    v_mul_u32_u24 v19, 0x60, v19
    v_lshl_add_u32 v19, v16, 3, v19
    v_add_u32 v250, s29, v19
    v_mov_b32 v17, v15
    v_and_b32 v18, 3, v17
    v_mul_u32_u24 v17, 0x1e00, v17
    v_lshlrev_b32 v18, 1, v18
    v_bfe_u32 v241, v16, 1, 1
    v_or_b32 v18, v18, v241
    v_xor_b32 v18, v18, v14
    v_lshl_add_u32 v17, v18, 4, v17
    v_mul_u32_u24 v18, 0x180, v16
    v_add_u32 v240, v17, v18
    v_xor_b32 v241, 64, v240
    s_add_u32 s55, s28, 3
    s_mul_i32 s56, s31, 3
    s_mul_i32 s55, s55, s30
    s_add_u32 s55, s55, s56
    s_add_u32 s55, s55, s32
    s_add_u32 s57, s28, 3
    s_mul_i32 s51, s31, 11
    s_mul_i32 s57, s57, s30
    s_add_u32 s57, s57, s51
    s_add_u32 s57, s57, s32
    s_add_u32 s52, s28, 3
    s_mul_i32 s53, s31, 7
    s_mul_i32 s52, s52, s30
    s_add_u32 s52, s52, s53
    s_add_u32 s52, s52, s32
    s_add_u32 s54, s28, 7
    s_mul_i32 s54, s54, s30
    s_add_u32 s56, s28, 7
    s_mul_i32 s56, s56, s30
    s_add_u32 s51, s28, 7
    s_mul_i32 s51, s51, s30
    s_add_u32 s53, s28, 11
    s_mul_i32 s53, s53, s30
    buffer_load_dwordx4 v172, s[8:11], s62 offen lds
    buffer_load_dwordx4 v173, s[8:11], s62 offen offset:1024 lds
    buffer_load_dwordx4 v174, s[8:11], s62 offen offset:2048 lds
    s_add_u32 m0, s46, 0x7800
    s_add_u32 s62, s39, 0x300
    buffer_load_dwordx4 v168, s[4:7], s41 offen lds
    buffer_load_dwordx4 v169, s[4:7], s41 offen offset:1024 lds
    s_waitcnt vmcnt(12)
    s_barrier
    ds_read_b128 a[216:219], v240 offset:3072
    ds_read_b128 a[220:223], v240 offset:4608
    ds_read_b128 a[240:243], v241 offset:3072
    buffer_load_dwordx4 v170, s[4:7], s41 offen offset:2048 lds
    s_add_u32 m0, s29, 0x2400
    s_waitcnt vmcnt(12)
    ds_read_b64_tr_b16 a[0:1], v249 offset:0
    ds_read_b64_tr_b16 a[2:3], v250 offset:0
    ds_read_b64_tr_b16 a[24:25], v249 offset:32
    ds_read_b64_tr_b16 a[26:27], v250 offset:32
    ds_read_b64_tr_b16 a[48:49], v249 offset:64
    ds_read_b64_tr_b16 a[50:51], v250 offset:64
    ds_read_b128 a[244:247], v241 offset:4608
    buffer_load_dwordx4 v172, s[8:11], s63 offen lds
    buffer_load_dwordx4 v173, s[8:11], s63 offen offset:1024 lds
    s_waitcnt lgkmcnt(5)
    v_mfma_f32_16x16x32_bf16 v[180:183], a[0:3], a[216:219], 0
    v_mfma_f32_16x16x32_bf16 v[192:195], a[0:3], a[220:223], 0
    s_waitcnt lgkmcnt(3)
    v_mfma_f32_16x16x32_bf16 v[184:187], a[24:27], a[216:219], 0
    s_waitcnt lgkmcnt(1)
    v_mfma_f32_16x16x32_bf16 v[188:191], a[48:51], a[216:219], 0
    buffer_load_dwordx4 v174, s[8:11], s63 offen offset:2048 lds
    s_add_u32 m0, s46, 0x8400
    v_mfma_f32_16x16x32_bf16 v[196:199], a[24:27], a[220:223], 0
    s_add_u32 s63, s39, 0x9300
    s_waitcnt vmcnt(12)
    s_barrier
    v_mfma_f32_16x16x32_bf16 v[200:203], a[48:51], a[220:223], 0
    ds_read_b128 a[224:227], v240 offset:0
    buffer_load_dwordx4 v168, s[4:7], s59 offen lds
    ds_read_b128 a[228:231], v240 offset:1536
    ds_read_b128 a[232:235], v241 offset:0
    ds_read_b128 a[236:239], v241 offset:1536
    ds_read_b128 a[216:219], v240 offset:128
    ds_read_b128 a[220:223], v240 offset:1664
    buffer_load_dwordx4 v169, s[4:7], s59 offen offset:1024 lds
    s_waitcnt lgkmcnt(5)
    v_mfma_f32_16x16x32_bf16 v[204:207], a[0:3], a[224:227], 0
    v_mfma_f32_16x16x32_bf16 v[208:211], a[24:27], a[224:227], 0
    buffer_load_dwordx4 v170, s[4:7], s59 offen offset:2048 lds
    s_add_u32 m0, s29, 0
    v_mfma_f32_16x16x32_bf16 v[212:215], a[48:51], a[224:227], 0
    s_waitcnt vmcnt(12) lgkmcnt(4)
    s_add_u32 s59, s42, s45
    ds_read_b64_tr_b16 a[4:5], v249 offset:3072
    v_mfma_f32_16x16x32_bf16 v[216:219], a[0:3], a[228:231], 0
    ds_read_b64_tr_b16 a[6:7], v250 offset:3072
    ds_read_b64_tr_b16 a[28:29], v249 offset:3104
    v_mfma_f32_16x16x32_bf16 v[220:223], a[24:27], a[228:231], 0
    ds_read_b64_tr_b16 a[30:31], v250 offset:3104
    buffer_load_dwordx4 v172, s[8:11], s60 offen lds
    v_mfma_f32_16x16x32_bf16 v[224:227], a[48:51], a[228:231], 0
    ds_read_b64_tr_b16 a[52:53], v249 offset:3136
    ds_read_b64_tr_b16 a[54:55], v250 offset:3136
    ds_read_b128 a[224:227], v240 offset:3200
    ds_read_b128 a[228:231], v240 offset:4736
    buffer_load_dwordx4 v173, s[8:11], s60 offen offset:1024 lds
    s_waitcnt lgkmcnt(6)
    v_mfma_f32_16x16x32_bf16 v[204:207], a[4:7], a[232:235], v[204:207]
    v_mfma_f32_16x16x32_bf16 v[216:219], a[4:7], a[236:239], v[216:219]
    s_waitcnt lgkmcnt(4)
    v_mfma_f32_16x16x32_bf16 v[208:211], a[28:31], a[232:235], v[208:211]
    buffer_load_dwordx4 v174, s[8:11], s60 offen offset:2048 lds
    s_add_u32 m0, s29, 0xc00
    v_mfma_f32_16x16x32_bf16 v[220:223], a[28:31], a[236:239], v[220:223]
    s_waitcnt vmcnt(12) lgkmcnt(2)
    s_add_u32 s60, s39, 0x12300
    ds_read_b64_tr_b16 a[8:9], v249 offset:6144
    v_mfma_f32_16x16x32_bf16 v[212:215], a[52:55], a[232:235], v[212:215]
    ds_read_b64_tr_b16 a[10:11], v250 offset:6144
    ds_read_b64_tr_b16 a[32:33], v249 offset:6176
    v_mfma_f32_16x16x32_bf16 v[224:227], a[52:55], a[236:239], v[224:227]
    ds_read_b64_tr_b16 a[34:35], v250 offset:6176
    ds_read_b64_tr_b16 a[56:57], v249 offset:6208
    v_mfma_f32_16x16x32_bf16 v[180:183], a[4:7], a[240:243], v[180:183]
    buffer_load_dwordx4 v172, s[8:11], s61 offen lds
    ds_read_b64_tr_b16 a[58:59], v250 offset:6208
    v_mfma_f32_16x16x32_bf16 v[184:187], a[28:31], a[240:243], v[184:187]
    s_waitcnt lgkmcnt(6)
    v_mfma_f32_16x16x32_bf16 v[188:191], a[52:55], a[240:243], v[188:191]
    v_mfma_f32_16x16x32_bf16 v[192:195], a[4:7], a[244:247], v[192:195]
    v_mfma_f32_16x16x32_bf16 v[196:199], a[28:31], a[244:247], v[196:199]
    buffer_load_dwordx4 v173, s[8:11], s61 offen offset:1024 lds
    v_mfma_f32_16x16x32_bf16 v[200:203], a[52:55], a[244:247], v[200:203]
    s_waitcnt lgkmcnt(4)
    v_mfma_f32_16x16x32_bf16 v[204:207], a[8:11], a[216:219], v[204:207]
    v_mfma_f32_16x16x32_bf16 v[216:219], a[8:11], a[220:223], v[216:219]
    s_waitcnt lgkmcnt(2)
    v_mfma_f32_16x16x32_bf16 v[208:211], a[32:35], a[216:219], v[208:211]
    buffer_load_dwordx4 v174, s[8:11], s61 offen offset:2048 lds
    s_add_u32 m0, s37, 0xd80
    v_mfma_f32_16x16x32_bf16 v[220:223], a[32:35], a[220:223], v[220:223]
    s_add_u32 s61, s39, 0x1b300
    s_waitcnt vmcnt(12) lgkmcnt(0)
    s_barrier
    v_mfma_f32_16x16x32_bf16 v[212:215], a[56:59], a[216:219], v[212:215]
    ds_read_b128 a[232:235], v240 offset:30720
    buffer_load_dwordx4 v12, s[16:19], s65 offen lds
    v_mfma_f32_16x16x32_bf16 v[224:227], a[56:59], a[220:223], v[224:227]
    s_add_u32 m0, s29, 0x1800
    ds_read_b128 a[236:239], v240 offset:32256
    v_mfma_f32_16x16x32_bf16 v[180:183], a[8:11], a[224:227], v[180:183]
    ds_read_b128 a[240:243], v241 offset:30720
    ds_read_b128 a[244:247], v241 offset:32256
    v_mfma_f32_16x16x32_bf16 v[184:187], a[32:35], a[224:227], v[184:187]
    ds_read_b128 a[216:219], v240 offset:30848
    ds_read_b128 a[220:223], v240 offset:32384
    v_mfma_f32_16x16x32_bf16 v[188:191], a[56:59], a[224:227], v[188:191]
    buffer_load_dwordx4 v172, s[8:11], s62 offen lds
    ds_read_b128 a[224:227], v241 offset:128
    v_mfma_f32_16x16x32_bf16 v[192:195], a[8:11], a[228:231], v[192:195]
    v_mfma_f32_16x16x32_bf16 v[196:199], a[32:35], a[228:231], v[196:199]
    v_mfma_f32_16x16x32_bf16 v[200:203], a[56:59], a[228:231], v[200:203]
    ds_read_b128 a[228:231], v241 offset:1664
    s_waitcnt lgkmcnt(7)
    v_mfma_f32_16x16x32_bf16 v[228:231], a[0:3], a[232:235], 0
    v_mfma_f32_16x16x32_bf16 v[232:235], a[24:27], a[232:235], 0
    buffer_load_dwordx4 v173, s[8:11], s62 offen offset:1024 lds
    s_waitcnt vmcnt(12) lgkmcnt(6)
    v_mfma_f32_16x16x32_bf16 v[236:239], a[48:51], a[232:235], 0
    ds_read_b64_tr_b16 a[12:13], v249 offset:9216
    ds_read_b64_tr_b16 a[14:15], v250 offset:9216
    v_mfma_f32_16x16x32_bf16 v[138:141], a[0:3], a[236:239], 0
    ds_read_b64_tr_b16 a[36:37], v249 offset:9248
    ds_read_b64_tr_b16 a[38:39], v250 offset:9248
    v_mfma_f32_16x16x32_bf16 v[142:145], a[24:27], a[236:239], 0
    ds_read_b64_tr_b16 a[60:61], v249 offset:9280
    buffer_load_dwordx4 v174, s[8:11], s62 offen offset:2048 lds
    v_mfma_f32_16x16x32_bf16 v[146:149], a[48:51], a[236:239], 0
    s_waitcnt lgkmcnt(9)
    s_add_u32 m0, s29, 0x2400
    s_add_u32 s62, s39, 0x24300
    v_mfma_f32_16x16x32_bf16 v[228:231], a[4:7], a[240:243], v[228:231]
    ds_read_b64_tr_b16 a[62:63], v250 offset:9280
    ds_read_b128 a[232:235], v241 offset:3200
    v_mfma_f32_16x16x32_bf16 v[232:235], a[28:31], a[240:243], v[232:235]
    ds_read_b128 a[236:239], v241 offset:4736
    s_add_u32 s50, s31, 0xfffffe80
    v_mfma_f32_16x16x32_bf16 v[236:239], a[52:55], a[240:243], v[236:239]
    ds_read_b128 a[240:243], v241 offset:30848
    v_add_u32 v8, 4, v2
    v_mfma_f32_16x16x32_bf16 v[138:141], a[4:7], a[244:247], v[138:141]
    s_and_b32 s66, s28, 1
    v_mul_u32_u24 v8, 11, v8
    v_bfe_u32 v9, v8, 6, 1
    v_mfma_f32_16x16x32_bf16 v[142:145], a[28:31], a[244:247], v[142:145]
    s_lshl_b32 s66, s66, 2
    v_lshrrev_b32 v8, 5, v8
    v_xor_b32 v9, v3, v9
    v_mfma_f32_16x16x32_bf16 v[146:149], a[52:55], a[244:247], v[146:149]
    s_waitcnt lgkmcnt(5)
    ds_read_b128 a[244:247], v241 offset:32384
    v_mfma_f32_16x16x32_bf16 v[228:231], a[8:11], a[216:219], v[228:231]
    s_lshr_b32 s67, s28, 1
    s_waitcnt vmcnt(10)
    s_barrier
    v_mfma_f32_16x16x32_bf16 v[232:235], a[32:35], a[216:219], v[232:235]
    s_waitcnt lgkmcnt(3)
    buffer_load_dwordx4 v172, s[8:11], s63 offen lds
    v_mfma_f32_16x16x32_bf16 v[236:239], a[56:59], a[216:219], v[236:239]
    ds_read_b128 a[216:219], v240 offset:33792
    v_mad_i32_i24 v8, v8, s50, v4
    v_mfma_f32_16x16x32_bf16 v[138:141], a[8:11], a[220:223], v[138:141]
    s_lshl_b32 s67, s67, 3
    v_lshl_add_u32 v171, v9, 4, v8
    v_mbcnt_lo_u32_b32 v67, -1, 0
    v_mfma_f32_16x16x32_bf16 v[142:145], a[32:35], a[220:223], v[142:145]
    s_mul_i32 s64, s35, 0xfc0
    v_mbcnt_hi_u32_b32 v67, -1, v67
    v_lshrrev_b32 v68, 1, v67
    v_mfma_f32_16x16x32_bf16 v[146:149], a[56:59], a[220:223], v[146:149]
    buffer_load_dwordx4 v173, s[8:11], s63 offen offset:1024 lds
    ds_read_b128 a[220:223], v240 offset:35328
    v_mfma_f32_16x16x32_bf16 v[204:207], a[12:15], a[224:227], v[204:207]
    s_add_u32 s64, s64, s37
    v_add_u32 v68, 0, v68
    v_mul_u32_u24 v69, 43, v68
    v_mfma_f32_16x16x32_bf16 v[208:211], a[36:39], a[224:227], v[208:211]
    s_waitcnt lgkmcnt(2)
    v_lshrrev_b32 v70, 8, v69
    v_lshrrev_b32 v69, 7, v69
    v_mfma_f32_16x16x32_bf16 v[212:215], a[60:63], a[224:227], v[212:215]
    ds_read_b128 a[224:227], v241 offset:33792
    v_mad_i32_i24 v68, v69, -3, v68
    v_mfma_f32_16x16x32_bf16 v[216:219], a[12:15], a[228:231], v[216:219]
    buffer_load_dwordx4 v174, s[8:11], s63 offen offset:2048 lds
    s_add_u32 m0, s29, 0
    v_mfma_f32_16x16x32_bf16 v[220:223], a[36:39], a[228:231], v[220:223]
    s_add_u32 s63, s39, 0x2d300
    v_and_b32 v70, 4, v70
    v_xor_b32 v69, v69, v70
    v_mfma_f32_16x16x32_bf16 v[224:227], a[60:63], a[228:231], v[224:227]
    ds_read_b128 a[228:231], v241 offset:35328
    s_waitcnt vmcnt(10) lgkmcnt(3)
    v_mfma_f32_16x16x32_bf16 v[180:183], a[12:15], a[232:235], v[180:183]
    ds_read_b64_tr_b16 a[16:17], v249 offset:0
    ds_read_b64_tr_b16 a[18:19], v250 offset:0
    v_mfma_f32_16x16x32_bf16 v[184:187], a[36:39], a[232:235], v[184:187]
    ds_read_b64_tr_b16 a[40:41], v249 offset:32
    ds_read_b64_tr_b16 a[42:43], v250 offset:32
    v_mfma_f32_16x16x32_bf16 v[188:191], a[60:63], a[232:235], v[188:191]
    ds_read_b64_tr_b16 a[64:65], v249 offset:64
    ds_read_b64_tr_b16 a[66:67], v250 offset:64
    v_mfma_f32_16x16x32_bf16 v[192:195], a[12:15], a[236:239], v[192:195]
    ds_read_b128 a[232:235], v240 offset:33920
    v_and_b32 v70, 4, v69
    v_mfma_f32_16x16x32_bf16 v[196:199], a[36:39], a[236:239], v[196:199]
    s_waitcnt lgkmcnt(9)
    v_mul_u32_u24 v252, 24, v70
    v_lshrrev_b32 v70, 3, v69
    v_mfma_f32_16x16x32_bf16 v[200:203], a[60:63], a[236:239], v[200:203]
    ds_read_b128 a[236:239], v240 offset:35456
    v_lshl_add_u32 v252, v70, 2, v252
    v_mfma_f32_16x16x32_bf16 v[228:231], a[12:15], a[240:243], v[228:231]
    s_waitcnt lgkmcnt(9)
    v_and_or_b32 v252, v69, 3, v252
    v_mad_u32_u24 v252, v252, 3, v68
    v_mfma_f32_16x16x32_bf16 v[232:235], a[36:39], a[240:243], v[232:235]
    v_and_b32 v70, 1, v67
    v_lshl_add_u32 v252, v252, 3, v70
    v_mfma_f32_16x16x32_bf16 v[236:239], a[60:63], a[240:243], v[236:239]
    ds_read_b128 a[240:243], v241 offset:33920
    v_lshlrev_b32 v252, 4, v252
    v_mfma_f32_16x16x32_bf16 v[138:141], a[12:15], a[244:247], v[138:141]
    s_waitcnt lgkmcnt(8)
    v_lshrrev_b32 v68, 1, v67
    v_add_u32 v68, 32, v68
    v_mfma_f32_16x16x32_bf16 v[142:145], a[36:39], a[244:247], v[142:145]
    s_waitcnt lgkmcnt(6)
    v_mul_u32_u24 v69, 43, v68
    s_waitcnt lgkmcnt(3)
    v_mfma_f32_16x16x32_bf16 v[146:149], a[60:63], a[244:247], v[146:149]
    buffer_load_dwordx4 v172, s[8:11], s60 offen lds
    ds_read_b128 a[244:247], v241 offset:35456
    v_mfma_f32_16x16x32_bf16 v[150:153], a[0:3], a[216:219], 0
    s_waitcnt vmcnt(8)
    ds_read_b64_tr_b16 a[20:21], v249 offset:3072
    v_mfma_f32_16x16x32_bf16 v[154:157], a[24:27], a[216:219], 0
    ds_read_b64_tr_b16 a[22:23], v250 offset:3072
    ds_read_b64_tr_b16 a[44:45], v249 offset:3104
    v_mfma_f32_16x16x32_bf16 v[158:161], a[48:51], a[216:219], 0
    ds_read_b64_tr_b16 a[46:47], v250 offset:3104
    buffer_load_dwordx4 v173, s[8:11], s60 offen offset:1024 lds
    v_mfma_f32_16x16x32_bf16 v[162:165], a[0:3], a[220:223], 0
    ds_read_b64_tr_b16 a[68:69], v249 offset:3136
    ds_read_b64_tr_b16 a[70:71], v250 offset:3136
    v_mfma_f32_16x16x32_bf16 v[24:27], a[24:27], a[220:223], 0
    ds_read_b128 a[216:219], v240 offset:256
    v_lshrrev_b32 v70, 8, v69
    v_mfma_f32_16x16x32_bf16 v[54:57], a[48:51], a[220:223], 0
    ds_read_b128 a[220:223], v240 offset:1792
    v_lshrrev_b32 v69, 7, v69
    v_mfma_f32_16x16x32_bf16 v[150:153], a[4:7], a[224:227], v[150:153]
    buffer_load_dwordx4 v174, s[8:11], s60 offen offset:2048 lds
    s_add_u32 m0, s29, 0xc00
    v_mfma_f32_16x16x32_bf16 v[154:157], a[28:31], a[224:227], v[154:157]
    s_add_u32 s60, s39, 0
    v_mad_i32_i24 v68, v69, -3, v68
    v_and_b32 v70, 4, v70
    v_mfma_f32_16x16x32_bf16 v[158:161], a[52:55], a[224:227], v[158:161]
    ds_read_b128 a[224:227], v240 offset:3328
    v_xor_b32 v69, v69, v70
    v_mfma_f32_16x16x32_bf16 v[162:165], a[4:7], a[228:231], v[162:165]
    s_waitcnt lgkmcnt(10)
    v_and_b32 v70, 4, v69
    v_mul_u32_u24 v253, 24, v70
    v_mfma_f32_16x16x32_bf16 v[24:27], a[28:31], a[228:231], v[24:27]
    s_waitcnt lgkmcnt(7)
    v_lshrrev_b32 v70, 3, v69
    v_lshl_add_u32 v253, v70, 2, v253
    v_mfma_f32_16x16x32_bf16 v[54:57], a[52:55], a[228:231], v[54:57]
    ds_read_b128 a[228:231], v240 offset:4864
    s_waitcnt lgkmcnt(4)
    v_mfma_f32_16x16x32_bf16 v[150:153], a[8:11], a[232:235], v[150:153]
    buffer_load_dwordx4 v172, s[8:11], s61 offen lds
    v_and_or_b32 v253, v69, 3, v253
    v_mfma_f32_16x16x32_bf16 v[154:157], a[32:35], a[232:235], v[154:157]
    s_waitcnt lgkmcnt(3)
    v_mad_u32_u24 v253, v253, 3, v68
    v_and_b32 v70, 1, v67
    v_mfma_f32_16x16x32_bf16 v[158:161], a[56:59], a[232:235], v[158:161]
    ds_read_b128 a[232:235], v240 offset:30976
    v_lshl_add_u32 v253, v253, 3, v70
    v_mfma_f32_16x16x32_bf16 v[162:165], a[8:11], a[236:239], v[162:165]
    s_waitcnt lgkmcnt(3)
    v_lshlrev_b32 v253, 4, v253
    v_add_u32 v253, 0xfffffc00, v253
    v_mfma_f32_16x16x32_bf16 v[24:27], a[32:35], a[236:239], v[24:27]
    buffer_load_dwordx4 v173, s[8:11], s61 offen offset:1024 lds
    s_waitcnt vmcnt(8) lgkmcnt(2)
    v_mfma_f32_16x16x32_bf16 v[54:57], a[56:59], a[236:239], v[54:57]
    ds_read_b64_tr_b16 a[72:73], v249 offset:6144
    ds_read_b64_tr_b16 a[74:75], v250 offset:6144
    v_mfma_f32_16x16x32_bf16 v[150:153], a[12:15], a[240:243], v[150:153]
    ds_read_b64_tr_b16 a[96:97], v249 offset:6176
    ds_read_b64_tr_b16 a[98:99], v250 offset:6176
    v_mfma_f32_16x16x32_bf16 v[154:157], a[36:39], a[240:243], v[154:157]
    ds_read_b64_tr_b16 a[120:121], v249 offset:6208
    buffer_load_dwordx4 v174, s[8:11], s61 offen offset:2048 lds
    v_mfma_f32_16x16x32_bf16 v[158:161], a[60:63], a[240:243], v[158:161]
    s_add_u32 m0, s29, 0x1800
    s_add_u32 s61, s39, 0x9000
    ds_read_b64_tr_b16 a[122:123], v250 offset:6208
    v_mfma_f32_16x16x32_bf16 v[162:165], a[12:15], a[244:247], v[162:165]
    ds_read_b128 a[236:239], v240 offset:32512
    ds_read_b128 a[240:243], v240 offset:34048
    v_mfma_f32_16x16x32_bf16 v[24:27], a[36:39], a[244:247], v[24:27]
    s_waitcnt lgkmcnt(8)
    v_add_u32 v17, 3, v15
    v_add_u32 v19, 3, v16
    v_mfma_f32_16x16x32_bf16 v[54:57], a[60:63], a[244:247], v[54:57]
    ds_read_b128 a[244:247], v240 offset:35584
    v_and_b32 v18, 3, v17
    v_mfma_f32_16x16x32_bf16 v[204:207], a[16:19], a[216:219], v[204:207]
    v_mul_u32_u24 v17, 0x1e00, v17
    v_lshlrev_b32 v18, 1, v18
    v_mfma_f32_16x16x32_bf16 v[208:211], a[40:43], a[216:219], v[208:211]
    v_bfe_u32 v243, v19, 1, 1
    v_or_b32 v18, v18, v243
    v_mfma_f32_16x16x32_bf16 v[212:215], a[64:67], a[216:219], v[212:215]
    ds_read_b128 a[216:219], v241 offset:256
    v_xor_b32 v18, v18, v14
    v_mfma_f32_16x16x32_bf16 v[216:219], a[16:19], a[220:223], v[216:219]
    s_waitcnt lgkmcnt(6)
    v_lshl_add_u32 v17, v18, 4, v17
    v_mul_u32_u24 v18, 0x180, v19
    v_mfma_f32_16x16x32_bf16 v[220:223], a[40:43], a[220:223], v[220:223]
    s_waitcnt lgkmcnt(5)
    s_waitcnt lgkmcnt(4)
    buffer_load_dwordx4 v172, s[8:11], s62 offen lds
    v_mfma_f32_16x16x32_bf16 v[224:227], a[64:67], a[220:223], v[224:227]
    ds_read_b128 a[220:223], v241 offset:1792
    v_add_u32 v242, v17, v18
    v_mfma_f32_16x16x32_bf16 v[180:183], a[16:19], a[224:227], v[180:183]
    s_waitcnt lgkmcnt(3)
    v_xor_b32 v243, 64, v242
    v_accvgpr_write_b32 a252, v168
    v_mfma_f32_16x16x32_bf16 v[184:187], a[40:43], a[224:227], v[184:187]
    s_waitcnt lgkmcnt(2)
    v_accvgpr_read_b32 v254, a252
    v_accvgpr_write_b32 a253, v169
    v_mfma_f32_16x16x32_bf16 v[188:191], a[64:67], a[224:227], v[188:191]
    buffer_load_dwordx4 v173, s[8:11], s62 offen offset:1024 lds
    s_waitcnt vmcnt(8)
    v_mfma_f32_16x16x32_bf16 v[192:195], a[16:19], a[228:231], v[192:195]
    ds_read_b64_tr_b16 a[76:77], v249 offset:9216
    ds_read_b64_tr_b16 a[78:79], v250 offset:9216
    v_mfma_f32_16x16x32_bf16 v[196:199], a[40:43], a[228:231], v[196:199]
    ds_read_b64_tr_b16 a[100:101], v249 offset:9248
    ds_read_b64_tr_b16 a[102:103], v250 offset:9248
    v_mfma_f32_16x16x32_bf16 v[200:203], a[64:67], a[228:231], v[200:203]
    ds_read_b64_tr_b16 a[124:125], v249 offset:9280
    buffer_load_dwordx4 v174, s[8:11], s62 offen offset:2048 lds
    v_mfma_f32_16x16x32_bf16 v[228:231], a[16:19], a[232:235], v[228:231]
    s_add_u32 m0, s29, 0x2400
    s_add_u32 s62, s39, 0x12000
    ds_read_b64_tr_b16 a[126:127], v250 offset:9280
    v_mfma_f32_16x16x32_bf16 v[232:235], a[40:43], a[232:235], v[232:235]
    ds_read_b128 a[224:227], v241 offset:3328
    ds_read_b128 a[228:231], v241 offset:4864
    v_mfma_f32_16x16x32_bf16 v[236:239], a[64:67], a[232:235], v[236:239]
    ds_read_b128 a[232:235], v241 offset:30976
    v_accvgpr_read_b32 v255, a253
    v_mfma_f32_16x16x32_bf16 v[138:141], a[16:19], a[236:239], v[138:141]
    s_waitcnt lgkmcnt(9)
    v_accvgpr_write_b32 a254, v170
    v_accvgpr_write_b32 a255, v171
    v_mfma_f32_16x16x32_bf16 v[142:145], a[40:43], a[236:239], v[142:145]
    v_mov_b32 v17, 0x3f803f80
    v_accvgpr_write_b32 a248, v17
    v_mfma_f32_16x16x32_bf16 v[146:149], a[64:67], a[236:239], v[146:149]
    ds_read_b128 a[236:239], v241 offset:32512
    v_accvgpr_write_b32 a249, v17
    v_mfma_f32_16x16x32_bf16 v[150:153], a[16:19], a[240:243], v[150:153]
    s_waitcnt lgkmcnt(8)
    v_accvgpr_write_b32 a250, v17
    v_accvgpr_write_b32 a251, v17
    v_mfma_f32_16x16x32_bf16 v[154:157], a[40:43], a[240:243], v[154:157]
    s_waitcnt lgkmcnt(6)
    v_mov_b32 v248, 0
    v_lshrrev_b32 v18, 1, v13
    v_mfma_f32_16x16x32_bf16 v[158:161], a[64:67], a[240:243], v[158:161]
    ds_read_b128 a[240:243], v241 offset:34048
    s_waitcnt lgkmcnt(5)
    v_mfma_f32_16x16x32_bf16 v[162:165], a[16:19], a[244:247], v[162:165]
    buffer_load_dwordx4 v172, s[8:11], s63 offen lds
    v_xor_b32 v18, v14, v18
    v_mfma_f32_16x16x32_bf16 v[24:27], a[40:43], a[244:247], v[24:27]
    s_waitcnt lgkmcnt(4)
    v_xor_b32 v18, s66, v18
    v_mul_u32_u24 v17, 0x180, v13
    v_mfma_f32_16x16x32_bf16 v[54:57], a[64:67], a[244:247], v[54:57]
    ds_read_b128 a[244:247], v241 offset:35584
    v_lshl_add_u32 v17, v18, 4, v17
    v_mfma_f32_16x16x32_bf16 v[204:207], a[20:23], a[216:219], v[204:207]
    s_lshl_b32 s66, s36, 1
    v_add_u32 v17, s67, v17
    s_mul_i32 s67, s36, 3
    v_mfma_f32_16x16x32_bf16 v[208:211], a[44:47], a[216:219], v[208:211]
    buffer_load_dwordx4 v173, s[8:11], s63 offen offset:1024 lds
    v_add_u32 v247, 0x7800, v17
    v_mfma_f32_16x16x32_bf16 v[212:215], a[68:71], a[216:219], v[212:215]
    ds_read_b128 a[216:219], v240 offset:0
    v_cvt_pk_bf16_f32 v102, v204, v205
    v_mfma_f32_16x16x32_bf16 v[216:219], a[20:23], a[220:223], v[216:219]
    s_sub_u32 s66, 1, s66
    v_cvt_pk_bf16_f32 v103, v206, v207
    v_cvt_pk_bf16_f32 v104, v208, v209
    v_mfma_f32_16x16x32_bf16 v[220:223], a[44:47], a[220:223], v[220:223]
    s_waitcnt lgkmcnt(3)
    v_cvt_pk_bf16_f32 v105, v210, v211
    v_cvt_pk_bf16_f32 v106, v212, v213
    v_mfma_f32_16x16x32_bf16 v[224:227], a[68:71], a[220:223], v[224:227]
    buffer_load_dwordx4 v174, s[8:11], s63 offen offset:2048 lds
    s_add_u32 m0, s46, 0x1800
    v_mfma_f32_16x16x32_bf16 v[180:183], a[20:23], a[224:227], v[180:183]
    s_add_u32 s63, s39, 0x1b000
    s_waitcnt vmcnt(9) lgkmcnt(2)
    ds_read_b64_tr_b16 a[80:81], v249 offset:0
    v_mfma_f32_16x16x32_bf16 v[184:187], a[44:47], a[224:227], v[184:187]
    ds_read_b64_tr_b16 a[82:83], v250 offset:0
    ds_read_b64_tr_b16 a[104:105], v249 offset:32
    v_mfma_f32_16x16x32_bf16 v[188:191], a[68:71], a[224:227], v[188:191]
    ds_read_b64_tr_b16 a[106:107], v250 offset:32
    buffer_load_dwordx4 v168, s[4:7], s58 offen lds
    v_mfma_f32_16x16x32_bf16 v[192:195], a[20:23], a[228:231], v[192:195]
    ds_read_b64_tr_b16 a[128:129], v249 offset:64
    ds_read_b64_tr_b16 a[130:131], v250 offset:64
    v_mfma_f32_16x16x32_bf16 v[196:199], a[44:47], a[228:231], v[196:199]
    s_waitcnt lgkmcnt(6)
    v_cvt_pk_bf16_f32 v107, v214, v215
    v_cvt_pk_bf16_f32 v108, v216, v217
    v_mfma_f32_16x16x32_bf16 v[200:203], a[68:71], a[228:231], v[200:203]
    v_cvt_pk_bf16_f32 v109, v218, v219
    v_cvt_pk_bf16_f32 v110, v220, v221
    v_mfma_f32_16x16x32_bf16 v[228:231], a[20:23], a[232:235], v[228:231]
    buffer_load_dwordx4 v171, s[4:7], s58 offen offset:512 lds
    s_lshl1_add_u32 s58, s45, s41
    v_mfma_f32_16x16x32_bf16 v[232:235], a[44:47], a[232:235], v[232:235]
    s_add_u32 m0, s46, 0x9000
    v_cvt_pk_bf16_f32 v111, v222, v223
    v_cvt_pk_bf16_f32 v112, v224, v225
    v_mfma_f32_16x16x32_bf16 v[236:239], a[68:71], a[232:235], v[236:239]
    v_cvt_pk_bf16_f32 v113, v226, v227
    v_cvt_pk_bf16_f32 v90, v180, v181
    v_mfma_f32_16x16x32_bf16 v[138:141], a[20:23], a[236:239], v[138:141]
    s_waitcnt lgkmcnt(5)
    v_cvt_pk_bf16_f32 v91, v182, v183
    v_cvt_pk_bf16_f32 v92, v184, v185
    v_mfma_f32_16x16x32_bf16 v[142:145], a[44:47], a[236:239], v[142:145]
    buffer_load_dwordx4 v168, s[4:7], s58 offen lds
    v_cvt_pk_bf16_f32 v93, v186, v187
    v_mfma_f32_16x16x32_bf16 v[146:149], a[68:71], a[236:239], v[146:149]
    s_waitcnt lgkmcnt(2)
    v_cvt_pk_bf16_f32 v94, v188, v189
    v_cvt_pk_bf16_f32 v95, v190, v191
    v_mfma_f32_16x16x32_bf16 v[150:153], a[20:23], a[240:243], v[150:153]
    v_cvt_pk_bf16_f32 v96, v192, v193
    v_cvt_pk_bf16_f32 v97, v194, v195
    v_mfma_f32_16x16x32_bf16 v[154:157], a[44:47], a[240:243], v[154:157]
    s_waitcnt vmcnt(9)
    ds_read_b64_tr_b16 a[84:85], v249 offset:3072
    v_mfma_f32_16x16x32_bf16 v[158:161], a[68:71], a[240:243], v[158:161]
    buffer_load_dwordx4 v171, s[4:7], s58 offen offset:512 lds
    s_add_u32 m0, s46, 0xf000
    v_mfma_f32_16x16x32_bf16 v[162:165], a[20:23], a[244:247], v[162:165]
    s_lshl1_add_u32 s58, s45, s42
    ds_read_b64_tr_b16 a[86:87], v250 offset:3072
    v_mfma_f32_16x16x32_bf16 v[24:27], a[44:47], a[244:247], v[24:27]
    ds_read_b64_tr_b16 a[108:109], v249 offset:3104
    ds_read_b64_tr_b16 a[110:111], v250 offset:3104
    v_mfma_f32_16x16x32_bf16 v[54:57], a[68:71], a[244:247], v[54:57]
    ds_read_b64_tr_b16 a[132:133], v249 offset:3136
    buffer_load_dwordx4 v168, s[4:7], s42 offen lds
    v_mfma_f32_16x16x32_bf16 v[84:87], a[216:219], a[72:75], 0
    ds_read_b64_tr_b16 a[134:135], v250 offset:3136
    v_cvt_pk_bf16_f32 v98, v196, v197
    v_mfma_f32_16x16x32_bf16 v[204:207], a[216:219], a[96:99], 0
    s_waitcnt lgkmcnt(6)
    v_cvt_pk_bf16_f32 v99, v198, v199
    v_cvt_pk_bf16_f32 v100, v200, v201
    v_mfma_f32_16x16x32_bf16 v[208:211], a[216:219], a[120:123], 0
    v_cvt_pk_bf16_f32 v101, v202, v203
    v_cvt_pk_bf16_f32 v114, v228, v229
    v_cvt_pk_bf16_f32 v115, v230, v231
    v_cvt_pk_bf16_f32 v116, v232, v233
    buffer_load_dwordx4 v169, s[4:7], s42 offen offset:1024 lds
    v_cvt_pk_bf16_f32 v117, v234, v235
    v_cvt_pk_bf16_f32 v118, v236, v237
    v_cvt_pk_bf16_f32 v119, v238, v239
    v_cvt_pk_bf16_f32 v120, v138, v139
    v_cvt_pk_bf16_f32 v121, v140, v141
    v_cvt_pk_bf16_f32 v122, v142, v143
    v_cvt_pk_bf16_f32 v123, v144, v145
    v_cvt_pk_bf16_f32 v124, v146, v147
    v_cvt_pk_bf16_f32 v125, v148, v149
    v_cvt_pk_bf16_f32 v126, v150, v151
    v_cvt_pk_bf16_f32 v127, v152, v153
    v_cvt_pk_bf16_f32 v128, v154, v155
    v_cvt_pk_bf16_f32 v129, v156, v157
    buffer_load_dwordx4 v170, s[4:7], s42 offen offset:2048 lds
    s_add_u32 m0, s46, 0xfc00
    v_cvt_pk_bf16_f32 v130, v158, v159
    v_cvt_pk_bf16_f32 v131, v160, v161
    v_cvt_pk_bf16_f32 v132, v162, v163
    v_cvt_pk_bf16_f32 v133, v164, v165
    v_cvt_pk_bf16_f32 v134, v24, v25
    v_cvt_pk_bf16_f32 v135, v26, v27
    v_cvt_pk_bf16_f32 v136, v54, v55
    v_cvt_pk_bf16_f32 v137, v56, v57
    ds_read_b128 a[220:223], v240 offset:1536
    ds_read_b128 a[224:227], v240 offset:3072
    buffer_load_dwordx4 v168, s[4:7], s59 offen lds
    ds_read_b128 a[228:231], v240 offset:4608
    s_waitcnt vmcnt(11)
    ds_read_b64_tr_b16 a[88:89], v249 offset:6144
    ds_read_b64_tr_b16 a[90:91], v250 offset:6144
    ds_read_b64_tr_b16 a[112:113], v249 offset:6176
    ds_read_b64_tr_b16 a[114:115], v250 offset:6176
    ds_read_b64_tr_b16 a[136:137], v249 offset:6208
    buffer_load_dwordx4 v169, s[4:7], s59 offen offset:1024 lds
    ds_read_b64_tr_b16 a[138:139], v250 offset:6208
    ds_read_b128 a[232:235], v240 offset:30720
    ds_read_b128 a[236:239], v240 offset:32256
    ds_read_b128 a[240:243], v240 offset:33792
    ds_read_b128 a[244:247], v240 offset:35328
    ds_read_b128 a[216:219], v241 offset:0
    s_waitcnt lgkmcnt(13)
    v_mfma_f32_16x16x32_bf16 v[212:215], a[220:223], a[72:75], 0
    v_add_u32 v251, 0x1e000, v17
    v_sub_u32 v17, v14, v15
    v_mfma_f32_16x16x32_bf16 v[216:219], a[220:223], a[96:99], 0
    s_waitcnt lgkmcnt(12)
    v_mul_i32_i24 v17, 0x1c0, v17
    v_lshlrev_b32 v18, 4, v16
    v_mfma_f32_16x16x32_bf16 v[220:223], a[220:223], a[120:123], 0
    ds_read_b128 a[220:223], v241 offset:1536
    buffer_load_dwordx4 v170, s[4:7], s59 offen offset:2048 lds
    v_mfma_f32_16x16x32_bf16 v[224:227], a[224:227], a[72:75], 0
    s_add_u32 m0, s46, 0x10800
    s_add_u32 s59, s43, s45
    v_sub_u32 v17, v17, v18
    v_mfma_f32_16x16x32_bf16 v[180:183], a[224:227], a[96:99], 0
    s_waitcnt lgkmcnt(12)
    v_add_u32 v17, s37, v17
    v_max_u32 v18, s33, v15
    v_mfma_f32_16x16x32_bf16 v[184:187], a[224:227], a[120:123], 0
    ds_read_b128 a[224:227], v241 offset:3072
    v_sub_u32 v18, v14, v18
    v_mfma_f32_16x16x32_bf16 v[188:191], a[228:231], a[72:75], 0
    s_waitcnt lgkmcnt(6)
    v_add_u32 v244, 0, v18
    v_cmp_gt_u32 vcc, 7, v244
    v_mfma_f32_16x16x32_bf16 v[192:195], a[228:231], a[96:99], 0
    buffer_load_dwordx4 v168, s[4:7], s58 offen lds
    v_add_u32 v244, 0xfffdc870, v17
    v_mfma_f32_16x16x32_bf16 v[196:199], a[228:231], a[120:123], 0
    ds_read_b128 a[228:231], v241 offset:4608
    v_cndmask_b32 v244, 0, v244, vcc
    v_mfma_f32_16x16x32_bf16 v[200:203], a[232:235], a[72:75], 0
    s_waitcnt lgkmcnt(4)
    v_add_u32 v244, 0x237c0, v244
    v_add_u32 v245, 4, v18
    v_mfma_f32_16x16x32_bf16 v[228:231], a[232:235], a[96:99], 0
    s_waitcnt lgkmcnt(3)
    v_cmp_gt_u32 vcc, 7, v245
    v_add_u32 v245, 0xfffdcf70, v17
    v_mfma_f32_16x16x32_bf16 v[232:235], a[232:235], a[120:123], 0
    buffer_load_dwordx4 v171, s[4:7], s58 offen offset:512 lds
    s_add_u32 m0, s29, 0
    v_mfma_f32_16x16x32_bf16 v[236:239], a[236:239], a[72:75], 0
    s_waitcnt vmcnt(12) lgkmcnt(2)
    ds_read_b64_tr_b16 a[92:93], v249 offset:9216
    v_mfma_f32_16x16x32_bf16 v[138:141], a[236:239], a[96:99], 0
    ds_read_b64_tr_b16 a[94:95], v250 offset:9216
    ds_read_b64_tr_b16 a[116:117], v249 offset:9248
    v_mfma_f32_16x16x32_bf16 v[142:145], a[236:239], a[120:123], 0
    ds_read_b64_tr_b16 a[118:119], v250 offset:9248
    ds_read_b64_tr_b16 a[140:141], v249 offset:9280
    v_mfma_f32_16x16x32_bf16 v[146:149], a[240:243], a[72:75], 0
    buffer_load_dwordx4 v172, s[8:11], s60 offen lds
    ds_read_b64_tr_b16 a[142:143], v250 offset:9280
    v_mfma_f32_16x16x32_bf16 v[150:153], a[240:243], a[96:99], 0
    ds_read_b128 a[232:235], v241 offset:30720
    ds_read_b128 a[236:239], v241 offset:32256
    v_mfma_f32_16x16x32_bf16 v[154:157], a[240:243], a[120:123], 0
    ds_read_b128 a[240:243], v241 offset:33792
    s_lshl1_add_u32 s58, s45, s43
    v_mfma_f32_16x16x32_bf16 v[158:161], a[244:247], a[72:75], 0
    s_waitcnt lgkmcnt(9)
    v_cndmask_b32 v245, 0, v245, vcc
    v_add_u32 v245, 0x237c0, v245
    v_mfma_f32_16x16x32_bf16 v[162:165], a[244:247], a[96:99], 0
    v_add_u32 v246, 8, v18
    v_cmp_gt_u32 vcc, 7, v246
    v_mfma_f32_16x16x32_bf16 v[24:27], a[244:247], a[120:123], 0
    ds_read_b128 a[244:247], v241 offset:35328
    v_add_u32 v246, 0xfffdd670, v17
    v_mfma_f32_16x16x32_bf16 v[84:87], a[216:219], a[76:79], v[84:87]
    s_waitcnt lgkmcnt(9)
    buffer_load_dwordx4 v173, s[8:11], s60 offen offset:1024 lds
    v_mfma_f32_16x16x32_bf16 v[204:207], a[216:219], a[100:103], v[204:207]
    s_waitcnt lgkmcnt(7)
    v_cndmask_b32 v246, 0, v246, vcc
    v_add_u32 v246, 0x237c0, v246
    v_mfma_f32_16x16x32_bf16 v[208:211], a[216:219], a[124:127], v[208:211]
    ds_read_b128 a[216:219], v240 offset:128
    v_min_u32 v20, 55, v1
    v_mfma_f32_16x16x32_bf16 v[212:215], a[220:223], a[76:79], v[212:215]
    s_waitcnt lgkmcnt(4)
    v_lshlrev_b32 v62, 3, v20
    v_add_u32 v62, s64, v62
    v_mfma_f32_16x16x32_bf16 v[216:219], a[220:223], a[100:103], v[216:219]
    s_and_b32 s64, s48, 15
    v_lshrrev_b32 v21, 1, v20
    v_and_b32 v20, 1, v20
    v_mfma_f32_16x16x32_bf16 v[220:223], a[220:223], a[124:127], v[220:223]
    ds_read_b128 a[220:223], v240 offset:1664
    v_lshlrev_b32 v20, 1, v20
    v_mfma_f32_16x16x32_bf16 v[224:227], a[224:227], a[76:79], v[224:227]
    s_add_u32 s64, s64, s37
    s_waitcnt vmcnt(10) lgkmcnt(3)
    s_barrier
    v_mfma_f32_16x16x32_bf16 v[180:183], a[224:227], a[100:103], v[180:183]
    buffer_load_dwordx4 v174, s[8:11], s60 offen offset:2048 lds
    s_add_u32 m0, s29, 0xc00
    v_mfma_f32_16x16x32_bf16 v[184:187], a[224:227], a[124:127], v[184:187]
    s_add_u32 s60, s39, 0x24000
    ds_read_b128 a[224:227], v240 offset:3200
    v_mfma_f32_16x16x32_bf16 v[188:191], a[228:231], a[76:79], v[188:191]
    s_waitcnt lgkmcnt(2)
    v_add_u32 v22, -12, v21
    v_cmp_lt_u32 vcc, 11, v21
    v_mfma_f32_16x16x32_bf16 v[192:195], a[228:231], a[100:103], v[192:195]
    v_mov_b32 v23, s34
    v_cndmask_b32 v22, v21, v22, vcc
    v_mfma_f32_16x16x32_bf16 v[196:199], a[228:231], a[124:127], v[196:199]
    ds_read_b128 a[228:231], v240 offset:4736
    v_cndmask_b32 v23, 0, v23, vcc
    v_mfma_f32_16x16x32_bf16 v[200:203], a[232:235], a[76:79], v[200:203]
    s_waitcnt lgkmcnt(2)
    v_add_u32 v63, 0, v20
    v_add3_u32 v64, v22, v63, -6
    v_mfma_f32_16x16x32_bf16 v[228:231], a[232:235], a[100:103], v[228:231]
    v_add_u32 v65, 3, v64
    v_and_b32 v66, 12, v22
    v_mfma_f32_16x16x32_bf16 v[232:235], a[232:235], a[124:127], v[232:235]
    buffer_load_dwordx4 v172, s[8:11], s61 offen lds
    ds_read_b128 a[232:235], v240 offset:30848
    v_mfma_f32_16x16x32_bf16 v[236:239], a[236:239], a[76:79], v[236:239]
    v_add3_u32 v66, v66, v63, -3
    v_cmp_ne_u32 vcc, 0, v23
    v_mfma_f32_16x16x32_bf16 v[138:141], a[236:239], a[100:103], v[138:141]
    v_mul_i32_i24 v64, s66, v64
    v_cndmask_b32 v65, v65, v66, vcc
    v_mfma_f32_16x16x32_bf16 v[142:145], a[236:239], a[124:127], v[142:145]
    ds_read_b128 a[236:239], v240 offset:32384
    v_cmp_gt_u32 vcc, 7, v65
    v_mfma_f32_16x16x32_bf16 v[146:149], a[240:243], a[76:79], v[146:149]
    s_waitcnt lgkmcnt(3)
    v_add_lshl_u32 v64, v64, 6, 1
    v_cndmask_b32 v50, 0, v64, vcc
    v_mfma_f32_16x16x32_bf16 v[150:153], a[240:243], a[100:103], v[150:153]
    s_waitcnt lgkmcnt(2)
    v_mov_b32 v64, 0x3fb8aa3b
    v_cndmask_b32 v52, 0, v64, vcc
    v_mfma_f32_16x16x32_bf16 v[154:157], a[240:243], a[124:127], v[154:157]
    ds_read_b128 a[240:243], v240 offset:33920
    v_mov_b32 v64, 0
    v_mfma_f32_16x16x32_bf16 v[158:161], a[244:247], a[76:79], v[158:161]
    v_mov_b32 v65, 0xf149f2ca
    v_cndmask_b32 v60, v65, v64, vcc
    v_mfma_f32_16x16x32_bf16 v[162:165], a[244:247], a[100:103], v[162:165]
    v_add_u32 v63, 1, v20
    v_add3_u32 v64, v22, v63, -6
    v_mfma_f32_16x16x32_bf16 v[24:27], a[244:247], a[124:127], v[24:27]
    ds_read_b128 a[244:247], v240 offset:35456
    v_add_u32 v65, 3, v64
    v_mfma_f32_16x16x32_bf16 v[84:87], a[216:219], a[80:83], v[84:87]
    s_waitcnt lgkmcnt(3)
    v_and_b32 v66, 12, v22
    v_add3_u32 v66, v66, v63, -3
    v_mfma_f32_16x16x32_bf16 v[204:207], a[216:219], a[104:107], v[204:207]
    v_cmp_ne_u32 vcc, 0, v23
    v_mul_i32_i24 v64, s66, v64
    v_mfma_f32_16x16x32_bf16 v[208:211], a[216:219], a[128:131], v[208:211]
    ds_read_b128 a[216:219], v241 offset:128
    s_mul_i32 s66, s28, 0xffffee00
    v_mfma_f32_16x16x32_bf16 v[212:215], a[220:223], a[80:83], v[212:215]
    s_waitcnt lgkmcnt(3)
    v_cndmask_b32 v65, v65, v66, vcc
    v_cmp_gt_u32 vcc, 7, v65
    v_mfma_f32_16x16x32_bf16 v[216:219], a[220:223], a[104:107], v[216:219]
    v_add_lshl_u32 v64, v64, 6, 1
    v_cndmask_b32 v51, 0, v64, vcc
    v_mfma_f32_16x16x32_bf16 v[220:223], a[220:223], a[128:131], v[220:223]
    ds_read_b128 a[220:223], v241 offset:1664
    v_mov_b32 v64, 0x3fb8aa3b
    v_mfma_f32_16x16x32_bf16 v[224:227], a[224:227], a[80:83], v[224:227]
    s_waitcnt lgkmcnt(3)
    v_cndmask_b32 v53, 0, v64, vcc
    v_mov_b32 v64, 0
    v_mfma_f32_16x16x32_bf16 v[180:183], a[224:227], a[104:107], v[180:183]
    v_mov_b32 v65, 0xf149f2ca
    v_cndmask_b32 v61, v65, v64, vcc
    v_mfma_f32_16x16x32_bf16 v[184:187], a[224:227], a[128:131], v[184:187]
    ds_read_b128 a[224:227], v241 offset:3200
    s_mov_b32 vcc_lo, 0xcccccccc
    v_mfma_f32_16x16x32_bf16 v[188:191], a[228:231], a[80:83], v[188:191]
    s_mov_b32 vcc_hi, 0xcccccccc
    v_add_u32 v50, s64, v50
    v_add_u32 v51, s64, v51
    v_mfma_f32_16x16x32_bf16 v[192:195], a[228:231], a[104:107], v[192:195]
    ds_read_u16 v30, v50 offset:3456
    ds_read_u16 v31, v51 offset:3456
    v_mfma_f32_16x16x32_bf16 v[196:199], a[228:231], a[128:131], v[196:199]
    ds_read_b128 a[228:231], v241 offset:4736
    ds_read_u16 v32, v50 offset:3482
    v_mfma_f32_16x16x32_bf16 v[200:203], a[232:235], a[80:83], v[200:203]
    ds_read_u16 v33, v51 offset:3482
    ds_read_u16 v34, v50 offset:3508
    v_mfma_f32_16x16x32_bf16 v[228:231], a[232:235], a[104:107], v[228:231]
    ds_read_u16 v35, v51 offset:3508
    ds_read_u16 v36, v50 offset:3534
    v_mfma_f32_16x16x32_bf16 v[232:235], a[232:235], a[128:131], v[232:235]
    ds_read_b128 a[232:235], v241 offset:30848
    ds_read_u16 v37, v51 offset:3534
    v_mfma_f32_16x16x32_bf16 v[236:239], a[236:239], a[80:83], v[236:239]
    ds_read_u16 v38, v50 offset:3560
    ds_read_u16 v39, v51 offset:3560
    v_mfma_f32_16x16x32_bf16 v[138:141], a[236:239], a[104:107], v[138:141]
    ds_read_u16 v40, v50 offset:3586
    ds_read_u16 v41, v51 offset:3586
    v_mfma_f32_16x16x32_bf16 v[142:145], a[236:239], a[128:131], v[142:145]
    ds_read_b128 a[236:239], v241 offset:32384
    ds_read_u16 v42, v50 offset:3612
    v_mfma_f32_16x16x32_bf16 v[146:149], a[240:243], a[80:83], v[146:149]
    ds_read_u16 v43, v51 offset:3612
    ds_read_u16 v44, v50 offset:3638
    v_mfma_f32_16x16x32_bf16 v[150:153], a[240:243], a[104:107], v[150:153]
    ds_read_u16 v45, v51 offset:3638
    ds_read_u16 v46, v50 offset:3664
    v_mfma_f32_16x16x32_bf16 v[154:157], a[240:243], a[128:131], v[154:157]
    s_waitcnt lgkmcnt(12)
    ds_read_b128 a[240:243], v241 offset:33920
    v_mfma_f32_16x16x32_bf16 v[158:161], a[244:247], a[80:83], v[158:161]
    ds_read_u16 v47, v51 offset:3664
    ds_read_u16 v48, v50 offset:3690
    v_mfma_f32_16x16x32_bf16 v[162:165], a[244:247], a[104:107], v[162:165]
    ds_read_u16 v49, v51 offset:3690
    v_lshlrev_b32 v30, 16, v30
    v_mfma_f32_16x16x32_bf16 v[24:27], a[244:247], a[128:131], v[24:27]
    ds_read_b128 a[244:247], v241 offset:35456
    v_fma_f32 v30, v30, v52, v60
    v_mfma_f32_16x16x32_bf16 v[84:87], a[216:219], a[84:87], v[84:87]
    s_waitcnt lgkmcnt(11)
    v_lshlrev_b32 v31, 16, v31
    v_fma_f32 v31, v31, v53, v61
    v_mfma_f32_16x16x32_bf16 v[204:207], a[216:219], a[108:111], v[204:207]
    ds_write_b64 v62, v[30:31] offset:0
    v_mfma_f32_16x16x32_bf16 v[208:211], a[216:219], a[132:135], v[208:211]
    ds_read_b128 a[216:219], v240 offset:256
    v_add_u32 v62, s49, v62
    v_mfma_f32_16x16x32_bf16 v[212:215], a[220:223], a[84:87], v[212:215]
    s_waitcnt lgkmcnt(7)
    v_lshlrev_b32 v32, 16, v32
    v_fma_f32 v32, v32, v52, v60
    v_mfma_f32_16x16x32_bf16 v[216:219], a[220:223], a[108:111], v[216:219]
    s_waitcnt lgkmcnt(6)
    v_lshlrev_b32 v33, 16, v33
    v_fma_f32 v33, v33, v53, v61
    v_mfma_f32_16x16x32_bf16 v[220:223], a[220:223], a[132:135], v[220:223]
    ds_read_b128 a[220:223], v240 offset:1792
    v_lshlrev_b32 v34, 16, v34
    v_mfma_f32_16x16x32_bf16 v[224:227], a[224:227], a[84:87], v[224:227]
    ds_write_b64 v62, v[32:33] offset:0
    v_mfma_f32_16x16x32_bf16 v[180:183], a[224:227], a[108:111], v[180:183]
    s_waitcnt lgkmcnt(4)
    v_add_u32 v62, s49, v62
    v_fma_f32 v34, v34, v52, v60
    v_mfma_f32_16x16x32_bf16 v[184:187], a[224:227], a[132:135], v[184:187]
    ds_read_b128 a[224:227], v240 offset:3328
    v_lshlrev_b32 v35, 16, v35
    v_mfma_f32_16x16x32_bf16 v[188:191], a[228:231], a[84:87], v[188:191]
    v_fma_f32 v35, v35, v53, v61
    v_lshlrev_b32 v36, 16, v36
    v_mfma_f32_16x16x32_bf16 v[192:195], a[228:231], a[108:111], v[192:195]
    ds_write_b64 v62, v[34:35] offset:0
    v_mfma_f32_16x16x32_bf16 v[196:199], a[228:231], a[132:135], v[196:199]
    ds_read_b128 a[228:231], v240 offset:4864
    v_add_u32 v62, s49, v62
    v_mfma_f32_16x16x32_bf16 v[200:203], a[232:235], a[84:87], v[200:203]
    s_waitcnt lgkmcnt(5)
    v_fma_f32 v36, v36, v52, v60
    v_lshlrev_b32 v37, 16, v37
    v_mfma_f32_16x16x32_bf16 v[228:231], a[232:235], a[108:111], v[228:231]
    s_waitcnt lgkmcnt(4)
    v_fma_f32 v37, v37, v53, v61
    v_lshlrev_b32 v38, 16, v38
    v_mfma_f32_16x16x32_bf16 v[232:235], a[232:235], a[132:135], v[232:235]
    ds_read_b128 a[232:235], v240 offset:30976
    v_fma_f32 v38, v38, v52, v60
    v_mfma_f32_16x16x32_bf16 v[236:239], a[236:239], a[84:87], v[236:239]
    ds_write_b64 v62, v[36:37] offset:0
    v_mfma_f32_16x16x32_bf16 v[138:141], a[236:239], a[108:111], v[138:141]
    s_waitcnt lgkmcnt(4)
    v_add_u32 v62, s49, v62
    v_lshlrev_b32 v39, 16, v39
    v_mfma_f32_16x16x32_bf16 v[142:145], a[236:239], a[132:135], v[142:145]
    ds_read_b128 a[236:239], v240 offset:32512
    v_fma_f32 v39, v39, v53, v61
    v_mfma_f32_16x16x32_bf16 v[146:149], a[240:243], a[84:87], v[146:149]
    ds_write_b64 v62, v[38:39] offset:0
    v_mfma_f32_16x16x32_bf16 v[150:153], a[240:243], a[108:111], v[150:153]
    s_waitcnt lgkmcnt(4)
    v_add_u32 v62, s49, v62
    v_lshlrev_b32 v40, 16, v40
    v_mfma_f32_16x16x32_bf16 v[154:157], a[240:243], a[132:135], v[154:157]
    ds_read_b128 a[240:243], v240 offset:34048
    v_fma_f32 v40, v40, v52, v60
    v_mfma_f32_16x16x32_bf16 v[158:161], a[244:247], a[84:87], v[158:161]
    v_lshlrev_b32 v41, 16, v41
    v_fma_f32 v41, v41, v53, v61
    v_mfma_f32_16x16x32_bf16 v[162:165], a[244:247], a[108:111], v[162:165]
    ds_write_b64 v62, v[40:41] offset:0
    v_mfma_f32_16x16x32_bf16 v[24:27], a[244:247], a[132:135], v[24:27]
    ds_read_b128 a[244:247], v240 offset:35584
    v_add_u32 v62, s49, v62
    v_mfma_f32_16x16x32_bf16 v[84:87], a[216:219], a[88:91], v[84:87]
    s_waitcnt lgkmcnt(6)
    v_lshlrev_b32 v42, 16, v42
    v_fma_f32 v42, v42, v52, v60
    v_mfma_f32_16x16x32_bf16 v[204:207], a[216:219], a[112:115], v[204:207]
    s_waitcnt lgkmcnt(4)
    v_lshlrev_b32 v43, 16, v43
    v_fma_f32 v43, v43, v53, v61
    v_mfma_f32_16x16x32_bf16 v[208:211], a[216:219], a[136:139], v[208:211]
    ds_read_b128 a[216:219], v241 offset:256
    v_lshlrev_b32 v44, 16, v44
    v_mfma_f32_16x16x32_bf16 v[212:215], a[220:223], a[88:91], v[212:215]
    ds_write_b64 v62, v[42:43] offset:0
    v_mfma_f32_16x16x32_bf16 v[216:219], a[220:223], a[112:115], v[216:219]
    buffer_load_dwordx4 v173, s[8:11], s61 offen offset:1024 lds
    v_add_u32 v62, s49, v62
    v_mfma_f32_16x16x32_bf16 v[220:223], a[220:223], a[136:139], v[220:223]
    ds_read_b128 a[220:223], v241 offset:1792
    v_fma_f32 v44, v44, v52, v60
    v_mfma_f32_16x16x32_bf16 v[224:227], a[224:227], a[88:91], v[224:227]
    s_waitcnt lgkmcnt(5)
    v_lshlrev_b32 v45, 16, v45
    v_fma_f32 v45, v45, v53, v61
    v_mfma_f32_16x16x32_bf16 v[180:183], a[224:227], a[112:115], v[180:183]
    ds_write_b64 v62, v[44:45] offset:0
    v_mfma_f32_16x16x32_bf16 v[184:187], a[224:227], a[136:139], v[184:187]
    ds_read_b128 a[224:227], v241 offset:3328
    v_add_u32 v62, s49, v62
    v_mfma_f32_16x16x32_bf16 v[188:191], a[228:231], a[88:91], v[188:191]
    s_waitcnt lgkmcnt(5)
    v_lshlrev_b32 v46, 16, v46
    v_fma_f32 v46, v46, v52, v60
    v_mfma_f32_16x16x32_bf16 v[192:195], a[228:231], a[112:115], v[192:195]
    s_waitcnt lgkmcnt(4)
    v_lshlrev_b32 v47, 16, v47
    v_fma_f32 v47, v47, v53, v61
    v_mfma_f32_16x16x32_bf16 v[196:199], a[228:231], a[136:139], v[196:199]
    buffer_load_dwordx4 v174, s[8:11], s61 offen offset:2048 lds
    s_add_u32 m0, s29, 0x1800
    v_mfma_f32_16x16x32_bf16 v[200:203], a[232:235], a[88:91], v[200:203]
    s_add_u32 s61, s39, 0x2d000
    ds_read_b128 a[228:231], v241 offset:4864
    v_mfma_f32_16x16x32_bf16 v[228:231], a[232:235], a[112:115], v[228:231]
    ds_write_b64 v62, v[46:47] offset:0
    v_mfma_f32_16x16x32_bf16 v[232:235], a[232:235], a[136:139], v[232:235]
    ds_read_b128 a[232:235], v241 offset:30976
    v_add_u32 v62, s49, v62
    v_mfma_f32_16x16x32_bf16 v[236:239], a[236:239], a[88:91], v[236:239]
    s_waitcnt lgkmcnt(5)
    v_lshlrev_b32 v48, 16, v48
    v_fma_f32 v48, v48, v52, v60
    v_mfma_f32_16x16x32_bf16 v[138:141], a[236:239], a[112:115], v[138:141]
    s_waitcnt lgkmcnt(3)
    v_lshlrev_b32 v49, 16, v49
    v_fma_f32 v49, v49, v53, v61
    v_mfma_f32_16x16x32_bf16 v[142:145], a[236:239], a[136:139], v[142:145]
    ds_read_b128 a[236:239], v241 offset:32512
    buffer_load_dwordx4 v172, s[8:11], s62 offen lds
    v_mfma_f32_16x16x32_bf16 v[146:149], a[240:243], a[88:91], v[146:149]
    ds_write_b64 v62, v[48:49] offset:0
    v_mfma_f32_16x16x32_bf16 v[150:153], a[240:243], a[112:115], v[150:153]
    v_add_u32 v62, s49, v62
    v_mov_b32 v64, 0xf149f2ca
    v_mfma_f32_16x16x32_bf16 v[154:157], a[240:243], a[136:139], v[154:157]
    ds_read_b128 a[240:243], v241 offset:34048
    s_waitcnt vmcnt(10) lgkmcnt(5)
    v_mfma_f32_16x16x32_bf16 v[158:161], a[244:247], a[88:91], v[158:161]
    s_barrier
    v_mfma_f32_16x16x32_bf16 v[162:165], a[244:247], a[112:115], v[162:165]
    s_waitcnt lgkmcnt(3)
    v_mov_b32 v65, 0xf149f2ca
    v_lshlrev_b32 v63, 3, v1
    v_mfma_f32_16x16x32_bf16 v[24:27], a[244:247], a[136:139], v[24:27]
    buffer_load_dwordx4 v173, s[8:11], s62 offen offset:1024 lds
    ds_read_b128 a[244:247], v241 offset:35584
    v_mfma_f32_16x16x32_bf16 v[84:87], a[216:219], a[92:95], v[84:87]
    s_waitcnt lgkmcnt(3)
    v_add_u32 v63, 0x237c0, v63
    v_mfma_f32_16x16x32_bf16 v[204:207], a[216:219], a[116:119], v[204:207]
    ds_write_b64 v63, v[64:65] offset:0
    v_mfma_f32_16x16x32_bf16 v[208:211], a[216:219], a[140:143], v[208:211]
    ds_read_b128 a[216:219], v240 offset:6144
    s_waitcnt lgkmcnt(3)
    v_mfma_f32_16x16x32_bf16 v[212:215], a[220:223], a[92:95], v[212:215]
    v_cvt_pk_bf16_f32 v0, v84, v85
    v_cvt_pk_bf16_f32 v3, v86, v87
    v_mfma_f32_16x16x32_bf16 v[216:219], a[220:223], a[116:119], v[216:219]
    v_cvt_pk_bf16_f32 v30, v204, v205
    v_cvt_pk_bf16_f32 v33, v206, v207
    v_mfma_f32_16x16x32_bf16 v[220:223], a[220:223], a[140:143], v[220:223]
    v_cvt_pk_bf16_f32 v60, v208, v209
    v_cvt_pk_bf16_f32 v63, v210, v211
    v_mfma_f32_16x16x32_bf16 v[224:227], a[224:227], a[92:95], v[224:227]
    buffer_load_dwordx4 v174, s[8:11], s62 offen offset:2048 lds
    s_add_u32 m0, s29, 0x2400
    v_mfma_f32_16x16x32_bf16 v[180:183], a[224:227], a[116:119], v[180:183]
    s_lshl_b32 s62, s28, 5
    s_add_u32 s62, s62, 0
    v_cvt_pk_bf16_f32 v6, v212, v213
    v_mfma_f32_16x16x32_bf16 v[184:187], a[224:227], a[140:143], v[184:187]
    s_waitcnt lgkmcnt(2)
    v_cvt_pk_bf16_f32 v9, v214, v215
    v_cvt_pk_bf16_f32 v36, v216, v217
    v_mfma_f32_16x16x32_bf16 v[188:191], a[228:231], a[92:95], v[188:191]
    v_cvt_pk_bf16_f32 v39, v218, v219
    v_cvt_pk_bf16_f32 v66, v220, v221
    v_mfma_f32_16x16x32_bf16 v[192:195], a[228:231], a[116:119], v[192:195]
    v_cvt_pk_bf16_f32 v69, v222, v223
    v_cvt_pk_bf16_f32 v12, v224, v225
    v_mfma_f32_16x16x32_bf16 v[196:199], a[228:231], a[140:143], v[196:199]
    v_cvt_pk_bf16_f32 v15, v226, v227
    v_cvt_pk_bf16_f32 v42, v180, v181
    v_mfma_f32_16x16x32_bf16 v[200:203], a[232:235], a[92:95], v[200:203]
    s_waitcnt lgkmcnt(0)
    v_cvt_pk_bf16_f32 v45, v182, v183
    v_cvt_pk_bf16_f32 v72, v184, v185
    v_mfma_f32_16x16x32_bf16 v[228:231], a[232:235], a[116:119], v[228:231]
    buffer_load_dwordx4 v172, s[8:11], s63 offen lds
    v_cvt_pk_bf16_f32 v75, v186, v187
    v_mfma_f32_16x16x32_bf16 v[232:235], a[232:235], a[140:143], v[232:235]
    v_cvt_pk_bf16_f32 v18, v188, v189
    v_cvt_pk_bf16_f32 v21, v190, v191
    v_mfma_f32_16x16x32_bf16 v[236:239], a[236:239], a[92:95], v[236:239]
    v_cvt_pk_bf16_f32 v48, v192, v193
    v_cvt_pk_bf16_f32 v51, v194, v195
    v_mfma_f32_16x16x32_bf16 v[138:141], a[236:239], a[116:119], v[138:141]
    v_cvt_pk_bf16_f32 v78, v196, v197
    v_cvt_pk_bf16_f32 v81, v198, v199
    v_mfma_f32_16x16x32_bf16 v[142:145], a[236:239], a[140:143], v[142:145]
    v_cvt_pk_bf16_f32 v1, v200, v201
    v_cvt_pk_bf16_f32 v4, v202, v203
    v_mfma_f32_16x16x32_bf16 v[146:149], a[240:243], a[92:95], v[146:149]
    v_cvt_pk_bf16_f32 v31, v228, v229
    v_cvt_pk_bf16_f32 v34, v230, v231
    v_mfma_f32_16x16x32_bf16 v[150:153], a[240:243], a[116:119], v[150:153]
    v_cvt_pk_bf16_f32 v61, v232, v233
    v_cvt_pk_bf16_f32 v64, v234, v235
    v_mfma_f32_16x16x32_bf16 v[154:157], a[240:243], a[140:143], v[154:157]
    buffer_load_dwordx4 v173, s[8:11], s63 offen offset:1024 lds
    v_cvt_pk_bf16_f32 v7, v236, v237
    v_mfma_f32_16x16x32_bf16 v[158:161], a[244:247], a[92:95], v[158:161]
    v_cvt_pk_bf16_f32 v10, v238, v239
    s_waitcnt vmcnt(8)
    v_mfma_f32_16x16x32_bf16 v[162:165], a[244:247], a[116:119], v[162:165]
    ds_read_b64_tr_b16 a[144:145], v249 offset:0
    ds_read_b64_tr_b16 a[146:147], v250 offset:0
    v_mfma_f32_16x16x32_bf16 v[24:27], a[244:247], a[140:143], v[24:27]
    ds_read_b64_tr_b16 a[168:169], v249 offset:32
    ds_read_b64_tr_b16 a[170:171], v250 offset:32
    v_mfma_f32_16x16x32_bf16 v[228:231], a[0:3], a[216:219], 0
    ds_read_b64_tr_b16 a[192:193], v249 offset:64
    ds_read_b64_tr_b16 a[194:195], v250 offset:64
    v_mfma_f32_16x16x32_bf16 v[232:235], a[24:27], a[216:219], 0
    v_cvt_pk_bf16_f32 v37, v138, v139
    v_cvt_pk_bf16_f32 v40, v140, v141
    v_mfma_f32_16x16x32_bf16 v[236:239], a[48:51], a[216:219], 0
    buffer_load_dwordx4 v174, s[8:11], s63 offen offset:2048 lds
    s_add_u32 m0, s29, 0
    s_lshl_b32 s63, s28, 5
    s_add_u32 s63, s63, 0x4800
    v_cvt_pk_bf16_f32 v67, v142, v143
    v_cvt_pk_bf16_f32 v70, v144, v145
    v_cvt_pk_bf16_f32 v13, v146, v147
    v_cvt_pk_bf16_f32 v16, v148, v149
    v_cvt_pk_bf16_f32 v43, v150, v151
    v_cvt_pk_bf16_f32 v46, v152, v153
    v_cvt_pk_bf16_f32 v73, v154, v155
    v_cvt_pk_bf16_f32 v76, v156, v157
    v_cvt_pk_bf16_f32 v19, v158, v159
    v_cvt_pk_bf16_f32 v22, v160, v161
    v_cvt_pk_bf16_f32 v49, v162, v163
    v_cvt_pk_bf16_f32 v52, v164, v165
    v_cvt_pk_bf16_f32 v79, v24, v25
    v_cvt_pk_bf16_f32 v82, v26, v27
    ds_read_b128 a[220:223], v241 offset:6144
    ds_read_b128 a[224:227], v240 offset:6272
    ds_read_b128 a[228:231], v241 offset:6272
    s_waitcnt lgkmcnt(3)
    buffer_load_dwordx4 v172, s[8:11], s60 offen lds
    ds_read_b128 a[232:235], v240 offset:6400
    ds_read_b128 a[236:239], v241 offset:6400
    s_waitcnt vmcnt(7)
    ds_read_b64_tr_b16 a[148:149], v249 offset:3072
    ds_read_b64_tr_b16 a[150:151], v250 offset:3072
    ds_read_b64_tr_b16 a[172:173], v249 offset:3104
    ds_read_b64_tr_b16 a[174:175], v250 offset:3104
    ds_read_b64_tr_b16 a[196:197], v249 offset:3136
    ds_read_b64_tr_b16 a[198:199], v250 offset:3136
    ds_read_b128 a[240:243], v240 offset:36864
    ds_read_b128 a[244:247], v241 offset:36864
    ds_read_b128 v[196:199], v244 offset:192
    v_mov_b32 v195, 0
    s_waitcnt lgkmcnt(13)
    v_mfma_f32_16x16x32_bf16 v[228:231], a[4:7], a[220:223], v[228:231]
    buffer_load_dwordx4 v173, s[8:11], s60 offen offset:1024 lds
    ds_read_b128 v[200:203], v245 offset:192
    v_mfma_f32_16x16x32_bf16 v[232:235], a[28:31], a[220:223], v[232:235]
    ds_read_b128 v[204:207], v246 offset:192
    ds_read_b128 v[208:211], v244 offset:256
    v_mfma_f32_16x16x32_bf16 v[236:239], a[52:55], a[220:223], v[236:239]
    s_waitcnt lgkmcnt(15)
    v_mfma_f32_16x16x32_bf16 v[228:231], a[8:11], a[224:227], v[228:231]
    s_waitcnt lgkmcnt(14)
    v_mfma_f32_16x16x32_bf16 v[228:231], a[12:15], a[228:231], v[228:231]
    s_waitcnt lgkmcnt(13)
    v_mfma_f32_16x16x32_bf16 v[228:231], a[16:19], a[232:235], v[228:231]
    s_waitcnt lgkmcnt(12)
    v_mfma_f32_16x16x32_bf16 v[228:231], a[20:23], a[236:239], v[228:231]
    s_waitcnt lgkmcnt(9)
    buffer_load_dwordx4 v174, s[8:11], s60 offen offset:2048 lds
    v_mfma_f32_16x16x32_bf16 v[232:235], a[32:35], a[224:227], v[232:235]
    s_add_u32 m0, s29, 0xc00
    s_waitcnt lgkmcnt(6)
    s_lshl_b32 s60, s28, 5
    v_mfma_f32_16x16x32_bf16 v[232:235], a[36:39], a[228:231], v[232:235]
    s_add_u32 s60, s60, 0x1800
    v_cvt_pk_bf16_f32 v138, v228, v229
    v_cvt_pk_bf16_f32 v139, v230, v231
    v_mfma_f32_16x16x32_bf16 v[232:235], a[40:43], a[232:235], v[232:235]
    s_waitcnt lgkmcnt(5)
    v_mfma_f32_16x16x32_bf16 v[232:235], a[44:47], a[236:239], v[232:235]
    s_waitcnt lgkmcnt(4)
    v_mfma_f32_16x16x32_bf16 v[236:239], a[56:59], a[224:227], v[236:239]
    s_waitcnt lgkmcnt(3)
    v_mfma_f32_16x16x32_bf16 v[236:239], a[60:63], a[228:231], v[236:239]
    s_waitcnt lgkmcnt(2)
    v_mfma_f32_16x16x32_bf16 v[236:239], a[64:67], a[232:235], v[236:239]
    s_waitcnt lgkmcnt(1)
    buffer_load_dwordx4 v172, s[8:11], s61 offen lds
    v_mfma_f32_16x16x32_bf16 v[236:239], a[68:71], a[236:239], v[236:239]
    s_waitcnt lgkmcnt(0)
    v_cvt_pk_bf16_f32 v140, v232, v233
    v_cvt_pk_bf16_f32 v141, v234, v235
    v_mfma_f32_16x16x32_bf16 v[228:231], a[216:219], a[72:75], 0
    s_waitcnt vmcnt(7)
    ds_read_b64_tr_b16 a[152:153], v249 offset:6144
    v_mfma_f32_16x16x32_bf16 v[228:231], a[220:223], a[76:79], v[228:231]
    ds_read_b64_tr_b16 a[154:155], v250 offset:6144
    ds_read_b64_tr_b16 a[176:177], v249 offset:6176
    v_mfma_f32_16x16x32_bf16 v[228:231], a[224:227], a[80:83], v[228:231]
    ds_read_b64_tr_b16 a[178:179], v250 offset:6176
    ds_read_b64_tr_b16 a[200:201], v249 offset:6208
    v_mfma_f32_16x16x32_bf16 v[228:231], a[228:231], a[84:87], v[228:231]
    ds_read_b64_tr_b16 a[202:203], v250 offset:6208
    v_cvt_pk_bf16_f32 v142, v236, v237
    v_mfma_f32_16x16x32_bf16 v[228:231], a[232:235], a[88:91], v[228:231]
    v_cvt_pk_bf16_f32 v143, v238, v239
    v_mfma_f32_16x16x32_bf16 v[228:231], a[236:239], a[92:95], v[228:231]
    buffer_load_dwordx4 v173, s[8:11], s61 offen offset:1024 lds
    v_mfma_f32_16x16x32_bf16 v[232:235], a[216:219], a[96:99], 0
    v_mfma_f32_16x16x32_bf16 v[232:235], a[220:223], a[100:103], v[232:235]
    v_mfma_f32_16x16x32_bf16 v[232:235], a[224:227], a[104:107], v[232:235]
    v_mfma_f32_16x16x32_bf16 v[232:235], a[228:231], a[108:111], v[232:235]
    v_mfma_f32_16x16x32_bf16 v[232:235], a[232:235], a[112:115], v[232:235]
    s_waitcnt lgkmcnt(4)
    v_mfma_f32_16x16x32_bf16 v[232:235], a[236:239], a[116:119], v[232:235]
    s_waitcnt lgkmcnt(3)
    v_cvt_pk_bf16_f32 v24, v228, v229
    v_cvt_pk_bf16_f32 v27, v230, v231
    v_mfma_f32_16x16x32_bf16 v[236:239], a[216:219], a[120:123], 0
    buffer_load_dwordx4 v174, s[8:11], s61 offen offset:2048 lds
    s_lshl_b32 s61, s28, 5
    v_mfma_f32_16x16x32_bf16 v[236:239], a[220:223], a[124:127], v[236:239]
    s_add_u32 s61, s61, 0x6000
    v_cvt_pk_bf16_f32 v54, v232, v233
    v_cvt_pk_bf16_f32 v57, v234, v235
    v_mfma_f32_16x16x32_bf16 v[236:239], a[224:227], a[128:131], v[236:239]
    ds_read_b128 a[216:219], v240 offset:36992
    ds_read_b128 a[220:223], v241 offset:36992
    v_mfma_f32_16x16x32_bf16 v[236:239], a[228:231], a[132:135], v[236:239]
    ds_read_b128 a[224:227], v240 offset:37120
    ds_read_b128 a[228:231], v241 offset:37120
    v_mfma_f32_16x16x32_bf16 v[236:239], a[232:235], a[136:139], v[236:239]
    ds_read_b128 a[232:235], v240 offset:61440
    s_add_u32 m0, s46, 0x16800
    v_mfma_f32_16x16x32_bf16 v[236:239], a[236:239], a[140:143], v[236:239]
    ds_read_b128 a[236:239], v241 offset:61440
    v_mfma_f32_16x16x32_bf16 v[228:231], a[0:3], a[240:243], 0
    s_waitcnt lgkmcnt(6)
    v_mfma_f32_16x16x32_bf16 v[228:231], a[4:7], a[244:247], v[228:231]
    v_mfma_f32_16x16x32_bf16 v[232:235], a[24:27], a[240:243], 0
    s_waitcnt vmcnt(6)
    ds_read_b64_tr_b16 a[156:157], v249 offset:9216
    v_mfma_f32_16x16x32_bf16 v[232:235], a[28:31], a[244:247], v[232:235]
    ds_read_b64_tr_b16 a[158:159], v250 offset:9216
    ds_read_b64_tr_b16 a[180:181], v249 offset:9248
    s_waitcnt lgkmcnt(8)
    v_mfma_f32_16x16x32_bf16 v[228:231], a[8:11], a[216:219], v[228:231]
    ds_read_b64_tr_b16 a[182:183], v250 offset:9248
    ds_read_b64_tr_b16 a[204:205], v249 offset:9280
    v_mfma_f32_16x16x32_bf16 v[232:235], a[32:35], a[216:219], v[232:235]
    s_waitcnt lgkmcnt(9)
    ds_read_b64_tr_b16 a[206:207], v250 offset:9280
    v_mfma_f32_16x16x32_bf16 v[228:231], a[12:15], a[220:223], v[228:231]
    s_waitcnt lgkmcnt(9)
    v_cvt_pk_bf16_f32 v84, v236, v237
    v_cvt_pk_bf16_f32 v87, v238, v239
    v_mfma_f32_16x16x32_bf16 v[228:231], a[16:19], a[224:227], v[228:231]
    s_waitcnt lgkmcnt(8)
    v_mfma_f32_16x16x32_bf16 v[228:231], a[20:23], a[228:231], v[228:231]
    v_mfma_f32_16x16x32_bf16 v[232:235], a[36:39], a[220:223], v[232:235]
    s_waitcnt lgkmcnt(7)
    v_mfma_f32_16x16x32_bf16 v[232:235], a[40:43], a[224:227], v[232:235]
    s_waitcnt lgkmcnt(6)
    v_mfma_f32_16x16x32_bf16 v[232:235], a[44:47], a[228:231], v[232:235]
    s_waitcnt lgkmcnt(5)
    v_mfma_f32_16x16x32_bf16 v[236:239], a[48:51], a[240:243], 0
    s_waitcnt lgkmcnt(4)
    v_cvt_pk_bf16_f32 v144, v228, v229
    v_cvt_pk_bf16_f32 v145, v230, v231
    v_mfma_f32_16x16x32_bf16 v[236:239], a[52:55], a[244:247], v[236:239]
    s_waitcnt lgkmcnt(3)
    v_mfma_f32_16x16x32_bf16 v[236:239], a[56:59], a[216:219], v[236:239]
    s_waitcnt lgkmcnt(1)
    v_cvt_pk_bf16_f32 v146, v232, v233
    v_cvt_pk_bf16_f32 v147, v234, v235
    v_mfma_f32_16x16x32_bf16 v[236:239], a[60:63], a[220:223], v[236:239]
    s_waitcnt lgkmcnt(0)
    v_mfma_f32_16x16x32_bf16 v[236:239], a[64:67], a[224:227], v[236:239]
    v_mfma_f32_16x16x32_bf16 v[236:239], a[68:71], a[228:231], v[236:239]
    v_mfma_f32_16x16x32_bf16 v[228:231], a[240:243], a[72:75], 0
    v_mfma_f32_16x16x32_bf16 v[228:231], a[244:247], a[76:79], v[228:231]
    v_mfma_f32_16x16x32_bf16 v[228:231], a[216:219], a[80:83], v[228:231]
    v_mfma_f32_16x16x32_bf16 v[228:231], a[220:223], a[84:87], v[228:231]
    v_mfma_f32_16x16x32_bf16 v[228:231], a[224:227], a[88:91], v[228:231]
    s_waitcnt vmcnt(3)
    ds_read_b64_tr_b16 a[160:161], v249 offset:0
    v_mfma_f32_16x16x32_bf16 v[228:231], a[228:231], a[92:95], v[228:231]
    ds_read_b64_tr_b16 a[162:163], v250 offset:0
    ds_read_b64_tr_b16 a[184:185], v249 offset:32
    v_mfma_f32_16x16x32_bf16 v[232:235], a[240:243], a[96:99], 0
    ds_read_b64_tr_b16 a[186:187], v250 offset:32
    ds_read_b64_tr_b16 a[208:209], v249 offset:64
    v_mfma_f32_16x16x32_bf16 v[232:235], a[244:247], a[100:103], v[232:235]
    ds_read_b64_tr_b16 a[210:211], v250 offset:64
    v_cvt_pk_bf16_f32 v148, v236, v237
    v_mfma_f32_16x16x32_bf16 v[232:235], a[216:219], a[104:107], v[232:235]
    v_cvt_pk_bf16_f32 v149, v238, v239
    v_cvt_pk_bf16_f32 v25, v228, v229
    v_mfma_f32_16x16x32_bf16 v[232:235], a[220:223], a[108:111], v[232:235]
    v_cvt_pk_bf16_f32 v28, v230, v231
    v_mfma_f32_16x16x32_bf16 v[232:235], a[224:227], a[112:115], v[232:235]
    v_mfma_f32_16x16x32_bf16 v[232:235], a[228:231], a[116:119], v[232:235]
    v_mfma_f32_16x16x32_bf16 v[236:239], a[240:243], a[120:123], 0
    ds_read_b128 a[240:243], v240 offset:61568
    v_mfma_f32_16x16x32_bf16 v[236:239], a[244:247], a[124:127], v[236:239]
    ds_read_b128 a[244:247], v241 offset:61568
    v_mfma_f32_16x16x32_bf16 v[236:239], a[216:219], a[128:131], v[236:239]
    ds_read_b128 a[216:219], v240 offset:61696
    v_mfma_f32_16x16x32_bf16 v[236:239], a[220:223], a[132:135], v[236:239]
    ds_read_b128 a[220:223], v241 offset:61696
    v_cvt_pk_bf16_f32 v55, v232, v233
    v_mfma_f32_16x16x32_bf16 v[236:239], a[224:227], a[136:139], v[236:239]
    ds_read_b128 a[224:227], v240 offset:62976
    v_cvt_pk_bf16_f32 v58, v234, v235
    v_mfma_f32_16x16x32_bf16 v[236:239], a[228:231], a[140:143], v[236:239]
    ds_read_b128 a[228:231], v241 offset:62976
    v_mfma_f32_16x16x32_bf16 v[228:231], a[0:3], a[232:235], 0
    s_waitcnt lgkmcnt(6)
    v_mfma_f32_16x16x32_bf16 v[228:231], a[4:7], a[236:239], v[228:231]
    v_mfma_f32_16x16x32_bf16 v[232:235], a[24:27], a[232:235], 0
    v_mfma_f32_16x16x32_bf16 v[232:235], a[28:31], a[236:239], v[232:235]
    s_waitcnt lgkmcnt(5)
    v_mfma_f32_16x16x32_bf16 v[228:231], a[8:11], a[240:243], v[228:231]
    s_waitcnt lgkmcnt(4)
    v_cvt_pk_bf16_f32 v85, v236, v237
    v_cvt_pk_bf16_f32 v88, v238, v239
    v_mfma_f32_16x16x32_bf16 v[228:231], a[12:15], a[244:247], v[228:231]
    s_waitcnt lgkmcnt(3)
    v_mfma_f32_16x16x32_bf16 v[228:231], a[16:19], a[216:219], v[228:231]
    s_waitcnt lgkmcnt(2)
    s_waitcnt vmcnt(0)
    ds_read_b64_tr_b16 a[164:165], v249 offset:3072
    v_mfma_f32_16x16x32_bf16 v[228:231], a[20:23], a[220:223], v[228:231]
    ds_read_b64_tr_b16 a[166:167], v250 offset:3072
    ds_read_b64_tr_b16 a[188:189], v249 offset:3104
    v_mfma_f32_16x16x32_bf16 v[232:235], a[32:35], a[240:243], v[232:235]
    ds_read_b64_tr_b16 a[190:191], v250 offset:3104
    ds_read_b64_tr_b16 a[212:213], v249 offset:3136
    v_mfma_f32_16x16x32_bf16 v[232:235], a[36:39], a[244:247], v[232:235]
    ds_read_b64_tr_b16 a[214:215], v250 offset:3136
    v_add_u32 v249, s66, v249
    v_mfma_f32_16x16x32_bf16 v[232:235], a[40:43], a[216:219], v[232:235]
    s_waitcnt lgkmcnt(6)
    v_cvt_pk_bf16_f32 v150, v228, v229
    v_cvt_pk_bf16_f32 v151, v230, v231
    v_mfma_f32_16x16x32_bf16 v[232:235], a[44:47], a[220:223], v[232:235]
    v_add_u32 v250, s66, v250
    s_lshl_b32 s66, s28, 1
    v_mfma_f32_16x16x32_bf16 v[236:239], a[48:51], a[232:235], 0
    v_mfma_f32_16x16x32_bf16 v[236:239], a[52:55], a[236:239], v[236:239]
    v_mfma_f32_16x16x32_bf16 v[236:239], a[56:59], a[240:243], v[236:239]
    v_mfma_f32_16x16x32_bf16 v[236:239], a[60:63], a[244:247], v[236:239]
    v_mfma_f32_16x16x32_bf16 v[236:239], a[64:67], a[216:219], v[236:239]
    s_waitcnt lgkmcnt(4)
    v_cvt_pk_bf16_f32 v152, v232, v233
    v_cvt_pk_bf16_f32 v153, v234, v235
    v_mfma_f32_16x16x32_bf16 v[236:239], a[68:71], a[220:223], v[236:239]
    s_waitcnt lgkmcnt(3)
    s_waitcnt lgkmcnt(0)
    s_barrier
    v_mfma_f32_16x16x32_bf16 v[228:231], a[232:235], a[72:75], 0
    s_barrier
    v_mfma_f32_16x16x32_bf16 v[228:231], a[236:239], a[76:79], v[228:231]
    buffer_load_dwordx4 v254, s[4:7], s43 offen lds
    v_accvgpr_read_b32 v254, a254
    v_mfma_f32_16x16x32_bf16 v[228:231], a[240:243], a[80:83], v[228:231]
    v_cvt_pk_bf16_f32 v154, v236, v237
    v_cvt_pk_bf16_f32 v155, v238, v239
    v_mfma_f32_16x16x32_bf16 v[228:231], a[244:247], a[84:87], v[228:231]
    v_mfma_f32_16x16x32_bf16 v[228:231], a[216:219], a[88:91], v[228:231]
    v_mfma_f32_16x16x32_bf16 v[228:231], a[220:223], a[92:95], v[228:231]
    buffer_load_dwordx4 v255, s[4:7], s43 offen offset:1024 lds
    v_accvgpr_read_b32 v255, a252
    v_mfma_f32_16x16x32_bf16 v[232:235], a[232:235], a[96:99], 0
    v_mfma_f32_16x16x32_bf16 v[232:235], a[236:239], a[100:103], v[232:235]
    v_mfma_f32_16x16x32_bf16 v[232:235], a[240:243], a[104:107], v[232:235]
    v_mfma_f32_16x16x32_bf16 v[232:235], a[244:247], a[108:111], v[232:235]
    buffer_load_dwordx4 v254, s[4:7], s43 offen offset:2048 lds
    s_add_u32 m0, s46, 0x17400
    v_mfma_f32_16x16x32_bf16 v[232:235], a[216:219], a[112:115], v[232:235]
    v_cvt_pk_bf16_f32 v2, v228, v229
    v_cvt_pk_bf16_f32 v5, v230, v231
    v_mfma_f32_16x16x32_bf16 v[232:235], a[220:223], a[116:119], v[232:235]
    v_accvgpr_read_b32 v254, a253
    v_mfma_f32_16x16x32_bf16 v[236:239], a[232:235], a[120:123], 0
    ds_read_b128 a[232:235], v240 offset:63104
    v_mfma_f32_16x16x32_bf16 v[236:239], a[236:239], a[124:127], v[236:239]
    ds_read_b128 a[236:239], v241 offset:63104
    buffer_load_dwordx4 v255, s[4:7], s59 offen lds
    v_mfma_f32_16x16x32_bf16 v[236:239], a[240:243], a[128:131], v[236:239]
    ds_read_b128 a[240:243], v240 offset:63232
    v_cvt_pk_bf16_f32 v32, v232, v233
    v_mfma_f32_16x16x32_bf16 v[236:239], a[244:247], a[132:135], v[236:239]
    ds_read_b128 a[244:247], v241 offset:63232
    v_cvt_pk_bf16_f32 v35, v234, v235
    v_mfma_f32_16x16x32_bf16 v[236:239], a[216:219], a[136:139], v[236:239]
    ds_read_b128 a[216:219], v240 offset:64512
    v_accvgpr_read_b32 v255, a254
    v_mfma_f32_16x16x32_bf16 v[236:239], a[220:223], a[140:143], v[236:239]
    ds_read_b128 a[220:223], v241 offset:64512
    buffer_load_dwordx4 v254, s[4:7], s59 offen offset:1024 lds
    v_mfma_f32_16x16x32_bf16 v[228:231], a[0:3], a[224:227], 0
    v_accvgpr_read_b32 v254, a252
    v_mfma_f32_16x16x32_bf16 v[228:231], a[4:7], a[228:231], v[228:231]
    v_mfma_f32_16x16x32_bf16 v[232:235], a[24:27], a[224:227], 0
    s_waitcnt lgkmcnt(5)
    v_mfma_f32_16x16x32_bf16 v[228:231], a[8:11], a[232:235], v[228:231]
    s_waitcnt lgkmcnt(4)
    v_cvt_pk_bf16_f32 v62, v236, v237
    v_cvt_pk_bf16_f32 v65, v238, v239
    v_mfma_f32_16x16x32_bf16 v[228:231], a[12:15], a[236:239], v[228:231]
    buffer_load_dwordx4 v255, s[4:7], s59 offen offset:2048 lds
    s_add_u32 m0, s46, 0x18000
    v_mfma_f32_16x16x32_bf16 v[232:235], a[28:31], a[228:231], v[232:235]
    s_add_u32 s59, s44, s45
    v_accvgpr_read_b32 v255, a255
    s_waitcnt lgkmcnt(3)
    v_mfma_f32_16x16x32_bf16 v[228:231], a[16:19], a[240:243], v[228:231]
    s_waitcnt lgkmcnt(2)
    v_mfma_f32_16x16x32_bf16 v[228:231], a[20:23], a[244:247], v[228:231]
    v_mfma_f32_16x16x32_bf16 v[232:235], a[32:35], a[232:235], v[232:235]
    buffer_load_dwordx4 v254, s[4:7], s58 offen lds
    v_xor_b32 v254, 16, v242
    v_mfma_f32_16x16x32_bf16 v[232:235], a[36:39], a[236:239], v[232:235]
    s_waitcnt lgkmcnt(0)
    v_add_u32 v254, 0x7500, v254
    v_cndmask_b32 v254, v242, v254, vcc
    v_mfma_f32_16x16x32_bf16 v[232:235], a[40:43], a[240:243], v[232:235]
    s_mov_b32 vcc_lo, 0x33333333
    v_cvt_pk_bf16_f32 v156, v228, v229
    v_cvt_pk_bf16_f32 v157, v230, v231
    v_mfma_f32_16x16x32_bf16 v[232:235], a[44:47], a[244:247], v[232:235]
    s_mov_b32 vcc_hi, 0x33333333
    v_mfma_f32_16x16x32_bf16 v[236:239], a[48:51], a[224:227], 0
    buffer_load_dwordx4 v255, s[4:7], s58 offen offset:512 lds
    v_xor_b32 v255, 64, v254
    v_mfma_f32_16x16x32_bf16 v[236:239], a[52:55], a[228:231], v[236:239]
    s_add_u32 m0, s46, 0
    s_lshl1_add_u32 s58, s45, s44
    v_mfma_f32_16x16x32_bf16 v[236:239], a[56:59], a[232:235], v[236:239]
    v_cvt_pk_bf16_f32 v158, v232, v233
    v_cvt_pk_bf16_f32 v159, v234, v235
    v_mfma_f32_16x16x32_bf16 v[236:239], a[60:63], a[236:239], v[236:239]
    v_mfma_f32_16x16x32_bf16 v[236:239], a[64:67], a[240:243], v[236:239]
    v_mfma_f32_16x16x32_bf16 v[236:239], a[68:71], a[244:247], v[236:239]
    v_mfma_f32_16x16x32_bf16 v[228:231], a[224:227], a[72:75], 0
    v_mfma_f32_16x16x32_bf16 v[228:231], a[228:231], a[76:79], v[228:231]
    v_mfma_f32_16x16x32_bf16 v[228:231], a[232:235], a[80:83], v[228:231]
    v_mfma_f32_16x16x32_bf16 v[228:231], a[236:239], a[84:87], v[228:231]
    v_mfma_f32_16x16x32_bf16 v[228:231], a[240:243], a[88:91], v[228:231]
    v_mfma_f32_16x16x32_bf16 v[228:231], a[244:247], a[92:95], v[228:231]
    v_mfma_f32_16x16x32_bf16 v[232:235], a[224:227], a[96:99], 0
    v_mfma_f32_16x16x32_bf16 v[232:235], a[228:231], a[100:103], v[232:235]
    v_cvt_pk_bf16_f32 v160, v236, v237
    v_cvt_pk_bf16_f32 v161, v238, v239
    v_mfma_f32_16x16x32_bf16 v[232:235], a[232:235], a[104:107], v[232:235]
    v_mfma_f32_16x16x32_bf16 v[232:235], a[236:239], a[108:111], v[232:235]
    v_mfma_f32_16x16x32_bf16 v[232:235], a[240:243], a[112:115], v[232:235]
    v_mfma_f32_16x16x32_bf16 v[232:235], a[244:247], a[116:119], v[232:235]
    v_cvt_pk_bf16_f32 v8, v228, v229
    v_cvt_pk_bf16_f32 v11, v230, v231
    v_mfma_f32_16x16x32_bf16 v[236:239], a[224:227], a[120:123], 0
    ds_read_b128 a[224:227], v240 offset:64640
    v_mfma_f32_16x16x32_bf16 v[236:239], a[228:231], a[124:127], v[236:239]
    ds_read_b128 a[228:231], v241 offset:64640
    v_mfma_f32_16x16x32_bf16 v[236:239], a[232:235], a[128:131], v[236:239]
    ds_read_b128 a[232:235], v240 offset:64768
    v_cvt_pk_bf16_f32 v38, v232, v233
    v_mfma_f32_16x16x32_bf16 v[236:239], a[236:239], a[132:135], v[236:239]
    ds_read_b128 a[236:239], v241 offset:64768
    v_cvt_pk_bf16_f32 v41, v234, v235
    v_mfma_f32_16x16x32_bf16 v[236:239], a[240:243], a[136:139], v[236:239]
    ds_read_b128 a[240:243], v242 offset:0
    v_add_u32 v240, 0xf000, v240
    v_mfma_f32_16x16x32_bf16 v[236:239], a[244:247], a[140:143], v[236:239]
    ds_read_b128 a[244:247], v243 offset:0
    v_add_u32 v241, 0xf000, v241
    v_mfma_f32_16x16x32_bf16 v[228:231], a[0:3], a[216:219], 0
    v_mfma_f32_16x16x32_bf16 v[228:231], a[4:7], a[220:223], v[228:231]
    v_mfma_f32_16x16x32_bf16 v[232:235], a[24:27], a[216:219], 0
    v_mfma_f32_16x16x32_bf16 v[232:235], a[28:31], a[220:223], v[232:235]
    s_waitcnt lgkmcnt(5)
    v_mfma_f32_16x16x32_bf16 v[228:231], a[8:11], a[224:227], v[228:231]
    s_waitcnt lgkmcnt(4)
    v_cvt_pk_bf16_f32 v68, v236, v237
    v_cvt_pk_bf16_f32 v71, v238, v239
    v_mfma_f32_16x16x32_bf16 v[228:231], a[12:15], a[228:231], v[228:231]
    s_waitcnt lgkmcnt(3)
    v_mfma_f32_16x16x32_bf16 v[228:231], a[16:19], a[232:235], v[228:231]
    s_waitcnt lgkmcnt(2)
    v_mfma_f32_16x16x32_bf16 v[228:231], a[20:23], a[236:239], v[228:231]
    v_mfma_f32_16x16x32_bf16 v[232:235], a[32:35], a[224:227], v[232:235]
    s_waitcnt lgkmcnt(1)
    v_mfma_f32_16x16x32_bf16 v[232:235], a[36:39], a[228:231], v[232:235]
    s_waitcnt lgkmcnt(0)
    v_mfma_f32_16x16x32_bf16 v[232:235], a[40:43], a[232:235], v[232:235]
    v_mfma_f32_16x16x32_bf16 v[232:235], a[44:47], a[236:239], v[232:235]
    v_mfma_f32_16x16x32_bf16 v[236:239], a[48:51], a[216:219], 0
    v_mfma_f32_16x16x32_bf16 v[236:239], a[52:55], a[220:223], v[236:239]
    v_cvt_pk_bf16_f32 v162, v228, v229
    v_cvt_pk_bf16_f32 v163, v230, v231
    v_mfma_f32_16x16x32_bf16 v[236:239], a[56:59], a[224:227], v[236:239]
    v_mfma_f32_16x16x32_bf16 v[236:239], a[60:63], a[228:231], v[236:239]
    v_mfma_f32_16x16x32_bf16 v[236:239], a[64:67], a[232:235], v[236:239]
    v_mfma_f32_16x16x32_bf16 v[236:239], a[68:71], a[236:239], v[236:239]
    v_cvt_pk_bf16_f32 v164, v232, v233
    v_cvt_pk_bf16_f32 v165, v234, v235
    v_mfma_f32_16x16x32_bf16 v[228:231], a[216:219], a[72:75], 0
    v_mfma_f32_16x16x32_bf16 v[228:231], a[220:223], a[76:79], v[228:231]
    v_mfma_f32_16x16x32_bf16 v[228:231], a[224:227], a[80:83], v[228:231]
    v_mfma_f32_16x16x32_bf16 v[228:231], a[228:231], a[84:87], v[228:231]
    v_mfma_f32_16x16x32_bf16 v[228:231], a[232:235], a[88:91], v[228:231]
    v_mfma_f32_16x16x32_bf16 v[228:231], a[236:239], a[92:95], v[228:231]
    v_cvt_pk_bf16_f32 v166, v236, v237
    v_cvt_pk_bf16_f32 v167, v238, v239
    v_mfma_f32_16x16x32_bf16 v[232:235], a[216:219], a[96:99], 0
    v_mfma_f32_16x16x32_bf16 v[232:235], a[220:223], a[100:103], v[232:235]
    v_mfma_f32_16x16x32_bf16 v[232:235], a[224:227], a[104:107], v[232:235]
    v_mfma_f32_16x16x32_bf16 v[232:235], a[228:231], a[108:111], v[232:235]
    v_mfma_f32_16x16x32_bf16 v[232:235], a[232:235], a[112:115], v[232:235]
    v_mfma_f32_16x16x32_bf16 v[232:235], a[236:239], a[116:119], v[232:235]
    v_cvt_pk_bf16_f32 v14, v228, v229
    v_cvt_pk_bf16_f32 v17, v230, v231
    v_mfma_f32_16x16x32_bf16 v[236:239], a[216:219], a[120:123], 0
    ds_read_b128 a[216:219], v242 offset:128
    v_mfma_f32_16x16x32_bf16 v[236:239], a[220:223], a[124:127], v[236:239]
    ds_read_b128 a[220:223], v243 offset:128
    v_mfma_f32_16x16x32_bf16 v[236:239], a[224:227], a[128:131], v[236:239]
    ds_read_b128 a[224:227], v242 offset:256
    v_cvt_pk_bf16_f32 v44, v232, v233
    v_mfma_f32_16x16x32_bf16 v[236:239], a[228:231], a[132:135], v[236:239]
    ds_read_b128 a[228:231], v243 offset:256
    v_cvt_pk_bf16_f32 v47, v234, v235
    v_mfma_f32_16x16x32_bf16 v[236:239], a[232:235], a[136:139], v[236:239]
    ds_read_b128 a[232:235], v242 offset:1536
    v_mfma_f32_16x16x32_bf16 v[236:239], a[236:239], a[140:143], v[236:239]
    ds_read_b128 a[236:239], v243 offset:1536
    v_mfma_f32_16x16x32_bf16 v[228:231], a[144:147], a[240:243], 0
    v_mfma_f32_16x16x32_bf16 v[228:231], a[148:151], a[244:247], v[228:231]
    v_mfma_f32_16x16x32_bf16 v[232:235], a[168:171], a[240:243], 0
    v_mfma_f32_16x16x32_bf16 v[232:235], a[172:175], a[244:247], v[232:235]
    s_waitcnt lgkmcnt(5)
    v_mfma_f32_16x16x32_bf16 v[228:231], a[152:155], a[216:219], v[228:231]
    s_waitcnt lgkmcnt(4)
    v_cvt_pk_bf16_f32 v74, v236, v237
    v_cvt_pk_bf16_f32 v77, v238, v239
    v_mfma_f32_16x16x32_bf16 v[228:231], a[156:159], a[220:223], v[228:231]
    s_waitcnt lgkmcnt(3)
    v_mfma_f32_16x16x32_bf16 v[228:231], a[160:163], a[224:227], v[228:231]
    s_waitcnt lgkmcnt(2)
    v_mfma_f32_16x16x32_bf16 v[228:231], a[164:167], a[228:231], v[228:231]
    v_mfma_f32_16x16x32_bf16 v[232:235], a[176:179], a[216:219], v[232:235]
    s_waitcnt lgkmcnt(1)
    v_mfma_f32_16x16x32_bf16 v[232:235], a[180:183], a[220:223], v[232:235]
    s_waitcnt lgkmcnt(0)
    v_mfma_f32_16x16x32_bf16 v[232:235], a[184:187], a[224:227], v[232:235]
    v_mfma_f32_16x16x32_bf16 v[232:235], a[188:191], a[228:231], v[232:235]
    v_mfma_f32_16x16x32_bf16 v[236:239], a[192:195], a[240:243], 0
    ds_read_b128 a[240:243], v242 offset:1664
    v_mul_f32 v228, s38, v228
    v_mfma_f32_16x16x32_bf16 v[236:239], a[196:199], a[244:247], v[236:239]
    v_mul_f32 v229, s38, v229
    v_mul_f32 v230, s38, v230
    v_mfma_f32_16x16x32_bf16 v[236:239], a[200:203], a[216:219], v[236:239]
    v_mul_f32 v231, s38, v231
    v_cvt_pk_bf16_f32 v168, v228, v229
    v_mfma_f32_16x16x32_bf16 v[236:239], a[204:207], a[220:223], v[236:239]
    v_cvt_pk_bf16_f32 v169, v230, v231
    v_mul_f32 v232, s3, v232
    v_mfma_f32_16x16x32_bf16 v[236:239], a[208:211], a[224:227], v[236:239]
    v_mul_f32 v233, s3, v233
    v_mul_f32 v234, s3, v234
    v_mfma_f32_16x16x32_bf16 v[236:239], a[212:215], a[228:231], v[236:239]
    v_mul_f32 v235, s3, v235
    v_cvt_pk_bf16_f32 v170, v232, v233
    v_mfma_f32_16x16x32_bf16 v[228:231], a[144:147], a[232:235], 0
    ds_read_b128 a[244:247], v243 offset:1664
    v_cvt_pk_bf16_f32 v171, v234, v235
    v_mfma_f32_16x16x32_bf16 v[228:231], a[148:151], a[236:239], v[228:231]
    ds_read_b128 a[216:219], v242 offset:1792
    ds_read_b128 a[220:223], v243 offset:1792
    v_mfma_f32_16x16x32_bf16 v[196:199], v[102:105], v[168:171], v[196:199]
    s_waitcnt lgkmcnt(3)
    v_mul_f32 v236, s38, v236
    v_mul_f32 v237, s38, v237
    v_mfma_f32_16x16x32_bf16 v[200:203], v[114:117], v[168:171], v[200:203]
    v_mul_f32 v238, s38, v238
    v_mul_f32 v239, s38, v239
    v_mfma_f32_16x16x32_bf16 v[204:207], v[150:153], v[168:171], v[204:207]
    v_cvt_pk_bf16_f32 v172, v236, v237
    v_cvt_pk_bf16_f32 v173, v238, v239
    v_mfma_f32_16x16x32_bf16 v[208:211], v[108:111], v[168:171], v[208:211]
    ds_read_b128 a[224:227], v240 offset:4608
    ds_read_b128 a[228:231], v241 offset:4608
    v_mfma_f32_16x16x32_bf16 v[196:199], v[104:107], v[170:173], v[196:199]
    v_mfma_f32_16x16x32_bf16 v[200:203], v[116:119], v[170:173], v[200:203]
    v_mfma_f32_16x16x32_bf16 v[204:207], v[152:155], v[170:173], v[204:207]
    v_mfma_f32_16x16x32_bf16 v[208:211], v[110:113], v[170:173], v[208:211]
    s_waitcnt lgkmcnt(4)
    v_mfma_f32_16x16x32_bf16 v[228:231], a[152:155], a[240:243], v[228:231]
    s_waitcnt lgkmcnt(3)
    v_mfma_f32_16x16x32_bf16 v[228:231], a[156:159], a[244:247], v[228:231]
    s_waitcnt lgkmcnt(2)
    v_max_f32 v248, v196, v197
    v_max3_f32 v248, v248, v198, v199
    v_mfma_f32_16x16x32_bf16 v[228:231], a[160:163], a[216:219], v[228:231]
    ds_read_b128 v[196:199], v245 offset:256
    v_max3_f32 v248, v248, v200, v201
    v_mfma_f32_16x16x32_bf16 v[228:231], a[164:167], a[220:223], v[228:231]
    v_max3_f32 v248, v248, v202, v203
    v_max3_f32 v248, v248, v204, v205
    v_mfma_f32_16x16x32_bf16 v[232:235], a[168:171], a[232:235], 0
    ds_read_b128 v[200:203], v246 offset:256
    v_max3_f32 v248, v248, v206, v207
    v_mfma_f32_16x16x32_bf16 v[232:235], a[172:175], a[236:239], v[232:235]
    ds_read_b128 v[204:207], v244 offset:320
    v_max3_f32 v248, v248, v208, v209
    v_mfma_f32_16x16x32_bf16 v[232:235], a[176:179], a[240:243], v[232:235]
    s_waitcnt lgkmcnt(3)
    v_mul_f32 v228, s38, v228
    v_mul_f32 v229, s38, v229
    v_mfma_f32_16x16x32_bf16 v[232:235], a[180:183], a[244:247], v[232:235]
    v_mul_f32 v230, s38, v230
    v_mul_f32 v231, s38, v231
    v_mfma_f32_16x16x32_bf16 v[232:235], a[184:187], a[216:219], v[232:235]
    v_cvt_pk_bf16_f32 v174, v228, v229
    v_cvt_pk_bf16_f32 v175, v230, v231
    v_mfma_f32_16x16x32_bf16 v[232:235], a[188:191], a[220:223], v[232:235]
    v_max3_f32 v248, v248, v210, v211
    v_mfma_f32_16x16x32_bf16 v[236:239], a[192:195], a[232:235], 0
    ds_read_b128 a[232:235], v240 offset:4736
    ds_read_b128 v[208:211], v245 offset:320
    v_mfma_f32_16x16x32_bf16 v[236:239], a[196:199], a[236:239], v[236:239]
    ds_read_b128 a[236:239], v241 offset:4736
    s_waitcnt lgkmcnt(5)
    v_mfma_f32_16x16x32_bf16 v[196:199], v[120:123], v[168:171], v[196:199]
    s_waitcnt lgkmcnt(4)
    v_mul_f32 v232, s3, v232
    v_mul_f32 v233, s3, v233
    v_mfma_f32_16x16x32_bf16 v[196:199], v[122:125], v[170:173], v[196:199]
    s_waitcnt lgkmcnt(3)
    v_mul_f32 v234, s3, v234
    v_mul_f32 v235, s3, v235
    v_mfma_f32_16x16x32_bf16 v[200:203], v[156:159], v[168:171], v[200:203]
    v_cvt_pk_bf16_f32 v176, v232, v233
    v_cvt_pk_bf16_f32 v177, v234, v235
    v_mfma_f32_16x16x32_bf16 v[200:203], v[158:161], v[170:173], v[200:203]
    v_mfma_f32_16x16x32_bf16 v[204:207], v[90:93], v[168:171], v[204:207]
    v_max3_f32 v248, v248, v196, v197
    v_max3_f32 v248, v248, v198, v199
    v_mfma_f32_16x16x32_bf16 v[204:207], v[92:95], v[170:173], v[204:207]
    ds_read_b128 v[196:199], v246 offset:320
    v_mfma_f32_16x16x32_bf16 v[236:239], a[200:203], a[240:243], v[236:239]
    ds_read_b128 a[240:243], v240 offset:4864
    v_mfma_f32_16x16x32_bf16 v[236:239], a[204:207], a[244:247], v[236:239]
    ds_read_b128 a[244:247], v241 offset:4864
    v_max3_f32 v248, v248, v200, v201
    v_mfma_f32_16x16x32_bf16 v[236:239], a[208:211], a[216:219], v[236:239]
    ds_read_b128 a[216:219], v242 offset:3072
    v_max3_f32 v248, v248, v202, v203
    v_mfma_f32_16x16x32_bf16 v[236:239], a[212:215], a[220:223], v[236:239]
    ds_read_b128 a[220:223], v243 offset:3072
    ds_read_b128 v[200:203], v244 offset:192
    v_mfma_f32_16x16x32_bf16 v[228:231], a[0:3], a[224:227], 0
    s_waitcnt lgkmcnt(7)
    v_max3_f32 v248, v248, v204, v205
    v_mfma_f32_16x16x32_bf16 v[208:211], v[126:129], v[168:171], v[208:211]
    ds_read_b128 v[204:207], v245 offset:192
    v_mfma_f32_16x16x32_bf16 v[208:211], v[128:131], v[170:173], v[208:211]
    s_waitcnt lgkmcnt(7)
    v_mul_f32 v236, s38, v236
    v_mul_f32 v237, s38, v237
    v_mfma_f32_16x16x32_bf16 v[228:231], a[4:7], a[228:231], v[228:231]
    s_waitcnt lgkmcnt(6)
    v_mul_f32 v238, s38, v238
    v_mul_f32 v239, s38, v239
    v_mfma_f32_16x16x32_bf16 v[196:199], v[162:165], v[168:171], v[196:199]
    v_cvt_pk_bf16_f32 v178, v236, v237
    v_cvt_pk_bf16_f32 v179, v238, v239
    v_mfma_f32_16x16x32_bf16 v[196:199], v[164:167], v[170:173], v[196:199]
    v_max3_f32 v248, v248, v208, v209
    v_mfma_f32_16x16x32_bf16 v[228:231], a[8:11], a[232:235], v[228:231]
    ds_read_b128 v[208:211], v246 offset:192
    v_mfma_f32_16x16x32_bf16 v[228:231], a[12:15], a[236:239], v[228:231]
    s_waitcnt lgkmcnt(6)
    v_mfma_f32_16x16x32_bf16 v[228:231], a[16:19], a[240:243], v[228:231]
    s_waitcnt lgkmcnt(2)
    v_mfma_f32_16x16x32_bf16 v[200:203], v[102:105], v[168:171], v[200:203]
    v_max3_f32 v248, v248, v196, v197
    v_mov_b32 v225, v248
    v_mfma_f32_16x16x32_bf16 v[200:203], v[104:107], v[170:173], v[200:203]
    ds_read_b128 v[196:199], v244 offset:256
    v_permlane16_swap_b32 v248, v225
    v_mfma_f32_16x16x32_bf16 v[228:231], a[20:23], a[244:247], v[228:231]
    s_waitcnt lgkmcnt(2)
    v_max_f32 v248, v248, v225
    v_mov_b32 v225, v248
    v_mfma_f32_16x16x32_bf16 v[204:207], v[114:117], v[168:171], v[204:207]
    v_mfma_f32_16x16x32_bf16 v[204:207], v[116:119], v[170:173], v[204:207]
    v_permlane32_swap_b32 v248, v225
    v_max_f32 v248, v248, v225
    v_mfma_f32_16x16x32_bf16 v[232:235], a[24:27], a[224:227], 0
    v_cvt_pk_bf16_f32 v102, v228, v229
    v_cvt_pk_bf16_f32 v103, v230, v231
    v_mfma_f32_16x16x32_bf16 v[232:235], a[28:31], a[228:231], v[232:235]
    s_waitcnt lgkmcnt(1)
    v_sub_f32 v200, v200, v248
    v_sub_f32 v201, v201, v248
    v_mfma_f32_16x16x32_bf16 v[208:211], v[150:153], v[168:171], v[208:211]
    v_exp_f32 v200, v200
    v_mfma_f32_16x16x32_bf16 v[208:211], v[152:155], v[170:173], v[208:211]
    v_exp_f32 v201, v201
    v_mfma_f32_16x16x32_bf16 v[232:235], a[32:35], a[232:235], v[232:235]
    v_sub_f32 v202, v202, v248
    v_sub_f32 v203, v203, v248
    v_mfma_f32_16x16x32_bf16 v[232:235], a[36:39], a[236:239], v[232:235]
    s_waitcnt lgkmcnt(0)
    v_exp_f32 v202, v202
    v_mfma_f32_16x16x32_bf16 v[196:199], v[108:111], v[168:171], v[196:199]
    v_exp_f32 v203, v203
    v_mfma_f32_16x16x32_bf16 v[196:199], v[110:113], v[170:173], v[196:199]
    v_cvt_pk_bf16_f32 v180, v200, v201
    v_cvt_pk_bf16_f32 v183, v202, v203
    v_mfma_f32_16x16x32_bf16 v[232:235], a[40:43], a[240:243], v[232:235]
    ds_read_b128 v[200:203], v245 offset:256
    v_sub_f32 v204, v204, v248
    v_mfma_f32_16x16x32_bf16 v[232:235], a[44:47], a[244:247], v[232:235]
    v_exp_f32 v204, v204
    v_mfma_f32_16x16x32_bf16 v[236:239], a[48:51], a[224:227], 0
    v_sub_f32 v205, v205, v248
    v_sub_f32 v206, v206, v248
    v_mfma_f32_16x16x32_bf16 v[236:239], a[52:55], a[228:231], v[236:239]
    v_exp_f32 v205, v205
    v_mfma_f32_16x16x32_bf16 v[236:239], a[56:59], a[232:235], v[236:239]
    v_exp_f32 v206, v206
    v_mfma_f32_16x16x32_bf16 v[236:239], a[60:63], a[236:239], v[236:239]
    v_cvt_pk_bf16_f32 v104, v232, v233
    v_cvt_pk_bf16_f32 v105, v234, v235
    v_mfma_f32_16x16x32_bf16 v[236:239], a[64:67], a[240:243], v[236:239]
    v_sub_f32 v207, v207, v248
    v_cvt_pk_bf16_f32 v181, v204, v205
    v_mfma_f32_16x16x32_bf16 v[236:239], a[68:71], a[244:247], v[236:239]
    v_exp_f32 v207, v207
    v_mfma_f32_16x16x32_bf16 v[228:231], a[224:227], a[72:75], 0
    v_cvt_pk_bf16_f32 v184, v206, v207
    v_sub_f32 v208, v208, v248
    v_mfma_f32_16x16x32_bf16 v[228:231], a[228:231], a[76:79], v[228:231]
    ds_read_b128 v[204:207], v246 offset:256
    v_sub_f32 v209, v209, v248
    v_mfma_f32_16x16x32_bf16 v[228:231], a[232:235], a[80:83], v[228:231]
    s_waitcnt lgkmcnt(1)
    v_cvt_pk_bf16_f32 v106, v236, v237
    v_cvt_pk_bf16_f32 v107, v238, v239
    v_mfma_f32_16x16x32_bf16 v[200:203], v[120:123], v[168:171], v[200:203]
    v_exp_f32 v208, v208
    v_mfma_f32_16x16x32_bf16 v[200:203], v[122:125], v[170:173], v[200:203]
    v_exp_f32 v209, v209
    v_mfma_f32_16x16x32_bf16 v[228:231], a[236:239], a[84:87], v[228:231]
    v_sub_f32 v210, v210, v248
    v_sub_f32 v211, v211, v248
    v_mfma_f32_16x16x32_bf16 v[228:231], a[240:243], a[88:91], v[228:231]
    v_exp_f32 v210, v210
    v_mfma_f32_16x16x32_bf16 v[228:231], a[244:247], a[92:95], v[228:231]
    v_exp_f32 v211, v211
    v_mfma_f32_16x16x32_bf16 v[232:235], a[224:227], a[96:99], 0
    v_cvt_pk_bf16_f32 v182, v208, v209
    v_cvt_pk_bf16_f32 v185, v210, v211
    v_mfma_f32_16x16x32_bf16 v[232:235], a[228:231], a[100:103], v[232:235]
    ds_read_b128 v[208:211], v244 offset:320
    v_sub_f32 v196, v196, v248
    v_mfma_f32_16x16x32_bf16 v[212:215], v[0:3], v[180:183], 0
    s_waitcnt lgkmcnt(1)
    v_cvt_pk_bf16_f32 v20, v228, v229
    v_cvt_pk_bf16_f32 v23, v230, v231
    v_mfma_f32_16x16x32_bf16 v[216:219], v[30:33], v[180:183], 0
    v_exp_f32 v196, v196
    v_mfma_f32_16x16x32_bf16 v[220:223], v[60:63], v[180:183], 0
    v_sub_f32 v197, v197, v248
    v_sub_f32 v198, v198, v248
    v_mfma_f32_16x16x32_bf16 v[224:227], a[248:251], v[180:183], 0
    v_exp_f32 v197, v197
    v_mfma_f32_16x16x32_bf16 v[204:207], v[156:159], v[168:171], v[204:207]
    v_exp_f32 v198, v198
    v_mfma_f32_16x16x32_bf16 v[204:207], v[158:161], v[170:173], v[204:207]
    v_sub_f32 v199, v199, v248
    v_cvt_pk_bf16_f32 v186, v196, v197
    v_mfma_f32_16x16x32_bf16 v[232:235], a[232:235], a[104:107], v[232:235]
    v_exp_f32 v199, v199
    v_mfma_f32_16x16x32_bf16 v[232:235], a[236:239], a[108:111], v[232:235]
    v_cvt_pk_bf16_f32 v189, v198, v199
    v_sub_f32 v200, v200, v248
    v_mfma_f32_16x16x32_bf16 v[232:235], a[240:243], a[112:115], v[232:235]
    ds_read_b128 v[196:199], v245 offset:320
    v_sub_f32 v201, v201, v248
    v_mfma_f32_16x16x32_bf16 v[232:235], a[244:247], a[116:119], v[232:235]
    s_waitcnt lgkmcnt(1)
    v_exp_f32 v200, v200
    v_mfma_f32_16x16x32_bf16 v[208:211], v[90:93], v[168:171], v[208:211]
    v_exp_f32 v201, v201
    v_mfma_f32_16x16x32_bf16 v[208:211], v[92:95], v[170:173], v[208:211]
    v_sub_f32 v202, v202, v248
    v_sub_f32 v203, v203, v248
    v_mfma_f32_16x16x32_bf16 v[236:239], a[224:227], a[120:123], 0
    v_cvt_pk_bf16_f32 v50, v232, v233
    v_cvt_pk_bf16_f32 v53, v234, v235
    v_mfma_f32_16x16x32_bf16 v[236:239], a[228:231], a[124:127], v[236:239]
    ds_read_b128 a[224:227], v242 offset:3200
    ds_read_b128 a[228:231], v243 offset:3200
    v_mfma_f32_16x16x32_bf16 v[236:239], a[232:235], a[128:131], v[236:239]
    ds_read_b128 a[232:235], v242 offset:3328
    v_cvt_pk_bf16_f32 v187, v200, v201
    v_mfma_f32_16x16x32_bf16 v[236:239], a[236:239], a[132:135], v[236:239]
    ds_read_b128 a[236:239], v243 offset:3328
    v_sub_f32 v204, v204, v248
    v_mfma_f32_16x16x32_bf16 v[212:215], v[4:7], v[184:187], v[212:215]
    s_waitcnt lgkmcnt(4)
    v_exp_f32 v202, v202
    v_mfma_f32_16x16x32_bf16 v[216:219], v[34:37], v[184:187], v[216:219]
    v_exp_f32 v203, v203
    v_mfma_f32_16x16x32_bf16 v[220:223], v[64:67], v[184:187], v[220:223]
    v_cvt_pk_bf16_f32 v190, v202, v203
    v_sub_f32 v205, v205, v248
    v_mfma_f32_16x16x32_bf16 v[224:227], a[248:251], v[184:187], v[224:227]
    ds_read_b128 v[200:203], v246 offset:320
    v_sub_f32 v206, v206, v248
    v_mfma_f32_16x16x32_bf16 v[196:199], v[126:129], v[168:171], v[196:199]
    v_exp_f32 v204, v204
    v_mfma_f32_16x16x32_bf16 v[196:199], v[128:131], v[170:173], v[196:199]
    v_exp_f32 v205, v205
    v_mfma_f32_16x16x32_bf16 v[236:239], a[240:243], a[136:139], v[236:239]
    ds_read_b128 a[240:243], v240 offset:6144
    v_sub_f32 v207, v207, v248
    v_mfma_f32_16x16x32_bf16 v[236:239], a[244:247], a[140:143], v[236:239]
    ds_read_b128 a[244:247], v241 offset:6144
    v_cvt_pk_bf16_f32 v188, v204, v205
    v_mfma_f32_16x16x32_bf16 v[228:231], a[144:147], a[216:219], 0
    s_waitcnt lgkmcnt(5)
    v_exp_f32 v206, v206
    v_mfma_f32_16x16x32_bf16 v[228:231], a[148:151], a[220:223], v[228:231]
    s_waitcnt lgkmcnt(4)
    v_exp_f32 v207, v207
    v_mfma_f32_16x16x32_bf16 v[228:231], a[152:155], a[224:227], v[228:231]
    s_waitcnt lgkmcnt(3)
    v_cvt_pk_bf16_f32 v80, v236, v237
    v_cvt_pk_bf16_f32 v83, v238, v239
    v_mfma_f32_16x16x32_bf16 v[228:231], a[156:159], a[228:231], v[228:231]
    v_cvt_pk_bf16_f32 v191, v206, v207
    v_sub_f32 v208, v208, v248
    v_mfma_f32_16x16x32_bf16 v[228:231], a[160:163], a[232:235], v[228:231]
    ds_read_b128 v[204:207], v244 offset:0
    v_sub_f32 v209, v209, v248
    v_mfma_f32_16x16x32_bf16 v[212:215], v[8:11], v[188:191], v[212:215]
    s_waitcnt lgkmcnt(3)
    v_exp_f32 v208, v208
    v_mfma_f32_16x16x32_bf16 v[216:219], v[38:41], v[188:191], v[216:219]
    v_exp_f32 v209, v209
    v_mfma_f32_16x16x32_bf16 v[220:223], v[68:71], v[188:191], v[220:223]
    v_cvt_pk_bf16_f32 v192, v208, v209
    v_sub_f32 v196, v196, v248
    v_mfma_f32_16x16x32_bf16 v[224:227], a[248:251], v[188:191], v[224:227]
    ds_read_b128 v[208:211], v245 offset:0
    v_sub_f32 v197, v197, v248
    v_mfma_f32_16x16x32_bf16 v[200:203], v[162:165], v[168:171], v[200:203]
    s_waitcnt lgkmcnt(2)
    v_exp_f32 v196, v196
    v_mfma_f32_16x16x32_bf16 v[200:203], v[164:167], v[170:173], v[200:203]
    v_exp_f32 v197, v197
    v_mfma_f32_16x16x32_bf16 v[228:231], a[164:167], a[236:239], v[228:231]
    v_cvt_pk_bf16_f32 v193, v196, v197
    v_mfma_f32_16x16x32_bf16 v[232:235], a[168:171], a[216:219], 0
    ds_read_b128 v[196:199], v246 offset:0
    s_waitcnt lgkmcnt(2)
    v_mfma_f32_16x16x32_bf16 v[204:207], v[108:111], v[174:177], v[204:207]
    v_mfma_f32_16x16x32_bf16 v[204:207], v[110:113], v[176:179], v[204:207]
    v_sub_f32 v200, v200, v248
    v_sub_f32 v201, v201, v248
    v_mfma_f32_16x16x32_bf16 v[232:235], a[172:175], a[220:223], v[232:235]
    v_mul_f32 v228, s38, v228
    v_mul_f32 v229, s38, v229
    v_mfma_f32_16x16x32_bf16 v[232:235], a[176:179], a[224:227], v[232:235]
    v_mul_f32 v230, s38, v230
    v_mul_f32 v231, s38, v231
    v_mfma_f32_16x16x32_bf16 v[232:235], a[180:183], a[228:231], v[232:235]
    s_waitcnt lgkmcnt(1)
    v_cvt_pk_bf16_f32 v168, v228, v229
    v_cvt_pk_bf16_f32 v169, v230, v231
    v_mfma_f32_16x16x32_bf16 v[208:211], v[120:123], v[174:177], v[208:211]
    v_exp_f32 v200, v200
    v_mfma_f32_16x16x32_bf16 v[208:211], v[122:125], v[176:179], v[208:211]
    v_exp_f32 v201, v201
    v_mfma_f32_16x16x32_bf16 v[232:235], a[184:187], a[232:235], v[232:235]
    v_cvt_pk_bf16_f32 v194, v200, v201
    v_max_f32 v248, v204, v205
    v_mfma_f32_16x16x32_bf16 v[232:235], a[188:191], a[236:239], v[232:235]
    ds_read_b128 v[200:203], v244 offset:64
    v_max3_f32 v248, v248, v206, v207
    v_mfma_f32_16x16x32_bf16 v[212:215], v[12:15], v[192:195], v[212:215]
    ds_read_b128 v[204:207], v245 offset:64
    v_max3_f32 v248, v248, v208, v209
    v_mfma_f32_16x16x32_bf16 v[216:219], v[42:45], v[192:195], v[216:219]
    s_waitcnt lgkmcnt(2)
    v_max3_f32 v248, v248, v210, v211
    v_mul_f32 v232, s3, v232
    v_mfma_f32_16x16x32_bf16 v[220:223], v[72:75], v[192:195], v[220:223]
    v_mul_f32 v233, s3, v233
    v_mul_f32 v234, s3, v234
    v_mfma_f32_16x16x32_bf16 v[224:227], a[248:251], v[192:195], v[224:227]
    v_mul_f32 v235, s3, v235
    v_cvt_pk_bf16_f32 v170, v232, v233
    v_mfma_f32_16x16x32_bf16 v[196:199], v[156:159], v[174:177], v[196:199]
    ds_read_b128 v[208:211], v246 offset:64
    v_cvt_pk_bf16_f32 v171, v234, v235
    v_mfma_f32_16x16x32_bf16 v[196:199], v[158:161], v[176:179], v[196:199]
    v_mfma_f32_16x16x32_bf16 v[236:239], a[192:195], a[216:219], 0
    ds_read_b128 a[216:219], v240 offset:6272
    v_mfma_f32_16x16x32_bf16 v[236:239], a[196:199], a[220:223], v[236:239]
    ds_read_b128 a[220:223], v241 offset:6272
    s_waitcnt lgkmcnt(4)
    v_mfma_f32_16x16x32_bf16 v[200:203], v[90:93], v[174:177], v[200:203]
    v_rcp_f32 v225, v224
    v_mfma_f32_16x16x32_bf16 v[200:203], v[92:95], v[176:179], v[200:203]
    s_waitcnt lgkmcnt(3)
    v_mul_f32 v212, v212, v225
    v_mul_f32 v213, v213, v225
    v_mfma_f32_16x16x32_bf16 v[204:207], v[126:129], v[174:177], v[204:207]
    v_mul_f32 v214, v214, v225
    v_mul_f32 v215, v215, v225
    v_mfma_f32_16x16x32_bf16 v[204:207], v[128:131], v[176:179], v[204:207]
    v_cvt_pk_bf16_f32 v212, v212, v213
    v_cvt_pk_bf16_f32 v213, v214, v215
    v_mfma_f32_16x16x32_bf16 v[236:239], a[200:203], a[224:227], v[236:239]
    ds_read_b128 a[224:227], v240 offset:6400
    v_mul_f32 v216, v216, v225
    v_mfma_f32_16x16x32_bf16 v[236:239], a[204:207], a[228:231], v[236:239]
    ds_read_b128 a[228:231], v241 offset:6400
    v_mul_f32 v217, v217, v225
    v_mfma_f32_16x16x32_bf16 v[236:239], a[208:211], a[232:235], v[236:239]
    ds_read_b128 a[232:235], v254 offset:4608
    v_mul_f32 v218, v218, v225
    v_mfma_f32_16x16x32_bf16 v[236:239], a[212:215], a[236:239], v[236:239]
    ds_read_b128 a[236:239], v255 offset:4608
    v_mul_f32 v219, v219, v225
    v_mfma_f32_16x16x32_bf16 v[228:231], a[0:3], a[240:243], 0
    ds_write_b64 v251, v[212:213] offset:0
    v_mfma_f32_16x16x32_bf16 v[228:231], a[4:7], a[244:247], v[228:231]
    s_waitcnt lgkmcnt(6)
    v_cvt_pk_bf16_f32 v216, v216, v217
    v_cvt_pk_bf16_f32 v217, v218, v219
    v_mfma_f32_16x16x32_bf16 v[208:211], v[162:165], v[174:177], v[208:211]
    s_waitcnt lgkmcnt(5)
    v_mul_f32 v236, s38, v236
    v_mul_f32 v237, s38, v237
    v_mfma_f32_16x16x32_bf16 v[208:211], v[164:167], v[176:179], v[208:211]
    v_mul_f32 v238, s38, v238
    v_mul_f32 v239, s38, v239
    v_mfma_f32_16x16x32_bf16 v[228:231], a[8:11], a[216:219], v[228:231]
    v_cvt_pk_bf16_f32 v172, v236, v237
    v_cvt_pk_bf16_f32 v173, v238, v239
    v_mfma_f32_16x16x32_bf16 v[228:231], a[12:15], a[220:223], v[228:231]
    ds_write_b64 v251, v[216:217] offset:128
    v_mfma_f32_16x16x32_bf16 v[232:235], a[24:27], a[240:243], 0
    s_waitcnt lgkmcnt(5)
    v_mul_f32 v220, v220, v225
    v_mul_f32 v221, v221, v225
    v_mfma_f32_16x16x32_bf16 v[228:231], a[16:19], a[224:227], v[228:231]
    s_waitcnt lgkmcnt(4)
    v_mul_f32 v222, v222, v225
    v_mul_f32 v223, v223, v225
    v_mfma_f32_16x16x32_bf16 v[228:231], a[20:23], a[228:231], v[228:231]
    s_waitcnt lgkmcnt(2)
    v_cvt_pk_bf16_f32 v220, v220, v221
    v_cvt_pk_bf16_f32 v221, v222, v223
    v_mfma_f32_16x16x32_bf16 v[232:235], a[28:31], a[244:247], v[232:235]
    ds_write_b64 v251, v[220:221] offset:256
    v_mfma_f32_16x16x32_bf16 v[232:235], a[32:35], a[216:219], v[232:235]
    v_max3_f32 v248, v248, v196, v197
    v_max3_f32 v248, v248, v198, v199
    v_mfma_f32_16x16x32_bf16 v[232:235], a[36:39], a[220:223], v[232:235]
    ds_read_b128 v[196:199], v244 offset:128
    v_max3_f32 v248, v248, v200, v201
    v_mfma_f32_16x16x32_bf16 v[232:235], a[40:43], a[224:227], v[232:235]
    v_max3_f32 v248, v248, v202, v203
    v_max3_f32 v248, v248, v204, v205
    v_mfma_f32_16x16x32_bf16 v[232:235], a[44:47], a[228:231], v[232:235]
    ds_read_b128 v[200:203], v245 offset:128
    v_max3_f32 v248, v248, v206, v207
    v_mfma_f32_16x16x32_bf16 v[236:239], a[48:51], a[240:243], 0
    ds_read_b128 v[204:207], v246 offset:128
    v_max3_f32 v248, v248, v208, v209
    v_mfma_f32_16x16x32_bf16 v[236:239], a[52:55], a[244:247], v[236:239]
    v_max3_f32 v248, v248, v210, v211
    v_mfma_f32_16x16x32_bf16 v[236:239], a[56:59], a[216:219], v[236:239]
    ds_read_b128 v[208:211], v244 offset:0
    v_mfma_f32_16x16x32_bf16 v[236:239], a[60:63], a[220:223], v[236:239]
    v_mfma_f32_16x16x32_bf16 v[236:239], a[64:67], a[224:227], v[236:239]
    v_mfma_f32_16x16x32_bf16 v[236:239], a[68:71], a[228:231], v[236:239]
    s_waitcnt lgkmcnt(3)
    v_mfma_f32_16x16x32_bf16 v[196:199], v[96:99], v[174:177], v[196:199]
    v_mfma_f32_16x16x32_bf16 v[196:199], v[98:101], v[176:179], v[196:199]
    s_nop 7
    s_waitcnt lgkmcnt(1)
    v_mfma_f32_16x16x32_bf16 v[200:203], v[132:135], v[174:177], v[200:203]
    v_max3_f32 v248, v248, v196, v197
    v_mfma_f32_16x16x32_bf16 v[200:203], v[134:137], v[176:179], v[200:203]
    ds_read_b128 v[196:199], v245 offset:0
    s_waitcnt lgkmcnt(1)
    v_mfma_f32_16x16x32_bf16 v[204:207], v[102:105], v[174:177], v[204:207]
    v_mfma_f32_16x16x32_bf16 v[204:207], v[104:107], v[176:179], v[204:207]
    v_mfma_f32_16x16x32_bf16 v[208:211], v[108:111], v[174:177], v[208:211]
    v_cvt_pk_bf16_f32 v108, v228, v229
    v_cvt_pk_bf16_f32 v109, v230, v231
    v_mfma_f32_16x16x32_bf16 v[208:211], v[110:113], v[176:179], v[208:211]
    v_cvt_pk_bf16_f32 v110, v232, v233
    v_cvt_pk_bf16_f32 v111, v234, v235
    v_mfma_f32_16x16x32_bf16 v[228:231], a[240:243], a[72:75], 0
    v_cvt_pk_bf16_f32 v112, v236, v237
    v_cvt_pk_bf16_f32 v113, v238, v239
    v_mfma_f32_16x16x32_bf16 v[228:231], a[244:247], a[76:79], v[228:231]
    v_max3_f32 v248, v248, v200, v201
    v_max3_f32 v248, v248, v204, v205
    v_mfma_f32_16x16x32_bf16 v[228:231], a[216:219], a[80:83], v[228:231]
    ds_read_b128 v[200:203], v246 offset:0
    ds_read_b128 v[204:207], v244 offset:64
    v_mfma_f32_16x16x32_bf16 v[228:231], a[220:223], a[84:87], v[228:231]
    s_waitcnt lgkmcnt(2)
    v_mov_b32 v225, v248
    v_mfma_f32_16x16x32_bf16 v[196:199], v[120:123], v[174:177], v[196:199]
    v_mfma_f32_16x16x32_bf16 v[196:199], v[122:125], v[176:179], v[196:199]
    v_permlane16_swap_b32 v248, v225
    v_max_f32 v248, v248, v225
    v_mfma_f32_16x16x32_bf16 v[228:231], a[224:227], a[88:91], v[228:231]
    v_mov_b32 v225, v248
    v_mfma_f32_16x16x32_bf16 v[228:231], a[228:231], a[92:95], v[228:231]
    v_mfma_f32_16x16x32_bf16 v[232:235], a[240:243], a[96:99], 0
    v_permlane32_swap_b32 v248, v225
    v_max_f32 v248, v248, v225
    v_mfma_f32_16x16x32_bf16 v[232:235], a[244:247], a[100:103], v[232:235]
    v_sub_f32 v208, v208, v248
    v_sub_f32 v209, v209, v248
    v_mfma_f32_16x16x32_bf16 v[232:235], a[216:219], a[104:107], v[232:235]
    s_waitcnt lgkmcnt(1)
    v_cvt_pk_bf16_f32 v26, v228, v229
    v_cvt_pk_bf16_f32 v29, v230, v231
    v_mfma_f32_16x16x32_bf16 v[200:203], v[156:159], v[174:177], v[200:203]
    s_waitcnt lgkmcnt(0)
    v_exp_f32 v208, v208
    v_mfma_f32_16x16x32_bf16 v[200:203], v[158:161], v[176:179], v[200:203]
    v_exp_f32 v209, v209
    v_mfma_f32_16x16x32_bf16 v[204:207], v[90:93], v[174:177], v[204:207]
    v_sub_f32 v210, v210, v248
    v_sub_f32 v211, v211, v248
    v_mfma_f32_16x16x32_bf16 v[204:207], v[92:95], v[176:179], v[204:207]
    v_exp_f32 v210, v210
    v_mfma_f32_16x16x32_bf16 v[232:235], a[220:223], a[108:111], v[232:235]
    v_exp_f32 v211, v211
    v_mfma_f32_16x16x32_bf16 v[232:235], a[224:227], a[112:115], v[232:235]
    v_cvt_pk_bf16_f32 v180, v208, v209
    v_cvt_pk_bf16_f32 v183, v210, v211
    v_mfma_f32_16x16x32_bf16 v[232:235], a[228:231], a[116:119], v[232:235]
    ds_read_b128 v[208:211], v245 offset:64
    v_sub_f32 v196, v196, v248
    v_mfma_f32_16x16x32_bf16 v[236:239], a[240:243], a[120:123], 0
    ds_read_b128 a[240:243], v254 offset:4736
    v_sub_f32 v197, v197, v248
    v_mfma_f32_16x16x32_bf16 v[236:239], a[244:247], a[124:127], v[236:239]
    ds_read_b128 a[244:247], v255 offset:4736
    v_sub_f32 v198, v198, v248
    v_mfma_f32_16x16x32_bf16 v[236:239], a[216:219], a[128:131], v[236:239]
    v_cvt_pk_bf16_f32 v56, v232, v233
    v_cvt_pk_bf16_f32 v59, v234, v235
    v_mfma_f32_16x16x32_bf16 v[236:239], a[220:223], a[132:135], v[236:239]
    ds_read_b128 a[216:219], v254 offset:4864
    ds_read_b128 a[220:223], v255 offset:4864
    v_mfma_f32_16x16x32_bf16 v[236:239], a[224:227], a[136:139], v[236:239]
    ds_read_b128 a[224:227], v242 offset:30720
    v_sub_f32 v199, v199, v248
    v_mfma_f32_16x16x32_bf16 v[236:239], a[228:231], a[140:143], v[236:239]
    ds_read_b128 a[228:231], v243 offset:30720
    v_sub_f32 v200, v200, v248
    v_mfma_f32_16x16x32_bf16 v[228:231], a[144:147], a[232:235], 0
    v_exp_f32 v196, v196
    v_mfma_f32_16x16x32_bf16 v[228:231], a[148:151], a[236:239], v[228:231]
    s_waitcnt lgkmcnt(6)
    v_exp_f32 v197, v197
    v_mfma_f32_16x16x32_bf16 v[208:211], v[126:129], v[174:177], v[208:211]
    s_waitcnt lgkmcnt(5)
    v_cvt_pk_bf16_f32 v86, v236, v237
    v_cvt_pk_bf16_f32 v89, v238, v239
    v_mfma_f32_16x16x32_bf16 v[208:211], v[128:131], v[176:179], v[208:211]
    v_exp_f32 v198, v198
    v_mfma_f32_16x16x32_bf16 v[228:231], a[152:155], a[240:243], v[228:231]
    s_waitcnt lgkmcnt(4)
    v_exp_f32 v199, v199
    v_mfma_f32_16x16x32_bf16 v[228:231], a[156:159], a[244:247], v[228:231]
    s_waitcnt lgkmcnt(3)
    v_cvt_pk_bf16_f32 v181, v196, v197
    v_cvt_pk_bf16_f32 v184, v198, v199
    v_mfma_f32_16x16x32_bf16 v[228:231], a[160:163], a[216:219], v[228:231]
    ds_read_b128 v[196:199], v246 offset:64
    s_waitcnt vmcnt(5) lgkmcnt(3)
    v_mfma_f32_16x16x32_bf16 v[228:231], a[164:167], a[220:223], v[228:231]
    s_barrier
    v_mfma_f32_16x16x32_bf16 v[232:235], a[168:171], a[232:235], 0
    s_waitcnt lgkmcnt(1)
    v_exp_f32 v200, v200
    v_mfma_f32_16x16x32_bf16 v[232:235], a[172:175], a[236:239], v[232:235]
    v_sub_f32 v201, v201, v248
    v_sub_f32 v202, v202, v248
    v_mfma_f32_16x16x32_bf16 v[232:235], a[176:179], a[240:243], v[232:235]
    v_mul_f32 v228, s38, v228
    v_mul_f32 v229, s38, v229
    v_mfma_f32_16x16x32_bf16 v[232:235], a[180:183], a[244:247], v[232:235]
    v_mul_f32 v230, s38, v230
    v_mul_f32 v231, s38, v231
    v_mfma_f32_16x16x32_bf16 v[232:235], a[184:187], a[216:219], v[232:235]
    v_exp_f32 v201, v201
    v_mfma_f32_16x16x32_bf16 v[232:235], a[188:191], a[220:223], v[232:235]
    s_waitcnt lgkmcnt(0)
    v_exp_f32 v202, v202
    v_mfma_f32_16x16x32_bf16 v[196:199], v[162:165], v[174:177], v[196:199]
    v_sub_f32 v203, v203, v248
    v_cvt_pk_bf16_f32 v182, v200, v201
    v_mfma_f32_16x16x32_bf16 v[196:199], v[164:167], v[176:179], v[196:199]
    v_exp_f32 v203, v203
    v_mfma_f32_16x16x32_bf16 v[212:215], v[6:9], v[180:183], 0
    v_mul_f32 v232, s3, v232
    v_mul_f32 v233, s3, v233
    v_mfma_f32_16x16x32_bf16 v[216:219], v[36:39], v[180:183], 0
    v_mul_f32 v234, s3, v234
    v_mul_f32 v235, s3, v235
    v_mfma_f32_16x16x32_bf16 v[220:223], v[66:69], v[180:183], 0
    v_cvt_pk_bf16_f32 v185, v202, v203
    v_sub_f32 v204, v204, v248
    v_mfma_f32_16x16x32_bf16 v[224:227], a[248:251], v[180:183], 0
    ds_read_b128 v[200:203], v244 offset:128
    v_sub_f32 v205, v205, v248
    v_mfma_f32_16x16x32_bf16 v[236:239], a[192:195], a[232:235], 0
    ds_read_b128 a[232:235], v242 offset:30848
    v_sub_f32 v206, v206, v248
    v_mfma_f32_16x16x32_bf16 v[236:239], a[196:199], a[236:239], v[236:239]
    ds_read_b128 a[236:239], v243 offset:30848
    v_sub_f32 v207, v207, v248
    v_mfma_f32_16x16x32_bf16 v[236:239], a[200:203], a[240:243], v[236:239]
    ds_read_b128 a[240:243], v242 offset:30976
    v_sub_f32 v208, v208, v248
    v_mfma_f32_16x16x32_bf16 v[236:239], a[204:207], a[244:247], v[236:239]
    ds_read_b128 a[244:247], v243 offset:30976
    v_sub_f32 v209, v209, v248
    v_mfma_f32_16x16x32_bf16 v[236:239], a[208:211], a[216:219], v[236:239]
    ds_read_b128 a[216:219], v240 offset:32256
    v_sub_f32 v210, v210, v248
    v_mfma_f32_16x16x32_bf16 v[236:239], a[212:215], a[220:223], v[236:239]
    ds_read_b128 a[220:223], v241 offset:32256
    v_exp_f32 v204, v204
    v_exp_f32 v205, v205
    v_exp_f32 v206, v206
    v_exp_f32 v207, v207
    s_waitcnt lgkmcnt(6)
    v_mfma_f32_16x16x32_bf16 v[200:203], v[96:99], v[174:177], v[200:203]
    v_cvt_pk_bf16_f32 v186, v204, v205
    v_mul_f32 v236, s38, v236
    v_mfma_f32_16x16x32_bf16 v[200:203], v[98:101], v[176:179], v[200:203]
    v_mul_f32 v237, s38, v237
    v_mul_f32 v238, s38, v238
    v_mul_f32 v239, s38, v239
    v_cvt_pk_bf16_f32 v189, v206, v207
    ds_read_b128 v[204:207], v245 offset:128
    v_exp_f32 v208, v208
    v_exp_f32 v209, v209
    v_exp_f32 v210, v210
    v_sub_f32 v211, v211, v248
    v_exp_f32 v211, v211
    v_cvt_pk_bf16_f32 v187, v208, v209
    v_cvt_pk_bf16_f32 v190, v210, v211
    ds_read_b128 v[208:211], v246 offset:128
    v_mfma_f32_16x16x32_bf16 v[212:215], v[10:13], v[184:187], v[212:215]
    s_waitcnt lgkmcnt(2)
    v_sub_f32 v196, v196, v248
    v_sub_f32 v197, v197, v248
    v_mfma_f32_16x16x32_bf16 v[216:219], v[40:43], v[184:187], v[216:219]
    v_exp_f32 v196, v196
    v_mfma_f32_16x16x32_bf16 v[220:223], v[70:73], v[184:187], v[220:223]
    v_exp_f32 v197, v197
    v_mfma_f32_16x16x32_bf16 v[224:227], a[248:251], v[184:187], v[224:227]
    v_sub_f32 v198, v198, v248
    v_exp_f32 v198, v198
    s_waitcnt lgkmcnt(1)
    v_mfma_f32_16x16x32_bf16 v[204:207], v[132:135], v[174:177], v[204:207]
    v_sub_f32 v199, v199, v248
    v_cvt_pk_bf16_f32 v188, v196, v197
    v_mfma_f32_16x16x32_bf16 v[204:207], v[134:137], v[176:179], v[204:207]
    v_exp_f32 v199, v199
    v_sub_f32 v200, v200, v248
    v_cvt_pk_bf16_f32 v191, v198, v199
    ds_read_b128 v[196:199], v244 offset:0
    s_waitcnt lgkmcnt(1)
    v_mfma_f32_16x16x32_bf16 v[212:215], v[14:17], v[188:191], v[212:215]
    v_exp_f32 v200, v200
    v_mfma_f32_16x16x32_bf16 v[216:219], v[44:47], v[188:191], v[216:219]
    v_sub_f32 v201, v201, v248
    v_sub_f32 v204, v204, v248
    v_mfma_f32_16x16x32_bf16 v[220:223], v[74:77], v[188:191], v[220:223]
    v_exp_f32 v201, v201
    v_mfma_f32_16x16x32_bf16 v[224:227], a[248:251], v[188:191], v[224:227]
    v_cvt_pk_bf16_f32 v192, v200, v201
    v_sub_f32 v205, v205, v248
    v_mfma_f32_16x16x32_bf16 v[208:211], v[102:105], v[174:177], v[208:211]
    v_cvt_pk_bf16_f32 v174, v228, v229
    v_cvt_pk_bf16_f32 v175, v230, v231
    v_mfma_f32_16x16x32_bf16 v[208:211], v[104:107], v[176:179], v[208:211]
    ds_write_b64 v247, v[174:175] offset:0
    v_mfma_f32_16x16x32_bf16 v[228:231], a[144:147], a[224:227], 0
    v_cvt_pk_bf16_f32 v176, v232, v233
    v_cvt_pk_bf16_f32 v177, v234, v235
    v_mfma_f32_16x16x32_bf16 v[228:231], a[148:151], a[228:231], v[228:231]
    ds_write_b64 v247, v[176:177] offset:128
    v_mfma_f32_16x16x32_bf16 v[228:231], a[152:155], a[232:235], v[228:231]
    s_waitcnt lgkmcnt(2)
    v_cvt_pk_bf16_f32 v178, v236, v237
    v_cvt_pk_bf16_f32 v179, v238, v239
    v_mfma_f32_16x16x32_bf16 v[196:199], v[90:93], v[168:171], v[196:199]
    ds_write_b64 v247, v[178:179] offset:256
    v_mfma_f32_16x16x32_bf16 v[196:199], v[92:95], v[170:173], v[196:199]
    ds_read_b128 v[200:203], v245 offset:0
    v_sub_f32 v208, v208, v248
    v_mfma_f32_16x16x32_bf16 v[228:231], a[156:159], a[236:239], v[228:231]
    v_exp_f32 v204, v204
    v_mfma_f32_16x16x32_bf16 v[228:231], a[160:163], a[240:243], v[228:231]
    v_exp_f32 v205, v205
    v_mfma_f32_16x16x32_bf16 v[228:231], a[164:167], a[244:247], v[228:231]
    v_cvt_pk_bf16_f32 v193, v204, v205
    v_sub_f32 v209, v209, v248
    v_mfma_f32_16x16x32_bf16 v[232:235], a[168:171], a[224:227], 0
    ds_read_b128 v[204:207], v246 offset:0
    v_max_f32 v248, v196, v197
    v_mfma_f32_16x16x32_bf16 v[232:235], a[172:175], a[228:231], v[232:235]
    v_exp_f32 v208, v208
    v_mfma_f32_16x16x32_bf16 v[232:235], a[176:179], a[232:235], v[232:235]
    v_mul_f32 v228, s38, v228
    v_mul_f32 v229, s38, v229
    v_mfma_f32_16x16x32_bf16 v[232:235], a[180:183], a[236:239], v[232:235]
    v_mul_f32 v230, s38, v230
    v_mul_f32 v231, s38, v231
    v_mfma_f32_16x16x32_bf16 v[232:235], a[184:187], a[240:243], v[232:235]
    v_exp_f32 v209, v209
    v_mfma_f32_16x16x32_bf16 v[232:235], a[188:191], a[244:247], v[232:235]
    s_waitcnt lgkmcnt(1)
    v_cvt_pk_bf16_f32 v194, v208, v209
    v_max3_f32 v248, v248, v198, v199
    v_mfma_f32_16x16x32_bf16 v[200:203], v[126:129], v[168:171], v[200:203]
    ds_read_b128 v[208:211], v244 offset:64
    ds_read_b128 v[196:199], v245 offset:64
    v_mfma_f32_16x16x32_bf16 v[212:215], v[18:21], v[192:195], v[212:215]
    v_accvgpr_read_b32 v254, a252
    v_mul_f32 v232, s3, v232
    v_mfma_f32_16x16x32_bf16 v[216:219], v[48:51], v[192:195], v[216:219]
    s_waitcnt lgkmcnt(2)
    v_mul_f32 v233, s3, v233
    v_mul_f32 v234, s3, v234
    v_mfma_f32_16x16x32_bf16 v[220:223], v[78:81], v[192:195], v[220:223]
    buffer_load_dwordx4 v254, s[4:7], s44 offen lds
    v_mul_f32 v235, s3, v235
    v_mfma_f32_16x16x32_bf16 v[224:227], a[248:251], v[192:195], v[224:227]
    v_accvgpr_read_b32 v255, a253
    v_accvgpr_read_b32 v254, a254
    v_mfma_f32_16x16x32_bf16 v[200:203], v[128:131], v[170:173], v[200:203]
    v_mfma_f32_16x16x32_bf16 v[204:207], v[162:165], v[168:171], v[204:207]
    v_mfma_f32_16x16x32_bf16 v[204:207], v[164:167], v[170:173], v[204:207]
    buffer_load_dwordx4 v255, s[4:7], s44 offen offset:1024 lds
    v_accvgpr_read_b32 v255, a252
    v_mfma_f32_16x16x32_bf16 v[236:239], a[192:195], a[224:227], 0
    ds_read_b128 a[224:227], v240 offset:32384
    s_waitcnt lgkmcnt(2)
    v_mfma_f32_16x16x32_bf16 v[208:211], v[96:99], v[168:171], v[208:211]
    s_waitcnt lgkmcnt(1)
    v_rcp_f32 v225, v224
    v_mfma_f32_16x16x32_bf16 v[208:211], v[98:101], v[170:173], v[208:211]
    v_mul_f32 v212, v212, v225
    v_mul_f32 v213, v213, v225
    v_mfma_f32_16x16x32_bf16 v[196:199], v[132:135], v[168:171], v[196:199]
    v_mul_f32 v214, v214, v225
    v_mul_f32 v215, v215, v225
    v_mfma_f32_16x16x32_bf16 v[196:199], v[134:137], v[170:173], v[196:199]
    v_cvt_pk_bf16_f32 v212, v212, v213
    v_cvt_pk_bf16_f32 v213, v214, v215
    v_mfma_f32_16x16x32_bf16 v[236:239], a[196:199], a[228:231], v[236:239]
    ds_read_b128 a[228:231], v241 offset:32384
    v_mul_f32 v216, v216, v225
    v_mfma_f32_16x16x32_bf16 v[236:239], a[200:203], a[232:235], v[236:239]
    ds_read_b128 a[232:235], v240 offset:32512
    v_mul_f32 v217, v217, v225
    v_mfma_f32_16x16x32_bf16 v[236:239], a[204:207], a[236:239], v[236:239]
    ds_read_b128 a[236:239], v241 offset:32512
    v_mul_f32 v218, v218, v225
    v_mfma_f32_16x16x32_bf16 v[236:239], a[208:211], a[240:243], v[236:239]
    ds_read_b128 a[240:243], v240 offset:30720
    v_mul_f32 v219, v219, v225
    v_mfma_f32_16x16x32_bf16 v[236:239], a[212:215], a[244:247], v[236:239]
    ds_read_b128 a[244:247], v241 offset:30720
    ds_write_b64 v251, v[212:213] offset:6144
    v_cvt_pk_bf16_f32 v216, v216, v217
    v_cvt_pk_bf16_f32 v217, v218, v219
    ds_write_b64 v251, v[216:217] offset:6272
    v_mul_f32 v220, v220, v225
    v_mul_f32 v221, v221, v225
    v_mul_f32 v222, v222, v225
    v_mul_f32 v236, s38, v236
    v_mul_f32 v237, s38, v237
    v_mul_f32 v238, s38, v238
    v_mul_f32 v239, s38, v239
    v_mul_f32 v223, v223, v225
    v_cvt_pk_bf16_f32 v220, v220, v221
    v_cvt_pk_bf16_f32 v221, v222, v223
    ds_write_b64 v251, v[220:221] offset:6400
    v_max3_f32 v248, v248, v200, v201
    v_max3_f32 v248, v248, v202, v203
    ds_read_b128 v[200:203], v246 offset:64
    v_max3_f32 v248, v248, v204, v205
    v_max3_f32 v248, v248, v206, v207
    ds_read_b128 v[204:207], v244 offset:128
    v_max3_f32 v248, v248, v208, v209
    v_max3_f32 v248, v248, v210, v211
    ds_read_b128 v[208:211], v245 offset:128
    v_max3_f32 v248, v248, v196, v197
    v_max3_f32 v248, v248, v198, v199
    ds_read_b128 v[196:199], v246 offset:128
    buffer_load_dwordx4 v254, s[4:7], s44 offen offset:2048 lds
    s_add_u32 m0, s46, 0xc00
    v_accvgpr_read_b32 v254, a253
    buffer_load_dwordx4 v255, s[4:7], s59 offen lds
    s_waitcnt lgkmcnt(3)
    v_mfma_f32_16x16x32_bf16 v[200:203], v[102:105], v[168:171], v[200:203]
    v_accvgpr_read_b32 v255, a254
    s_waitcnt lgkmcnt(2)
    v_mfma_f32_16x16x32_bf16 v[200:203], v[104:107], v[170:173], v[200:203]
    v_mfma_f32_16x16x32_bf16 v[204:207], v[138:141], v[168:171], v[204:207]
    s_waitcnt lgkmcnt(1)
    v_mfma_f32_16x16x32_bf16 v[204:207], v[140:143], v[170:173], v[204:207]
    buffer_load_dwordx4 v254, s[4:7], s59 offen offset:1024 lds
    v_accvgpr_read_b32 v254, a252
    v_mfma_f32_16x16x32_bf16 v[208:211], v[144:147], v[168:171], v[208:211]
    s_waitcnt lgkmcnt(0)
    v_mfma_f32_16x16x32_bf16 v[208:211], v[146:149], v[170:173], v[208:211]
    v_max3_f32 v248, v248, v200, v201
    v_max3_f32 v248, v248, v202, v203
    v_mfma_f32_16x16x32_bf16 v[196:199], v[108:111], v[168:171], v[196:199]
    ds_read_b128 v[200:203], v244 offset:0
    v_max3_f32 v248, v248, v204, v205
    v_mfma_f32_16x16x32_bf16 v[196:199], v[110:113], v[170:173], v[196:199]
    ds_read_b128 v[204:207], v245 offset:0
    buffer_load_dwordx4 v255, s[4:7], s59 offen offset:2048 lds
    v_max3_f32 v248, v248, v208, v209
    ds_read_b128 v[208:211], v246 offset:0
    s_add_u32 m0, s46, 0x1800
    v_accvgpr_read_b32 v255, a255
    s_nop 1
    v_max3_f32 v248, v248, v196, v197
    ds_read_b128 v[196:199], v244 offset:64
    v_mov_b32 v225, v248
    buffer_load_dwordx4 v254, s[4:7], s58 offen lds
    s_nop 0
    v_permlane16_swap_b32 v248, v225
    v_max_f32 v248, v248, v225
    v_mov_b32 v225, v248
    s_nop 1
    v_permlane32_swap_b32 v248, v225
    v_max_f32 v248, v248, v225
    s_waitcnt lgkmcnt(3)
    v_mfma_f32_16x16x32_bf16 v[200:203], v[90:93], v[168:171], v[200:203]
    v_mfma_f32_16x16x32_bf16 v[200:203], v[92:95], v[170:173], v[200:203]
    s_waitcnt lgkmcnt(2)
    buffer_load_dwordx4 v255, s[4:7], s58 offen offset:512 lds
    v_mfma_f32_16x16x32_bf16 v[204:207], v[126:129], v[168:171], v[204:207]
    s_add_u32 m0, s46, 0x16800
    s_waitcnt lgkmcnt(1)
    v_mfma_f32_16x16x32_bf16 v[204:207], v[128:131], v[170:173], v[204:207]
    v_mfma_f32_16x16x32_bf16 v[208:211], v[162:165], v[168:171], v[208:211]
    s_waitcnt lgkmcnt(0)
    v_sub_f32 v200, v200, v248
    v_sub_f32 v201, v201, v248
    v_mfma_f32_16x16x32_bf16 v[208:211], v[164:167], v[170:173], v[208:211]
    v_exp_f32 v200, v200
    v_mfma_f32_16x16x32_bf16 v[196:199], v[96:99], v[168:171], v[196:199]
    v_exp_f32 v201, v201
    v_mfma_f32_16x16x32_bf16 v[196:199], v[98:101], v[170:173], v[196:199]
    v_sub_f32 v202, v202, v248
    v_exp_f32 v202, v202
    v_sub_f32 v203, v203, v248
    v_exp_f32 v203, v203
    v_cvt_pk_bf16_f32 v180, v200, v201
    v_cvt_pk_bf16_f32 v183, v202, v203
    ds_read_b128 v[200:203], v245 offset:64
    v_sub_f32 v204, v204, v248
    v_exp_f32 v204, v204
    v_sub_f32 v205, v205, v248
    v_exp_f32 v205, v205
    v_sub_f32 v206, v206, v248
    v_exp_f32 v206, v206
    v_sub_f32 v207, v207, v248
    v_exp_f32 v207, v207
    v_cvt_pk_bf16_f32 v181, v204, v205
    v_cvt_pk_bf16_f32 v184, v206, v207
    ds_read_b128 v[204:207], v246 offset:64
    v_sub_f32 v208, v208, v248
    v_exp_f32 v208, v208
    v_sub_f32 v209, v209, v248
    v_exp_f32 v209, v209
    v_sub_f32 v210, v210, v248
    v_exp_f32 v210, v210
    v_sub_f32 v211, v211, v248
    v_exp_f32 v211, v211
    v_cvt_pk_bf16_f32 v182, v208, v209
    v_cvt_pk_bf16_f32 v185, v210, v211
    s_waitcnt lgkmcnt(1)
    v_mfma_f32_16x16x32_bf16 v[212:215], v[12:15], v[180:183], 0
    ds_read_b128 v[208:211], v244 offset:128
    v_sub_f32 v196, v196, v248
    v_mfma_f32_16x16x32_bf16 v[216:219], v[42:45], v[180:183], 0
    v_exp_f32 v196, v196
    v_mfma_f32_16x16x32_bf16 v[220:223], v[72:75], v[180:183], 0
    v_sub_f32 v197, v197, v248
    v_sub_f32 v198, v198, v248
    v_mfma_f32_16x16x32_bf16 v[224:227], a[248:251], v[180:183], 0
    v_exp_f32 v197, v197
    v_mfma_f32_16x16x32_bf16 v[200:203], v[132:135], v[168:171], v[200:203]
    s_waitcnt lgkmcnt(1)
    v_exp_f32 v198, v198
    v_mfma_f32_16x16x32_bf16 v[200:203], v[134:137], v[170:173], v[200:203]
    v_sub_f32 v199, v199, v248
    v_cvt_pk_bf16_f32 v186, v196, v197
    v_mfma_f32_16x16x32_bf16 v[204:207], v[102:105], v[168:171], v[204:207]
    v_exp_f32 v199, v199
    v_mfma_f32_16x16x32_bf16 v[204:207], v[104:107], v[170:173], v[204:207]
    v_cvt_pk_bf16_f32 v189, v198, v199
    ds_read_b128 v[196:199], v245 offset:128
    s_waitcnt lgkmcnt(1)
    v_mfma_f32_16x16x32_bf16 v[208:211], v[138:141], v[168:171], v[208:211]
    v_sub_f32 v200, v200, v248
    v_sub_f32 v201, v201, v248
    v_mfma_f32_16x16x32_bf16 v[208:211], v[140:143], v[170:173], v[208:211]
    v_exp_f32 v200, v200
    v_exp_f32 v201, v201
    v_sub_f32 v202, v202, v248
    v_exp_f32 v202, v202
    v_sub_f32 v203, v203, v248
    v_exp_f32 v203, v203
    v_cvt_pk_bf16_f32 v187, v200, v201
    v_cvt_pk_bf16_f32 v190, v202, v203
    ds_read_b128 v[200:203], v246 offset:128
    v_mfma_f32_16x16x32_bf16 v[212:215], v[16:19], v[184:187], v[212:215]
    v_sub_f32 v204, v204, v248
    v_sub_f32 v205, v205, v248
    v_mfma_f32_16x16x32_bf16 v[216:219], v[46:49], v[184:187], v[216:219]
    v_exp_f32 v204, v204
    v_mfma_f32_16x16x32_bf16 v[220:223], v[76:79], v[184:187], v[220:223]
    s_waitcnt lgkmcnt(1)
    v_exp_f32 v205, v205
    v_mfma_f32_16x16x32_bf16 v[224:227], a[248:251], v[184:187], v[224:227]
    v_sub_f32 v206, v206, v248
    v_sub_f32 v207, v207, v248
    v_mfma_f32_16x16x32_bf16 v[196:199], v[144:147], v[168:171], v[196:199]
    v_exp_f32 v206, v206
    v_mfma_f32_16x16x32_bf16 v[196:199], v[146:149], v[170:173], v[196:199]
    v_exp_f32 v207, v207
    v_cvt_pk_bf16_f32 v188, v204, v205
    v_cvt_pk_bf16_f32 v191, v206, v207
    ds_read_b128 v[204:207], v244 offset:0
    v_sub_f32 v208, v208, v248
    v_mfma_f32_16x16x32_bf16 v[212:215], v[20:23], v[188:191], v[212:215]
    s_waitcnt lgkmcnt(1)
    v_exp_f32 v208, v208
    v_mfma_f32_16x16x32_bf16 v[216:219], v[50:53], v[188:191], v[216:219]
    v_sub_f32 v209, v209, v248
    v_sub_f32 v196, v196, v248
    v_mfma_f32_16x16x32_bf16 v[220:223], v[80:83], v[188:191], v[220:223]
    v_exp_f32 v209, v209
    v_mfma_f32_16x16x32_bf16 v[224:227], a[248:251], v[188:191], v[224:227]
    v_cvt_pk_bf16_f32 v192, v208, v209
    v_sub_f32 v197, v197, v248
    v_mfma_f32_16x16x32_bf16 v[200:203], v[108:111], v[168:171], v[200:203]
    v_cvt_pk_bf16_f32 v168, v228, v229
    v_cvt_pk_bf16_f32 v169, v230, v231
    v_mfma_f32_16x16x32_bf16 v[200:203], v[110:113], v[170:173], v[200:203]
    v_cvt_pk_bf16_f32 v170, v232, v233
    v_cvt_pk_bf16_f32 v171, v234, v235
    v_mfma_f32_16x16x32_bf16 v[228:231], a[0:3], a[216:219], 0
    v_cvt_pk_bf16_f32 v172, v236, v237
    v_cvt_pk_bf16_f32 v173, v238, v239
    v_mfma_f32_16x16x32_bf16 v[228:231], a[4:7], a[220:223], v[228:231]
    ds_read_b128 v[208:211], v245 offset:0
    s_waitcnt lgkmcnt(1)
    v_mfma_f32_16x16x32_bf16 v[204:207], v[96:99], v[174:177], v[204:207]
    v_exp_f32 v196, v196
    v_mfma_f32_16x16x32_bf16 v[204:207], v[98:101], v[176:179], v[204:207]
    v_exp_f32 v197, v197
    v_mfma_f32_16x16x32_bf16 v[228:231], a[8:11], a[224:227], v[228:231]
    v_cvt_pk_bf16_f32 v193, v196, v197
    v_sub_f32 v200, v200, v248
    v_mfma_f32_16x16x32_bf16 v[228:231], a[12:15], a[228:231], v[228:231]
    ds_read_b128 v[196:199], v246 offset:0
    v_sub_f32 v201, v201, v248
    v_mfma_f32_16x16x32_bf16 v[228:231], a[16:19], a[232:235], v[228:231]
    v_exp_f32 v200, v200
    v_mfma_f32_16x16x32_bf16 v[228:231], a[20:23], a[236:239], v[228:231]
    v_exp_f32 v201, v201
    v_mfma_f32_16x16x32_bf16 v[232:235], a[24:27], a[216:219], 0
    v_cvt_pk_bf16_f32 v194, v200, v201
    v_max_f32 v248, v204, v205
    v_mfma_f32_16x16x32_bf16 v[232:235], a[28:31], a[220:223], v[232:235]
    ds_read_b128 v[200:203], v244 offset:64
    v_max3_f32 v248, v248, v206, v207
    v_mfma_f32_16x16x32_bf16 v[212:215], v[24:27], v[192:195], v[212:215]
    s_waitcnt lgkmcnt(2)
    v_cvt_pk_bf16_f32 v90, v228, v229
    v_cvt_pk_bf16_f32 v91, v230, v231
    v_mfma_f32_16x16x32_bf16 v[216:219], v[54:57], v[192:195], v[216:219]
    ds_read_b128 v[204:207], v245 offset:64
    v_mfma_f32_16x16x32_bf16 v[220:223], v[84:87], v[192:195], v[220:223]
    v_mfma_f32_16x16x32_bf16 v[224:227], a[248:251], v[192:195], v[224:227]
    v_mfma_f32_16x16x32_bf16 v[208:211], v[132:135], v[174:177], v[208:211]
    s_waitcnt lgkmcnt(2)
    v_mfma_f32_16x16x32_bf16 v[208:211], v[134:137], v[176:179], v[208:211]
    v_mfma_f32_16x16x32_bf16 v[196:199], v[102:105], v[174:177], v[196:199]
    v_mfma_f32_16x16x32_bf16 v[196:199], v[104:107], v[176:179], v[196:199]
    v_mfma_f32_16x16x32_bf16 v[232:235], a[32:35], a[224:227], v[232:235]
    s_waitcnt lgkmcnt(1)
    v_mfma_f32_16x16x32_bf16 v[200:203], v[138:141], v[174:177], v[200:203]
    v_rcp_f32 v225, v224
    v_mfma_f32_16x16x32_bf16 v[200:203], v[140:143], v[176:179], v[200:203]
    s_waitcnt lgkmcnt(0)
    v_mul_f32 v212, v212, v225
    v_mul_f32 v213, v213, v225
    v_mfma_f32_16x16x32_bf16 v[204:207], v[144:147], v[174:177], v[204:207]
    v_mul_f32 v214, v214, v225
    v_mul_f32 v215, v215, v225
    v_mfma_f32_16x16x32_bf16 v[204:207], v[146:149], v[176:179], v[204:207]
    v_cvt_pk_bf16_f32 v212, v212, v213
    v_cvt_pk_bf16_f32 v213, v214, v215
    v_mfma_f32_16x16x32_bf16 v[232:235], a[36:39], a[228:231], v[232:235]
    ds_write_b64 v251, v[212:213] offset:12288
    v_mfma_f32_16x16x32_bf16 v[232:235], a[40:43], a[232:235], v[232:235]
    v_mul_f32 v216, v216, v225
    v_mul_f32 v217, v217, v225
    v_mfma_f32_16x16x32_bf16 v[232:235], a[44:47], a[236:239], v[232:235]
    v_mul_f32 v218, v218, v225
    v_mul_f32 v219, v219, v225
    v_mfma_f32_16x16x32_bf16 v[236:239], a[48:51], a[216:219], 0
    v_cvt_pk_bf16_f32 v216, v216, v217
    v_cvt_pk_bf16_f32 v217, v218, v219
    v_mfma_f32_16x16x32_bf16 v[236:239], a[52:55], a[220:223], v[236:239]
    ds_write_b64 v251, v[216:217] offset:12416
    v_mfma_f32_16x16x32_bf16 v[236:239], a[56:59], a[224:227], v[236:239]
    v_cvt_pk_bf16_f32 v92, v232, v233
    v_cvt_pk_bf16_f32 v93, v234, v235
    v_mfma_f32_16x16x32_bf16 v[236:239], a[60:63], a[228:231], v[236:239]
    v_mul_f32 v220, v220, v225
    v_mul_f32 v221, v221, v225
    v_mfma_f32_16x16x32_bf16 v[236:239], a[64:67], a[232:235], v[236:239]
    v_mul_f32 v222, v222, v225
    v_mul_f32 v223, v223, v225
    v_mfma_f32_16x16x32_bf16 v[236:239], a[68:71], a[236:239], v[236:239]
    v_cvt_pk_bf16_f32 v220, v220, v221
    v_cvt_pk_bf16_f32 v221, v222, v223
    v_mfma_f32_16x16x32_bf16 v[228:231], a[216:219], a[72:75], 0
    ds_write_b64 v251, v[220:221] offset:12544
    v_mfma_f32_16x16x32_bf16 v[228:231], a[220:223], a[76:79], v[228:231]
    v_max3_f32 v248, v248, v208, v209
    v_max3_f32 v248, v248, v210, v211
    v_mfma_f32_16x16x32_bf16 v[228:231], a[224:227], a[80:83], v[228:231]
    v_cvt_pk_bf16_f32 v94, v236, v237
    v_cvt_pk_bf16_f32 v95, v238, v239
    v_mfma_f32_16x16x32_bf16 v[228:231], a[228:231], a[84:87], v[228:231]
    ds_read_b128 v[208:211], v246 offset:64
    v_max3_f32 v248, v248, v196, v197
    v_mfma_f32_16x16x32_bf16 v[228:231], a[232:235], a[88:91], v[228:231]
    v_max3_f32 v248, v248, v198, v199
    v_max3_f32 v248, v248, v200, v201
    v_mfma_f32_16x16x32_bf16 v[228:231], a[236:239], a[92:95], v[228:231]
    ds_read_b128 v[196:199], v244 offset:0
    v_max3_f32 v248, v248, v202, v203
    v_mfma_f32_16x16x32_bf16 v[232:235], a[216:219], a[96:99], 0
    ds_read_b128 v[200:203], v245 offset:0
    v_max3_f32 v248, v248, v204, v205
    v_mfma_f32_16x16x32_bf16 v[232:235], a[220:223], a[100:103], v[232:235]
    v_max3_f32 v248, v248, v206, v207
    v_mfma_f32_16x16x32_bf16 v[232:235], a[224:227], a[104:107], v[232:235]
    v_cvt_pk_bf16_f32 v6, v228, v229
    v_cvt_pk_bf16_f32 v9, v230, v231
    v_mfma_f32_16x16x32_bf16 v[232:235], a[228:231], a[108:111], v[232:235]
    ds_read_b128 v[204:207], v246 offset:0
    v_mfma_f32_16x16x32_bf16 v[232:235], a[232:235], a[112:115], v[232:235]
    v_mfma_f32_16x16x32_bf16 v[232:235], a[236:239], a[116:119], v[232:235]
    v_mfma_f32_16x16x32_bf16 v[236:239], a[216:219], a[120:123], 0
    ds_read_b128 a[216:219], v240 offset:30848
    s_waitcnt lgkmcnt(4)
    v_mfma_f32_16x16x32_bf16 v[208:211], v[108:111], v[174:177], v[208:211]
    v_mfma_f32_16x16x32_bf16 v[208:211], v[110:113], v[176:179], v[208:211]
    s_waitcnt lgkmcnt(3)
    s_waitcnt lgkmcnt(2)
    v_mfma_f32_16x16x32_bf16 v[196:199], v[96:99], v[174:177], v[196:199]
    v_cvt_pk_bf16_f32 v36, v232, v233
    v_cvt_pk_bf16_f32 v39, v234, v235
    v_mfma_f32_16x16x32_bf16 v[196:199], v[98:101], v[176:179], v[196:199]
    v_mfma_f32_16x16x32_bf16 v[200:203], v[132:135], v[174:177], v[200:203]
    v_mfma_f32_16x16x32_bf16 v[200:203], v[134:137], v[176:179], v[200:203]
    s_waitcnt lgkmcnt(1)
    v_max3_f32 v248, v248, v208, v209
    v_max3_f32 v248, v248, v210, v211
    v_mfma_f32_16x16x32_bf16 v[204:207], v[102:105], v[174:177], v[204:207]
    ds_read_b128 v[208:211], v244 offset:64
    v_mov_b32 v225, v248
    v_mfma_f32_16x16x32_bf16 v[204:207], v[104:107], v[176:179], v[204:207]
    v_mfma_f32_16x16x32_bf16 v[236:239], a[220:223], a[124:127], v[236:239]
    ds_read_b128 a[220:223], v241 offset:30848
    v_permlane16_swap_b32 v248, v225
    v_mfma_f32_16x16x32_bf16 v[236:239], a[224:227], a[128:131], v[236:239]
    ds_read_b128 a[224:227], v240 offset:30976
    v_max_f32 v248, v248, v225
    v_mfma_f32_16x16x32_bf16 v[236:239], a[228:231], a[132:135], v[236:239]
    ds_read_b128 a[228:231], v241 offset:30976
    v_mov_b32 v225, v248
    v_mfma_f32_16x16x32_bf16 v[236:239], a[232:235], a[136:139], v[236:239]
    ds_read_b128 a[232:235], v242 offset:32256
    v_permlane32_swap_b32 v248, v225
    v_mfma_f32_16x16x32_bf16 v[236:239], a[236:239], a[140:143], v[236:239]
    ds_read_b128 a[236:239], v243 offset:32256
    v_max_f32 v248, v248, v225
    v_mfma_f32_16x16x32_bf16 v[228:231], a[0:3], a[240:243], 0
    s_waitcnt lgkmcnt(6)
    v_sub_f32 v196, v196, v248
    v_sub_f32 v197, v197, v248
    v_mfma_f32_16x16x32_bf16 v[228:231], a[4:7], a[244:247], v[228:231]
    v_exp_f32 v196, v196
    v_mfma_f32_16x16x32_bf16 v[228:231], a[8:11], a[216:219], v[228:231]
    s_waitcnt lgkmcnt(5)
    v_cvt_pk_bf16_f32 v66, v236, v237
    v_cvt_pk_bf16_f32 v69, v238, v239
    v_mfma_f32_16x16x32_bf16 v[208:211], v[138:141], v[174:177], v[208:211]
    v_exp_f32 v197, v197
    v_mfma_f32_16x16x32_bf16 v[208:211], v[140:143], v[176:179], v[208:211]
    s_waitcnt lgkmcnt(4)
    v_sub_f32 v198, v198, v248
    v_sub_f32 v199, v199, v248
    v_mfma_f32_16x16x32_bf16 v[228:231], a[12:15], a[220:223], v[228:231]
    s_waitcnt lgkmcnt(3)
    v_exp_f32 v198, v198
    v_mfma_f32_16x16x32_bf16 v[228:231], a[16:19], a[224:227], v[228:231]
    s_waitcnt lgkmcnt(2)
    v_exp_f32 v199, v199
    v_mfma_f32_16x16x32_bf16 v[228:231], a[20:23], a[228:231], v[228:231]
    v_cvt_pk_bf16_f32 v180, v196, v197
    v_cvt_pk_bf16_f32 v183, v198, v199
    v_mfma_f32_16x16x32_bf16 v[232:235], a[24:27], a[240:243], 0
    ds_read_b128 v[196:199], v245 offset:64
    v_sub_f32 v200, v200, v248
    v_mfma_f32_16x16x32_bf16 v[232:235], a[28:31], a[244:247], v[232:235]
    s_waitcnt lgkmcnt(1)
    v_exp_f32 v200, v200
    v_mfma_f32_16x16x32_bf16 v[232:235], a[32:35], a[216:219], v[232:235]
    v_cvt_pk_bf16_f32 v96, v228, v229
    v_cvt_pk_bf16_f32 v97, v230, v231
    v_mfma_f32_16x16x32_bf16 v[232:235], a[36:39], a[220:223], v[232:235]
    v_sub_f32 v201, v201, v248
    v_sub_f32 v202, v202, v248
    v_mfma_f32_16x16x32_bf16 v[232:235], a[40:43], a[224:227], v[232:235]
    v_exp_f32 v201, v201
    v_mfma_f32_16x16x32_bf16 v[232:235], a[44:47], a[228:231], v[232:235]
    v_exp_f32 v202, v202
    v_mfma_f32_16x16x32_bf16 v[236:239], a[48:51], a[240:243], 0
    v_sub_f32 v203, v203, v248
    v_cvt_pk_bf16_f32 v181, v200, v201
    v_mfma_f32_16x16x32_bf16 v[236:239], a[52:55], a[244:247], v[236:239]
    v_exp_f32 v203, v203
    v_mfma_f32_16x16x32_bf16 v[236:239], a[56:59], a[216:219], v[236:239]
    v_cvt_pk_bf16_f32 v184, v202, v203
    v_cvt_pk_bf16_f32 v98, v232, v233
    v_mfma_f32_16x16x32_bf16 v[236:239], a[60:63], a[220:223], v[236:239]
    ds_read_b128 v[200:203], v246 offset:64
    v_cvt_pk_bf16_f32 v99, v234, v235
    v_mfma_f32_16x16x32_bf16 v[236:239], a[64:67], a[224:227], v[236:239]
    s_waitcnt lgkmcnt(1)
    v_sub_f32 v204, v204, v248
    v_sub_f32 v205, v205, v248
    v_mfma_f32_16x16x32_bf16 v[196:199], v[144:147], v[174:177], v[196:199]
    v_exp_f32 v204, v204
    v_mfma_f32_16x16x32_bf16 v[196:199], v[146:149], v[176:179], v[196:199]
    v_exp_f32 v205, v205
    v_mfma_f32_16x16x32_bf16 v[236:239], a[68:71], a[228:231], v[236:239]
    v_sub_f32 v206, v206, v248
    v_sub_f32 v207, v207, v248
    v_mfma_f32_16x16x32_bf16 v[228:231], a[240:243], a[72:75], 0
    v_exp_f32 v206, v206
    v_mfma_f32_16x16x32_bf16 v[228:231], a[244:247], a[76:79], v[228:231]
    v_exp_f32 v207, v207
    v_mfma_f32_16x16x32_bf16 v[228:231], a[216:219], a[80:83], v[228:231]
    v_cvt_pk_bf16_f32 v182, v204, v205
    v_cvt_pk_bf16_f32 v100, v236, v237
    v_mfma_f32_16x16x32_bf16 v[228:231], a[220:223], a[84:87], v[228:231]
    v_cvt_pk_bf16_f32 v101, v238, v239
    v_cvt_pk_bf16_f32 v185, v206, v207
    v_mfma_f32_16x16x32_bf16 v[212:215], v[18:21], v[180:183], 0
    s_waitcnt lgkmcnt(0)
    v_sub_f32 v208, v208, v248
    v_sub_f32 v209, v209, v248
    v_mfma_f32_16x16x32_bf16 v[216:219], v[48:51], v[180:183], 0
    v_exp_f32 v208, v208
    v_mfma_f32_16x16x32_bf16 v[220:223], v[78:81], v[180:183], 0
    v_exp_f32 v209, v209
    v_mfma_f32_16x16x32_bf16 v[224:227], a[248:251], v[180:183], 0
    v_sub_f32 v210, v210, v248
    v_sub_f32 v211, v211, v248
    v_mfma_f32_16x16x32_bf16 v[200:203], v[108:111], v[174:177], v[200:203]
    v_exp_f32 v210, v210
    v_mfma_f32_16x16x32_bf16 v[200:203], v[110:113], v[176:179], v[200:203]
    v_exp_f32 v211, v211
    v_mfma_f32_16x16x32_bf16 v[228:231], a[224:227], a[88:91], v[228:231]
    v_cvt_pk_bf16_f32 v186, v208, v209
    v_cvt_pk_bf16_f32 v189, v210, v211
    v_mfma_f32_16x16x32_bf16 v[228:231], a[228:231], a[92:95], v[228:231]
    v_sub_f32 v196, v196, v248
    v_sub_f32 v197, v197, v248
    v_mfma_f32_16x16x32_bf16 v[232:235], a[240:243], a[96:99], 0
    v_exp_f32 v196, v196
    v_mfma_f32_16x16x32_bf16 v[232:235], a[244:247], a[100:103], v[232:235]
    v_exp_f32 v197, v197
    v_mfma_f32_16x16x32_bf16 v[232:235], a[216:219], a[104:107], v[232:235]
    v_sub_f32 v198, v198, v248
    v_cvt_pk_bf16_f32 v0, v228, v229
    v_mfma_f32_16x16x32_bf16 v[232:235], a[220:223], a[108:111], v[232:235]
    v_cvt_pk_bf16_f32 v3, v230, v231
    v_sub_f32 v199, v199, v248
    v_mfma_f32_16x16x32_bf16 v[232:235], a[224:227], a[112:115], v[232:235]
    v_exp_f32 v198, v198
    v_mfma_f32_16x16x32_bf16 v[232:235], a[228:231], a[116:119], v[232:235]
    v_exp_f32 v199, v199
    v_mfma_f32_16x16x32_bf16 v[236:239], a[240:243], a[120:123], 0
    ds_read_b128 a[240:243], v242 offset:32384
    v_cvt_pk_bf16_f32 v187, v196, v197
    v_mfma_f32_16x16x32_bf16 v[236:239], a[244:247], a[124:127], v[236:239]
    ds_read_b128 a[244:247], v243 offset:32384
    v_cvt_pk_bf16_f32 v190, v198, v199
    v_mfma_f32_16x16x32_bf16 v[212:215], v[22:25], v[184:187], v[212:215]
    v_cvt_pk_bf16_f32 v30, v232, v233
    v_cvt_pk_bf16_f32 v33, v234, v235
    v_mfma_f32_16x16x32_bf16 v[216:219], v[52:55], v[184:187], v[216:219]
    v_sub_f32 v200, v200, v248
    v_sub_f32 v201, v201, v248
    v_mfma_f32_16x16x32_bf16 v[220:223], v[82:85], v[184:187], v[220:223]
    v_exp_f32 v200, v200
    v_mfma_f32_16x16x32_bf16 v[224:227], a[248:251], v[184:187], v[224:227]
    v_exp_f32 v201, v201
    v_mfma_f32_16x16x32_bf16 v[236:239], a[216:219], a[128:131], v[236:239]
    ds_read_b128 a[216:219], v242 offset:32512
    v_sub_f32 v202, v202, v248
    v_mfma_f32_16x16x32_bf16 v[236:239], a[220:223], a[132:135], v[236:239]
    ds_read_b128 a[220:223], v243 offset:32512
    v_sub_f32 v203, v203, v248
    v_mfma_f32_16x16x32_bf16 v[236:239], a[224:227], a[136:139], v[236:239]
    ds_read_b128 a[224:227], v242 offset:33792
    v_cvt_pk_bf16_f32 v188, v200, v201
    v_mfma_f32_16x16x32_bf16 v[236:239], a[228:231], a[140:143], v[236:239]
    ds_read_b128 a[228:231], v243 offset:33792
    v_mov_b32 v204, 0x237c0
    v_mfma_f32_16x16x32_bf16 v[228:231], a[144:147], a[232:235], 0
    s_waitcnt lgkmcnt(5)
    v_exp_f32 v202, v202
    v_mfma_f32_16x16x32_bf16 v[228:231], a[148:151], a[236:239], v[228:231]
    s_waitcnt lgkmcnt(4)
    v_exp_f32 v203, v203
    v_mfma_f32_16x16x32_bf16 v[228:231], a[152:155], a[240:243], v[228:231]
    v_cvt_pk_bf16_f32 v60, v236, v237
    v_cvt_pk_bf16_f32 v63, v238, v239
    v_mfma_f32_16x16x32_bf16 v[228:231], a[156:159], a[244:247], v[228:231]
    v_cvt_pk_bf16_f32 v191, v202, v203
    v_add_u32 v205, 0xfffff900, v245
    v_mfma_f32_16x16x32_bf16 v[232:235], a[168:171], a[232:235], 0
    v_add_u32 v246, 0x700, v245
    s_waitcnt lgkmcnt(3)
    v_mfma_f32_16x16x32_bf16 v[212:215], v[26:29], v[188:191], v[212:215]
    v_mfma_f32_16x16x32_bf16 v[216:219], v[56:59], v[188:191], v[216:219]
    v_mfma_f32_16x16x32_bf16 v[220:223], v[86:89], v[188:191], v[220:223]
    s_waitcnt lgkmcnt(2)
    v_mfma_f32_16x16x32_bf16 v[224:227], a[248:251], v[188:191], v[224:227]
    s_waitcnt lgkmcnt(1)
    v_mov_b32 v191, 0
    v_mfma_f32_16x16x32_bf16 v[228:231], a[160:163], a[216:219], v[228:231]
    s_waitcnt lgkmcnt(0)
    v_mfma_f32_16x16x32_bf16 v[228:231], a[164:167], a[220:223], v[228:231]
    v_mfma_f32_16x16x32_bf16 v[232:235], a[172:175], a[236:239], v[232:235]
    v_mfma_f32_16x16x32_bf16 v[232:235], a[176:179], a[240:243], v[232:235]
    v_mfma_f32_16x16x32_bf16 v[232:235], a[180:183], a[244:247], v[232:235]
    v_rcp_f32 v225, v224
    v_mfma_f32_16x16x32_bf16 v[232:235], a[184:187], a[216:219], v[232:235]
    v_mov_b32 v226, 0x22e00
    v_cndmask_b32 v226, v226, v247, vcc
    v_mfma_f32_16x16x32_bf16 v[232:235], a[188:191], a[220:223], v[232:235]
    s_mov_b32 vcc_lo, 0x0
    v_mul_f32 v228, s38, v228
    v_mul_f32 v229, s38, v229
    v_mfma_f32_16x16x32_bf16 v[236:239], a[192:195], a[232:235], 0
    s_mov_b32 vcc_hi, 0xf0000
    v_mul_f32 v230, s38, v230
    v_mul_f32 v231, s38, v231
    v_mfma_f32_16x16x32_bf16 v[236:239], a[196:199], a[236:239], v[236:239]
    v_cvt_pk_bf16_f32 v174, v228, v229
    v_cvt_pk_bf16_f32 v175, v230, v231
    v_mfma_f32_16x16x32_bf16 v[236:239], a[200:203], a[240:243], v[236:239]
    v_mul_f32 v232, s3, v232
    v_mul_f32 v233, s3, v233
    v_mfma_f32_16x16x32_bf16 v[236:239], a[204:207], a[244:247], v[236:239]
    v_mul_f32 v234, s3, v234
    v_mul_f32 v235, s3, v235
    v_mfma_f32_16x16x32_bf16 v[236:239], a[208:211], a[216:219], v[236:239]
    v_cvt_pk_bf16_f32 v176, v232, v233
    v_cvt_pk_bf16_f32 v177, v234, v235
    v_mfma_f32_16x16x32_bf16 v[236:239], a[212:215], a[220:223], v[236:239]
    ds_read_b128 a[232:235], v242 offset:33920
    ds_read_b128 a[236:239], v243 offset:33920
    v_mfma_f32_16x16x32_bf16 v[228:231], a[144:147], a[224:227], 0
    ds_read_b128 a[240:243], v242 offset:34048
    ds_read_b128 a[244:247], v243 offset:34048
    v_mfma_f32_16x16x32_bf16 v[228:231], a[148:151], a[228:231], v[228:231]
    v_mul_f32 v212, v212, v225
    v_mul_f32 v213, v213, v225
    v_mfma_f32_16x16x32_bf16 v[232:235], a[168:171], a[224:227], 0
    v_mul_f32 v236, s38, v236
    v_mul_f32 v237, s38, v237
    v_mfma_f32_16x16x32_bf16 v[232:235], a[172:175], a[228:231], v[232:235]
    v_mul_f32 v238, s38, v238
    v_mul_f32 v239, s38, v239
    v_cvt_pk_bf16_f32 v178, v236, v237
    v_cvt_pk_bf16_f32 v179, v238, v239
    v_mfma_f32_16x16x32_bf16 v[236:239], a[192:195], a[224:227], 0
    v_mul_f32 v214, v214, v225
    v_mul_f32 v215, v215, v225
    v_mfma_f32_16x16x32_bf16 v[236:239], a[196:199], a[228:231], v[236:239]
    v_cvt_pk_bf16_f32 v212, v212, v213
    v_cvt_pk_bf16_f32 v213, v214, v215
    ds_write_b64 v226, v[212:213] offset:0
    s_waitcnt lgkmcnt(4)
    v_mfma_f32_16x16x32_bf16 v[228:231], a[152:155], a[232:235], v[228:231]
    s_waitcnt lgkmcnt(3)
    v_mul_f32 v216, v216, v225
    v_mul_f32 v217, v217, v225
    v_mfma_f32_16x16x32_bf16 v[228:231], a[156:159], a[236:239], v[228:231]
    s_waitcnt lgkmcnt(2)
    v_mul_f32 v218, v218, v225
    v_mul_f32 v219, v219, v225
    v_mfma_f32_16x16x32_bf16 v[228:231], a[160:163], a[240:243], v[228:231]
    s_waitcnt vmcnt(10) lgkmcnt(1)
    s_barrier
    v_mfma_f32_16x16x32_bf16 v[228:231], a[164:167], a[244:247], v[228:231]
    ds_read_b128 a[216:219], v240 offset:33792
    ds_read_b128 a[220:223], v241 offset:33792
    v_mfma_f32_16x16x32_bf16 v[232:235], a[176:179], a[232:235], v[232:235]
    ds_read_b128 a[224:227], v240 offset:33920
    ds_read_b128 a[228:231], v241 offset:33920
    v_mfma_f32_16x16x32_bf16 v[232:235], a[180:183], a[236:239], v[232:235]
    v_cvt_pk_bf16_f32 v216, v216, v217
    v_cvt_pk_bf16_f32 v217, v218, v219
    v_mfma_f32_16x16x32_bf16 v[232:235], a[184:187], a[240:243], v[232:235]
    v_mul_f32 v228, s38, v228
    v_mul_f32 v229, s38, v229
    v_mfma_f32_16x16x32_bf16 v[232:235], a[188:191], a[244:247], v[232:235]
    v_mul_f32 v230, s38, v230
    v_mul_f32 v231, s38, v231
    v_mfma_f32_16x16x32_bf16 v[236:239], a[200:203], a[232:235], v[236:239]
    ds_read_b128 a[232:235], v240 offset:34048
    v_cvt_pk_bf16_f32 v228, v228, v229
    v_mfma_f32_16x16x32_bf16 v[236:239], a[204:207], a[236:239], v[236:239]
    ds_read_b128 a[236:239], v241 offset:34048
    v_cvt_pk_bf16_f32 v229, v230, v231
    v_mfma_f32_16x16x32_bf16 v[236:239], a[208:211], a[240:243], v[236:239]
    ds_write_b64 v247, v[228:229] offset:18432
    v_mfma_f32_16x16x32_bf16 v[236:239], a[212:215], a[244:247], v[236:239]
    s_waitcnt lgkmcnt(6)
    v_mul_f32 v232, s3, v232
    v_mul_f32 v233, s3, v233
    v_mfma_f32_16x16x32_bf16 v[228:231], a[0:3], a[216:219], 0
    s_waitcnt lgkmcnt(5)
    v_mul_f32 v234, s3, v234
    v_mul_f32 v235, s3, v235
    v_mfma_f32_16x16x32_bf16 v[228:231], a[4:7], a[220:223], v[228:231]
    s_waitcnt lgkmcnt(4)
    v_cvt_pk_bf16_f32 v232, v232, v233
    v_cvt_pk_bf16_f32 v233, v234, v235
    v_mfma_f32_16x16x32_bf16 v[228:231], a[8:11], a[224:227], v[228:231]
    s_waitcnt lgkmcnt(3)
    v_mul_f32 v236, s38, v236
    v_mul_f32 v237, s38, v237
    v_mfma_f32_16x16x32_bf16 v[228:231], a[12:15], a[228:231], v[228:231]
    ds_write_b64 v247, v[232:233] offset:18560
    v_mfma_f32_16x16x32_bf16 v[232:235], a[24:27], a[216:219], 0
    s_waitcnt lgkmcnt(3)
    v_mul_f32 v238, s38, v238
    v_mul_f32 v239, s38, v239
    v_mfma_f32_16x16x32_bf16 v[228:231], a[16:19], a[232:235], v[228:231]
    ds_read_b128 a[240:243], v242 offset:61440
    v_cvt_pk_bf16_f32 v236, v236, v237
    v_mfma_f32_16x16x32_bf16 v[232:235], a[28:31], a[220:223], v[232:235]
    ds_read_b128 a[244:247], v243 offset:61440
    v_cvt_pk_bf16_f32 v237, v238, v239
    v_mfma_f32_16x16x32_bf16 v[232:235], a[32:35], a[224:227], v[232:235]
    ds_write_b64 v247, v[236:237] offset:18688
    v_mfma_f32_16x16x32_bf16 v[232:235], a[36:39], a[228:231], v[232:235]
    ds_write_b64 v226, v[216:217] offset:128
    v_mfma_f32_16x16x32_bf16 v[232:235], a[40:43], a[232:235], v[232:235]
    s_waitcnt lgkmcnt(6)
    v_mul_f32 v220, v220, v225
    v_mul_f32 v221, v221, v225
    v_mfma_f32_16x16x32_bf16 v[228:231], a[20:23], a[236:239], v[228:231]
    v_mul_f32 v222, v222, v225
    v_mul_f32 v223, v223, v225
    v_mfma_f32_16x16x32_bf16 v[232:235], a[44:47], a[236:239], v[232:235]
    v_cvt_pk_bf16_f32 v220, v220, v221
    v_cvt_pk_bf16_f32 v221, v222, v223
    v_mfma_f32_16x16x32_bf16 v[236:239], a[48:51], a[216:219], 0
    ds_write_b64 v226, v[220:221] offset:256
    v_mfma_f32_16x16x32_bf16 v[236:239], a[52:55], a[220:223], v[236:239]
    v_cvt_pk_bf16_f32 v138, v228, v229
    v_cvt_pk_bf16_f32 v139, v230, v231
    v_mfma_f32_16x16x32_bf16 v[236:239], a[56:59], a[224:227], v[236:239]
    s_waitcnt lgkmcnt(4)
    v_cvt_pk_bf16_f32 v140, v232, v233
    v_cvt_pk_bf16_f32 v141, v234, v235
    v_mfma_f32_16x16x32_bf16 v[236:239], a[60:63], a[228:231], v[236:239]
    s_waitcnt lgkmcnt(3)
    v_cndmask_b32 v244, v205, v244, vcc
    v_cndmask_b32 v245, v245, v204, vcc
    v_mfma_f32_16x16x32_bf16 v[236:239], a[64:67], a[232:235], v[236:239]
    ds_read_b128 v[208:211], v245 offset:192
    s_mov_b32 vcc_lo, 0xff00fff0
    v_mfma_f32_16x16x32_bf16 v[236:239], a[68:71], a[236:239], v[236:239]
    s_mov_b32 vcc_hi, 0xf000
    v_cndmask_b32 v244, v244, v204, vcc
    s_mov_b32 vcc_lo, 0xfff00ff
    v_mfma_f32_16x16x32_bf16 v[228:231], a[216:219], a[72:75], 0
    ds_read_b128 v[200:203], v244 offset:256
    s_mov_b32 vcc_hi, 0xffffffff
    v_mfma_f32_16x16x32_bf16 v[228:231], a[220:223], a[76:79], v[228:231]
    v_cndmask_b32 v246, v246, v204, vcc
    v_cvt_pk_bf16_f32 v142, v236, v237
    v_mfma_f32_16x16x32_bf16 v[228:231], a[224:227], a[80:83], v[228:231]
    ds_read_b128 v[204:207], v244 offset:192
    v_cvt_pk_bf16_f32 v143, v238, v239
    v_mfma_f32_16x16x32_bf16 v[228:231], a[228:231], a[84:87], v[228:231]
    ds_read_b128 v[196:199], v246 offset:192
    s_mov_b32 vcc_lo, 0xff00ff00
    v_mfma_f32_16x16x32_bf16 v[228:231], a[232:235], a[88:91], v[228:231]
    s_mov_b32 vcc_hi, 0xff00ff00
    v_mfma_f32_16x16x32_bf16 v[228:231], a[236:239], a[92:95], v[228:231]
    v_mfma_f32_16x16x32_bf16 v[232:235], a[216:219], a[96:99], 0
    v_mfma_f32_16x16x32_bf16 v[232:235], a[220:223], a[100:103], v[232:235]
    s_waitcnt lgkmcnt(3)
    v_mfma_f32_16x16x32_bf16 v[208:211], v[150:153], v[168:171], v[208:211]
    v_mfma_f32_16x16x32_bf16 v[208:211], v[152:155], v[170:173], v[208:211]
    s_waitcnt lgkmcnt(2)
    v_mfma_f32_16x16x32_bf16 v[200:203], v[120:123], v[168:171], v[200:203]
    v_mfma_f32_16x16x32_bf16 v[200:203], v[122:125], v[170:173], v[200:203]
    s_waitcnt lgkmcnt(1)
    v_cvt_pk_bf16_f32 v12, v228, v229
    v_cvt_pk_bf16_f32 v15, v230, v231
    v_mfma_f32_16x16x32_bf16 v[204:207], v[114:117], v[168:171], v[204:207]
    s_waitcnt lgkmcnt(0)
    v_mfma_f32_16x16x32_bf16 v[204:207], v[116:119], v[170:173], v[204:207]
    v_mfma_f32_16x16x32_bf16 v[196:199], v[96:99], v[168:171], v[196:199]
    v_mfma_f32_16x16x32_bf16 v[196:199], v[98:101], v[170:173], v[196:199]
    v_mfma_f32_16x16x32_bf16 v[232:235], a[224:227], a[104:107], v[232:235]
    v_mfma_f32_16x16x32_bf16 v[232:235], a[228:231], a[108:111], v[232:235]
    v_mfma_f32_16x16x32_bf16 v[232:235], a[232:235], a[112:115], v[232:235]
    v_mfma_f32_16x16x32_bf16 v[232:235], a[236:239], a[116:119], v[232:235]
    v_mfma_f32_16x16x32_bf16 v[236:239], a[216:219], a[120:123], 0
    ds_read_b128 a[216:219], v242 offset:61568
    v_max_f32 v248, v204, v205
    v_mfma_f32_16x16x32_bf16 v[236:239], a[220:223], a[124:127], v[236:239]
    ds_read_b128 a[220:223], v243 offset:61568
    v_max3_f32 v248, v248, v206, v207
    v_mfma_f32_16x16x32_bf16 v[236:239], a[224:227], a[128:131], v[236:239]
    ds_read_b128 a[224:227], v242 offset:61696
    v_cvt_pk_bf16_f32 v42, v232, v233
    v_mfma_f32_16x16x32_bf16 v[236:239], a[228:231], a[132:135], v[236:239]
    ds_read_b128 a[228:231], v243 offset:61696
    v_cvt_pk_bf16_f32 v45, v234, v235
    v_mfma_f32_16x16x32_bf16 v[236:239], a[232:235], a[136:139], v[236:239]
    ds_read_b128 a[232:235], v242 offset:64512
    ds_read_b128 v[204:207], v245 offset:256
    v_mfma_f32_16x16x32_bf16 v[236:239], a[236:239], a[140:143], v[236:239]
    ds_read_b128 a[236:239], v243 offset:64512
    v_max3_f32 v248, v248, v208, v209
    v_mfma_f32_16x16x32_bf16 v[228:231], a[144:147], a[240:243], 0
    v_max3_f32 v248, v248, v210, v211
    v_max3_f32 v248, v248, v196, v197
    v_mfma_f32_16x16x32_bf16 v[228:231], a[148:151], a[244:247], v[228:231]
    ds_read_b128 v[208:211], v246 offset:256
    v_max3_f32 v248, v248, v198, v199
    v_mfma_f32_16x16x32_bf16 v[232:235], a[168:171], a[240:243], 0
    s_waitcnt lgkmcnt(7)
    v_cvt_pk_bf16_f32 v72, v236, v237
    v_cvt_pk_bf16_f32 v75, v238, v239
    v_mfma_f32_16x16x32_bf16 v[228:231], a[152:155], a[216:219], v[228:231]
    ds_read_b128 v[196:199], v244 offset:320
    v_max3_f32 v248, v248, v200, v201
    v_mfma_f32_16x16x32_bf16 v[232:235], a[172:175], a[244:247], v[232:235]
    s_waitcnt lgkmcnt(7)
    v_max3_f32 v248, v248, v202, v203
    v_mfma_f32_16x16x32_bf16 v[228:231], a[156:159], a[220:223], v[228:231]
    ds_read_b128 v[200:203], v245 offset:320
    s_waitcnt vmcnt(0) lgkmcnt(6)
    v_mfma_f32_16x16x32_bf16 v[228:231], a[160:163], a[224:227], v[228:231]
    s_barrier
    v_mfma_f32_16x16x32_bf16 v[228:231], a[164:167], a[228:231], v[228:231]
    s_waitcnt lgkmcnt(4)
    v_mfma_f32_16x16x32_bf16 v[204:207], v[156:159], v[168:171], v[204:207]
    s_waitcnt lgkmcnt(2)
    v_mfma_f32_16x16x32_bf16 v[204:207], v[158:161], v[170:173], v[204:207]
    v_mfma_f32_16x16x32_bf16 v[208:211], v[90:93], v[168:171], v[208:211]
    s_waitcnt lgkmcnt(1)
    v_mfma_f32_16x16x32_bf16 v[208:211], v[92:95], v[170:173], v[208:211]
    v_mfma_f32_16x16x32_bf16 v[196:199], v[126:129], v[168:171], v[196:199]
    s_waitcnt lgkmcnt(0)
    v_mul_f32 v228, s38, v228
    v_mul_f32 v229, s38, v229
    v_mfma_f32_16x16x32_bf16 v[196:199], v[128:131], v[170:173], v[196:199]
    v_mul_f32 v230, s38, v230
    v_mul_f32 v231, s38, v231
    v_mfma_f32_16x16x32_bf16 v[200:203], v[162:165], v[168:171], v[200:203]
    v_cvt_pk_bf16_f32 v228, v228, v229
    v_cvt_pk_bf16_f32 v229, v230, v231
    v_mfma_f32_16x16x32_bf16 v[200:203], v[164:167], v[170:173], v[200:203]
    ds_write_b64 v247, v[228:229] offset:24576
    v_mfma_f32_16x16x32_bf16 v[232:235], a[176:179], a[216:219], v[232:235]
    v_max3_f32 v248, v248, v204, v205
    v_max3_f32 v248, v248, v206, v207
    v_mfma_f32_16x16x32_bf16 v[232:235], a[180:183], a[220:223], v[232:235]
    ds_read_b128 v[204:207], v246 offset:320
    v_max3_f32 v248, v248, v208, v209
    v_mfma_f32_16x16x32_bf16 v[232:235], a[184:187], a[224:227], v[232:235]
    v_max3_f32 v248, v248, v210, v211
    v_max3_f32 v248, v248, v196, v197
    v_mfma_f32_16x16x32_bf16 v[232:235], a[188:191], a[228:231], v[232:235]
    ds_read_b128 v[208:211], v244 offset:192
    ds_read_b128 v[196:199], v245 offset:192
    v_mfma_f32_16x16x32_bf16 v[236:239], a[192:195], a[240:243], 0
    ds_read_b128 a[240:243], v242 offset:64640
    v_max3_f32 v248, v248, v200, v201
    v_mfma_f32_16x16x32_bf16 v[236:239], a[196:199], a[244:247], v[236:239]
    ds_read_b128 a[244:247], v243 offset:64640
    ds_read_b128 v[200:203], v246 offset:192
    v_mfma_f32_16x16x32_bf16 v[236:239], a[200:203], a[216:219], v[236:239]
    v_mul_f32 v232, s3, v232
    v_mul_f32 v233, s3, v233
    v_mfma_f32_16x16x32_bf16 v[236:239], a[204:207], a[220:223], v[236:239]
    v_mul_f32 v234, s3, v234
    v_mul_f32 v235, s3, v235
    v_mfma_f32_16x16x32_bf16 v[236:239], a[208:211], a[224:227], v[236:239]
    ds_read_b128 a[216:219], v242 offset:64768
    v_cvt_pk_bf16_f32 v232, v232, v233
    v_mfma_f32_16x16x32_bf16 v[236:239], a[212:215], a[228:231], v[236:239]
    ds_read_b128 a[220:223], v243 offset:64768
    v_cvt_pk_bf16_f32 v233, v234, v235
    v_mfma_f32_16x16x32_bf16 v[228:231], a[144:147], a[232:235], 0
    ds_write_b64 v247, v[232:233] offset:24704
    v_mfma_f32_16x16x32_bf16 v[228:231], a[148:151], a[236:239], v[228:231]
    ds_read_b128 a[224:227], v240 offset:35328
    ds_read_b128 a[228:231], v241 offset:35328
    v_mfma_f32_16x16x32_bf16 v[232:235], a[168:171], a[232:235], 0
    s_waitcnt lgkmcnt(8)
    v_mul_f32 v236, s38, v236
    v_mul_f32 v237, s38, v237
    v_mfma_f32_16x16x32_bf16 v[204:207], v[138:141], v[168:171], v[204:207]
    s_waitcnt lgkmcnt(7)
    v_mul_f32 v238, s38, v238
    v_mul_f32 v239, s38, v239
    v_mfma_f32_16x16x32_bf16 v[204:207], v[140:143], v[170:173], v[204:207]
    v_cvt_pk_bf16_f32 v236, v236, v237
    v_cvt_pk_bf16_f32 v237, v238, v239
    v_mfma_f32_16x16x32_bf16 v[208:211], v[114:117], v[168:171], v[208:211]
    ds_write_b64 v247, v[236:237] offset:24832
    v_mfma_f32_16x16x32_bf16 v[208:211], v[116:119], v[170:173], v[208:211]
    s_waitcnt lgkmcnt(6)
    v_add_u32 v242, 0xf000, v242
    v_add_u32 v243, 0xf000, v243
    v_mfma_f32_16x16x32_bf16 v[196:199], v[150:153], v[168:171], v[196:199]
    s_waitcnt lgkmcnt(5)
    v_max3_f32 v248, v248, v204, v205
    v_mov_b32 v225, v248
    v_mfma_f32_16x16x32_bf16 v[196:199], v[152:155], v[170:173], v[196:199]
    ds_read_b128 v[204:207], v244 offset:256
    v_permlane16_swap_b32 v248, v225
    v_mfma_f32_16x16x32_bf16 v[200:203], v[96:99], v[168:171], v[200:203]
    s_waitcnt lgkmcnt(5)
    v_max_f32 v248, v248, v225
    v_mov_b32 v225, v248
    v_mfma_f32_16x16x32_bf16 v[200:203], v[98:101], v[170:173], v[200:203]
    v_mfma_f32_16x16x32_bf16 v[228:231], a[152:155], a[240:243], v[228:231]
    s_waitcnt lgkmcnt(3)
    v_permlane32_swap_b32 v248, v225
    v_max_f32 v248, v248, v225
    v_mfma_f32_16x16x32_bf16 v[228:231], a[156:159], a[244:247], v[228:231]
    s_waitcnt lgkmcnt(2)
    v_sub_f32 v208, v208, v248
    v_sub_f32 v209, v209, v248
    v_mfma_f32_16x16x32_bf16 v[228:231], a[160:163], a[216:219], v[228:231]
    v_exp_f32 v208, v208
    v_mfma_f32_16x16x32_bf16 v[228:231], a[164:167], a[220:223], v[228:231]
    v_exp_f32 v209, v209
    v_mfma_f32_16x16x32_bf16 v[232:235], a[172:175], a[236:239], v[232:235]
    v_sub_f32 v210, v210, v248
    v_sub_f32 v211, v211, v248
    v_mfma_f32_16x16x32_bf16 v[232:235], a[176:179], a[240:243], v[232:235]
    v_exp_f32 v210, v210
    v_mfma_f32_16x16x32_bf16 v[232:235], a[180:183], a[244:247], v[232:235]
    s_waitcnt lgkmcnt(0)
    v_mul_f32 v228, s38, v228
    v_mul_f32 v229, s38, v229
    v_mfma_f32_16x16x32_bf16 v[204:207], v[120:123], v[168:171], v[204:207]
    v_mul_f32 v230, s38, v230
    v_mul_f32 v231, s38, v231
    v_mfma_f32_16x16x32_bf16 v[204:207], v[122:125], v[170:173], v[204:207]
    v_cvt_pk_bf16_f32 v228, v228, v229
    v_cvt_pk_bf16_f32 v229, v230, v231
    v_mfma_f32_16x16x32_bf16 v[232:235], a[184:187], a[216:219], v[232:235]
    ds_write_b64 v247, v[228:229] offset:36864
    v_mfma_f32_16x16x32_bf16 v[232:235], a[188:191], a[220:223], v[232:235]
    v_exp_f32 v211, v211
    v_mfma_f32_16x16x32_bf16 v[236:239], a[192:195], a[232:235], 0
    ds_read_b128 a[232:235], v240 offset:35456
    v_cvt_pk_bf16_f32 v193, v208, v209
    v_mfma_f32_16x16x32_bf16 v[236:239], a[196:199], a[236:239], v[236:239]
    ds_read_b128 a[236:239], v241 offset:35456
    v_cvt_pk_bf16_f32 v180, v210, v211
    v_mfma_f32_16x16x32_bf16 v[236:239], a[200:203], a[240:243], v[236:239]
    v_mul_f32 v232, s3, v232
    v_mul_f32 v233, s3, v233
    v_mfma_f32_16x16x32_bf16 v[236:239], a[204:207], a[244:247], v[236:239]
    v_mul_f32 v234, s3, v234
    v_mul_f32 v235, s3, v235
    v_mfma_f32_16x16x32_bf16 v[236:239], a[208:211], a[216:219], v[236:239]
    ds_read_b128 a[240:243], v240 offset:35584
    v_cvt_pk_bf16_f32 v232, v232, v233
    v_mfma_f32_16x16x32_bf16 v[236:239], a[212:215], a[220:223], v[236:239]
    ds_read_b128 a[244:247], v241 offset:35584
    v_cvt_pk_bf16_f32 v233, v234, v235
    v_mfma_f32_16x16x32_bf16 v[228:231], a[0:3], a[224:227], 0
    ds_write_b64 v247, v[232:233] offset:36992
    v_mfma_f32_16x16x32_bf16 v[228:231], a[4:7], a[228:231], v[228:231]
    ds_read_b128 a[216:219], v242 offset:4608
    ds_read_b128 a[220:223], v243 offset:4608
    v_mfma_f32_16x16x32_bf16 v[232:235], a[24:27], a[224:227], 0
    s_waitcnt lgkmcnt(6)
    v_mul_f32 v236, s38, v236
    v_mul_f32 v237, s38, v237
    v_mfma_f32_16x16x32_bf16 v[228:231], a[8:11], a[232:235], v[228:231]
    s_waitcnt lgkmcnt(5)
    v_mul_f32 v238, s38, v238
    v_mul_f32 v239, s38, v239
    v_mfma_f32_16x16x32_bf16 v[228:231], a[12:15], a[236:239], v[228:231]
    ds_read_b128 v[208:211], v245 offset:256
    v_cvt_pk_bf16_f32 v236, v236, v237
    v_mfma_f32_16x16x32_bf16 v[232:235], a[28:31], a[228:231], v[232:235]
    v_cvt_pk_bf16_f32 v237, v238, v239
    v_sub_f32 v196, v196, v248
    v_mfma_f32_16x16x32_bf16 v[232:235], a[32:35], a[232:235], v[232:235]
    ds_write_b64 v247, v[236:237] offset:37120
    v_mfma_f32_16x16x32_bf16 v[232:235], a[36:39], a[236:239], v[232:235]
    s_waitcnt lgkmcnt(6)
    v_exp_f32 v196, v196
    v_mfma_f32_16x16x32_bf16 v[228:231], a[16:19], a[240:243], v[228:231]
    s_waitcnt lgkmcnt(5)
    v_sub_f32 v197, v197, v248
    v_sub_f32 v198, v198, v248
    v_mfma_f32_16x16x32_bf16 v[228:231], a[20:23], a[244:247], v[228:231]
    v_exp_f32 v197, v197
    v_mfma_f32_16x16x32_bf16 v[232:235], a[40:43], a[240:243], v[232:235]
    v_exp_f32 v198, v198
    v_mfma_f32_16x16x32_bf16 v[232:235], a[44:47], a[244:247], v[232:235]
    s_waitcnt lgkmcnt(3)
    v_sub_f32 v199, v199, v248
    v_cvt_pk_bf16_f32 v194, v196, v197
    v_mfma_f32_16x16x32_bf16 v[236:239], a[48:51], a[224:227], 0
    s_waitcnt lgkmcnt(1)
    v_cvt_pk_bf16_f32 v114, v228, v229
    v_cvt_pk_bf16_f32 v115, v230, v231
    v_mfma_f32_16x16x32_bf16 v[208:211], v[156:159], v[168:171], v[208:211]
    v_cvt_pk_bf16_f32 v116, v232, v233
    v_cvt_pk_bf16_f32 v117, v234, v235
    v_mfma_f32_16x16x32_bf16 v[208:211], v[158:161], v[170:173], v[208:211]
    v_exp_f32 v199, v199
    v_mfma_f32_16x16x32_bf16 v[236:239], a[52:55], a[228:231], v[236:239]
    v_cvt_pk_bf16_f32 v181, v198, v199
    v_sub_f32 v200, v200, v248
    v_mfma_f32_16x16x32_bf16 v[236:239], a[56:59], a[232:235], v[236:239]
    ds_read_b128 v[196:199], v246 offset:256
    v_sub_f32 v201, v201, v248
    v_mfma_f32_16x16x32_bf16 v[236:239], a[60:63], a[236:239], v[236:239]
    v_exp_f32 v200, v200
    v_mfma_f32_16x16x32_bf16 v[236:239], a[64:67], a[240:243], v[236:239]
    v_exp_f32 v201, v201
    v_mfma_f32_16x16x32_bf16 v[236:239], a[68:71], a[244:247], v[236:239]
    v_sub_f32 v202, v202, v248
    v_sub_f32 v203, v203, v248
    v_mfma_f32_16x16x32_bf16 v[228:231], a[224:227], a[72:75], 0
    v_exp_f32 v202, v202
    v_mfma_f32_16x16x32_bf16 v[228:231], a[228:231], a[76:79], v[228:231]
    v_exp_f32 v203, v203
    v_mfma_f32_16x16x32_bf16 v[228:231], a[232:235], a[80:83], v[228:231]
    v_cvt_pk_bf16_f32 v192, v200, v201
    v_cvt_pk_bf16_f32 v118, v236, v237
    v_mfma_f32_16x16x32_bf16 v[228:231], a[236:239], a[84:87], v[228:231]
    v_cvt_pk_bf16_f32 v119, v238, v239
    v_cvt_pk_bf16_f32 v195, v202, v203
    v_mfma_f32_16x16x32_bf16 v[228:231], a[240:243], a[88:91], v[228:231]
    ds_read_b128 v[200:203], v244 offset:320
    v_sub_f32 v204, v204, v248
    v_mfma_f32_16x16x32_bf16 v[212:215], v[0:3], v[192:195], 0
    s_waitcnt lgkmcnt(1)
    v_exp_f32 v204, v204
    v_mfma_f32_16x16x32_bf16 v[216:219], v[30:33], v[192:195], 0
    v_sub_f32 v205, v205, v248
    v_sub_f32 v206, v206, v248
    v_mfma_f32_16x16x32_bf16 v[220:223], v[60:63], v[192:195], 0
    v_exp_f32 v205, v205
    v_mfma_f32_16x16x32_bf16 v[224:227], a[248:251], v[192:195], 0
    v_exp_f32 v206, v206
    v_mfma_f32_16x16x32_bf16 v[196:199], v[90:93], v[168:171], v[196:199]
    v_sub_f32 v207, v207, v248
    v_cvt_pk_bf16_f32 v183, v204, v205
    v_mfma_f32_16x16x32_bf16 v[196:199], v[92:95], v[170:173], v[196:199]
    v_exp_f32 v207, v207
    v_mfma_f32_16x16x32_bf16 v[228:231], a[244:247], a[92:95], v[228:231]
    v_cvt_pk_bf16_f32 v186, v206, v207
    v_sub_f32 v208, v208, v248
    v_mfma_f32_16x16x32_bf16 v[232:235], a[224:227], a[96:99], 0
    ds_read_b128 v[204:207], v245 offset:320
    v_sub_f32 v209, v209, v248
    v_mfma_f32_16x16x32_bf16 v[232:235], a[228:231], a[100:103], v[232:235]
    s_waitcnt lgkmcnt(1)
    v_exp_f32 v208, v208
    v_mfma_f32_16x16x32_bf16 v[200:203], v[126:129], v[168:171], v[200:203]
    v_cvt_pk_bf16_f32 v18, v228, v229
    v_cvt_pk_bf16_f32 v21, v230, v231
    v_mfma_f32_16x16x32_bf16 v[200:203], v[128:131], v[170:173], v[200:203]
    v_exp_f32 v209, v209
    v_mfma_f32_16x16x32_bf16 v[232:235], a[232:235], a[104:107], v[232:235]
    v_sub_f32 v210, v210, v248
    v_sub_f32 v211, v211, v248
    v_mfma_f32_16x16x32_bf16 v[232:235], a[236:239], a[108:111], v[232:235]
    v_exp_f32 v210, v210
    v_mfma_f32_16x16x32_bf16 v[232:235], a[240:243], a[112:115], v[232:235]
    v_exp_f32 v211, v211
    v_mfma_f32_16x16x32_bf16 v[232:235], a[244:247], a[116:119], v[232:235]
    v_cvt_pk_bf16_f32 v184, v208, v209
    v_cvt_pk_bf16_f32 v187, v210, v211
    v_mfma_f32_16x16x32_bf16 v[236:239], a[224:227], a[120:123], 0
    ds_read_b128 a[224:227], v242 offset:4736
    ds_read_b128 v[208:211], v246 offset:320
    v_mfma_f32_16x16x32_bf16 v[236:239], a[228:231], a[124:127], v[236:239]
    ds_read_b128 a[228:231], v243 offset:4736
    v_sub_f32 v196, v196, v248
    v_mfma_f32_16x16x32_bf16 v[236:239], a[232:235], a[128:131], v[236:239]
    s_waitcnt lgkmcnt(3)
    v_cvt_pk_bf16_f32 v48, v232, v233
    v_cvt_pk_bf16_f32 v51, v234, v235
    v_mfma_f32_16x16x32_bf16 v[204:207], v[162:165], v[168:171], v[204:207]
    ds_read_b128 a[232:235], v242 offset:4864
    v_sub_f32 v197, v197, v248
    v_mfma_f32_16x16x32_bf16 v[204:207], v[164:167], v[170:173], v[204:207]
    v_exp_f32 v196, v196
    v_mfma_f32_16x16x32_bf16 v[236:239], a[236:239], a[132:135], v[236:239]
    ds_read_b128 a[236:239], v243 offset:4864
    v_sub_f32 v198, v198, v248
    v_mfma_f32_16x16x32_bf16 v[236:239], a[240:243], a[136:139], v[236:239]
    ds_read_b128 a[240:243], v242 offset:1536
    v_sub_f32 v199, v199, v248
    v_mfma_f32_16x16x32_bf16 v[236:239], a[244:247], a[140:143], v[236:239]
    ds_read_b128 a[244:247], v243 offset:1536
    v_sub_f32 v200, v200, v248
    v_mfma_f32_16x16x32_bf16 v[228:231], a[144:147], a[216:219], 0
    v_exp_f32 v197, v197
    v_mfma_f32_16x16x32_bf16 v[228:231], a[148:151], a[220:223], v[228:231]
    s_waitcnt lgkmcnt(5)
    v_exp_f32 v198, v198
    v_mfma_f32_16x16x32_bf16 v[208:211], v[138:141], v[168:171], v[208:211]
    v_cvt_pk_bf16_f32 v78, v236, v237
    v_cvt_pk_bf16_f32 v81, v238, v239
    v_mfma_f32_16x16x32_bf16 v[208:211], v[140:143], v[170:173], v[208:211]
    ds_read_b64 v[168:169], v247 offset:18432
    ds_read_b64 v[170:171], v247 offset:18560
    v_mfma_f32_16x16x32_bf16 v[228:231], a[152:155], a[224:227], v[228:231]
    ds_read_b64 v[172:173], v247 offset:18688
    v_cvt_pk_bf16_f32 v182, v196, v197
    v_mfma_f32_16x16x32_bf16 v[232:235], a[168:171], a[216:219], 0
    s_waitcnt lgkmcnt(7)
    v_exp_f32 v199, v199
    v_mfma_f32_16x16x32_bf16 v[212:215], v[4:7], v[180:183], v[212:215]
    s_waitcnt lgkmcnt(6)
    v_cvt_pk_bf16_f32 v185, v198, v199
    v_sub_f32 v201, v201, v248
    v_mfma_f32_16x16x32_bf16 v[216:219], v[34:37], v[180:183], v[216:219]
    ds_read_b128 v[196:199], v244 offset:0
    v_sub_f32 v204, v204, v248
    v_mfma_f32_16x16x32_bf16 v[220:223], v[64:67], v[180:183], v[220:223]
    s_waitcnt lgkmcnt(5)
    v_exp_f32 v200, v200
    v_mfma_f32_16x16x32_bf16 v[224:227], a[248:251], v[180:183], v[224:227]
    s_waitcnt lgkmcnt(4)
    v_exp_f32 v201, v201
    v_mfma_f32_16x16x32_bf16 v[212:215], v[8:11], v[184:187], v[212:215]
    v_cvt_pk_bf16_f32 v189, v200, v201
    v_sub_f32 v205, v205, v248
    v_mfma_f32_16x16x32_bf16 v[216:219], v[38:41], v[184:187], v[216:219]
    ds_read_b128 v[200:203], v245 offset:0
    v_sub_f32 v208, v208, v248
    v_mfma_f32_16x16x32_bf16 v[220:223], v[68:71], v[184:187], v[220:223]
    v_exp_f32 v204, v204
    v_mfma_f32_16x16x32_bf16 v[224:227], a[248:251], v[184:187], v[224:227]
    s_waitcnt lgkmcnt(3)
    v_exp_f32 v205, v205
    v_mfma_f32_16x16x32_bf16 v[228:231], a[156:159], a[228:231], v[228:231]
    s_waitcnt lgkmcnt(2)
    v_cvt_pk_bf16_f32 v190, v204, v205
    v_sub_f32 v209, v209, v248
    v_mfma_f32_16x16x32_bf16 v[228:231], a[160:163], a[232:235], v[228:231]
    ds_read_b128 v[204:207], v246 offset:0
    s_waitcnt lgkmcnt(2)
    v_mfma_f32_16x16x32_bf16 v[196:199], v[120:123], v[174:177], v[196:199]
    v_exp_f32 v208, v208
    v_mfma_f32_16x16x32_bf16 v[196:199], v[122:125], v[176:179], v[196:199]
    v_exp_f32 v209, v209
    v_mfma_f32_16x16x32_bf16 v[228:231], a[164:167], a[236:239], v[228:231]
    v_cvt_pk_bf16_f32 v188, v208, v209
    v_mfma_f32_16x16x32_bf16 v[232:235], a[172:175], a[220:223], v[232:235]
    ds_read_b128 v[208:211], v244 offset:64
    s_waitcnt lgkmcnt(2)
    v_mfma_f32_16x16x32_bf16 v[212:215], v[12:15], v[188:191], v[212:215]
    v_mfma_f32_16x16x32_bf16 v[216:219], v[42:45], v[188:191], v[216:219]
    v_max_f32 v248, v196, v197
    v_max3_f32 v248, v248, v198, v199
    v_mfma_f32_16x16x32_bf16 v[220:223], v[72:75], v[188:191], v[220:223]
    v_mul_f32 v228, s38, v228
    v_mul_f32 v229, s38, v229
    v_mfma_f32_16x16x32_bf16 v[224:227], a[248:251], v[188:191], v[224:227]
    v_mul_f32 v230, s38, v230
    v_mul_f32 v231, s38, v231
    v_mfma_f32_16x16x32_bf16 v[200:203], v[156:159], v[174:177], v[200:203]
    ds_read_b128 v[196:199], v245 offset:64
    v_cvt_pk_bf16_f32 v228, v228, v229
    v_mfma_f32_16x16x32_bf16 v[200:203], v[158:161], v[176:179], v[200:203]
    s_waitcnt lgkmcnt(2)
    v_cvt_pk_bf16_f32 v229, v230, v231
    v_mfma_f32_16x16x32_bf16 v[204:207], v[90:93], v[174:177], v[204:207]
    ds_write_b64 v247, v[228:229] offset:43008
    v_mfma_f32_16x16x32_bf16 v[204:207], v[92:95], v[176:179], v[204:207]
    s_waitcnt lgkmcnt(2)
    v_rcp_f32 v225, v224
    v_mfma_f32_16x16x32_bf16 v[208:211], v[126:129], v[174:177], v[208:211]
    v_mul_f32 v212, v212, v225
    v_mul_f32 v213, v213, v225
    v_mfma_f32_16x16x32_bf16 v[208:211], v[128:131], v[176:179], v[208:211]
    v_mul_f32 v214, v214, v225
    v_mul_f32 v215, v215, v225
    v_mfma_f32_16x16x32_bf16 v[232:235], a[176:179], a[224:227], v[232:235]
    v_cvt_pk_bf16_f32 v212, v212, v213
    v_cvt_pk_bf16_f32 v213, v214, v215
    v_mfma_f32_16x16x32_bf16 v[232:235], a[180:183], a[228:231], v[232:235]
    ds_write_b64 v247, v[212:213] offset:6144
    v_mfma_f32_16x16x32_bf16 v[232:235], a[184:187], a[232:235], v[232:235]
    s_waitcnt lgkmcnt(2)
    v_mul_f32 v216, v216, v225
    v_mul_f32 v217, v217, v225
    v_mfma_f32_16x16x32_bf16 v[196:199], v[162:165], v[174:177], v[196:199]
    v_mul_f32 v218, v218, v225
    v_mul_f32 v219, v219, v225
    v_mfma_f32_16x16x32_bf16 v[196:199], v[164:167], v[176:179], v[196:199]
    v_cvt_pk_bf16_f32 v216, v216, v217
    v_cvt_pk_bf16_f32 v217, v218, v219
    v_mfma_f32_16x16x32_bf16 v[232:235], a[188:191], a[236:239], v[232:235]
    ds_write_b64 v247, v[216:217] offset:6272
    v_mfma_f32_16x16x32_bf16 v[236:239], a[192:195], a[216:219], 0
    ds_read_b128 a[216:219], v242 offset:1664
    v_mul_f32 v220, v220, v225
    v_mfma_f32_16x16x32_bf16 v[236:239], a[196:199], a[220:223], v[236:239]
    ds_read_b128 a[220:223], v243 offset:1664
    v_mul_f32 v221, v221, v225
    v_mfma_f32_16x16x32_bf16 v[236:239], a[200:203], a[224:227], v[236:239]
    v_mul_f32 v232, s3, v232
    v_mul_f32 v233, s3, v233
    v_mfma_f32_16x16x32_bf16 v[236:239], a[204:207], a[228:231], v[236:239]
    v_mul_f32 v234, s3, v234
    v_mul_f32 v235, s3, v235
    v_mfma_f32_16x16x32_bf16 v[236:239], a[208:211], a[232:235], v[236:239]
    ds_read_b128 a[224:227], v242 offset:1792
    v_cvt_pk_bf16_f32 v232, v232, v233
    v_mfma_f32_16x16x32_bf16 v[236:239], a[212:215], a[236:239], v[236:239]
    ds_read_b128 a[228:231], v243 offset:1792
    v_cvt_pk_bf16_f32 v233, v234, v235
    v_mfma_f32_16x16x32_bf16 v[228:231], a[144:147], a[240:243], 0
    ds_write_b64 v247, v[232:233] offset:43136
    v_mfma_f32_16x16x32_bf16 v[228:231], a[148:151], a[244:247], v[228:231]
    v_add_u32 v242, 0x7800, v242
    v_add_u32 v243, 0x4200, v243
    v_mfma_f32_16x16x32_bf16 v[232:235], a[168:171], a[240:243], 0
    s_waitcnt lgkmcnt(4)
    v_mul_f32 v236, s38, v236
    v_mul_f32 v237, s38, v237
    v_mfma_f32_16x16x32_bf16 v[228:231], a[152:155], a[216:219], v[228:231]
    s_waitcnt lgkmcnt(3)
    v_mul_f32 v238, s38, v238
    v_mul_f32 v239, s38, v239
    v_mfma_f32_16x16x32_bf16 v[228:231], a[156:159], a[220:223], v[228:231]
    v_cvt_pk_bf16_f32 v236, v236, v237
    v_cvt_pk_bf16_f32 v237, v238, v239
    v_mfma_f32_16x16x32_bf16 v[232:235], a[172:175], a[244:247], v[232:235]
    ds_write_b64 v247, v[236:237] offset:43264
    v_mfma_f32_16x16x32_bf16 v[232:235], a[176:179], a[216:219], v[232:235]
    s_waitcnt lgkmcnt(3)
    v_cndmask_b32 v242, v242, v243, vcc
    v_add_u32 v243, 0xfffe2000, v242
    v_mfma_f32_16x16x32_bf16 v[228:231], a[160:163], a[224:227], v[228:231]
    s_mov_b32 vcc_lo, 0xf0f0f0f0
    s_mov_b32 vcc_hi, 0xf0f0f0f0
    v_cndmask_b32 v242, v242, v243, vcc
    v_mfma_f32_16x16x32_bf16 v[232:235], a[180:183], a[220:223], v[232:235]
    ds_read_b128 a[232:235], v242 offset:0
    v_xor_b32 v243, 64, v242
    v_mfma_f32_16x16x32_bf16 v[232:235], a[184:187], a[224:227], v[232:235]
    ds_read_b128 a[236:239], v243 offset:0
    v_mul_f32 v222, v222, v225
    v_mfma_f32_16x16x32_bf16 v[236:239], a[192:195], a[240:243], 0
    ds_read_b128 a[240:243], v242 offset:128
    v_mul_f32 v223, v223, v225
    v_mfma_f32_16x16x32_bf16 v[236:239], a[196:199], a[244:247], v[236:239]
    ds_read_b128 a[244:247], v243 offset:128
    v_cvt_pk_bf16_f32 v220, v220, v221
    v_mfma_f32_16x16x32_bf16 v[236:239], a[200:203], a[216:219], v[236:239]
    ds_read_b128 a[216:219], v242 offset:256
    v_cvt_pk_bf16_f32 v221, v222, v223
    v_mfma_f32_16x16x32_bf16 v[236:239], a[204:207], a[220:223], v[236:239]
    ds_read_b128 a[220:223], v243 offset:256
    v_max3_f32 v248, v248, v200, v201
    v_mfma_f32_16x16x32_bf16 v[236:239], a[208:211], a[224:227], v[236:239]
    s_waitcnt lgkmcnt(7)
    ds_read_b128 a[224:227], v240 offset:36864
    v_mfma_f32_16x16x32_bf16 v[228:231], a[164:167], a[228:231], v[228:231]
    ds_write_b64 v247, v[220:221] offset:6400
    v_mfma_f32_16x16x32_bf16 v[232:235], a[188:191], a[228:231], v[232:235]
    s_mov_b32 vcc_lo, 0xcccccccc
    v_max3_f32 v248, v248, v202, v203
    v_max3_f32 v248, v248, v204, v205
    v_mfma_f32_16x16x32_bf16 v[236:239], a[212:215], a[228:231], v[236:239]
    ds_read_b128 a[228:231], v241 offset:36864
    ds_read_b128 v[200:203], v246 offset:64
    v_mul_f32 v228, s38, v228
    v_mul_f32 v229, s38, v229
    v_mul_f32 v230, s38, v230
    v_mul_f32 v231, s38, v231
    v_cvt_pk_bf16_f32 v228, v228, v229
    v_cvt_pk_bf16_f32 v229, v230, v231
    ds_write_b64 v247, v[228:229] offset:30720
    s_waitcnt lgkmcnt(10)
    v_mfma_f32_16x16x32_bf16 v[228:231], a[144:147], a[232:235], 0
    s_waitcnt lgkmcnt(9)
    v_mul_f32 v232, s3, v232
    v_mul_f32 v233, s3, v233
    v_mfma_f32_16x16x32_bf16 v[228:231], a[148:151], a[236:239], v[228:231]
    s_waitcnt lgkmcnt(8)
    v_mul_f32 v234, s3, v234
    v_mul_f32 v235, s3, v235
    v_mfma_f32_16x16x32_bf16 v[228:231], a[152:155], a[240:243], v[228:231]
    s_waitcnt lgkmcnt(7)
    v_cvt_pk_bf16_f32 v232, v232, v233
    v_cvt_pk_bf16_f32 v233, v234, v235
    v_mfma_f32_16x16x32_bf16 v[228:231], a[156:159], a[244:247], v[228:231]
    s_waitcnt lgkmcnt(6)
    v_mul_f32 v236, s38, v236
    v_mul_f32 v237, s38, v237
    v_mfma_f32_16x16x32_bf16 v[228:231], a[160:163], a[216:219], v[228:231]
    s_waitcnt lgkmcnt(5)
    v_mul_f32 v238, s38, v238
    v_mul_f32 v239, s38, v239
    v_mfma_f32_16x16x32_bf16 v[228:231], a[164:167], a[220:223], v[228:231]
    s_waitcnt lgkmcnt(1)
    v_cvt_pk_bf16_f32 v236, v236, v237
    v_cvt_pk_bf16_f32 v237, v238, v239
    v_mfma_f32_16x16x32_bf16 v[200:203], v[138:141], v[174:177], v[200:203]
    ds_write_b64 v247, v[232:233] offset:30848
    v_mfma_f32_16x16x32_bf16 v[200:203], v[140:143], v[176:179], v[200:203]
    ds_write_b64 v247, v[236:237] offset:30976
    v_mfma_f32_16x16x32_bf16 v[232:235], a[168:171], a[232:235], 0
    s_mov_b32 vcc_hi, 0xcccccccc
    v_mul_f32 v228, s38, v228
    v_mul_f32 v229, s38, v229
    v_mfma_f32_16x16x32_bf16 v[232:235], a[172:175], a[236:239], v[232:235]
    v_mul_f32 v230, s38, v230
    v_mul_f32 v231, s38, v231
    v_mfma_f32_16x16x32_bf16 v[232:235], a[176:179], a[240:243], v[232:235]
    v_cvt_pk_bf16_f32 v228, v228, v229
    v_cvt_pk_bf16_f32 v229, v230, v231
    v_mfma_f32_16x16x32_bf16 v[232:235], a[180:183], a[244:247], v[232:235]
    ds_write_b64 v247, v[228:229] offset:49152
    v_mfma_f32_16x16x32_bf16 v[232:235], a[184:187], a[216:219], v[232:235]
    v_max3_f32 v248, v248, v206, v207
    v_max3_f32 v248, v248, v208, v209
    v_mfma_f32_16x16x32_bf16 v[232:235], a[188:191], a[220:223], v[232:235]
    ds_read_b128 v[204:207], v244 offset:128
    v_max3_f32 v248, v248, v210, v211
    v_mfma_f32_16x16x32_bf16 v[236:239], a[192:195], a[232:235], 0
    ds_read_b128 a[232:235], v240 offset:36992
    ds_read_b128 v[208:211], v245 offset:128
    v_mfma_f32_16x16x32_bf16 v[236:239], a[196:199], a[236:239], v[236:239]
    ds_read_b128 a[236:239], v241 offset:36992
    v_max3_f32 v248, v248, v196, v197
    v_mfma_f32_16x16x32_bf16 v[236:239], a[200:203], a[240:243], v[236:239]
    v_mul_f32 v232, s3, v232
    v_mul_f32 v233, s3, v233
    v_mfma_f32_16x16x32_bf16 v[236:239], a[204:207], a[244:247], v[236:239]
    v_mul_f32 v234, s3, v234
    v_mul_f32 v235, s3, v235
    v_mfma_f32_16x16x32_bf16 v[236:239], a[208:211], a[216:219], v[236:239]
    ds_read_b128 a[240:243], v240 offset:37120
    v_cvt_pk_bf16_f32 v232, v232, v233
    v_mfma_f32_16x16x32_bf16 v[236:239], a[212:215], a[220:223], v[236:239]
    ds_read_b128 a[244:247], v241 offset:37120
    v_cvt_pk_bf16_f32 v233, v234, v235
    v_mfma_f32_16x16x32_bf16 v[228:231], a[0:3], a[224:227], 0
    ds_write_b64 v247, v[232:233] offset:49280
    v_mfma_f32_16x16x32_bf16 v[228:231], a[4:7], a[228:231], v[228:231]
    ds_read_b128 a[216:219], v242 offset:3072
    ds_read_b128 a[220:223], v243 offset:3072
    v_mfma_f32_16x16x32_bf16 v[232:235], a[24:27], a[224:227], 0
    s_waitcnt lgkmcnt(7)
    v_mul_f32 v236, s38, v236
    v_mul_f32 v237, s38, v237
    v_mfma_f32_16x16x32_bf16 v[204:207], v[132:135], v[174:177], v[204:207]
    s_waitcnt lgkmcnt(6)
    v_mul_f32 v238, s38, v238
    v_mul_f32 v239, s38, v239
    v_mfma_f32_16x16x32_bf16 v[204:207], v[134:137], v[176:179], v[204:207]
    v_cvt_pk_bf16_f32 v236, v236, v237
    v_cvt_pk_bf16_f32 v237, v238, v239
    v_mfma_f32_16x16x32_bf16 v[208:211], v[102:105], v[174:177], v[208:211]
    ds_write_b64 v247, v[236:237] offset:49408
    v_mfma_f32_16x16x32_bf16 v[208:211], v[104:107], v[176:179], v[208:211]
    s_waitcnt lgkmcnt(6)
    v_add_u32 v240, 0xffff1000, v240
    v_add_u32 v241, 0xffff1000, v241
    v_mfma_f32_16x16x32_bf16 v[228:231], a[8:11], a[232:235], v[228:231]
    s_waitcnt lgkmcnt(5)
    v_max3_f32 v248, v248, v198, v199
    v_max3_f32 v248, v248, v200, v201
    v_mfma_f32_16x16x32_bf16 v[228:231], a[12:15], a[236:239], v[228:231]
    ds_read_b128 v[196:199], v246 offset:128
    v_max3_f32 v248, v248, v202, v203
    v_mfma_f32_16x16x32_bf16 v[228:231], a[16:19], a[240:243], v[228:231]
    ds_read_b128 v[200:203], v244 offset:0
    v_max3_f32 v248, v248, v204, v205
    v_mfma_f32_16x16x32_bf16 v[232:235], a[28:31], a[228:231], v[232:235]
    ds_read_b128 v[204:207], v245 offset:0
    v_max3_f32 v248, v248, v208, v209
    v_mfma_f32_16x16x32_bf16 v[232:235], a[32:35], a[232:235], v[232:235]
    ds_read_b128 v[208:211], v246 offset:0
    s_waitcnt lgkmcnt(8)
    v_mfma_f32_16x16x32_bf16 v[228:231], a[20:23], a[244:247], v[228:231]
    s_waitcnt lgkmcnt(5)
    v_mfma_f32_16x16x32_bf16 v[232:235], a[36:39], a[236:239], v[232:235]
    v_mfma_f32_16x16x32_bf16 v[232:235], a[40:43], a[240:243], v[232:235]
    v_mfma_f32_16x16x32_bf16 v[232:235], a[44:47], a[244:247], v[232:235]
    v_mfma_f32_16x16x32_bf16 v[236:239], a[48:51], a[224:227], 0
    v_mfma_f32_16x16x32_bf16 v[236:239], a[52:55], a[228:231], v[236:239]
    s_waitcnt lgkmcnt(3)
    s_waitcnt lgkmcnt(2)
    v_mfma_f32_16x16x32_bf16 v[196:199], v[114:117], v[174:177], v[196:199]
    v_mfma_f32_16x16x32_bf16 v[196:199], v[116:119], v[176:179], v[196:199]
    s_waitcnt lgkmcnt(1)
    s_waitcnt lgkmcnt(0)
    v_mfma_f32_16x16x32_bf16 v[200:203], v[120:123], v[174:177], v[200:203]
    v_cvt_pk_bf16_f32 v120, v228, v229
    v_cvt_pk_bf16_f32 v121, v230, v231
    v_mfma_f32_16x16x32_bf16 v[200:203], v[122:125], v[176:179], v[200:203]
    v_cvt_pk_bf16_f32 v122, v232, v233
    v_cvt_pk_bf16_f32 v123, v234, v235
    v_mfma_f32_16x16x32_bf16 v[204:207], v[156:159], v[174:177], v[204:207]
    v_max3_f32 v248, v248, v196, v197
    v_mov_b32 v225, v248
    v_mfma_f32_16x16x32_bf16 v[204:207], v[158:161], v[176:179], v[204:207]
    ds_read_b128 v[196:199], v244 offset:64
    v_permlane16_swap_b32 v248, v225
    v_mfma_f32_16x16x32_bf16 v[208:211], v[90:93], v[174:177], v[208:211]
    v_max_f32 v248, v248, v225
    v_mov_b32 v225, v248
    v_mfma_f32_16x16x32_bf16 v[208:211], v[92:95], v[176:179], v[208:211]
    v_mfma_f32_16x16x32_bf16 v[236:239], a[56:59], a[232:235], v[236:239]
    v_permlane32_swap_b32 v248, v225
    v_max_f32 v248, v248, v225
    v_mfma_f32_16x16x32_bf16 v[236:239], a[60:63], a[236:239], v[236:239]
    v_sub_f32 v200, v200, v248
    v_sub_f32 v201, v201, v248
    v_mfma_f32_16x16x32_bf16 v[236:239], a[64:67], a[240:243], v[236:239]
    v_exp_f32 v200, v200
    v_mfma_f32_16x16x32_bf16 v[236:239], a[68:71], a[244:247], v[236:239]
    v_exp_f32 v201, v201
    v_mfma_f32_16x16x32_bf16 v[228:231], a[224:227], a[72:75], 0
    v_sub_f32 v202, v202, v248
    v_sub_f32 v203, v203, v248
    v_mfma_f32_16x16x32_bf16 v[228:231], a[228:231], a[76:79], v[228:231]
    v_exp_f32 v202, v202
    v_mfma_f32_16x16x32_bf16 v[228:231], a[232:235], a[80:83], v[228:231]
    s_waitcnt lgkmcnt(0)
    v_cvt_pk_bf16_f32 v124, v236, v237
    v_cvt_pk_bf16_f32 v125, v238, v239
    v_mfma_f32_16x16x32_bf16 v[196:199], v[126:129], v[174:177], v[196:199]
    v_exp_f32 v203, v203
    v_mfma_f32_16x16x32_bf16 v[196:199], v[128:131], v[176:179], v[196:199]
    v_cvt_pk_bf16_f32 v193, v200, v201
    v_cvt_pk_bf16_f32 v180, v202, v203
    v_mfma_f32_16x16x32_bf16 v[228:231], a[236:239], a[84:87], v[228:231]
    ds_read_b128 v[200:203], v245 offset:64
    v_sub_f32 v204, v204, v248
    v_mfma_f32_16x16x32_bf16 v[228:231], a[240:243], a[88:91], v[228:231]
    v_exp_f32 v204, v204
    v_mfma_f32_16x16x32_bf16 v[228:231], a[244:247], a[92:95], v[228:231]
    v_sub_f32 v205, v205, v248
    v_sub_f32 v206, v206, v248
    v_mfma_f32_16x16x32_bf16 v[232:235], a[224:227], a[96:99], 0
    v_exp_f32 v205, v205
    v_mfma_f32_16x16x32_bf16 v[232:235], a[228:231], a[100:103], v[232:235]
    v_exp_f32 v206, v206
    v_mfma_f32_16x16x32_bf16 v[232:235], a[232:235], a[104:107], v[232:235]
    v_sub_f32 v207, v207, v248
    v_cvt_pk_bf16_f32 v24, v228, v229
    v_mfma_f32_16x16x32_bf16 v[232:235], a[236:239], a[108:111], v[232:235]
    v_cvt_pk_bf16_f32 v27, v230, v231
    v_mbcnt_lo_u32_b32 v228, -1, 0
    v_mfma_f32_16x16x32_bf16 v[232:235], a[240:243], a[112:115], v[232:235]
    v_mbcnt_hi_u32_b32 v228, -1, v228
    v_lshrrev_b32 v229, 1, v228
    v_mfma_f32_16x16x32_bf16 v[232:235], a[244:247], a[116:119], v[232:235]
    v_add_u32 v229, 64, v229
    v_mul_u32_u24 v230, 43, v229
    v_mfma_f32_16x16x32_bf16 v[236:239], a[224:227], a[120:123], 0
    ds_read_b128 a[224:227], v242 offset:3200
    v_lshrrev_b32 v231, 8, v230
    v_mfma_f32_16x16x32_bf16 v[236:239], a[228:231], a[124:127], v[236:239]
    ds_read_b128 a[228:231], v243 offset:3200
    v_lshrrev_b32 v230, 7, v230
    v_mfma_f32_16x16x32_bf16 v[236:239], a[232:235], a[128:131], v[236:239]
    s_waitcnt lgkmcnt(2)
    v_cvt_pk_bf16_f32 v54, v232, v233
    v_cvt_pk_bf16_f32 v57, v234, v235
    v_mfma_f32_16x16x32_bf16 v[200:203], v[162:165], v[174:177], v[200:203]
    ds_read_b128 a[232:235], v242 offset:3328
    v_mad_i32_i24 v229, v230, -3, v229
    v_mfma_f32_16x16x32_bf16 v[200:203], v[164:167], v[176:179], v[200:203]
    v_and_b32 v231, 4, v231
    v_xor_b32 v230, v230, v231
    v_mfma_f32_16x16x32_bf16 v[236:239], a[236:239], a[132:135], v[236:239]
    ds_read_b128 a[236:239], v243 offset:3328
    v_and_b32 v231, 4, v230
    v_mfma_f32_16x16x32_bf16 v[236:239], a[240:243], a[136:139], v[236:239]
    ds_read_b128 a[240:243], v240 offset:1536
    v_mul_u32_u24 v251, 24, v231
    v_mfma_f32_16x16x32_bf16 v[236:239], a[244:247], a[140:143], v[236:239]
    ds_read_b128 a[244:247], v241 offset:1536
    v_lshrrev_b32 v231, 3, v230
    v_mfma_f32_16x16x32_bf16 v[232:235], a[144:147], a[216:219], 0
    v_lshl_add_u32 v251, v231, 2, v251
    v_and_or_b32 v251, v230, 3, v251
    v_mfma_f32_16x16x32_bf16 v[232:235], a[148:151], a[220:223], v[232:235]
    s_waitcnt lgkmcnt(5)
    v_mad_u32_u24 v251, v251, 3, v229
    v_cvt_pk_bf16_f32 v84, v236, v237
    v_mfma_f32_16x16x32_bf16 v[232:235], a[152:155], a[224:227], v[232:235]
    s_waitcnt lgkmcnt(4)
    v_cvt_pk_bf16_f32 v87, v238, v239
    v_and_b32 v231, 1, v228
    v_mfma_f32_16x16x32_bf16 v[232:235], a[156:159], a[228:231], v[232:235]
    v_lshl_add_u32 v251, v251, 3, v231
    v_lshlrev_b32 v251, 4, v251
    v_mfma_f32_16x16x32_bf16 v[236:239], a[168:171], a[216:219], 0
    s_waitcnt lgkmcnt(3)
    v_add_u32 v251, 0xfffff800, v251
    v_cvt_pk_bf16_f32 v194, v204, v205
    v_mfma_f32_16x16x32_bf16 v[232:235], a[160:163], a[232:235], v[232:235]
    v_exp_f32 v207, v207
    v_mfma_f32_16x16x32_bf16 v[236:239], a[172:175], a[220:223], v[236:239]
    s_waitcnt lgkmcnt(2)
    s_barrier
    v_mfma_f32_16x16x32_bf16 v[232:235], a[164:167], a[236:239], v[232:235]
    buffer_load_dwordx4 v252, s[12:15], s62 offen lds
    v_cvt_pk_bf16_f32 v181, v206, v207
    v_mfma_f32_16x16x32_bf16 v[236:239], a[176:179], a[224:227], v[236:239]
    ds_read_b128 v[204:207], v246 offset:64
    v_sub_f32 v208, v208, v248
    v_mfma_f32_16x16x32_bf16 v[236:239], a[180:183], a[228:231], v[236:239]
    s_waitcnt lgkmcnt(1)
    v_exp_f32 v208, v208
    v_mfma_f32_16x16x32_bf16 v[236:239], a[184:187], a[232:235], v[236:239]
    v_mul_f32 v232, s38, v232
    v_mul_f32 v233, s38, v233
    v_mfma_f32_16x16x32_bf16 v[236:239], a[188:191], a[236:239], v[236:239]
    buffer_load_dwordx4 v253, s[12:15], s62 offen offset:1024 lds
    v_mul_f32 v234, s38, v234
    v_mfma_f32_16x16x32_bf16 v[228:231], a[192:195], a[216:219], 0
    v_mul_f32 v235, s38, v235
    v_cvt_pk_bf16_f32 v232, v232, v233
    v_mfma_f32_16x16x32_bf16 v[228:231], a[196:199], a[220:223], v[228:231]
    ds_read_b128 a[216:219], v240 offset:1664
    v_cvt_pk_bf16_f32 v233, v234, v235
    v_mfma_f32_16x16x32_bf16 v[228:231], a[200:203], a[224:227], v[228:231]
    ds_write_b64 v247, v[232:233] offset:55296
    v_mfma_f32_16x16x32_bf16 v[228:231], a[204:207], a[228:231], v[228:231]
    buffer_load_dwordx4 v251, s[12:15], s62 offen offset:2048 lds
    s_add_u32 m0, s46, 0x17400
    v_mfma_f32_16x16x32_bf16 v[228:231], a[208:211], a[232:235], v[228:231]
    s_lshl_b32 s62, s28, 5
    s_add_u32 s62, s62, 0x3000
    v_mul_f32 v236, s3, v236
    v_mfma_f32_16x16x32_bf16 v[228:231], a[212:215], a[236:239], v[228:231]
    s_waitcnt lgkmcnt(2)
    v_mul_f32 v237, s3, v237
    v_mul_f32 v238, s3, v238
    v_mfma_f32_16x16x32_bf16 v[204:207], v[138:141], v[174:177], v[204:207]
    v_mul_f32 v239, s3, v239
    v_cvt_pk_bf16_f32 v236, v236, v237
    v_mfma_f32_16x16x32_bf16 v[204:207], v[140:143], v[176:179], v[204:207]
    buffer_load_dwordx4 v252, s[12:15], s63 offen lds
    v_cvt_pk_bf16_f32 v237, v238, v239
    v_mfma_f32_16x16x32_bf16 v[232:235], a[0:3], a[240:243], 0
    ds_write_b64 v247, v[236:237] offset:55424
    v_mfma_f32_16x16x32_bf16 v[232:235], a[4:7], a[244:247], v[232:235]
    s_waitcnt lgkmcnt(2)
    v_mul_f32 v228, s38, v228
    v_mul_f32 v229, s38, v229
    v_mfma_f32_16x16x32_bf16 v[232:235], a[8:11], a[216:219], v[232:235]
    v_mul_f32 v230, s38, v230
    v_mul_f32 v231, s38, v231
    v_mfma_f32_16x16x32_bf16 v[236:239], a[24:27], a[240:243], 0
    buffer_load_dwordx4 v253, s[12:15], s63 offen offset:1024 lds
    v_cvt_pk_bf16_f32 v228, v228, v229
    v_mfma_f32_16x16x32_bf16 v[236:239], a[28:31], a[244:247], v[236:239]
    ds_read_b128 a[220:223], v241 offset:1664
    v_cvt_pk_bf16_f32 v229, v230, v231
    v_mfma_f32_16x16x32_bf16 v[236:239], a[32:35], a[216:219], v[236:239]
    ds_write_b64 v247, v[228:229] offset:55552
    v_mfma_f32_16x16x32_bf16 v[228:231], a[48:51], a[240:243], 0
    ds_read_b128 a[224:227], v240 offset:1792
    buffer_load_dwordx4 v251, s[12:15], s63 offen offset:2048 lds
    v_mfma_f32_16x16x32_bf16 v[228:231], a[52:55], a[244:247], v[228:231]
    s_add_u32 m0, s46, 0x16800
    s_lshl_b32 s63, s28, 5
    s_add_u32 s63, s63, 0x7800
    v_mfma_f32_16x16x32_bf16 v[228:231], a[56:59], a[216:219], v[228:231]
    ds_read_b128 a[228:231], v241 offset:1792
    ds_read_b128 a[232:235], v240 offset:0
    ds_read_b128 a[236:239], v241 offset:0
    v_sub_f32 v209, v209, v248
    v_exp_f32 v209, v209
    v_sub_f32 v210, v210, v248
    v_exp_f32 v210, v210
    v_sub_f32 v211, v211, v248
    v_exp_f32 v211, v211
    s_waitcnt lgkmcnt(5)
    v_mfma_f32_16x16x32_bf16 v[232:235], a[12:15], a[220:223], v[232:235]
    v_cvt_pk_bf16_f32 v192, v208, v209
    v_cvt_pk_bf16_f32 v195, v210, v211
    v_mfma_f32_16x16x32_bf16 v[236:239], a[36:39], a[220:223], v[236:239]
    ds_read_b128 v[208:211], v244 offset:128
    v_sub_f32 v196, v196, v248
    v_mfma_f32_16x16x32_bf16 v[212:215], v[6:9], v[192:195], 0
    s_waitcnt lgkmcnt(4)
    v_exp_f32 v196, v196
    v_mfma_f32_16x16x32_bf16 v[216:219], v[36:39], v[192:195], 0
    v_sub_f32 v197, v197, v248
    v_sub_f32 v198, v198, v248
    v_mfma_f32_16x16x32_bf16 v[220:223], v[66:69], v[192:195], 0
    v_exp_f32 v197, v197
    v_mfma_f32_16x16x32_bf16 v[224:227], a[248:251], v[192:195], 0
    v_exp_f32 v198, v198
    v_mfma_f32_16x16x32_bf16 v[232:235], a[16:19], a[224:227], v[232:235]
    s_waitcnt lgkmcnt(3)
    v_sub_f32 v199, v199, v248
    v_cvt_pk_bf16_f32 v183, v196, v197
    v_mfma_f32_16x16x32_bf16 v[232:235], a[20:23], a[228:231], v[232:235]
    s_waitcnt lgkmcnt(2)
    v_exp_f32 v199, v199
    v_mfma_f32_16x16x32_bf16 v[236:239], a[40:43], a[224:227], v[236:239]
    s_waitcnt lgkmcnt(1)
    v_cvt_pk_bf16_f32 v186, v198, v199
    v_sub_f32 v200, v200, v248
    v_mfma_f32_16x16x32_bf16 v[236:239], a[44:47], a[228:231], v[236:239]
    ds_read_b128 v[196:199], v245 offset:128
    v_sub_f32 v201, v201, v248
    v_mfma_f32_16x16x32_bf16 v[228:231], a[60:63], a[220:223], v[228:231]
    s_waitcnt lgkmcnt(1)
    v_exp_f32 v200, v200
    v_mfma_f32_16x16x32_bf16 v[208:211], v[132:135], v[174:177], v[208:211]
    v_exp_f32 v201, v201
    v_mfma_f32_16x16x32_bf16 v[208:211], v[134:137], v[176:179], v[208:211]
    v_sub_f32 v202, v202, v248
    v_sub_f32 v203, v203, v248
    v_mfma_f32_16x16x32_bf16 v[228:231], a[64:67], a[224:227], v[228:231]
    v_exp_f32 v202, v202
    v_mfma_f32_16x16x32_bf16 v[228:231], a[68:71], a[228:231], v[228:231]
    v_exp_f32 v203, v203
    v_cvt_pk_bf16_f32 v184, v200, v201
    v_cvt_pk_bf16_f32 v187, v202, v203
    ds_read_b128 v[200:203], v246 offset:128
    v_sub_f32 v204, v204, v248
    v_exp_f32 v204, v204
    v_sub_f32 v205, v205, v248
    v_exp_f32 v205, v205
    s_waitcnt lgkmcnt(1)
    v_mfma_f32_16x16x32_bf16 v[196:199], v[102:105], v[174:177], v[196:199]
    v_sub_f32 v206, v206, v248
    v_sub_f32 v207, v207, v248
    v_mfma_f32_16x16x32_bf16 v[196:199], v[104:107], v[176:179], v[196:199]
    v_exp_f32 v206, v206
    v_exp_f32 v207, v207
    v_cvt_pk_bf16_f32 v182, v204, v205
    v_cvt_pk_bf16_f32 v185, v206, v207
    ds_read_b128 v[204:207], v244 offset:0
    v_mfma_f32_16x16x32_bf16 v[212:215], v[10:13], v[180:183], v[212:215]
    v_sub_f32 v208, v208, v248
    v_sub_f32 v209, v209, v248
    v_mfma_f32_16x16x32_bf16 v[216:219], v[40:43], v[180:183], v[216:219]
    v_exp_f32 v208, v208
    v_mfma_f32_16x16x32_bf16 v[220:223], v[70:73], v[180:183], v[220:223]
    s_waitcnt lgkmcnt(1)
    v_exp_f32 v209, v209
    v_mfma_f32_16x16x32_bf16 v[224:227], a[248:251], v[180:183], v[224:227]
    v_cvt_pk_bf16_f32 v189, v208, v209
    v_sub_f32 v196, v196, v248
    v_mfma_f32_16x16x32_bf16 v[212:215], v[14:17], v[184:187], v[212:215]
    ds_read_b128 v[208:211], v245 offset:0
    v_sub_f32 v197, v197, v248
    v_mfma_f32_16x16x32_bf16 v[216:219], v[44:47], v[184:187], v[216:219]
    v_exp_f32 v196, v196
    v_mfma_f32_16x16x32_bf16 v[220:223], v[74:77], v[184:187], v[220:223]
    v_exp_f32 v197, v197
    v_mfma_f32_16x16x32_bf16 v[224:227], a[248:251], v[184:187], v[224:227]
    v_cvt_pk_bf16_f32 v190, v196, v197
    s_waitcnt lgkmcnt(1)
    v_mfma_f32_16x16x32_bf16 v[200:203], v[114:117], v[174:177], v[200:203]
    ds_read_b128 v[196:199], v246 offset:0
    ds_read_b64 v[174:175], v247 offset:0
    v_mfma_f32_16x16x32_bf16 v[200:203], v[116:119], v[176:179], v[200:203]
    ds_read_b64 v[176:177], v247 offset:128
    ds_read_b64 v[178:179], v247 offset:256
    v_mfma_f32_16x16x32_bf16 v[204:207], v[126:129], v[168:171], v[204:207]
    v_mfma_f32_16x16x32_bf16 v[204:207], v[128:131], v[170:173], v[204:207]
    s_waitcnt vmcnt(3)
    ds_read_b64_tr_b16 a[144:145], v249 offset:0
    s_waitcnt lgkmcnt(5)
    v_mfma_f32_16x16x32_bf16 v[208:211], v[162:165], v[168:171], v[208:211]
    ds_read_b64_tr_b16 a[146:147], v250 offset:0
    ds_read_b64_tr_b16 a[168:169], v249 offset:32
    v_mfma_f32_16x16x32_bf16 v[208:211], v[164:167], v[170:173], v[208:211]
    ds_read_b64_tr_b16 a[170:171], v250 offset:32
    ds_read_b64_tr_b16 a[192:193], v249 offset:64
    ds_read_b64_tr_b16 a[194:195], v250 offset:64
    v_sub_f32 v200, v200, v248
    v_exp_f32 v200, v200
    s_waitcnt lgkmcnt(9)
    v_mfma_f32_16x16x32_bf16 v[196:199], v[138:141], v[168:171], v[196:199]
    v_sub_f32 v201, v201, v248
    v_max_f32 v248, v204, v205
    v_mfma_f32_16x16x32_bf16 v[196:199], v[140:143], v[170:173], v[196:199]
    v_exp_f32 v201, v201
    v_max3_f32 v248, v248, v206, v207
    ds_read_b128 v[204:207], v245 offset:64
    v_cvt_pk_bf16_f32 v188, v200, v201
    ds_read_b128 v[200:203], v244 offset:64
    v_max3_f32 v248, v248, v208, v209
    v_mfma_f32_16x16x32_bf16 v[212:215], v[18:21], v[188:191], v[212:215]
    s_waitcnt lgkmcnt(8)
    v_max3_f32 v248, v248, v210, v211
    v_max3_f32 v248, v248, v196, v197
    v_mfma_f32_16x16x32_bf16 v[216:219], v[48:51], v[188:191], v[216:219]
    ds_read_b128 v[208:211], v246 offset:64
    v_max3_f32 v248, v248, v198, v199
    v_mfma_f32_16x16x32_bf16 v[220:223], v[78:81], v[188:191], v[220:223]
    ds_read_b128 v[196:199], v244 offset:128
    s_waitcnt lgkmcnt(4)
    v_mfma_f32_16x16x32_bf16 v[224:227], a[248:251], v[188:191], v[224:227]
    buffer_load_dwordx4 v252, s[12:15], s60 offen lds
    s_waitcnt vmcnt(1)
    ds_read_b64_tr_b16 a[148:149], v249 offset:3072
    ds_read_b64_tr_b16 a[150:151], v250 offset:3072
    ds_read_b64_tr_b16 a[172:173], v249 offset:3104
    ds_read_b64_tr_b16 a[174:175], v250 offset:3104
    ds_read_b64_tr_b16 a[196:197], v249 offset:3136
    s_waitcnt lgkmcnt(8)
    v_mfma_f32_16x16x32_bf16 v[204:207], v[102:105], v[168:171], v[204:207]
    buffer_load_dwordx4 v253, s[12:15], s60 offen offset:1024 lds
    ds_read_b64_tr_b16 a[198:199], v250 offset:3136
    v_mfma_f32_16x16x32_bf16 v[204:207], v[104:107], v[170:173], v[204:207]
    s_waitcnt lgkmcnt(8)
    v_rcp_f32 v225, v224
    v_mfma_f32_16x16x32_bf16 v[200:203], v[132:135], v[168:171], v[200:203]
    v_mul_f32 v212, v212, v225
    v_mul_f32 v213, v213, v225
    v_mfma_f32_16x16x32_bf16 v[200:203], v[134:137], v[170:173], v[200:203]
    s_waitcnt lgkmcnt(7)
    v_mul_f32 v214, v214, v225
    v_mul_f32 v215, v215, v225
    v_mfma_f32_16x16x32_bf16 v[208:211], v[114:117], v[168:171], v[208:211]
    buffer_load_dwordx4 v251, s[12:15], s60 offen offset:2048 lds
    s_add_u32 m0, s46, 0x17400
    v_mfma_f32_16x16x32_bf16 v[208:211], v[116:119], v[170:173], v[208:211]
    s_waitcnt lgkmcnt(6)
    v_cvt_pk_bf16_f32 v212, v212, v213
    v_cvt_pk_bf16_f32 v213, v214, v215
    v_mfma_f32_16x16x32_bf16 v[196:199], v[144:147], v[168:171], v[196:199]
    ds_write_b64 v247, v[212:213] offset:12288
    v_mfma_f32_16x16x32_bf16 v[196:199], v[146:149], v[170:173], v[196:199]
    v_mul_f32 v216, v216, v225
    v_mul_f32 v217, v217, v225
    v_mul_f32 v218, v218, v225
    s_waitcnt lgkmcnt(1)
    buffer_load_dwordx4 v252, s[12:15], s61 offen lds
    v_mul_f32 v219, v219, v225
    v_cvt_pk_bf16_f32 v216, v216, v217
    v_cvt_pk_bf16_f32 v217, v218, v219
    ds_write_b64 v247, v[216:217] offset:12416
    v_mul_f32 v220, v220, v225
    v_mul_f32 v221, v221, v225
    v_mul_f32 v222, v222, v225
    v_mul_f32 v223, v223, v225
    v_cvt_pk_bf16_f32 v220, v220, v221
    buffer_load_dwordx4 v253, s[12:15], s61 offen offset:1024 lds
    v_cvt_pk_bf16_f32 v221, v222, v223
    ds_write_b64 v247, v[220:221] offset:12544
    v_max3_f32 v248, v248, v200, v201
    v_max3_f32 v248, v248, v202, v203
    ds_read_b128 v[200:203], v245 offset:128
    v_max3_f32 v248, v248, v204, v205
    v_max3_f32 v248, v248, v206, v207
    buffer_load_dwordx4 v251, s[12:15], s61 offen offset:2048 lds
    s_add_u32 m0, s46, 0x16800
    ds_read_b128 v[204:207], v246 offset:128
    v_max3_f32 v248, v248, v208, v209
    v_max3_f32 v248, v248, v210, v211
    ds_read_b128 v[208:211], v244 offset:0
    v_max3_f32 v248, v248, v196, v197
    ds_read_b128 v[196:199], v245 offset:0
    s_waitcnt lgkmcnt(3)
    v_mfma_f32_16x16x32_bf16 v[200:203], v[108:111], v[168:171], v[200:203]
    v_mfma_f32_16x16x32_bf16 v[200:203], v[110:113], v[170:173], v[200:203]
    s_nop 7
    s_waitcnt lgkmcnt(1)
    v_mfma_f32_16x16x32_bf16 v[204:207], v[120:123], v[168:171], v[204:207]
    v_max3_f32 v248, v248, v200, v201
    s_waitcnt lgkmcnt(0)
    v_mfma_f32_16x16x32_bf16 v[204:207], v[122:125], v[170:173], v[204:207]
    ds_read_b128 v[200:203], v246 offset:0
    v_mfma_f32_16x16x32_bf16 v[208:211], v[126:129], v[168:171], v[208:211]
    v_cvt_pk_bf16_f32 v126, v232, v233
    v_cvt_pk_bf16_f32 v127, v234, v235
    v_mfma_f32_16x16x32_bf16 v[208:211], v[128:131], v[170:173], v[208:211]
    v_cvt_pk_bf16_f32 v128, v236, v237
    v_cvt_pk_bf16_f32 v129, v238, v239
    v_mfma_f32_16x16x32_bf16 v[196:199], v[162:165], v[168:171], v[196:199]
    v_cvt_pk_bf16_f32 v130, v228, v229
    v_cvt_pk_bf16_f32 v131, v230, v231
    v_mfma_f32_16x16x32_bf16 v[196:199], v[164:167], v[170:173], v[196:199]
    v_max3_f32 v248, v248, v204, v205
    v_mov_b32 v225, v248
    v_mfma_f32_16x16x32_bf16 v[232:235], a[240:243], a[72:75], 0
    ds_read_b128 v[204:207], v244 offset:64
    v_permlane16_swap_b32 v248, v225
    v_mfma_f32_16x16x32_bf16 v[232:235], a[244:247], a[76:79], v[232:235]
    v_max_f32 v248, v248, v225
    v_mov_b32 v225, v248
    v_mfma_f32_16x16x32_bf16 v[232:235], a[216:219], a[80:83], v[232:235]
    v_mfma_f32_16x16x32_bf16 v[232:235], a[220:223], a[84:87], v[232:235]
    v_permlane32_swap_b32 v248, v225
    v_max_f32 v248, v248, v225
    v_mfma_f32_16x16x32_bf16 v[232:235], a[224:227], a[88:91], v[232:235]
    s_waitcnt lgkmcnt(1)
    v_sub_f32 v208, v208, v248
    v_sub_f32 v209, v209, v248
    v_mfma_f32_16x16x32_bf16 v[200:203], v[138:141], v[168:171], v[200:203]
    v_exp_f32 v208, v208
    v_mfma_f32_16x16x32_bf16 v[200:203], v[140:143], v[170:173], v[200:203]
    v_exp_f32 v209, v209
    v_mfma_f32_16x16x32_bf16 v[232:235], a[228:231], a[92:95], v[232:235]
    v_sub_f32 v210, v210, v248
    v_sub_f32 v211, v211, v248
    v_mfma_f32_16x16x32_bf16 v[236:239], a[240:243], a[96:99], 0
    v_exp_f32 v210, v210
    v_mfma_f32_16x16x32_bf16 v[236:239], a[244:247], a[100:103], v[236:239]
    s_waitcnt lgkmcnt(0)
    v_exp_f32 v211, v211
    v_mfma_f32_16x16x32_bf16 v[204:207], v[132:135], v[168:171], v[204:207]
    v_cvt_pk_bf16_f32 v7, v232, v233
    v_cvt_pk_bf16_f32 v10, v234, v235
    v_mfma_f32_16x16x32_bf16 v[204:207], v[134:137], v[170:173], v[204:207]
    v_cvt_pk_bf16_f32 v193, v208, v209
    v_cvt_pk_bf16_f32 v180, v210, v211
    v_mfma_f32_16x16x32_bf16 v[236:239], a[216:219], a[104:107], v[236:239]
    ds_read_b128 v[208:211], v245 offset:64
    v_sub_f32 v196, v196, v248
    v_mfma_f32_16x16x32_bf16 v[236:239], a[220:223], a[108:111], v[236:239]
    v_exp_f32 v196, v196
    v_mfma_f32_16x16x32_bf16 v[236:239], a[224:227], a[112:115], v[236:239]
    v_sub_f32 v197, v197, v248
    v_sub_f32 v198, v198, v248
    v_mfma_f32_16x16x32_bf16 v[236:239], a[228:231], a[116:119], v[236:239]
    v_exp_f32 v197, v197
    v_mfma_f32_16x16x32_bf16 v[228:231], a[240:243], a[120:123], 0
    ds_read_b128 a[240:243], v240 offset:128
    v_sub_f32 v199, v199, v248
    v_mfma_f32_16x16x32_bf16 v[228:231], a[244:247], a[124:127], v[228:231]
    ds_read_b128 a[244:247], v241 offset:128
    v_cvt_pk_bf16_f32 v194, v196, v197
    v_mfma_f32_16x16x32_bf16 v[228:231], a[216:219], a[128:131], v[228:231]
    v_cvt_pk_bf16_f32 v37, v236, v237
    v_cvt_pk_bf16_f32 v40, v238, v239
    v_mfma_f32_16x16x32_bf16 v[228:231], a[220:223], a[132:135], v[228:231]
    ds_read_b128 a[216:219], v240 offset:256
    ds_read_b128 a[220:223], v241 offset:256
    v_mfma_f32_16x16x32_bf16 v[228:231], a[224:227], a[136:139], v[228:231]
    ds_read_b128 a[224:227], v240 offset:3072
    v_sub_f32 v200, v200, v248
    v_mfma_f32_16x16x32_bf16 v[228:231], a[228:231], a[140:143], v[228:231]
    ds_read_b128 a[228:231], v241 offset:3072
    s_waitcnt vmcnt(3) lgkmcnt(6)
    v_mfma_f32_16x16x32_bf16 v[208:211], v[102:105], v[168:171], v[208:211]
    ds_read_b64_tr_b16 a[152:153], v249 offset:0
    ds_read_b64_tr_b16 a[154:155], v250 offset:0
    v_mfma_f32_16x16x32_bf16 v[208:211], v[104:107], v[170:173], v[208:211]
    ds_read_b64_tr_b16 a[176:177], v249 offset:32
    ds_read_b64_tr_b16 a[178:179], v250 offset:32
    v_mfma_f32_16x16x32_bf16 v[232:235], a[0:3], a[232:235], 0
    ds_read_b64_tr_b16 a[200:201], v249 offset:64
    ds_read_b64_tr_b16 a[202:203], v250 offset:64
    v_mfma_f32_16x16x32_bf16 v[232:235], a[4:7], a[236:239], v[232:235]
    s_waitcnt lgkmcnt(11)
    v_cvt_pk_bf16_f32 v67, v228, v229
    v_cvt_pk_bf16_f32 v70, v230, v231
    v_mfma_f32_16x16x32_bf16 v[232:235], a[8:11], a[240:243], v[232:235]
    s_waitcnt lgkmcnt(10)
    v_exp_f32 v198, v198
    v_mfma_f32_16x16x32_bf16 v[232:235], a[12:15], a[244:247], v[232:235]
    s_waitcnt lgkmcnt(9)
    v_exp_f32 v199, v199
    v_mfma_f32_16x16x32_bf16 v[232:235], a[16:19], a[216:219], v[232:235]
    s_waitcnt lgkmcnt(8)
    v_cvt_pk_bf16_f32 v181, v198, v199
    v_sub_f32 v201, v201, v248
    v_mfma_f32_16x16x32_bf16 v[232:235], a[20:23], a[220:223], v[232:235]
    ds_read_b128 v[196:199], v246 offset:64
    v_sub_f32 v202, v202, v248
    v_mfma_f32_16x16x32_bf16 v[236:239], a[24:27], a[232:235], 0
    s_waitcnt lgkmcnt(8)
    v_exp_f32 v200, v200
    v_mfma_f32_16x16x32_bf16 v[236:239], a[28:31], a[236:239], v[236:239]
    s_waitcnt lgkmcnt(6)
    v_exp_f32 v201, v201
    v_mfma_f32_16x16x32_bf16 v[236:239], a[32:35], a[240:243], v[236:239]
    s_waitcnt lgkmcnt(4)
    v_exp_f32 v202, v202
    v_mfma_f32_16x16x32_bf16 v[236:239], a[36:39], a[244:247], v[236:239]
    s_waitcnt lgkmcnt(1)
    buffer_load_dwordx4 v252, s[12:15], s62 offen lds
    v_mfma_f32_16x16x32_bf16 v[236:239], a[40:43], a[216:219], v[236:239]
    s_waitcnt vmcnt(1)
    ds_read_b64_tr_b16 a[156:157], v249 offset:3072
    v_mfma_f32_16x16x32_bf16 v[236:239], a[44:47], a[220:223], v[236:239]
    ds_read_b64_tr_b16 a[158:159], v250 offset:3072
    ds_read_b64_tr_b16 a[180:181], v249 offset:3104
    v_mfma_f32_16x16x32_bf16 v[228:231], a[48:51], a[232:235], 0
    ds_read_b64_tr_b16 a[182:183], v250 offset:3104
    ds_read_b64_tr_b16 a[204:205], v249 offset:3136
    v_mfma_f32_16x16x32_bf16 v[228:231], a[52:55], a[236:239], v[228:231]
    buffer_load_dwordx4 v253, s[12:15], s62 offen offset:1024 lds
    ds_read_b64_tr_b16 a[206:207], v250 offset:3136
    v_mfma_f32_16x16x32_bf16 v[228:231], a[56:59], a[240:243], v[228:231]
    s_waitcnt lgkmcnt(6)
    v_sub_f32 v203, v203, v248
    v_cvt_pk_bf16_f32 v192, v200, v201
    v_mfma_f32_16x16x32_bf16 v[196:199], v[114:117], v[168:171], v[196:199]
    v_exp_f32 v203, v203
    v_mfma_f32_16x16x32_bf16 v[196:199], v[116:119], v[170:173], v[196:199]
    v_cvt_pk_bf16_f32 v195, v202, v203
    v_sub_f32 v204, v204, v248
    v_mfma_f32_16x16x32_bf16 v[228:231], a[60:63], a[244:247], v[228:231]
    buffer_load_dwordx4 v251, s[12:15], s62 offen offset:2048 lds
    s_add_u32 m0, s46, 0x17400
    v_mfma_f32_16x16x32_bf16 v[212:215], v[12:15], v[192:195], 0
    ds_read_b128 v[200:203], v244 offset:128
    v_sub_f32 v205, v205, v248
    v_mfma_f32_16x16x32_bf16 v[216:219], v[42:45], v[192:195], 0
    s_waitcnt lgkmcnt(6)
    v_exp_f32 v204, v204
    v_mfma_f32_16x16x32_bf16 v[220:223], v[72:75], v[192:195], 0
    s_waitcnt lgkmcnt(5)
    v_exp_f32 v205, v205
    v_mfma_f32_16x16x32_bf16 v[224:227], a[248:251], v[192:195], 0
    s_waitcnt lgkmcnt(3)
    s_waitcnt lgkmcnt(1)
    buffer_load_dwordx4 v252, s[12:15], s63 offen lds
    v_mfma_f32_16x16x32_bf16 v[228:231], a[64:67], a[216:219], v[228:231]
    v_sub_f32 v206, v206, v248
    v_sub_f32 v207, v207, v248
    v_mfma_f32_16x16x32_bf16 v[228:231], a[68:71], a[220:223], v[228:231]
    v_exp_f32 v206, v206
    v_exp_f32 v207, v207
    v_cvt_pk_bf16_f32 v183, v204, v205
    v_cvt_pk_bf16_f32 v186, v206, v207
    ds_read_b128 v[204:207], v245 offset:128
    buffer_load_dwordx4 v253, s[12:15], s63 offen offset:1024 lds
    s_waitcnt lgkmcnt(1)
    v_mfma_f32_16x16x32_bf16 v[200:203], v[144:147], v[168:171], v[200:203]
    v_sub_f32 v208, v208, v248
    v_sub_f32 v209, v209, v248
    v_mfma_f32_16x16x32_bf16 v[200:203], v[146:149], v[170:173], v[200:203]
    v_exp_f32 v208, v208
    v_exp_f32 v209, v209
    v_sub_f32 v210, v210, v248
    v_exp_f32 v210, v210
    buffer_load_dwordx4 v251, s[12:15], s63 offen offset:2048 lds
    v_sub_f32 v211, v211, v248
    v_exp_f32 v211, v211
    v_cvt_pk_bf16_f32 v184, v208, v209
    v_cvt_pk_bf16_f32 v187, v210, v211
    ds_read_b128 v[208:211], v246 offset:128
    v_sub_f32 v196, v196, v248
    v_exp_f32 v196, v196
    v_sub_f32 v197, v197, v248
    s_waitcnt lgkmcnt(1)
    v_mfma_f32_16x16x32_bf16 v[204:207], v[108:111], v[168:171], v[204:207]
    v_exp_f32 v197, v197
    v_mfma_f32_16x16x32_bf16 v[204:207], v[110:113], v[170:173], v[204:207]
    v_sub_f32 v198, v198, v248
    v_exp_f32 v198, v198
    v_sub_f32 v199, v199, v248
    v_exp_f32 v199, v199
    v_cvt_pk_bf16_f32 v182, v196, v197
    v_cvt_pk_bf16_f32 v185, v198, v199
    ds_read_b128 v[196:199], v244 offset:32
    v_mfma_f32_16x16x32_bf16 v[212:215], v[16:19], v[180:183], v[212:215]
    v_sub_f32 v200, v200, v248
    v_sub_f32 v201, v201, v248
    v_mfma_f32_16x16x32_bf16 v[216:219], v[46:49], v[180:183], v[216:219]
    v_exp_f32 v200, v200
    v_mfma_f32_16x16x32_bf16 v[220:223], v[76:79], v[180:183], v[220:223]
    s_waitcnt lgkmcnt(1)
    v_exp_f32 v201, v201
    v_mfma_f32_16x16x32_bf16 v[224:227], a[248:251], v[180:183], v[224:227]
    v_cvt_pk_bf16_f32 v189, v200, v201
    v_sub_f32 v204, v204, v248
    v_mfma_f32_16x16x32_bf16 v[212:215], v[20:23], v[184:187], v[212:215]
    ds_read_b128 v[200:203], v245 offset:32
    v_sub_f32 v205, v205, v248
    v_mfma_f32_16x16x32_bf16 v[216:219], v[50:53], v[184:187], v[216:219]
    v_exp_f32 v204, v204
    v_mfma_f32_16x16x32_bf16 v[220:223], v[80:83], v[184:187], v[220:223]
    v_exp_f32 v205, v205
    v_mfma_f32_16x16x32_bf16 v[224:227], a[248:251], v[184:187], v[224:227]
    v_cvt_pk_bf16_f32 v190, v204, v205
    s_waitcnt lgkmcnt(1)
    v_mfma_f32_16x16x32_bf16 v[208:211], v[120:123], v[168:171], v[208:211]
    ds_read_b128 v[204:207], v246 offset:32
    ds_read_b64 v[168:169], v247 offset:24576
    v_mfma_f32_16x16x32_bf16 v[208:211], v[122:125], v[170:173], v[208:211]
    ds_read_b64 v[170:171], v247 offset:24704
    ds_read_b64 v[172:173], v247 offset:24832
    v_mfma_f32_16x16x32_bf16 v[196:199], v[132:135], v[174:177], v[196:199]
    v_mfma_f32_16x16x32_bf16 v[196:199], v[134:137], v[176:179], v[196:199]
    s_nop 3
    s_waitcnt lgkmcnt(4)
    v_mfma_f32_16x16x32_bf16 v[200:203], v[102:105], v[174:177], v[200:203]
    v_sub_f32 v208, v208, v248
    v_sub_f32 v209, v209, v248
    v_mfma_f32_16x16x32_bf16 v[200:203], v[104:107], v[176:179], v[200:203]
    v_exp_f32 v208, v208
    v_exp_f32 v209, v209
    v_max_f32 v248, v196, v197
    v_cvt_pk_bf16_f32 v188, v208, v209
    ds_read_b128 v[208:211], v244 offset:96
    s_waitcnt lgkmcnt(4)
    v_mfma_f32_16x16x32_bf16 v[212:215], v[24:27], v[188:191], v[212:215]
    v_max3_f32 v248, v248, v198, v199
    v_max3_f32 v248, v248, v200, v201
    v_mfma_f32_16x16x32_bf16 v[216:219], v[54:57], v[188:191], v[216:219]
    ds_read_b128 v[196:199], v245 offset:96
    v_max3_f32 v248, v248, v202, v203
    v_mfma_f32_16x16x32_bf16 v[220:223], v[84:87], v[188:191], v[220:223]
    ds_read_b128 v[200:203], v246 offset:96
    v_mfma_f32_16x16x32_bf16 v[224:227], a[248:251], v[188:191], v[224:227]
    s_waitcnt lgkmcnt(3)
    v_mfma_f32_16x16x32_bf16 v[204:207], v[114:117], v[174:177], v[204:207]
    v_mfma_f32_16x16x32_bf16 v[204:207], v[116:119], v[176:179], v[204:207]
    s_nop 4
    v_rcp_f32 v225, v224
    s_nop 0
    v_mul_f32 v212, v212, v225
    s_waitcnt lgkmcnt(2)
    v_mfma_f32_16x16x32_bf16 v[208:211], v[144:147], v[174:177], v[208:211]
    v_mul_f32 v213, v213, v225
    v_mul_f32 v214, v214, v225
    v_mfma_f32_16x16x32_bf16 v[208:211], v[146:149], v[176:179], v[208:211]
    v_mul_f32 v215, v215, v225
    s_waitcnt lgkmcnt(1)
    v_mfma_f32_16x16x32_bf16 v[196:199], v[108:111], v[174:177], v[196:199]
    v_cvt_pk_bf16_f32 v212, v212, v213
    v_cvt_pk_bf16_f32 v213, v214, v215
    v_mfma_f32_16x16x32_bf16 v[196:199], v[110:113], v[176:179], v[196:199]
    s_waitcnt lgkmcnt(0)
    v_mul_f32 v216, v216, v225
    v_mul_f32 v217, v217, v225
    v_mfma_f32_16x16x32_bf16 v[200:203], v[120:123], v[174:177], v[200:203]
    ds_write_b64 v247, v[212:213] offset:18432
    v_mfma_f32_16x16x32_bf16 v[200:203], v[122:125], v[176:179], v[200:203]
    s_waitcnt vmcnt(3)
    ds_read_b64_tr_b16 a[160:161], v249 offset:0
    ds_read_b64_tr_b16 a[162:163], v250 offset:0
    ds_read_b64_tr_b16 a[184:185], v249 offset:32
    ds_read_b64_tr_b16 a[186:187], v250 offset:32
    ds_read_b64_tr_b16 a[208:209], v249 offset:64
    ds_read_b64_tr_b16 a[210:211], v250 offset:64
    v_mul_f32 v218, v218, v225
    v_mul_f32 v219, v219, v225
    v_cvt_pk_bf16_f32 v216, v216, v217
    v_cvt_pk_bf16_f32 v217, v218, v219
    ds_write_b64 v247, v[216:217] offset:18560
    v_mul_f32 v220, v220, v225
    v_mul_f32 v221, v221, v225
    v_mul_f32 v222, v222, v225
    v_mul_f32 v223, v223, v225
    v_cvt_pk_bf16_f32 v220, v220, v221
    v_cvt_pk_bf16_f32 v221, v222, v223
    ds_write_b64 v247, v[220:221] offset:18688
    v_max3_f32 v248, v248, v204, v205
    v_max3_f32 v248, v248, v206, v207
    ds_read_b128 v[204:207], v244 offset:32
    v_max3_f32 v248, v248, v208, v209
    v_max3_f32 v248, v248, v210, v211
    ds_read_b128 v[208:211], v245 offset:32
    v_max3_f32 v248, v248, v196, v197
    v_max3_f32 v248, v248, v198, v199
    ds_read_b128 v[196:199], v246 offset:32
    v_max3_f32 v248, v248, v200, v201
    s_waitcnt vmcnt(0)
    ds_read_b64_tr_b16 a[164:165], v249 offset:3072
    ds_read_b64_tr_b16 a[166:167], v250 offset:3072
    ds_read_b64_tr_b16 a[188:189], v249 offset:3104
    ds_read_b64_tr_b16 a[190:191], v250 offset:3104
    ds_read_b64_tr_b16 a[212:213], v249 offset:3136
    ds_read_b64_tr_b16 a[214:215], v250 offset:3136
    v_max3_f32 v248, v248, v202, v203
    ds_read_b128 v[200:203], v244 offset:96
    v_mov_b32 v225, v248
    s_nop 1
    s_waitcnt lgkmcnt(9)
    v_mfma_f32_16x16x32_bf16 v[204:207], v[132:135], v[174:177], v[204:207]
    v_cvt_pk_bf16_f32 v132, v232, v233
    v_cvt_pk_bf16_f32 v133, v234, v235
    v_mfma_f32_16x16x32_bf16 v[204:207], v[134:137], v[176:179], v[204:207]
    s_waitcnt lgkmcnt(8)
    v_cvt_pk_bf16_f32 v134, v236, v237
    v_cvt_pk_bf16_f32 v135, v238, v239
    v_mfma_f32_16x16x32_bf16 v[208:211], v[102:105], v[174:177], v[208:211]
    s_waitcnt lgkmcnt(7)
    v_cvt_pk_bf16_f32 v136, v228, v229
    v_cvt_pk_bf16_f32 v137, v230, v231
    v_mfma_f32_16x16x32_bf16 v[208:211], v[104:107], v[176:179], v[208:211]
    v_permlane16_swap_b32 v248, v225
    v_max_f32 v248, v248, v225
    v_mfma_f32_16x16x32_bf16 v[196:199], v[114:117], v[174:177], v[196:199]
    v_mov_b32 v225, v248
    v_mfma_f32_16x16x32_bf16 v[196:199], v[116:119], v[176:179], v[196:199]
    s_waitcnt lgkmcnt(5)
    v_permlane32_swap_b32 v248, v225
    s_waitcnt lgkmcnt(1)
    v_mfma_f32_16x16x32_bf16 v[232:235], a[232:235], a[72:75], 0
    s_barrier
    v_mfma_f32_16x16x32_bf16 v[232:235], a[236:239], a[76:79], v[232:235]
    s_waitcnt lgkmcnt(0)
    v_max_f32 v248, v248, v225
    v_sub_f32 v204, v204, v248
    v_mfma_f32_16x16x32_bf16 v[200:203], v[144:147], v[174:177], v[200:203]
    v_exp_f32 v204, v204
    v_mfma_f32_16x16x32_bf16 v[200:203], v[146:149], v[176:179], v[200:203]
    v_sub_f32 v205, v205, v248
    v_sub_f32 v206, v206, v248
    v_mfma_f32_16x16x32_bf16 v[232:235], a[240:243], a[80:83], v[232:235]
    v_exp_f32 v205, v205
    v_mfma_f32_16x16x32_bf16 v[232:235], a[244:247], a[84:87], v[232:235]
    v_exp_f32 v206, v206
    v_mfma_f32_16x16x32_bf16 v[232:235], a[216:219], a[88:91], v[232:235]
    v_sub_f32 v207, v207, v248
    v_cvt_pk_bf16_f32 v193, v204, v205
    v_mfma_f32_16x16x32_bf16 v[232:235], a[220:223], a[92:95], v[232:235]
    v_exp_f32 v207, v207
    v_mfma_f32_16x16x32_bf16 v[236:239], a[232:235], a[96:99], 0
    v_cvt_pk_bf16_f32 v180, v206, v207
    v_sub_f32 v208, v208, v248
    v_mfma_f32_16x16x32_bf16 v[236:239], a[236:239], a[100:103], v[236:239]
    ds_read_b128 v[204:207], v245 offset:96
    v_sub_f32 v209, v209, v248
    v_mfma_f32_16x16x32_bf16 v[236:239], a[240:243], a[104:107], v[236:239]
    v_cvt_pk_bf16_f32 v1, v232, v233
    v_cvt_pk_bf16_f32 v4, v234, v235
    v_mfma_f32_16x16x32_bf16 v[236:239], a[244:247], a[108:111], v[236:239]
    v_exp_f32 v208, v208
    v_mfma_f32_16x16x32_bf16 v[236:239], a[216:219], a[112:115], v[236:239]
    v_exp_f32 v209, v209
    v_mfma_f32_16x16x32_bf16 v[236:239], a[220:223], a[116:119], v[236:239]
    v_sub_f32 v210, v210, v248
    v_sub_f32 v211, v211, v248
    v_mfma_f32_16x16x32_bf16 v[228:231], a[232:235], a[120:123], 0
    ds_read_b128 a[232:235], v240 offset:3200
    v_cvt_pk_bf16_f32 v194, v208, v209
    v_mfma_f32_16x16x32_bf16 v[228:231], a[236:239], a[124:127], v[228:231]
    ds_read_b128 a[236:239], v241 offset:3200
    v_sub_f32 v196, v196, v248
    v_mfma_f32_16x16x32_bf16 v[228:231], a[240:243], a[128:131], v[228:231]
    v_cvt_pk_bf16_f32 v31, v236, v237
    v_cvt_pk_bf16_f32 v34, v238, v239
    v_mfma_f32_16x16x32_bf16 v[228:231], a[244:247], a[132:135], v[228:231]
    ds_read_b128 a[240:243], v240 offset:3328
    ds_read_b128 a[244:247], v241 offset:3328
    v_mfma_f32_16x16x32_bf16 v[228:231], a[216:219], a[136:139], v[228:231]
    ds_read_b128 a[216:219], v240 offset:4608
    v_sub_f32 v197, v197, v248
    v_mfma_f32_16x16x32_bf16 v[228:231], a[220:223], a[140:143], v[228:231]
    ds_read_b128 a[220:223], v241 offset:4608
    v_sub_f32 v198, v198, v248
    v_mfma_f32_16x16x32_bf16 v[232:235], a[0:3], a[224:227], 0
    s_waitcnt lgkmcnt(6)
    v_exp_f32 v210, v210
    v_mfma_f32_16x16x32_bf16 v[204:207], v[108:111], v[174:177], v[204:207]
    v_exp_f32 v211, v211
    v_mfma_f32_16x16x32_bf16 v[204:207], v[110:113], v[176:179], v[204:207]
    v_cvt_pk_bf16_f32 v61, v228, v229
    v_cvt_pk_bf16_f32 v64, v230, v231
    v_mfma_f32_16x16x32_bf16 v[232:235], a[4:7], a[228:231], v[232:235]
    s_waitcnt lgkmcnt(5)
    v_cvt_pk_bf16_f32 v181, v210, v211
    v_sub_f32 v199, v199, v248
    v_mfma_f32_16x16x32_bf16 v[232:235], a[8:11], a[232:235], v[232:235]
    ds_read_b128 v[208:211], v246 offset:96
    v_sub_f32 v200, v200, v248
    v_mfma_f32_16x16x32_bf16 v[236:239], a[24:27], a[224:227], 0
    s_waitcnt lgkmcnt(5)
    v_exp_f32 v196, v196
    v_mfma_f32_16x16x32_bf16 v[232:235], a[12:15], a[236:239], v[232:235]
    s_waitcnt lgkmcnt(4)
    v_exp_f32 v197, v197
    v_mfma_f32_16x16x32_bf16 v[232:235], a[16:19], a[240:243], v[232:235]
    s_waitcnt lgkmcnt(3)
    v_exp_f32 v198, v198
    v_mfma_f32_16x16x32_bf16 v[232:235], a[20:23], a[244:247], v[232:235]
    v_exp_f32 v199, v199
    v_mfma_f32_16x16x32_bf16 v[236:239], a[28:31], a[228:231], v[236:239]
    s_waitcnt lgkmcnt(2)
    v_cvt_pk_bf16_f32 v192, v196, v197
    v_cvt_pk_bf16_f32 v195, v198, v199
    v_mfma_f32_16x16x32_bf16 v[236:239], a[32:35], a[232:235], v[236:239]
    ds_read_b128 v[196:199], v244 offset:192
    v_sub_f32 v201, v201, v248
    v_mfma_f32_16x16x32_bf16 v[212:215], v[18:21], v[192:195], 0
    s_waitcnt lgkmcnt(2)
    v_cvt_pk_bf16_f32 v144, v232, v233
    v_cvt_pk_bf16_f32 v145, v234, v235
    v_mfma_f32_16x16x32_bf16 v[216:219], v[48:51], v[192:195], 0
    v_exp_f32 v200, v200
    v_mfma_f32_16x16x32_bf16 v[220:223], v[78:81], v[192:195], 0
    s_waitcnt lgkmcnt(1)
    v_exp_f32 v201, v201
    v_mfma_f32_16x16x32_bf16 v[224:227], a[248:251], v[192:195], 0
    v_sub_f32 v202, v202, v248
    v_sub_f32 v203, v203, v248
    v_mfma_f32_16x16x32_bf16 v[208:211], v[120:123], v[174:177], v[208:211]
    ds_read_b64 v[174:175], v247 offset:30720
    v_cvt_pk_bf16_f32 v183, v200, v201
    v_mfma_f32_16x16x32_bf16 v[208:211], v[122:125], v[176:179], v[208:211]
    ds_read_b64 v[176:177], v247 offset:30848
    ds_read_b64 v[178:179], v247 offset:30976
    v_mfma_f32_16x16x32_bf16 v[236:239], a[36:39], a[236:239], v[236:239]
    v_exp_f32 v202, v202
    v_mfma_f32_16x16x32_bf16 v[236:239], a[40:43], a[240:243], v[236:239]
    s_waitcnt lgkmcnt(3)
    v_exp_f32 v203, v203
    v_mfma_f32_16x16x32_bf16 v[196:199], v[150:153], v[168:171], v[196:199]
    v_cvt_pk_bf16_f32 v186, v202, v203
    v_sub_f32 v204, v204, v248
    v_mfma_f32_16x16x32_bf16 v[196:199], v[152:155], v[170:173], v[196:199]
    ds_read_b128 v[200:203], v245 offset:192
    v_sub_f32 v205, v205, v248
    v_mfma_f32_16x16x32_bf16 v[236:239], a[44:47], a[244:247], v[236:239]
    v_exp_f32 v204, v204
    v_mfma_f32_16x16x32_bf16 v[228:231], a[48:51], a[224:227], 0
    v_exp_f32 v205, v205
    v_mfma_f32_16x16x32_bf16 v[228:231], a[52:55], a[228:231], v[228:231]
    v_sub_f32 v206, v206, v248
    v_sub_f32 v207, v207, v248
    v_mfma_f32_16x16x32_bf16 v[228:231], a[56:59], a[232:235], v[228:231]
    v_exp_f32 v206, v206
    v_mfma_f32_16x16x32_bf16 v[228:231], a[60:63], a[236:239], v[228:231]
    s_waitcnt lgkmcnt(3)
    v_cvt_pk_bf16_f32 v146, v236, v237
    v_cvt_pk_bf16_f32 v147, v238, v239
    v_mfma_f32_16x16x32_bf16 v[228:231], a[64:67], a[240:243], v[228:231]
    s_waitcnt lgkmcnt(1)
    v_exp_f32 v207, v207
    v_mfma_f32_16x16x32_bf16 v[228:231], a[68:71], a[244:247], v[228:231]
    v_cvt_pk_bf16_f32 v184, v204, v205
    v_cvt_pk_bf16_f32 v187, v206, v207
    v_mfma_f32_16x16x32_bf16 v[232:235], a[224:227], a[72:75], 0
    ds_read_b128 v[204:207], v246 offset:192
    v_sub_f32 v208, v208, v248
    v_mfma_f32_16x16x32_bf16 v[232:235], a[228:231], a[76:79], v[232:235]
    s_waitcnt lgkmcnt(1)
    v_exp_f32 v208, v208
    v_mfma_f32_16x16x32_bf16 v[200:203], v[96:99], v[168:171], v[200:203]
    v_cvt_pk_bf16_f32 v148, v228, v229
    v_cvt_pk_bf16_f32 v149, v230, v231
    v_mfma_f32_16x16x32_bf16 v[200:203], v[98:101], v[170:173], v[200:203]
    v_sub_f32 v209, v209, v248
    v_sub_f32 v210, v210, v248
    v_mfma_f32_16x16x32_bf16 v[232:235], a[232:235], a[80:83], v[232:235]
    v_exp_f32 v209, v209
    v_mfma_f32_16x16x32_bf16 v[232:235], a[236:239], a[84:87], v[232:235]
    v_exp_f32 v210, v210
    v_mfma_f32_16x16x32_bf16 v[232:235], a[240:243], a[88:91], v[232:235]
    v_sub_f32 v211, v211, v248
    v_cvt_pk_bf16_f32 v182, v208, v209
    v_mfma_f32_16x16x32_bf16 v[232:235], a[244:247], a[92:95], v[232:235]
    v_exp_f32 v211, v211
    v_mfma_f32_16x16x32_bf16 v[212:215], v[22:25], v[180:183], v[212:215]
    v_cvt_pk_bf16_f32 v185, v210, v211
    v_max_f32 v248, v196, v197
    v_mfma_f32_16x16x32_bf16 v[216:219], v[52:55], v[180:183], v[216:219]
    ds_read_b128 v[208:211], v244 offset:256
    v_max3_f32 v248, v248, v198, v199
    v_mfma_f32_16x16x32_bf16 v[220:223], v[82:85], v[180:183], v[220:223]
    s_waitcnt lgkmcnt(1)
    v_cvt_pk_bf16_f32 v13, v232, v233
    v_cvt_pk_bf16_f32 v16, v234, v235
    v_mfma_f32_16x16x32_bf16 v[224:227], a[248:251], v[180:183], v[224:227]
    ds_read_b128 v[196:199], v245 offset:256
    v_max3_f32 v248, v248, v200, v201
    v_mfma_f32_16x16x32_bf16 v[212:215], v[26:29], v[184:187], v[212:215]
    v_max3_f32 v248, v248, v202, v203
    v_mfma_f32_16x16x32_bf16 v[216:219], v[56:59], v[184:187], v[216:219]
    ds_read_b128 v[200:203], v246 offset:256
    v_mfma_f32_16x16x32_bf16 v[220:223], v[86:89], v[184:187], v[220:223]
    v_mfma_f32_16x16x32_bf16 v[224:227], a[248:251], v[184:187], v[224:227]
    v_mov_b32 v187, 0
    v_mfma_f32_16x16x32_bf16 v[204:207], v[132:135], v[168:171], v[204:207]
    v_mfma_f32_16x16x32_bf16 v[204:207], v[134:137], v[170:173], v[204:207]
    v_mfma_f32_16x16x32_bf16 v[236:239], a[224:227], a[96:99], 0
    s_waitcnt lgkmcnt(2)
    v_mfma_f32_16x16x32_bf16 v[208:211], v[156:159], v[168:171], v[208:211]
    v_mfma_f32_16x16x32_bf16 v[208:211], v[158:161], v[170:173], v[208:211]
    s_waitcnt lgkmcnt(1)
    v_rcp_f32 v225, v224
    v_mfma_f32_16x16x32_bf16 v[196:199], v[90:93], v[168:171], v[196:199]
    v_mov_b32 v226, 0x22e00
    v_cndmask_b32 v226, v226, v247, vcc
    v_mfma_f32_16x16x32_bf16 v[196:199], v[92:95], v[170:173], v[196:199]
    s_mov_b32 vcc_lo, 0xff00fff0
    v_mul_f32 v212, v212, v225
    v_mul_f32 v213, v213, v225
    v_mfma_f32_16x16x32_bf16 v[236:239], a[228:231], a[100:103], v[236:239]
    s_mov_b32 vcc_hi, 0xf000
    v_mul_f32 v214, v214, v225
    v_mul_f32 v215, v215, v225
    v_mfma_f32_16x16x32_bf16 v[236:239], a[232:235], a[104:107], v[236:239]
    s_waitcnt lgkmcnt(0)
    v_cvt_pk_bf16_f32 v212, v212, v213
    v_cvt_pk_bf16_f32 v213, v214, v215
    v_mfma_f32_16x16x32_bf16 v[200:203], v[126:129], v[168:171], v[200:203]
    ds_write_b64 v226, v[212:213] offset:0
    v_mfma_f32_16x16x32_bf16 v[200:203], v[128:131], v[170:173], v[200:203]
    v_mul_f32 v216, v216, v225
    v_mul_f32 v217, v217, v225
    v_mfma_f32_16x16x32_bf16 v[236:239], a[236:239], a[108:111], v[236:239]
    v_mul_f32 v218, v218, v225
    v_mul_f32 v219, v219, v225
    v_mfma_f32_16x16x32_bf16 v[236:239], a[240:243], a[112:115], v[236:239]
    v_cvt_pk_bf16_f32 v216, v216, v217
    v_cvt_pk_bf16_f32 v217, v218, v219
    v_mfma_f32_16x16x32_bf16 v[236:239], a[244:247], a[116:119], v[236:239]
    ds_write_b64 v226, v[216:217] offset:128
    v_mfma_f32_16x16x32_bf16 v[228:231], a[224:227], a[120:123], 0
    ds_read_b128 a[224:227], v240 offset:4736
    v_mul_f32 v220, v220, v225
    v_mfma_f32_16x16x32_bf16 v[228:231], a[228:231], a[124:127], v[228:231]
    ds_read_b128 a[228:231], v241 offset:4736
    v_mul_f32 v221, v221, v225
    v_mfma_f32_16x16x32_bf16 v[228:231], a[232:235], a[128:131], v[228:231]
    v_cvt_pk_bf16_f32 v43, v236, v237
    v_cvt_pk_bf16_f32 v46, v238, v239
    v_mfma_f32_16x16x32_bf16 v[228:231], a[236:239], a[132:135], v[228:231]
    ds_read_b128 a[232:235], v240 offset:4864
    ds_read_b128 a[236:239], v241 offset:4864
    v_mfma_f32_16x16x32_bf16 v[228:231], a[240:243], a[136:139], v[228:231]
    v_mul_f32 v222, v222, v225
    v_mul_f32 v223, v223, v225
    v_mfma_f32_16x16x32_bf16 v[228:231], a[244:247], a[140:143], v[228:231]
    v_cvt_pk_bf16_f32 v220, v220, v221
    v_cvt_pk_bf16_f32 v221, v222, v223
    v_mfma_f32_16x16x32_bf16 v[232:235], a[0:3], a[216:219], 0
    ds_write_b64 v226, v[220:221] offset:256
    v_mfma_f32_16x16x32_bf16 v[232:235], a[4:7], a[220:223], v[232:235]
    v_max3_f32 v248, v248, v204, v205
    v_max3_f32 v248, v248, v206, v207
    v_mfma_f32_16x16x32_bf16 v[236:239], a[24:27], a[216:219], 0
    s_waitcnt lgkmcnt(4)
    v_cvt_pk_bf16_f32 v73, v228, v229
    v_cvt_pk_bf16_f32 v76, v230, v231
    v_mfma_f32_16x16x32_bf16 v[232:235], a[8:11], a[224:227], v[232:235]
    ds_read_b128 v[204:207], v244 offset:320
    v_max3_f32 v248, v248, v208, v209
    v_mfma_f32_16x16x32_bf16 v[236:239], a[28:31], a[220:223], v[236:239]
    s_waitcnt lgkmcnt(4)
    v_max3_f32 v248, v248, v210, v211
    v_max3_f32 v248, v248, v196, v197
    v_mfma_f32_16x16x32_bf16 v[232:235], a[12:15], a[228:231], v[232:235]
    ds_read_b128 v[208:211], v245 offset:320
    v_max3_f32 v248, v248, v198, v199
    v_mfma_f32_16x16x32_bf16 v[236:239], a[32:35], a[224:227], v[236:239]
    ds_read_b128 v[196:199], v246 offset:320
    v_max3_f32 v248, v248, v200, v201
    v_mfma_f32_16x16x32_bf16 v[236:239], a[36:39], a[228:231], v[236:239]
    s_waitcnt lgkmcnt(5)
    v_max3_f32 v248, v248, v202, v203
    v_mfma_f32_16x16x32_bf16 v[232:235], a[16:19], a[232:235], v[232:235]
    ds_read_b128 v[200:203], v244 offset:192
    s_waitcnt lgkmcnt(5)
    v_mfma_f32_16x16x32_bf16 v[232:235], a[20:23], a[236:239], v[232:235]
    v_mfma_f32_16x16x32_bf16 v[236:239], a[40:43], a[232:235], v[236:239]
    v_mfma_f32_16x16x32_bf16 v[236:239], a[44:47], a[236:239], v[236:239]
    v_mfma_f32_16x16x32_bf16 v[228:231], a[48:51], a[216:219], 0
    s_waitcnt lgkmcnt(3)
    v_mfma_f32_16x16x32_bf16 v[204:207], v[162:165], v[168:171], v[204:207]
    v_mfma_f32_16x16x32_bf16 v[204:207], v[164:167], v[170:173], v[204:207]
    s_waitcnt lgkmcnt(2)
    s_waitcnt lgkmcnt(1)
    v_mfma_f32_16x16x32_bf16 v[208:211], v[138:141], v[168:171], v[208:211]
    v_mfma_f32_16x16x32_bf16 v[208:211], v[140:143], v[170:173], v[208:211]
    v_mfma_f32_16x16x32_bf16 v[196:199], v[144:147], v[168:171], v[196:199]
    s_waitcnt lgkmcnt(0)
    v_mfma_f32_16x16x32_bf16 v[196:199], v[146:149], v[170:173], v[196:199]
    v_mfma_f32_16x16x32_bf16 v[200:203], v[150:153], v[168:171], v[200:203]
    v_cvt_pk_bf16_f32 v150, v232, v233
    v_cvt_pk_bf16_f32 v151, v234, v235
    v_mfma_f32_16x16x32_bf16 v[200:203], v[152:155], v[170:173], v[200:203]
    v_cvt_pk_bf16_f32 v152, v236, v237
    v_cvt_pk_bf16_f32 v153, v238, v239
    v_mfma_f32_16x16x32_bf16 v[228:231], a[52:55], a[220:223], v[228:231]
    v_max3_f32 v248, v248, v204, v205
    v_max3_f32 v248, v248, v208, v209
    v_mfma_f32_16x16x32_bf16 v[228:231], a[56:59], a[224:227], v[228:231]
    ds_read_b128 v[204:207], v245 offset:192
    ds_read_b128 v[208:211], v246 offset:192
    v_mfma_f32_16x16x32_bf16 v[228:231], a[60:63], a[228:231], v[228:231]
    v_max3_f32 v248, v248, v196, v197
    v_mov_b32 v225, v248
    v_mfma_f32_16x16x32_bf16 v[228:231], a[64:67], a[232:235], v[228:231]
    ds_read_b128 v[196:199], v244 offset:256
    v_permlane16_swap_b32 v248, v225
    v_mfma_f32_16x16x32_bf16 v[228:231], a[68:71], a[236:239], v[228:231]
    v_max_f32 v248, v248, v225
    v_mov_b32 v225, v248
    v_mfma_f32_16x16x32_bf16 v[232:235], a[216:219], a[72:75], 0
    v_mfma_f32_16x16x32_bf16 v[232:235], a[220:223], a[76:79], v[232:235]
    v_permlane32_swap_b32 v248, v225
    v_max_f32 v248, v248, v225
    v_mfma_f32_16x16x32_bf16 v[232:235], a[224:227], a[80:83], v[232:235]
    v_sub_f32 v200, v200, v248
    v_cvt_pk_bf16_f32 v154, v228, v229
    v_mfma_f32_16x16x32_bf16 v[232:235], a[228:231], a[84:87], v[232:235]
    v_cvt_pk_bf16_f32 v155, v230, v231
    v_sub_f32 v201, v201, v248
    v_mfma_f32_16x16x32_bf16 v[232:235], a[232:235], a[88:91], v[232:235]
    s_waitcnt lgkmcnt(2)
    v_exp_f32 v200, v200
    v_mfma_f32_16x16x32_bf16 v[204:207], v[96:99], v[168:171], v[204:207]
    s_waitcnt lgkmcnt(1)
    v_exp_f32 v201, v201
    v_mfma_f32_16x16x32_bf16 v[204:207], v[98:101], v[170:173], v[204:207]
    v_sub_f32 v202, v202, v248
    v_sub_f32 v203, v203, v248
    v_mfma_f32_16x16x32_bf16 v[208:211], v[132:135], v[168:171], v[208:211]
    s_waitcnt lgkmcnt(0)
    v_exp_f32 v202, v202
    v_mfma_f32_16x16x32_bf16 v[208:211], v[134:137], v[170:173], v[208:211]
    v_exp_f32 v203, v203
    v_mfma_f32_16x16x32_bf16 v[196:199], v[156:159], v[168:171], v[196:199]
    v_cvt_pk_bf16_f32 v190, v200, v201
    v_cvt_pk_bf16_f32 v193, v202, v203
    v_mfma_f32_16x16x32_bf16 v[196:199], v[158:161], v[170:173], v[196:199]
    ds_read_b128 v[200:203], v245 offset:256
    v_sub_f32 v204, v204, v248
    v_mfma_f32_16x16x32_bf16 v[232:235], a[236:239], a[92:95], v[232:235]
    v_exp_f32 v204, v204
    v_mfma_f32_16x16x32_bf16 v[236:239], a[216:219], a[96:99], 0
    v_sub_f32 v205, v205, v248
    v_sub_f32 v206, v206, v248
    v_mfma_f32_16x16x32_bf16 v[236:239], a[220:223], a[100:103], v[236:239]
    v_exp_f32 v205, v205
    v_mfma_f32_16x16x32_bf16 v[236:239], a[224:227], a[104:107], v[236:239]
    v_exp_f32 v206, v206
    v_mfma_f32_16x16x32_bf16 v[236:239], a[228:231], a[108:111], v[236:239]
    v_cvt_pk_bf16_f32 v19, v232, v233
    v_cvt_pk_bf16_f32 v22, v234, v235
    v_mfma_f32_16x16x32_bf16 v[236:239], a[232:235], a[112:115], v[236:239]
    v_mbcnt_lo_u32_b32 v232, -1, 0
    v_mbcnt_hi_u32_b32 v232, -1, v232
    v_mfma_f32_16x16x32_bf16 v[236:239], a[236:239], a[116:119], v[236:239]
    v_and_b32 v233, 15, v232
    v_lshrrev_b32 v232, 4, v232
    v_mfma_f32_16x16x32_bf16 v[228:231], a[216:219], a[120:123], 0
    v_lshrrev_b32 v234, 1, v233
    v_mul_u32_u24 v235, 0x180, v233
    v_mfma_f32_16x16x32_bf16 v[228:231], a[220:223], a[124:127], v[228:231]
    s_waitcnt lgkmcnt(0)
    v_xor_b32 v243, v232, v234
    v_cvt_pk_bf16_f32 v49, v236, v237
    v_mfma_f32_16x16x32_bf16 v[200:203], v[90:93], v[168:171], v[200:203]
    v_cvt_pk_bf16_f32 v52, v238, v239
    v_lshl_add_u32 v242, v243, 4, v235
    v_mfma_f32_16x16x32_bf16 v[200:203], v[92:95], v[170:173], v[200:203]
    v_xor_b32 v243, 64, v242
    v_add_u32 v242, 0x1e000, v242
    v_mfma_f32_16x16x32_bf16 v[228:231], a[224:227], a[128:131], v[228:231]
    ds_read_b128 a[240:243], v242 offset:0
    v_add_u32 v243, 0x1e000, v243
    v_mfma_f32_16x16x32_bf16 v[228:231], a[228:231], a[132:135], v[228:231]
    ds_read_b128 a[244:247], v243 offset:0
    ds_read_b128 a[216:219], v242 offset:128
    v_mfma_f32_16x16x32_bf16 v[228:231], a[232:235], a[136:139], v[228:231]
    ds_read_b128 a[220:223], v243 offset:128
    ds_read_b128 a[224:227], v242 offset:256
    v_mfma_f32_16x16x32_bf16 v[228:231], a[236:239], a[140:143], v[228:231]
    ds_read_b128 a[228:231], v243 offset:256
    ds_read_b128 a[232:235], v242 offset:12288
    ds_read_b128 a[236:239], v243 offset:12288
    v_lshrrev_b32 v249, 1, v232
    v_or_b32 v249, s66, v249
    v_mov_b32 v253, v249
    v_xor_b32 v249, v249, v234
    v_lshl_add_u32 v249, v249, 4, v235
    v_cvt_pk_bf16_f32 v79, v228, v229
    v_cvt_pk_bf16_f32 v82, v230, v231
    v_and_b32 v235, 1, v232
    v_lshl_add_u32 v249, v235, 3, v249
    v_add_u32 v249, 0x16800, v249
    v_xor_b32 v250, s67, v232
    v_mul_u32_u24 v250, 0x300, v250
    s_mul_i32 s67, s28, 0x600
    s_add_u32 s67, s67, 0x16800
    v_mul_u32_u24 v232, 0x180, v232
    v_add_u32 v232, s67, v232
    v_lshlrev_b32 v235, 3, v235
    v_xor_b32 v252, v233, v235
    v_xor_b32 v252, v252, v253
    v_lshl_add_u32 v252, v252, 4, v232
    v_xor_b32 v253, v253, v234
    v_lshl_add_u32 v253, v253, 4, v232
    v_and_b32 v234, 1, v233
    v_lshl_add_u32 v253, v234, 3, v253
    v_lshl_add_u32 v251, v233, 3, v250
    v_xor_b32 v233, v233, v235
    v_lshl_add_u32 v250, v233, 4, v250
    v_sub_f32 v207, v207, v248
    v_exp_f32 v207, v207
    v_cvt_pk_bf16_f32 v188, v204, v205
    v_cvt_pk_bf16_f32 v191, v206, v207
    ds_read_b128 v[204:207], v246 offset:256
    v_sub_f32 v208, v208, v248
    v_exp_f32 v208, v208
    v_sub_f32 v209, v209, v248
    v_exp_f32 v209, v209
    v_sub_f32 v210, v210, v248
    v_exp_f32 v210, v210
    v_sub_f32 v211, v211, v248
    v_exp_f32 v211, v211
    v_cvt_pk_bf16_f32 v189, v208, v209
    v_cvt_pk_bf16_f32 v192, v210, v211
    ds_read_b128 v[208:211], v244 offset:320
    v_mfma_f32_16x16x32_bf16 v[212:215], v[0:3], v[188:191], 0
    s_waitcnt lgkmcnt(2)
    v_sub_f32 v196, v196, v248
    v_sub_f32 v197, v197, v248
    v_mfma_f32_16x16x32_bf16 v[216:219], v[30:33], v[188:191], 0
    v_exp_f32 v196, v196
    v_mfma_f32_16x16x32_bf16 v[220:223], v[60:63], v[188:191], 0
    v_exp_f32 v197, v197
    v_mfma_f32_16x16x32_bf16 v[224:227], a[248:251], v[188:191], 0
    v_sub_f32 v198, v198, v248
    s_waitcnt lgkmcnt(1)
    v_mfma_f32_16x16x32_bf16 v[204:207], v[126:129], v[168:171], v[204:207]
    v_exp_f32 v198, v198
    v_mfma_f32_16x16x32_bf16 v[204:207], v[128:131], v[170:173], v[204:207]
    v_sub_f32 v199, v199, v248
    v_exp_f32 v199, v199
    v_cvt_pk_bf16_f32 v180, v196, v197
    v_cvt_pk_bf16_f32 v183, v198, v199
    ds_read_b128 v[196:199], v245 offset:320
    v_sub_f32 v200, v200, v248
    s_waitcnt lgkmcnt(1)
    v_mfma_f32_16x16x32_bf16 v[208:211], v[162:165], v[168:171], v[208:211]
    v_exp_f32 v200, v200
    v_mfma_f32_16x16x32_bf16 v[208:211], v[164:167], v[170:173], v[208:211]
    v_sub_f32 v201, v201, v248
    v_exp_f32 v201, v201
    v_sub_f32 v202, v202, v248
    v_exp_f32 v202, v202
    v_sub_f32 v203, v203, v248
    v_exp_f32 v203, v203
    v_cvt_pk_bf16_f32 v194, v200, v201
    v_cvt_pk_bf16_f32 v181, v202, v203
    ds_read_b128 v[200:203], v246 offset:320
    v_sub_f32 v204, v204, v248
    v_exp_f32 v204, v204
    v_sub_f32 v205, v205, v248
    v_exp_f32 v205, v205
    v_sub_f32 v206, v206, v248
    v_exp_f32 v206, v206
    s_waitcnt lgkmcnt(1)
    v_mfma_f32_16x16x32_bf16 v[196:199], v[138:141], v[168:171], v[196:199]
    v_sub_f32 v207, v207, v248
    v_cvt_pk_bf16_f32 v195, v204, v205
    v_mfma_f32_16x16x32_bf16 v[196:199], v[140:143], v[170:173], v[196:199]
    v_exp_f32 v207, v207
    v_mfma_f32_16x16x32_bf16 v[212:215], v[4:7], v[192:195], v[212:215]
    v_cvt_pk_bf16_f32 v182, v206, v207
    v_sub_f32 v208, v208, v248
    v_mfma_f32_16x16x32_bf16 v[216:219], v[34:37], v[192:195], v[216:219]
    ds_read_b128 v[204:207], v244 offset:0
    v_sub_f32 v209, v209, v248
    v_mfma_f32_16x16x32_bf16 v[220:223], v[64:67], v[192:195], v[220:223]
    v_exp_f32 v208, v208
    v_mfma_f32_16x16x32_bf16 v[224:227], a[248:251], v[192:195], v[224:227]
    s_waitcnt lgkmcnt(1)
    v_exp_f32 v209, v209
    v_mfma_f32_16x16x32_bf16 v[212:215], v[8:11], v[180:183], v[212:215]
    v_cvt_pk_bf16_f32 v186, v208, v209
    v_sub_f32 v196, v196, v248
    v_mfma_f32_16x16x32_bf16 v[216:219], v[38:41], v[180:183], v[216:219]
    ds_read_b128 v[208:211], v245 offset:0
    v_sub_f32 v197, v197, v248
    v_mfma_f32_16x16x32_bf16 v[220:223], v[68:71], v[180:183], v[220:223]
    v_exp_f32 v196, v196
    v_mfma_f32_16x16x32_bf16 v[224:227], a[248:251], v[180:183], v[224:227]
    v_exp_f32 v197, v197
    v_mfma_f32_16x16x32_bf16 v[200:203], v[144:147], v[168:171], v[200:203]
    ds_read_b64 v[168:169], v247 offset:36864
    v_cvt_pk_bf16_f32 v184, v196, v197
    v_mfma_f32_16x16x32_bf16 v[200:203], v[146:149], v[170:173], v[200:203]
    ds_read_b128 v[196:199], v246 offset:0
    s_waitcnt lgkmcnt(3)
    v_mfma_f32_16x16x32_bf16 v[204:207], v[156:159], v[174:177], v[204:207]
    ds_read_b64 v[170:171], v247 offset:36992
    ds_read_b64 v[172:173], v247 offset:37120
    v_mfma_f32_16x16x32_bf16 v[204:207], v[158:161], v[176:179], v[204:207]
    s_nop 1
    v_sub_f32 v200, v200, v248
    v_exp_f32 v200, v200
    v_sub_f32 v201, v201, v248
    v_exp_f32 v201, v201
    s_waitcnt lgkmcnt(4)
    v_mfma_f32_16x16x32_bf16 v[208:211], v[90:93], v[174:177], v[208:211]
    v_cvt_pk_bf16_f32 v185, v200, v201
    v_max_f32 v248, v204, v205
    v_mfma_f32_16x16x32_bf16 v[208:211], v[92:95], v[176:179], v[208:211]
    ds_read_b128 v[200:203], v244 offset:64
    v_max3_f32 v248, v248, v206, v207
    v_mfma_f32_16x16x32_bf16 v[212:215], v[12:15], v[184:187], v[212:215]
    ds_read_b128 v[204:207], v245 offset:64
    v_mfma_f32_16x16x32_bf16 v[216:219], v[42:45], v[184:187], v[216:219]
    v_mfma_f32_16x16x32_bf16 v[220:223], v[72:75], v[184:187], v[220:223]
    s_waitcnt lgkmcnt(4)
    v_mfma_f32_16x16x32_bf16 v[224:227], a[248:251], v[184:187], v[224:227]
    v_max3_f32 v248, v248, v208, v209
    v_max3_f32 v248, v248, v210, v211
    v_mfma_f32_16x16x32_bf16 v[196:199], v[126:129], v[174:177], v[196:199]
    ds_read_b128 v[208:211], v246 offset:64
    v_mfma_f32_16x16x32_bf16 v[196:199], v[128:131], v[176:179], v[196:199]
    s_nop 2
    v_rcp_f32 v225, v224
    s_nop 0
    v_mul_f32 v212, v212, v225
    v_mul_f32 v213, v213, v225
    v_mul_f32 v214, v214, v225
    s_waitcnt lgkmcnt(2)
    v_mfma_f32_16x16x32_bf16 v[200:203], v[162:165], v[174:177], v[200:203]
    v_mul_f32 v215, v215, v225
    v_cvt_pk_bf16_f32 v212, v212, v213
    v_mfma_f32_16x16x32_bf16 v[200:203], v[164:167], v[176:179], v[200:203]
    s_waitcnt lgkmcnt(1)
    v_cvt_pk_bf16_f32 v213, v214, v215
    v_mul_f32 v216, v216, v225
    v_mfma_f32_16x16x32_bf16 v[204:207], v[138:141], v[174:177], v[204:207]
    ds_write_b64 v247, v[212:213] offset:24576
    v_mfma_f32_16x16x32_bf16 v[204:207], v[140:143], v[176:179], v[204:207]
    v_mul_f32 v217, v217, v225
    v_mul_f32 v218, v218, v225
    v_mfma_f32_16x16x32_bf16 v[236:239], a[144:147], a[240:243], 0
    v_mul_f32 v219, v219, v225
    v_cvt_pk_bf16_f32 v216, v216, v217
    v_mfma_f32_16x16x32_bf16 v[236:239], a[148:151], a[244:247], v[236:239]
    s_waitcnt lgkmcnt(1)
    v_cvt_pk_bf16_f32 v217, v218, v219
    v_mul_f32 v220, v220, v225
    v_mfma_f32_16x16x32_bf16 v[208:211], v[144:147], v[174:177], v[208:211]
    ds_write_b64 v247, v[216:217] offset:24704
    v_mfma_f32_16x16x32_bf16 v[208:211], v[146:149], v[176:179], v[208:211]
    v_mul_f32 v221, v221, v225
    v_mul_f32 v222, v222, v225
    v_mfma_f32_16x16x32_bf16 v[236:239], a[152:155], a[216:219], v[236:239]
    v_mul_f32 v223, v223, v225
    v_cvt_pk_bf16_f32 v220, v220, v221
    v_mfma_f32_16x16x32_bf16 v[236:239], a[156:159], a[220:223], v[236:239]
    v_cvt_pk_bf16_f32 v221, v222, v223
    v_max3_f32 v248, v248, v196, v197
    v_mfma_f32_16x16x32_bf16 v[236:239], a[160:163], a[224:227], v[236:239]
    ds_write_b64 v247, v[220:221] offset:24832
    v_mfma_f32_16x16x32_bf16 v[236:239], a[164:167], a[228:231], v[236:239]
    v_max3_f32 v248, v248, v198, v199
    v_max3_f32 v248, v248, v200, v201
    v_mfma_f32_16x16x32_bf16 v[228:231], a[168:171], a[240:243], 0
    ds_read_b128 v[196:199], v244 offset:128
    v_max3_f32 v248, v248, v202, v203
    v_mfma_f32_16x16x32_bf16 v[228:231], a[172:175], a[244:247], v[228:231]
    ds_read_b128 v[200:203], v245 offset:128
    v_max3_f32 v248, v248, v204, v205
    v_mfma_f32_16x16x32_bf16 v[228:231], a[176:179], a[216:219], v[228:231]
    v_cvt_pk_bf16_f32 v236, v236, v237
    v_cvt_pk_bf16_f32 v237, v238, v239
    v_mfma_f32_16x16x32_bf16 v[228:231], a[180:183], a[220:223], v[228:231]
    ds_write_b64 v249, v[236:237] offset:0
    v_mfma_f32_16x16x32_bf16 v[228:231], a[184:187], a[224:227], v[228:231]
    v_max3_f32 v248, v248, v206, v207
    v_max3_f32 v248, v248, v208, v209
    v_mfma_f32_16x16x32_bf16 v[228:231], a[188:191], a[228:231], v[228:231]
    ds_read_b128 v[204:207], v246 offset:128
    v_max3_f32 v248, v248, v210, v211
    v_mfma_f32_16x16x32_bf16 v[232:235], a[192:195], a[240:243], 0
    ds_read_b128 a[240:243], v242 offset:12416
    ds_read_b128 v[208:211], v244 offset:0
    v_mfma_f32_16x16x32_bf16 v[232:235], a[196:199], a[244:247], v[232:235]
    ds_read_b128 a[244:247], v243 offset:12416
    v_mfma_f32_16x16x32_bf16 v[232:235], a[200:203], a[216:219], v[232:235]
    ds_read_b128 a[216:219], v242 offset:12544
    v_cvt_pk_bf16_f32 v228, v228, v229
    v_mfma_f32_16x16x32_bf16 v[232:235], a[204:207], a[220:223], v[232:235]
    ds_read_b128 a[220:223], v243 offset:12544
    v_cvt_pk_bf16_f32 v229, v230, v231
    v_mfma_f32_16x16x32_bf16 v[232:235], a[208:211], a[224:227], v[232:235]
    ds_write_b64 v249, v[228:229] offset:128
    v_mfma_f32_16x16x32_bf16 v[232:235], a[212:215], a[228:231], v[232:235]
    ds_read_b128 a[224:227], v240 offset:6144
    ds_read_b128 a[228:231], v241 offset:6144
    v_mfma_f32_16x16x32_bf16 v[236:239], a[144:147], a[232:235], 0
    s_waitcnt lgkmcnt(10)
    v_mfma_f32_16x16x32_bf16 v[196:199], v[102:105], v[174:177], v[196:199]
    s_waitcnt lgkmcnt(8)
    v_mfma_f32_16x16x32_bf16 v[196:199], v[104:107], v[176:179], v[196:199]
    v_mfma_f32_16x16x32_bf16 v[200:203], v[114:117], v[174:177], v[200:203]
    s_waitcnt lgkmcnt(6)
    v_cvt_pk_bf16_f32 v232, v232, v233
    v_cvt_pk_bf16_f32 v233, v234, v235
    v_mfma_f32_16x16x32_bf16 v[200:203], v[116:119], v[176:179], v[200:203]
    ds_write_b64 v249, v[232:233] offset:256
    v_mfma_f32_16x16x32_bf16 v[204:207], v[150:153], v[174:177], v[204:207]
    s_waitcnt lgkmcnt(6)
    v_max3_f32 v248, v248, v196, v197
    v_mfma_f32_16x16x32_bf16 v[204:207], v[152:155], v[176:179], v[204:207]
    ds_read_b128 v[196:199], v245 offset:0
    v_mfma_f32_16x16x32_bf16 v[208:211], v[156:159], v[174:177], v[208:211]
    s_waitcnt lgkmcnt(5)
    v_max3_f32 v248, v248, v200, v201
    v_mfma_f32_16x16x32_bf16 v[208:211], v[158:161], v[176:179], v[208:211]
    ds_read_b128 v[200:203], v246 offset:0
    v_mfma_f32_16x16x32_bf16 v[236:239], a[148:151], a[236:239], v[236:239]
    s_waitcnt lgkmcnt(4)
    v_max3_f32 v248, v248, v204, v205
    v_mov_b32 v225, v248
    v_mfma_f32_16x16x32_bf16 v[236:239], a[152:155], a[240:243], v[236:239]
    ds_read_b128 v[204:207], v244 offset:64
    v_permlane16_swap_b32 v248, v225
    v_mfma_f32_16x16x32_bf16 v[236:239], a[156:159], a[244:247], v[236:239]
    s_waitcnt lgkmcnt(4)
    v_max_f32 v248, v248, v225
    v_mov_b32 v225, v248
    v_mfma_f32_16x16x32_bf16 v[236:239], a[160:163], a[216:219], v[236:239]
    v_mfma_f32_16x16x32_bf16 v[236:239], a[164:167], a[220:223], v[236:239]
    v_permlane32_swap_b32 v248, v225
    v_max_f32 v248, v248, v225
    v_mfma_f32_16x16x32_bf16 v[228:231], a[168:171], a[232:235], 0
    v_sub_f32 v208, v208, v248
    v_sub_f32 v209, v209, v248
    v_mfma_f32_16x16x32_bf16 v[228:231], a[172:175], a[236:239], v[228:231]
    s_waitcnt lgkmcnt(2)
    v_exp_f32 v208, v208
    v_mfma_f32_16x16x32_bf16 v[196:199], v[90:93], v[174:177], v[196:199]
    v_cvt_pk_bf16_f32 v236, v236, v237
    v_cvt_pk_bf16_f32 v237, v238, v239
    v_mfma_f32_16x16x32_bf16 v[196:199], v[92:95], v[176:179], v[196:199]
    ds_write_b64 v249, v[236:237] offset:6144
    v_mfma_f32_16x16x32_bf16 v[228:231], a[176:179], a[240:243], v[228:231]
    s_waitcnt lgkmcnt(1)
    v_exp_f32 v209, v209
    v_mfma_f32_16x16x32_bf16 v[200:203], v[126:129], v[174:177], v[200:203]
    v_sub_f32 v210, v210, v248
    v_sub_f32 v211, v211, v248
    v_mfma_f32_16x16x32_bf16 v[200:203], v[128:131], v[176:179], v[200:203]
    v_exp_f32 v210, v210
    v_mfma_f32_16x16x32_bf16 v[204:207], v[162:165], v[174:177], v[204:207]
    v_exp_f32 v211, v211
    v_mfma_f32_16x16x32_bf16 v[204:207], v[164:167], v[176:179], v[204:207]
    v_cvt_pk_bf16_f32 v190, v208, v209
    v_cvt_pk_bf16_f32 v193, v210, v211
    v_mfma_f32_16x16x32_bf16 v[228:231], a[180:183], a[244:247], v[228:231]
    ds_read_b128 v[208:211], v245 offset:64
    v_sub_f32 v196, v196, v248
    v_mfma_f32_16x16x32_bf16 v[228:231], a[184:187], a[216:219], v[228:231]
    v_exp_f32 v196, v196
    v_mfma_f32_16x16x32_bf16 v[228:231], a[188:191], a[220:223], v[228:231]
    v_sub_f32 v197, v197, v248
    v_sub_f32 v198, v198, v248
    v_mfma_f32_16x16x32_bf16 v[232:235], a[192:195], a[232:235], 0
    ds_read_b128 a[232:235], v240 offset:6272
    v_sub_f32 v199, v199, v248
    v_mfma_f32_16x16x32_bf16 v[232:235], a[196:199], a[236:239], v[232:235]
    ds_read_b128 a[236:239], v241 offset:6272
    v_sub_f32 v200, v200, v248
    v_mfma_f32_16x16x32_bf16 v[232:235], a[200:203], a[240:243], v[232:235]
    ds_read_b128 a[240:243], v240 offset:6400
    v_cvt_pk_bf16_f32 v228, v228, v229
    v_mfma_f32_16x16x32_bf16 v[232:235], a[204:207], a[244:247], v[232:235]
    ds_read_b128 a[244:247], v241 offset:6400
    v_cvt_pk_bf16_f32 v229, v230, v231
    v_mfma_f32_16x16x32_bf16 v[232:235], a[208:211], a[216:219], v[232:235]
    ds_write_b64 v249, v[228:229] offset:6272
    v_mfma_f32_16x16x32_bf16 v[232:235], a[212:215], a[220:223], v[232:235]
    ds_read_b128 a[216:219], v242 offset:6144
    ds_read_b128 a[220:223], v243 offset:6144
    v_mfma_f32_16x16x32_bf16 v[236:239], a[0:3], a[224:227], 0
    s_waitcnt lgkmcnt(7)
    v_exp_f32 v197, v197
    v_mfma_f32_16x16x32_bf16 v[208:211], v[138:141], v[174:177], v[208:211]
    v_exp_f32 v198, v198
    v_mfma_f32_16x16x32_bf16 v[208:211], v[140:143], v[176:179], v[208:211]
    v_cvt_pk_bf16_f32 v232, v232, v233
    v_cvt_pk_bf16_f32 v233, v234, v235
    v_mfma_f32_16x16x32_bf16 v[236:239], a[4:7], a[228:231], v[236:239]
    ds_write_b64 v249, v[232:233] offset:6400
    v_mfma_f32_16x16x32_bf16 v[228:231], a[24:27], a[224:227], 0
    s_waitcnt lgkmcnt(7)
    v_exp_f32 v199, v199
    v_mfma_f32_16x16x32_bf16 v[236:239], a[8:11], a[232:235], v[236:239]
    s_waitcnt lgkmcnt(6)
    v_cvt_pk_bf16_f32 v188, v196, v197
    v_cvt_pk_bf16_f32 v191, v198, v199
    v_mfma_f32_16x16x32_bf16 v[236:239], a[12:15], a[236:239], v[236:239]
    ds_read_b128 v[196:199], v246 offset:64
    v_sub_f32 v201, v201, v248
    v_mfma_f32_16x16x32_bf16 v[228:231], a[28:31], a[228:231], v[228:231]
    s_waitcnt lgkmcnt(6)
    v_exp_f32 v200, v200
    v_mfma_f32_16x16x32_bf16 v[236:239], a[16:19], a[240:243], v[236:239]
    s_waitcnt lgkmcnt(5)
    v_exp_f32 v201, v201
    v_mfma_f32_16x16x32_bf16 v[236:239], a[20:23], a[244:247], v[236:239]
    s_waitcnt lgkmcnt(3)
    v_sub_f32 v202, v202, v248
    v_sub_f32 v203, v203, v248
    v_mfma_f32_16x16x32_bf16 v[228:231], a[32:35], a[232:235], v[228:231]
    s_waitcnt lgkmcnt(2)
    v_exp_f32 v202, v202
    v_mfma_f32_16x16x32_bf16 v[228:231], a[36:39], a[236:239], v[228:231]
    s_waitcnt lgkmcnt(1)
    v_cvt_pk_bf16_f32 v156, v236, v237
    v_cvt_pk_bf16_f32 v157, v238, v239
    v_mfma_f32_16x16x32_bf16 v[228:231], a[40:43], a[240:243], v[228:231]
    s_barrier
    v_mfma_f32_16x16x32_bf16 v[228:231], a[44:47], a[244:247], v[228:231]
    ds_read_b128 a[252:255], v252 offset:0
    ds_read_b64 v[254:255], v253 offset:256
    v_mfma_f32_16x16x32_bf16 v[232:235], a[48:51], a[224:227], 0
    s_waitcnt lgkmcnt(2)
    v_exp_f32 v203, v203
    v_mfma_f32_16x16x32_bf16 v[196:199], v[144:147], v[174:177], v[196:199]
    v_cvt_pk_bf16_f32 v189, v200, v201
    v_cvt_pk_bf16_f32 v192, v202, v203
    v_mfma_f32_16x16x32_bf16 v[196:199], v[146:149], v[176:179], v[196:199]
    v_cvt_pk_bf16_f32 v158, v228, v229
    v_cvt_pk_bf16_f32 v159, v230, v231
    v_mfma_f32_16x16x32_bf16 v[212:215], v[6:9], v[188:191], 0
    ds_read_b128 v[200:203], v244 offset:128
    v_sub_f32 v204, v204, v248
    v_mfma_f32_16x16x32_bf16 v[216:219], v[36:39], v[188:191], 0
    v_exp_f32 v204, v204
    v_mfma_f32_16x16x32_bf16 v[220:223], v[66:69], v[188:191], 0
    v_sub_f32 v205, v205, v248
    v_sub_f32 v206, v206, v248
    v_mfma_f32_16x16x32_bf16 v[224:227], a[248:251], v[188:191], 0
    v_exp_f32 v205, v205
    v_mfma_f32_16x16x32_bf16 v[232:235], a[52:55], a[228:231], v[232:235]
    s_waitcnt lgkmcnt(2)
    v_exp_f32 v206, v206
    v_mfma_f32_16x16x32_bf16 v[232:235], a[56:59], a[232:235], v[232:235]
    buffer_store_dwordx4 a[252:255], v250, s[20:23], s55 offen nt
    v_mfma_f32_16x16x32_bf16 v[232:235], a[60:63], a[236:239], v[232:235]
    s_waitcnt lgkmcnt(1)
    ds_read_b128 a[252:255], v252 offset:6144
    v_mfma_f32_16x16x32_bf16 v[232:235], a[64:67], a[240:243], v[232:235]
    v_sub_f32 v207, v207, v248
    v_cvt_pk_bf16_f32 v180, v204, v205
    v_mfma_f32_16x16x32_bf16 v[232:235], a[68:71], a[244:247], v[232:235]
    buffer_store_dwordx2 v[254:255], v251, s[20:23], s55 offen offset:256 nt
    v_mfma_f32_16x16x32_bf16 v[236:239], a[224:227], a[72:75], 0
    ds_read_b64 v[254:255], v253 offset:6400
    s_mul_i32 s55, s31, 7
    v_mfma_f32_16x16x32_bf16 v[236:239], a[228:231], a[76:79], v[236:239]
    s_add_u32 s54, s54, s55
    s_add_u32 s54, s54, s32
    s_add_u32 s55, s28, 11
    v_mfma_f32_16x16x32_bf16 v[236:239], a[232:235], a[80:83], v[236:239]
    s_mul_i32 s55, s55, s30
    v_cvt_pk_bf16_f32 v160, v232, v233
    v_cvt_pk_bf16_f32 v161, v234, v235
    v_mfma_f32_16x16x32_bf16 v[236:239], a[236:239], a[84:87], v[236:239]
    s_waitcnt lgkmcnt(2)
    v_exp_f32 v207, v207
    v_mfma_f32_16x16x32_bf16 v[200:203], v[102:105], v[174:177], v[200:203]
    v_cvt_pk_bf16_f32 v183, v206, v207
    v_sub_f32 v208, v208, v248
    v_mfma_f32_16x16x32_bf16 v[200:203], v[104:107], v[176:179], v[200:203]
    ds_read_b128 v[204:207], v245 offset:128
    s_waitcnt lgkmcnt(2)
    v_mfma_f32_16x16x32_bf16 v[236:239], a[240:243], a[88:91], v[236:239]
    buffer_store_dwordx4 a[252:255], v250, s[20:23], s57 offen nt
    v_mfma_f32_16x16x32_bf16 v[236:239], a[244:247], a[92:95], v[236:239]
    v_exp_f32 v208, v208
    v_mfma_f32_16x16x32_bf16 v[228:231], a[224:227], a[96:99], 0
    s_waitcnt lgkmcnt(1)
    v_sub_f32 v209, v209, v248
    v_sub_f32 v210, v210, v248
    v_mfma_f32_16x16x32_bf16 v[228:231], a[228:231], a[100:103], v[228:231]
    buffer_store_dwordx2 v[254:255], v251, s[20:23], s57 offen offset:256 nt
    v_mfma_f32_16x16x32_bf16 v[228:231], a[232:235], a[104:107], v[228:231]
    s_mul_i32 s57, s31, 3
    v_cvt_pk_bf16_f32 v25, v236, v237
    v_cvt_pk_bf16_f32 v28, v238, v239
    v_mfma_f32_16x16x32_bf16 v[228:231], a[236:239], a[108:111], v[228:231]
    s_add_u32 s56, s56, s57
    s_add_u32 s56, s56, s32
    s_add_u32 s57, s28, 3
    v_mfma_f32_16x16x32_bf16 v[228:231], a[240:243], a[112:115], v[228:231]
    s_mul_i32 s57, s57, s30
    v_exp_f32 v209, v209
    v_mfma_f32_16x16x32_bf16 v[228:231], a[244:247], a[116:119], v[228:231]
    s_waitcnt lgkmcnt(0)
    v_exp_f32 v210, v210
    v_mfma_f32_16x16x32_bf16 v[204:207], v[114:117], v[174:177], v[204:207]
    v_sub_f32 v211, v211, v248
    v_cvt_pk_bf16_f32 v194, v208, v209
    v_mfma_f32_16x16x32_bf16 v[204:207], v[116:119], v[176:179], v[204:207]
    v_exp_f32 v211, v211
    v_mfma_f32_16x16x32_bf16 v[232:235], a[224:227], a[120:123], 0
    v_cvt_pk_bf16_f32 v55, v228, v229
    v_cvt_pk_bf16_f32 v58, v230, v231
    v_mfma_f32_16x16x32_bf16 v[232:235], a[228:231], a[124:127], v[232:235]
    ds_read_b128 a[224:227], v242 offset:6272
    ds_read_b128 a[228:231], v243 offset:6272
    v_mfma_f32_16x16x32_bf16 v[232:235], a[232:235], a[128:131], v[232:235]
    ds_read_b128 a[232:235], v242 offset:6400
    v_add_u32 v242, 0xfffe9800, v242
    v_mfma_f32_16x16x32_bf16 v[232:235], a[236:239], a[132:135], v[232:235]
    ds_read_b128 a[236:239], v243 offset:6400
    v_add_u32 v243, 0xfffe9800, v243
    v_mfma_f32_16x16x32_bf16 v[232:235], a[240:243], a[136:139], v[232:235]
    ds_read_b128 a[240:243], v242 offset:12288
    v_cvt_pk_bf16_f32 v181, v210, v211
    v_mfma_f32_16x16x32_bf16 v[232:235], a[244:247], a[140:143], v[232:235]
    ds_read_b128 a[244:247], v243 offset:12288
    ds_read_b128 v[208:211], v246 offset:128
    v_mfma_f32_16x16x32_bf16 v[236:239], a[144:147], a[216:219], 0
    v_sub_f32 v196, v196, v248
    v_sub_f32 v197, v197, v248
    v_mfma_f32_16x16x32_bf16 v[236:239], a[148:151], a[220:223], v[236:239]
    v_exp_f32 v196, v196
    v_mfma_f32_16x16x32_bf16 v[228:231], a[168:171], a[216:219], 0
    v_cvt_pk_bf16_f32 v85, v232, v233
    v_cvt_pk_bf16_f32 v88, v234, v235
    v_mfma_f32_16x16x32_bf16 v[228:231], a[172:175], a[220:223], v[228:231]
    s_waitcnt lgkmcnt(6)
    v_exp_f32 v197, v197
    v_mfma_f32_16x16x32_bf16 v[236:239], a[152:155], a[224:227], v[236:239]
    s_waitcnt lgkmcnt(5)
    v_sub_f32 v198, v198, v248
    v_sub_f32 v199, v199, v248
    v_mfma_f32_16x16x32_bf16 v[236:239], a[156:159], a[228:231], v[236:239]
    s_waitcnt lgkmcnt(4)
    v_exp_f32 v198, v198
    v_mfma_f32_16x16x32_bf16 v[236:239], a[160:163], a[232:235], v[236:239]
    s_waitcnt lgkmcnt(3)
    v_exp_f32 v199, v199
    v_mfma_f32_16x16x32_bf16 v[236:239], a[164:167], a[236:239], v[236:239]
    v_cvt_pk_bf16_f32 v195, v196, v197
    v_cvt_pk_bf16_f32 v182, v198, v199
    v_mfma_f32_16x16x32_bf16 v[228:231], a[176:179], a[224:227], v[228:231]
    ds_read_b128 v[196:199], v244 offset:0
    v_sub_f32 v200, v200, v248
    v_mfma_f32_16x16x32_bf16 v[212:215], v[10:13], v[192:195], v[212:215]
    s_waitcnt lgkmcnt(1)
    v_exp_f32 v200, v200
    v_mfma_f32_16x16x32_bf16 v[216:219], v[40:43], v[192:195], v[216:219]
    v_cvt_pk_bf16_f32 v236, v236, v237
    v_cvt_pk_bf16_f32 v237, v238, v239
    v_mfma_f32_16x16x32_bf16 v[220:223], v[70:73], v[192:195], v[220:223]
    ds_write_b64 v249, v[236:237] offset:12288
    v_mfma_f32_16x16x32_bf16 v[224:227], a[248:251], v[192:195], v[224:227]
    v_sub_f32 v201, v201, v248
    v_sub_f32 v204, v204, v248
    v_mfma_f32_16x16x32_bf16 v[212:215], v[14:17], v[180:183], v[212:215]
    v_exp_f32 v201, v201
    v_mfma_f32_16x16x32_bf16 v[216:219], v[44:47], v[180:183], v[216:219]
    v_cvt_pk_bf16_f32 v186, v200, v201
    v_sub_f32 v205, v205, v248
    v_mfma_f32_16x16x32_bf16 v[220:223], v[74:77], v[180:183], v[220:223]
    ds_read_b128 v[200:203], v245 offset:0
    v_mfma_f32_16x16x32_bf16 v[224:227], a[248:251], v[180:183], v[224:227]
    s_waitcnt lgkmcnt(2)
    v_exp_f32 v204, v204
    v_mfma_f32_16x16x32_bf16 v[208:211], v[150:153], v[174:177], v[208:211]
    ds_read_b64 v[174:175], v247 offset:43008
    v_mfma_f32_16x16x32_bf16 v[208:211], v[152:155], v[176:179], v[208:211]
    ds_read_b64 v[176:177], v247 offset:43136
    ds_read_b64 v[178:179], v247 offset:43264
    v_mfma_f32_16x16x32_bf16 v[196:199], v[162:165], v[168:171], v[196:199]
    v_exp_f32 v205, v205
    v_mfma_f32_16x16x32_bf16 v[196:199], v[164:167], v[170:173], v[196:199]
    v_cvt_pk_bf16_f32 v184, v204, v205
    v_mfma_f32_16x16x32_bf16 v[228:231], a[180:183], a[228:231], v[228:231]
    ds_read_b128 v[204:207], v246 offset:0
    v_sub_f32 v208, v208, v248
    v_mfma_f32_16x16x32_bf16 v[228:231], a[184:187], a[232:235], v[228:231]
    v_exp_f32 v208, v208
    v_mfma_f32_16x16x32_bf16 v[228:231], a[188:191], a[236:239], v[228:231]
    s_waitcnt lgkmcnt(4)
    v_sub_f32 v209, v209, v248
    v_max_f32 v248, v196, v197
    v_mfma_f32_16x16x32_bf16 v[200:203], v[138:141], v[168:171], v[200:203]
    v_exp_f32 v209, v209
    v_mfma_f32_16x16x32_bf16 v[200:203], v[140:143], v[170:173], v[200:203]
    v_cvt_pk_bf16_f32 v185, v208, v209
    v_max3_f32 v248, v248, v198, v199
    v_mfma_f32_16x16x32_bf16 v[232:235], a[192:195], a[216:219], 0
    ds_read_b128 a[216:219], v242 offset:12416
    v_cvt_pk_bf16_f32 v228, v228, v229
    v_mfma_f32_16x16x32_bf16 v[212:215], v[18:21], v[184:187], v[212:215]
    ds_read_b128 v[208:211], v244 offset:64
    v_cvt_pk_bf16_f32 v229, v230, v231
    v_mfma_f32_16x16x32_bf16 v[216:219], v[48:51], v[184:187], v[216:219]
    ds_write_b64 v249, v[228:229] offset:12416
    v_mfma_f32_16x16x32_bf16 v[220:223], v[78:81], v[184:187], v[220:223]
    ds_read_b128 v[196:199], v245 offset:64
    v_max3_f32 v248, v248, v200, v201
    v_mfma_f32_16x16x32_bf16 v[224:227], a[248:251], v[184:187], v[224:227]
    s_waitcnt lgkmcnt(4)
    v_max3_f32 v248, v248, v202, v203
    v_mfma_f32_16x16x32_bf16 v[204:207], v[144:147], v[168:171], v[204:207]
    ds_read_b128 v[200:203], v246 offset:64
    v_mfma_f32_16x16x32_bf16 v[204:207], v[146:149], v[170:173], v[204:207]
    v_mfma_f32_16x16x32_bf16 v[232:235], a[196:199], a[220:223], v[232:235]
    ds_read_b128 a[220:223], v243 offset:12416
    v_mfma_f32_16x16x32_bf16 v[232:235], a[200:203], a[224:227], v[232:235]
    ds_read_b128 a[224:227], v242 offset:12544
    v_mfma_f32_16x16x32_bf16 v[232:235], a[204:207], a[228:231], v[232:235]
    ds_read_b128 a[228:231], v243 offset:12544
    s_waitcnt lgkmcnt(6)
    v_mfma_f32_16x16x32_bf16 v[208:211], v[102:105], v[168:171], v[208:211]
    v_rcp_f32 v225, v224
    v_mfma_f32_16x16x32_bf16 v[208:211], v[104:107], v[170:173], v[208:211]
    v_mul_f32 v212, v212, v225
    v_mul_f32 v213, v213, v225
    v_mfma_f32_16x16x32_bf16 v[232:235], a[208:211], a[232:235], v[232:235]
    ds_read_b128 a[232:235], v242 offset:6144
    v_mul_f32 v214, v214, v225
    v_mfma_f32_16x16x32_bf16 v[232:235], a[212:215], a[236:239], v[232:235]
    ds_read_b128 a[236:239], v243 offset:6144
    v_mul_f32 v215, v215, v225
    v_mfma_f32_16x16x32_bf16 v[236:239], a[144:147], a[240:243], 0
    s_waitcnt lgkmcnt(5)
    v_cvt_pk_bf16_f32 v212, v212, v213
    v_cvt_pk_bf16_f32 v213, v214, v215
    v_mfma_f32_16x16x32_bf16 v[196:199], v[114:117], v[168:171], v[196:199]
    ds_write_b64 v247, v[212:213] offset:30720
    v_mfma_f32_16x16x32_bf16 v[196:199], v[116:119], v[170:173], v[196:199]
    v_cvt_pk_bf16_f32 v232, v232, v233
    v_cvt_pk_bf16_f32 v233, v234, v235
    v_mfma_f32_16x16x32_bf16 v[200:203], v[150:153], v[168:171], v[200:203]
    ds_write_b64 v249, v[232:233] offset:12544
    v_mfma_f32_16x16x32_bf16 v[200:203], v[152:155], v[170:173], v[200:203]
    s_waitcnt lgkmcnt(4)
    v_mul_f32 v216, v216, v225
    v_mul_f32 v217, v217, v225
    v_mfma_f32_16x16x32_bf16 v[236:239], a[148:151], a[244:247], v[236:239]
    v_mul_f32 v218, v218, v225
    v_mul_f32 v219, v219, v225
    v_mfma_f32_16x16x32_bf16 v[236:239], a[152:155], a[216:219], v[236:239]
    v_cvt_pk_bf16_f32 v216, v216, v217
    v_cvt_pk_bf16_f32 v217, v218, v219
    v_mfma_f32_16x16x32_bf16 v[236:239], a[156:159], a[220:223], v[236:239]
    ds_write_b64 v247, v[216:217] offset:30848
    v_mfma_f32_16x16x32_bf16 v[236:239], a[160:163], a[224:227], v[236:239]
    s_waitcnt lgkmcnt(3)
    v_mul_f32 v220, v220, v225
    v_mul_f32 v221, v221, v225
    v_mfma_f32_16x16x32_bf16 v[236:239], a[164:167], a[228:231], v[236:239]
    v_mul_f32 v222, v222, v225
    v_mul_f32 v223, v223, v225
    v_mfma_f32_16x16x32_bf16 v[228:231], a[168:171], a[240:243], 0
    v_cvt_pk_bf16_f32 v220, v220, v221
    v_cvt_pk_bf16_f32 v221, v222, v223
    v_mfma_f32_16x16x32_bf16 v[228:231], a[172:175], a[244:247], v[228:231]
    ds_write_b64 v247, v[220:221] offset:30976
    v_mfma_f32_16x16x32_bf16 v[228:231], a[176:179], a[216:219], v[228:231]
    v_cvt_pk_bf16_f32 v236, v236, v237
    v_cvt_pk_bf16_f32 v237, v238, v239
    v_mfma_f32_16x16x32_bf16 v[228:231], a[180:183], a[220:223], v[228:231]
    ds_write_b64 v249, v[236:237] offset:18432
    v_mfma_f32_16x16x32_bf16 v[228:231], a[184:187], a[224:227], v[228:231]
    v_max3_f32 v248, v248, v204, v205
    v_max3_f32 v248, v248, v206, v207
    v_mfma_f32_16x16x32_bf16 v[228:231], a[188:191], a[228:231], v[228:231]
    ds_read_b128 v[204:207], v244 offset:128
    v_max3_f32 v248, v248, v208, v209
    v_mfma_f32_16x16x32_bf16 v[232:235], a[192:195], a[240:243], 0
    ds_read_b128 a[240:243], v242 offset:6272
    v_max3_f32 v248, v248, v210, v211
    v_mfma_f32_16x16x32_bf16 v[232:235], a[196:199], a[244:247], v[232:235]
    ds_read_b128 a[244:247], v243 offset:6272
    ds_read_b128 v[208:211], v245 offset:128
    v_mfma_f32_16x16x32_bf16 v[232:235], a[200:203], a[216:219], v[232:235]
    ds_read_b128 a[216:219], v242 offset:6400
    v_cvt_pk_bf16_f32 v228, v228, v229
    v_mfma_f32_16x16x32_bf16 v[232:235], a[204:207], a[220:223], v[232:235]
    ds_read_b128 a[220:223], v243 offset:6400
    v_cvt_pk_bf16_f32 v229, v230, v231
    v_mfma_f32_16x16x32_bf16 v[232:235], a[208:211], a[224:227], v[232:235]
    ds_write_b64 v249, v[228:229] offset:18560
    v_mfma_f32_16x16x32_bf16 v[232:235], a[212:215], a[228:231], v[232:235]
    ds_read_b128 a[224:227], v242 offset:18432
    ds_read_b128 a[228:231], v243 offset:18432
    v_mfma_f32_16x16x32_bf16 v[236:239], a[144:147], a[232:235], 0
    v_max3_f32 v248, v248, v196, v197
    v_max3_f32 v248, v248, v198, v199
    v_mfma_f32_16x16x32_bf16 v[236:239], a[148:151], a[236:239], v[236:239]
    ds_read_b128 v[196:199], v246 offset:128
    v_max3_f32 v248, v248, v200, v201
    v_mfma_f32_16x16x32_bf16 v[228:231], a[168:171], a[232:235], 0
    s_waitcnt lgkmcnt(8)
    v_cvt_pk_bf16_f32 v232, v232, v233
    v_cvt_pk_bf16_f32 v233, v234, v235
    v_mfma_f32_16x16x32_bf16 v[204:207], v[108:111], v[168:171], v[204:207]
    ds_write_b64 v249, v[232:233] offset:18688
    v_mfma_f32_16x16x32_bf16 v[204:207], v[110:113], v[170:173], v[204:207]
    s_waitcnt lgkmcnt(7)
    v_max3_f32 v248, v248, v202, v203
    v_mfma_f32_16x16x32_bf16 v[208:211], v[120:123], v[168:171], v[208:211]
    ds_read_b128 v[200:203], v244 offset:0
    v_mfma_f32_16x16x32_bf16 v[208:211], v[122:125], v[170:173], v[208:211]
    s_waitcnt lgkmcnt(7)
    v_mfma_f32_16x16x32_bf16 v[236:239], a[152:155], a[240:243], v[236:239]
    s_waitcnt lgkmcnt(6)
    v_max3_f32 v248, v248, v204, v205
    v_mfma_f32_16x16x32_bf16 v[236:239], a[156:159], a[244:247], v[236:239]
    ds_read_b128 v[204:207], v245 offset:0
    v_mfma_f32_16x16x32_bf16 v[236:239], a[160:163], a[216:219], v[236:239]
    s_waitcnt lgkmcnt(5)
    v_max3_f32 v248, v248, v208, v209
    v_mfma_f32_16x16x32_bf16 v[236:239], a[164:167], a[220:223], v[236:239]
    ds_read_b128 v[208:211], v246 offset:0
    s_waitcnt lgkmcnt(4)
    v_mfma_f32_16x16x32_bf16 v[196:199], v[156:159], v[168:171], v[196:199]
    v_mfma_f32_16x16x32_bf16 v[196:199], v[158:161], v[170:173], v[196:199]
    v_mfma_f32_16x16x32_bf16 v[228:231], a[172:175], a[236:239], v[228:231]
    v_mfma_f32_16x16x32_bf16 v[228:231], a[176:179], a[240:243], v[228:231]
    s_waitcnt lgkmcnt(2)
    v_mfma_f32_16x16x32_bf16 v[200:203], v[162:165], v[168:171], v[200:203]
    v_cvt_pk_bf16_f32 v236, v236, v237
    v_cvt_pk_bf16_f32 v237, v238, v239
    v_mfma_f32_16x16x32_bf16 v[200:203], v[164:167], v[170:173], v[200:203]
    ds_write_b64 v249, v[236:237] offset:24576
    v_mfma_f32_16x16x32_bf16 v[228:231], a[180:183], a[244:247], v[228:231]
    s_waitcnt lgkmcnt(2)
    v_max3_f32 v248, v248, v196, v197
    v_mov_b32 v225, v248
    v_mfma_f32_16x16x32_bf16 v[204:207], v[138:141], v[168:171], v[204:207]
    ds_read_b128 v[196:199], v244 offset:64
    v_permlane16_swap_b32 v248, v225
    v_mfma_f32_16x16x32_bf16 v[204:207], v[140:143], v[170:173], v[204:207]
    s_waitcnt lgkmcnt(2)
    v_max_f32 v248, v248, v225
    v_mov_b32 v225, v248
    v_mfma_f32_16x16x32_bf16 v[208:211], v[144:147], v[168:171], v[208:211]
    v_mfma_f32_16x16x32_bf16 v[208:211], v[146:149], v[170:173], v[208:211]
    v_permlane32_swap_b32 v248, v225
    v_max_f32 v248, v248, v225
    v_mfma_f32_16x16x32_bf16 v[228:231], a[184:187], a[216:219], v[228:231]
    v_sub_f32 v200, v200, v248
    v_sub_f32 v201, v201, v248
    v_mfma_f32_16x16x32_bf16 v[228:231], a[188:191], a[220:223], v[228:231]
    v_exp_f32 v200, v200
    v_mfma_f32_16x16x32_bf16 v[232:235], a[192:195], a[232:235], 0
    ds_read_b128 a[232:235], v242 offset:18560
    v_sub_f32 v202, v202, v248
    v_mfma_f32_16x16x32_bf16 v[232:235], a[196:199], a[236:239], v[232:235]
    ds_read_b128 a[236:239], v243 offset:18560
    v_sub_f32 v203, v203, v248
    v_mfma_f32_16x16x32_bf16 v[232:235], a[200:203], a[240:243], v[232:235]
    ds_read_b128 a[240:243], v242 offset:18688
    v_cvt_pk_bf16_f32 v228, v228, v229
    v_mfma_f32_16x16x32_bf16 v[232:235], a[204:207], a[244:247], v[232:235]
    ds_read_b128 a[244:247], v243 offset:18688
    v_cvt_pk_bf16_f32 v229, v230, v231
    v_mfma_f32_16x16x32_bf16 v[232:235], a[208:211], a[216:219], v[232:235]
    ds_write_b64 v249, v[228:229] offset:24704
    v_mfma_f32_16x16x32_bf16 v[232:235], a[212:215], a[220:223], v[232:235]
    ds_read_b128 a[216:219], v242 offset:24576
    ds_read_b128 a[220:223], v243 offset:24576
    v_mfma_f32_16x16x32_bf16 v[236:239], a[144:147], a[224:227], 0
    s_waitcnt lgkmcnt(7)
    v_exp_f32 v201, v201
    v_mfma_f32_16x16x32_bf16 v[196:199], v[102:105], v[168:171], v[196:199]
    v_exp_f32 v202, v202
    v_mfma_f32_16x16x32_bf16 v[196:199], v[104:107], v[170:173], v[196:199]
    v_cvt_pk_bf16_f32 v232, v232, v233
    v_cvt_pk_bf16_f32 v233, v234, v235
    v_mfma_f32_16x16x32_bf16 v[236:239], a[148:151], a[228:231], v[236:239]
    ds_write_b64 v249, v[232:233] offset:24832
    v_mfma_f32_16x16x32_bf16 v[228:231], a[168:171], a[224:227], 0
    s_waitcnt lgkmcnt(7)
    v_exp_f32 v203, v203
    v_mfma_f32_16x16x32_bf16 v[236:239], a[152:155], a[232:235], v[236:239]
    s_waitcnt lgkmcnt(6)
    v_cvt_pk_bf16_f32 v190, v200, v201
    v_cvt_pk_bf16_f32 v193, v202, v203
    v_mfma_f32_16x16x32_bf16 v[236:239], a[156:159], a[236:239], v[236:239]
    ds_read_b128 v[200:203], v245 offset:64
    v_sub_f32 v204, v204, v248
    v_mfma_f32_16x16x32_bf16 v[228:231], a[172:175], a[228:231], v[228:231]
    s_waitcnt lgkmcnt(6)
    v_exp_f32 v204, v204
    v_mfma_f32_16x16x32_bf16 v[236:239], a[160:163], a[240:243], v[236:239]
    s_waitcnt lgkmcnt(5)
    v_sub_f32 v205, v205, v248
    v_sub_f32 v206, v206, v248
    v_mfma_f32_16x16x32_bf16 v[236:239], a[164:167], a[244:247], v[236:239]
    s_waitcnt lgkmcnt(3)
    v_exp_f32 v205, v205
    v_mfma_f32_16x16x32_bf16 v[228:231], a[176:179], a[232:235], v[228:231]
    s_waitcnt lgkmcnt(2)
    v_exp_f32 v206, v206
    v_mfma_f32_16x16x32_bf16 v[228:231], a[180:183], a[236:239], v[228:231]
    s_waitcnt lgkmcnt(1)
    s_barrier
    v_mfma_f32_16x16x32_bf16 v[228:231], a[184:187], a[240:243], v[228:231]
    ds_read_b128 a[252:255], v252 offset:12288
    v_cvt_pk_bf16_f32 v236, v236, v237
    v_mfma_f32_16x16x32_bf16 v[228:231], a[188:191], a[244:247], v[228:231]
    ds_read_b64 v[254:255], v253 offset:12544
    v_cvt_pk_bf16_f32 v237, v238, v239
    v_mfma_f32_16x16x32_bf16 v[232:235], a[192:195], a[224:227], 0
    ds_write_b64 v249, v[236:237] offset:0
    v_mfma_f32_16x16x32_bf16 v[232:235], a[196:199], a[228:231], v[232:235]
    ds_read_b128 a[224:227], v242 offset:24704
    ds_read_b128 a[228:231], v243 offset:24704
    v_mfma_f32_16x16x32_bf16 v[232:235], a[200:203], a[232:235], v[232:235]
    ds_read_b128 a[232:235], v242 offset:24832
    v_cvt_pk_bf16_f32 v228, v228, v229
    v_mfma_f32_16x16x32_bf16 v[232:235], a[204:207], a[236:239], v[232:235]
    ds_read_b128 a[236:239], v243 offset:24832
    v_cvt_pk_bf16_f32 v229, v230, v231
    v_mfma_f32_16x16x32_bf16 v[232:235], a[208:211], a[240:243], v[232:235]
    ds_write_b64 v249, v[228:229] offset:128
    v_mfma_f32_16x16x32_bf16 v[232:235], a[212:215], a[244:247], v[232:235]
    s_waitcnt lgkmcnt(8)
    ds_read_b128 a[240:243], v242 offset:30720
    v_mfma_f32_16x16x32_bf16 v[200:203], v[114:117], v[168:171], v[200:203]
    ds_read_b128 a[244:247], v243 offset:30720
    s_waitcnt lgkmcnt(8)
    v_mfma_f32_16x16x32_bf16 v[200:203], v[116:119], v[170:173], v[200:203]
    buffer_store_dwordx4 a[252:255], v250, s[20:23], s52 offen nt
    v_sub_f32 v207, v207, v248
    v_cvt_pk_bf16_f32 v232, v232, v233
    v_cvt_pk_bf16_f32 v233, v234, v235
    ds_write_b64 v249, v[232:233] offset:256
    ds_read_b128 a[252:255], v252 offset:18432
    buffer_store_dwordx2 v[254:255], v251, s[20:23], s52 offen offset:256 nt
    ds_read_b64 v[254:255], v253 offset:18688
    s_mul_i32 s52, s31, 11
    s_add_u32 s51, s51, s52
    s_add_u32 s51, s51, s32
    s_add_u32 s52, s28, 7
    s_mul_i32 s52, s52, s30
    v_exp_f32 v207, v207
    v_cvt_pk_bf16_f32 v188, v204, v205
    v_cvt_pk_bf16_f32 v191, v206, v207
    ds_read_b128 v[204:207], v246 offset:64
    v_sub_f32 v208, v208, v248
    v_exp_f32 v208, v208
    v_sub_f32 v209, v209, v248
    v_exp_f32 v209, v209
    v_sub_f32 v210, v210, v248
    v_exp_f32 v210, v210
    v_sub_f32 v211, v211, v248
    v_exp_f32 v211, v211
    v_cvt_pk_bf16_f32 v189, v208, v209
    v_cvt_pk_bf16_f32 v192, v210, v211
    ds_read_b128 v[208:211], v244 offset:128
    v_mfma_f32_16x16x32_bf16 v[212:215], v[12:15], v[188:191], 0
    s_waitcnt lgkmcnt(3)
    s_waitcnt lgkmcnt(2)
    v_sub_f32 v196, v196, v248
    v_mfma_f32_16x16x32_bf16 v[216:219], v[42:45], v[188:191], 0
    buffer_store_dwordx4 a[252:255], v250, s[20:23], s54 offen nt
    v_mfma_f32_16x16x32_bf16 v[220:223], v[72:75], v[188:191], 0
    v_exp_f32 v196, v196
    v_mfma_f32_16x16x32_bf16 v[224:227], a[248:251], v[188:191], 0
    s_waitcnt lgkmcnt(1)
    ds_read_b128 a[252:255], v252 offset:24576
    v_mfma_f32_16x16x32_bf16 v[204:207], v[150:153], v[168:171], v[204:207]
    buffer_store_dwordx2 v[254:255], v251, s[20:23], s54 offen offset:256 nt
    v_mfma_f32_16x16x32_bf16 v[204:207], v[152:155], v[170:173], v[204:207]
    ds_read_b64 v[254:255], v253 offset:24832
    s_mul_i32 s54, s31, 3
    s_add_u32 s53, s53, s54
    s_add_u32 s53, s53, s32
    s_add_u32 s54, s28, 11
    s_waitcnt lgkmcnt(2)
    v_mfma_f32_16x16x32_bf16 v[208:211], v[108:111], v[168:171], v[208:211]
    s_mul_i32 s54, s54, s30
    v_sub_f32 v197, v197, v248
    v_sub_f32 v198, v198, v248
    v_mfma_f32_16x16x32_bf16 v[208:211], v[110:113], v[170:173], v[208:211]
    v_exp_f32 v197, v197
    v_exp_f32 v198, v198
    v_sub_f32 v199, v199, v248
    v_exp_f32 v199, v199
    v_cvt_pk_bf16_f32 v180, v196, v197
    v_cvt_pk_bf16_f32 v183, v198, v199
    ds_read_b128 v[196:199], v245 offset:128
    s_waitcnt lgkmcnt(2)
    buffer_store_dwordx4 a[252:255], v250, s[20:23], s56 offen nt
    v_sub_f32 v200, v200, v248
    s_waitcnt lgkmcnt(1)
    v_exp_f32 v200, v200
    v_sub_f32 v201, v201, v248
    v_exp_f32 v201, v201
    v_sub_f32 v202, v202, v248
    v_exp_f32 v202, v202
    buffer_store_dwordx2 v[254:255], v251, s[20:23], s56 offen offset:256 nt
    s_mul_i32 s56, s31, 7
    s_add_u32 s55, s55, s56
    s_add_u32 s55, s55, s32
    s_add_u32 s56, s28, 11
    s_mul_i32 s56, s56, s30
    v_sub_f32 v203, v203, v248
    v_exp_f32 v203, v203
    v_cvt_pk_bf16_f32 v194, v200, v201
    s_waitcnt lgkmcnt(0)
    v_mfma_f32_16x16x32_bf16 v[196:199], v[120:123], v[168:171], v[196:199]
    v_cvt_pk_bf16_f32 v181, v202, v203
    v_sub_f32 v204, v204, v248
    v_mfma_f32_16x16x32_bf16 v[196:199], v[122:125], v[170:173], v[196:199]
    ds_read_b128 v[200:203], v246 offset:128
    v_exp_f32 v204, v204
    v_sub_f32 v205, v205, v248
    v_exp_f32 v205, v205
    v_sub_f32 v206, v206, v248
    v_exp_f32 v206, v206
    v_sub_f32 v207, v207, v248
    v_exp_f32 v207, v207
    v_cvt_pk_bf16_f32 v195, v204, v205
    v_cvt_pk_bf16_f32 v182, v206, v207
    ds_read_b128 v[204:207], v244 offset:0
    v_mfma_f32_16x16x32_bf16 v[212:215], v[16:19], v[192:195], v[212:215]
    v_sub_f32 v208, v208, v248
    v_sub_f32 v209, v209, v248
    v_mfma_f32_16x16x32_bf16 v[216:219], v[46:49], v[192:195], v[216:219]
    v_exp_f32 v208, v208
    v_mfma_f32_16x16x32_bf16 v[220:223], v[76:79], v[192:195], v[220:223]
    v_exp_f32 v209, v209
    v_mfma_f32_16x16x32_bf16 v[224:227], a[248:251], v[192:195], v[224:227]
    v_cvt_pk_bf16_f32 v186, v208, v209
    v_sub_f32 v196, v196, v248
    v_mfma_f32_16x16x32_bf16 v[212:215], v[20:23], v[180:183], v[212:215]
    ds_read_b128 v[208:211], v245 offset:0
    v_sub_f32 v197, v197, v248
    v_mfma_f32_16x16x32_bf16 v[216:219], v[50:53], v[180:183], v[216:219]
    s_waitcnt lgkmcnt(2)
    v_exp_f32 v196, v196
    v_mfma_f32_16x16x32_bf16 v[220:223], v[80:83], v[180:183], v[220:223]
    v_exp_f32 v197, v197
    v_mfma_f32_16x16x32_bf16 v[224:227], a[248:251], v[180:183], v[224:227]
    v_cvt_pk_bf16_f32 v184, v196, v197
    s_waitcnt lgkmcnt(1)
    v_mfma_f32_16x16x32_bf16 v[200:203], v[156:159], v[168:171], v[200:203]
    ds_read_b128 v[196:199], v246 offset:0
    ds_read_b64 v[168:169], v247 offset:49152
    v_mfma_f32_16x16x32_bf16 v[200:203], v[158:161], v[170:173], v[200:203]
    ds_read_b64 v[170:171], v247 offset:49280
    ds_read_b64 v[172:173], v247 offset:49408
    v_mfma_f32_16x16x32_bf16 v[204:207], v[102:105], v[174:177], v[204:207]
    v_mfma_f32_16x16x32_bf16 v[204:207], v[104:107], v[176:179], v[204:207]
    s_nop 3
    s_waitcnt lgkmcnt(4)
    v_mfma_f32_16x16x32_bf16 v[208:211], v[114:117], v[174:177], v[208:211]
    v_sub_f32 v200, v200, v248
    v_sub_f32 v201, v201, v248
    v_mfma_f32_16x16x32_bf16 v[208:211], v[116:119], v[176:179], v[208:211]
    v_exp_f32 v200, v200
    v_exp_f32 v201, v201
    v_max_f32 v248, v204, v205
    v_cvt_pk_bf16_f32 v185, v200, v201
    ds_read_b128 v[200:203], v244 offset:64
    s_waitcnt lgkmcnt(4)
    v_mfma_f32_16x16x32_bf16 v[212:215], v[24:27], v[184:187], v[212:215]
    v_max3_f32 v248, v248, v206, v207
    v_max3_f32 v248, v248, v208, v209
    v_mfma_f32_16x16x32_bf16 v[216:219], v[54:57], v[184:187], v[216:219]
    ds_read_b128 v[204:207], v245 offset:64
    v_max3_f32 v248, v248, v210, v211
    v_mfma_f32_16x16x32_bf16 v[220:223], v[84:87], v[184:187], v[220:223]
    ds_read_b128 v[208:211], v246 offset:64
    v_mfma_f32_16x16x32_bf16 v[224:227], a[248:251], v[184:187], v[224:227]
    s_waitcnt lgkmcnt(3)
    v_mov_b32 v186, 0
    v_mfma_f32_16x16x32_bf16 v[196:199], v[150:153], v[174:177], v[196:199]
    v_mfma_f32_16x16x32_bf16 v[196:199], v[152:155], v[176:179], v[196:199]
    s_nop 3
    v_rcp_f32 v225, v224
    s_nop 0
    v_mul_f32 v212, v212, v225
    v_mul_f32 v213, v213, v225
    s_waitcnt lgkmcnt(2)
    v_mfma_f32_16x16x32_bf16 v[200:203], v[108:111], v[174:177], v[200:203]
    v_mul_f32 v214, v214, v225
    v_mul_f32 v215, v215, v225
    v_mfma_f32_16x16x32_bf16 v[200:203], v[110:113], v[176:179], v[200:203]
    v_cvt_pk_bf16_f32 v212, v212, v213
    s_waitcnt lgkmcnt(1)
    v_mfma_f32_16x16x32_bf16 v[204:207], v[120:123], v[174:177], v[204:207]
    v_cvt_pk_bf16_f32 v213, v214, v215
    v_mul_f32 v216, v216, v225
    v_mfma_f32_16x16x32_bf16 v[204:207], v[122:125], v[176:179], v[204:207]
    s_waitcnt lgkmcnt(0)
    v_mul_f32 v217, v217, v225
    v_mul_f32 v218, v218, v225
    v_mfma_f32_16x16x32_bf16 v[208:211], v[156:159], v[174:177], v[208:211]
    ds_write_b64 v247, v[212:213] offset:36864
    v_mfma_f32_16x16x32_bf16 v[208:211], v[158:161], v[176:179], v[208:211]
    v_mul_f32 v219, v219, v225
    v_cvt_pk_bf16_f32 v216, v216, v217
    v_cvt_pk_bf16_f32 v217, v218, v219
    ds_write_b64 v247, v[216:217] offset:36992
    v_mul_f32 v220, v220, v225
    v_mul_f32 v221, v221, v225
    v_mul_f32 v222, v222, v225
    v_mul_f32 v223, v223, v225
    v_cvt_pk_bf16_f32 v220, v220, v221
    v_cvt_pk_bf16_f32 v221, v222, v223
    ds_write_b64 v247, v[220:221] offset:37120
    v_max3_f32 v248, v248, v196, v197
    v_max3_f32 v248, v248, v198, v199
    ds_read_b128 v[196:199], v244 offset:0
    v_max3_f32 v248, v248, v200, v201
    v_max3_f32 v248, v248, v202, v203
    ds_read_b128 v[200:203], v245 offset:0
    v_max3_f32 v248, v248, v204, v205
    v_max3_f32 v248, v248, v206, v207
    ds_read_b128 v[204:207], v246 offset:0
    v_max3_f32 v248, v248, v208, v209
    v_max3_f32 v248, v248, v210, v211
    ds_read_b128 v[208:211], v244 offset:64
    v_mov_b32 v225, v248
    s_nop 1
    v_permlane16_swap_b32 v248, v225
    v_max_f32 v248, v248, v225
    v_mov_b32 v225, v248
    s_nop 1
    v_permlane32_swap_b32 v248, v225
    v_max_f32 v248, v248, v225
    s_waitcnt lgkmcnt(3)
    v_mfma_f32_16x16x32_bf16 v[196:199], v[102:105], v[174:177], v[196:199]
    v_mfma_f32_16x16x32_bf16 v[196:199], v[104:107], v[176:179], v[196:199]
    s_waitcnt lgkmcnt(2)
    v_mfma_f32_16x16x32_bf16 v[200:203], v[114:117], v[174:177], v[200:203]
    s_waitcnt lgkmcnt(1)
    v_mfma_f32_16x16x32_bf16 v[200:203], v[116:119], v[176:179], v[200:203]
    v_mfma_f32_16x16x32_bf16 v[204:207], v[150:153], v[174:177], v[204:207]
    s_waitcnt lgkmcnt(0)
    v_mfma_f32_16x16x32_bf16 v[204:207], v[152:155], v[176:179], v[204:207]
    v_mfma_f32_16x16x32_bf16 v[208:211], v[108:111], v[174:177], v[208:211]
    v_sub_f32 v196, v196, v248
    v_sub_f32 v197, v197, v248
    v_mfma_f32_16x16x32_bf16 v[208:211], v[110:113], v[176:179], v[208:211]
    v_exp_f32 v196, v196
    v_exp_f32 v197, v197
    v_sub_f32 v198, v198, v248
    v_exp_f32 v198, v198
    v_sub_f32 v199, v199, v248
    v_exp_f32 v199, v199
    v_cvt_pk_bf16_f32 v190, v196, v197
    v_cvt_pk_bf16_f32 v193, v198, v199
    ds_read_b128 v[196:199], v245 offset:64
    v_sub_f32 v200, v200, v248
    v_exp_f32 v200, v200
    v_sub_f32 v201, v201, v248
    v_exp_f32 v201, v201
    v_sub_f32 v202, v202, v248
    v_exp_f32 v202, v202
    v_sub_f32 v203, v203, v248
    v_exp_f32 v203, v203
    v_cvt_pk_bf16_f32 v188, v200, v201
    v_cvt_pk_bf16_f32 v191, v202, v203
    ds_read_b128 v[200:203], v246 offset:64
    v_sub_f32 v204, v204, v248
    v_exp_f32 v204, v204
    v_sub_f32 v205, v205, v248
    v_exp_f32 v205, v205
    v_sub_f32 v206, v206, v248
    v_exp_f32 v206, v206
    v_sub_f32 v207, v207, v248
    v_exp_f32 v207, v207
    v_cvt_pk_bf16_f32 v189, v204, v205
    v_cvt_pk_bf16_f32 v192, v206, v207
    s_waitcnt lgkmcnt(1)
    v_mfma_f32_16x16x32_bf16 v[212:215], v[18:21], v[188:191], 0
    v_sub_f32 v208, v208, v248
    v_sub_f32 v209, v209, v248
    v_mfma_f32_16x16x32_bf16 v[216:219], v[48:51], v[188:191], 0
    v_exp_f32 v208, v208
    v_mfma_f32_16x16x32_bf16 v[220:223], v[78:81], v[188:191], 0
    v_exp_f32 v209, v209
    v_mfma_f32_16x16x32_bf16 v[224:227], a[248:251], v[188:191], 0
    v_sub_f32 v210, v210, v248
    v_sub_f32 v211, v211, v248
    v_mfma_f32_16x16x32_bf16 v[196:199], v[120:123], v[174:177], v[196:199]
    s_waitcnt lgkmcnt(0)
    v_exp_f32 v210, v210
    v_mfma_f32_16x16x32_bf16 v[196:199], v[122:125], v[176:179], v[196:199]
    v_exp_f32 v211, v211
    v_mfma_f32_16x16x32_bf16 v[200:203], v[156:159], v[174:177], v[200:203]
    ds_read_b64 v[174:175], v247 offset:55296
    v_cvt_pk_bf16_f32 v180, v208, v209
    v_mfma_f32_16x16x32_bf16 v[200:203], v[158:161], v[176:179], v[200:203]
    ds_read_b64 v[176:177], v247 offset:55424
    ds_read_b64 v[178:179], v247 offset:55552
    v_cvt_pk_bf16_f32 v183, v210, v211
    v_sub_f32 v196, v196, v248
    v_exp_f32 v196, v196
    v_sub_f32 v197, v197, v248
    v_exp_f32 v197, v197
    v_sub_f32 v198, v198, v248
    v_exp_f32 v198, v198
    v_sub_f32 v199, v199, v248
    v_exp_f32 v199, v199
    v_cvt_pk_bf16_f32 v194, v196, v197
    v_cvt_pk_bf16_f32 v181, v198, v199
    v_sub_f32 v200, v200, v248
    v_exp_f32 v200, v200
    v_sub_f32 v201, v201, v248
    v_exp_f32 v201, v201
    v_sub_f32 v202, v202, v248
    v_exp_f32 v202, v202
    v_sub_f32 v203, v203, v248
    v_exp_f32 v203, v203
    v_cvt_pk_bf16_f32 v195, v200, v201
    v_cvt_pk_bf16_f32 v182, v202, v203
    v_mov_b32 v204, 0x237c0
    v_mfma_f32_16x16x32_bf16 v[212:215], v[22:25], v[192:195], v[212:215]
    s_waitcnt lgkmcnt(2)
    v_add_u32 v205, 0xfffff900, v245
    v_cndmask_b32 v205, v244, v205, vcc
    v_mfma_f32_16x16x32_bf16 v[216:219], v[52:55], v[192:195], v[216:219]
    s_mov_b32 vcc_lo, 0xff00ff00
    v_add_u32 v206, 0xc0, v205
    v_add_u32 v205, 0x340, v205
    v_mfma_f32_16x16x32_bf16 v[220:223], v[82:85], v[192:195], v[220:223]
    s_mov_b32 vcc_hi, 0xff00ff00
    v_cndmask_b32 v244, v206, v205, vcc
    v_add_u32 v245, 0x700, v244
    v_mfma_f32_16x16x32_bf16 v[224:227], a[248:251], v[192:195], v[224:227]
    s_mov_b32 vcc_lo, 0xf0f0
    s_mov_b32 vcc_hi, 0x0
    v_cndmask_b32 v244, v244, v204, vcc
    v_mfma_f32_16x16x32_bf16 v[212:215], v[26:29], v[180:183], v[212:215]
    ds_read_b128 v[196:199], v244 offset:64
    s_mov_b32 vcc_lo, 0x0
    v_mfma_f32_16x16x32_bf16 v[216:219], v[56:59], v[180:183], v[216:219]
    s_mov_b32 vcc_hi, 0xf0f0000
    v_cndmask_b32 v245, v245, v204, vcc
    v_mov_b32 v189, 0
    v_mfma_f32_16x16x32_bf16 v[220:223], v[86:89], v[180:183], v[220:223]
    ds_read_b128 v[204:207], v244 offset:0
    ds_read_b128 v[208:211], v245 offset:0
    v_mfma_f32_16x16x32_bf16 v[224:227], a[248:251], v[180:183], v[224:227]
    ds_read_b128 v[200:203], v245 offset:64
    v_mov_b32 v192, 0
    v_mov_b32 v195, 0
    v_mov_b32 v182, 0
    s_mov_b32 vcc_lo, 0xff000f
    s_mov_b32 vcc_hi, 0xff00ff
    s_nop 1
    v_rcp_f32 v225, v224
    s_nop 0
    v_mul_f32 v212, v212, v225
    v_mul_f32 v213, v213, v225
    v_mul_f32 v214, v214, v225
    v_mul_f32 v215, v215, v225
    v_cvt_pk_bf16_f32 v212, v212, v213
    v_cvt_pk_bf16_f32 v213, v214, v215
    ds_write_b64 v247, v[212:213] offset:43008
    s_waitcnt lgkmcnt(4)
    v_mfma_f32_16x16x32_bf16 v[196:199], v[90:93], v[168:171], v[196:199]
    v_mul_f32 v216, v216, v225
    v_mul_f32 v217, v217, v225
    v_mfma_f32_16x16x32_bf16 v[196:199], v[92:95], v[170:173], v[196:199]
    s_waitcnt lgkmcnt(3)
    v_mul_f32 v218, v218, v225
    v_mul_f32 v219, v219, v225
    v_mfma_f32_16x16x32_bf16 v[204:207], v[96:99], v[168:171], v[204:207]
    s_waitcnt lgkmcnt(2)
    v_cvt_pk_bf16_f32 v216, v216, v217
    v_cvt_pk_bf16_f32 v217, v218, v219
    v_mfma_f32_16x16x32_bf16 v[204:207], v[98:101], v[170:173], v[204:207]
    ds_write_b64 v247, v[216:217] offset:43136
    v_mfma_f32_16x16x32_bf16 v[208:211], v[132:135], v[168:171], v[208:211]
    s_waitcnt lgkmcnt(2)
    v_mul_f32 v220, v220, v225
    v_mul_f32 v221, v221, v225
    v_mfma_f32_16x16x32_bf16 v[208:211], v[134:137], v[170:173], v[208:211]
    v_mul_f32 v222, v222, v225
    v_mul_f32 v223, v223, v225
    v_mfma_f32_16x16x32_bf16 v[200:203], v[126:129], v[168:171], v[200:203]
    v_cvt_pk_bf16_f32 v220, v220, v221
    v_cvt_pk_bf16_f32 v221, v222, v223
    v_mfma_f32_16x16x32_bf16 v[200:203], v[128:131], v[170:173], v[200:203]
    ds_write_b64 v247, v[220:221] offset:43264
    v_mfma_f32_16x16x32_bf16 v[236:239], a[144:147], a[216:219], 0
    v_max_f32 v248, v204, v205
    v_max3_f32 v248, v248, v206, v207
    v_mfma_f32_16x16x32_bf16 v[236:239], a[148:151], a[220:223], v[236:239]
    ds_read_b128 v[204:207], v244 offset:128
    v_max3_f32 v248, v248, v208, v209
    v_mfma_f32_16x16x32_bf16 v[236:239], a[152:155], a[224:227], v[236:239]
    v_max3_f32 v248, v248, v210, v211
    v_max3_f32 v248, v248, v196, v197
    v_mfma_f32_16x16x32_bf16 v[236:239], a[156:159], a[228:231], v[236:239]
    ds_read_b128 v[208:211], v245 offset:128
    v_max3_f32 v248, v248, v198, v199
    v_mfma_f32_16x16x32_bf16 v[236:239], a[160:163], a[232:235], v[236:239]
    ds_read_b128 v[196:199], v244 offset:192
    v_max3_f32 v248, v248, v200, v201
    v_mfma_f32_16x16x32_bf16 v[236:239], a[164:167], a[236:239], v[236:239]
    v_max3_f32 v248, v248, v202, v203
    v_mfma_f32_16x16x32_bf16 v[228:231], a[168:171], a[216:219], 0
    ds_read_b128 v[200:203], v245 offset:192
    v_mfma_f32_16x16x32_bf16 v[228:231], a[172:175], a[220:223], v[228:231]
    v_mfma_f32_16x16x32_bf16 v[228:231], a[176:179], a[224:227], v[228:231]
    v_mfma_f32_16x16x32_bf16 v[228:231], a[180:183], a[228:231], v[228:231]
    v_mfma_f32_16x16x32_bf16 v[228:231], a[184:187], a[232:235], v[228:231]
    s_waitcnt lgkmcnt(3)
    v_cvt_pk_bf16_f32 v236, v236, v237
    v_cvt_pk_bf16_f32 v237, v238, v239
    v_mfma_f32_16x16x32_bf16 v[204:207], v[138:141], v[168:171], v[204:207]
    ds_write_b64 v249, v[236:237] offset:6144
    v_mfma_f32_16x16x32_bf16 v[204:207], v[140:143], v[170:173], v[204:207]
    s_waitcnt lgkmcnt(2)
    v_mfma_f32_16x16x32_bf16 v[208:211], v[144:147], v[168:171], v[208:211]
    v_mfma_f32_16x16x32_bf16 v[208:211], v[146:149], v[170:173], v[208:211]
    s_waitcnt lgkmcnt(1)
    v_mfma_f32_16x16x32_bf16 v[196:199], v[114:117], v[168:171], v[196:199]
    v_mfma_f32_16x16x32_bf16 v[196:199], v[116:119], v[170:173], v[196:199]
    v_mfma_f32_16x16x32_bf16 v[200:203], v[150:153], v[168:171], v[200:203]
    v_mfma_f32_16x16x32_bf16 v[200:203], v[152:155], v[170:173], v[200:203]
    v_max3_f32 v248, v248, v204, v205
    v_max3_f32 v248, v248, v206, v207
    v_mfma_f32_16x16x32_bf16 v[228:231], a[188:191], a[236:239], v[228:231]
    ds_read_b128 v[204:207], v244 offset:0
    v_max3_f32 v248, v248, v208, v209
    v_mfma_f32_16x16x32_bf16 v[232:235], a[192:195], a[216:219], 0
    ds_read_b128 a[216:219], v242 offset:30848
    v_max3_f32 v248, v248, v210, v211
    v_mfma_f32_16x16x32_bf16 v[232:235], a[196:199], a[220:223], v[232:235]
    ds_read_b128 a[220:223], v243 offset:30848
    ds_read_b128 v[208:211], v245 offset:0
    v_mfma_f32_16x16x32_bf16 v[232:235], a[200:203], a[224:227], v[232:235]
    ds_read_b128 a[224:227], v242 offset:30976
    v_cvt_pk_bf16_f32 v228, v228, v229
    v_mfma_f32_16x16x32_bf16 v[232:235], a[204:207], a[228:231], v[232:235]
    ds_read_b128 a[228:231], v243 offset:30976
    v_cvt_pk_bf16_f32 v229, v230, v231
    v_mfma_f32_16x16x32_bf16 v[232:235], a[208:211], a[232:235], v[232:235]
    ds_write_b64 v249, v[228:229] offset:6272
    v_mfma_f32_16x16x32_bf16 v[232:235], a[212:215], a[236:239], v[232:235]
    ds_read_b128 a[232:235], v242 offset:0
    ds_read_b128 a[236:239], v243 offset:0
    v_mfma_f32_16x16x32_bf16 v[236:239], a[144:147], a[240:243], 0
    v_max3_f32 v248, v248, v196, v197
    v_max3_f32 v248, v248, v200, v201
    v_mfma_f32_16x16x32_bf16 v[236:239], a[148:151], a[244:247], v[236:239]
    ds_read_b128 v[196:199], v244 offset:64
    ds_read_b128 v[200:203], v245 offset:64
    v_mfma_f32_16x16x32_bf16 v[228:231], a[168:171], a[240:243], 0
    s_waitcnt lgkmcnt(9)
    v_cvt_pk_bf16_f32 v232, v232, v233
    v_cvt_pk_bf16_f32 v233, v234, v235
    v_mfma_f32_16x16x32_bf16 v[204:207], v[96:99], v[168:171], v[204:207]
    ds_write_b64 v249, v[232:233] offset:6400
    v_mfma_f32_16x16x32_bf16 v[204:207], v[98:101], v[170:173], v[204:207]
    s_waitcnt lgkmcnt(8)
    v_mov_b32 v225, v248
    v_mfma_f32_16x16x32_bf16 v[208:211], v[132:135], v[168:171], v[208:211]
    v_mfma_f32_16x16x32_bf16 v[208:211], v[134:137], v[170:173], v[208:211]
    s_waitcnt lgkmcnt(7)
    v_permlane16_swap_b32 v248, v225
    v_max_f32 v248, v248, v225
    v_mfma_f32_16x16x32_bf16 v[236:239], a[152:155], a[216:219], v[236:239]
    s_waitcnt lgkmcnt(6)
    v_mov_b32 v225, v248
    v_mfma_f32_16x16x32_bf16 v[236:239], a[156:159], a[220:223], v[236:239]
    v_mfma_f32_16x16x32_bf16 v[236:239], a[160:163], a[224:227], v[236:239]
    s_waitcnt lgkmcnt(4)
    v_permlane32_swap_b32 v248, v225
    v_max_f32 v248, v248, v225
    v_mfma_f32_16x16x32_bf16 v[236:239], a[164:167], a[228:231], v[236:239]
    s_waitcnt lgkmcnt(2)
    v_sub_f32 v204, v204, v248
    v_sub_f32 v205, v205, v248
    v_mfma_f32_16x16x32_bf16 v[196:199], v[90:93], v[168:171], v[196:199]
    s_waitcnt lgkmcnt(1)
    v_exp_f32 v204, v204
    v_mfma_f32_16x16x32_bf16 v[196:199], v[92:95], v[170:173], v[196:199]
    s_waitcnt lgkmcnt(0)
    v_cvt_pk_bf16_f32 v236, v236, v237
    v_cvt_pk_bf16_f32 v237, v238, v239
    v_mfma_f32_16x16x32_bf16 v[200:203], v[126:129], v[168:171], v[200:203]
    s_barrier
    v_mfma_f32_16x16x32_bf16 v[200:203], v[128:131], v[170:173], v[200:203]
    ds_write_b64 v249, v[236:237] offset:12288
    v_mfma_f32_16x16x32_bf16 v[228:231], a[172:175], a[244:247], v[228:231]
    ds_read_b128 a[252:255], v252 offset:0
    ds_read_b64 v[254:255], v253 offset:256
    v_mfma_f32_16x16x32_bf16 v[228:231], a[176:179], a[216:219], v[228:231]
    v_exp_f32 v205, v205
    v_mfma_f32_16x16x32_bf16 v[228:231], a[180:183], a[220:223], v[228:231]
    v_sub_f32 v206, v206, v248
    v_sub_f32 v207, v207, v248
    v_mfma_f32_16x16x32_bf16 v[228:231], a[184:187], a[224:227], v[228:231]
    v_exp_f32 v206, v206
    v_mfma_f32_16x16x32_bf16 v[228:231], a[188:191], a[228:231], v[228:231]
    v_exp_f32 v207, v207
    v_mfma_f32_16x16x32_bf16 v[232:235], a[192:195], a[240:243], 0
    ds_read_b128 a[240:243], v242 offset:128
    v_cvt_pk_bf16_f32 v184, v204, v205
    v_mfma_f32_16x16x32_bf16 v[232:235], a[196:199], a[244:247], v[232:235]
    ds_read_b128 a[244:247], v243 offset:128
    v_cvt_pk_bf16_f32 v187, v206, v207
    v_mfma_f32_16x16x32_bf16 v[232:235], a[200:203], a[216:219], v[232:235]
    ds_read_b128 a[216:219], v242 offset:256
    v_cvt_pk_bf16_f32 v228, v228, v229
    v_mfma_f32_16x16x32_bf16 v[232:235], a[204:207], a[220:223], v[232:235]
    ds_read_b128 a[220:223], v243 offset:256
    v_cvt_pk_bf16_f32 v229, v230, v231
    v_mfma_f32_16x16x32_bf16 v[232:235], a[208:211], a[224:227], v[232:235]
    ds_write_b64 v249, v[228:229] offset:12416
    v_mfma_f32_16x16x32_bf16 v[232:235], a[212:215], a[228:231], v[232:235]
    ds_read_b128 a[224:227], v242 offset:36864
    ds_read_b128 a[228:231], v243 offset:36864
    v_mfma_f32_16x16x32_bf16 v[236:239], a[144:147], a[232:235], 0
    ds_read_b128 v[204:207], v244 offset:128
    s_waitcnt lgkmcnt(8)
    v_mfma_f32_16x16x32_bf16 v[236:239], a[148:151], a[236:239], v[236:239]
    buffer_store_dwordx4 a[252:255], v250, s[20:23], s51 offen nt
    v_mfma_f32_16x16x32_bf16 v[228:231], a[168:171], a[232:235], 0
    s_waitcnt lgkmcnt(7)
    v_cvt_pk_bf16_f32 v232, v232, v233
    v_cvt_pk_bf16_f32 v233, v234, v235
    v_mfma_f32_16x16x32_bf16 v[236:239], a[152:155], a[240:243], v[236:239]
    ds_write_b64 v249, v[232:233] offset:12544
    v_mfma_f32_16x16x32_bf16 v[228:231], a[172:175], a[236:239], v[228:231]
    buffer_store_dwordx2 v[254:255], v251, s[20:23], s51 offen offset:256 nt
    v_mfma_f32_16x16x32_bf16 v[228:231], a[176:179], a[240:243], v[228:231]
    ds_read_b128 a[252:255], v252 offset:6144
    ds_read_b64 v[254:255], v253 offset:6400
    v_mfma_f32_16x16x32_bf16 v[232:235], a[192:195], a[232:235], 0
    ds_read_b128 a[232:235], v242 offset:36992
    s_mul_i32 s51, s31, 15
    v_mfma_f32_16x16x32_bf16 v[232:235], a[196:199], a[236:239], v[232:235]
    ds_read_b128 a[236:239], v243 offset:36992
    s_add_u32 s57, s57, s51
    v_mfma_f32_16x16x32_bf16 v[232:235], a[200:203], a[240:243], v[232:235]
    s_waitcnt lgkmcnt(5)
    ds_read_b128 a[240:243], v242 offset:37120
    v_mfma_f32_16x16x32_bf16 v[204:207], v[138:141], v[168:171], v[204:207]
    s_add_u32 s57, s57, s32
    s_and_b32 s51, s28, 1
    s_add_u32 s51, s51, 15
    v_mfma_f32_16x16x32_bf16 v[204:207], v[140:143], v[170:173], v[204:207]
    s_mul_i32 s51, s51, s30
    v_sub_f32 v208, v208, v248
    v_sub_f32 v209, v209, v248
    v_mfma_f32_16x16x32_bf16 v[236:239], a[156:159], a[244:247], v[236:239]
    v_exp_f32 v208, v208
    v_mfma_f32_16x16x32_bf16 v[236:239], a[160:163], a[216:219], v[236:239]
    v_exp_f32 v209, v209
    v_mfma_f32_16x16x32_bf16 v[236:239], a[164:167], a[220:223], v[236:239]
    s_waitcnt lgkmcnt(4)
    v_sub_f32 v210, v210, v248
    s_waitcnt lgkmcnt(3)
    v_mfma_f32_16x16x32_bf16 v[228:231], a[180:183], a[244:247], v[228:231]
    buffer_store_dwordx4 a[252:255], v250, s[20:23], s53 offen nt
    v_mfma_f32_16x16x32_bf16 v[228:231], a[184:187], a[216:219], v[228:231]
    s_waitcnt lgkmcnt(2)
    v_exp_f32 v210, v210
    v_mfma_f32_16x16x32_bf16 v[228:231], a[188:191], a[220:223], v[228:231]
    s_waitcnt lgkmcnt(1)
    v_cvt_pk_bf16_f32 v236, v236, v237
    v_cvt_pk_bf16_f32 v237, v238, v239
    v_mfma_f32_16x16x32_bf16 v[232:235], a[204:207], a[244:247], v[232:235]
    ds_write_b64 v249, v[236:237] offset:18432
    v_mfma_f32_16x16x32_bf16 v[232:235], a[208:211], a[216:219], v[232:235]
    ds_read_b128 a[244:247], v243 offset:37120
    ds_read_b128 a[216:219], v242 offset:43008
    v_mfma_f32_16x16x32_bf16 v[232:235], a[212:215], a[220:223], v[232:235]
    v_cvt_pk_bf16_f32 v228, v228, v229
    v_cvt_pk_bf16_f32 v229, v230, v231
    ds_write_b64 v249, v[228:229] offset:18560
    ds_read_b128 a[220:223], v243 offset:43008
    buffer_store_dwordx2 v[254:255], v251, s[20:23], s53 offen offset:256 nt
    s_mul_i32 s53, s31, 13
    s_add_u32 s52, s52, s53
    s_add_u32 s52, s52, s32
    v_cvt_pk_bf16_f32 v232, v232, v233
    v_cvt_pk_bf16_f32 v233, v234, v235
    ds_write_b64 v249, v[232:233] offset:18688
    s_lshr_b32 s53, s28, 1
    s_sub_u32 s53, s53, 1
    v_sub_f32 v211, v211, v248
    v_exp_f32 v211, v211
    v_cvt_pk_bf16_f32 v185, v208, v209
    v_cvt_pk_bf16_f32 v188, v210, v211
    ds_read_b128 v[208:211], v245 offset:128
    v_mfma_f32_16x16x32_bf16 v[212:215], v[0:3], v[184:187], 0
    s_waitcnt lgkmcnt(5)
    v_sub_f32 v196, v196, v248
    v_sub_f32 v197, v197, v248
    v_mfma_f32_16x16x32_bf16 v[216:219], v[30:33], v[184:187], 0
    s_waitcnt lgkmcnt(4)
    v_exp_f32 v196, v196
    v_mfma_f32_16x16x32_bf16 v[220:223], v[60:63], v[184:187], 0
    v_exp_f32 v197, v197
    v_mfma_f32_16x16x32_bf16 v[224:227], a[248:251], v[184:187], 0
    v_sub_f32 v198, v198, v248
    v_exp_f32 v198, v198
    v_sub_f32 v199, v199, v248
    v_exp_f32 v199, v199
    v_cvt_pk_bf16_f32 v190, v196, v197
    v_cvt_pk_bf16_f32 v193, v198, v199
    ds_read_b128 v[196:199], v244 offset:192
    v_sub_f32 v200, v200, v248
    v_exp_f32 v200, v200
    v_sub_f32 v201, v201, v248
    v_exp_f32 v201, v201
    s_waitcnt lgkmcnt(1)
    v_mfma_f32_16x16x32_bf16 v[208:211], v[144:147], v[168:171], v[208:211]
    v_sub_f32 v202, v202, v248
    v_sub_f32 v203, v203, v248
    v_mfma_f32_16x16x32_bf16 v[208:211], v[146:149], v[170:173], v[208:211]
    v_exp_f32 v202, v202
    v_exp_f32 v203, v203
    v_cvt_pk_bf16_f32 v191, v200, v201
    v_cvt_pk_bf16_f32 v194, v202, v203
    ds_read_b128 v[200:203], v245 offset:192
    v_mfma_f32_16x16x32_bf16 v[212:215], v[4:7], v[188:191], v[212:215]
    v_sub_f32 v204, v204, v248
    v_sub_f32 v205, v205, v248
    v_mfma_f32_16x16x32_bf16 v[216:219], v[34:37], v[188:191], v[216:219]
    v_exp_f32 v204, v204
    v_mfma_f32_16x16x32_bf16 v[220:223], v[64:67], v[188:191], v[220:223]
    s_waitcnt lgkmcnt(1)
    v_exp_f32 v205, v205
    v_mfma_f32_16x16x32_bf16 v[224:227], a[248:251], v[188:191], v[224:227]
    v_sub_f32 v206, v206, v248
    v_sub_f32 v207, v207, v248
    v_mfma_f32_16x16x32_bf16 v[212:215], v[8:11], v[192:195], v[212:215]
    v_exp_f32 v206, v206
    v_mfma_f32_16x16x32_bf16 v[216:219], v[38:41], v[192:195], v[216:219]
    v_exp_f32 v207, v207
    v_mfma_f32_16x16x32_bf16 v[220:223], v[68:71], v[192:195], v[220:223]
    v_cvt_pk_bf16_f32 v180, v204, v205
    v_cvt_pk_bf16_f32 v183, v206, v207
    v_mfma_f32_16x16x32_bf16 v[224:227], a[248:251], v[192:195], v[224:227]
    v_sub_f32 v208, v208, v248
    v_sub_f32 v209, v209, v248
    v_mfma_f32_16x16x32_bf16 v[196:199], v[114:117], v[168:171], v[196:199]
    s_waitcnt lgkmcnt(0)
    v_exp_f32 v208, v208
    v_mfma_f32_16x16x32_bf16 v[196:199], v[116:119], v[170:173], v[196:199]
    v_exp_f32 v209, v209
    v_mfma_f32_16x16x32_bf16 v[200:203], v[150:153], v[168:171], v[200:203]
    v_sub_f32 v210, v210, v248
    v_sub_f32 v211, v211, v248
    v_mfma_f32_16x16x32_bf16 v[200:203], v[152:155], v[170:173], v[200:203]
    v_exp_f32 v210, v210
    v_exp_f32 v211, v211
    v_cvt_pk_bf16_f32 v181, v208, v209
    v_cvt_pk_bf16_f32 v184, v210, v211
    v_sub_f32 v196, v196, v248
    v_mfma_f32_16x16x32_bf16 v[212:215], v[12:15], v[180:183], v[212:215]
    v_exp_f32 v196, v196
    v_mfma_f32_16x16x32_bf16 v[216:219], v[42:45], v[180:183], v[216:219]
    v_sub_f32 v197, v197, v248
    v_sub_f32 v200, v200, v248
    v_mfma_f32_16x16x32_bf16 v[220:223], v[72:75], v[180:183], v[220:223]
    v_exp_f32 v197, v197
    v_mfma_f32_16x16x32_bf16 v[224:227], a[248:251], v[180:183], v[224:227]
    v_cvt_pk_bf16_f32 v186, v196, v197
    v_exp_f32 v200, v200
    v_sub_f32 v201, v201, v248
    v_exp_f32 v201, v201
    v_mov_b32 v185, 0
    v_cvt_pk_bf16_f32 v187, v200, v201
    v_add_u32 v204, 0xffffff40, v244
    v_cndmask_b32 v244, v244, v204, vcc
    v_mfma_f32_16x16x32_bf16 v[212:215], v[16:19], v[184:187], v[212:215]
    ds_read_b128 v[196:199], v244 offset:64
    v_add_u32 v205, 0xffffff40, v245
    v_mfma_f32_16x16x32_bf16 v[216:219], v[46:49], v[184:187], v[216:219]
    s_mov_b32 vcc_lo, 0xff00ff
    s_mov_b32 vcc_hi, 0xf000ff
    v_cndmask_b32 v245, v245, v205, vcc
    v_mfma_f32_16x16x32_bf16 v[220:223], v[76:79], v[184:187], v[220:223]
    ds_read_b128 v[204:207], v244 offset:0
    ds_read_b128 v[208:211], v245 offset:0
    v_mfma_f32_16x16x32_bf16 v[224:227], a[248:251], v[184:187], v[224:227]
    ds_read_b128 v[200:203], v245 offset:64
    v_mov_b32 v190, 0
    v_mov_b32 v193, 0
    v_mov_b32 v180, 0
    v_mov_b32 v183, 0
    v_mov_b32 v186, 0
    s_nop 1
    v_rcp_f32 v225, v224
    s_nop 0
    v_mul_f32 v212, v212, v225
    v_mul_f32 v213, v213, v225
    v_mul_f32 v214, v214, v225
    v_mul_f32 v215, v215, v225
    v_cvt_pk_bf16_f32 v212, v212, v213
    v_cvt_pk_bf16_f32 v213, v214, v215
    ds_write_b64 v247, v[212:213] offset:49152
    s_waitcnt lgkmcnt(4)
    v_mfma_f32_16x16x32_bf16 v[196:199], v[114:117], v[174:177], v[196:199]
    v_mul_f32 v216, v216, v225
    v_mul_f32 v217, v217, v225
    v_mfma_f32_16x16x32_bf16 v[196:199], v[116:119], v[176:179], v[196:199]
    s_waitcnt lgkmcnt(3)
    v_mul_f32 v218, v218, v225
    v_mul_f32 v219, v219, v225
    v_mfma_f32_16x16x32_bf16 v[204:207], v[138:141], v[174:177], v[204:207]
    s_waitcnt lgkmcnt(2)
    v_cvt_pk_bf16_f32 v216, v216, v217
    v_cvt_pk_bf16_f32 v217, v218, v219
    v_mfma_f32_16x16x32_bf16 v[204:207], v[140:143], v[176:179], v[204:207]
    ds_write_b64 v247, v[216:217] offset:49280
    v_mfma_f32_16x16x32_bf16 v[208:211], v[144:147], v[174:177], v[208:211]
    s_waitcnt lgkmcnt(2)
    v_mul_f32 v220, v220, v225
    v_mul_f32 v221, v221, v225
    v_mfma_f32_16x16x32_bf16 v[208:211], v[146:149], v[176:179], v[208:211]
    v_mul_f32 v222, v222, v225
    v_mul_f32 v223, v223, v225
    v_mfma_f32_16x16x32_bf16 v[200:203], v[150:153], v[174:177], v[200:203]
    v_cvt_pk_bf16_f32 v220, v220, v221
    v_cvt_pk_bf16_f32 v221, v222, v223
    v_mfma_f32_16x16x32_bf16 v[200:203], v[152:155], v[176:179], v[200:203]
    ds_write_b64 v247, v[220:221] offset:49408
    v_mfma_f32_16x16x32_bf16 v[236:239], a[144:147], a[224:227], 0
    v_max_f32 v248, v204, v205
    v_max3_f32 v248, v248, v206, v207
    v_mfma_f32_16x16x32_bf16 v[236:239], a[148:151], a[228:231], v[236:239]
    ds_read_b128 v[204:207], v244 offset:128
    v_max3_f32 v248, v248, v208, v209
    v_mfma_f32_16x16x32_bf16 v[236:239], a[152:155], a[232:235], v[236:239]
    v_max3_f32 v248, v248, v210, v211
    v_max3_f32 v248, v248, v196, v197
    v_mfma_f32_16x16x32_bf16 v[236:239], a[156:159], a[236:239], v[236:239]
    ds_read_b128 v[208:211], v245 offset:128
    v_max3_f32 v248, v248, v198, v199
    v_mfma_f32_16x16x32_bf16 v[236:239], a[160:163], a[240:243], v[236:239]
    ds_read_b128 v[196:199], v244 offset:0
    v_max3_f32 v248, v248, v200, v201
    v_mfma_f32_16x16x32_bf16 v[236:239], a[164:167], a[244:247], v[236:239]
    v_max3_f32 v248, v248, v202, v203
    v_mfma_f32_16x16x32_bf16 v[228:231], a[168:171], a[224:227], 0
    ds_read_b128 v[200:203], v245 offset:0
    v_mfma_f32_16x16x32_bf16 v[228:231], a[172:175], a[228:231], v[228:231]
    v_mfma_f32_16x16x32_bf16 v[228:231], a[176:179], a[232:235], v[228:231]
    v_mfma_f32_16x16x32_bf16 v[228:231], a[180:183], a[236:239], v[228:231]
    v_mfma_f32_16x16x32_bf16 v[228:231], a[184:187], a[240:243], v[228:231]
    s_waitcnt lgkmcnt(3)
    v_cvt_pk_bf16_f32 v236, v236, v237
    v_cvt_pk_bf16_f32 v237, v238, v239
    v_mfma_f32_16x16x32_bf16 v[204:207], v[120:123], v[174:177], v[204:207]
    ds_write_b64 v249, v[236:237] offset:24576
    v_mfma_f32_16x16x32_bf16 v[204:207], v[122:125], v[176:179], v[204:207]
    s_waitcnt lgkmcnt(2)
    v_mfma_f32_16x16x32_bf16 v[208:211], v[156:159], v[174:177], v[208:211]
    v_mfma_f32_16x16x32_bf16 v[208:211], v[158:161], v[176:179], v[208:211]
    s_waitcnt lgkmcnt(1)
    v_mfma_f32_16x16x32_bf16 v[196:199], v[138:141], v[174:177], v[196:199]
    v_mfma_f32_16x16x32_bf16 v[196:199], v[140:143], v[176:179], v[196:199]
    v_mfma_f32_16x16x32_bf16 v[200:203], v[144:147], v[174:177], v[200:203]
    v_mfma_f32_16x16x32_bf16 v[200:203], v[146:149], v[176:179], v[200:203]
    v_max3_f32 v248, v248, v204, v205
    v_max3_f32 v248, v248, v206, v207
    v_mfma_f32_16x16x32_bf16 v[228:231], a[188:191], a[244:247], v[228:231]
    ds_read_b128 v[204:207], v244 offset:64
    v_max3_f32 v248, v248, v208, v209
    v_mfma_f32_16x16x32_bf16 v[232:235], a[192:195], a[224:227], 0
    ds_read_b128 a[224:227], v242 offset:43136
    v_max3_f32 v248, v248, v210, v211
    v_mfma_f32_16x16x32_bf16 v[232:235], a[196:199], a[228:231], v[232:235]
    ds_read_b128 a[228:231], v243 offset:43136
    ds_read_b128 v[208:211], v245 offset:64
    v_mfma_f32_16x16x32_bf16 v[232:235], a[200:203], a[232:235], v[232:235]
    ds_read_b128 a[232:235], v242 offset:43264
    v_cvt_pk_bf16_f32 v228, v228, v229
    v_mfma_f32_16x16x32_bf16 v[232:235], a[204:207], a[236:239], v[232:235]
    ds_read_b128 a[236:239], v243 offset:43264
    v_cvt_pk_bf16_f32 v229, v230, v231
    v_mfma_f32_16x16x32_bf16 v[232:235], a[208:211], a[240:243], v[232:235]
    ds_write_b64 v249, v[228:229] offset:24704
    v_mfma_f32_16x16x32_bf16 v[232:235], a[212:215], a[244:247], v[232:235]
    v_mov_b32 v225, v248
    v_mfma_f32_16x16x32_bf16 v[236:239], a[144:147], a[216:219], 0
    v_mfma_f32_16x16x32_bf16 v[236:239], a[148:151], a[220:223], v[236:239]
    s_waitcnt lgkmcnt(6)
    v_permlane16_swap_b32 v248, v225
    v_max_f32 v248, v248, v225
    v_mfma_f32_16x16x32_bf16 v[204:207], v[114:117], v[174:177], v[204:207]
    s_waitcnt lgkmcnt(5)
    v_cvt_pk_bf16_f32 v232, v232, v233
    v_cvt_pk_bf16_f32 v233, v234, v235
    v_mfma_f32_16x16x32_bf16 v[204:207], v[116:119], v[176:179], v[204:207]
    ds_write_b64 v249, v[232:233] offset:24832
    v_mfma_f32_16x16x32_bf16 v[236:239], a[152:155], a[224:227], v[236:239]
    s_waitcnt lgkmcnt(4)
    v_mov_b32 v225, v248
    v_mfma_f32_16x16x32_bf16 v[208:211], v[150:153], v[174:177], v[208:211]
    v_mfma_f32_16x16x32_bf16 v[208:211], v[152:155], v[176:179], v[208:211]
    s_waitcnt lgkmcnt(3)
    v_permlane32_swap_b32 v248, v225
    v_max_f32 v248, v248, v225
    v_mfma_f32_16x16x32_bf16 v[236:239], a[156:159], a[228:231], v[236:239]
    s_waitcnt lgkmcnt(2)
    v_sub_f32 v196, v196, v248
    v_sub_f32 v197, v197, v248
    v_mfma_f32_16x16x32_bf16 v[236:239], a[160:163], a[232:235], v[236:239]
    v_exp_f32 v196, v196
    v_mfma_f32_16x16x32_bf16 v[236:239], a[164:167], a[236:239], v[236:239]
    v_exp_f32 v197, v197
    v_mfma_f32_16x16x32_bf16 v[228:231], a[168:171], a[216:219], 0
    v_sub_f32 v198, v198, v248
    v_sub_f32 v199, v199, v248
    v_mfma_f32_16x16x32_bf16 v[228:231], a[172:175], a[220:223], v[228:231]
    s_waitcnt lgkmcnt(0)
    s_barrier
    v_mfma_f32_16x16x32_bf16 v[228:231], a[176:179], a[224:227], v[228:231]
    ds_read_b128 a[240:243], v242 offset:49152
    v_cvt_pk_bf16_f32 v236, v236, v237
    v_mfma_f32_16x16x32_bf16 v[228:231], a[180:183], a[228:231], v[228:231]
    ds_read_b128 a[244:247], v243 offset:49152
    v_cvt_pk_bf16_f32 v237, v238, v239
    v_mfma_f32_16x16x32_bf16 v[228:231], a[184:187], a[232:235], v[228:231]
    ds_write_b64 v249, v[236:237] offset:0
    v_mfma_f32_16x16x32_bf16 v[228:231], a[188:191], a[236:239], v[228:231]
    ds_read_b128 a[252:255], v252 offset:12288
    ds_read_b64 v[254:255], v253 offset:12544
    v_mfma_f32_16x16x32_bf16 v[232:235], a[192:195], a[216:219], 0
    ds_read_b128 a[216:219], v242 offset:49280
    v_cvt_pk_bf16_f32 v188, v196, v197
    v_mfma_f32_16x16x32_bf16 v[232:235], a[196:199], a[220:223], v[232:235]
    ds_read_b128 a[220:223], v243 offset:49280
    v_sub_f32 v200, v200, v248
    v_mfma_f32_16x16x32_bf16 v[232:235], a[200:203], a[224:227], v[232:235]
    ds_read_b128 a[224:227], v242 offset:49408
    v_cvt_pk_bf16_f32 v228, v228, v229
    v_mfma_f32_16x16x32_bf16 v[232:235], a[204:207], a[228:231], v[232:235]
    ds_read_b128 a[228:231], v243 offset:49408
    v_cvt_pk_bf16_f32 v229, v230, v231
    v_mfma_f32_16x16x32_bf16 v[232:235], a[208:211], a[232:235], v[232:235]
    ds_write_b64 v249, v[228:229] offset:128
    v_mfma_f32_16x16x32_bf16 v[232:235], a[212:215], a[236:239], v[232:235]
    v_exp_f32 v198, v198
    v_exp_f32 v199, v199
    v_exp_f32 v200, v200
    v_cvt_pk_bf16_f32 v191, v198, v199
    ds_read_b128 v[196:199], v244 offset:128
    s_waitcnt lgkmcnt(6)
    buffer_store_dwordx4 a[252:255], v250, s[20:23], s55 offen nt
    v_sub_f32 v201, v201, v248
    v_cvt_pk_bf16_f32 v232, v232, v233
    v_cvt_pk_bf16_f32 v233, v234, v235
    ds_write_b64 v249, v[232:233] offset:256
    ds_read_b128 a[252:255], v252 offset:18432
    buffer_store_dwordx2 v[254:255], v251, s[20:23], s55 offen offset:256 nt
    ds_read_b64 v[254:255], v253 offset:18688
    s_mul_i32 s55, s31, 11
    s_add_u32 s54, s54, s55
    s_add_u32 s54, s54, s32
    s_lshr_b32 s55, s28, 1
    s_lshl2_add_u32 s55, s55, 11
    s_mul_i32 s55, s55, s31
    v_exp_f32 v201, v201
    v_sub_f32 v202, v202, v248
    s_waitcnt lgkmcnt(3)
    v_mfma_f32_16x16x32_bf16 v[196:199], v[120:123], v[174:177], v[196:199]
    v_exp_f32 v202, v202
    v_mfma_f32_16x16x32_bf16 v[196:199], v[122:125], v[176:179], v[196:199]
    v_sub_f32 v203, v203, v248
    v_exp_f32 v203, v203
    v_cvt_pk_bf16_f32 v189, v200, v201
    v_cvt_pk_bf16_f32 v192, v202, v203
    ds_read_b128 v[200:203], v245 offset:128
    v_mfma_f32_16x16x32_bf16 v[212:215], v[12:15], v[188:191], 0
    s_waitcnt lgkmcnt(3)
    s_waitcnt lgkmcnt(2)
    s_barrier
    v_mfma_f32_16x16x32_bf16 v[216:219], v[42:45], v[188:191], 0
    s_mov_b32 exec_hi, 0
    buffer_store_dwordx4 a[252:255], v250, s[20:23], s57 offen nt
    s_mov_b32 exec_hi, -1
    v_mfma_f32_16x16x32_bf16 v[220:223], v[72:75], v[188:191], 0
    s_waitcnt lgkmcnt(1)
    v_sub_f32 v204, v204, v248
    v_sub_f32 v205, v205, v248
    v_mfma_f32_16x16x32_bf16 v[224:227], a[248:251], v[188:191], 0
    v_exp_f32 v204, v204
    v_exp_f32 v205, v205
    s_mov_b32 exec_hi, 0
    buffer_store_dwordx2 v[254:255], v251, s[20:23], s57 offen offset:256 nt
    s_mov_b32 exec_hi, -1
    s_waitcnt lgkmcnt(0)
    v_mfma_f32_16x16x32_bf16 v[200:203], v[156:159], v[174:177], v[200:203]
    s_mul_i32 s57, s31, 15
    s_add_u32 s56, s56, s57
    s_add_u32 s56, s56, s32
    v_mfma_f32_16x16x32_bf16 v[200:203], v[158:161], v[176:179], v[200:203]
    v_sub_f32 v206, v206, v248
    v_exp_f32 v206, v206
    v_sub_f32 v207, v207, v248
    s_mov_b32 exec_lo, 0
    buffer_store_dwordx4 a[252:255], v250, s[20:23], s52 offen nt
    s_mov_b32 exec_lo, -1
    v_exp_f32 v207, v207
    v_cvt_pk_bf16_f32 v194, v204, v205
    ds_read_b128 a[252:255], v252 offset:24576
    v_cvt_pk_bf16_f32 v181, v206, v207
    v_sub_f32 v208, v208, v248
    v_exp_f32 v208, v208
    s_mov_b32 exec_lo, 0
    buffer_store_dwordx2 v[254:255], v251, s[20:23], s52 offen offset:256 nt
    s_mov_b32 exec_lo, -1
    ds_read_b64 v[254:255], v253 offset:24832
    s_lshr_b32 s52, s28, 1
    s_lshl2_add_u32 s52, s52, 3
    s_mul_i32 s52, s52, s31
    s_add_u32 s51, s51, s52
    s_add_u32 s51, s51, s32
    v_sub_f32 v209, v209, v248
    v_exp_f32 v209, v209
    v_sub_f32 v210, v210, v248
    v_exp_f32 v210, v210
    v_sub_f32 v211, v211, v248
    v_exp_f32 v211, v211
    v_cvt_pk_bf16_f32 v195, v208, v209
    v_cvt_pk_bf16_f32 v182, v210, v211
    v_sub_f32 v196, v196, v248
    v_mfma_f32_16x16x32_bf16 v[212:215], v[16:19], v[192:195], v[212:215]
    v_exp_f32 v196, v196
    v_mfma_f32_16x16x32_bf16 v[216:219], v[46:49], v[192:195], v[216:219]
    s_waitcnt lgkmcnt(1)
    v_sub_f32 v197, v197, v248
    v_sub_f32 v198, v198, v248
    v_mfma_f32_16x16x32_bf16 v[220:223], v[76:79], v[192:195], v[220:223]
    buffer_store_dwordx4 a[252:255], v250, s[20:23], s54 offen nt
    v_mfma_f32_16x16x32_bf16 v[224:227], a[248:251], v[192:195], v[224:227]
    s_waitcnt lgkmcnt(0)
    ds_read_b128 a[252:255], v252 offset:0
    v_mfma_f32_16x16x32_bf16 v[212:215], v[20:23], v[180:183], v[212:215]
    v_exp_f32 v197, v197
    v_mfma_f32_16x16x32_bf16 v[216:219], v[50:53], v[180:183], v[216:219]
    buffer_store_dwordx2 v[254:255], v251, s[20:23], s54 offen offset:256 nt
    v_mfma_f32_16x16x32_bf16 v[220:223], v[80:83], v[180:183], v[220:223]
    ds_read_b64 v[254:255], v253 offset:256
    s_and_b32 s54, s28, 1
    v_mfma_f32_16x16x32_bf16 v[224:227], a[248:251], v[180:183], v[224:227]
    s_add_u32 s54, s54, 15
    s_mul_i32 s54, s54, s30
    s_add_u32 s54, s54, s55
    s_add_u32 s54, s54, s32
    v_exp_f32 v198, v198
    v_sub_f32 v199, v199, v248
    v_exp_f32 v199, v199
    v_cvt_pk_bf16_f32 v184, v196, v197
    v_cvt_pk_bf16_f32 v187, v198, v199
    v_sub_f32 v200, v200, v248
    v_exp_f32 v200, v200
    v_sub_f32 v201, v201, v248
    v_exp_f32 v201, v201
    s_waitcnt lgkmcnt(1)
    s_mov_b32 exec_hi, 0
    buffer_store_dwordx4 a[252:255], v250, s[20:23], s56 offen nt
    s_mov_b32 exec_hi, -1
    v_sub_f32 v202, v202, v248
    v_exp_f32 v202, v202
    v_sub_f32 v203, v203, v248
    v_exp_f32 v203, v203
    s_waitcnt lgkmcnt(0)
    v_cvt_pk_bf16_f32 v185, v200, v201
    v_cvt_pk_bf16_f32 v188, v202, v203
    s_mov_b32 exec_hi, 0
    buffer_store_dwordx2 v[254:255], v251, s[20:23], s56 offen offset:256 nt
    s_mov_b32 exec_hi, -1
    v_mfma_f32_16x16x32_bf16 v[212:215], v[24:27], v[184:187], v[212:215]
    v_mov_b32 v189, 0
    v_mov_b32 v191, 0
    v_mfma_f32_16x16x32_bf16 v[216:219], v[54:57], v[184:187], v[216:219]
    v_mfma_f32_16x16x32_bf16 v[220:223], v[84:87], v[184:187], v[220:223]
    v_mfma_f32_16x16x32_bf16 v[224:227], a[248:251], v[184:187], v[224:227]
    v_mfma_f32_16x16x32_bf16 v[212:215], v[28:31], v[188:191], v[212:215]
    v_mfma_f32_16x16x32_bf16 v[216:219], v[58:61], v[188:191], v[216:219]
    v_mfma_f32_16x16x32_bf16 v[220:223], v[88:91], v[188:191], v[220:223]
    v_mfma_f32_16x16x32_bf16 v[224:227], a[248:251], v[188:191], v[224:227]
    s_nop 7
    v_rcp_f32 v225, v224
    s_nop 0
    v_mul_f32 v212, v212, v225
    v_mul_f32 v213, v213, v225
    v_mul_f32 v214, v214, v225
    v_mul_f32 v215, v215, v225
    v_cvt_pk_bf16_f32 v212, v212, v213
    v_cvt_pk_bf16_f32 v213, v214, v215
    ds_write_b64 v247, v[212:213] offset:55296
    v_mul_f32 v216, v216, v225
    v_mul_f32 v217, v217, v225
    v_mul_f32 v218, v218, v225
    v_mul_f32 v219, v219, v225
    v_cvt_pk_bf16_f32 v216, v216, v217
    v_cvt_pk_bf16_f32 v217, v218, v219
    ds_write_b64 v247, v[216:217] offset:55424
    v_mul_f32 v220, v220, v225
    v_mul_f32 v221, v221, v225
    v_mul_f32 v222, v222, v225
    v_mul_f32 v223, v223, v225
    v_cvt_pk_bf16_f32 v220, v220, v221
    v_cvt_pk_bf16_f32 v221, v222, v223
    ds_write_b64 v247, v[220:221] offset:55552
    v_mfma_f32_16x16x32_bf16 v[236:239], a[144:147], a[240:243], 0
    v_mfma_f32_16x16x32_bf16 v[236:239], a[148:151], a[244:247], v[236:239]
    v_mfma_f32_16x16x32_bf16 v[236:239], a[152:155], a[216:219], v[236:239]
    v_mfma_f32_16x16x32_bf16 v[236:239], a[156:159], a[220:223], v[236:239]
    v_mfma_f32_16x16x32_bf16 v[236:239], a[160:163], a[224:227], v[236:239]
    v_mfma_f32_16x16x32_bf16 v[236:239], a[164:167], a[228:231], v[236:239]
    v_mfma_f32_16x16x32_bf16 v[228:231], a[168:171], a[240:243], 0
    v_mfma_f32_16x16x32_bf16 v[228:231], a[172:175], a[244:247], v[228:231]
    v_mfma_f32_16x16x32_bf16 v[228:231], a[176:179], a[216:219], v[228:231]
    v_mfma_f32_16x16x32_bf16 v[228:231], a[180:183], a[220:223], v[228:231]
    v_mfma_f32_16x16x32_bf16 v[228:231], a[184:187], a[224:227], v[228:231]
    v_mfma_f32_16x16x32_bf16 v[228:231], a[188:191], a[228:231], v[228:231]
    v_mfma_f32_16x16x32_bf16 v[232:235], a[192:195], a[240:243], 0
    v_mfma_f32_16x16x32_bf16 v[232:235], a[196:199], a[244:247], v[232:235]
    v_cvt_pk_bf16_f32 v236, v236, v237
    v_cvt_pk_bf16_f32 v237, v238, v239
    v_mfma_f32_16x16x32_bf16 v[232:235], a[200:203], a[216:219], v[232:235]
    ds_write_b64 v249, v[236:237] offset:6144
    v_mfma_f32_16x16x32_bf16 v[232:235], a[204:207], a[220:223], v[232:235]
    v_mfma_f32_16x16x32_bf16 v[232:235], a[208:211], a[224:227], v[232:235]
    v_cvt_pk_bf16_f32 v228, v228, v229
    v_cvt_pk_bf16_f32 v229, v230, v231
    v_mfma_f32_16x16x32_bf16 v[232:235], a[212:215], a[228:231], v[232:235]
    ds_write_b64 v249, v[228:229] offset:6272
    s_nop 6
    v_cvt_pk_bf16_f32 v232, v232, v233
    v_cvt_pk_bf16_f32 v233, v234, v235
    ds_write_b64 v249, v[232:233] offset:6400
    s_waitcnt lgkmcnt(0)
    s_barrier
    ds_read_b128 a[232:235], v242 offset:55296
    ds_read_b128 a[236:239], v243 offset:55296
    ds_read_b128 a[240:243], v242 offset:55424
    ds_read_b128 a[244:247], v243 offset:55424
    ds_read_b128 a[216:219], v242 offset:55552
    ds_read_b128 a[220:223], v243 offset:55552
    ds_read_b128 a[252:255], v252 offset:6144
    ds_read_b64 v[254:255], v253 offset:6400
    s_waitcnt lgkmcnt(7)
    v_mfma_f32_16x16x32_bf16 v[236:239], a[144:147], a[232:235], 0
    v_mfma_f32_16x16x32_bf16 v[228:231], a[168:171], a[232:235], 0
    s_waitcnt lgkmcnt(6)
    v_mfma_f32_16x16x32_bf16 v[236:239], a[148:151], a[236:239], v[236:239]
    s_waitcnt lgkmcnt(5)
    v_mfma_f32_16x16x32_bf16 v[236:239], a[152:155], a[240:243], v[236:239]
    s_waitcnt lgkmcnt(4)
    v_mfma_f32_16x16x32_bf16 v[236:239], a[156:159], a[244:247], v[236:239]
    s_waitcnt lgkmcnt(3)
    v_mfma_f32_16x16x32_bf16 v[236:239], a[160:163], a[216:219], v[236:239]
    s_waitcnt lgkmcnt(2)
    v_mfma_f32_16x16x32_bf16 v[236:239], a[164:167], a[220:223], v[236:239]
    s_waitcnt lgkmcnt(0)
    v_mfma_f32_16x16x32_bf16 v[228:231], a[172:175], a[236:239], v[228:231]
    buffer_store_dwordx4 a[252:255], v250, s[20:23], s51 offen nt
    v_mfma_f32_16x16x32_bf16 v[228:231], a[176:179], a[240:243], v[228:231]
    v_mfma_f32_16x16x32_bf16 v[228:231], a[180:183], a[244:247], v[228:231]
    v_mfma_f32_16x16x32_bf16 v[228:231], a[184:187], a[216:219], v[228:231]
    buffer_store_dwordx2 v[254:255], v251, s[20:23], s51 offen offset:256 nt
    v_mfma_f32_16x16x32_bf16 v[228:231], a[188:191], a[220:223], v[228:231]
    v_cvt_pk_bf16_f32 v236, v236, v237
    v_cvt_pk_bf16_f32 v237, v238, v239
    v_mfma_f32_16x16x32_bf16 v[232:235], a[192:195], a[232:235], 0
    ds_write_b64 v249, v[236:237] offset:12288
    v_mfma_f32_16x16x32_bf16 v[232:235], a[196:199], a[236:239], v[232:235]
    v_mfma_f32_16x16x32_bf16 v[232:235], a[200:203], a[240:243], v[232:235]
    v_mfma_f32_16x16x32_bf16 v[232:235], a[204:207], a[244:247], v[232:235]
    v_mfma_f32_16x16x32_bf16 v[232:235], a[208:211], a[216:219], v[232:235]
    v_cvt_pk_bf16_f32 v228, v228, v229
    v_cvt_pk_bf16_f32 v229, v230, v231
    v_mfma_f32_16x16x32_bf16 v[232:235], a[212:215], a[220:223], v[232:235]
    ds_write_b64 v249, v[228:229] offset:12416
    s_nop 6
    v_cvt_pk_bf16_f32 v232, v232, v233
    v_cvt_pk_bf16_f32 v233, v234, v235
    ds_write_b64 v249, v[232:233] offset:12544
    s_waitcnt lgkmcnt(0)
    s_barrier
    ds_read_b128 a[8:11], v252 offset:12288
    ds_read_b64 a[12:13], v253 offset:12544
    s_waitcnt lgkmcnt(1)
    s_mov_b32 exec_hi, s53
    buffer_store_dwordx4 a[8:11], v250, s[20:23], s54 offen nt
    s_mov_b32 exec_hi, -1
    s_waitcnt lgkmcnt(0)
    s_mov_b32 exec_hi, s53
    buffer_store_dwordx2 a[12:13], v251, s[20:23], s54 offen offset:256 nt
    s_mov_b32 exec_hi, -1
    s_endpgm
.section .rodata,"a"
.p2align 6
.amdhsa_kernel standalone__neighborhood_dinat__vision_kernel
  .amdhsa_next_free_vgpr 512
  .amdhsa_next_free_sgpr 102
  .amdhsa_accum_offset 256
  .amdhsa_group_segment_fixed_size 0
  .amdhsa_kernarg_size 56
  .amdhsa_user_sgpr_count 2
  .amdhsa_user_sgpr_kernarg_segment_ptr 1
  .amdhsa_system_sgpr_workgroup_id_x 1
.end_amdhsa_kernel
```
